```python
import torch

def _softmax(x, axis=-1):
    return torch.softmax(x, dim=axis)
def _gelu(x):
    return torch.nn.functional.gelu(x, approximate="tanh")
def _silu(x):
    return torch.nn.functional.silu(x)
def _sigmoid(x):
    return torch.sigmoid(x)
def _layernorm(x, axis=-1, eps=1e-5):
    m = x.mean(dim=axis, keepdim=True)
    v = x.var(dim=axis, keepdim=True, unbiased=False)
    return (x - m) / torch.sqrt(v + eps)
def _scatter_add(tgt, idx, src, axis=0):
    return tgt.clone().index_add_(axis, idx, src)
def _segment_sum(src, seg, n):
    out = torch.zeros((n,) + src.shape[1:], dtype=src.dtype)
    return out.index_add_(0, seg, src)
def _pad(x, pw):
    flat = tuple(v for pair in reversed(pw) for v in pair)
    return torch.nn.functional.pad(x, flat)

kernel_name = 'standalone__molecular_angular_gemnet__graph'

def setup_inputs():

    _w = (lambda a: (lambda t: t.to(torch.bfloat16) if t.is_floating_point() else t)(torch.as_tensor(a)))
    N, deg, De, L = 12500, 64, 4, 1
    E = N * deg
    T = E * deg
    NR = 8
    dist = torch.rand(E).to(float)
    angle = (torch.rand(T) * torch.pi).to(float)
    centers = torch.linspace(0.0, 1.0, NR).to(float)
    ang_freq = torch.arange(1, L + 1).to(float)
    return {
        "m": _w((lambda *s: torch.randn(*s, dtype=torch.bfloat16) * 0.05)(E, De)),
        "idx_in": _w((lambda lo, hi, *s: torch.randint(lo, hi, s))(0, E, T).to(torch.int64)),
        "idx_out": _w((lambda lo, hi, *s: torch.randint(lo, hi, s))(0, E, T).to(torch.int64)),
        "dist": _w(dist),
        "angle": _w(angle),
        "centers": _w(centers),
        "ang_freq": _w(ang_freq),
        "w_rbf": _w((lambda *s: torch.randn(*s, dtype=torch.bfloat16) * 0.2)(NR, De)),
        "w_sbf": _w((lambda *s: torch.randn(*s, dtype=torch.bfloat16) * 0.2)(NR * L, De)),
        "w_down": _w((lambda *s: torch.randn(*s, dtype=torch.bfloat16) * 0.2)(De, De)),
        "w_up": _w((lambda *s: torch.randn(*s, dtype=torch.bfloat16) * 0.2)(De, De)),
    }

def reference(m, idx_in, idx_out, dist, angle, centers, ang_freq, w_rbf, w_sbf, w_down, w_up):
    E, De = m.shape[0], m.shape[1]
    NR = centers.shape[0]
    L = ang_freq.shape[0]
    rbf = torch.exp(-10.0 * (dist[:, None] - centers[None, :]) ** 2)
    cbf = torch.cos(ang_freq[None, :] * angle[:, None])
    rbf_t = rbf[idx_out]
    sbf = torch.reshape(rbf_t[:, :, None] * cbf[:, None, :], (-1, NR * L))
    x = (m[idx_in] @ w_down) * (sbf @ w_sbf)
    agg = _segment_sum(x, idx_out, E)
    return m + (agg @ w_up) * (rbf @ w_rbf)
```

```asm
; @launch kernel=p1_kernel grid=(256,1,1) block=(1024,1,1) lds=161280
; @launch kernel=p2_kernel grid=(256,1,1) block=(1024,1,1) lds=154368
; @launch kernel=p3_kernel grid=(3125,1,1) block=(256,1,1) lds=0
.amdgcn_target "amdgcn-amd-amdhsa--gfx950"
.text
.globl p1_kernel
.p2align 8
.type p1_kernel,@function
p1_kernel:
    s_cmp_ge_u32 s2, 256
    s_cbranch_scc1 p1_end
    s_load_dwordx2 s[52:53], s[0:1], 0
    s_load_dwordx4 s[56:59], s[0:1], 8
    s_load_dwordx2 s[54:55], s[0:1], 32
    s_load_dwordx2 s[60:61], s[0:1], 48
    s_load_dwordx2 s[48:49], s[0:1], 104
    v_lshlrev_b32 v1, 4, v0
    v_lshlrev_b32 v2, 3, v0
    v_mov_b32 v3, 1
    v_lshrrev_b32 v117, 6, v0
    s_nop 0
    v_readfirstlane_b32 s28, v117
    s_waitcnt lgkmcnt(0)
    s_load_dword s41, s[60:61], 0
    s_mov_b32 s24, s52
    s_and_b32 s25, s53, 0xffff
    s_mov_b32 s26, 6400000
    s_mov_b32 s27, 0x20000
    s_mov_b32 s4, s56
    s_and_b32 s5, s57, 0xffff
    s_mov_b32 s6, 204800000
    s_mov_b32 s7, 0x20000
    s_mov_b32 s8, s58
    s_and_b32 s9, s59, 0xffff
    s_mov_b32 s10, 204800000
    s_mov_b32 s11, 0x20000
    s_mov_b32 s12, s54
    s_and_b32 s13, s55, 0xffff
    s_mov_b32 s14, 102400000
    s_mov_b32 s15, 0x20000
    s_mov_b32 s16, s48
    s_and_b32 s17, s49, 0xffff
    s_mov_b32 s18, 819200000
    s_mov_b32 s19, 0x20000
    s_mov_b32 s20, s48
    s_and_b32 s21, s49, 0xffff
    s_mov_b32 s22, 0
    s_mov_b32 s23, 0x20000
    s_mov_b32 s36, 643152
    s_mov_b32 s37, 107192
    s_mov_b32 s38, 687195
    s_mov_b32 s39, -53423
    s_mov_b32 s40, -6250
    s_mov_b32 s42, 0x03800000
    s_mov_b32 s43, 8323199
    s_mov_b32 s44, 4294901760
    s_mov_b32 s45, 3758096384
    s_waitcnt lgkmcnt(0)
    s_lshl_b32 s41, s41, 16
    s_mov_b32 s46, 0
    s_cmp_lt_u32 s46, 5
    s_cselect_b32 s34, 7, 6
    s_mul_i32 s47, s46, 391
    s_sub_i32 s50, s46, 5
    s_max_i32 s50, s50, 0
    s_sub_u32 s47, s47, s50
    s_lshl_b32 s47, s47, 8
    s_add_u32 s50, s34, 384
    s_mul_i32 s50, s50, s2
    s_add_u32 s47, s47, s50
    s_lshl_b32 s30, s47, 8
    s_lshl_b32 s31, s47, 7
    s_add_u32 s32, s30, 0
    buffer_load_dwordx4 v[4:7], v1, s[4:7], s32 offen nt
    buffer_load_dwordx4 v[28:31], v1, s[8:11], s32 offen nt
    s_add_u32 s32, s31, 0
    buffer_load_dwordx2 v[52:53], v2, s[12:15], s32 offen nt
    s_add_u32 s32, s30, 16384
    buffer_load_dwordx4 v[8:11], v1, s[4:7], s32 offen nt
    buffer_load_dwordx4 v[32:35], v1, s[8:11], s32 offen nt
    s_add_u32 s32, s31, 8192
    buffer_load_dwordx2 v[54:55], v2, s[12:15], s32 offen nt
    s_add_u32 s32, s30, 32768
    buffer_load_dwordx4 v[12:15], v1, s[4:7], s32 offen nt
    buffer_load_dwordx4 v[36:39], v1, s[8:11], s32 offen nt
    s_add_u32 s32, s31, 16384
    buffer_load_dwordx2 v[56:57], v2, s[12:15], s32 offen nt
    s_add_u32 s32, s30, 49152
    buffer_load_dwordx4 v[16:19], v1, s[4:7], s32 offen nt
    buffer_load_dwordx4 v[40:43], v1, s[8:11], s32 offen nt
    s_add_u32 s32, s31, 24576
    buffer_load_dwordx2 v[58:59], v2, s[12:15], s32 offen nt
    s_add_u32 s32, s30, 65536
    buffer_load_dwordx4 v[20:23], v1, s[4:7], s32 offen nt
    buffer_load_dwordx4 v[44:47], v1, s[8:11], s32 offen nt
    s_add_u32 s32, s31, 32768
    buffer_load_dwordx2 v[60:61], v2, s[12:15], s32 offen nt
    s_add_u32 s32, s30, 81920
    buffer_load_dwordx4 v[24:27], v1, s[4:7], s32 offen nt
    buffer_load_dwordx4 v[48:51], v1, s[8:11], s32 offen nt
    s_add_u32 s32, s31, 40960
    buffer_load_dwordx2 v[62:63], v2, s[12:15], s32 offen nt
    s_cmp_lt_u32 s28, s34
    s_cselect_b32 s46, 0, 0x40000000
    v_lshl_add_u32 v117, v0, 2, s46
    s_add_u32 s32, s30, 98304
    buffer_load_dword v64, v117, s[4:7], s32 offen nt
    buffer_load_dword v65, v117, s[8:11], s32 offen nt
    v_lshrrev_b32 v117, 1, v117
    s_add_u32 s32, s31, 49152
    buffer_load_ushort v66, v117, s[12:15], s32 offen nt
    v_mov_b32 v68, 0
    v_mov_b32 v69, 0
    v_mov_b32 v70, 0
    v_mov_b32 v71, 0
    ds_write_b128 v1, v[68:71] offset:0
    v_and_b32 v118, 63, v0
    v_mov_b32 v121, 0
    v_mov_b32 v122, 0
    s_lshl_b32 s52, s2, 4
    s_add_u32 s52, s52, s28
    s_mov_b32 s57, 0x7fff7fff
    s_mul_hi_u32 s54, s52, 89478486
    s_mul_i32 s55, s54, 48
    s_sub_u32 s55, s52, s55
    s_mul_i32 s55, s55, 1024
    s_add_u32 s55, s55, 0
    s_mul_i32 s56, s54, 53424
    s_add_u32 s56, s56, s55
    v_lshl_add_u32 v119, v118, 2, s56
    s_mul_i32 s56, s54, 53760
    s_add_u32 s56, s56, s55
    s_add_u32 s56, s56, 340000768
    v_lshl_add_u32 v120, v118, 4, s56
    buffer_load_dword v72, v119, s[24:27], 0 offen offset:0
    buffer_load_dword v73, v119, s[24:27], 0 offen offset:256
    buffer_load_dword v74, v119, s[24:27], 0 offen offset:512
    buffer_load_dword v75, v119, s[24:27], 0 offen offset:768
    s_waitcnt vmcnt(0)
    buffer_store_dwordx4 v[72:75], v120, s[16:19], 0 offen
    v_and_b32 v123, s57, v72
    v_pk_max_u16 v121, v121, v123
    v_lshlrev_b32 v124, 16, v123
    v_and_b32 v123, s44, v123
    v_add_f32 v122, v122, v124
    v_add_f32 v122, v122, v123
    v_and_b32 v123, s57, v73
    v_pk_max_u16 v121, v121, v123
    v_lshlrev_b32 v124, 16, v123
    v_and_b32 v123, s44, v123
    v_add_f32 v122, v122, v124
    v_add_f32 v122, v122, v123
    v_and_b32 v123, s57, v74
    v_pk_max_u16 v121, v121, v123
    v_lshlrev_b32 v124, 16, v123
    v_and_b32 v123, s44, v123
    v_add_f32 v122, v122, v124
    v_add_f32 v122, v122, v123
    v_and_b32 v123, s57, v75
    v_pk_max_u16 v121, v121, v123
    v_lshlrev_b32 v124, 16, v123
    v_and_b32 v123, s44, v123
    v_add_f32 v122, v122, v124
    v_add_f32 v122, v122, v123
    s_cmp_ge_u32 s52, 1664
    s_cbranch_scc1 p1_m2
    s_add_u32 s53, s52, 4096
    s_mul_hi_u32 s54, s53, 89478486
    s_mul_i32 s55, s54, 48
    s_sub_u32 s55, s53, s55
    s_mul_i32 s55, s55, 1024
    s_add_u32 s55, s55, 0
    s_mul_i32 s56, s54, 53424
    s_add_u32 s56, s56, s55
    v_lshl_add_u32 v119, v118, 2, s56
    s_mul_i32 s56, s54, 53760
    s_add_u32 s56, s56, s55
    s_add_u32 s56, s56, 340000768
    v_lshl_add_u32 v120, v118, 4, s56
    buffer_load_dword v72, v119, s[24:27], 0 offen offset:0
    buffer_load_dword v73, v119, s[24:27], 0 offen offset:256
    buffer_load_dword v74, v119, s[24:27], 0 offen offset:512
    buffer_load_dword v75, v119, s[24:27], 0 offen offset:768
    s_waitcnt vmcnt(0)
    buffer_store_dwordx4 v[72:75], v120, s[16:19], 0 offen
    v_and_b32 v123, s57, v72
    v_pk_max_u16 v121, v121, v123
    v_lshlrev_b32 v124, 16, v123
    v_and_b32 v123, s44, v123
    v_add_f32 v122, v122, v124
    v_add_f32 v122, v122, v123
    v_and_b32 v123, s57, v73
    v_pk_max_u16 v121, v121, v123
    v_lshlrev_b32 v124, 16, v123
    v_and_b32 v123, s44, v123
    v_add_f32 v122, v122, v124
    v_add_f32 v122, v122, v123
    v_and_b32 v123, s57, v74
    v_pk_max_u16 v121, v121, v123
    v_lshlrev_b32 v124, 16, v123
    v_and_b32 v123, s44, v123
    v_add_f32 v122, v122, v124
    v_add_f32 v122, v122, v123
    v_and_b32 v123, s57, v75
    v_pk_max_u16 v121, v121, v123
    v_lshlrev_b32 v124, 16, v123
    v_and_b32 v123, s44, v123
    v_add_f32 v122, v122, v124
    v_add_f32 v122, v122, v123
    s_branch p1_m3
p1_m2:
    s_sub_u32 s53, s52, 1664
    s_cmp_ge_u32 s53, 1080
    s_cbranch_scc1 p1_m3
    s_mul_hi_u32 s54, s53, 477218589
    s_mul_i32 s55, s54, 9
    s_sub_u32 s55, s53, s55
    s_mul_i32 s55, s55, 512
    s_add_u32 s55, s55, 49152
    s_mul_i32 s56, s54, 53424
    s_add_u32 s56, s56, s55
    v_lshl_add_u32 v119, v118, 2, s56
    s_mul_i32 s56, s54, 53760
    s_add_u32 s56, s56, s55
    s_add_u32 s56, s56, 340000768
    v_lshl_add_u32 v120, v118, 3, s56
    buffer_load_dword v72, v119, s[24:27], 0 offen offset:0
    buffer_load_dword v73, v119, s[24:27], 0 offen offset:256
    s_waitcnt vmcnt(0)
    buffer_store_dwordx2 v[72:73], v120, s[16:19], 0 offen
    v_and_b32 v123, s57, v72
    v_pk_max_u16 v121, v121, v123
    v_lshlrev_b32 v124, 16, v123
    v_and_b32 v123, s44, v123
    v_add_f32 v122, v122, v124
    v_add_f32 v122, v122, v123
    v_and_b32 v123, s57, v73
    v_pk_max_u16 v121, v121, v123
    v_lshlrev_b32 v124, 16, v123
    v_and_b32 v123, s44, v123
    v_add_f32 v122, v122, v124
    v_add_f32 v122, v122, v123
p1_m3:
    v_lshrrev_b32 v123, 16, v121
    v_and_b32 v121, 0xffff, v121
    v_max_u32 v121, v121, v123
    s_nop 1
    v_max_u32_dpp v121, v121, v121 row_shr:1 row_mask:0xf bank_mask:0xf bound_ctrl:0
    v_add_f32_dpp v122, v122, v122 row_shr:1 row_mask:0xf bank_mask:0xf bound_ctrl:0
    s_nop 0
    v_max_u32_dpp v121, v121, v121 row_shr:2 row_mask:0xf bank_mask:0xf bound_ctrl:0
    v_add_f32_dpp v122, v122, v122 row_shr:2 row_mask:0xf bank_mask:0xf bound_ctrl:0
    s_nop 0
    v_max_u32_dpp v121, v121, v121 row_shr:4 row_mask:0xf bank_mask:0xf bound_ctrl:0
    v_add_f32_dpp v122, v122, v122 row_shr:4 row_mask:0xf bank_mask:0xf bound_ctrl:0
    s_nop 0
    v_max_u32_dpp v121, v121, v121 row_shr:8 row_mask:0xf bank_mask:0xf bound_ctrl:0
    v_add_f32_dpp v122, v122, v122 row_shr:8 row_mask:0xf bank_mask:0xf bound_ctrl:0
    s_nop 0
    v_max_u32_dpp v121, v121, v121 row_bcast:15 row_mask:0xa bank_mask:0xf
    v_add_f32_dpp v122, v122, v122 row_bcast:15 row_mask:0xa bank_mask:0xf
    s_nop 0
    v_max_u32_dpp v121, v121, v121 row_bcast:31 row_mask:0xc bank_mask:0xf
    v_add_f32_dpp v122, v122, v122 row_bcast:31 row_mask:0xc bank_mask:0xf
    s_nop 0
    s_nop 0
    v_mov_b32 v72, v121
    v_mov_b32 v73, v122
    s_lshl_b32 s52, s52, 3
    s_add_u32 s52, s52, 346451968
    v_mov_b32 v120, s52
    v_cmp_eq_u32 vcc, 63, v118
    s_and_saveexec_b64 s[54:55], vcc
    buffer_store_dwordx2 v[72:73], v120, s[16:19], 0 offen
    s_mov_b64 exec, -1
    s_mov_b32 s29, 0
    s_waitcnt vmcnt(0) lgkmcnt(0)
    s_barrier
p1_tile:
    s_mov_b32 s33, s34
    s_add_u32 s46, s29, 1
    s_cmp_lt_u32 s46, 5
    s_cselect_b32 s34, 7, 6
    s_mul_i32 s47, s46, 391
    s_sub_i32 s50, s46, 5
    s_max_i32 s50, s50, 0
    s_sub_u32 s47, s47, s50
    s_lshl_b32 s47, s47, 8
    s_add_u32 s50, s34, 384
    s_mul_i32 s50, s50, s2
    s_add_u32 s47, s47, s50
    s_lshl_b32 s30, s47, 8
    s_lshl_b32 s31, s47, 7
    s_cmp_lt_u32 s46, 8
    s_cselect_b32 s6, 204800000, 0
    s_cselect_b32 s10, 204800000, 0
    s_cselect_b32 s14, 102400000, 0
    s_cselect_b32 s30, s30, 0
    s_cselect_b32 s31, s31, 0
    v_mov_b32 v68, 0
    v_mov_b32 v69, 0
    v_mov_b32 v70, 0
    v_mov_b32 v71, 0
    ds_write_b128 v1, v[68:71] offset:10496
    ds_write_b128 v1, v[68:71] offset:26880
    s_waitcnt vmcnt(10)
    v_lshlrev_b32 v117, 16, v52
    v_and_b32 v118, s44, v52
    v_mul_f32 v117, s41, v117
    v_mul_f32 v118, s41, v118
    v_cvt_pk_bf16_f32 v117, v117, v118
    v_and_b32 v118, s44, v117
    v_lshlrev_b32 v117, 16, v117
    v_mul_f32 v117, 0.15915494, v117
    v_mul_f32 v118, 0.15915494, v118
    v_fract_f32 v117, v117
    v_fract_f32 v118, v118
    v_cos_f32 v117, v117
    v_cos_f32 v118, v118
    v_mul_hi_u32_u24 v120, s36, v4
    v_mul_hi_u32_u24 v121, s37, v4
    v_mul_hi_u32_u24 v122, s38, v28
    v_lshlrev_b32 v67, 3, v4
    v_mad_u32_u24 v92, v122, 20, v121
    v_mad_i32_i24 v67, v120, s39, v67
    v_lshlrev_b32 v92, 2, v92
    v_mad_i32_i24 v122, v122, s40, v28
    ds_add_u32 v92, v3 offset:0
    v_mad_i32_i24 v67, v121, -6, v67
    v_lshl_or_b32 v67, v122, 16, v67
    v_mul_f32 v117, s42, v117
    v_mul_f32 v118, s42, v118
    v_cvt_pk_bf16_f32 v117, v117, v118
    v_mul_hi_u32_u24 v123, s36, v5
    v_mul_hi_u32_u24 v124, s37, v5
    v_mul_hi_u32_u24 v125, s38, v29
    v_lshlrev_b32 v68, 3, v5
    v_mad_u32_u24 v93, v125, 20, v124
    v_mad_i32_i24 v68, v123, s39, v68
    v_lshlrev_b32 v93, 2, v93
    v_mad_i32_i24 v125, v125, s40, v29
    ds_add_u32 v93, v3 offset:0
    v_mad_i32_i24 v68, v124, -6, v68
    v_lshl_or_b32 v68, v125, 16, v68
    v_lshrrev_b32 v118, 3, v117
    v_lshrrev_b32 v119, 8, v117
    v_lshl_or_b32 v67, v117, 29, v67
    v_bitop3_b32 v119, v118, v119, s43 bitop3:0x4e
    v_lshlrev_b32 v117, 13, v117
    v_lshl_or_b32 v92, v119, 16, v92
    v_and_or_b32 v68, v117, s45, v68
    v_and_or_b32 v93, v119, s44, v93
    v_lshlrev_b32 v117, 16, v53
    v_and_b32 v118, s44, v53
    v_mul_f32 v117, s41, v117
    v_mul_f32 v118, s41, v118
    v_cvt_pk_bf16_f32 v117, v117, v118
    v_and_b32 v118, s44, v117
    v_lshlrev_b32 v117, 16, v117
    v_mul_f32 v117, 0.15915494, v117
    v_mul_f32 v118, 0.15915494, v118
    v_fract_f32 v117, v117
    v_fract_f32 v118, v118
    v_cos_f32 v117, v117
    v_cos_f32 v118, v118
    v_mul_hi_u32_u24 v120, s36, v6
    v_mul_hi_u32_u24 v121, s37, v6
    v_mul_hi_u32_u24 v122, s38, v30
    v_lshlrev_b32 v69, 3, v6
    v_mad_u32_u24 v94, v122, 20, v121
    v_mad_i32_i24 v69, v120, s39, v69
    v_lshlrev_b32 v94, 2, v94
    v_mad_i32_i24 v122, v122, s40, v30
    ds_add_u32 v94, v3 offset:0
    v_mad_i32_i24 v69, v121, -6, v69
    v_lshl_or_b32 v69, v122, 16, v69
    v_mul_f32 v117, s42, v117
    v_mul_f32 v118, s42, v118
    v_cvt_pk_bf16_f32 v117, v117, v118
    v_mul_hi_u32_u24 v123, s36, v7
    v_mul_hi_u32_u24 v124, s37, v7
    v_mul_hi_u32_u24 v125, s38, v31
    v_lshlrev_b32 v70, 3, v7
    v_mad_u32_u24 v95, v125, 20, v124
    v_mad_i32_i24 v70, v123, s39, v70
    v_lshlrev_b32 v95, 2, v95
    v_mad_i32_i24 v125, v125, s40, v31
    ds_add_u32 v95, v3 offset:0
    v_mad_i32_i24 v70, v124, -6, v70
    v_lshl_or_b32 v70, v125, 16, v70
    v_lshrrev_b32 v118, 3, v117
    v_lshrrev_b32 v119, 8, v117
    v_lshl_or_b32 v69, v117, 29, v69
    v_bitop3_b32 v119, v118, v119, s43 bitop3:0x4e
    v_lshlrev_b32 v117, 13, v117
    v_lshl_or_b32 v94, v119, 16, v94
    v_and_or_b32 v70, v117, s45, v70
    v_and_or_b32 v95, v119, s44, v95
    v_lshlrev_b32 v117, 16, v54
    v_and_b32 v118, s44, v54
    v_mul_f32 v117, s41, v117
    v_mul_f32 v118, s41, v118
    v_cvt_pk_bf16_f32 v117, v117, v118
    v_and_b32 v118, s44, v117
    v_lshlrev_b32 v117, 16, v117
    v_mul_f32 v117, 0.15915494, v117
    v_mul_f32 v118, 0.15915494, v118
    v_fract_f32 v117, v117
    v_fract_f32 v118, v118
    v_cos_f32 v117, v117
    v_cos_f32 v118, v118
    v_mul_hi_u32_u24 v120, s36, v8
    v_mul_hi_u32_u24 v121, s37, v8
    v_mul_hi_u32_u24 v122, s38, v32
    v_lshlrev_b32 v71, 3, v8
    v_mad_u32_u24 v96, v122, 20, v121
    v_mad_i32_i24 v71, v120, s39, v71
    v_lshlrev_b32 v96, 2, v96
    v_mad_i32_i24 v122, v122, s40, v32
    ds_add_u32 v96, v3 offset:0
    v_mad_i32_i24 v71, v121, -6, v71
    v_lshl_or_b32 v71, v122, 16, v71
    v_mul_f32 v117, s42, v117
    v_mul_f32 v118, s42, v118
    v_cvt_pk_bf16_f32 v117, v117, v118
    v_mul_hi_u32_u24 v123, s36, v9
    v_mul_hi_u32_u24 v124, s37, v9
    v_mul_hi_u32_u24 v125, s38, v33
    v_lshlrev_b32 v72, 3, v9
    v_mad_u32_u24 v97, v125, 20, v124
    v_mad_i32_i24 v72, v123, s39, v72
    v_lshlrev_b32 v97, 2, v97
    v_mad_i32_i24 v125, v125, s40, v33
    ds_add_u32 v97, v3 offset:0
    v_mad_i32_i24 v72, v124, -6, v72
    v_lshl_or_b32 v72, v125, 16, v72
    v_lshrrev_b32 v118, 3, v117
    v_lshrrev_b32 v119, 8, v117
    v_lshl_or_b32 v71, v117, 29, v71
    v_bitop3_b32 v119, v118, v119, s43 bitop3:0x4e
    v_lshlrev_b32 v117, 13, v117
    v_lshl_or_b32 v96, v119, 16, v96
    v_and_or_b32 v72, v117, s45, v72
    v_and_or_b32 v97, v119, s44, v97
    v_lshlrev_b32 v117, 16, v55
    v_and_b32 v118, s44, v55
    v_mul_f32 v117, s41, v117
    v_mul_f32 v118, s41, v118
    v_cvt_pk_bf16_f32 v117, v117, v118
    v_and_b32 v118, s44, v117
    v_lshlrev_b32 v117, 16, v117
    v_mul_f32 v117, 0.15915494, v117
    v_mul_f32 v118, 0.15915494, v118
    v_fract_f32 v117, v117
    v_fract_f32 v118, v118
    v_cos_f32 v117, v117
    v_cos_f32 v118, v118
    v_mul_hi_u32_u24 v120, s36, v10
    v_mul_hi_u32_u24 v121, s37, v10
    v_mul_hi_u32_u24 v122, s38, v34
    v_lshlrev_b32 v73, 3, v10
    v_mad_u32_u24 v98, v122, 20, v121
    v_mad_i32_i24 v73, v120, s39, v73
    v_lshlrev_b32 v98, 2, v98
    v_mad_i32_i24 v122, v122, s40, v34
    ds_add_u32 v98, v3 offset:0
    v_mad_i32_i24 v73, v121, -6, v73
    v_lshl_or_b32 v73, v122, 16, v73
    v_mul_f32 v117, s42, v117
    v_mul_f32 v118, s42, v118
    v_cvt_pk_bf16_f32 v117, v117, v118
    v_mul_hi_u32_u24 v123, s36, v11
    v_mul_hi_u32_u24 v124, s37, v11
    v_mul_hi_u32_u24 v125, s38, v35
    v_lshlrev_b32 v74, 3, v11
    v_mad_u32_u24 v99, v125, 20, v124
    v_mad_i32_i24 v74, v123, s39, v74
    v_lshlrev_b32 v99, 2, v99
    v_mad_i32_i24 v125, v125, s40, v35
    ds_add_u32 v99, v3 offset:0
    v_mad_i32_i24 v74, v124, -6, v74
    v_lshl_or_b32 v74, v125, 16, v74
    v_lshrrev_b32 v118, 3, v117
    v_lshrrev_b32 v119, 8, v117
    v_lshl_or_b32 v73, v117, 29, v73
    v_bitop3_b32 v119, v118, v119, s43 bitop3:0x4e
    v_lshlrev_b32 v117, 13, v117
    v_lshl_or_b32 v98, v119, 16, v98
    v_and_or_b32 v74, v117, s45, v74
    v_and_or_b32 v99, v119, s44, v99
    s_waitcnt lgkmcnt(4)
    v_lshlrev_b32 v117, 16, v56
    v_and_b32 v118, s44, v56
    v_mul_f32 v117, s41, v117
    v_mul_f32 v118, s41, v118
    v_cvt_pk_bf16_f32 v117, v117, v118
    v_and_b32 v118, s44, v117
    v_lshlrev_b32 v117, 16, v117
    v_mul_f32 v117, 0.15915494, v117
    v_mul_f32 v118, 0.15915494, v118
    v_fract_f32 v117, v117
    v_fract_f32 v118, v118
    v_cos_f32 v117, v117
    v_cos_f32 v118, v118
    v_mul_hi_u32_u24 v120, s36, v12
    v_mul_hi_u32_u24 v121, s37, v12
    v_mul_hi_u32_u24 v122, s38, v36
    v_lshlrev_b32 v75, 3, v12
    v_mad_u32_u24 v100, v122, 20, v121
    v_mad_i32_i24 v75, v120, s39, v75
    v_lshlrev_b32 v100, 2, v100
    v_mad_i32_i24 v122, v122, s40, v36
    ds_add_u32 v100, v3 offset:0
    v_mad_i32_i24 v75, v121, -6, v75
    v_lshl_or_b32 v75, v122, 16, v75
    v_mul_f32 v117, s42, v117
    v_mul_f32 v118, s42, v118
    v_cvt_pk_bf16_f32 v117, v117, v118
    v_mul_hi_u32_u24 v123, s36, v13
    v_mul_hi_u32_u24 v124, s37, v13
    v_mul_hi_u32_u24 v125, s38, v37
    v_lshlrev_b32 v76, 3, v13
    v_mad_u32_u24 v101, v125, 20, v124
    v_mad_i32_i24 v76, v123, s39, v76
    v_lshlrev_b32 v101, 2, v101
    v_mad_i32_i24 v125, v125, s40, v37
    ds_add_u32 v101, v3 offset:0
    v_mad_i32_i24 v76, v124, -6, v76
    v_lshl_or_b32 v76, v125, 16, v76
    v_lshrrev_b32 v118, 3, v117
    v_lshrrev_b32 v119, 8, v117
    v_lshl_or_b32 v75, v117, 29, v75
    v_bitop3_b32 v119, v118, v119, s43 bitop3:0x4e
    v_lshlrev_b32 v117, 13, v117
    v_lshl_or_b32 v100, v119, 16, v100
    v_and_or_b32 v76, v117, s45, v76
    v_and_or_b32 v101, v119, s44, v101
    v_lshlrev_b32 v117, 16, v57
    v_and_b32 v118, s44, v57
    v_mul_f32 v117, s41, v117
    v_mul_f32 v118, s41, v118
    v_cvt_pk_bf16_f32 v117, v117, v118
    v_and_b32 v118, s44, v117
    v_lshlrev_b32 v117, 16, v117
    v_mul_f32 v117, 0.15915494, v117
    v_mul_f32 v118, 0.15915494, v118
    v_fract_f32 v117, v117
    v_fract_f32 v118, v118
    v_cos_f32 v117, v117
    v_cos_f32 v118, v118
    v_mul_hi_u32_u24 v120, s36, v14
    v_mul_hi_u32_u24 v121, s37, v14
    v_mul_hi_u32_u24 v122, s38, v38
    v_lshlrev_b32 v77, 3, v14
    v_mad_u32_u24 v102, v122, 20, v121
    v_mad_i32_i24 v77, v120, s39, v77
    v_lshlrev_b32 v102, 2, v102
    v_mad_i32_i24 v122, v122, s40, v38
    ds_add_u32 v102, v3 offset:0
    v_mad_i32_i24 v77, v121, -6, v77
    v_lshl_or_b32 v77, v122, 16, v77
    v_mul_f32 v117, s42, v117
    v_mul_f32 v118, s42, v118
    v_cvt_pk_bf16_f32 v117, v117, v118
    v_mul_hi_u32_u24 v123, s36, v15
    v_mul_hi_u32_u24 v124, s37, v15
    v_mul_hi_u32_u24 v125, s38, v39
    v_lshlrev_b32 v78, 3, v15
    v_mad_u32_u24 v103, v125, 20, v124
    v_mad_i32_i24 v78, v123, s39, v78
    v_lshlrev_b32 v103, 2, v103
    v_mad_i32_i24 v125, v125, s40, v39
    ds_add_u32 v103, v3 offset:0
    v_mad_i32_i24 v78, v124, -6, v78
    v_lshl_or_b32 v78, v125, 16, v78
    v_lshrrev_b32 v118, 3, v117
    v_lshrrev_b32 v119, 8, v117
    v_lshl_or_b32 v77, v117, 29, v77
    v_bitop3_b32 v119, v118, v119, s43 bitop3:0x4e
    v_lshlrev_b32 v117, 13, v117
    v_lshl_or_b32 v102, v119, 16, v102
    v_and_or_b32 v78, v117, s45, v78
    v_and_or_b32 v103, v119, s44, v103
    s_add_u32 s32, s30, 0
    buffer_load_dwordx4 v[4:7], v1, s[4:7], s32 offen nt
    buffer_load_dwordx4 v[28:31], v1, s[8:11], s32 offen nt
    s_add_u32 s32, s31, 0
    buffer_load_dwordx2 v[52:53], v2, s[12:15], s32 offen nt
    v_lshlrev_b32 v117, 16, v58
    v_and_b32 v118, s44, v58
    v_mul_f32 v117, s41, v117
    v_mul_f32 v118, s41, v118
    v_cvt_pk_bf16_f32 v117, v117, v118
    v_and_b32 v118, s44, v117
    v_lshlrev_b32 v117, 16, v117
    v_mul_f32 v117, 0.15915494, v117
    v_mul_f32 v118, 0.15915494, v118
    v_fract_f32 v117, v117
    v_fract_f32 v118, v118
    v_cos_f32 v117, v117
    v_cos_f32 v118, v118
    v_mul_hi_u32_u24 v120, s36, v16
    v_mul_hi_u32_u24 v121, s37, v16
    v_mul_hi_u32_u24 v122, s38, v40
    v_lshlrev_b32 v79, 3, v16
    v_mad_u32_u24 v104, v122, 20, v121
    v_mad_i32_i24 v79, v120, s39, v79
    v_lshlrev_b32 v104, 2, v104
    v_mad_i32_i24 v122, v122, s40, v40
    ds_add_u32 v104, v3 offset:0
    v_mad_i32_i24 v79, v121, -6, v79
    v_lshl_or_b32 v79, v122, 16, v79
    v_mul_f32 v117, s42, v117
    v_mul_f32 v118, s42, v118
    v_cvt_pk_bf16_f32 v117, v117, v118
    v_mul_hi_u32_u24 v123, s36, v17
    v_mul_hi_u32_u24 v124, s37, v17
    v_mul_hi_u32_u24 v125, s38, v41
    v_lshlrev_b32 v80, 3, v17
    v_mad_u32_u24 v105, v125, 20, v124
    v_mad_i32_i24 v80, v123, s39, v80
    v_lshlrev_b32 v105, 2, v105
    v_mad_i32_i24 v125, v125, s40, v41
    ds_add_u32 v105, v3 offset:0
    v_mad_i32_i24 v80, v124, -6, v80
    v_lshl_or_b32 v80, v125, 16, v80
    v_lshrrev_b32 v118, 3, v117
    v_lshrrev_b32 v119, 8, v117
    v_lshl_or_b32 v79, v117, 29, v79
    v_bitop3_b32 v119, v118, v119, s43 bitop3:0x4e
    v_lshlrev_b32 v117, 13, v117
    v_lshl_or_b32 v104, v119, 16, v104
    v_and_or_b32 v80, v117, s45, v80
    v_and_or_b32 v105, v119, s44, v105
    v_lshlrev_b32 v117, 16, v59
    v_and_b32 v118, s44, v59
    v_mul_f32 v117, s41, v117
    v_mul_f32 v118, s41, v118
    v_cvt_pk_bf16_f32 v117, v117, v118
    v_and_b32 v118, s44, v117
    v_lshlrev_b32 v117, 16, v117
    v_mul_f32 v117, 0.15915494, v117
    v_mul_f32 v118, 0.15915494, v118
    v_fract_f32 v117, v117
    v_fract_f32 v118, v118
    v_cos_f32 v117, v117
    v_cos_f32 v118, v118
    v_mul_hi_u32_u24 v120, s36, v18
    v_mul_hi_u32_u24 v121, s37, v18
    v_mul_hi_u32_u24 v122, s38, v42
    v_lshlrev_b32 v81, 3, v18
    v_mad_u32_u24 v106, v122, 20, v121
    v_mad_i32_i24 v81, v120, s39, v81
    v_lshlrev_b32 v106, 2, v106
    v_mad_i32_i24 v122, v122, s40, v42
    ds_add_u32 v106, v3 offset:0
    v_mad_i32_i24 v81, v121, -6, v81
    v_lshl_or_b32 v81, v122, 16, v81
    v_mul_f32 v117, s42, v117
    v_mul_f32 v118, s42, v118
    v_cvt_pk_bf16_f32 v117, v117, v118
    v_mul_hi_u32_u24 v123, s36, v19
    v_mul_hi_u32_u24 v124, s37, v19
    v_mul_hi_u32_u24 v125, s38, v43
    v_lshlrev_b32 v82, 3, v19
    v_mad_u32_u24 v107, v125, 20, v124
    v_mad_i32_i24 v82, v123, s39, v82
    v_lshlrev_b32 v107, 2, v107
    v_mad_i32_i24 v125, v125, s40, v43
    ds_add_u32 v107, v3 offset:0
    v_mad_i32_i24 v82, v124, -6, v82
    v_lshl_or_b32 v82, v125, 16, v82
    v_lshrrev_b32 v118, 3, v117
    v_lshrrev_b32 v119, 8, v117
    v_lshl_or_b32 v81, v117, 29, v81
    v_bitop3_b32 v119, v118, v119, s43 bitop3:0x4e
    v_lshlrev_b32 v117, 13, v117
    v_lshl_or_b32 v106, v119, 16, v106
    v_and_or_b32 v82, v117, s45, v82
    v_and_or_b32 v107, v119, s44, v107
    s_waitcnt lgkmcnt(4)
    v_lshlrev_b32 v117, 16, v60
    v_and_b32 v118, s44, v60
    v_mul_f32 v117, s41, v117
    v_mul_f32 v118, s41, v118
    v_cvt_pk_bf16_f32 v117, v117, v118
    v_and_b32 v118, s44, v117
    v_lshlrev_b32 v117, 16, v117
    v_mul_f32 v117, 0.15915494, v117
    v_mul_f32 v118, 0.15915494, v118
    v_fract_f32 v117, v117
    v_fract_f32 v118, v118
    v_cos_f32 v117, v117
    v_cos_f32 v118, v118
    v_mul_hi_u32_u24 v120, s36, v20
    v_mul_hi_u32_u24 v121, s37, v20
    v_mul_hi_u32_u24 v122, s38, v44
    v_lshlrev_b32 v83, 3, v20
    v_mad_u32_u24 v108, v122, 20, v121
    v_mad_i32_i24 v83, v120, s39, v83
    v_lshlrev_b32 v108, 2, v108
    v_mad_i32_i24 v122, v122, s40, v44
    ds_add_u32 v108, v3 offset:0
    v_mad_i32_i24 v83, v121, -6, v83
    v_lshl_or_b32 v83, v122, 16, v83
    v_mul_f32 v117, s42, v117
    v_mul_f32 v118, s42, v118
    v_cvt_pk_bf16_f32 v117, v117, v118
    v_mul_hi_u32_u24 v123, s36, v21
    v_mul_hi_u32_u24 v124, s37, v21
    v_mul_hi_u32_u24 v125, s38, v45
    v_lshlrev_b32 v84, 3, v21
    v_mad_u32_u24 v109, v125, 20, v124
    v_mad_i32_i24 v84, v123, s39, v84
    v_lshlrev_b32 v109, 2, v109
    v_mad_i32_i24 v125, v125, s40, v45
    ds_add_u32 v109, v3 offset:0
    v_mad_i32_i24 v84, v124, -6, v84
    v_lshl_or_b32 v84, v125, 16, v84
    v_lshrrev_b32 v118, 3, v117
    v_lshrrev_b32 v119, 8, v117
    v_lshl_or_b32 v83, v117, 29, v83
    v_bitop3_b32 v119, v118, v119, s43 bitop3:0x4e
    v_lshlrev_b32 v117, 13, v117
    v_lshl_or_b32 v108, v119, 16, v108
    v_and_or_b32 v84, v117, s45, v84
    v_and_or_b32 v109, v119, s44, v109
    v_lshlrev_b32 v117, 16, v61
    v_and_b32 v118, s44, v61
    v_mul_f32 v117, s41, v117
    v_mul_f32 v118, s41, v118
    v_cvt_pk_bf16_f32 v117, v117, v118
    v_and_b32 v118, s44, v117
    v_lshlrev_b32 v117, 16, v117
    v_mul_f32 v117, 0.15915494, v117
    v_mul_f32 v118, 0.15915494, v118
    v_fract_f32 v117, v117
    v_fract_f32 v118, v118
    v_cos_f32 v117, v117
    v_cos_f32 v118, v118
    v_mul_hi_u32_u24 v120, s36, v22
    v_mul_hi_u32_u24 v121, s37, v22
    v_mul_hi_u32_u24 v122, s38, v46
    v_lshlrev_b32 v85, 3, v22
    v_mad_u32_u24 v110, v122, 20, v121
    v_mad_i32_i24 v85, v120, s39, v85
    v_lshlrev_b32 v110, 2, v110
    v_mad_i32_i24 v122, v122, s40, v46
    ds_add_u32 v110, v3 offset:0
    v_mad_i32_i24 v85, v121, -6, v85
    v_lshl_or_b32 v85, v122, 16, v85
    v_mul_f32 v117, s42, v117
    v_mul_f32 v118, s42, v118
    v_cvt_pk_bf16_f32 v117, v117, v118
    v_mul_hi_u32_u24 v123, s36, v23
    v_mul_hi_u32_u24 v124, s37, v23
    v_mul_hi_u32_u24 v125, s38, v47
    v_lshlrev_b32 v86, 3, v23
    v_mad_u32_u24 v111, v125, 20, v124
    v_mad_i32_i24 v86, v123, s39, v86
    v_lshlrev_b32 v111, 2, v111
    v_mad_i32_i24 v125, v125, s40, v47
    ds_add_u32 v111, v3 offset:0
    v_mad_i32_i24 v86, v124, -6, v86
    v_lshl_or_b32 v86, v125, 16, v86
    v_lshrrev_b32 v118, 3, v117
    v_lshrrev_b32 v119, 8, v117
    v_lshl_or_b32 v85, v117, 29, v85
    v_bitop3_b32 v119, v118, v119, s43 bitop3:0x4e
    v_lshlrev_b32 v117, 13, v117
    v_lshl_or_b32 v110, v119, 16, v110
    v_and_or_b32 v86, v117, s45, v86
    v_and_or_b32 v111, v119, s44, v111
    v_lshlrev_b32 v117, 16, v62
    v_and_b32 v118, s44, v62
    v_mul_f32 v117, s41, v117
    v_mul_f32 v118, s41, v118
    v_cvt_pk_bf16_f32 v117, v117, v118
    v_and_b32 v118, s44, v117
    v_lshlrev_b32 v117, 16, v117
    v_mul_f32 v117, 0.15915494, v117
    v_mul_f32 v118, 0.15915494, v118
    v_fract_f32 v117, v117
    v_fract_f32 v118, v118
    v_cos_f32 v117, v117
    v_cos_f32 v118, v118
    v_mul_hi_u32_u24 v120, s36, v24
    v_mul_hi_u32_u24 v121, s37, v24
    v_mul_hi_u32_u24 v122, s38, v48
    v_lshlrev_b32 v87, 3, v24
    v_mad_u32_u24 v112, v122, 20, v121
    v_mad_i32_i24 v87, v120, s39, v87
    v_lshlrev_b32 v112, 2, v112
    v_mad_i32_i24 v122, v122, s40, v48
    ds_add_u32 v112, v3 offset:0
    v_mad_i32_i24 v87, v121, -6, v87
    v_lshl_or_b32 v87, v122, 16, v87
    v_mul_f32 v117, s42, v117
    v_mul_f32 v118, s42, v118
    v_cvt_pk_bf16_f32 v117, v117, v118
    v_mul_hi_u32_u24 v123, s36, v25
    v_mul_hi_u32_u24 v124, s37, v25
    v_mul_hi_u32_u24 v125, s38, v49
    v_lshlrev_b32 v88, 3, v25
    v_mad_u32_u24 v113, v125, 20, v124
    v_mad_i32_i24 v88, v123, s39, v88
    v_lshlrev_b32 v113, 2, v113
    v_mad_i32_i24 v125, v125, s40, v49
    ds_add_u32 v113, v3 offset:0
    v_mad_i32_i24 v88, v124, -6, v88
    v_lshl_or_b32 v88, v125, 16, v88
    v_lshrrev_b32 v118, 3, v117
    v_lshrrev_b32 v119, 8, v117
    v_lshl_or_b32 v87, v117, 29, v87
    v_bitop3_b32 v119, v118, v119, s43 bitop3:0x4e
    v_lshlrev_b32 v117, 13, v117
    v_lshl_or_b32 v112, v119, 16, v112
    v_and_or_b32 v88, v117, s45, v88
    v_and_or_b32 v113, v119, s44, v113
    v_lshlrev_b32 v117, 16, v63
    v_and_b32 v118, s44, v63
    v_mul_f32 v117, s41, v117
    v_mul_f32 v118, s41, v118
    v_cvt_pk_bf16_f32 v117, v117, v118
    v_and_b32 v118, s44, v117
    v_lshlrev_b32 v117, 16, v117
    v_mul_f32 v117, 0.15915494, v117
    v_mul_f32 v118, 0.15915494, v118
    v_fract_f32 v117, v117
    v_fract_f32 v118, v118
    v_cos_f32 v117, v117
    v_cos_f32 v118, v118
    v_mul_hi_u32_u24 v120, s36, v26
    v_mul_hi_u32_u24 v121, s37, v26
    v_mul_hi_u32_u24 v122, s38, v50
    v_lshlrev_b32 v89, 3, v26
    v_mad_u32_u24 v114, v122, 20, v121
    v_mad_i32_i24 v89, v120, s39, v89
    v_lshlrev_b32 v114, 2, v114
    v_mad_i32_i24 v122, v122, s40, v50
    ds_add_u32 v114, v3 offset:0
    v_mad_i32_i24 v89, v121, -6, v89
    v_lshl_or_b32 v89, v122, 16, v89
    v_mul_f32 v117, s42, v117
    v_mul_f32 v118, s42, v118
    v_cvt_pk_bf16_f32 v117, v117, v118
    v_mul_hi_u32_u24 v123, s36, v27
    v_mul_hi_u32_u24 v124, s37, v27
    v_mul_hi_u32_u24 v125, s38, v51
    v_lshlrev_b32 v90, 3, v27
    v_mad_u32_u24 v115, v125, 20, v124
    v_mad_i32_i24 v90, v123, s39, v90
    v_lshlrev_b32 v115, 2, v115
    v_mad_i32_i24 v125, v125, s40, v51
    ds_add_u32 v115, v3 offset:0
    v_mad_i32_i24 v90, v124, -6, v90
    v_lshl_or_b32 v90, v125, 16, v90
    v_lshrrev_b32 v118, 3, v117
    v_lshrrev_b32 v119, 8, v117
    v_lshl_or_b32 v89, v117, 29, v89
    v_bitop3_b32 v119, v118, v119, s43 bitop3:0x4e
    v_lshlrev_b32 v117, 13, v117
    v_lshl_or_b32 v114, v119, 16, v114
    v_and_or_b32 v90, v117, s45, v90
    v_and_or_b32 v115, v119, s44, v115
    s_waitcnt lgkmcnt(4)
    s_add_u32 s32, s30, 16384
    buffer_load_dwordx4 v[8:11], v1, s[4:7], s32 offen nt
    buffer_load_dwordx4 v[32:35], v1, s[8:11], s32 offen nt
    s_add_u32 s32, s31, 8192
    buffer_load_dwordx2 v[54:55], v2, s[12:15], s32 offen nt
    s_cmp_ge_u32 s28, s33
    s_cbranch_scc1 p1_r_done
    v_lshlrev_b32 v117, 16, v66
    v_and_b32 v118, s44, v66
    v_mul_f32 v117, s41, v117
    v_mul_f32 v118, s41, v118
    v_cvt_pk_bf16_f32 v117, v117, v118
    v_and_b32 v118, s44, v117
    v_lshlrev_b32 v117, 16, v117
    v_mul_f32 v117, 0.15915494, v117
    v_mul_f32 v118, 0.15915494, v118
    v_fract_f32 v117, v117
    v_fract_f32 v118, v118
    v_cos_f32 v117, v117
    v_cos_f32 v118, v118
    v_mul_hi_u32_u24 v120, s36, v64
    v_mul_hi_u32_u24 v121, s37, v64
    v_mul_hi_u32_u24 v122, s38, v65
    v_lshlrev_b32 v91, 3, v64
    v_mad_u32_u24 v116, v122, 20, v121
    v_mad_i32_i24 v91, v120, s39, v91
    v_lshlrev_b32 v116, 2, v116
    v_mad_i32_i24 v122, v122, s40, v65
    ds_add_u32 v116, v3 offset:0
    v_mad_i32_i24 v91, v121, -6, v91
    v_lshl_or_b32 v91, v122, 16, v91
    v_mul_f32 v117, s42, v117
    v_mul_f32 v118, s42, v118
    v_cvt_pk_bf16_f32 v117, v117, v118
    v_lshrrev_b32 v118, 3, v117
    v_lshrrev_b32 v119, 8, v117
    v_lshl_or_b32 v91, v117, 29, v91
    v_bitop3_b32 v119, v118, v119, s43 bitop3:0x4e
    v_lshl_or_b32 v116, v119, 16, v116
p1_r_done:
    s_waitcnt lgkmcnt(0)
    s_barrier
    s_cmp_ge_u32 s28, 10
    s_cbranch_scc1 p1_s1_skip
    s_lshr_b32 s52, s28, 1
    s_and_b32 s53, s28, 1
    v_and_b32 v126, 127, v0
    s_lshl_b32 s54, s52, 4
    v_mul_u32_u24 v117, 80, v126
    v_add_u32 v117, s54, v117
    ds_read_b128 v[118:121], v117 offset:0
    s_mov_b32 s55, 43691
    s_waitcnt lgkmcnt(0)
    v_add_u32 v118, 2, v118
    v_add_u32 v119, 2, v119
    v_add_u32 v120, 2, v120
    v_add_u32 v121, 2, v121
    v_mul_u32_u24 v118, s55, v118
    v_mul_u32_u24 v119, s55, v119
    v_mul_u32_u24 v120, s55, v120
    v_mul_u32_u24 v121, s55, v121
    v_lshrrev_b32 v118, 17, v118
    v_lshrrev_b32 v119, 17, v119
    v_lshrrev_b32 v120, 17, v120
    v_lshrrev_b32 v121, 17, v121
    v_lshl_or_b32 v122, v119, 16, v118
    v_lshl_or_b32 v123, v121, 16, v120
    v_mov_b32 v124, v122
    v_mov_b32 v125, v123
    s_nop 1
    v_add_u32_dpp v124, v124, v124 row_shr:1 row_mask:0xf bank_mask:0xf bound_ctrl:0
    v_add_u32_dpp v125, v125, v125 row_shr:1 row_mask:0xf bank_mask:0xf bound_ctrl:0
    s_nop 0
    v_add_u32_dpp v124, v124, v124 row_shr:2 row_mask:0xf bank_mask:0xf bound_ctrl:0
    v_add_u32_dpp v125, v125, v125 row_shr:2 row_mask:0xf bank_mask:0xf bound_ctrl:0
    s_nop 0
    v_add_u32_dpp v124, v124, v124 row_shr:4 row_mask:0xf bank_mask:0xf bound_ctrl:0
    v_add_u32_dpp v125, v125, v125 row_shr:4 row_mask:0xf bank_mask:0xf bound_ctrl:0
    s_nop 0
    v_add_u32_dpp v124, v124, v124 row_shr:8 row_mask:0xf bank_mask:0xf bound_ctrl:0
    v_add_u32_dpp v125, v125, v125 row_shr:8 row_mask:0xf bank_mask:0xf bound_ctrl:0
    s_nop 0
    v_add_u32_dpp v124, v124, v124 row_bcast:15 row_mask:0xa bank_mask:0xf
    v_add_u32_dpp v125, v125, v125 row_bcast:15 row_mask:0xa bank_mask:0xf
    s_nop 0
    v_add_u32_dpp v124, v124, v124 row_bcast:31 row_mask:0xc bank_mask:0xf
    v_add_u32_dpp v125, v125, v125 row_bcast:31 row_mask:0xc bank_mask:0xf
    s_nop 0
    s_nop 0
    s_lshl_b32 s54, s52, 3
    s_add_u32 s54, s54, s53
    s_lshl_b32 s55, s54, 2
    v_mov_b32 v127, s55
    v_and_b32 v118, 0xffff, v124
    v_lshrrev_b32 v119, 16, v124
    v_and_b32 v120, 0xffff, v125
    v_lshrrev_b32 v121, 16, v125
    s_mov_b64 exec, 1
    s_lshl_b64 exec, exec, 63
    ds_write_b32 v127, v118 offset:10240
    ds_write_b32 v127, v119 offset:10248
    ds_write_b32 v127, v120 offset:10256
    ds_write_b32 v127, v121 offset:10264
    s_mov_b64 exec, -1
p1_s1_skip:
    s_waitcnt lgkmcnt(0)
    s_barrier
    v_and_b32 v127, 63, v0
    v_lshlrev_b32 v118, 2, v127
    v_cmp_gt_u32 vcc, 40, v127
    ds_read_b32 v119, v118 offset:10240
    s_waitcnt lgkmcnt(0)
    v_cndmask_b32 v119, 0, v119, vcc
    v_mov_b32 v120, v119
    s_nop 1
    v_add_u32_dpp v120, v120, v120 row_shr:1 row_mask:0xf bank_mask:0xf bound_ctrl:0
    s_nop 1
    v_add_u32_dpp v120, v120, v120 row_shr:2 row_mask:0xf bank_mask:0xf bound_ctrl:0
    s_nop 1
    v_add_u32_dpp v120, v120, v120 row_shr:4 row_mask:0xf bank_mask:0xf bound_ctrl:0
    s_nop 1
    v_add_u32_dpp v120, v120, v120 row_shr:8 row_mask:0xf bank_mask:0xf bound_ctrl:0
    s_nop 1
    v_add_u32_dpp v120, v120, v120 row_bcast:15 row_mask:0xa bank_mask:0xf
    s_nop 1
    v_add_u32_dpp v120, v120, v120 row_bcast:31 row_mask:0xc bank_mask:0xf
    s_nop 1
    s_nop 0
    v_sub_u32 v119, v120, v119
    v_readlane_b32 s35, v120, 63
    s_lshl_b32 s51, s29, 8
    s_add_u32 s51, s51, s2
    s_cmp_ge_u32 s28, 10
    s_cbranch_scc1 p1_s2_skip
    s_add_u32 s55, s54, 0
    v_readlane_b32 s56, v119, s55
    s_add_u32 s55, s54, 2
    v_readlane_b32 s57, v119, s55
    s_add_u32 s55, s54, 4
    v_readlane_b32 s58, v119, s55
    s_add_u32 s55, s54, 6
    v_readlane_b32 s59, v119, s55
    s_nop 0
    s_lshl_b32 s57, s57, 16
    s_or_b32 s56, s56, s57
    s_lshl_b32 s59, s59, 16
    s_or_b32 s58, s58, s59
    v_add_u32 v124, s56, v124
    v_add_u32 v125, s58, v125
    v_sub_u32 v122, v124, v122
    v_sub_u32 v123, v125, v123
    s_mul_i32 s55, s51, 5248
    s_mul_i32 s56, s52, 1032
    s_add_u32 s55, s55, s56
    s_add_u32 s55, s55, 329252864
    v_lshl_add_u32 v127, v126, 3, s55
    buffer_store_dwordx2 v[122:123], v127, s[16:19], 0 offen
    v_and_b32 v118, 0xffff, v122
    v_lshrrev_b32 v119, 16, v122
    v_and_b32 v120, 0xffff, v123
    v_lshrrev_b32 v121, 16, v123
    v_mul_u32_u24 v118, 3, v118
    v_mul_u32_u24 v119, 3, v119
    v_mul_u32_u24 v120, 3, v120
    v_mul_u32_u24 v121, 3, v121
    ds_write_b128 v117, v[118:121] offset:0
    s_cmp_eq_u32 s53, 0
    s_cbranch_scc1 p1_s2_skip
    s_mov_b64 exec, 1
    s_lshl_b64 exec, exec, 63
    buffer_store_dwordx2 v[124:125], v127, s[16:19], 0 offen offset:8
    s_mov_b64 exec, -1
p1_s2_skip:
    s_mul_i32 s52, s51, 160768
    s_add_u32 s20, s48, s52
    s_addc_u32 s21, s49, 0
    s_and_b32 s21, s21, 0xffff
    s_lshl_b32 s22, s35, 4
    s_waitcnt lgkmcnt(0)
    s_barrier
    v_and_b32 v117, 0xffff, v92
    ds_add_rtn_u32 v117, v117, v3 offset:0
    v_and_b32 v118, 0xffff, v93
    ds_add_rtn_u32 v118, v118, v3 offset:0
    v_and_b32 v119, 0xffff, v94
    ds_add_rtn_u32 v119, v119, v3 offset:0
    v_and_b32 v120, 0xffff, v95
    ds_add_rtn_u32 v120, v120, v3 offset:0
    s_add_u32 s32, s30, 32768
    buffer_load_dwordx4 v[12:15], v1, s[4:7], s32 offen nt
    buffer_load_dwordx4 v[36:39], v1, s[8:11], s32 offen nt
    s_add_u32 s32, s31, 16384
    buffer_load_dwordx2 v[56:57], v2, s[12:15], s32 offen nt
    v_and_b32 v121, 0xffff, v96
    ds_add_rtn_u32 v121, v121, v3 offset:0
    v_and_b32 v122, 0xffff, v97
    ds_add_rtn_u32 v122, v122, v3 offset:0
    v_and_b32 v123, 0xffff, v98
    ds_add_rtn_u32 v123, v123, v3 offset:0
    v_and_b32 v124, 0xffff, v99
    ds_add_rtn_u32 v124, v124, v3 offset:0
    s_waitcnt lgkmcnt(4)
    ds_write_b8_d16_hi v117, v92 offset:10496
    v_lshlrev_b32 v117, 2, v117
    ds_write_b32 v117, v67 offset:40704
    ds_write_b8_d16_hi v118, v93 offset:10496
    v_lshlrev_b32 v118, 2, v118
    ds_write_b32 v118, v68 offset:40704
    ds_write_b8_d16_hi v119, v94 offset:10496
    v_lshlrev_b32 v119, 2, v119
    ds_write_b32 v119, v69 offset:40704
    ds_write_b8_d16_hi v120, v95 offset:10496
    v_lshlrev_b32 v120, 2, v120
    ds_write_b32 v120, v70 offset:40704
    s_add_u32 s32, s30, 49152
    buffer_load_dwordx4 v[16:19], v1, s[4:7], s32 offen nt
    buffer_load_dwordx4 v[40:43], v1, s[8:11], s32 offen nt
    s_add_u32 s32, s31, 24576
    buffer_load_dwordx2 v[58:59], v2, s[12:15], s32 offen nt
    v_and_b32 v117, 0xffff, v100
    ds_add_rtn_u32 v117, v117, v3 offset:0
    v_and_b32 v118, 0xffff, v101
    ds_add_rtn_u32 v118, v118, v3 offset:0
    v_and_b32 v119, 0xffff, v102
    ds_add_rtn_u32 v119, v119, v3 offset:0
    v_and_b32 v120, 0xffff, v103
    ds_add_rtn_u32 v120, v120, v3 offset:0
    s_waitcnt lgkmcnt(4)
    ds_write_b8_d16_hi v121, v96 offset:10496
    v_lshlrev_b32 v121, 2, v121
    ds_write_b32 v121, v71 offset:40704
    ds_write_b8_d16_hi v122, v97 offset:10496
    v_lshlrev_b32 v122, 2, v122
    ds_write_b32 v122, v72 offset:40704
    ds_write_b8_d16_hi v123, v98 offset:10496
    v_lshlrev_b32 v123, 2, v123
    ds_write_b32 v123, v73 offset:40704
    ds_write_b8_d16_hi v124, v99 offset:10496
    v_lshlrev_b32 v124, 2, v124
    ds_write_b32 v124, v74 offset:40704
    s_add_u32 s32, s30, 65536
    buffer_load_dwordx4 v[20:23], v1, s[4:7], s32 offen nt
    buffer_load_dwordx4 v[44:47], v1, s[8:11], s32 offen nt
    s_add_u32 s32, s31, 32768
    buffer_load_dwordx2 v[60:61], v2, s[12:15], s32 offen nt
    v_and_b32 v121, 0xffff, v104
    ds_add_rtn_u32 v121, v121, v3 offset:0
    v_and_b32 v122, 0xffff, v105
    ds_add_rtn_u32 v122, v122, v3 offset:0
    v_and_b32 v123, 0xffff, v106
    ds_add_rtn_u32 v123, v123, v3 offset:0
    v_and_b32 v124, 0xffff, v107
    ds_add_rtn_u32 v124, v124, v3 offset:0
    s_waitcnt lgkmcnt(4)
    ds_write_b8_d16_hi v117, v100 offset:10496
    v_lshlrev_b32 v117, 2, v117
    ds_write_b32 v117, v75 offset:40704
    ds_write_b8_d16_hi v118, v101 offset:10496
    v_lshlrev_b32 v118, 2, v118
    ds_write_b32 v118, v76 offset:40704
    ds_write_b8_d16_hi v119, v102 offset:10496
    v_lshlrev_b32 v119, 2, v119
    ds_write_b32 v119, v77 offset:40704
    ds_write_b8_d16_hi v120, v103 offset:10496
    v_lshlrev_b32 v120, 2, v120
    ds_write_b32 v120, v78 offset:40704
    s_add_u32 s32, s30, 81920
    buffer_load_dwordx4 v[24:27], v1, s[4:7], s32 offen nt
    buffer_load_dwordx4 v[48:51], v1, s[8:11], s32 offen nt
    s_add_u32 s32, s31, 40960
    buffer_load_dwordx2 v[62:63], v2, s[12:15], s32 offen nt
    v_and_b32 v117, 0xffff, v108
    ds_add_rtn_u32 v117, v117, v3 offset:0
    v_and_b32 v118, 0xffff, v109
    ds_add_rtn_u32 v118, v118, v3 offset:0
    v_and_b32 v119, 0xffff, v110
    ds_add_rtn_u32 v119, v119, v3 offset:0
    v_and_b32 v120, 0xffff, v111
    ds_add_rtn_u32 v120, v120, v3 offset:0
    s_waitcnt lgkmcnt(4)
    ds_write_b8_d16_hi v121, v104 offset:10496
    v_lshlrev_b32 v121, 2, v121
    ds_write_b32 v121, v79 offset:40704
    ds_write_b8_d16_hi v122, v105 offset:10496
    v_lshlrev_b32 v122, 2, v122
    ds_write_b32 v122, v80 offset:40704
    ds_write_b8_d16_hi v123, v106 offset:10496
    v_lshlrev_b32 v123, 2, v123
    ds_write_b32 v123, v81 offset:40704
    ds_write_b8_d16_hi v124, v107 offset:10496
    v_lshlrev_b32 v124, 2, v124
    ds_write_b32 v124, v82 offset:40704
    s_cmp_lt_u32 s28, s34
    s_cselect_b32 s46, 0, 0x40000000
    v_lshl_add_u32 v126, v0, 2, s46
    s_add_u32 s32, s30, 98304
    buffer_load_dword v64, v126, s[4:7], s32 offen nt
    buffer_load_dword v65, v126, s[8:11], s32 offen nt
    v_lshrrev_b32 v126, 1, v126
    s_add_u32 s32, s31, 49152
    buffer_load_ushort v66, v126, s[12:15], s32 offen nt
    v_and_b32 v121, 0xffff, v112
    ds_add_rtn_u32 v121, v121, v3 offset:0
    v_and_b32 v122, 0xffff, v113
    ds_add_rtn_u32 v122, v122, v3 offset:0
    v_and_b32 v123, 0xffff, v114
    ds_add_rtn_u32 v123, v123, v3 offset:0
    v_and_b32 v124, 0xffff, v115
    ds_add_rtn_u32 v124, v124, v3 offset:0
    s_waitcnt lgkmcnt(4)
    ds_write_b8_d16_hi v117, v108 offset:10496
    v_lshlrev_b32 v117, 2, v117
    ds_write_b32 v117, v83 offset:40704
    ds_write_b8_d16_hi v118, v109 offset:10496
    v_lshlrev_b32 v118, 2, v118
    ds_write_b32 v118, v84 offset:40704
    ds_write_b8_d16_hi v119, v110 offset:10496
    v_lshlrev_b32 v119, 2, v119
    ds_write_b32 v119, v85 offset:40704
    ds_write_b8_d16_hi v120, v111 offset:10496
    v_lshlrev_b32 v120, 2, v120
    ds_write_b32 v120, v86 offset:40704
    s_waitcnt lgkmcnt(0)
    ds_write_b8_d16_hi v121, v112 offset:10496
    v_lshlrev_b32 v121, 2, v121
    ds_write_b32 v121, v87 offset:40704
    ds_write_b8_d16_hi v122, v113 offset:10496
    v_lshlrev_b32 v122, 2, v122
    ds_write_b32 v122, v88 offset:40704
    ds_write_b8_d16_hi v123, v114 offset:10496
    v_lshlrev_b32 v123, 2, v123
    ds_write_b32 v123, v89 offset:40704
    ds_write_b8_d16_hi v124, v115 offset:10496
    v_lshlrev_b32 v124, 2, v124
    ds_write_b32 v124, v90 offset:40704
    s_cmp_ge_u32 s28, s33
    s_cbranch_scc1 p1_p_done
    v_and_b32 v125, 0xffff, v116
    ds_add_rtn_u32 v125, v125, v3 offset:0
    s_waitcnt lgkmcnt(0)
    ds_write_b8_d16_hi v125, v116 offset:10496
    v_lshlrev_b32 v125, 2, v125
    ds_write_b32 v125, v91 offset:40704
p1_p_done:
    s_waitcnt lgkmcnt(0)
    s_barrier
    v_mul_u32_u24 v119, 3, v0
    v_lshlrev_b32 v117, 2, v119
    v_add_u32 v117, 40704, v117
    v_and_b32 v118, -4, v119
    v_mov_b32 v120, v1
    v_mov_b32 v122, 0
    v_mov_b32 v123, 0
    v_mov_b32 v124, 0
    v_mov_b32 v125, 0
    v_cmp_gt_u32 vcc, 640, v0
    s_and_saveexec_b64 s[52:53], vcc
    ds_write_b128 v1, v[122:125] offset:0
    s_mov_b64 exec, -1
    ds_read_b32 v68, v117 offset:0
    ds_read_b32 v69, v117 offset:4
    ds_read_b32 v70, v117 offset:8
    ds_read_b32 v71, v118 offset:10496
    ds_read_b32 v72, v118 offset:10500
    ds_read_b32 v74, v117 offset:12288
    ds_read_b32 v75, v117 offset:12292
    ds_read_b32 v76, v117 offset:12296
    ds_read_b32 v77, v118 offset:13568
    ds_read_b32 v78, v118 offset:13572
    s_waitcnt lgkmcnt(5)
    ds_read_b32 v80, v117 offset:24576
    ds_read_b32 v81, v117 offset:24580
    ds_read_b32 v82, v117 offset:24584
    ds_read_b32 v83, v118 offset:16640
    ds_read_b32 v84, v118 offset:16644
    v_alignbyte_b32 v71, v72, v71, v119
    buffer_store_dwordx4 v[68:71], v120, s[20:23], 0 offen nt
    v_add_u32 v120, 16384, v120
    s_waitcnt lgkmcnt(5)
    ds_read_b32 v86, v117 offset:36864
    ds_read_b32 v87, v117 offset:36868
    ds_read_b32 v88, v117 offset:36872
    ds_read_b32 v89, v118 offset:19712
    ds_read_b32 v90, v118 offset:19716
    v_alignbyte_b32 v77, v78, v77, v119
    buffer_store_dwordx4 v[74:77], v120, s[20:23], 0 offen nt
    v_add_u32 v120, 16384, v120
    s_waitcnt lgkmcnt(5)
    ds_read_b32 v92, v117 offset:49152
    ds_read_b32 v93, v117 offset:49156
    ds_read_b32 v94, v117 offset:49160
    ds_read_b32 v95, v118 offset:22784
    ds_read_b32 v96, v118 offset:22788
    v_alignbyte_b32 v83, v84, v83, v119
    buffer_store_dwordx4 v[80:83], v120, s[20:23], 0 offen nt
    v_add_u32 v120, 16384, v120
    s_waitcnt lgkmcnt(5)
    v_add_u32 v117, 61440, v117
    ds_read_b32 v98, v117 offset:0
    ds_read_b32 v99, v117 offset:4
    ds_read_b32 v100, v117 offset:8
    ds_read_b32 v101, v118 offset:25856
    ds_read_b32 v102, v118 offset:25860
    v_alignbyte_b32 v89, v90, v89, v119
    buffer_store_dwordx4 v[86:89], v120, s[20:23], 0 offen nt
    v_add_u32 v120, 16384, v120
    s_waitcnt lgkmcnt(5)
    ds_read_b32 v104, v117 offset:12288
    ds_read_b32 v105, v117 offset:12292
    ds_read_b32 v106, v117 offset:12296
    ds_read_b32 v107, v118 offset:28928
    ds_read_b32 v108, v118 offset:28932
    v_alignbyte_b32 v95, v96, v95, v119
    buffer_store_dwordx4 v[92:95], v120, s[20:23], 0 offen nt
    v_add_u32 v120, 16384, v120
    s_waitcnt lgkmcnt(5)
    ds_read_b32 v110, v117 offset:24576
    ds_read_b32 v111, v117 offset:24580
    ds_read_b32 v112, v117 offset:24584
    ds_read_b32 v113, v118 offset:32000
    ds_read_b32 v114, v118 offset:32004
    v_alignbyte_b32 v101, v102, v101, v119
    buffer_store_dwordx4 v[98:101], v120, s[20:23], 0 offen nt
    v_add_u32 v120, 16384, v120
    s_waitcnt lgkmcnt(5)
    ds_read_b32 v68, v117 offset:36864
    ds_read_b32 v69, v117 offset:36868
    ds_read_b32 v70, v117 offset:36872
    ds_read_b32 v71, v118 offset:35072
    ds_read_b32 v72, v118 offset:35076
    v_alignbyte_b32 v107, v108, v107, v119
    buffer_store_dwordx4 v[104:107], v120, s[20:23], 0 offen nt
    v_add_u32 v120, 16384, v120
    s_waitcnt lgkmcnt(5)
    ds_read_b32 v74, v117 offset:49152
    ds_read_b32 v75, v117 offset:49156
    ds_read_b32 v76, v117 offset:49160
    ds_read_b32 v77, v118 offset:38144
    ds_read_b32 v78, v118 offset:38148
    v_alignbyte_b32 v113, v114, v113, v119
    buffer_store_dwordx4 v[110:113], v120, s[20:23], 0 offen nt
    v_add_u32 v120, 16384, v120
    s_waitcnt lgkmcnt(5)
    v_alignbyte_b32 v71, v72, v71, v119
    buffer_store_dwordx4 v[68:71], v120, s[20:23], 0 offen nt
    v_add_u32 v120, 16384, v120
    s_waitcnt lgkmcnt(0)
    v_alignbyte_b32 v77, v78, v77, v119
    buffer_store_dwordx4 v[74:77], v120, s[20:23], 0 offen nt
    s_barrier
    s_add_u32 s29, s29, 1
    s_cmp_lt_u32 s29, 8
    s_cbranch_scc1 p1_tile
p1_end:
    s_endpgm
.globl p2_kernel
.p2align 8
.type p2_kernel,@function
p2_kernel:
    s_cmp_ge_u32 s2, 256
    s_cbranch_scc1 p2_end
    s_load_dwordx2 s[8:9], s[0:1], 104
    v_mov_b32 v102, v0
    v_and_b32 v103, 63, v0
    v_lshrrev_b32 v108, 6, v0
    v_mov_b32 v106, 0x03f80000
    v_readfirstlane_b32 s10, v108
    s_and_b32 s44, s2, 7
    s_lshr_b32 s11, s44, 2
    s_and_b32 s44, s44, 3
    s_lshl_b32 s12, s44, 5
    s_lshr_b32 s44, s2, 3
    s_add_u32 s12, s12, s44
    s_mov_b32 s25, 54272
    s_mov_b32 s27, 2214526976
    s_mov_b32 s28, 4294901760
    s_mov_b32 s29, 16777216
    s_mov_b32 s31, 67305996
    s_mov_b32 s32, 84083212
    s_mov_b32 s33, 100860428
    s_mul_i32 s23, s10, 3072
    s_lshl_b32 s24, s10, 9
    v_lshl_add_u32 v104, v103, 4, s23
    s_cmp_lt_u32 s10, 9
    s_cselect_b32 s44, 0, 0x70000000
    s_add_u32 s44, s44, s24
    s_add_u32 s44, s44, 49152
    v_lshl_add_u32 v105, v103, 3, s44
    s_lshl_b32 s41, s10, 7
    s_lshl_b32 s40, s12, 3
    s_add_u32 s40, s40, 329252864
    s_waitcnt lgkmcnt(0)
    s_mov_b32 s4, s8
    s_and_b32 s5, s9, 0xffff
    s_mov_b32 s6, 819200000
    s_mov_b32 s7, 0x20000
    v_lshlrev_b32 v108, 5, v102
    s_mov_b32 s44, 346451968
    buffer_load_dwordx4 v[0:3], v108, s[4:7], s44 offen
    buffer_load_dwordx4 v[4:7], v108, s[4:7], s44 offen offset:16
    s_waitcnt vmcnt(0)
    v_max3_u32 v0, v0, v2, v4
    v_max_u32 v0, v0, v6
    v_add_f32 v1, v1, v3
    v_add_f32 v5, v5, v7
    v_add_f32 v1, v1, v5
    s_nop 1
    v_max_u32_dpp v0, v0, v0 row_shr:1 row_mask:0xf bank_mask:0xf bound_ctrl:0
    v_add_f32_dpp v1, v1, v1 row_shr:1 row_mask:0xf bank_mask:0xf bound_ctrl:0
    s_nop 0
    v_max_u32_dpp v0, v0, v0 row_shr:2 row_mask:0xf bank_mask:0xf bound_ctrl:0
    v_add_f32_dpp v1, v1, v1 row_shr:2 row_mask:0xf bank_mask:0xf bound_ctrl:0
    s_nop 0
    v_max_u32_dpp v0, v0, v0 row_shr:4 row_mask:0xf bank_mask:0xf bound_ctrl:0
    v_add_f32_dpp v1, v1, v1 row_shr:4 row_mask:0xf bank_mask:0xf bound_ctrl:0
    s_nop 0
    v_max_u32_dpp v0, v0, v0 row_shr:8 row_mask:0xf bank_mask:0xf bound_ctrl:0
    v_add_f32_dpp v1, v1, v1 row_shr:8 row_mask:0xf bank_mask:0xf bound_ctrl:0
    s_nop 0
    v_max_u32_dpp v0, v0, v0 row_bcast:15 row_mask:0xa bank_mask:0xf
    v_add_f32_dpp v1, v1, v1 row_bcast:15 row_mask:0xa bank_mask:0xf
    s_nop 0
    v_max_u32_dpp v0, v0, v0 row_bcast:31 row_mask:0xc bank_mask:0xf
    v_add_f32_dpp v1, v1, v1 row_bcast:31 row_mask:0xc bank_mask:0xf
    s_nop 0
    s_nop 0
    s_lshl_b32 s44, s10, 3
    v_mov_b32 v2, s44
    s_mov_b64 exec, 1
    s_lshl_b64 exec, exec, 63
    ds_write_b64 v2, v[0:1] offset:53824
    s_mov_b64 exec, -1
    s_waitcnt lgkmcnt(0)
    s_barrier
    v_and_b32 v2, 15, v103
    v_lshlrev_b32 v2, 3, v2
    ds_read_b64 v[0:1], v2 offset:53824
    s_waitcnt lgkmcnt(0)
    s_nop 1
    v_max_u32_dpp v0, v0, v0 row_shr:1 row_mask:0xf bank_mask:0xf bound_ctrl:0
    v_add_f32_dpp v1, v1, v1 row_shr:1 row_mask:0xf bank_mask:0xf bound_ctrl:0
    s_nop 0
    v_max_u32_dpp v0, v0, v0 row_shr:2 row_mask:0xf bank_mask:0xf bound_ctrl:0
    v_add_f32_dpp v1, v1, v1 row_shr:2 row_mask:0xf bank_mask:0xf bound_ctrl:0
    s_nop 0
    v_max_u32_dpp v0, v0, v0 row_shr:4 row_mask:0xf bank_mask:0xf bound_ctrl:0
    v_add_f32_dpp v1, v1, v1 row_shr:4 row_mask:0xf bank_mask:0xf bound_ctrl:0
    s_nop 0
    v_max_u32_dpp v0, v0, v0 row_shr:8 row_mask:0xf bank_mask:0xf bound_ctrl:0
    v_add_f32_dpp v1, v1, v1 row_shr:8 row_mask:0xf bank_mask:0xf bound_ctrl:0
    s_nop 0
    v_max_u32_dpp v0, v0, v0 row_bcast:15 row_mask:0xa bank_mask:0xf
    v_add_f32_dpp v1, v1, v1 row_bcast:15 row_mask:0xa bank_mask:0xf
    s_nop 0
    v_max_u32_dpp v0, v0, v0 row_bcast:31 row_mask:0xc bank_mask:0xf
    v_add_f32_dpp v1, v1, v1 row_bcast:31 row_mask:0xc bank_mask:0xf
    s_nop 0
    s_nop 0
    v_readlane_b32 s44, v0, 15
    v_readlane_b32 s45, v1, 15
    s_nop 1
    s_lshl_b32 s44, s44, 16
    s_lshr_b32 s46, s44, 23
    s_sub_u32 s47, s46, 30
    s_cmp_lt_u32 s47, 190
    s_cselect_b32 s21, 0, 1
    v_mov_b32 v0, s45
    v_mul_f32 v0, 0x37a7c5ac, v0
    v_cmp_nle_f32 vcc, s44, v0
    s_nop 1
    s_cmp_lg_u64 vcc, 0
    s_cselect_b32 s21, 1, s21
    s_and_b32 s47, s44, 0x7fffff
    s_or_b32 s47, s47, 0x3f000000
    v_rcp_f32 v0, s47
    s_nop 0
    v_mul_f32 v0, 0x3f7f8000, v0
    v_rcp_f32 v1, v0
    v_mul_f32 v0, 0x7b800000, v0
    s_add_u32 s48, s46, -14
    s_lshl_b32 s48, s48, 23
    v_mul_f32 v1, s48, v1
    s_nop 0
    v_readfirstlane_b32 s26, v0
    v_readfirstlane_b32 s30, v1
    s_add_u32 s34, s48, 197132288
    s_mov_b32 s35, s34
    s_sub_u32 s36, 0, s34
    s_subb_u32 s37, 0, s34
p2_restart:
    s_cmp_eq_u32 s21, 0
    s_cselect_b32 s26, s26, 0x7b800000
    s_mul_i32 s13, s11, 10
    s_add_u32 s14, s13, 10
    s_lshr_b32 s44, s13, 2
    s_mul_i32 s44, s44, 1032
    s_add_u32 s44, s44, s40
    v_add_u32 v108, s41, v103
    v_mul_u32_u24 v108, 5248, v108
    buffer_load_dwordx4 v[86:89], v108, s[4:7], s44 offen
    s_add_u32 s44, s44, 335872
    buffer_load_dwordx4 v[90:93], v108, s[4:7], s44 offen
    s_mul_i32 s20, s13, 322560
    s_add_u32 s20, s20, 340000768
    buffer_load_dwordx4 v[72:75], v104, s[4:7], s20 offen offset:0
    buffer_load_dwordx4 v[76:79], v104, s[4:7], s20 offen offset:1024
    buffer_load_dwordx4 v[80:83], v104, s[4:7], s20 offen offset:2048
    buffer_load_dwordx2 v[84:85], v105, s[4:7], s20 offen
    s_barrier
    v_mov_b32 v0, 0
    v_mov_b32 v1, 0
    v_mov_b32 v2, 0
    v_mov_b32 v3, 0
    v_lshlrev_b32 v108, 4, v102
    v_add_u32 v108, 53760, v108
    ds_write_b128 v108, v[0:3] offset:0
    ds_write_b128 v108, v[0:3] offset:16384
    ds_write_b128 v108, v[0:3] offset:32768
    v_add_u32 v108, 49152, v108
    ds_write_b128 v108, v[0:3] offset:0
    ds_write_b128 v108, v[0:3] offset:16384
    ds_write_b128 v108, v[0:3] offset:32768
    v_cmp_gt_u32 vcc, 144, v102
    s_and_saveexec_b64 s[44:45], vcc
    ds_write_b128 v108, v[0:3] offset:49152
    s_mov_b64 exec, -1
    s_mov_b32 s16, 0
    s_mov_b32 s19, 0
    s_mov_b32 s39, 0
    s_mov_b32 s22, 0
    s_waitcnt vmcnt(0) lgkmcnt(0)
    s_barrier
    s_cmp_eq_u32 s11, 0
    s_cbranch_scc1 p2_top
    v_lshrrev_b64 v[86:87], 32, v[86:87]
    v_lshrrev_b64 v[88:89], 32, v[88:89]
    v_lshrrev_b64 v[90:91], 32, v[90:91]
    v_lshrrev_b64 v[92:93], 32, v[92:93]
p2_top:
    s_mov_b32 s17, 0
    s_cmp_lg_u32 s39, 0
    s_cbranch_scc1 p2_add
    v_sub_u32_sdwa v108, v88, v86 dst_sel:DWORD dst_unused:UNUSED_PAD src0_sel:WORD_0 src1_sel:WORD_0
    v_sub_u32_sdwa v109, v92, v90 dst_sel:DWORD dst_unused:UNUSED_PAD src0_sel:WORD_0 src1_sel:WORD_0
    s_movk_i32 s44, 512
    v_med3_i32 v108, v108, 0, s44
    v_med3_i32 v109, v109, 0, s44
    v_lshl_or_b32 v111, v109, 16, v108
    v_mov_b32 v110, v111
    s_mov_b32 m0, s23
    v_mov_b32 v112, 0
    ds_write_addtid_b32 v112 offset:0
    ds_write_addtid_b32 v112 offset:256
    ds_write_addtid_b32 v112 offset:512
    ds_write_addtid_b32 v112 offset:768
    ds_write_addtid_b32 v112 offset:1024
    ds_write_addtid_b32 v112 offset:1280
    ds_write_addtid_b32 v112 offset:1536
    ds_write_addtid_b32 v112 offset:1792
    s_nop 1
    v_add_u32_dpp v110, v110, v110 row_shr:1 row_mask:0xf bank_mask:0xf bound_ctrl:0
    s_nop 1
    v_add_u32_dpp v110, v110, v110 row_shr:2 row_mask:0xf bank_mask:0xf bound_ctrl:0
    s_nop 1
    v_add_u32_dpp v110, v110, v110 row_shr:4 row_mask:0xf bank_mask:0xf bound_ctrl:0
    s_nop 1
    v_add_u32_dpp v110, v110, v110 row_shr:8 row_mask:0xf bank_mask:0xf bound_ctrl:0
    s_nop 1
    v_add_u32_dpp v110, v110, v110 row_bcast:15 row_mask:0xa bank_mask:0xf
    s_nop 1
    v_add_u32_dpp v110, v110, v110 row_bcast:31 row_mask:0xc bank_mask:0xf
    s_nop 1
    s_nop 0
    v_readlane_b32 s44, v110, 63
    v_sub_u32 v110, v110, v111
    v_and_b32 v112, 0xffff, v110
    v_lshrrev_b32 v113, 16, v110
    s_and_b32 s45, s44, 0xffff
    s_lshr_b32 s44, s44, 16
    s_add_u32 s38, s44, s45
    s_min_u32 s38, s38, 512
    v_add_u32 v113, s45, v113
    s_add_u32 s17, s38, 63
    s_lshr_b32 s17, s17, 6
    v_add_u32 v116, s41, v103
    v_mul_u32_u24 v116, 10048, v116
    v_add_u32 v117, 643072, v116
    v_sub_u32 v114, 512, v112
    v_add_u32 v116, v116, v114
    v_med3_i32 v114, v114, 0, v108
    v_add_u32_sdwa v116, v116, v86 dst_sel:DWORD dst_unused:UNUSED_PAD src0_sel:DWORD src1_sel:WORD_0
    v_lshl_add_u32 v112, v112, 2, s23
    v_add_u32 v86, v86, v114
    v_cmpx_lt_u32 vcc, 0, v114
    ds_write_b32 v112, v116
    s_mov_b64 exec, -1
    v_sub_u32 v115, 512, v113
    v_add_u32 v117, v117, v115
    v_med3_i32 v115, v115, 0, v109
    v_add_u32_sdwa v117, v117, v90 dst_sel:DWORD dst_unused:UNUSED_PAD src0_sel:DWORD src1_sel:WORD_0
    v_lshl_add_u32 v113, v113, 2, s23
    v_add_u32 v90, v90, v115
    v_cmpx_lt_u32 vcc, 0, v115
    ds_write_b32 v113, v117
    s_mov_b64 exec, -1
    ds_read_addtid_b32 v94 offset:0
    ds_read_addtid_b32 v95 offset:256
    ds_read_addtid_b32 v96 offset:512
    ds_read_addtid_b32 v97 offset:768
    ds_read_addtid_b32 v98 offset:1024
    ds_read_addtid_b32 v99 offset:1280
    ds_read_addtid_b32 v100 offset:1536
    ds_read_addtid_b32 v101 offset:1792
    v_cmp_lt_u32_sdwa s[44:45], v86, v88 src0_sel:WORD_0 src1_sel:WORD_0
    v_cmp_lt_u32_sdwa s[46:47], v90, v92 src0_sel:WORD_0 src1_sel:WORD_0
    s_nop 0
    s_or_b64 s[44:45], s[44:45], s[46:47]
    s_cbranch_scc0 p2_nomore
    v_mov_b32 v112, s19
    v_mov_b32 v113, 1
    ds_write_b32 v112, v113 offset:53760
p2_nomore:
    s_waitcnt lgkmcnt(0)
    s_nop 1
    v_max_u32_dpp v94, v94, v94 row_shr:1 row_mask:0xf bank_mask:0xf bound_ctrl:0
    v_max_u32_dpp v95, v95, v95 row_shr:1 row_mask:0xf bank_mask:0xf bound_ctrl:0
    v_max_u32_dpp v96, v96, v96 row_shr:1 row_mask:0xf bank_mask:0xf bound_ctrl:0
    v_max_u32_dpp v97, v97, v97 row_shr:1 row_mask:0xf bank_mask:0xf bound_ctrl:0
    v_max_u32_dpp v98, v98, v98 row_shr:1 row_mask:0xf bank_mask:0xf bound_ctrl:0
    v_max_u32_dpp v99, v99, v99 row_shr:1 row_mask:0xf bank_mask:0xf bound_ctrl:0
    v_max_u32_dpp v100, v100, v100 row_shr:1 row_mask:0xf bank_mask:0xf bound_ctrl:0
    v_max_u32_dpp v101, v101, v101 row_shr:1 row_mask:0xf bank_mask:0xf bound_ctrl:0
    v_max_u32_dpp v94, v94, v94 row_shr:2 row_mask:0xf bank_mask:0xf bound_ctrl:0
    v_max_u32_dpp v95, v95, v95 row_shr:2 row_mask:0xf bank_mask:0xf bound_ctrl:0
    v_max_u32_dpp v96, v96, v96 row_shr:2 row_mask:0xf bank_mask:0xf bound_ctrl:0
    v_max_u32_dpp v97, v97, v97 row_shr:2 row_mask:0xf bank_mask:0xf bound_ctrl:0
    v_max_u32_dpp v98, v98, v98 row_shr:2 row_mask:0xf bank_mask:0xf bound_ctrl:0
    v_max_u32_dpp v99, v99, v99 row_shr:2 row_mask:0xf bank_mask:0xf bound_ctrl:0
    v_max_u32_dpp v100, v100, v100 row_shr:2 row_mask:0xf bank_mask:0xf bound_ctrl:0
    v_max_u32_dpp v101, v101, v101 row_shr:2 row_mask:0xf bank_mask:0xf bound_ctrl:0
    v_max_u32_dpp v94, v94, v94 row_shr:4 row_mask:0xf bank_mask:0xf bound_ctrl:0
    v_max_u32_dpp v95, v95, v95 row_shr:4 row_mask:0xf bank_mask:0xf bound_ctrl:0
    v_max_u32_dpp v96, v96, v96 row_shr:4 row_mask:0xf bank_mask:0xf bound_ctrl:0
    v_max_u32_dpp v97, v97, v97 row_shr:4 row_mask:0xf bank_mask:0xf bound_ctrl:0
    v_max_u32_dpp v98, v98, v98 row_shr:4 row_mask:0xf bank_mask:0xf bound_ctrl:0
    v_max_u32_dpp v99, v99, v99 row_shr:4 row_mask:0xf bank_mask:0xf bound_ctrl:0
    v_max_u32_dpp v100, v100, v100 row_shr:4 row_mask:0xf bank_mask:0xf bound_ctrl:0
    v_max_u32_dpp v101, v101, v101 row_shr:4 row_mask:0xf bank_mask:0xf bound_ctrl:0
    v_max_u32_dpp v94, v94, v94 row_shr:8 row_mask:0xf bank_mask:0xf bound_ctrl:0
    v_max_u32_dpp v95, v95, v95 row_shr:8 row_mask:0xf bank_mask:0xf bound_ctrl:0
    v_max_u32_dpp v96, v96, v96 row_shr:8 row_mask:0xf bank_mask:0xf bound_ctrl:0
    v_max_u32_dpp v97, v97, v97 row_shr:8 row_mask:0xf bank_mask:0xf bound_ctrl:0
    v_max_u32_dpp v98, v98, v98 row_shr:8 row_mask:0xf bank_mask:0xf bound_ctrl:0
    v_max_u32_dpp v99, v99, v99 row_shr:8 row_mask:0xf bank_mask:0xf bound_ctrl:0
    v_max_u32_dpp v100, v100, v100 row_shr:8 row_mask:0xf bank_mask:0xf bound_ctrl:0
    v_max_u32_dpp v101, v101, v101 row_shr:8 row_mask:0xf bank_mask:0xf bound_ctrl:0
    v_max_u32_dpp v94, v94, v94 row_bcast:15 row_mask:0xa bank_mask:0xf
    v_max_u32_dpp v95, v95, v95 row_bcast:15 row_mask:0xa bank_mask:0xf
    v_max_u32_dpp v96, v96, v96 row_bcast:15 row_mask:0xa bank_mask:0xf
    v_max_u32_dpp v97, v97, v97 row_bcast:15 row_mask:0xa bank_mask:0xf
    v_max_u32_dpp v98, v98, v98 row_bcast:15 row_mask:0xa bank_mask:0xf
    v_max_u32_dpp v99, v99, v99 row_bcast:15 row_mask:0xa bank_mask:0xf
    v_max_u32_dpp v100, v100, v100 row_bcast:15 row_mask:0xa bank_mask:0xf
    v_max_u32_dpp v101, v101, v101 row_bcast:15 row_mask:0xa bank_mask:0xf
    v_max_u32_dpp v94, v94, v94 row_bcast:31 row_mask:0xc bank_mask:0xf
    v_max_u32_dpp v95, v95, v95 row_bcast:31 row_mask:0xc bank_mask:0xf
    v_max_u32_dpp v96, v96, v96 row_bcast:31 row_mask:0xc bank_mask:0xf
    v_max_u32_dpp v97, v97, v97 row_bcast:31 row_mask:0xc bank_mask:0xf
    v_max_u32_dpp v98, v98, v98 row_bcast:31 row_mask:0xc bank_mask:0xf
    v_max_u32_dpp v99, v99, v99 row_bcast:31 row_mask:0xc bank_mask:0xf
    v_max_u32_dpp v100, v100, v100 row_bcast:31 row_mask:0xc bank_mask:0xf
    v_max_u32_dpp v101, v101, v101 row_bcast:31 row_mask:0xc bank_mask:0xf
    s_nop 0
    v_readlane_b32 s44, v94, 63
    s_nop 1
    v_max_u32 v95, s44, v95
    s_nop 0
    v_readlane_b32 s44, v95, 63
    s_nop 1
    v_max_u32 v96, s44, v96
    s_nop 0
    v_readlane_b32 s44, v96, 63
    s_nop 1
    v_max_u32 v97, s44, v97
    s_nop 0
    v_readlane_b32 s44, v97, 63
    s_nop 1
    v_max_u32 v98, s44, v98
    s_nop 0
    v_readlane_b32 s44, v98, 63
    s_nop 1
    v_max_u32 v99, s44, v99
    s_nop 0
    v_readlane_b32 s44, v99, 63
    s_nop 1
    v_max_u32 v100, s44, v100
    s_nop 0
    v_readlane_b32 s44, v100, 63
    s_nop 1
    v_max_u32 v101, s44, v101
    s_nop 0
    v_mov_b32 v113, 0x7000000
    v_add_u32 v112, 0, v103
    v_cmp_gt_u32 vcc, s38, v112
    v_add_u32 v94, v94, v112
    v_subrev_u32 v94, 512, v94
    v_cndmask_b32 v94, v113, v94, vcc
    v_lshlrev_b32 v94, 4, v94
    v_add_u32 v112, 64, v103
    v_cmp_gt_u32 vcc, s38, v112
    v_add_u32 v95, v95, v112
    v_subrev_u32 v95, 512, v95
    v_cndmask_b32 v95, v113, v95, vcc
    v_lshlrev_b32 v95, 4, v95
    v_add_u32 v112, 128, v103
    v_cmp_gt_u32 vcc, s38, v112
    v_add_u32 v96, v96, v112
    v_subrev_u32 v96, 512, v96
    v_cndmask_b32 v96, v113, v96, vcc
    v_lshlrev_b32 v96, 4, v96
    v_add_u32 v112, 192, v103
    v_cmp_gt_u32 vcc, s38, v112
    v_add_u32 v97, v97, v112
    v_subrev_u32 v97, 512, v97
    v_cndmask_b32 v97, v113, v97, vcc
    v_lshlrev_b32 v97, 4, v97
    v_add_u32 v112, 256, v103
    v_cmp_gt_u32 vcc, s38, v112
    v_add_u32 v98, v98, v112
    v_subrev_u32 v98, 512, v98
    v_cndmask_b32 v98, v113, v98, vcc
    v_lshlrev_b32 v98, 4, v98
    v_add_u32 v112, 320, v103
    v_cmp_gt_u32 vcc, s38, v112
    v_add_u32 v99, v99, v112
    v_subrev_u32 v99, 512, v99
    v_cndmask_b32 v99, v113, v99, vcc
    v_lshlrev_b32 v99, 4, v99
    v_add_u32 v112, 384, v103
    v_cmp_gt_u32 vcc, s38, v112
    v_add_u32 v100, v100, v112
    v_subrev_u32 v100, 512, v100
    v_cndmask_b32 v100, v113, v100, vcc
    v_lshlrev_b32 v100, 4, v100
    v_add_u32 v112, 448, v103
    v_cmp_gt_u32 vcc, s38, v112
    v_add_u32 v101, v101, v112
    v_subrev_u32 v101, 512, v101
    v_cndmask_b32 v101, v113, v101, vcc
    v_lshlrev_b32 v101, 4, v101
p2_add:
    s_cmp_lg_u32 s21, 0
    s_cbranch_scc1 p2_addf
    s_cmp_le_u32 s16, 0
    s_cbranch_scc1 p2_na0_0
    v_ashrrev_i32 v108, 5, v48
    v_bfe_u32 v109, v48, 8, 13
    v_lshlrev_b32 v110, 16, v0
    v_and_b32 v111, s28, v0
    v_bitop3_b32 v108, v108, v106, s27 bitop3:0x28
    v_lshl_add_u32 v109, v109, 3, s25
    v_lshlrev_b32 v112, 16, v1
    v_mul_f32 v108, s26, v108
    v_and_b32 v113, s28, v1
    v_pk_fma_f32 v[110:111], v[110:111], v[108:109], s[34:35] op_sel_hi:[1,0,1]
    v_pk_fma_f32 v[112:113], v[112:113], v[108:109], s[34:35] op_sel_hi:[1,0,1]
    v_lshl_add_u64 v[110:111], v[110:111], 0, s[36:37]
    v_lshl_add_u64 v[112:113], v[112:113], 0, s[36:37]
    v_cmpx_le_u32 vcc, s29, v48
    ds_add_u64 v109, v[110:111]
    ds_add_u64 v109, v[112:113] offset:50048
    s_mov_b64 exec, -1
    v_ashrrev_i32 v114, 5, v49
    v_bfe_u32 v115, v49, 8, 13
    v_lshlrev_b32 v116, 16, v2
    v_and_b32 v117, s28, v2
    v_bitop3_b32 v114, v114, v106, s27 bitop3:0x28
    v_lshl_add_u32 v115, v115, 3, s25
    v_lshlrev_b32 v118, 16, v3
    v_mul_f32 v114, s26, v114
    v_and_b32 v119, s28, v3
    v_pk_fma_f32 v[116:117], v[116:117], v[114:115], s[34:35] op_sel_hi:[1,0,1]
    v_pk_fma_f32 v[118:119], v[118:119], v[114:115], s[34:35] op_sel_hi:[1,0,1]
    v_lshl_add_u64 v[116:117], v[116:117], 0, s[36:37]
    v_lshl_add_u64 v[118:119], v[118:119], 0, s[36:37]
    v_cmpx_le_u32 vcc, s29, v49
    ds_add_u64 v115, v[116:117]
    ds_add_u64 v115, v[118:119] offset:50048
    s_mov_b64 exec, -1
    v_ashrrev_i32 v120, 5, v50
    v_bfe_u32 v121, v50, 8, 13
    v_lshlrev_b32 v122, 16, v4
    v_and_b32 v123, s28, v4
    v_bitop3_b32 v120, v120, v106, s27 bitop3:0x28
    v_lshl_add_u32 v121, v121, 3, s25
    v_lshlrev_b32 v124, 16, v5
    v_mul_f32 v120, s26, v120
    v_and_b32 v125, s28, v5
    v_pk_fma_f32 v[122:123], v[122:123], v[120:121], s[34:35] op_sel_hi:[1,0,1]
    v_pk_fma_f32 v[124:125], v[124:125], v[120:121], s[34:35] op_sel_hi:[1,0,1]
    v_lshl_add_u64 v[122:123], v[122:123], 0, s[36:37]
    v_lshl_add_u64 v[124:125], v[124:125], 0, s[36:37]
    v_cmpx_le_u32 vcc, s29, v50
    ds_add_u64 v121, v[122:123]
    ds_add_u64 v121, v[124:125] offset:50048
    s_mov_b64 exec, -1
p2_na0_0:
    s_cmp_le_u32 s17, 0
    s_cbranch_scc1 p2_nl0_0
    buffer_load_dwordx4 v[0:3], v94, s[4:7], 0 offen
p2_nl0_0:
    s_cmp_le_u32 s16, 1
    s_cbranch_scc1 p2_na0_1
    v_ashrrev_i32 v108, 5, v51
    v_bfe_u32 v109, v51, 8, 13
    v_lshlrev_b32 v110, 16, v6
    v_and_b32 v111, s28, v6
    v_bitop3_b32 v108, v108, v106, s27 bitop3:0x28
    v_lshl_add_u32 v109, v109, 3, s25
    v_lshlrev_b32 v112, 16, v7
    v_mul_f32 v108, s26, v108
    v_and_b32 v113, s28, v7
    v_pk_fma_f32 v[110:111], v[110:111], v[108:109], s[34:35] op_sel_hi:[1,0,1]
    v_pk_fma_f32 v[112:113], v[112:113], v[108:109], s[34:35] op_sel_hi:[1,0,1]
    v_lshl_add_u64 v[110:111], v[110:111], 0, s[36:37]
    v_lshl_add_u64 v[112:113], v[112:113], 0, s[36:37]
    v_cmpx_le_u32 vcc, s29, v51
    ds_add_u64 v109, v[110:111]
    ds_add_u64 v109, v[112:113] offset:50048
    s_mov_b64 exec, -1
    v_ashrrev_i32 v114, 5, v52
    v_bfe_u32 v115, v52, 8, 13
    v_lshlrev_b32 v116, 16, v8
    v_and_b32 v117, s28, v8
    v_bitop3_b32 v114, v114, v106, s27 bitop3:0x28
    v_lshl_add_u32 v115, v115, 3, s25
    v_lshlrev_b32 v118, 16, v9
    v_mul_f32 v114, s26, v114
    v_and_b32 v119, s28, v9
    v_pk_fma_f32 v[116:117], v[116:117], v[114:115], s[34:35] op_sel_hi:[1,0,1]
    v_pk_fma_f32 v[118:119], v[118:119], v[114:115], s[34:35] op_sel_hi:[1,0,1]
    v_lshl_add_u64 v[116:117], v[116:117], 0, s[36:37]
    v_lshl_add_u64 v[118:119], v[118:119], 0, s[36:37]
    v_cmpx_le_u32 vcc, s29, v52
    ds_add_u64 v115, v[116:117]
    ds_add_u64 v115, v[118:119] offset:50048
    s_mov_b64 exec, -1
    v_ashrrev_i32 v120, 5, v53
    v_bfe_u32 v121, v53, 8, 13
    v_lshlrev_b32 v122, 16, v10
    v_and_b32 v123, s28, v10
    v_bitop3_b32 v120, v120, v106, s27 bitop3:0x28
    v_lshl_add_u32 v121, v121, 3, s25
    v_lshlrev_b32 v124, 16, v11
    v_mul_f32 v120, s26, v120
    v_and_b32 v125, s28, v11
    v_pk_fma_f32 v[122:123], v[122:123], v[120:121], s[34:35] op_sel_hi:[1,0,1]
    v_pk_fma_f32 v[124:125], v[124:125], v[120:121], s[34:35] op_sel_hi:[1,0,1]
    v_lshl_add_u64 v[122:123], v[122:123], 0, s[36:37]
    v_lshl_add_u64 v[124:125], v[124:125], 0, s[36:37]
    v_cmpx_le_u32 vcc, s29, v53
    ds_add_u64 v121, v[122:123]
    ds_add_u64 v121, v[124:125] offset:50048
    s_mov_b64 exec, -1
p2_na0_1:
    s_cmp_le_u32 s17, 1
    s_cbranch_scc1 p2_nl0_1
    buffer_load_dwordx4 v[6:9], v95, s[4:7], 0 offen
p2_nl0_1:
    s_cmp_le_u32 s16, 2
    s_cbranch_scc1 p2_na0_2
    v_ashrrev_i32 v108, 5, v54
    v_bfe_u32 v109, v54, 8, 13
    v_lshlrev_b32 v110, 16, v12
    v_and_b32 v111, s28, v12
    v_bitop3_b32 v108, v108, v106, s27 bitop3:0x28
    v_lshl_add_u32 v109, v109, 3, s25
    v_lshlrev_b32 v112, 16, v13
    v_mul_f32 v108, s26, v108
    v_and_b32 v113, s28, v13
    v_pk_fma_f32 v[110:111], v[110:111], v[108:109], s[34:35] op_sel_hi:[1,0,1]
    v_pk_fma_f32 v[112:113], v[112:113], v[108:109], s[34:35] op_sel_hi:[1,0,1]
    v_lshl_add_u64 v[110:111], v[110:111], 0, s[36:37]
    v_lshl_add_u64 v[112:113], v[112:113], 0, s[36:37]
    v_cmpx_le_u32 vcc, s29, v54
    ds_add_u64 v109, v[110:111]
    ds_add_u64 v109, v[112:113] offset:50048
    s_mov_b64 exec, -1
    v_ashrrev_i32 v114, 5, v55
    v_bfe_u32 v115, v55, 8, 13
    v_lshlrev_b32 v116, 16, v14
    v_and_b32 v117, s28, v14
    v_bitop3_b32 v114, v114, v106, s27 bitop3:0x28
    v_lshl_add_u32 v115, v115, 3, s25
    v_lshlrev_b32 v118, 16, v15
    v_mul_f32 v114, s26, v114
    v_and_b32 v119, s28, v15
    v_pk_fma_f32 v[116:117], v[116:117], v[114:115], s[34:35] op_sel_hi:[1,0,1]
    v_pk_fma_f32 v[118:119], v[118:119], v[114:115], s[34:35] op_sel_hi:[1,0,1]
    v_lshl_add_u64 v[116:117], v[116:117], 0, s[36:37]
    v_lshl_add_u64 v[118:119], v[118:119], 0, s[36:37]
    v_cmpx_le_u32 vcc, s29, v55
    ds_add_u64 v115, v[116:117]
    ds_add_u64 v115, v[118:119] offset:50048
    s_mov_b64 exec, -1
    v_ashrrev_i32 v120, 5, v56
    v_bfe_u32 v121, v56, 8, 13
    v_lshlrev_b32 v122, 16, v16
    v_and_b32 v123, s28, v16
    v_bitop3_b32 v120, v120, v106, s27 bitop3:0x28
    v_lshl_add_u32 v121, v121, 3, s25
    v_lshlrev_b32 v124, 16, v17
    v_mul_f32 v120, s26, v120
    v_and_b32 v125, s28, v17
    v_pk_fma_f32 v[122:123], v[122:123], v[120:121], s[34:35] op_sel_hi:[1,0,1]
    v_pk_fma_f32 v[124:125], v[124:125], v[120:121], s[34:35] op_sel_hi:[1,0,1]
    v_lshl_add_u64 v[122:123], v[122:123], 0, s[36:37]
    v_lshl_add_u64 v[124:125], v[124:125], 0, s[36:37]
    v_cmpx_le_u32 vcc, s29, v56
    ds_add_u64 v121, v[122:123]
    ds_add_u64 v121, v[124:125] offset:50048
    s_mov_b64 exec, -1
p2_na0_2:
    s_cmp_le_u32 s17, 2
    s_cbranch_scc1 p2_nl0_2
    buffer_load_dwordx4 v[12:15], v96, s[4:7], 0 offen
p2_nl0_2:
    s_cmp_le_u32 s16, 3
    s_cbranch_scc1 p2_na0_3
    v_ashrrev_i32 v108, 5, v57
    v_bfe_u32 v109, v57, 8, 13
    v_lshlrev_b32 v110, 16, v18
    v_and_b32 v111, s28, v18
    v_bitop3_b32 v108, v108, v106, s27 bitop3:0x28
    v_lshl_add_u32 v109, v109, 3, s25
    v_lshlrev_b32 v112, 16, v19
    v_mul_f32 v108, s26, v108
    v_and_b32 v113, s28, v19
    v_pk_fma_f32 v[110:111], v[110:111], v[108:109], s[34:35] op_sel_hi:[1,0,1]
    v_pk_fma_f32 v[112:113], v[112:113], v[108:109], s[34:35] op_sel_hi:[1,0,1]
    v_lshl_add_u64 v[110:111], v[110:111], 0, s[36:37]
    v_lshl_add_u64 v[112:113], v[112:113], 0, s[36:37]
    v_cmpx_le_u32 vcc, s29, v57
    ds_add_u64 v109, v[110:111]
    ds_add_u64 v109, v[112:113] offset:50048
    s_mov_b64 exec, -1
    v_ashrrev_i32 v114, 5, v58
    v_bfe_u32 v115, v58, 8, 13
    v_lshlrev_b32 v116, 16, v20
    v_and_b32 v117, s28, v20
    v_bitop3_b32 v114, v114, v106, s27 bitop3:0x28
    v_lshl_add_u32 v115, v115, 3, s25
    v_lshlrev_b32 v118, 16, v21
    v_mul_f32 v114, s26, v114
    v_and_b32 v119, s28, v21
    v_pk_fma_f32 v[116:117], v[116:117], v[114:115], s[34:35] op_sel_hi:[1,0,1]
    v_pk_fma_f32 v[118:119], v[118:119], v[114:115], s[34:35] op_sel_hi:[1,0,1]
    v_lshl_add_u64 v[116:117], v[116:117], 0, s[36:37]
    v_lshl_add_u64 v[118:119], v[118:119], 0, s[36:37]
    v_cmpx_le_u32 vcc, s29, v58
    ds_add_u64 v115, v[116:117]
    ds_add_u64 v115, v[118:119] offset:50048
    s_mov_b64 exec, -1
    v_ashrrev_i32 v120, 5, v59
    v_bfe_u32 v121, v59, 8, 13
    v_lshlrev_b32 v122, 16, v22
    v_and_b32 v123, s28, v22
    v_bitop3_b32 v120, v120, v106, s27 bitop3:0x28
    v_lshl_add_u32 v121, v121, 3, s25
    v_lshlrev_b32 v124, 16, v23
    v_mul_f32 v120, s26, v120
    v_and_b32 v125, s28, v23
    v_pk_fma_f32 v[122:123], v[122:123], v[120:121], s[34:35] op_sel_hi:[1,0,1]
    v_pk_fma_f32 v[124:125], v[124:125], v[120:121], s[34:35] op_sel_hi:[1,0,1]
    v_lshl_add_u64 v[122:123], v[122:123], 0, s[36:37]
    v_lshl_add_u64 v[124:125], v[124:125], 0, s[36:37]
    v_cmpx_le_u32 vcc, s29, v59
    ds_add_u64 v121, v[122:123]
    ds_add_u64 v121, v[124:125] offset:50048
    s_mov_b64 exec, -1
p2_na0_3:
    s_cmp_le_u32 s17, 3
    s_cbranch_scc1 p2_nl0_3
    buffer_load_dwordx4 v[18:21], v97, s[4:7], 0 offen
p2_nl0_3:
    s_cmp_le_u32 s16, 4
    s_cbranch_scc1 p2_na0_4
    v_ashrrev_i32 v108, 5, v60
    v_bfe_u32 v109, v60, 8, 13
    v_lshlrev_b32 v110, 16, v24
    v_and_b32 v111, s28, v24
    v_bitop3_b32 v108, v108, v106, s27 bitop3:0x28
    v_lshl_add_u32 v109, v109, 3, s25
    v_lshlrev_b32 v112, 16, v25
    v_mul_f32 v108, s26, v108
    v_and_b32 v113, s28, v25
    v_pk_fma_f32 v[110:111], v[110:111], v[108:109], s[34:35] op_sel_hi:[1,0,1]
    v_pk_fma_f32 v[112:113], v[112:113], v[108:109], s[34:35] op_sel_hi:[1,0,1]
    v_lshl_add_u64 v[110:111], v[110:111], 0, s[36:37]
    v_lshl_add_u64 v[112:113], v[112:113], 0, s[36:37]
    v_cmpx_le_u32 vcc, s29, v60
    ds_add_u64 v109, v[110:111]
    ds_add_u64 v109, v[112:113] offset:50048
    s_mov_b64 exec, -1
    v_ashrrev_i32 v114, 5, v61
    v_bfe_u32 v115, v61, 8, 13
    v_lshlrev_b32 v116, 16, v26
    v_and_b32 v117, s28, v26
    v_bitop3_b32 v114, v114, v106, s27 bitop3:0x28
    v_lshl_add_u32 v115, v115, 3, s25
    v_lshlrev_b32 v118, 16, v27
    v_mul_f32 v114, s26, v114
    v_and_b32 v119, s28, v27
    v_pk_fma_f32 v[116:117], v[116:117], v[114:115], s[34:35] op_sel_hi:[1,0,1]
    v_pk_fma_f32 v[118:119], v[118:119], v[114:115], s[34:35] op_sel_hi:[1,0,1]
    v_lshl_add_u64 v[116:117], v[116:117], 0, s[36:37]
    v_lshl_add_u64 v[118:119], v[118:119], 0, s[36:37]
    v_cmpx_le_u32 vcc, s29, v61
    ds_add_u64 v115, v[116:117]
    ds_add_u64 v115, v[118:119] offset:50048
    s_mov_b64 exec, -1
    v_ashrrev_i32 v120, 5, v62
    v_bfe_u32 v121, v62, 8, 13
    v_lshlrev_b32 v122, 16, v28
    v_and_b32 v123, s28, v28
    v_bitop3_b32 v120, v120, v106, s27 bitop3:0x28
    v_lshl_add_u32 v121, v121, 3, s25
    v_lshlrev_b32 v124, 16, v29
    v_mul_f32 v120, s26, v120
    v_and_b32 v125, s28, v29
    v_pk_fma_f32 v[122:123], v[122:123], v[120:121], s[34:35] op_sel_hi:[1,0,1]
    v_pk_fma_f32 v[124:125], v[124:125], v[120:121], s[34:35] op_sel_hi:[1,0,1]
    v_lshl_add_u64 v[122:123], v[122:123], 0, s[36:37]
    v_lshl_add_u64 v[124:125], v[124:125], 0, s[36:37]
    v_cmpx_le_u32 vcc, s29, v62
    ds_add_u64 v121, v[122:123]
    ds_add_u64 v121, v[124:125] offset:50048
    s_mov_b64 exec, -1
p2_na0_4:
    s_cmp_le_u32 s17, 4
    s_cbranch_scc1 p2_nl0_4
    buffer_load_dwordx4 v[24:27], v98, s[4:7], 0 offen
p2_nl0_4:
    s_cmp_le_u32 s16, 5
    s_cbranch_scc1 p2_na0_5
    v_ashrrev_i32 v108, 5, v63
    v_bfe_u32 v109, v63, 8, 13
    v_lshlrev_b32 v110, 16, v30
    v_and_b32 v111, s28, v30
    v_bitop3_b32 v108, v108, v106, s27 bitop3:0x28
    v_lshl_add_u32 v109, v109, 3, s25
    v_lshlrev_b32 v112, 16, v31
    v_mul_f32 v108, s26, v108
    v_and_b32 v113, s28, v31
    v_pk_fma_f32 v[110:111], v[110:111], v[108:109], s[34:35] op_sel_hi:[1,0,1]
    v_pk_fma_f32 v[112:113], v[112:113], v[108:109], s[34:35] op_sel_hi:[1,0,1]
    v_lshl_add_u64 v[110:111], v[110:111], 0, s[36:37]
    v_lshl_add_u64 v[112:113], v[112:113], 0, s[36:37]
    v_cmpx_le_u32 vcc, s29, v63
    ds_add_u64 v109, v[110:111]
    ds_add_u64 v109, v[112:113] offset:50048
    s_mov_b64 exec, -1
    v_ashrrev_i32 v114, 5, v64
    v_bfe_u32 v115, v64, 8, 13
    v_lshlrev_b32 v116, 16, v32
    v_and_b32 v117, s28, v32
    v_bitop3_b32 v114, v114, v106, s27 bitop3:0x28
    v_lshl_add_u32 v115, v115, 3, s25
    v_lshlrev_b32 v118, 16, v33
    v_mul_f32 v114, s26, v114
    v_and_b32 v119, s28, v33
    v_pk_fma_f32 v[116:117], v[116:117], v[114:115], s[34:35] op_sel_hi:[1,0,1]
    v_pk_fma_f32 v[118:119], v[118:119], v[114:115], s[34:35] op_sel_hi:[1,0,1]
    v_lshl_add_u64 v[116:117], v[116:117], 0, s[36:37]
    v_lshl_add_u64 v[118:119], v[118:119], 0, s[36:37]
    v_cmpx_le_u32 vcc, s29, v64
    ds_add_u64 v115, v[116:117]
    ds_add_u64 v115, v[118:119] offset:50048
    s_mov_b64 exec, -1
    v_ashrrev_i32 v120, 5, v65
    v_bfe_u32 v121, v65, 8, 13
    v_lshlrev_b32 v122, 16, v34
    v_and_b32 v123, s28, v34
    v_bitop3_b32 v120, v120, v106, s27 bitop3:0x28
    v_lshl_add_u32 v121, v121, 3, s25
    v_lshlrev_b32 v124, 16, v35
    v_mul_f32 v120, s26, v120
    v_and_b32 v125, s28, v35
    v_pk_fma_f32 v[122:123], v[122:123], v[120:121], s[34:35] op_sel_hi:[1,0,1]
    v_pk_fma_f32 v[124:125], v[124:125], v[120:121], s[34:35] op_sel_hi:[1,0,1]
    v_lshl_add_u64 v[122:123], v[122:123], 0, s[36:37]
    v_lshl_add_u64 v[124:125], v[124:125], 0, s[36:37]
    v_cmpx_le_u32 vcc, s29, v65
    ds_add_u64 v121, v[122:123]
    ds_add_u64 v121, v[124:125] offset:50048
    s_mov_b64 exec, -1
p2_na0_5:
    s_cmp_le_u32 s17, 5
    s_cbranch_scc1 p2_nl0_5
    buffer_load_dwordx4 v[30:33], v99, s[4:7], 0 offen
p2_nl0_5:
    s_cmp_le_u32 s16, 6
    s_cbranch_scc1 p2_na0_6
    v_ashrrev_i32 v108, 5, v66
    v_bfe_u32 v109, v66, 8, 13
    v_lshlrev_b32 v110, 16, v36
    v_and_b32 v111, s28, v36
    v_bitop3_b32 v108, v108, v106, s27 bitop3:0x28
    v_lshl_add_u32 v109, v109, 3, s25
    v_lshlrev_b32 v112, 16, v37
    v_mul_f32 v108, s26, v108
    v_and_b32 v113, s28, v37
    v_pk_fma_f32 v[110:111], v[110:111], v[108:109], s[34:35] op_sel_hi:[1,0,1]
    v_pk_fma_f32 v[112:113], v[112:113], v[108:109], s[34:35] op_sel_hi:[1,0,1]
    v_lshl_add_u64 v[110:111], v[110:111], 0, s[36:37]
    v_lshl_add_u64 v[112:113], v[112:113], 0, s[36:37]
    v_cmpx_le_u32 vcc, s29, v66
    ds_add_u64 v109, v[110:111]
    ds_add_u64 v109, v[112:113] offset:50048
    s_mov_b64 exec, -1
    v_ashrrev_i32 v114, 5, v67
    v_bfe_u32 v115, v67, 8, 13
    v_lshlrev_b32 v116, 16, v38
    v_and_b32 v117, s28, v38
    v_bitop3_b32 v114, v114, v106, s27 bitop3:0x28
    v_lshl_add_u32 v115, v115, 3, s25
    v_lshlrev_b32 v118, 16, v39
    v_mul_f32 v114, s26, v114
    v_and_b32 v119, s28, v39
    v_pk_fma_f32 v[116:117], v[116:117], v[114:115], s[34:35] op_sel_hi:[1,0,1]
    v_pk_fma_f32 v[118:119], v[118:119], v[114:115], s[34:35] op_sel_hi:[1,0,1]
    v_lshl_add_u64 v[116:117], v[116:117], 0, s[36:37]
    v_lshl_add_u64 v[118:119], v[118:119], 0, s[36:37]
    v_cmpx_le_u32 vcc, s29, v67
    ds_add_u64 v115, v[116:117]
    ds_add_u64 v115, v[118:119] offset:50048
    s_mov_b64 exec, -1
    v_ashrrev_i32 v120, 5, v68
    v_bfe_u32 v121, v68, 8, 13
    v_lshlrev_b32 v122, 16, v40
    v_and_b32 v123, s28, v40
    v_bitop3_b32 v120, v120, v106, s27 bitop3:0x28
    v_lshl_add_u32 v121, v121, 3, s25
    v_lshlrev_b32 v124, 16, v41
    v_mul_f32 v120, s26, v120
    v_and_b32 v125, s28, v41
    v_pk_fma_f32 v[122:123], v[122:123], v[120:121], s[34:35] op_sel_hi:[1,0,1]
    v_pk_fma_f32 v[124:125], v[124:125], v[120:121], s[34:35] op_sel_hi:[1,0,1]
    v_lshl_add_u64 v[122:123], v[122:123], 0, s[36:37]
    v_lshl_add_u64 v[124:125], v[124:125], 0, s[36:37]
    v_cmpx_le_u32 vcc, s29, v68
    ds_add_u64 v121, v[122:123]
    ds_add_u64 v121, v[124:125] offset:50048
    s_mov_b64 exec, -1
p2_na0_6:
    s_cmp_le_u32 s17, 6
    s_cbranch_scc1 p2_nl0_6
    buffer_load_dwordx4 v[36:39], v100, s[4:7], 0 offen
p2_nl0_6:
    s_cmp_le_u32 s16, 7
    s_cbranch_scc1 p2_na0_7
    v_ashrrev_i32 v108, 5, v69
    v_bfe_u32 v109, v69, 8, 13
    v_lshlrev_b32 v110, 16, v42
    v_and_b32 v111, s28, v42
    v_bitop3_b32 v108, v108, v106, s27 bitop3:0x28
    v_lshl_add_u32 v109, v109, 3, s25
    v_lshlrev_b32 v112, 16, v43
    v_mul_f32 v108, s26, v108
    v_and_b32 v113, s28, v43
    v_pk_fma_f32 v[110:111], v[110:111], v[108:109], s[34:35] op_sel_hi:[1,0,1]
    v_pk_fma_f32 v[112:113], v[112:113], v[108:109], s[34:35] op_sel_hi:[1,0,1]
    v_lshl_add_u64 v[110:111], v[110:111], 0, s[36:37]
    v_lshl_add_u64 v[112:113], v[112:113], 0, s[36:37]
    v_cmpx_le_u32 vcc, s29, v69
    ds_add_u64 v109, v[110:111]
    ds_add_u64 v109, v[112:113] offset:50048
    s_mov_b64 exec, -1
    v_ashrrev_i32 v114, 5, v70
    v_bfe_u32 v115, v70, 8, 13
    v_lshlrev_b32 v116, 16, v44
    v_and_b32 v117, s28, v44
    v_bitop3_b32 v114, v114, v106, s27 bitop3:0x28
    v_lshl_add_u32 v115, v115, 3, s25
    v_lshlrev_b32 v118, 16, v45
    v_mul_f32 v114, s26, v114
    v_and_b32 v119, s28, v45
    v_pk_fma_f32 v[116:117], v[116:117], v[114:115], s[34:35] op_sel_hi:[1,0,1]
    v_pk_fma_f32 v[118:119], v[118:119], v[114:115], s[34:35] op_sel_hi:[1,0,1]
    v_lshl_add_u64 v[116:117], v[116:117], 0, s[36:37]
    v_lshl_add_u64 v[118:119], v[118:119], 0, s[36:37]
    v_cmpx_le_u32 vcc, s29, v70
    ds_add_u64 v115, v[116:117]
    ds_add_u64 v115, v[118:119] offset:50048
    s_mov_b64 exec, -1
    v_ashrrev_i32 v120, 5, v71
    v_bfe_u32 v121, v71, 8, 13
    v_lshlrev_b32 v122, 16, v46
    v_and_b32 v123, s28, v46
    v_bitop3_b32 v120, v120, v106, s27 bitop3:0x28
    v_lshl_add_u32 v121, v121, 3, s25
    v_lshlrev_b32 v124, 16, v47
    v_mul_f32 v120, s26, v120
    v_and_b32 v125, s28, v47
    v_pk_fma_f32 v[122:123], v[122:123], v[120:121], s[34:35] op_sel_hi:[1,0,1]
    v_pk_fma_f32 v[124:125], v[124:125], v[120:121], s[34:35] op_sel_hi:[1,0,1]
    v_lshl_add_u64 v[122:123], v[122:123], 0, s[36:37]
    v_lshl_add_u64 v[124:125], v[124:125], 0, s[36:37]
    v_cmpx_le_u32 vcc, s29, v71
    ds_add_u64 v121, v[122:123]
    ds_add_u64 v121, v[124:125] offset:50048
    s_mov_b64 exec, -1
p2_na0_7:
    s_cmp_le_u32 s17, 7
    s_cbranch_scc1 p2_nl0_7
    buffer_load_dwordx4 v[42:45], v101, s[4:7], 0 offen
p2_nl0_7:
    s_branch p2_added
p2_addf:
    s_cmp_le_u32 s16, 0
    s_cbranch_scc1 p2_na1_0
    v_ashrrev_i32 v108, 5, v48
    v_bfe_u32 v109, v48, 8, 13
    v_lshlrev_b32 v110, 16, v0
    v_and_b32 v111, s28, v0
    v_bitop3_b32 v108, v108, v106, s27 bitop3:0x28
    v_lshl_add_u32 v109, v109, 3, s25
    v_lshlrev_b32 v112, 16, v1
    v_mul_f32 v108, s26, v108
    v_and_b32 v113, s28, v1
    v_mul_f32 v110, v108, v110
    v_mul_f32 v111, v108, v111
    v_mul_f32 v112, v108, v112
    v_mul_f32 v113, v108, v113
    v_cmpx_le_u32 vcc, s29, v48
    ds_add_f32 v109, v110 offset:0
    ds_add_f32 v109, v111 offset:4
    ds_add_f32 v109, v112 offset:50048
    ds_add_f32 v109, v113 offset:50052
    s_mov_b64 exec, -1
    v_ashrrev_i32 v114, 5, v49
    v_bfe_u32 v115, v49, 8, 13
    v_lshlrev_b32 v116, 16, v2
    v_and_b32 v117, s28, v2
    v_bitop3_b32 v114, v114, v106, s27 bitop3:0x28
    v_lshl_add_u32 v115, v115, 3, s25
    v_lshlrev_b32 v118, 16, v3
    v_mul_f32 v114, s26, v114
    v_and_b32 v119, s28, v3
    v_mul_f32 v116, v114, v116
    v_mul_f32 v117, v114, v117
    v_mul_f32 v118, v114, v118
    v_mul_f32 v119, v114, v119
    v_cmpx_le_u32 vcc, s29, v49
    ds_add_f32 v115, v116 offset:0
    ds_add_f32 v115, v117 offset:4
    ds_add_f32 v115, v118 offset:50048
    ds_add_f32 v115, v119 offset:50052
    s_mov_b64 exec, -1
    v_ashrrev_i32 v120, 5, v50
    v_bfe_u32 v121, v50, 8, 13
    v_lshlrev_b32 v122, 16, v4
    v_and_b32 v123, s28, v4
    v_bitop3_b32 v120, v120, v106, s27 bitop3:0x28
    v_lshl_add_u32 v121, v121, 3, s25
    v_lshlrev_b32 v124, 16, v5
    v_mul_f32 v120, s26, v120
    v_and_b32 v125, s28, v5
    v_mul_f32 v122, v120, v122
    v_mul_f32 v123, v120, v123
    v_mul_f32 v124, v120, v124
    v_mul_f32 v125, v120, v125
    v_cmpx_le_u32 vcc, s29, v50
    ds_add_f32 v121, v122 offset:0
    ds_add_f32 v121, v123 offset:4
    ds_add_f32 v121, v124 offset:50048
    ds_add_f32 v121, v125 offset:50052
    s_mov_b64 exec, -1
p2_na1_0:
    s_cmp_le_u32 s17, 0
    s_cbranch_scc1 p2_nl1_0
    buffer_load_dwordx4 v[0:3], v94, s[4:7], 0 offen
p2_nl1_0:
    s_cmp_le_u32 s16, 1
    s_cbranch_scc1 p2_na1_1
    v_ashrrev_i32 v108, 5, v51
    v_bfe_u32 v109, v51, 8, 13
    v_lshlrev_b32 v110, 16, v6
    v_and_b32 v111, s28, v6
    v_bitop3_b32 v108, v108, v106, s27 bitop3:0x28
    v_lshl_add_u32 v109, v109, 3, s25
    v_lshlrev_b32 v112, 16, v7
    v_mul_f32 v108, s26, v108
    v_and_b32 v113, s28, v7
    v_mul_f32 v110, v108, v110
    v_mul_f32 v111, v108, v111
    v_mul_f32 v112, v108, v112
    v_mul_f32 v113, v108, v113
    v_cmpx_le_u32 vcc, s29, v51
    ds_add_f32 v109, v110 offset:0
    ds_add_f32 v109, v111 offset:4
    ds_add_f32 v109, v112 offset:50048
    ds_add_f32 v109, v113 offset:50052
    s_mov_b64 exec, -1
    v_ashrrev_i32 v114, 5, v52
    v_bfe_u32 v115, v52, 8, 13
    v_lshlrev_b32 v116, 16, v8
    v_and_b32 v117, s28, v8
    v_bitop3_b32 v114, v114, v106, s27 bitop3:0x28
    v_lshl_add_u32 v115, v115, 3, s25
    v_lshlrev_b32 v118, 16, v9
    v_mul_f32 v114, s26, v114
    v_and_b32 v119, s28, v9
    v_mul_f32 v116, v114, v116
    v_mul_f32 v117, v114, v117
    v_mul_f32 v118, v114, v118
    v_mul_f32 v119, v114, v119
    v_cmpx_le_u32 vcc, s29, v52
    ds_add_f32 v115, v116 offset:0
    ds_add_f32 v115, v117 offset:4
    ds_add_f32 v115, v118 offset:50048
    ds_add_f32 v115, v119 offset:50052
    s_mov_b64 exec, -1
    v_ashrrev_i32 v120, 5, v53
    v_bfe_u32 v121, v53, 8, 13
    v_lshlrev_b32 v122, 16, v10
    v_and_b32 v123, s28, v10
    v_bitop3_b32 v120, v120, v106, s27 bitop3:0x28
    v_lshl_add_u32 v121, v121, 3, s25
    v_lshlrev_b32 v124, 16, v11
    v_mul_f32 v120, s26, v120
    v_and_b32 v125, s28, v11
    v_mul_f32 v122, v120, v122
    v_mul_f32 v123, v120, v123
    v_mul_f32 v124, v120, v124
    v_mul_f32 v125, v120, v125
    v_cmpx_le_u32 vcc, s29, v53
    ds_add_f32 v121, v122 offset:0
    ds_add_f32 v121, v123 offset:4
    ds_add_f32 v121, v124 offset:50048
    ds_add_f32 v121, v125 offset:50052
    s_mov_b64 exec, -1
p2_na1_1:
    s_cmp_le_u32 s17, 1
    s_cbranch_scc1 p2_nl1_1
    buffer_load_dwordx4 v[6:9], v95, s[4:7], 0 offen
p2_nl1_1:
    s_cmp_le_u32 s16, 2
    s_cbranch_scc1 p2_na1_2
    v_ashrrev_i32 v108, 5, v54
    v_bfe_u32 v109, v54, 8, 13
    v_lshlrev_b32 v110, 16, v12
    v_and_b32 v111, s28, v12
    v_bitop3_b32 v108, v108, v106, s27 bitop3:0x28
    v_lshl_add_u32 v109, v109, 3, s25
    v_lshlrev_b32 v112, 16, v13
    v_mul_f32 v108, s26, v108
    v_and_b32 v113, s28, v13
    v_mul_f32 v110, v108, v110
    v_mul_f32 v111, v108, v111
    v_mul_f32 v112, v108, v112
    v_mul_f32 v113, v108, v113
    v_cmpx_le_u32 vcc, s29, v54
    ds_add_f32 v109, v110 offset:0
    ds_add_f32 v109, v111 offset:4
    ds_add_f32 v109, v112 offset:50048
    ds_add_f32 v109, v113 offset:50052
    s_mov_b64 exec, -1
    v_ashrrev_i32 v114, 5, v55
    v_bfe_u32 v115, v55, 8, 13
    v_lshlrev_b32 v116, 16, v14
    v_and_b32 v117, s28, v14
    v_bitop3_b32 v114, v114, v106, s27 bitop3:0x28
    v_lshl_add_u32 v115, v115, 3, s25
    v_lshlrev_b32 v118, 16, v15
    v_mul_f32 v114, s26, v114
    v_and_b32 v119, s28, v15
    v_mul_f32 v116, v114, v116
    v_mul_f32 v117, v114, v117
    v_mul_f32 v118, v114, v118
    v_mul_f32 v119, v114, v119
    v_cmpx_le_u32 vcc, s29, v55
    ds_add_f32 v115, v116 offset:0
    ds_add_f32 v115, v117 offset:4
    ds_add_f32 v115, v118 offset:50048
    ds_add_f32 v115, v119 offset:50052
    s_mov_b64 exec, -1
    v_ashrrev_i32 v120, 5, v56
    v_bfe_u32 v121, v56, 8, 13
    v_lshlrev_b32 v122, 16, v16
    v_and_b32 v123, s28, v16
    v_bitop3_b32 v120, v120, v106, s27 bitop3:0x28
    v_lshl_add_u32 v121, v121, 3, s25
    v_lshlrev_b32 v124, 16, v17
    v_mul_f32 v120, s26, v120
    v_and_b32 v125, s28, v17
    v_mul_f32 v122, v120, v122
    v_mul_f32 v123, v120, v123
    v_mul_f32 v124, v120, v124
    v_mul_f32 v125, v120, v125
    v_cmpx_le_u32 vcc, s29, v56
    ds_add_f32 v121, v122 offset:0
    ds_add_f32 v121, v123 offset:4
    ds_add_f32 v121, v124 offset:50048
    ds_add_f32 v121, v125 offset:50052
    s_mov_b64 exec, -1
p2_na1_2:
    s_cmp_le_u32 s17, 2
    s_cbranch_scc1 p2_nl1_2
    buffer_load_dwordx4 v[12:15], v96, s[4:7], 0 offen
p2_nl1_2:
    s_cmp_le_u32 s16, 3
    s_cbranch_scc1 p2_na1_3
    v_ashrrev_i32 v108, 5, v57
    v_bfe_u32 v109, v57, 8, 13
    v_lshlrev_b32 v110, 16, v18
    v_and_b32 v111, s28, v18
    v_bitop3_b32 v108, v108, v106, s27 bitop3:0x28
    v_lshl_add_u32 v109, v109, 3, s25
    v_lshlrev_b32 v112, 16, v19
    v_mul_f32 v108, s26, v108
    v_and_b32 v113, s28, v19
    v_mul_f32 v110, v108, v110
    v_mul_f32 v111, v108, v111
    v_mul_f32 v112, v108, v112
    v_mul_f32 v113, v108, v113
    v_cmpx_le_u32 vcc, s29, v57
    ds_add_f32 v109, v110 offset:0
    ds_add_f32 v109, v111 offset:4
    ds_add_f32 v109, v112 offset:50048
    ds_add_f32 v109, v113 offset:50052
    s_mov_b64 exec, -1
    v_ashrrev_i32 v114, 5, v58
    v_bfe_u32 v115, v58, 8, 13
    v_lshlrev_b32 v116, 16, v20
    v_and_b32 v117, s28, v20
    v_bitop3_b32 v114, v114, v106, s27 bitop3:0x28
    v_lshl_add_u32 v115, v115, 3, s25
    v_lshlrev_b32 v118, 16, v21
    v_mul_f32 v114, s26, v114
    v_and_b32 v119, s28, v21
    v_mul_f32 v116, v114, v116
    v_mul_f32 v117, v114, v117
    v_mul_f32 v118, v114, v118
    v_mul_f32 v119, v114, v119
    v_cmpx_le_u32 vcc, s29, v58
    ds_add_f32 v115, v116 offset:0
    ds_add_f32 v115, v117 offset:4
    ds_add_f32 v115, v118 offset:50048
    ds_add_f32 v115, v119 offset:50052
    s_mov_b64 exec, -1
    v_ashrrev_i32 v120, 5, v59
    v_bfe_u32 v121, v59, 8, 13
    v_lshlrev_b32 v122, 16, v22
    v_and_b32 v123, s28, v22
    v_bitop3_b32 v120, v120, v106, s27 bitop3:0x28
    v_lshl_add_u32 v121, v121, 3, s25
    v_lshlrev_b32 v124, 16, v23
    v_mul_f32 v120, s26, v120
    v_and_b32 v125, s28, v23
    v_mul_f32 v122, v120, v122
    v_mul_f32 v123, v120, v123
    v_mul_f32 v124, v120, v124
    v_mul_f32 v125, v120, v125
    v_cmpx_le_u32 vcc, s29, v59
    ds_add_f32 v121, v122 offset:0
    ds_add_f32 v121, v123 offset:4
    ds_add_f32 v121, v124 offset:50048
    ds_add_f32 v121, v125 offset:50052
    s_mov_b64 exec, -1
p2_na1_3:
    s_cmp_le_u32 s17, 3
    s_cbranch_scc1 p2_nl1_3
    buffer_load_dwordx4 v[18:21], v97, s[4:7], 0 offen
p2_nl1_3:
    s_cmp_le_u32 s16, 4
    s_cbranch_scc1 p2_na1_4
    v_ashrrev_i32 v108, 5, v60
    v_bfe_u32 v109, v60, 8, 13
    v_lshlrev_b32 v110, 16, v24
    v_and_b32 v111, s28, v24
    v_bitop3_b32 v108, v108, v106, s27 bitop3:0x28
    v_lshl_add_u32 v109, v109, 3, s25
    v_lshlrev_b32 v112, 16, v25
    v_mul_f32 v108, s26, v108
    v_and_b32 v113, s28, v25
    v_mul_f32 v110, v108, v110
    v_mul_f32 v111, v108, v111
    v_mul_f32 v112, v108, v112
    v_mul_f32 v113, v108, v113
    v_cmpx_le_u32 vcc, s29, v60
    ds_add_f32 v109, v110 offset:0
    ds_add_f32 v109, v111 offset:4
    ds_add_f32 v109, v112 offset:50048
    ds_add_f32 v109, v113 offset:50052
    s_mov_b64 exec, -1
    v_ashrrev_i32 v114, 5, v61
    v_bfe_u32 v115, v61, 8, 13
    v_lshlrev_b32 v116, 16, v26
    v_and_b32 v117, s28, v26
    v_bitop3_b32 v114, v114, v106, s27 bitop3:0x28
    v_lshl_add_u32 v115, v115, 3, s25
    v_lshlrev_b32 v118, 16, v27
    v_mul_f32 v114, s26, v114
    v_and_b32 v119, s28, v27
    v_mul_f32 v116, v114, v116
    v_mul_f32 v117, v114, v117
    v_mul_f32 v118, v114, v118
    v_mul_f32 v119, v114, v119
    v_cmpx_le_u32 vcc, s29, v61
    ds_add_f32 v115, v116 offset:0
    ds_add_f32 v115, v117 offset:4
    ds_add_f32 v115, v118 offset:50048
    ds_add_f32 v115, v119 offset:50052
    s_mov_b64 exec, -1
    v_ashrrev_i32 v120, 5, v62
    v_bfe_u32 v121, v62, 8, 13
    v_lshlrev_b32 v122, 16, v28
    v_and_b32 v123, s28, v28
    v_bitop3_b32 v120, v120, v106, s27 bitop3:0x28
    v_lshl_add_u32 v121, v121, 3, s25
    v_lshlrev_b32 v124, 16, v29
    v_mul_f32 v120, s26, v120
    v_and_b32 v125, s28, v29
    v_mul_f32 v122, v120, v122
    v_mul_f32 v123, v120, v123
    v_mul_f32 v124, v120, v124
    v_mul_f32 v125, v120, v125
    v_cmpx_le_u32 vcc, s29, v62
    ds_add_f32 v121, v122 offset:0
    ds_add_f32 v121, v123 offset:4
    ds_add_f32 v121, v124 offset:50048
    ds_add_f32 v121, v125 offset:50052
    s_mov_b64 exec, -1
p2_na1_4:
    s_cmp_le_u32 s17, 4
    s_cbranch_scc1 p2_nl1_4
    buffer_load_dwordx4 v[24:27], v98, s[4:7], 0 offen
p2_nl1_4:
    s_cmp_le_u32 s16, 5
    s_cbranch_scc1 p2_na1_5
    v_ashrrev_i32 v108, 5, v63
    v_bfe_u32 v109, v63, 8, 13
    v_lshlrev_b32 v110, 16, v30
    v_and_b32 v111, s28, v30
    v_bitop3_b32 v108, v108, v106, s27 bitop3:0x28
    v_lshl_add_u32 v109, v109, 3, s25
    v_lshlrev_b32 v112, 16, v31
    v_mul_f32 v108, s26, v108
    v_and_b32 v113, s28, v31
    v_mul_f32 v110, v108, v110
    v_mul_f32 v111, v108, v111
    v_mul_f32 v112, v108, v112
    v_mul_f32 v113, v108, v113
    v_cmpx_le_u32 vcc, s29, v63
    ds_add_f32 v109, v110 offset:0
    ds_add_f32 v109, v111 offset:4
    ds_add_f32 v109, v112 offset:50048
    ds_add_f32 v109, v113 offset:50052
    s_mov_b64 exec, -1
    v_ashrrev_i32 v114, 5, v64
    v_bfe_u32 v115, v64, 8, 13
    v_lshlrev_b32 v116, 16, v32
    v_and_b32 v117, s28, v32
    v_bitop3_b32 v114, v114, v106, s27 bitop3:0x28
    v_lshl_add_u32 v115, v115, 3, s25
    v_lshlrev_b32 v118, 16, v33
    v_mul_f32 v114, s26, v114
    v_and_b32 v119, s28, v33
    v_mul_f32 v116, v114, v116
    v_mul_f32 v117, v114, v117
    v_mul_f32 v118, v114, v118
    v_mul_f32 v119, v114, v119
    v_cmpx_le_u32 vcc, s29, v64
    ds_add_f32 v115, v116 offset:0
    ds_add_f32 v115, v117 offset:4
    ds_add_f32 v115, v118 offset:50048
    ds_add_f32 v115, v119 offset:50052
    s_mov_b64 exec, -1
    v_ashrrev_i32 v120, 5, v65
    v_bfe_u32 v121, v65, 8, 13
    v_lshlrev_b32 v122, 16, v34
    v_and_b32 v123, s28, v34
    v_bitop3_b32 v120, v120, v106, s27 bitop3:0x28
    v_lshl_add_u32 v121, v121, 3, s25
    v_lshlrev_b32 v124, 16, v35
    v_mul_f32 v120, s26, v120
    v_and_b32 v125, s28, v35
    v_mul_f32 v122, v120, v122
    v_mul_f32 v123, v120, v123
    v_mul_f32 v124, v120, v124
    v_mul_f32 v125, v120, v125
    v_cmpx_le_u32 vcc, s29, v65
    ds_add_f32 v121, v122 offset:0
    ds_add_f32 v121, v123 offset:4
    ds_add_f32 v121, v124 offset:50048
    ds_add_f32 v121, v125 offset:50052
    s_mov_b64 exec, -1
p2_na1_5:
    s_cmp_le_u32 s17, 5
    s_cbranch_scc1 p2_nl1_5
    buffer_load_dwordx4 v[30:33], v99, s[4:7], 0 offen
p2_nl1_5:
    s_cmp_le_u32 s16, 6
    s_cbranch_scc1 p2_na1_6
    v_ashrrev_i32 v108, 5, v66
    v_bfe_u32 v109, v66, 8, 13
    v_lshlrev_b32 v110, 16, v36
    v_and_b32 v111, s28, v36
    v_bitop3_b32 v108, v108, v106, s27 bitop3:0x28
    v_lshl_add_u32 v109, v109, 3, s25
    v_lshlrev_b32 v112, 16, v37
    v_mul_f32 v108, s26, v108
    v_and_b32 v113, s28, v37
    v_mul_f32 v110, v108, v110
    v_mul_f32 v111, v108, v111
    v_mul_f32 v112, v108, v112
    v_mul_f32 v113, v108, v113
    v_cmpx_le_u32 vcc, s29, v66
    ds_add_f32 v109, v110 offset:0
    ds_add_f32 v109, v111 offset:4
    ds_add_f32 v109, v112 offset:50048
    ds_add_f32 v109, v113 offset:50052
    s_mov_b64 exec, -1
    v_ashrrev_i32 v114, 5, v67
    v_bfe_u32 v115, v67, 8, 13
    v_lshlrev_b32 v116, 16, v38
    v_and_b32 v117, s28, v38
    v_bitop3_b32 v114, v114, v106, s27 bitop3:0x28
    v_lshl_add_u32 v115, v115, 3, s25
    v_lshlrev_b32 v118, 16, v39
    v_mul_f32 v114, s26, v114
    v_and_b32 v119, s28, v39
    v_mul_f32 v116, v114, v116
    v_mul_f32 v117, v114, v117
    v_mul_f32 v118, v114, v118
    v_mul_f32 v119, v114, v119
    v_cmpx_le_u32 vcc, s29, v67
    ds_add_f32 v115, v116 offset:0
    ds_add_f32 v115, v117 offset:4
    ds_add_f32 v115, v118 offset:50048
    ds_add_f32 v115, v119 offset:50052
    s_mov_b64 exec, -1
    v_ashrrev_i32 v120, 5, v68
    v_bfe_u32 v121, v68, 8, 13
    v_lshlrev_b32 v122, 16, v40
    v_and_b32 v123, s28, v40
    v_bitop3_b32 v120, v120, v106, s27 bitop3:0x28
    v_lshl_add_u32 v121, v121, 3, s25
    v_lshlrev_b32 v124, 16, v41
    v_mul_f32 v120, s26, v120
    v_and_b32 v125, s28, v41
    v_mul_f32 v122, v120, v122
    v_mul_f32 v123, v120, v123
    v_mul_f32 v124, v120, v124
    v_mul_f32 v125, v120, v125
    v_cmpx_le_u32 vcc, s29, v68
    ds_add_f32 v121, v122 offset:0
    ds_add_f32 v121, v123 offset:4
    ds_add_f32 v121, v124 offset:50048
    ds_add_f32 v121, v125 offset:50052
    s_mov_b64 exec, -1
p2_na1_6:
    s_cmp_le_u32 s17, 6
    s_cbranch_scc1 p2_nl1_6
    buffer_load_dwordx4 v[36:39], v100, s[4:7], 0 offen
p2_nl1_6:
    s_cmp_le_u32 s16, 7
    s_cbranch_scc1 p2_na1_7
    v_ashrrev_i32 v108, 5, v69
    v_bfe_u32 v109, v69, 8, 13
    v_lshlrev_b32 v110, 16, v42
    v_and_b32 v111, s28, v42
    v_bitop3_b32 v108, v108, v106, s27 bitop3:0x28
    v_lshl_add_u32 v109, v109, 3, s25
    v_lshlrev_b32 v112, 16, v43
    v_mul_f32 v108, s26, v108
    v_and_b32 v113, s28, v43
    v_mul_f32 v110, v108, v110
    v_mul_f32 v111, v108, v111
    v_mul_f32 v112, v108, v112
    v_mul_f32 v113, v108, v113
    v_cmpx_le_u32 vcc, s29, v69
    ds_add_f32 v109, v110 offset:0
    ds_add_f32 v109, v111 offset:4
    ds_add_f32 v109, v112 offset:50048
    ds_add_f32 v109, v113 offset:50052
    s_mov_b64 exec, -1
    v_ashrrev_i32 v114, 5, v70
    v_bfe_u32 v115, v70, 8, 13
    v_lshlrev_b32 v116, 16, v44
    v_and_b32 v117, s28, v44
    v_bitop3_b32 v114, v114, v106, s27 bitop3:0x28
    v_lshl_add_u32 v115, v115, 3, s25
    v_lshlrev_b32 v118, 16, v45
    v_mul_f32 v114, s26, v114
    v_and_b32 v119, s28, v45
    v_mul_f32 v116, v114, v116
    v_mul_f32 v117, v114, v117
    v_mul_f32 v118, v114, v118
    v_mul_f32 v119, v114, v119
    v_cmpx_le_u32 vcc, s29, v70
    ds_add_f32 v115, v116 offset:0
    ds_add_f32 v115, v117 offset:4
    ds_add_f32 v115, v118 offset:50048
    ds_add_f32 v115, v119 offset:50052
    s_mov_b64 exec, -1
    v_ashrrev_i32 v120, 5, v71
    v_bfe_u32 v121, v71, 8, 13
    v_lshlrev_b32 v122, 16, v46
    v_and_b32 v123, s28, v46
    v_bitop3_b32 v120, v120, v106, s27 bitop3:0x28
    v_lshl_add_u32 v121, v121, 3, s25
    v_lshlrev_b32 v124, 16, v47
    v_mul_f32 v120, s26, v120
    v_and_b32 v125, s28, v47
    v_mul_f32 v122, v120, v122
    v_mul_f32 v123, v120, v123
    v_mul_f32 v124, v120, v124
    v_mul_f32 v125, v120, v125
    v_cmpx_le_u32 vcc, s29, v71
    ds_add_f32 v121, v122 offset:0
    ds_add_f32 v121, v123 offset:4
    ds_add_f32 v121, v124 offset:50048
    ds_add_f32 v121, v125 offset:50052
    s_mov_b64 exec, -1
p2_na1_7:
    s_cmp_le_u32 s17, 7
    s_cbranch_scc1 p2_nl1_7
    buffer_load_dwordx4 v[42:45], v101, s[4:7], 0 offen
p2_nl1_7:
p2_added:
    s_cmp_lg_u32 s39, 0
    s_cbranch_scc1 p2_fin
    s_mov_b32 s16, s17
    s_waitcnt vmcnt(0)
    v_perm_b32 v48, v3, v0, s31
    v_perm_b32 v49, v3, v1, s32
    v_perm_b32 v50, v3, v2, s33
    v_and_or_b32 v48, v0, 7, v48
    v_and_or_b32 v49, v1, 7, v49
    v_and_or_b32 v50, v2, 7, v50
    v_and_b32 v4, 0xfff8, v2
    v_and_b32 v2, 0xfff8, v1
    v_and_b32 v0, 0xfff8, v0
    v_perm_b32 v51, v9, v6, s31
    v_perm_b32 v52, v9, v7, s32
    v_perm_b32 v53, v9, v8, s33
    v_and_or_b32 v51, v6, 7, v51
    v_and_or_b32 v52, v7, 7, v52
    v_and_or_b32 v53, v8, 7, v53
    v_and_b32 v10, 0xfff8, v8
    v_and_b32 v8, 0xfff8, v7
    v_and_b32 v6, 0xfff8, v6
    v_perm_b32 v54, v15, v12, s31
    v_perm_b32 v55, v15, v13, s32
    v_perm_b32 v56, v15, v14, s33
    v_and_or_b32 v54, v12, 7, v54
    v_and_or_b32 v55, v13, 7, v55
    v_and_or_b32 v56, v14, 7, v56
    v_and_b32 v16, 0xfff8, v14
    v_and_b32 v14, 0xfff8, v13
    v_and_b32 v12, 0xfff8, v12
    v_perm_b32 v57, v21, v18, s31
    v_perm_b32 v58, v21, v19, s32
    v_perm_b32 v59, v21, v20, s33
    v_and_or_b32 v57, v18, 7, v57
    v_and_or_b32 v58, v19, 7, v58
    v_and_or_b32 v59, v20, 7, v59
    v_and_b32 v22, 0xfff8, v20
    v_and_b32 v20, 0xfff8, v19
    v_and_b32 v18, 0xfff8, v18
    v_perm_b32 v60, v27, v24, s31
    v_perm_b32 v61, v27, v25, s32
    v_perm_b32 v62, v27, v26, s33
    v_and_or_b32 v60, v24, 7, v60
    v_and_or_b32 v61, v25, 7, v61
    v_and_or_b32 v62, v26, 7, v62
    v_and_b32 v28, 0xfff8, v26
    v_and_b32 v26, 0xfff8, v25
    v_and_b32 v24, 0xfff8, v24
    v_perm_b32 v63, v33, v30, s31
    v_perm_b32 v64, v33, v31, s32
    v_perm_b32 v65, v33, v32, s33
    v_and_or_b32 v63, v30, 7, v63
    v_and_or_b32 v64, v31, 7, v64
    v_and_or_b32 v65, v32, 7, v65
    v_and_b32 v34, 0xfff8, v32
    v_and_b32 v32, 0xfff8, v31
    v_and_b32 v30, 0xfff8, v30
    v_perm_b32 v66, v39, v36, s31
    v_perm_b32 v67, v39, v37, s32
    v_perm_b32 v68, v39, v38, s33
    v_and_or_b32 v66, v36, 7, v66
    v_and_or_b32 v67, v37, 7, v67
    v_and_or_b32 v68, v38, 7, v68
    v_and_b32 v40, 0xfff8, v38
    v_and_b32 v38, 0xfff8, v37
    v_and_b32 v36, 0xfff8, v36
    v_perm_b32 v69, v45, v42, s31
    v_perm_b32 v70, v45, v43, s32
    v_perm_b32 v71, v45, v44, s33
    v_and_or_b32 v69, v42, 7, v69
    v_and_or_b32 v70, v43, 7, v70
    v_and_or_b32 v71, v44, 7, v71
    v_and_b32 v46, 0xfff8, v44
    v_and_b32 v44, 0xfff8, v43
    v_and_b32 v42, 0xfff8, v42
    s_mov_b32 s15, 0
p2_step:
    s_waitcnt vmcnt(0)
    s_mov_b32 m0, s23
    s_nop 0
    ds_write_addtid_b32 v72 offset:0
    ds_write_addtid_b32 v73 offset:256
    ds_write_addtid_b32 v74 offset:512
    ds_write_addtid_b32 v75 offset:768
    ds_write_addtid_b32 v76 offset:1024
    ds_write_addtid_b32 v77 offset:1280
    ds_write_addtid_b32 v78 offset:1536
    ds_write_addtid_b32 v79 offset:1792
    ds_write_addtid_b32 v80 offset:2048
    ds_write_addtid_b32 v81 offset:2304
    ds_write_addtid_b32 v82 offset:2560
    ds_write_addtid_b32 v83 offset:2816
    s_cmp_ge_u32 s10, 9
    s_cbranch_scc1 p2_notail
    s_mov_b32 m0, s24
    s_nop 0
    ds_write_addtid_b32 v84 offset:49152
    ds_write_addtid_b32 v85 offset:49408
p2_notail:
    s_add_u32 s20, s20, 53760
    s_cmp_eq_u32 s15, 5
    s_cselect_b32 s44, s18, 0
    s_mul_i32 s44, s44, 322560
    s_sub_u32 s20, s20, s44
    buffer_load_dwordx4 v[72:75], v104, s[4:7], s20 offen offset:0
    buffer_load_dwordx4 v[76:79], v104, s[4:7], s20 offen offset:1024
    buffer_load_dwordx4 v[80:83], v104, s[4:7], s20 offen offset:2048
    buffer_load_dwordx2 v[84:85], v105, s[4:7], s20 offen
    s_waitcnt lgkmcnt(0)
    s_barrier
    s_cmp_le_u32 s16, 0
    s_cbranch_scc1 p2_gdone
    v_cmpx_eq_u32_sdwa vcc, v48, s15 src0_sel:BYTE_0 src1_sel:DWORD
    ds_read_b64 v[0:1], v0
    s_mov_b64 exec, -1
    v_cmpx_eq_u32_sdwa vcc, v49, s15 src0_sel:BYTE_0 src1_sel:DWORD
    ds_read_b64 v[2:3], v2
    s_mov_b64 exec, -1
    v_cmpx_eq_u32_sdwa vcc, v50, s15 src0_sel:BYTE_0 src1_sel:DWORD
    ds_read_b64 v[4:5], v4
    s_mov_b64 exec, -1
    s_cmp_le_u32 s16, 1
    s_cbranch_scc1 p2_gdone
    v_cmpx_eq_u32_sdwa vcc, v51, s15 src0_sel:BYTE_0 src1_sel:DWORD
    ds_read_b64 v[6:7], v6
    s_mov_b64 exec, -1
    v_cmpx_eq_u32_sdwa vcc, v52, s15 src0_sel:BYTE_0 src1_sel:DWORD
    ds_read_b64 v[8:9], v8
    s_mov_b64 exec, -1
    v_cmpx_eq_u32_sdwa vcc, v53, s15 src0_sel:BYTE_0 src1_sel:DWORD
    ds_read_b64 v[10:11], v10
    s_mov_b64 exec, -1
    s_cmp_le_u32 s16, 2
    s_cbranch_scc1 p2_gdone
    v_cmpx_eq_u32_sdwa vcc, v54, s15 src0_sel:BYTE_0 src1_sel:DWORD
    ds_read_b64 v[12:13], v12
    s_mov_b64 exec, -1
    v_cmpx_eq_u32_sdwa vcc, v55, s15 src0_sel:BYTE_0 src1_sel:DWORD
    ds_read_b64 v[14:15], v14
    s_mov_b64 exec, -1
    v_cmpx_eq_u32_sdwa vcc, v56, s15 src0_sel:BYTE_0 src1_sel:DWORD
    ds_read_b64 v[16:17], v16
    s_mov_b64 exec, -1
    s_cmp_le_u32 s16, 3
    s_cbranch_scc1 p2_gdone
    v_cmpx_eq_u32_sdwa vcc, v57, s15 src0_sel:BYTE_0 src1_sel:DWORD
    ds_read_b64 v[18:19], v18
    s_mov_b64 exec, -1
    v_cmpx_eq_u32_sdwa vcc, v58, s15 src0_sel:BYTE_0 src1_sel:DWORD
    ds_read_b64 v[20:21], v20
    s_mov_b64 exec, -1
    v_cmpx_eq_u32_sdwa vcc, v59, s15 src0_sel:BYTE_0 src1_sel:DWORD
    ds_read_b64 v[22:23], v22
    s_mov_b64 exec, -1
    s_cmp_le_u32 s16, 4
    s_cbranch_scc1 p2_gdone
    v_cmpx_eq_u32_sdwa vcc, v60, s15 src0_sel:BYTE_0 src1_sel:DWORD
    ds_read_b64 v[24:25], v24
    s_mov_b64 exec, -1
    v_cmpx_eq_u32_sdwa vcc, v61, s15 src0_sel:BYTE_0 src1_sel:DWORD
    ds_read_b64 v[26:27], v26
    s_mov_b64 exec, -1
    v_cmpx_eq_u32_sdwa vcc, v62, s15 src0_sel:BYTE_0 src1_sel:DWORD
    ds_read_b64 v[28:29], v28
    s_mov_b64 exec, -1
    s_cmp_le_u32 s16, 5
    s_cbranch_scc1 p2_gdone
    v_cmpx_eq_u32_sdwa vcc, v63, s15 src0_sel:BYTE_0 src1_sel:DWORD
    ds_read_b64 v[30:31], v30
    s_mov_b64 exec, -1
    v_cmpx_eq_u32_sdwa vcc, v64, s15 src0_sel:BYTE_0 src1_sel:DWORD
    ds_read_b64 v[32:33], v32
    s_mov_b64 exec, -1
    v_cmpx_eq_u32_sdwa vcc, v65, s15 src0_sel:BYTE_0 src1_sel:DWORD
    ds_read_b64 v[34:35], v34
    s_mov_b64 exec, -1
    s_cmp_le_u32 s16, 6
    s_cbranch_scc1 p2_gdone
    v_cmpx_eq_u32_sdwa vcc, v66, s15 src0_sel:BYTE_0 src1_sel:DWORD
    ds_read_b64 v[36:37], v36
    s_mov_b64 exec, -1
    v_cmpx_eq_u32_sdwa vcc, v67, s15 src0_sel:BYTE_0 src1_sel:DWORD
    ds_read_b64 v[38:39], v38
    s_mov_b64 exec, -1
    v_cmpx_eq_u32_sdwa vcc, v68, s15 src0_sel:BYTE_0 src1_sel:DWORD
    ds_read_b64 v[40:41], v40
    s_mov_b64 exec, -1
    s_cmp_le_u32 s16, 7
    s_cbranch_scc1 p2_gdone
    v_cmpx_eq_u32_sdwa vcc, v69, s15 src0_sel:BYTE_0 src1_sel:DWORD
    ds_read_b64 v[42:43], v42
    s_mov_b64 exec, -1
    v_cmpx_eq_u32_sdwa vcc, v70, s15 src0_sel:BYTE_0 src1_sel:DWORD
    ds_read_b64 v[44:45], v44
    s_mov_b64 exec, -1
    v_cmpx_eq_u32_sdwa vcc, v71, s15 src0_sel:BYTE_0 src1_sel:DWORD
    ds_read_b64 v[46:47], v46
    s_mov_b64 exec, -1
p2_gdone:
    s_cmp_gt_u32 s15, 1
    s_cbranch_scc1 p2_send
    s_cmp_eq_u32 s15, 1
    s_cbranch_scc1 p2_j1
    s_add_u32 s22, s22, 1
    s_and_b32 s44, s22, 1
    s_andn2_b32 s44, s44, s21
    s_cbranch_scc0 p2_send
    v_lshl_add_u32 v108, v102, 4, s25
    v_mov_b32 v109, 0
    s_mov_b32 s44, 0x10000000
    ds_read_b128 v[110:113], v108 offset:0
    ds_read_b128 v[114:117], v108 offset:16384
    ds_read_b128 v[118:121], v108 offset:32768
    ds_read_b128 v[122:125], v108 offset:49152
    s_mov_b64 exec, -1
    v_add_u32 v108, 65536, v108
    s_waitcnt lgkmcnt(0)
    v_add_u32 v110, s44, v110
    v_add_u32 v111, s44, v111
    v_add_u32 v112, s44, v112
    v_add_u32 v113, s44, v113
    v_add_u32 v114, s44, v114
    v_add_u32 v115, s44, v115
    v_add_u32 v116, s44, v116
    v_add_u32 v117, s44, v117
    v_add_u32 v118, s44, v118
    v_add_u32 v119, s44, v119
    v_add_u32 v120, s44, v120
    v_add_u32 v121, s44, v121
    v_add_u32 v122, s44, v122
    v_add_u32 v123, s44, v123
    v_add_u32 v124, s44, v124
    v_add_u32 v125, s44, v125
    v_or3_b32 v109, v109, v110, v111
    v_or3_b32 v109, v109, v112, v113
    v_or3_b32 v109, v109, v114, v115
    v_or3_b32 v109, v109, v116, v117
    v_or3_b32 v109, v109, v118, v119
    v_or3_b32 v109, v109, v120, v121
    v_or3_b32 v109, v109, v122, v123
    v_or3_b32 v109, v109, v124, v125
    ds_read_b128 v[110:113], v108 offset:0
    ds_read_b128 v[114:117], v108 offset:16384
    v_mov_b32 v118, 0
    v_mov_b32 v119, 0
    v_mov_b32 v120, 0
    v_mov_b32 v121, 0
    v_cmpx_gt_u32 vcc, 112, v102
    ds_read_b128 v[118:121], v108 offset:32768
    s_mov_b64 exec, -1
    s_waitcnt lgkmcnt(0)
    v_add_u32 v110, s44, v110
    v_add_u32 v111, s44, v111
    v_add_u32 v112, s44, v112
    v_add_u32 v113, s44, v113
    v_add_u32 v114, s44, v114
    v_add_u32 v115, s44, v115
    v_add_u32 v116, s44, v116
    v_add_u32 v117, s44, v117
    v_add_u32 v118, s44, v118
    v_add_u32 v119, s44, v119
    v_add_u32 v120, s44, v120
    v_add_u32 v121, s44, v121
    v_or3_b32 v109, v109, v110, v111
    v_or3_b32 v109, v109, v112, v113
    v_or3_b32 v109, v109, v114, v115
    v_or3_b32 v109, v109, v116, v117
    v_or3_b32 v109, v109, v118, v119
    v_or3_b32 v109, v109, v120, v121
    v_mov_b32 v110, 0
    v_cmpx_le_u32 vcc, 0x20000000, v109
    ds_write_b32 v110, v109 offset:53768
    s_mov_b64 exec, -1
    s_branch p2_send
p2_j1:
    v_mov_b32 v108, s19
    s_xor_b32 s19, s19, 4
    v_mov_b32 v109, s19
    v_mov_b32 v110, 0
    ds_read_b32 v111, v108 offset:53760
    ds_read_b32 v112, v110 offset:53768
    ds_write_b32 v109, v110 offset:53760
    s_waitcnt lgkmcnt(0)
    v_readfirstlane_b32 s18, v111
    v_readfirstlane_b32 s44, v112
    s_nop 0
    s_cmp_eq_u32 s44, 0
    s_cbranch_scc1 p2_noviol
    s_mov_b32 s21, 1
    s_waitcnt vmcnt(0)
    s_branch p2_restart
p2_noviol:
    s_cmp_lg_u32 s18, 0
    s_cbranch_scc1 p2_send
    s_add_u32 s13, s13, 1
    s_cmp_ge_u32 s13, s14
    s_cselect_b32 s39, 1, 0
    s_cbranch_scc1 p2_send
    s_and_b32 s44, s13, 3
    s_cbranch_scc0 p2_newdesc
    v_lshrrev_b64 v[86:87], 16, v[86:87]
    v_lshrrev_b64 v[88:89], 16, v[88:89]
    v_lshrrev_b64 v[90:91], 16, v[90:91]
    v_lshrrev_b64 v[92:93], 16, v[92:93]
    s_branch p2_send
p2_newdesc:
    s_lshr_b32 s44, s13, 2
    s_mul_i32 s44, s44, 1032
    s_add_u32 s44, s44, s40
    v_add_u32 v108, s41, v103
    v_mul_u32_u24 v108, 5248, v108
    buffer_load_dwordx4 v[86:89], v108, s[4:7], s44 offen
    s_add_u32 s44, s44, 335872
    buffer_load_dwordx4 v[90:93], v108, s[4:7], s44 offen
p2_send:
    s_waitcnt lgkmcnt(0)
    s_barrier
    s_add_u32 s15, s15, 1
    s_cmp_lt_u32 s15, 6
    s_cbranch_scc1 p2_step
    s_branch p2_top
p2_fin:
    s_waitcnt vmcnt(0) lgkmcnt(0)
    s_barrier
    s_mul_i32 s44, s11, 12800000
    s_mul_i32 s45, s12, 100000
    s_add_u32 s44, s44, s45
    s_add_u32 s44, s44, 346484736
    v_lshl_add_u32 v108, v102, 3, s25
    v_add_u32 v110, 50048, v108
    v_lshlrev_b32 v109, 4, v102
    ds_read_b64 v[0:1], v108 offset:0
    ds_read_b64 v[2:3], v110 offset:0
    ds_read_b64 v[4:5], v108 offset:8192
    ds_read_b64 v[6:7], v110 offset:8192
    ds_read_b64 v[8:9], v108 offset:16384
    ds_read_b64 v[10:11], v110 offset:16384
    ds_read_b64 v[12:13], v108 offset:24576
    ds_read_b64 v[14:15], v110 offset:24576
    ds_read_b64 v[16:17], v108 offset:32768
    ds_read_b64 v[18:19], v110 offset:32768
    ds_read_b64 v[20:21], v108 offset:40960
    ds_read_b64 v[22:23], v110 offset:40960
    ds_read_b64 v[24:25], v108 offset:49152
    ds_read_b64 v[26:27], v110 offset:49152
    s_waitcnt lgkmcnt(0)
    s_cmp_lg_u32 s21, 0
    s_cbranch_scc1 p2_st
    v_ashrrev_i32 v111, 31, v0
    v_sub_u32 v1, v1, v111
    v_cvt_f32_i32 v0, v0
    v_cvt_f32_i32 v1, v1
    v_mul_f32 v0, s30, v0
    v_mul_f32 v1, s30, v1
    v_ashrrev_i32 v111, 31, v2
    v_sub_u32 v3, v3, v111
    v_cvt_f32_i32 v2, v2
    v_cvt_f32_i32 v3, v3
    v_mul_f32 v2, s30, v2
    v_mul_f32 v3, s30, v3
    v_ashrrev_i32 v111, 31, v4
    v_sub_u32 v5, v5, v111
    v_cvt_f32_i32 v4, v4
    v_cvt_f32_i32 v5, v5
    v_mul_f32 v4, s30, v4
    v_mul_f32 v5, s30, v5
    v_ashrrev_i32 v111, 31, v6
    v_sub_u32 v7, v7, v111
    v_cvt_f32_i32 v6, v6
    v_cvt_f32_i32 v7, v7
    v_mul_f32 v6, s30, v6
    v_mul_f32 v7, s30, v7
    v_ashrrev_i32 v111, 31, v8
    v_sub_u32 v9, v9, v111
    v_cvt_f32_i32 v8, v8
    v_cvt_f32_i32 v9, v9
    v_mul_f32 v8, s30, v8
    v_mul_f32 v9, s30, v9
    v_ashrrev_i32 v111, 31, v10
    v_sub_u32 v11, v11, v111
    v_cvt_f32_i32 v10, v10
    v_cvt_f32_i32 v11, v11
    v_mul_f32 v10, s30, v10
    v_mul_f32 v11, s30, v11
    v_ashrrev_i32 v111, 31, v12
    v_sub_u32 v13, v13, v111
    v_cvt_f32_i32 v12, v12
    v_cvt_f32_i32 v13, v13
    v_mul_f32 v12, s30, v12
    v_mul_f32 v13, s30, v13
    v_ashrrev_i32 v111, 31, v14
    v_sub_u32 v15, v15, v111
    v_cvt_f32_i32 v14, v14
    v_cvt_f32_i32 v15, v15
    v_mul_f32 v14, s30, v14
    v_mul_f32 v15, s30, v15
    v_ashrrev_i32 v111, 31, v16
    v_sub_u32 v17, v17, v111
    v_cvt_f32_i32 v16, v16
    v_cvt_f32_i32 v17, v17
    v_mul_f32 v16, s30, v16
    v_mul_f32 v17, s30, v17
    v_ashrrev_i32 v111, 31, v18
    v_sub_u32 v19, v19, v111
    v_cvt_f32_i32 v18, v18
    v_cvt_f32_i32 v19, v19
    v_mul_f32 v18, s30, v18
    v_mul_f32 v19, s30, v19
    v_ashrrev_i32 v111, 31, v20
    v_sub_u32 v21, v21, v111
    v_cvt_f32_i32 v20, v20
    v_cvt_f32_i32 v21, v21
    v_mul_f32 v20, s30, v20
    v_mul_f32 v21, s30, v21
    v_ashrrev_i32 v111, 31, v22
    v_sub_u32 v23, v23, v111
    v_cvt_f32_i32 v22, v22
    v_cvt_f32_i32 v23, v23
    v_mul_f32 v22, s30, v22
    v_mul_f32 v23, s30, v23
    v_ashrrev_i32 v111, 31, v24
    v_sub_u32 v25, v25, v111
    v_cvt_f32_i32 v24, v24
    v_cvt_f32_i32 v25, v25
    v_mul_f32 v24, s30, v24
    v_mul_f32 v25, s30, v25
    v_ashrrev_i32 v111, 31, v26
    v_sub_u32 v27, v27, v111
    v_cvt_f32_i32 v26, v26
    v_cvt_f32_i32 v27, v27
    v_mul_f32 v26, s30, v26
    v_mul_f32 v27, s30, v27
p2_st:
    buffer_store_dwordx4 v[0:3], v109, s[4:7], s44 offen
    s_add_u32 s44, s44, 16384
    buffer_store_dwordx4 v[4:7], v109, s[4:7], s44 offen
    s_add_u32 s44, s44, 16384
    buffer_store_dwordx4 v[8:11], v109, s[4:7], s44 offen
    s_add_u32 s44, s44, 16384
    buffer_store_dwordx4 v[12:15], v109, s[4:7], s44 offen
    s_add_u32 s44, s44, 16384
    buffer_store_dwordx4 v[16:19], v109, s[4:7], s44 offen
    s_add_u32 s44, s44, 16384
    buffer_store_dwordx4 v[20:23], v109, s[4:7], s44 offen
    s_add_u32 s44, s44, 16384
    v_cmp_gt_u32 vcc, 106, v102
    s_and_saveexec_b64 s[46:47], vcc
    s_cbranch_execz p2_end
    buffer_store_dwordx4 v[24:27], v109, s[4:7], s44 offen
    s_add_u32 s44, s44, 16384
p2_end:
    s_endpgm
.globl p3_kernel
.p2align 8
.type p3_kernel,@function
p3_kernel:
    s_cmp_ge_u32 s2, 3125
    s_cbranch_scc1 p3_end
    s_load_dwordx2 s[4:5], s[0:1], 0
    s_load_dwordx2 s[6:7], s[0:1], 24
    s_load_dwordx2 s[8:9], s[0:1], 40
    s_load_dwordx8 s[12:19], s[0:1], 56
    s_load_dwordx2 s[10:11], s[0:1], 88
    s_load_dwordx2 s[20:21], s[0:1], 104
    s_lshl_b32 s3, s2, 8
    v_add_u32 v0, s3, v0
    v_lshlrev_b32 v1, 4, v0
    v_lshlrev_b32 v2, 3, v0
    v_lshlrev_b32 v3, 1, v0
    s_waitcnt lgkmcnt(0)
    s_load_dwordx4 s[40:43], s[8:9], 0
    s_load_dwordx16 s[44:59], s[12:13], 0
    s_load_dwordx16 s[60:75], s[14:15], 0
    s_load_dwordx8 s[76:83], s[16:17], 0
    s_load_dwordx8 s[84:91], s[18:19], 0
    s_mov_b32 s24, s4
    s_and_b32 s25, s5, 0xffff
    s_mov_b32 s26, 6400000
    s_mov_b32 s27, 0x20000
    s_mov_b32 s28, s6
    s_and_b32 s29, s7, 0xffff
    s_mov_b32 s30, 1600000
    s_mov_b32 s31, 0x20000
    s_mov_b32 s32, s10
    s_and_b32 s33, s11, 0xffff
    s_mov_b32 s34, 6400000
    s_mov_b32 s35, 0x20000
    s_mov_b32 s36, s20
    s_and_b32 s37, s21, 0xffff
    s_mov_b32 s38, 819200000
    s_mov_b32 s39, 0x20000
    s_mov_b32 s22, 346484736
    s_mov_b32 s23, 359284736
    buffer_load_ushort v14, v3, s[28:31], 0 offen
    buffer_load_dwordx4 v[4:7], v1, s[36:39], s22 offen
    buffer_load_dwordx4 v[8:11], v1, s[36:39], s23 offen
    buffer_load_dwordx2 v[12:13], v2, s[24:27], 0 offen
    s_mov_b32 s92, 0xffff0000
    s_waitcnt vmcnt(3) lgkmcnt(0)
    v_lshlrev_b32 v14, 16, v14
    s_lshl_b32 s94, s40, 16
    v_subrev_f32 v16, s94, v14
    s_and_b32 s95, s40, s92
    v_subrev_f32 v17, s95, v14
    s_lshl_b32 s96, s41, 16
    v_subrev_f32 v18, s96, v14
    s_and_b32 s93, s41, s92
    v_subrev_f32 v19, s93, v14
    s_lshl_b32 s94, s42, 16
    v_subrev_f32 v20, s94, v14
    s_and_b32 s95, s42, s92
    v_subrev_f32 v21, s95, v14
    s_lshl_b32 s96, s43, 16
    v_subrev_f32 v22, s96, v14
    s_and_b32 s93, s43, s92
    v_subrev_f32 v23, s93, v14
    v_cvt_pk_bf16_f32 v16, v16, v17
    v_cvt_pk_bf16_f32 v18, v18, v19
    v_cvt_pk_bf16_f32 v20, v20, v21
    v_cvt_pk_bf16_f32 v22, v22, v23
    v_and_b32 v17, s92, v16
    v_lshlrev_b32 v16, 16, v16
    v_and_b32 v19, s92, v18
    v_lshlrev_b32 v18, 16, v18
    v_and_b32 v21, s92, v20
    v_lshlrev_b32 v20, 16, v20
    v_and_b32 v23, s92, v22
    v_lshlrev_b32 v22, 16, v22
    v_mul_f32 v16, v16, v16
    v_mul_f32 v17, v17, v17
    v_mul_f32 v18, v18, v18
    v_mul_f32 v19, v19, v19
    v_mul_f32 v20, v20, v20
    v_mul_f32 v21, v21, v21
    v_mul_f32 v22, v22, v22
    v_mul_f32 v23, v23, v23
    v_cvt_pk_bf16_f32 v16, v16, v17
    v_cvt_pk_bf16_f32 v18, v18, v19
    v_cvt_pk_bf16_f32 v20, v20, v21
    v_cvt_pk_bf16_f32 v22, v22, v23
    v_and_b32 v17, s92, v16
    v_lshlrev_b32 v16, 16, v16
    v_and_b32 v19, s92, v18
    v_lshlrev_b32 v18, 16, v18
    v_and_b32 v21, s92, v20
    v_lshlrev_b32 v20, 16, v20
    v_and_b32 v23, s92, v22
    v_lshlrev_b32 v22, 16, v22
    v_mul_f32 v16, 0xc1200000, v16
    v_mul_f32 v17, 0xc1200000, v17
    v_mul_f32 v18, 0xc1200000, v18
    v_mul_f32 v19, 0xc1200000, v19
    v_mul_f32 v20, 0xc1200000, v20
    v_mul_f32 v21, 0xc1200000, v21
    v_mul_f32 v22, 0xc1200000, v22
    v_mul_f32 v23, 0xc1200000, v23
    v_cvt_pk_bf16_f32 v16, v16, v17
    v_cvt_pk_bf16_f32 v18, v18, v19
    v_cvt_pk_bf16_f32 v20, v20, v21
    v_cvt_pk_bf16_f32 v22, v22, v23
    v_and_b32 v17, s92, v16
    v_lshlrev_b32 v16, 16, v16
    v_and_b32 v19, s92, v18
    v_lshlrev_b32 v18, 16, v18
    v_and_b32 v21, s92, v20
    v_lshlrev_b32 v20, 16, v20
    v_and_b32 v23, s92, v22
    v_lshlrev_b32 v22, 16, v22
    v_mul_f32 v16, 0x3fb8aa3b, v16
    v_mul_f32 v17, 0x3fb8aa3b, v17
    v_mul_f32 v18, 0x3fb8aa3b, v18
    v_mul_f32 v19, 0x3fb8aa3b, v19
    v_mul_f32 v20, 0x3fb8aa3b, v20
    v_mul_f32 v21, 0x3fb8aa3b, v21
    v_mul_f32 v22, 0x3fb8aa3b, v22
    v_mul_f32 v23, 0x3fb8aa3b, v23
    v_exp_f32 v16, v16
    v_exp_f32 v17, v17
    v_exp_f32 v18, v18
    v_exp_f32 v19, v19
    v_exp_f32 v20, v20
    v_exp_f32 v21, v21
    v_exp_f32 v22, v22
    v_exp_f32 v23, v23
    s_nop 0
    v_cvt_pk_bf16_f32 v16, v16, v17
    v_cvt_pk_bf16_f32 v18, v18, v19
    v_cvt_pk_bf16_f32 v20, v20, v21
    v_cvt_pk_bf16_f32 v22, v22, v23
    v_and_b32 v17, s92, v16
    v_lshlrev_b32 v16, 16, v16
    v_and_b32 v19, s92, v18
    v_lshlrev_b32 v18, 16, v18
    v_and_b32 v21, s92, v20
    v_lshlrev_b32 v20, 16, v20
    v_and_b32 v23, s92, v22
    v_lshlrev_b32 v22, 16, v22
    s_lshl_b32 s94, s60, 16
    v_mul_f32 v24, s94, v16
    s_and_b32 s95, s60, s92
    v_mul_f32 v25, s95, v16
    s_lshl_b32 s96, s61, 16
    v_mul_f32 v26, s96, v16
    s_and_b32 s93, s61, s92
    v_mul_f32 v27, s93, v16
    s_lshl_b32 s94, s62, 16
    v_fmac_f32 v24, s94, v17
    s_and_b32 s95, s62, s92
    v_fmac_f32 v25, s95, v17
    s_lshl_b32 s96, s63, 16
    v_fmac_f32 v26, s96, v17
    s_and_b32 s93, s63, s92
    v_fmac_f32 v27, s93, v17
    s_lshl_b32 s94, s64, 16
    v_fmac_f32 v24, s94, v18
    s_and_b32 s95, s64, s92
    v_fmac_f32 v25, s95, v18
    s_lshl_b32 s96, s65, 16
    v_fmac_f32 v26, s96, v18
    s_and_b32 s93, s65, s92
    v_fmac_f32 v27, s93, v18
    s_lshl_b32 s94, s66, 16
    v_fmac_f32 v24, s94, v19
    s_and_b32 s95, s66, s92
    v_fmac_f32 v25, s95, v19
    s_lshl_b32 s96, s67, 16
    v_fmac_f32 v26, s96, v19
    s_and_b32 s93, s67, s92
    v_fmac_f32 v27, s93, v19
    s_lshl_b32 s94, s68, 16
    v_fmac_f32 v24, s94, v20
    s_and_b32 s95, s68, s92
    v_fmac_f32 v25, s95, v20
    s_lshl_b32 s96, s69, 16
    v_fmac_f32 v26, s96, v20
    s_and_b32 s93, s69, s92
    v_fmac_f32 v27, s93, v20
    s_lshl_b32 s94, s70, 16
    v_fmac_f32 v24, s94, v21
    s_and_b32 s95, s70, s92
    v_fmac_f32 v25, s95, v21
    s_lshl_b32 s96, s71, 16
    v_fmac_f32 v26, s96, v21
    s_and_b32 s93, s71, s92
    v_fmac_f32 v27, s93, v21
    s_lshl_b32 s94, s72, 16
    v_fmac_f32 v24, s94, v22
    s_and_b32 s95, s72, s92
    v_fmac_f32 v25, s95, v22
    s_lshl_b32 s96, s73, 16
    v_fmac_f32 v26, s96, v22
    s_and_b32 s93, s73, s92
    v_fmac_f32 v27, s93, v22
    s_lshl_b32 s94, s74, 16
    v_fmac_f32 v24, s94, v23
    s_and_b32 s95, s74, s92
    v_fmac_f32 v25, s95, v23
    s_lshl_b32 s96, s75, 16
    v_fmac_f32 v26, s96, v23
    s_and_b32 s93, s75, s92
    v_fmac_f32 v27, s93, v23
    s_lshl_b32 s94, s44, 16
    v_mul_f32 v28, s94, v16
    s_and_b32 s95, s44, s92
    v_mul_f32 v29, s95, v16
    s_lshl_b32 s96, s45, 16
    v_mul_f32 v30, s96, v16
    s_and_b32 s93, s45, s92
    v_mul_f32 v31, s93, v16
    s_lshl_b32 s94, s46, 16
    v_fmac_f32 v28, s94, v17
    s_and_b32 s95, s46, s92
    v_fmac_f32 v29, s95, v17
    s_lshl_b32 s96, s47, 16
    v_fmac_f32 v30, s96, v17
    s_and_b32 s93, s47, s92
    v_fmac_f32 v31, s93, v17
    s_lshl_b32 s94, s48, 16
    v_fmac_f32 v28, s94, v18
    s_and_b32 s95, s48, s92
    v_fmac_f32 v29, s95, v18
    s_lshl_b32 s96, s49, 16
    v_fmac_f32 v30, s96, v18
    s_and_b32 s93, s49, s92
    v_fmac_f32 v31, s93, v18
    s_lshl_b32 s94, s50, 16
    v_fmac_f32 v28, s94, v19
    s_and_b32 s95, s50, s92
    v_fmac_f32 v29, s95, v19
    s_lshl_b32 s96, s51, 16
    v_fmac_f32 v30, s96, v19
    s_and_b32 s93, s51, s92
    v_fmac_f32 v31, s93, v19
    s_lshl_b32 s94, s52, 16
    v_fmac_f32 v28, s94, v20
    s_and_b32 s95, s52, s92
    v_fmac_f32 v29, s95, v20
    s_lshl_b32 s96, s53, 16
    v_fmac_f32 v30, s96, v20
    s_and_b32 s93, s53, s92
    v_fmac_f32 v31, s93, v20
    s_lshl_b32 s94, s54, 16
    v_fmac_f32 v28, s94, v21
    s_and_b32 s95, s54, s92
    v_fmac_f32 v29, s95, v21
    s_lshl_b32 s96, s55, 16
    v_fmac_f32 v30, s96, v21
    s_and_b32 s93, s55, s92
    v_fmac_f32 v31, s93, v21
    s_lshl_b32 s94, s56, 16
    v_fmac_f32 v28, s94, v22
    s_and_b32 s95, s56, s92
    v_fmac_f32 v29, s95, v22
    s_lshl_b32 s96, s57, 16
    v_fmac_f32 v30, s96, v22
    s_and_b32 s93, s57, s92
    v_fmac_f32 v31, s93, v22
    s_lshl_b32 s94, s58, 16
    v_fmac_f32 v28, s94, v23
    s_and_b32 s95, s58, s92
    v_fmac_f32 v29, s95, v23
    s_lshl_b32 s96, s59, 16
    v_fmac_f32 v30, s96, v23
    s_and_b32 s93, s59, s92
    v_fmac_f32 v31, s93, v23
    v_cvt_pk_bf16_f32 v28, v28, v29
    v_cvt_pk_bf16_f32 v30, v30, v31
    v_and_b32 v29, s92, v28
    v_lshlrev_b32 v28, 16, v28
    v_and_b32 v31, s92, v30
    v_lshlrev_b32 v30, 16, v30
    s_waitcnt vmcnt(0)
    v_add_f32 v4, v4, v8
    v_add_f32 v5, v5, v9
    v_add_f32 v6, v6, v10
    v_add_f32 v7, v7, v11
    s_lshl_b32 s94, s76, 16
    v_mul_f32 v8, s94, v4
    s_and_b32 s95, s76, s92
    v_mul_f32 v9, s95, v4
    s_lshl_b32 s96, s77, 16
    v_mul_f32 v10, s96, v4
    s_and_b32 s93, s77, s92
    v_mul_f32 v11, s93, v4
    s_lshl_b32 s94, s78, 16
    v_fmac_f32 v8, s94, v5
    s_and_b32 s95, s78, s92
    v_fmac_f32 v9, s95, v5
    s_lshl_b32 s96, s79, 16
    v_fmac_f32 v10, s96, v5
    s_and_b32 s93, s79, s92
    v_fmac_f32 v11, s93, v5
    s_lshl_b32 s94, s80, 16
    v_fmac_f32 v8, s94, v6
    s_and_b32 s95, s80, s92
    v_fmac_f32 v9, s95, v6
    s_lshl_b32 s96, s81, 16
    v_fmac_f32 v10, s96, v6
    s_and_b32 s93, s81, s92
    v_fmac_f32 v11, s93, v6
    s_lshl_b32 s94, s82, 16
    v_fmac_f32 v8, s94, v7
    s_and_b32 s95, s82, s92
    v_fmac_f32 v9, s95, v7
    s_lshl_b32 s96, s83, 16
    v_fmac_f32 v10, s96, v7
    s_and_b32 s93, s83, s92
    v_fmac_f32 v11, s93, v7
    v_mul_f32 v24, v24, v8
    v_mul_f32 v25, v25, v9
    v_mul_f32 v26, v26, v10
    v_mul_f32 v27, v27, v11
    v_cvt_pk_bf16_f32 v24, v24, v25
    v_cvt_pk_bf16_f32 v26, v26, v27
    v_and_b32 v25, s92, v24
    v_lshlrev_b32 v24, 16, v24
    v_and_b32 v27, s92, v26
    v_lshlrev_b32 v26, 16, v26
    s_lshl_b32 s94, s84, 16
    v_mul_f32 v8, s94, v24
    s_and_b32 s95, s84, s92
    v_mul_f32 v9, s95, v24
    s_lshl_b32 s96, s85, 16
    v_mul_f32 v10, s96, v24
    s_and_b32 s93, s85, s92
    v_mul_f32 v11, s93, v24
    s_lshl_b32 s94, s86, 16
    v_fmac_f32 v8, s94, v25
    s_and_b32 s95, s86, s92
    v_fmac_f32 v9, s95, v25
    s_lshl_b32 s96, s87, 16
    v_fmac_f32 v10, s96, v25
    s_and_b32 s93, s87, s92
    v_fmac_f32 v11, s93, v25
    s_lshl_b32 s94, s88, 16
    v_fmac_f32 v8, s94, v26
    s_and_b32 s95, s88, s92
    v_fmac_f32 v9, s95, v26
    s_lshl_b32 s96, s89, 16
    v_fmac_f32 v10, s96, v26
    s_and_b32 s93, s89, s92
    v_fmac_f32 v11, s93, v26
    s_lshl_b32 s94, s90, 16
    v_fmac_f32 v8, s94, v27
    s_and_b32 s95, s90, s92
    v_fmac_f32 v9, s95, v27
    s_lshl_b32 s96, s91, 16
    v_fmac_f32 v10, s96, v27
    s_and_b32 s93, s91, s92
    v_fmac_f32 v11, s93, v27
    v_cvt_pk_bf16_f32 v8, v8, v9
    v_cvt_pk_bf16_f32 v10, v10, v11
    v_and_b32 v9, s92, v8
    v_lshlrev_b32 v8, 16, v8
    v_and_b32 v11, s92, v10
    v_lshlrev_b32 v10, 16, v10
    v_mul_f32 v8, v8, v28
    v_mul_f32 v9, v9, v29
    v_mul_f32 v10, v10, v30
    v_mul_f32 v11, v11, v31
    v_cvt_pk_bf16_f32 v8, v8, v9
    v_cvt_pk_bf16_f32 v10, v10, v11
    v_and_b32 v9, s92, v8
    v_lshlrev_b32 v8, 16, v8
    v_and_b32 v11, s92, v10
    v_lshlrev_b32 v10, 16, v10
    v_lshlrev_b32 v4, 16, v12
    v_and_b32 v5, s92, v12
    v_lshlrev_b32 v6, 16, v13
    v_and_b32 v7, s92, v13
    v_add_f32 v4, v4, v8
    v_add_f32 v5, v5, v9
    v_add_f32 v6, v6, v10
    v_add_f32 v7, v7, v11
    v_cvt_pk_bf16_f32 v4, v4, v5
    v_cvt_pk_bf16_f32 v5, v6, v7
    buffer_store_dwordx2 v[4:5], v2, s[32:35], 0 offen
p3_end:
    s_endpgm
.section .rodata,"a"
.p2align 6
.amdhsa_kernel p1_kernel
  .amdhsa_next_free_vgpr 128
  .amdhsa_next_free_sgpr 72
  .amdhsa_accum_offset 128
  .amdhsa_group_segment_fixed_size 0
  .amdhsa_kernarg_size 112
  .amdhsa_user_sgpr_count 2
  .amdhsa_user_sgpr_kernarg_segment_ptr 1
  .amdhsa_system_sgpr_workgroup_id_x 1
  .amdhsa_float_denorm_mode_32 3
.end_amdhsa_kernel
.p2align 6
.amdhsa_kernel p2_kernel
  .amdhsa_next_free_vgpr 128
  .amdhsa_next_free_sgpr 64
  .amdhsa_accum_offset 128
  .amdhsa_group_segment_fixed_size 0
  .amdhsa_kernarg_size 112
  .amdhsa_user_sgpr_count 2
  .amdhsa_user_sgpr_kernarg_segment_ptr 1
  .amdhsa_system_sgpr_workgroup_id_x 1
  .amdhsa_float_denorm_mode_32 3
.end_amdhsa_kernel
.p2align 6
.amdhsa_kernel p3_kernel
  .amdhsa_next_free_vgpr 32
  .amdhsa_next_free_sgpr 100
  .amdhsa_accum_offset 32
  .amdhsa_group_segment_fixed_size 0
  .amdhsa_kernarg_size 112
  .amdhsa_user_sgpr_count 2
  .amdhsa_user_sgpr_kernarg_segment_ptr 1
  .amdhsa_system_sgpr_workgroup_id_x 1
  .amdhsa_float_denorm_mode_32 3
.end_amdhsa_kernel
```

```asm
; @launch kernel=p1_kernel grid=(256,1,1) block=(1024,1,1) lds=161280
; @launch kernel=p2_kernel grid=(256,1,1) block=(1024,1,1) lds=154368
; @launch kernel=p3_kernel grid=(3125,1,1) block=(256,1,1) lds=0
.amdgcn_target "amdgcn-amd-amdhsa--gfx950"
.text
.globl p1_kernel
.p2align 8
.type p1_kernel,@function
p1_kernel:
    s_cmp_ge_u32 s2, 256
    s_cbranch_scc1 p1_end
    s_load_dwordx2 s[52:53], s[0:1], 0
    s_load_dwordx4 s[56:59], s[0:1], 8
    s_load_dwordx2 s[54:55], s[0:1], 32
    s_load_dwordx2 s[60:61], s[0:1], 48
    s_load_dwordx2 s[48:49], s[0:1], 104
    v_lshlrev_b32 v1, 4, v0
    v_lshlrev_b32 v2, 3, v0
    v_mov_b32 v3, 1
    v_lshrrev_b32 v117, 6, v0
    s_nop 0
    v_readfirstlane_b32 s28, v117
    s_waitcnt lgkmcnt(0)
    s_load_dword s41, s[60:61], 0
    s_mov_b32 s24, s52
    s_and_b32 s25, s53, 0xffff
    s_mov_b32 s26, 6400000
    s_mov_b32 s27, 0x20000
    s_mov_b32 s4, s56
    s_and_b32 s5, s57, 0xffff
    s_mov_b32 s6, 204800000
    s_mov_b32 s7, 0x20000
    s_mov_b32 s8, s58
    s_and_b32 s9, s59, 0xffff
    s_mov_b32 s10, 204800000
    s_mov_b32 s11, 0x20000
    s_mov_b32 s12, s54
    s_and_b32 s13, s55, 0xffff
    s_mov_b32 s14, 102400000
    s_mov_b32 s15, 0x20000
    s_mov_b32 s16, s48
    s_and_b32 s17, s49, 0xffff
    s_mov_b32 s18, 819200000
    s_mov_b32 s19, 0x20000
    s_mov_b32 s20, s48
    s_and_b32 s21, s49, 0xffff
    s_mov_b32 s22, 0
    s_mov_b32 s23, 0x20000
    s_mov_b32 s36, 643827
    s_mov_b32 s37, 214609
    s_mov_b32 s38, 343268
    s_mov_b32 s39, -6671
    s_mov_b32 s40, -12512
    s_mov_b32 s42, 0x03800000
    s_mov_b32 s43, 8323199
    s_mov_b32 s44, 4294901760
    s_mov_b32 s45, 57344
    s_waitcnt lgkmcnt(0)
    s_lshl_b32 s41, s41, 16
    s_and_b32 s68, s2, 7
    s_lshl_b32 s68, s68, 8
    s_and_b32 s46, s2, 0xf8
    s_or_b32 s68, s68, s46
    s_mov_b32 s46, 0
    s_cmp_lt_u32 s46, 5
    s_cselect_b32 s34, 7, 6
    s_mul_i32 s47, s46, 391
    s_sub_i32 s50, s46, 5
    s_max_i32 s50, s50, 0
    s_sub_u32 s47, s47, s50
    s_lshl_b32 s47, s47, 8
    s_add_u32 s50, s34, 384
    s_mul_i32 s50, s50, s2
    s_add_u32 s47, s47, s50
    s_lshl_b32 s30, s47, 8
    s_lshl_b32 s31, s47, 7
    s_add_u32 s32, s30, 0
    buffer_load_dwordx4 v[4:7], v1, s[4:7], s32 offen nt
    buffer_load_dwordx4 v[28:31], v1, s[8:11], s32 offen nt
    s_add_u32 s32, s31, 0
    buffer_load_dwordx2 v[52:53], v2, s[12:15], s32 offen nt
    s_add_u32 s32, s30, 16384
    buffer_load_dwordx4 v[8:11], v1, s[4:7], s32 offen nt
    buffer_load_dwordx4 v[32:35], v1, s[8:11], s32 offen nt
    s_add_u32 s32, s31, 8192
    buffer_load_dwordx2 v[54:55], v2, s[12:15], s32 offen nt
    s_add_u32 s32, s30, 32768
    buffer_load_dwordx4 v[12:15], v1, s[4:7], s32 offen nt
    buffer_load_dwordx4 v[36:39], v1, s[8:11], s32 offen nt
    s_add_u32 s32, s31, 16384
    buffer_load_dwordx2 v[56:57], v2, s[12:15], s32 offen nt
    s_add_u32 s32, s30, 49152
    buffer_load_dwordx4 v[16:19], v1, s[4:7], s32 offen nt
    buffer_load_dwordx4 v[40:43], v1, s[8:11], s32 offen nt
    s_add_u32 s32, s31, 24576
    buffer_load_dwordx2 v[58:59], v2, s[12:15], s32 offen nt
    s_add_u32 s32, s30, 65536
    buffer_load_dwordx4 v[20:23], v1, s[4:7], s32 offen nt
    buffer_load_dwordx4 v[44:47], v1, s[8:11], s32 offen nt
    s_add_u32 s32, s31, 32768
    buffer_load_dwordx2 v[60:61], v2, s[12:15], s32 offen nt
    s_add_u32 s32, s30, 81920
    buffer_load_dwordx4 v[24:27], v1, s[4:7], s32 offen nt
    buffer_load_dwordx4 v[48:51], v1, s[8:11], s32 offen nt
    s_add_u32 s32, s31, 40960
    buffer_load_dwordx2 v[62:63], v2, s[12:15], s32 offen nt
    s_cmp_lt_u32 s28, s34
    s_cselect_b32 s46, 0, 0x40000000
    v_lshl_add_u32 v117, v0, 2, s46
    s_add_u32 s32, s30, 98304
    buffer_load_dword v64, v117, s[4:7], s32 offen nt
    buffer_load_dword v65, v117, s[8:11], s32 offen nt
    v_lshrrev_b32 v117, 1, v117
    s_add_u32 s32, s31, 49152
    buffer_load_ushort v66, v117, s[12:15], s32 offen nt
    v_mov_b32 v68, 0
    v_mov_b32 v69, 0
    v_mov_b32 v70, 0
    v_mov_b32 v71, 0
    ds_write_b128 v1, v[68:71] offset:0
    v_and_b32 v118, 63, v0
    v_mov_b32 v121, 0
    v_mov_b32 v122, 0
    s_lshl_b32 s52, s2, 4
    s_add_u32 s52, s52, s28
    s_mov_b32 s57, 0x7fff7fff
    s_mul_hi_u32 s54, s52, 89478486
    s_mul_i32 s55, s54, 48
    s_sub_u32 s55, s52, s55
    s_mul_i32 s55, s55, 1024
    s_add_u32 s55, s55, 0
    s_mul_i32 s56, s54, 53368
    s_add_u32 s56, s56, s55
    v_lshl_add_u32 v119, v118, 2, s56
    s_mul_i32 s56, s54, 53760
    s_add_u32 s56, s56, s55
    s_add_u32 s56, s56, 350650368
    v_lshl_add_u32 v120, v118, 4, s56
    buffer_load_dword v72, v119, s[24:27], 0 offen offset:0
    buffer_load_dword v73, v119, s[24:27], 0 offen offset:256
    buffer_load_dword v74, v119, s[24:27], 0 offen offset:512
    buffer_load_dword v75, v119, s[24:27], 0 offen offset:768
    s_waitcnt vmcnt(0)
    buffer_store_dwordx4 v[72:75], v120, s[16:19], 0 offen
    v_and_b32 v123, s57, v72
    v_pk_max_u16 v121, v121, v123
    v_lshlrev_b32 v124, 16, v123
    v_and_b32 v123, s44, v123
    v_fmac_f32 v122, v124, v124
    v_fmac_f32 v122, v123, v123
    v_and_b32 v123, s57, v73
    v_pk_max_u16 v121, v121, v123
    v_lshlrev_b32 v124, 16, v123
    v_and_b32 v123, s44, v123
    v_fmac_f32 v122, v124, v124
    v_fmac_f32 v122, v123, v123
    v_and_b32 v123, s57, v74
    v_pk_max_u16 v121, v121, v123
    v_lshlrev_b32 v124, 16, v123
    v_and_b32 v123, s44, v123
    v_fmac_f32 v122, v124, v124
    v_fmac_f32 v122, v123, v123
    v_and_b32 v123, s57, v75
    v_pk_max_u16 v121, v121, v123
    v_lshlrev_b32 v124, 16, v123
    v_and_b32 v123, s44, v123
    v_fmac_f32 v122, v124, v124
    v_fmac_f32 v122, v123, v123
    s_cmp_ge_u32 s52, 1664
    s_cbranch_scc1 p1_m2
    s_add_u32 s53, s52, 4096
    s_mul_hi_u32 s54, s53, 89478486
    s_mul_i32 s55, s54, 48
    s_sub_u32 s55, s53, s55
    s_mul_i32 s55, s55, 1024
    s_add_u32 s55, s55, 0
    s_mul_i32 s56, s54, 53368
    s_add_u32 s56, s56, s55
    v_lshl_add_u32 v119, v118, 2, s56
    s_mul_i32 s56, s54, 53760
    s_add_u32 s56, s56, s55
    s_add_u32 s56, s56, 350650368
    v_lshl_add_u32 v120, v118, 4, s56
    buffer_load_dword v72, v119, s[24:27], 0 offen offset:0
    buffer_load_dword v73, v119, s[24:27], 0 offen offset:256
    buffer_load_dword v74, v119, s[24:27], 0 offen offset:512
    buffer_load_dword v75, v119, s[24:27], 0 offen offset:768
    s_waitcnt vmcnt(0)
    buffer_store_dwordx4 v[72:75], v120, s[16:19], 0 offen
    v_and_b32 v123, s57, v72
    v_pk_max_u16 v121, v121, v123
    v_lshlrev_b32 v124, 16, v123
    v_and_b32 v123, s44, v123
    v_fmac_f32 v122, v124, v124
    v_fmac_f32 v122, v123, v123
    v_and_b32 v123, s57, v73
    v_pk_max_u16 v121, v121, v123
    v_lshlrev_b32 v124, 16, v123
    v_and_b32 v123, s44, v123
    v_fmac_f32 v122, v124, v124
    v_fmac_f32 v122, v123, v123
    v_and_b32 v123, s57, v74
    v_pk_max_u16 v121, v121, v123
    v_lshlrev_b32 v124, 16, v123
    v_and_b32 v123, s44, v123
    v_fmac_f32 v122, v124, v124
    v_fmac_f32 v122, v123, v123
    v_and_b32 v123, s57, v75
    v_pk_max_u16 v121, v121, v123
    v_lshlrev_b32 v124, 16, v123
    v_and_b32 v123, s44, v123
    v_fmac_f32 v122, v124, v124
    v_fmac_f32 v122, v123, v123
    s_branch p1_m3
p1_m2:
    s_sub_u32 s53, s52, 1664
    s_cmp_ge_u32 s53, 1080
    s_cbranch_scc1 p1_m3
    s_mul_hi_u32 s54, s53, 477218589
    s_mul_i32 s55, s54, 9
    s_sub_u32 s55, s53, s55
    s_mul_i32 s55, s55, 512
    s_add_u32 s55, s55, 49152
    s_mul_i32 s56, s54, 53368
    s_add_u32 s56, s56, s55
    v_lshl_add_u32 v119, v118, 2, s56
    s_mul_i32 s56, s54, 53760
    s_add_u32 s56, s56, s55
    s_add_u32 s56, s56, 350650368
    v_lshl_add_u32 v120, v118, 3, s56
    buffer_load_dword v72, v119, s[24:27], 0 offen offset:0
    buffer_load_dword v73, v119, s[24:27], 0 offen offset:256
    s_waitcnt vmcnt(0)
    buffer_store_dwordx2 v[72:73], v120, s[16:19], 0 offen
    v_and_b32 v123, s57, v72
    v_pk_max_u16 v121, v121, v123
    v_lshlrev_b32 v124, 16, v123
    v_and_b32 v123, s44, v123
    v_fmac_f32 v122, v124, v124
    v_fmac_f32 v122, v123, v123
    v_and_b32 v123, s57, v73
    v_pk_max_u16 v121, v121, v123
    v_lshlrev_b32 v124, 16, v123
    v_and_b32 v123, s44, v123
    v_fmac_f32 v122, v124, v124
    v_fmac_f32 v122, v123, v123
p1_m3:
    v_lshrrev_b32 v123, 16, v121
    v_and_b32 v121, 0xffff, v121
    v_max_u32 v121, v121, v123
    s_nop 1
    v_max_u32_dpp v121, v121, v121 row_shr:1 row_mask:0xf bank_mask:0xf bound_ctrl:0
    v_add_f32_dpp v122, v122, v122 row_shr:1 row_mask:0xf bank_mask:0xf bound_ctrl:0
    s_nop 0
    v_max_u32_dpp v121, v121, v121 row_shr:2 row_mask:0xf bank_mask:0xf bound_ctrl:0
    v_add_f32_dpp v122, v122, v122 row_shr:2 row_mask:0xf bank_mask:0xf bound_ctrl:0
    s_nop 0
    v_max_u32_dpp v121, v121, v121 row_shr:4 row_mask:0xf bank_mask:0xf bound_ctrl:0
    v_add_f32_dpp v122, v122, v122 row_shr:4 row_mask:0xf bank_mask:0xf bound_ctrl:0
    s_nop 0
    v_max_u32_dpp v121, v121, v121 row_shr:8 row_mask:0xf bank_mask:0xf bound_ctrl:0
    v_add_f32_dpp v122, v122, v122 row_shr:8 row_mask:0xf bank_mask:0xf bound_ctrl:0
    s_nop 0
    v_max_u32_dpp v121, v121, v121 row_bcast:15 row_mask:0xa bank_mask:0xf
    v_add_f32_dpp v122, v122, v122 row_bcast:15 row_mask:0xa bank_mask:0xf
    s_nop 0
    v_max_u32_dpp v121, v121, v121 row_bcast:31 row_mask:0xc bank_mask:0xf
    v_add_f32_dpp v122, v122, v122 row_bcast:31 row_mask:0xc bank_mask:0xf
    s_nop 0
    s_nop 0
    v_mov_b32 v72, v121
    v_mov_b32 v73, v122
    s_lshl_b32 s52, s52, 3
    s_add_u32 s52, s52, 357101568
    v_mov_b32 v120, s52
    v_cmp_eq_u32 vcc, 63, v118
    s_and_saveexec_b64 s[54:55], vcc
    buffer_store_dwordx2 v[72:73], v120, s[16:19], 0 offen
    s_mov_b64 exec, -1
    s_mov_b32 s29, 0
    s_waitcnt vmcnt(0) lgkmcnt(0)
    s_barrier
p1_tile:
    s_mov_b32 s33, s34
    s_add_u32 s46, s29, 1
    s_cmp_lt_u32 s46, 5
    s_cselect_b32 s34, 7, 6
    s_mul_i32 s47, s46, 391
    s_sub_i32 s50, s46, 5
    s_max_i32 s50, s50, 0
    s_sub_u32 s47, s47, s50
    s_lshl_b32 s47, s47, 8
    s_add_u32 s50, s34, 384
    s_mul_i32 s50, s50, s2
    s_add_u32 s47, s47, s50
    s_lshl_b32 s30, s47, 8
    s_lshl_b32 s31, s47, 7
    s_cmp_lt_u32 s46, 8
    s_cselect_b32 s6, 204800000, 0
    s_cselect_b32 s10, 204800000, 0
    s_cselect_b32 s14, 102400000, 0
    s_cselect_b32 s30, s30, 0
    s_cselect_b32 s31, s31, 0
    v_mov_b32 v68, 0
    v_mov_b32 v69, 0
    v_mov_b32 v70, 0
    v_mov_b32 v71, 0
    ds_write_b128 v1, v[68:71] offset:10496
    ds_write_b128 v1, v[68:71] offset:26880
    s_waitcnt vmcnt(10)
    v_lshlrev_b32 v117, 16, v52
    v_and_b32 v118, s44, v52
    v_mul_f32 v117, s41, v117
    v_mul_f32 v118, s41, v118
    v_cvt_pk_bf16_f32 v117, v117, v118
    v_and_b32 v118, s44, v117
    v_lshlrev_b32 v117, 16, v117
    v_mul_f32 v117, 0.15915494, v117
    v_mul_f32 v118, 0.15915494, v118
    v_fract_f32 v117, v117
    v_fract_f32 v118, v118
    v_cos_f32 v117, v117
    v_cos_f32 v118, v118
    v_mul_hi_u32_u24 v120, s36, v4
    v_mul_hi_u32_u24 v121, s37, v4
    v_mul_hi_u32_u24 v122, s38, v28
    v_mad_i32_i24 v67, v120, s39, v4
    v_mad_u32_u24 v92, v122, 40, v121
    v_mad_i32_i24 v120, v121, -3, v120
    v_lshlrev_b32 v92, 2, v92
    v_mad_i32_i24 v122, v122, s40, v28
    ds_add_u32 v92, v3 offset:0
    v_lshl_or_b32 v67, v120, 30, v67
    v_lshl_or_b32 v67, v122, 16, v67
    v_mul_f32 v117, s42, v117
    v_mul_f32 v118, s42, v118
    v_cvt_pk_bf16_f32 v117, v117, v118
    v_mul_hi_u32_u24 v123, s36, v5
    v_mul_hi_u32_u24 v124, s37, v5
    v_mul_hi_u32_u24 v125, s38, v29
    v_mad_i32_i24 v68, v123, s39, v5
    v_mad_u32_u24 v93, v125, 40, v124
    v_mad_i32_i24 v123, v124, -3, v123
    v_lshlrev_b32 v93, 2, v93
    v_mad_i32_i24 v125, v125, s40, v29
    ds_add_u32 v93, v3 offset:0
    v_lshl_or_b32 v68, v123, 30, v68
    v_lshl_or_b32 v68, v125, 16, v68
    v_lshrrev_b32 v118, 3, v117
    v_lshrrev_b32 v119, 8, v117
    v_lshlrev_b32 v117, 13, v117
    v_bitop3_b32 v119, v118, v119, s43 bitop3:0x1b
    v_bitop3_b32 v67, v117, s45, v67 bitop3:0xae
    v_lshl_or_b32 v92, v119, 16, v92
    v_bitop3_b32 v68, v118, s45, v68 bitop3:0xae
    v_and_or_b32 v93, v119, s44, v93
    v_lshlrev_b32 v117, 16, v53
    v_and_b32 v118, s44, v53
    v_mul_f32 v117, s41, v117
    v_mul_f32 v118, s41, v118
    v_cvt_pk_bf16_f32 v117, v117, v118
    v_and_b32 v118, s44, v117
    v_lshlrev_b32 v117, 16, v117
    v_mul_f32 v117, 0.15915494, v117
    v_mul_f32 v118, 0.15915494, v118
    v_fract_f32 v117, v117
    v_fract_f32 v118, v118
    v_cos_f32 v117, v117
    v_cos_f32 v118, v118
    v_mul_hi_u32_u24 v120, s36, v6
    v_mul_hi_u32_u24 v121, s37, v6
    v_mul_hi_u32_u24 v122, s38, v30
    v_mad_i32_i24 v69, v120, s39, v6
    v_mad_u32_u24 v94, v122, 40, v121
    v_mad_i32_i24 v120, v121, -3, v120
    v_lshlrev_b32 v94, 2, v94
    v_mad_i32_i24 v122, v122, s40, v30
    ds_add_u32 v94, v3 offset:0
    v_lshl_or_b32 v69, v120, 30, v69
    v_lshl_or_b32 v69, v122, 16, v69
    v_mul_f32 v117, s42, v117
    v_mul_f32 v118, s42, v118
    v_cvt_pk_bf16_f32 v117, v117, v118
    v_mul_hi_u32_u24 v123, s36, v7
    v_mul_hi_u32_u24 v124, s37, v7
    v_mul_hi_u32_u24 v125, s38, v31
    v_mad_i32_i24 v70, v123, s39, v7
    v_mad_u32_u24 v95, v125, 40, v124
    v_mad_i32_i24 v123, v124, -3, v123
    v_lshlrev_b32 v95, 2, v95
    v_mad_i32_i24 v125, v125, s40, v31
    ds_add_u32 v95, v3 offset:0
    v_lshl_or_b32 v70, v123, 30, v70
    v_lshl_or_b32 v70, v125, 16, v70
    v_lshrrev_b32 v118, 3, v117
    v_lshrrev_b32 v119, 8, v117
    v_lshlrev_b32 v117, 13, v117
    v_bitop3_b32 v119, v118, v119, s43 bitop3:0x1b
    v_bitop3_b32 v69, v117, s45, v69 bitop3:0xae
    v_lshl_or_b32 v94, v119, 16, v94
    v_bitop3_b32 v70, v118, s45, v70 bitop3:0xae
    v_and_or_b32 v95, v119, s44, v95
    v_lshlrev_b32 v117, 16, v54
    v_and_b32 v118, s44, v54
    v_mul_f32 v117, s41, v117
    v_mul_f32 v118, s41, v118
    v_cvt_pk_bf16_f32 v117, v117, v118
    v_and_b32 v118, s44, v117
    v_lshlrev_b32 v117, 16, v117
    v_mul_f32 v117, 0.15915494, v117
    v_mul_f32 v118, 0.15915494, v118
    v_fract_f32 v117, v117
    v_fract_f32 v118, v118
    v_cos_f32 v117, v117
    v_cos_f32 v118, v118
    v_mul_hi_u32_u24 v120, s36, v8
    v_mul_hi_u32_u24 v121, s37, v8
    v_mul_hi_u32_u24 v122, s38, v32
    v_mad_i32_i24 v71, v120, s39, v8
    v_mad_u32_u24 v96, v122, 40, v121
    v_mad_i32_i24 v120, v121, -3, v120
    v_lshlrev_b32 v96, 2, v96
    v_mad_i32_i24 v122, v122, s40, v32
    ds_add_u32 v96, v3 offset:0
    v_lshl_or_b32 v71, v120, 30, v71
    v_lshl_or_b32 v71, v122, 16, v71
    v_mul_f32 v117, s42, v117
    v_mul_f32 v118, s42, v118
    v_cvt_pk_bf16_f32 v117, v117, v118
    v_mul_hi_u32_u24 v123, s36, v9
    v_mul_hi_u32_u24 v124, s37, v9
    v_mul_hi_u32_u24 v125, s38, v33
    v_mad_i32_i24 v72, v123, s39, v9
    v_mad_u32_u24 v97, v125, 40, v124
    v_mad_i32_i24 v123, v124, -3, v123
    v_lshlrev_b32 v97, 2, v97
    v_mad_i32_i24 v125, v125, s40, v33
    ds_add_u32 v97, v3 offset:0
    v_lshl_or_b32 v72, v123, 30, v72
    v_lshl_or_b32 v72, v125, 16, v72
    v_lshrrev_b32 v118, 3, v117
    v_lshrrev_b32 v119, 8, v117
    v_lshlrev_b32 v117, 13, v117
    v_bitop3_b32 v119, v118, v119, s43 bitop3:0x1b
    v_bitop3_b32 v71, v117, s45, v71 bitop3:0xae
    v_lshl_or_b32 v96, v119, 16, v96
    v_bitop3_b32 v72, v118, s45, v72 bitop3:0xae
    v_and_or_b32 v97, v119, s44, v97
    v_lshlrev_b32 v117, 16, v55
    v_and_b32 v118, s44, v55
    v_mul_f32 v117, s41, v117
    v_mul_f32 v118, s41, v118
    v_cvt_pk_bf16_f32 v117, v117, v118
    v_and_b32 v118, s44, v117
    v_lshlrev_b32 v117, 16, v117
    v_mul_f32 v117, 0.15915494, v117
    v_mul_f32 v118, 0.15915494, v118
    v_fract_f32 v117, v117
    v_fract_f32 v118, v118
    v_cos_f32 v117, v117
    v_cos_f32 v118, v118
    v_mul_hi_u32_u24 v120, s36, v10
    v_mul_hi_u32_u24 v121, s37, v10
    v_mul_hi_u32_u24 v122, s38, v34
    v_mad_i32_i24 v73, v120, s39, v10
    v_mad_u32_u24 v98, v122, 40, v121
    v_mad_i32_i24 v120, v121, -3, v120
    v_lshlrev_b32 v98, 2, v98
    v_mad_i32_i24 v122, v122, s40, v34
    ds_add_u32 v98, v3 offset:0
    v_lshl_or_b32 v73, v120, 30, v73
    v_lshl_or_b32 v73, v122, 16, v73
    v_mul_f32 v117, s42, v117
    v_mul_f32 v118, s42, v118
    v_cvt_pk_bf16_f32 v117, v117, v118
    v_mul_hi_u32_u24 v123, s36, v11
    v_mul_hi_u32_u24 v124, s37, v11
    v_mul_hi_u32_u24 v125, s38, v35
    v_mad_i32_i24 v74, v123, s39, v11
    v_mad_u32_u24 v99, v125, 40, v124
    v_mad_i32_i24 v123, v124, -3, v123
    v_lshlrev_b32 v99, 2, v99
    v_mad_i32_i24 v125, v125, s40, v35
    ds_add_u32 v99, v3 offset:0
    v_lshl_or_b32 v74, v123, 30, v74
    v_lshl_or_b32 v74, v125, 16, v74
    v_lshrrev_b32 v118, 3, v117
    v_lshrrev_b32 v119, 8, v117
    v_lshlrev_b32 v117, 13, v117
    v_bitop3_b32 v119, v118, v119, s43 bitop3:0x1b
    v_bitop3_b32 v73, v117, s45, v73 bitop3:0xae
    v_lshl_or_b32 v98, v119, 16, v98
    v_bitop3_b32 v74, v118, s45, v74 bitop3:0xae
    v_and_or_b32 v99, v119, s44, v99
    s_waitcnt lgkmcnt(4)
    v_lshlrev_b32 v117, 16, v56
    v_and_b32 v118, s44, v56
    v_mul_f32 v117, s41, v117
    v_mul_f32 v118, s41, v118
    v_cvt_pk_bf16_f32 v117, v117, v118
    v_and_b32 v118, s44, v117
    v_lshlrev_b32 v117, 16, v117
    v_mul_f32 v117, 0.15915494, v117
    v_mul_f32 v118, 0.15915494, v118
    v_fract_f32 v117, v117
    v_fract_f32 v118, v118
    v_cos_f32 v117, v117
    v_cos_f32 v118, v118
    v_mul_hi_u32_u24 v120, s36, v12
    v_mul_hi_u32_u24 v121, s37, v12
    v_mul_hi_u32_u24 v122, s38, v36
    v_mad_i32_i24 v75, v120, s39, v12
    v_mad_u32_u24 v100, v122, 40, v121
    v_mad_i32_i24 v120, v121, -3, v120
    v_lshlrev_b32 v100, 2, v100
    v_mad_i32_i24 v122, v122, s40, v36
    ds_add_u32 v100, v3 offset:0
    v_lshl_or_b32 v75, v120, 30, v75
    v_lshl_or_b32 v75, v122, 16, v75
    v_mul_f32 v117, s42, v117
    v_mul_f32 v118, s42, v118
    v_cvt_pk_bf16_f32 v117, v117, v118
    v_mul_hi_u32_u24 v123, s36, v13
    v_mul_hi_u32_u24 v124, s37, v13
    v_mul_hi_u32_u24 v125, s38, v37
    v_mad_i32_i24 v76, v123, s39, v13
    v_mad_u32_u24 v101, v125, 40, v124
    v_mad_i32_i24 v123, v124, -3, v123
    v_lshlrev_b32 v101, 2, v101
    v_mad_i32_i24 v125, v125, s40, v37
    ds_add_u32 v101, v3 offset:0
    v_lshl_or_b32 v76, v123, 30, v76
    v_lshl_or_b32 v76, v125, 16, v76
    v_lshrrev_b32 v118, 3, v117
    v_lshrrev_b32 v119, 8, v117
    v_lshlrev_b32 v117, 13, v117
    v_bitop3_b32 v119, v118, v119, s43 bitop3:0x1b
    v_bitop3_b32 v75, v117, s45, v75 bitop3:0xae
    v_lshl_or_b32 v100, v119, 16, v100
    v_bitop3_b32 v76, v118, s45, v76 bitop3:0xae
    v_and_or_b32 v101, v119, s44, v101
    v_lshlrev_b32 v117, 16, v57
    v_and_b32 v118, s44, v57
    v_mul_f32 v117, s41, v117
    v_mul_f32 v118, s41, v118
    v_cvt_pk_bf16_f32 v117, v117, v118
    v_and_b32 v118, s44, v117
    v_lshlrev_b32 v117, 16, v117
    v_mul_f32 v117, 0.15915494, v117
    v_mul_f32 v118, 0.15915494, v118
    v_fract_f32 v117, v117
    v_fract_f32 v118, v118
    v_cos_f32 v117, v117
    v_cos_f32 v118, v118
    v_mul_hi_u32_u24 v120, s36, v14
    v_mul_hi_u32_u24 v121, s37, v14
    v_mul_hi_u32_u24 v122, s38, v38
    v_mad_i32_i24 v77, v120, s39, v14
    v_mad_u32_u24 v102, v122, 40, v121
    v_mad_i32_i24 v120, v121, -3, v120
    v_lshlrev_b32 v102, 2, v102
    v_mad_i32_i24 v122, v122, s40, v38
    ds_add_u32 v102, v3 offset:0
    v_lshl_or_b32 v77, v120, 30, v77
    v_lshl_or_b32 v77, v122, 16, v77
    v_mul_f32 v117, s42, v117
    v_mul_f32 v118, s42, v118
    v_cvt_pk_bf16_f32 v117, v117, v118
    v_mul_hi_u32_u24 v123, s36, v15
    v_mul_hi_u32_u24 v124, s37, v15
    v_mul_hi_u32_u24 v125, s38, v39
    v_mad_i32_i24 v78, v123, s39, v15
    v_mad_u32_u24 v103, v125, 40, v124
    v_mad_i32_i24 v123, v124, -3, v123
    v_lshlrev_b32 v103, 2, v103
    v_mad_i32_i24 v125, v125, s40, v39
    ds_add_u32 v103, v3 offset:0
    v_lshl_or_b32 v78, v123, 30, v78
    v_lshl_or_b32 v78, v125, 16, v78
    v_lshrrev_b32 v118, 3, v117
    v_lshrrev_b32 v119, 8, v117
    v_lshlrev_b32 v117, 13, v117
    v_bitop3_b32 v119, v118, v119, s43 bitop3:0x1b
    v_bitop3_b32 v77, v117, s45, v77 bitop3:0xae
    v_lshl_or_b32 v102, v119, 16, v102
    v_bitop3_b32 v78, v118, s45, v78 bitop3:0xae
    v_and_or_b32 v103, v119, s44, v103
    s_add_u32 s32, s30, 0
    buffer_load_dwordx4 v[4:7], v1, s[4:7], s32 offen nt
    buffer_load_dwordx4 v[28:31], v1, s[8:11], s32 offen nt
    s_add_u32 s32, s31, 0
    buffer_load_dwordx2 v[52:53], v2, s[12:15], s32 offen nt
    v_lshlrev_b32 v117, 16, v58
    v_and_b32 v118, s44, v58
    v_mul_f32 v117, s41, v117
    v_mul_f32 v118, s41, v118
    v_cvt_pk_bf16_f32 v117, v117, v118
    v_and_b32 v118, s44, v117
    v_lshlrev_b32 v117, 16, v117
    v_mul_f32 v117, 0.15915494, v117
    v_mul_f32 v118, 0.15915494, v118
    v_fract_f32 v117, v117
    v_fract_f32 v118, v118
    v_cos_f32 v117, v117
    v_cos_f32 v118, v118
    v_mul_hi_u32_u24 v120, s36, v16
    v_mul_hi_u32_u24 v121, s37, v16
    v_mul_hi_u32_u24 v122, s38, v40
    v_mad_i32_i24 v79, v120, s39, v16
    v_mad_u32_u24 v104, v122, 40, v121
    v_mad_i32_i24 v120, v121, -3, v120
    v_lshlrev_b32 v104, 2, v104
    v_mad_i32_i24 v122, v122, s40, v40
    ds_add_u32 v104, v3 offset:0
    v_lshl_or_b32 v79, v120, 30, v79
    v_lshl_or_b32 v79, v122, 16, v79
    v_mul_f32 v117, s42, v117
    v_mul_f32 v118, s42, v118
    v_cvt_pk_bf16_f32 v117, v117, v118
    v_mul_hi_u32_u24 v123, s36, v17
    v_mul_hi_u32_u24 v124, s37, v17
    v_mul_hi_u32_u24 v125, s38, v41
    v_mad_i32_i24 v80, v123, s39, v17
    v_mad_u32_u24 v105, v125, 40, v124
    v_mad_i32_i24 v123, v124, -3, v123
    v_lshlrev_b32 v105, 2, v105
    v_mad_i32_i24 v125, v125, s40, v41
    ds_add_u32 v105, v3 offset:0
    v_lshl_or_b32 v80, v123, 30, v80
    v_lshl_or_b32 v80, v125, 16, v80
    v_lshrrev_b32 v118, 3, v117
    v_lshrrev_b32 v119, 8, v117
    v_lshlrev_b32 v117, 13, v117
    v_bitop3_b32 v119, v118, v119, s43 bitop3:0x1b
    v_bitop3_b32 v79, v117, s45, v79 bitop3:0xae
    v_lshl_or_b32 v104, v119, 16, v104
    v_bitop3_b32 v80, v118, s45, v80 bitop3:0xae
    v_and_or_b32 v105, v119, s44, v105
    v_lshlrev_b32 v117, 16, v59
    v_and_b32 v118, s44, v59
    v_mul_f32 v117, s41, v117
    v_mul_f32 v118, s41, v118
    v_cvt_pk_bf16_f32 v117, v117, v118
    v_and_b32 v118, s44, v117
    v_lshlrev_b32 v117, 16, v117
    v_mul_f32 v117, 0.15915494, v117
    v_mul_f32 v118, 0.15915494, v118
    v_fract_f32 v117, v117
    v_fract_f32 v118, v118
    v_cos_f32 v117, v117
    v_cos_f32 v118, v118
    v_mul_hi_u32_u24 v120, s36, v18
    v_mul_hi_u32_u24 v121, s37, v18
    v_mul_hi_u32_u24 v122, s38, v42
    v_mad_i32_i24 v81, v120, s39, v18
    v_mad_u32_u24 v106, v122, 40, v121
    v_mad_i32_i24 v120, v121, -3, v120
    v_lshlrev_b32 v106, 2, v106
    v_mad_i32_i24 v122, v122, s40, v42
    ds_add_u32 v106, v3 offset:0
    v_lshl_or_b32 v81, v120, 30, v81
    v_lshl_or_b32 v81, v122, 16, v81
    v_mul_f32 v117, s42, v117
    v_mul_f32 v118, s42, v118
    v_cvt_pk_bf16_f32 v117, v117, v118
    v_mul_hi_u32_u24 v123, s36, v19
    v_mul_hi_u32_u24 v124, s37, v19
    v_mul_hi_u32_u24 v125, s38, v43
    v_mad_i32_i24 v82, v123, s39, v19
    v_mad_u32_u24 v107, v125, 40, v124
    v_mad_i32_i24 v123, v124, -3, v123
    v_lshlrev_b32 v107, 2, v107
    v_mad_i32_i24 v125, v125, s40, v43
    ds_add_u32 v107, v3 offset:0
    v_lshl_or_b32 v82, v123, 30, v82
    v_lshl_or_b32 v82, v125, 16, v82
    v_lshrrev_b32 v118, 3, v117
    v_lshrrev_b32 v119, 8, v117
    v_lshlrev_b32 v117, 13, v117
    v_bitop3_b32 v119, v118, v119, s43 bitop3:0x1b
    v_bitop3_b32 v81, v117, s45, v81 bitop3:0xae
    v_lshl_or_b32 v106, v119, 16, v106
    v_bitop3_b32 v82, v118, s45, v82 bitop3:0xae
    v_and_or_b32 v107, v119, s44, v107
    s_waitcnt lgkmcnt(4)
    v_lshlrev_b32 v117, 16, v60
    v_and_b32 v118, s44, v60
    v_mul_f32 v117, s41, v117
    v_mul_f32 v118, s41, v118
    v_cvt_pk_bf16_f32 v117, v117, v118
    v_and_b32 v118, s44, v117
    v_lshlrev_b32 v117, 16, v117
    v_mul_f32 v117, 0.15915494, v117
    v_mul_f32 v118, 0.15915494, v118
    v_fract_f32 v117, v117
    v_fract_f32 v118, v118
    v_cos_f32 v117, v117
    v_cos_f32 v118, v118
    v_mul_hi_u32_u24 v120, s36, v20
    v_mul_hi_u32_u24 v121, s37, v20
    v_mul_hi_u32_u24 v122, s38, v44
    v_mad_i32_i24 v83, v120, s39, v20
    v_mad_u32_u24 v108, v122, 40, v121
    v_mad_i32_i24 v120, v121, -3, v120
    v_lshlrev_b32 v108, 2, v108
    v_mad_i32_i24 v122, v122, s40, v44
    ds_add_u32 v108, v3 offset:0
    v_lshl_or_b32 v83, v120, 30, v83
    v_lshl_or_b32 v83, v122, 16, v83
    v_mul_f32 v117, s42, v117
    v_mul_f32 v118, s42, v118
    v_cvt_pk_bf16_f32 v117, v117, v118
    v_mul_hi_u32_u24 v123, s36, v21
    v_mul_hi_u32_u24 v124, s37, v21
    v_mul_hi_u32_u24 v125, s38, v45
    v_mad_i32_i24 v84, v123, s39, v21
    v_mad_u32_u24 v109, v125, 40, v124
    v_mad_i32_i24 v123, v124, -3, v123
    v_lshlrev_b32 v109, 2, v109
    v_mad_i32_i24 v125, v125, s40, v45
    ds_add_u32 v109, v3 offset:0
    v_lshl_or_b32 v84, v123, 30, v84
    v_lshl_or_b32 v84, v125, 16, v84
    v_lshrrev_b32 v118, 3, v117
    v_lshrrev_b32 v119, 8, v117
    v_lshlrev_b32 v117, 13, v117
    v_bitop3_b32 v119, v118, v119, s43 bitop3:0x1b
    v_bitop3_b32 v83, v117, s45, v83 bitop3:0xae
    v_lshl_or_b32 v108, v119, 16, v108
    v_bitop3_b32 v84, v118, s45, v84 bitop3:0xae
    v_and_or_b32 v109, v119, s44, v109
    v_lshlrev_b32 v117, 16, v61
    v_and_b32 v118, s44, v61
    v_mul_f32 v117, s41, v117
    v_mul_f32 v118, s41, v118
    v_cvt_pk_bf16_f32 v117, v117, v118
    v_and_b32 v118, s44, v117
    v_lshlrev_b32 v117, 16, v117
    v_mul_f32 v117, 0.15915494, v117
    v_mul_f32 v118, 0.15915494, v118
    v_fract_f32 v117, v117
    v_fract_f32 v118, v118
    v_cos_f32 v117, v117
    v_cos_f32 v118, v118
    v_mul_hi_u32_u24 v120, s36, v22
    v_mul_hi_u32_u24 v121, s37, v22
    v_mul_hi_u32_u24 v122, s38, v46
    v_mad_i32_i24 v85, v120, s39, v22
    v_mad_u32_u24 v110, v122, 40, v121
    v_mad_i32_i24 v120, v121, -3, v120
    v_lshlrev_b32 v110, 2, v110
    v_mad_i32_i24 v122, v122, s40, v46
    ds_add_u32 v110, v3 offset:0
    v_lshl_or_b32 v85, v120, 30, v85
    v_lshl_or_b32 v85, v122, 16, v85
    v_mul_f32 v117, s42, v117
    v_mul_f32 v118, s42, v118
    v_cvt_pk_bf16_f32 v117, v117, v118
    v_mul_hi_u32_u24 v123, s36, v23
    v_mul_hi_u32_u24 v124, s37, v23
    v_mul_hi_u32_u24 v125, s38, v47
    v_mad_i32_i24 v86, v123, s39, v23
    v_mad_u32_u24 v111, v125, 40, v124
    v_mad_i32_i24 v123, v124, -3, v123
    v_lshlrev_b32 v111, 2, v111
    v_mad_i32_i24 v125, v125, s40, v47
    ds_add_u32 v111, v3 offset:0
    v_lshl_or_b32 v86, v123, 30, v86
    v_lshl_or_b32 v86, v125, 16, v86
    v_lshrrev_b32 v118, 3, v117
    v_lshrrev_b32 v119, 8, v117
    v_lshlrev_b32 v117, 13, v117
    v_bitop3_b32 v119, v118, v119, s43 bitop3:0x1b
    v_bitop3_b32 v85, v117, s45, v85 bitop3:0xae
    v_lshl_or_b32 v110, v119, 16, v110
    v_bitop3_b32 v86, v118, s45, v86 bitop3:0xae
    v_and_or_b32 v111, v119, s44, v111
    v_lshlrev_b32 v117, 16, v62
    v_and_b32 v118, s44, v62
    v_mul_f32 v117, s41, v117
    v_mul_f32 v118, s41, v118
    v_cvt_pk_bf16_f32 v117, v117, v118
    v_and_b32 v118, s44, v117
    v_lshlrev_b32 v117, 16, v117
    v_mul_f32 v117, 0.15915494, v117
    v_mul_f32 v118, 0.15915494, v118
    v_fract_f32 v117, v117
    v_fract_f32 v118, v118
    v_cos_f32 v117, v117
    v_cos_f32 v118, v118
    v_mul_hi_u32_u24 v120, s36, v24
    v_mul_hi_u32_u24 v121, s37, v24
    v_mul_hi_u32_u24 v122, s38, v48
    v_mad_i32_i24 v87, v120, s39, v24
    v_mad_u32_u24 v112, v122, 40, v121
    v_mad_i32_i24 v120, v121, -3, v120
    v_lshlrev_b32 v112, 2, v112
    v_mad_i32_i24 v122, v122, s40, v48
    ds_add_u32 v112, v3 offset:0
    v_lshl_or_b32 v87, v120, 30, v87
    v_lshl_or_b32 v87, v122, 16, v87
    v_mul_f32 v117, s42, v117
    v_mul_f32 v118, s42, v118
    v_cvt_pk_bf16_f32 v117, v117, v118
    v_mul_hi_u32_u24 v123, s36, v25
    v_mul_hi_u32_u24 v124, s37, v25
    v_mul_hi_u32_u24 v125, s38, v49
    v_mad_i32_i24 v88, v123, s39, v25
    v_mad_u32_u24 v113, v125, 40, v124
    v_mad_i32_i24 v123, v124, -3, v123
    v_lshlrev_b32 v113, 2, v113
    v_mad_i32_i24 v125, v125, s40, v49
    ds_add_u32 v113, v3 offset:0
    v_lshl_or_b32 v88, v123, 30, v88
    v_lshl_or_b32 v88, v125, 16, v88
    v_lshrrev_b32 v118, 3, v117
    v_lshrrev_b32 v119, 8, v117
    v_lshlrev_b32 v117, 13, v117
    v_bitop3_b32 v119, v118, v119, s43 bitop3:0x1b
    v_bitop3_b32 v87, v117, s45, v87 bitop3:0xae
    v_lshl_or_b32 v112, v119, 16, v112
    v_bitop3_b32 v88, v118, s45, v88 bitop3:0xae
    v_and_or_b32 v113, v119, s44, v113
    v_lshlrev_b32 v117, 16, v63
    v_and_b32 v118, s44, v63
    v_mul_f32 v117, s41, v117
    v_mul_f32 v118, s41, v118
    v_cvt_pk_bf16_f32 v117, v117, v118
    v_and_b32 v118, s44, v117
    v_lshlrev_b32 v117, 16, v117
    v_mul_f32 v117, 0.15915494, v117
    v_mul_f32 v118, 0.15915494, v118
    v_fract_f32 v117, v117
    v_fract_f32 v118, v118
    v_cos_f32 v117, v117
    v_cos_f32 v118, v118
    v_mul_hi_u32_u24 v120, s36, v26
    v_mul_hi_u32_u24 v121, s37, v26
    v_mul_hi_u32_u24 v122, s38, v50
    v_mad_i32_i24 v89, v120, s39, v26
    v_mad_u32_u24 v114, v122, 40, v121
    v_mad_i32_i24 v120, v121, -3, v120
    v_lshlrev_b32 v114, 2, v114
    v_mad_i32_i24 v122, v122, s40, v50
    ds_add_u32 v114, v3 offset:0
    v_lshl_or_b32 v89, v120, 30, v89
    v_lshl_or_b32 v89, v122, 16, v89
    v_mul_f32 v117, s42, v117
    v_mul_f32 v118, s42, v118
    v_cvt_pk_bf16_f32 v117, v117, v118
    v_mul_hi_u32_u24 v123, s36, v27
    v_mul_hi_u32_u24 v124, s37, v27
    v_mul_hi_u32_u24 v125, s38, v51
    v_mad_i32_i24 v90, v123, s39, v27
    v_mad_u32_u24 v115, v125, 40, v124
    v_mad_i32_i24 v123, v124, -3, v123
    v_lshlrev_b32 v115, 2, v115
    v_mad_i32_i24 v125, v125, s40, v51
    ds_add_u32 v115, v3 offset:0
    v_lshl_or_b32 v90, v123, 30, v90
    v_lshl_or_b32 v90, v125, 16, v90
    v_lshrrev_b32 v118, 3, v117
    v_lshrrev_b32 v119, 8, v117
    v_lshlrev_b32 v117, 13, v117
    v_bitop3_b32 v119, v118, v119, s43 bitop3:0x1b
    v_bitop3_b32 v89, v117, s45, v89 bitop3:0xae
    v_lshl_or_b32 v114, v119, 16, v114
    v_bitop3_b32 v90, v118, s45, v90 bitop3:0xae
    v_and_or_b32 v115, v119, s44, v115
    s_waitcnt lgkmcnt(4)
    s_add_u32 s32, s30, 16384
    buffer_load_dwordx4 v[8:11], v1, s[4:7], s32 offen nt
    buffer_load_dwordx4 v[32:35], v1, s[8:11], s32 offen nt
    s_add_u32 s32, s31, 8192
    buffer_load_dwordx2 v[54:55], v2, s[12:15], s32 offen nt
    s_cmp_ge_u32 s28, s33
    s_cbranch_scc1 p1_r_done
    v_lshlrev_b32 v117, 16, v66
    v_and_b32 v118, s44, v66
    v_mul_f32 v117, s41, v117
    v_mul_f32 v118, s41, v118
    v_cvt_pk_bf16_f32 v117, v117, v118
    v_and_b32 v118, s44, v117
    v_lshlrev_b32 v117, 16, v117
    v_mul_f32 v117, 0.15915494, v117
    v_mul_f32 v118, 0.15915494, v118
    v_fract_f32 v117, v117
    v_fract_f32 v118, v118
    v_cos_f32 v117, v117
    v_cos_f32 v118, v118
    v_mul_hi_u32_u24 v120, s36, v64
    v_mul_hi_u32_u24 v121, s37, v64
    v_mul_hi_u32_u24 v122, s38, v65
    v_mad_i32_i24 v91, v120, s39, v64
    v_mad_u32_u24 v116, v122, 40, v121
    v_mad_i32_i24 v120, v121, -3, v120
    v_lshlrev_b32 v116, 2, v116
    v_mad_i32_i24 v122, v122, s40, v65
    ds_add_u32 v116, v3 offset:0
    v_lshl_or_b32 v91, v120, 30, v91
    v_lshl_or_b32 v91, v122, 16, v91
    v_mul_f32 v117, s42, v117
    v_mul_f32 v118, s42, v118
    v_cvt_pk_bf16_f32 v117, v117, v118
    v_lshrrev_b32 v118, 3, v117
    v_lshrrev_b32 v119, 8, v117
    v_lshlrev_b32 v117, 13, v117
    v_bitop3_b32 v119, v118, v119, s43 bitop3:0x1b
    v_bitop3_b32 v91, v117, s45, v91 bitop3:0xae
    v_lshl_or_b32 v116, v119, 16, v116
p1_r_done:
    s_waitcnt lgkmcnt(0)
    s_barrier
    s_cmp_ge_u32 s28, 10
    s_cbranch_scc1 p1_s1_skip
    v_and_b32 v126, 63, v0
    s_lshl_b32 s54, s28, 4
    v_mul_u32_u24 v117, 160, v126
    v_add_u32 v117, s54, v117
    ds_read_b128 v[118:121], v117 offset:0
    s_mov_b32 s55, 43691
    s_waitcnt lgkmcnt(0)
    v_add_u32 v118, 2, v118
    v_add_u32 v119, 2, v119
    v_add_u32 v120, 2, v120
    v_add_u32 v121, 2, v121
    v_mul_u32_u24 v118, s55, v118
    v_mul_u32_u24 v119, s55, v119
    v_mul_u32_u24 v120, s55, v120
    v_mul_u32_u24 v121, s55, v121
    v_lshrrev_b32 v118, 17, v118
    v_lshrrev_b32 v119, 17, v119
    v_lshrrev_b32 v120, 17, v120
    v_lshrrev_b32 v121, 17, v121
    v_lshl_or_b32 v122, v119, 16, v118
    v_lshl_or_b32 v123, v121, 16, v120
    v_mov_b32 v124, v122
    v_mov_b32 v125, v123
    s_nop 1
    v_add_u32_dpp v124, v124, v124 row_shr:1 row_mask:0xf bank_mask:0xf bound_ctrl:0
    v_add_u32_dpp v125, v125, v125 row_shr:1 row_mask:0xf bank_mask:0xf bound_ctrl:0
    s_nop 0
    v_add_u32_dpp v124, v124, v124 row_shr:2 row_mask:0xf bank_mask:0xf bound_ctrl:0
    v_add_u32_dpp v125, v125, v125 row_shr:2 row_mask:0xf bank_mask:0xf bound_ctrl:0
    s_nop 0
    v_add_u32_dpp v124, v124, v124 row_shr:4 row_mask:0xf bank_mask:0xf bound_ctrl:0
    v_add_u32_dpp v125, v125, v125 row_shr:4 row_mask:0xf bank_mask:0xf bound_ctrl:0
    s_nop 0
    v_add_u32_dpp v124, v124, v124 row_shr:8 row_mask:0xf bank_mask:0xf bound_ctrl:0
    v_add_u32_dpp v125, v125, v125 row_shr:8 row_mask:0xf bank_mask:0xf bound_ctrl:0
    s_nop 0
    v_add_u32_dpp v124, v124, v124 row_bcast:15 row_mask:0xa bank_mask:0xf
    v_add_u32_dpp v125, v125, v125 row_bcast:15 row_mask:0xa bank_mask:0xf
    s_nop 0
    v_add_u32_dpp v124, v124, v124 row_bcast:31 row_mask:0xc bank_mask:0xf
    v_add_u32_dpp v125, v125, v125 row_bcast:31 row_mask:0xc bank_mask:0xf
    s_nop 0
    s_nop 0
    v_mov_b32 v127, s54
    v_and_b32 v118, 0xffff, v124
    v_lshrrev_b32 v119, 16, v124
    v_and_b32 v120, 0xffff, v125
    v_lshrrev_b32 v121, 16, v125
    s_mov_b64 exec, 1
    s_lshl_b64 exec, exec, 63
    ds_write_b128 v127, v[118:121] offset:10240
    s_mov_b64 exec, -1
p1_s1_skip:
    s_waitcnt lgkmcnt(0)
    s_barrier
    v_and_b32 v127, 63, v0
    v_lshlrev_b32 v118, 2, v127
    v_cmp_gt_u32 vcc, 40, v127
    ds_read_b32 v119, v118 offset:10240
    s_waitcnt lgkmcnt(0)
    v_cndmask_b32 v119, 0, v119, vcc
    v_mov_b32 v120, v119
    s_nop 1
    v_add_u32_dpp v120, v120, v120 row_shr:1 row_mask:0xf bank_mask:0xf bound_ctrl:0
    s_nop 1
    v_add_u32_dpp v120, v120, v120 row_shr:2 row_mask:0xf bank_mask:0xf bound_ctrl:0
    s_nop 1
    v_add_u32_dpp v120, v120, v120 row_shr:4 row_mask:0xf bank_mask:0xf bound_ctrl:0
    s_nop 1
    v_add_u32_dpp v120, v120, v120 row_shr:8 row_mask:0xf bank_mask:0xf bound_ctrl:0
    s_nop 1
    v_add_u32_dpp v120, v120, v120 row_bcast:15 row_mask:0xa bank_mask:0xf
    s_nop 1
    v_add_u32_dpp v120, v120, v120 row_bcast:31 row_mask:0xc bank_mask:0xf
    s_nop 1
    s_nop 0
    v_sub_u32 v119, v120, v119
    v_readlane_b32 s35, v120, 63
    s_add_u32 s51, s68, s29
    s_cmp_ge_u32 s28, 10
    s_cbranch_scc1 p1_s2_skip
    s_lshl_b32 s54, s28, 2
    s_add_u32 s55, s54, 0
    v_readlane_b32 s56, v119, s55
    s_add_u32 s55, s54, 1
    v_readlane_b32 s57, v119, s55
    s_add_u32 s55, s54, 2
    v_readlane_b32 s58, v119, s55
    s_add_u32 s55, s54, 3
    v_readlane_b32 s59, v119, s55
    s_nop 0
    s_lshl_b32 s57, s57, 16
    s_or_b32 s56, s56, s57
    s_lshl_b32 s59, s59, 16
    s_or_b32 s58, s58, s59
    v_add_u32 v124, s56, v124
    v_add_u32 v125, s58, v125
    v_sub_u32 v122, v124, v122
    v_sub_u32 v123, v125, v123
    s_mul_i32 s55, s51, 5248
    s_mul_i32 s56, s28, 520
    s_add_u32 s55, s55, s56
    s_add_u32 s55, s55, 329252864
    v_lshl_add_u32 v127, v126, 3, s55
    buffer_store_dwordx2 v[122:123], v127, s[16:19], 0 offen
    v_and_b32 v118, 0xffff, v122
    v_lshrrev_b32 v119, 16, v122
    v_and_b32 v120, 0xffff, v123
    v_lshrrev_b32 v121, 16, v123
    v_mul_u32_u24 v118, 3, v118
    v_mul_u32_u24 v119, 3, v119
    v_mul_u32_u24 v120, 3, v120
    v_mul_u32_u24 v121, 3, v121
    ds_write_b128 v117, v[118:121] offset:0
    s_mov_b64 exec, 1
    s_lshl_b64 exec, exec, 63
    buffer_store_dwordx2 v[124:125], v127, s[16:19], 0 offen offset:8
    s_mov_b64 exec, -1
p1_s2_skip:
    s_mul_i32 s52, s51, 160768
    s_add_u32 s20, s48, s52
    s_addc_u32 s21, s49, 0
    s_and_b32 s21, s21, 0xffff
    s_lshl_b32 s22, s35, 4
    s_waitcnt lgkmcnt(0)
    s_barrier
    v_and_b32 v117, 0xffff, v92
    ds_add_rtn_u32 v117, v117, v3 offset:0
    v_and_b32 v118, 0xffff, v93
    ds_add_rtn_u32 v118, v118, v3 offset:0
    v_and_b32 v119, 0xffff, v94
    ds_add_rtn_u32 v119, v119, v3 offset:0
    v_and_b32 v120, 0xffff, v95
    ds_add_rtn_u32 v120, v120, v3 offset:0
    s_add_u32 s32, s30, 32768
    buffer_load_dwordx4 v[12:15], v1, s[4:7], s32 offen nt
    buffer_load_dwordx4 v[36:39], v1, s[8:11], s32 offen nt
    s_add_u32 s32, s31, 16384
    buffer_load_dwordx2 v[56:57], v2, s[12:15], s32 offen nt
    v_and_b32 v121, 0xffff, v96
    ds_add_rtn_u32 v121, v121, v3 offset:0
    v_and_b32 v122, 0xffff, v97
    ds_add_rtn_u32 v122, v122, v3 offset:0
    v_and_b32 v123, 0xffff, v98
    ds_add_rtn_u32 v123, v123, v3 offset:0
    v_and_b32 v124, 0xffff, v99
    ds_add_rtn_u32 v124, v124, v3 offset:0
    s_waitcnt lgkmcnt(4)
    ds_write_b8_d16_hi v117, v92 offset:10496
    v_lshlrev_b32 v117, 2, v117
    ds_write_b32 v117, v67 offset:40704
    ds_write_b8_d16_hi v118, v93 offset:10496
    v_lshlrev_b32 v118, 2, v118
    ds_write_b32 v118, v68 offset:40704
    ds_write_b8_d16_hi v119, v94 offset:10496
    v_lshlrev_b32 v119, 2, v119
    ds_write_b32 v119, v69 offset:40704
    ds_write_b8_d16_hi v120, v95 offset:10496
    v_lshlrev_b32 v120, 2, v120
    ds_write_b32 v120, v70 offset:40704
    s_add_u32 s32, s30, 49152
    buffer_load_dwordx4 v[16:19], v1, s[4:7], s32 offen nt
    buffer_load_dwordx4 v[40:43], v1, s[8:11], s32 offen nt
    s_add_u32 s32, s31, 24576
    buffer_load_dwordx2 v[58:59], v2, s[12:15], s32 offen nt
    v_and_b32 v117, 0xffff, v100
    ds_add_rtn_u32 v117, v117, v3 offset:0
    v_and_b32 v118, 0xffff, v101
    ds_add_rtn_u32 v118, v118, v3 offset:0
    v_and_b32 v119, 0xffff, v102
    ds_add_rtn_u32 v119, v119, v3 offset:0
    v_and_b32 v120, 0xffff, v103
    ds_add_rtn_u32 v120, v120, v3 offset:0
    s_waitcnt lgkmcnt(4)
    ds_write_b8_d16_hi v121, v96 offset:10496
    v_lshlrev_b32 v121, 2, v121
    ds_write_b32 v121, v71 offset:40704
    ds_write_b8_d16_hi v122, v97 offset:10496
    v_lshlrev_b32 v122, 2, v122
    ds_write_b32 v122, v72 offset:40704
    ds_write_b8_d16_hi v123, v98 offset:10496
    v_lshlrev_b32 v123, 2, v123
    ds_write_b32 v123, v73 offset:40704
    ds_write_b8_d16_hi v124, v99 offset:10496
    v_lshlrev_b32 v124, 2, v124
    ds_write_b32 v124, v74 offset:40704
    s_add_u32 s32, s30, 65536
    buffer_load_dwordx4 v[20:23], v1, s[4:7], s32 offen nt
    buffer_load_dwordx4 v[44:47], v1, s[8:11], s32 offen nt
    s_add_u32 s32, s31, 32768
    buffer_load_dwordx2 v[60:61], v2, s[12:15], s32 offen nt
    v_and_b32 v121, 0xffff, v104
    ds_add_rtn_u32 v121, v121, v3 offset:0
    v_and_b32 v122, 0xffff, v105
    ds_add_rtn_u32 v122, v122, v3 offset:0
    v_and_b32 v123, 0xffff, v106
    ds_add_rtn_u32 v123, v123, v3 offset:0
    v_and_b32 v124, 0xffff, v107
    ds_add_rtn_u32 v124, v124, v3 offset:0
    s_waitcnt lgkmcnt(4)
    ds_write_b8_d16_hi v117, v100 offset:10496
    v_lshlrev_b32 v117, 2, v117
    ds_write_b32 v117, v75 offset:40704
    ds_write_b8_d16_hi v118, v101 offset:10496
    v_lshlrev_b32 v118, 2, v118
    ds_write_b32 v118, v76 offset:40704
    ds_write_b8_d16_hi v119, v102 offset:10496
    v_lshlrev_b32 v119, 2, v119
    ds_write_b32 v119, v77 offset:40704
    ds_write_b8_d16_hi v120, v103 offset:10496
    v_lshlrev_b32 v120, 2, v120
    ds_write_b32 v120, v78 offset:40704
    s_add_u32 s32, s30, 81920
    buffer_load_dwordx4 v[24:27], v1, s[4:7], s32 offen nt
    buffer_load_dwordx4 v[48:51], v1, s[8:11], s32 offen nt
    s_add_u32 s32, s31, 40960
    buffer_load_dwordx2 v[62:63], v2, s[12:15], s32 offen nt
    v_and_b32 v117, 0xffff, v108
    ds_add_rtn_u32 v117, v117, v3 offset:0
    v_and_b32 v118, 0xffff, v109
    ds_add_rtn_u32 v118, v118, v3 offset:0
    v_and_b32 v119, 0xffff, v110
    ds_add_rtn_u32 v119, v119, v3 offset:0
    v_and_b32 v120, 0xffff, v111
    ds_add_rtn_u32 v120, v120, v3 offset:0
    s_waitcnt lgkmcnt(4)
    ds_write_b8_d16_hi v121, v104 offset:10496
    v_lshlrev_b32 v121, 2, v121
    ds_write_b32 v121, v79 offset:40704
    ds_write_b8_d16_hi v122, v105 offset:10496
    v_lshlrev_b32 v122, 2, v122
    ds_write_b32 v122, v80 offset:40704
    ds_write_b8_d16_hi v123, v106 offset:10496
    v_lshlrev_b32 v123, 2, v123
    ds_write_b32 v123, v81 offset:40704
    ds_write_b8_d16_hi v124, v107 offset:10496
    v_lshlrev_b32 v124, 2, v124
    ds_write_b32 v124, v82 offset:40704
    s_cmp_lt_u32 s28, s34
    s_cselect_b32 s46, 0, 0x40000000
    v_lshl_add_u32 v126, v0, 2, s46
    s_add_u32 s32, s30, 98304
    buffer_load_dword v64, v126, s[4:7], s32 offen nt
    buffer_load_dword v65, v126, s[8:11], s32 offen nt
    v_lshrrev_b32 v126, 1, v126
    s_add_u32 s32, s31, 49152
    buffer_load_ushort v66, v126, s[12:15], s32 offen nt
    v_and_b32 v121, 0xffff, v112
    ds_add_rtn_u32 v121, v121, v3 offset:0
    v_and_b32 v122, 0xffff, v113
    ds_add_rtn_u32 v122, v122, v3 offset:0
    v_and_b32 v123, 0xffff, v114
    ds_add_rtn_u32 v123, v123, v3 offset:0
    v_and_b32 v124, 0xffff, v115
    ds_add_rtn_u32 v124, v124, v3 offset:0
    s_waitcnt lgkmcnt(4)
    ds_write_b8_d16_hi v117, v108 offset:10496
    v_lshlrev_b32 v117, 2, v117
    ds_write_b32 v117, v83 offset:40704
    ds_write_b8_d16_hi v118, v109 offset:10496
    v_lshlrev_b32 v118, 2, v118
    ds_write_b32 v118, v84 offset:40704
    ds_write_b8_d16_hi v119, v110 offset:10496
    v_lshlrev_b32 v119, 2, v119
    ds_write_b32 v119, v85 offset:40704
    ds_write_b8_d16_hi v120, v111 offset:10496
    v_lshlrev_b32 v120, 2, v120
    ds_write_b32 v120, v86 offset:40704
    s_waitcnt lgkmcnt(0)
    ds_write_b8_d16_hi v121, v112 offset:10496
    v_lshlrev_b32 v121, 2, v121
    ds_write_b32 v121, v87 offset:40704
    ds_write_b8_d16_hi v122, v113 offset:10496
    v_lshlrev_b32 v122, 2, v122
    ds_write_b32 v122, v88 offset:40704
    ds_write_b8_d16_hi v123, v114 offset:10496
    v_lshlrev_b32 v123, 2, v123
    ds_write_b32 v123, v89 offset:40704
    ds_write_b8_d16_hi v124, v115 offset:10496
    v_lshlrev_b32 v124, 2, v124
    ds_write_b32 v124, v90 offset:40704
    s_cmp_ge_u32 s28, s33
    s_cbranch_scc1 p1_p_done
    v_and_b32 v125, 0xffff, v116
    ds_add_rtn_u32 v125, v125, v3 offset:0
    s_waitcnt lgkmcnt(0)
    ds_write_b8_d16_hi v125, v116 offset:10496
    v_lshlrev_b32 v125, 2, v125
    ds_write_b32 v125, v91 offset:40704
p1_p_done:
    s_waitcnt lgkmcnt(0)
    s_barrier
    v_mul_u32_u24 v119, 3, v0
    v_lshlrev_b32 v117, 2, v119
    v_add_u32 v117, 40704, v117
    v_and_b32 v118, -4, v119
    v_mov_b32 v120, v1
    v_mov_b32 v122, 0
    v_mov_b32 v123, 0
    v_mov_b32 v124, 0
    v_mov_b32 v125, 0
    v_cmp_gt_u32 vcc, 640, v0
    s_and_saveexec_b64 s[52:53], vcc
    ds_write_b128 v1, v[122:125] offset:0
    s_mov_b64 exec, -1
    ds_read_b32 v68, v117 offset:0
    ds_read_b32 v69, v117 offset:4
    ds_read_b32 v70, v117 offset:8
    ds_read_b32 v71, v118 offset:10496
    ds_read_b32 v72, v118 offset:10500
    ds_read_b32 v74, v117 offset:12288
    ds_read_b32 v75, v117 offset:12292
    ds_read_b32 v76, v117 offset:12296
    ds_read_b32 v77, v118 offset:13568
    ds_read_b32 v78, v118 offset:13572
    s_waitcnt lgkmcnt(5)
    ds_read_b32 v80, v117 offset:24576
    ds_read_b32 v81, v117 offset:24580
    ds_read_b32 v82, v117 offset:24584
    ds_read_b32 v83, v118 offset:16640
    ds_read_b32 v84, v118 offset:16644
    v_alignbyte_b32 v71, v72, v71, v119
    buffer_store_dwordx4 v[68:71], v120, s[20:23], 0 offen nt
    v_add_u32 v120, 16384, v120
    s_waitcnt lgkmcnt(5)
    ds_read_b32 v86, v117 offset:36864
    ds_read_b32 v87, v117 offset:36868
    ds_read_b32 v88, v117 offset:36872
    ds_read_b32 v89, v118 offset:19712
    ds_read_b32 v90, v118 offset:19716
    v_alignbyte_b32 v77, v78, v77, v119
    buffer_store_dwordx4 v[74:77], v120, s[20:23], 0 offen nt
    v_add_u32 v120, 16384, v120
    s_waitcnt lgkmcnt(5)
    ds_read_b32 v92, v117 offset:49152
    ds_read_b32 v93, v117 offset:49156
    ds_read_b32 v94, v117 offset:49160
    ds_read_b32 v95, v118 offset:22784
    ds_read_b32 v96, v118 offset:22788
    v_alignbyte_b32 v83, v84, v83, v119
    buffer_store_dwordx4 v[80:83], v120, s[20:23], 0 offen nt
    v_add_u32 v120, 16384, v120
    s_waitcnt lgkmcnt(5)
    v_add_u32 v117, 61440, v117
    ds_read_b32 v98, v117 offset:0
    ds_read_b32 v99, v117 offset:4
    ds_read_b32 v100, v117 offset:8
    ds_read_b32 v101, v118 offset:25856
    ds_read_b32 v102, v118 offset:25860
    v_alignbyte_b32 v89, v90, v89, v119
    buffer_store_dwordx4 v[86:89], v120, s[20:23], 0 offen nt
    v_add_u32 v120, 16384, v120
    s_waitcnt lgkmcnt(5)
    ds_read_b32 v104, v117 offset:12288
    ds_read_b32 v105, v117 offset:12292
    ds_read_b32 v106, v117 offset:12296
    ds_read_b32 v107, v118 offset:28928
    ds_read_b32 v108, v118 offset:28932
    v_alignbyte_b32 v95, v96, v95, v119
    buffer_store_dwordx4 v[92:95], v120, s[20:23], 0 offen nt
    v_add_u32 v120, 16384, v120
    s_waitcnt lgkmcnt(5)
    ds_read_b32 v110, v117 offset:24576
    ds_read_b32 v111, v117 offset:24580
    ds_read_b32 v112, v117 offset:24584
    ds_read_b32 v113, v118 offset:32000
    ds_read_b32 v114, v118 offset:32004
    v_alignbyte_b32 v101, v102, v101, v119
    buffer_store_dwordx4 v[98:101], v120, s[20:23], 0 offen nt
    v_add_u32 v120, 16384, v120
    s_waitcnt lgkmcnt(5)
    ds_read_b32 v68, v117 offset:36864
    ds_read_b32 v69, v117 offset:36868
    ds_read_b32 v70, v117 offset:36872
    ds_read_b32 v71, v118 offset:35072
    ds_read_b32 v72, v118 offset:35076
    v_alignbyte_b32 v107, v108, v107, v119
    buffer_store_dwordx4 v[104:107], v120, s[20:23], 0 offen nt
    v_add_u32 v120, 16384, v120
    s_waitcnt lgkmcnt(5)
    ds_read_b32 v74, v117 offset:49152
    ds_read_b32 v75, v117 offset:49156
    ds_read_b32 v76, v117 offset:49160
    ds_read_b32 v77, v118 offset:38144
    ds_read_b32 v78, v118 offset:38148
    v_alignbyte_b32 v113, v114, v113, v119
    buffer_store_dwordx4 v[110:113], v120, s[20:23], 0 offen nt
    v_add_u32 v120, 16384, v120
    s_waitcnt lgkmcnt(5)
    v_alignbyte_b32 v71, v72, v71, v119
    buffer_store_dwordx4 v[68:71], v120, s[20:23], 0 offen nt
    v_add_u32 v120, 16384, v120
    s_waitcnt lgkmcnt(0)
    v_alignbyte_b32 v77, v78, v77, v119
    buffer_store_dwordx4 v[74:77], v120, s[20:23], 0 offen nt
    s_barrier
    s_add_u32 s29, s29, 1
    s_cmp_lt_u32 s29, 8
    s_cbranch_scc1 p1_tile
    s_cmp_ge_u32 s28, 10
    s_cbranch_scc1 p1_tr_done
    s_mul_i32 s52, s68, 5248
    s_mul_i32 s53, s28, 520
    s_add_u32 s52, s52, s53
    s_add_u32 s52, s52, 329252864
    s_mul_i32 s53, s28, 1064960
    s_lshl_b32 s54, s68, 3
    s_add_u32 s53, s53, s54
    s_add_u32 s53, s53, 340000768
    s_waitcnt vmcnt(10)
    v_and_b32 v4, 63, v0
    v_lshlrev_b32 v5, 3, v4
    v_lshlrev_b32 v6, 14, v4
    buffer_load_dwordx4 v[8:11], v5, s[16:19], s52 offen sc1
    s_add_u32 s52, s52, 5248
    buffer_load_dwordx4 v[12:15], v5, s[16:19], s52 offen sc1
    s_add_u32 s52, s52, 5248
    buffer_load_dwordx4 v[16:19], v5, s[16:19], s52 offen sc1
    s_add_u32 s52, s52, 5248
    buffer_load_dwordx4 v[20:23], v5, s[16:19], s52 offen sc1
    s_add_u32 s52, s52, 5248
    buffer_load_dwordx4 v[24:27], v5, s[16:19], s52 offen sc1
    s_add_u32 s52, s52, 5248
    buffer_load_dwordx4 v[28:31], v5, s[16:19], s52 offen sc1
    s_add_u32 s52, s52, 5248
    buffer_load_dwordx4 v[32:35], v5, s[16:19], s52 offen sc1
    s_add_u32 s52, s52, 5248
    buffer_load_dwordx4 v[36:39], v5, s[16:19], s52 offen sc1
    s_add_u32 s52, s52, 5248
    s_waitcnt vmcnt(0)
    v_mov_b32 v40, v10
    v_mov_b32 v41, v11
    v_mov_b32 v42, v14
    v_mov_b32 v43, v15
    v_mov_b32 v10, v12
    v_mov_b32 v11, v13
    v_mov_b32 v44, v18
    v_mov_b32 v45, v19
    v_mov_b32 v12, v16
    v_mov_b32 v13, v17
    v_mov_b32 v46, v22
    v_mov_b32 v47, v23
    v_mov_b32 v14, v20
    v_mov_b32 v15, v21
    v_mov_b32 v48, v26
    v_mov_b32 v49, v27
    v_mov_b32 v16, v24
    v_mov_b32 v17, v25
    v_mov_b32 v50, v30
    v_mov_b32 v51, v31
    v_mov_b32 v18, v28
    v_mov_b32 v19, v29
    v_mov_b32 v52, v34
    v_mov_b32 v53, v35
    v_mov_b32 v20, v32
    v_mov_b32 v21, v33
    v_mov_b32 v54, v38
    v_mov_b32 v55, v39
    v_mov_b32 v22, v36
    v_mov_b32 v23, v37
    buffer_store_dwordx4 v[8:11], v6, s[16:19], s53 offen offset:0
    buffer_store_dwordx4 v[12:15], v6, s[16:19], s53 offen offset:16
    buffer_store_dwordx4 v[16:19], v6, s[16:19], s53 offen offset:32
    buffer_store_dwordx4 v[20:23], v6, s[16:19], s53 offen offset:48
    s_add_u32 s53, s53, 16384
    s_mov_b64 exec, 1
    s_lshl_b64 exec, exec, 63
    buffer_store_dwordx4 v[40:43], v6, s[16:19], s53 offen offset:0
    buffer_store_dwordx4 v[44:47], v6, s[16:19], s53 offen offset:16
    buffer_store_dwordx4 v[48:51], v6, s[16:19], s53 offen offset:32
    buffer_store_dwordx4 v[52:55], v6, s[16:19], s53 offen offset:48
    s_mov_b64 exec, -1
p1_tr_done:
p1_end:
    s_endpgm
.globl p2_kernel
.p2align 8
.type p2_kernel,@function
p2_kernel:
    s_cmp_ge_u32 s2, 256
    s_cbranch_scc1 p2_end
    s_load_dwordx2 s[8:9], s[0:1], 104
    v_and_b32 v116, 63, v0
    v_lshrrev_b32 v122, 6, v0
    v_lshlrev_b32 v123, 5, v0
    v_lshlrev_b32 v116, 4, v116
    v_readfirstlane_b32 s10, v122
    s_and_b32 s44, s2, 7
    s_lshr_b32 s11, s44, 1
    s_and_b32 s44, s44, 1
    s_lshl_b32 s12, s44, 5
    s_lshr_b32 s44, s2, 3
    s_add_u32 s12, s12, s44
    s_mov_b32 s25, 54272
    s_mov_b32 s27, 2214526976
    s_mov_b32 s28, 4294901760
    s_mov_b32 s31, 50463745
    s_mov_b32 s32, 50464001
    s_mov_b32 s33, 50464257
    s_mov_b32 s21, 0
    s_mul_i32 s23, s10, 3072
    s_lshl_b32 s24, s10, 9
    s_lshl_b32 s64, s10, 10
    s_sub_u32 s42, s24, s23
    s_add_u32 s42, s42, 49152
    s_mul_i32 s41, s10, 20578304
    s_mul_i32 s40, s12, 16384
    s_add_u32 s40, s40, 340000768
    s_add_u32 s40, s40, s64
    s_waitcnt lgkmcnt(0)
    s_mov_b32 s4, s8
    s_and_b32 s5, s9, 0xffff
    s_mov_b32 s6, 819200000
    s_mov_b32 s7, 0x20000
    s_mov_b32 s44, 357101568
    buffer_load_dwordx4 v[60:63], v123, s[4:7], s44 offen
    buffer_load_dwordx4 v[64:67], v123, s[4:7], s44 offen offset:16
p2_restart:
    s_mul_i32 s13, s11, 10
    s_add_u32 s14, s13, 10
    s_lshr_b32 s44, s13, 2
    s_mul_i32 s44, s44, 1064960
    s_add_u32 s44, s44, s40
    s_and_b32 s45, s13, 2
    s_lshl_b32 s45, s45, 1
    s_add_u32 s44, s44, s45
    buffer_load_dword v86, v116, s[4:7], s44 offen offset:0
    buffer_load_dword v87, v116, s[4:7], s44 offen offset:8
    s_add_u32 s44, s44, 16384
    buffer_load_dword v88, v116, s[4:7], s44 offen offset:0
    buffer_load_dword v89, v116, s[4:7], s44 offen offset:8
    s_mul_i32 s20, s13, 161280
    s_add_u32 s20, s20, 350650368
    s_add_u32 s20, s20, s23
    s_cmp_ge_u32 s10, 9
    s_cbranch_scc1 p2_nmp
    v_lshrrev_b32 v84, 1, v116
    s_add_u32 s44, s20, s42
    buffer_load_dwordx2 v[84:85], v84, s[4:7], s44 offen
p2_nmp:
    buffer_load_dwordx4 v[72:75], v116, s[4:7], s20 offen offset:0
    buffer_load_dwordx4 v[76:79], v116, s[4:7], s20 offen offset:1024
    buffer_load_dwordx4 v[80:83], v116, s[4:7], s20 offen offset:2048
    s_barrier
    v_mov_b32 v117, 0
    v_mov_b32 v118, 0
    v_mov_b32 v119, 0
    v_mov_b32 v120, 0
    v_mov_b32 v121, 0
    ds_write_b128 v117, v[118:121] offset:53760
    s_cmp_eq_u32 s21, 0
    s_cselect_b32 s44, 1879076864, 0
    v_mov_b32 v124, s44
    v_mov_b32 v125, s44
    v_mov_b32 v126, s44
    v_mov_b32 v127, s44
    v_add_u32 v123, s64, v116
    v_add_u32 v122, s25, v123
    ds_write_b128 v122, v[124:127] offset:0
    ds_write_b128 v122, v[124:127] offset:16384
    ds_write_b128 v122, v[124:127] offset:32768
    v_add_u32 v122, 49152, v122
    ds_write_b128 v122, v[124:127] offset:0
    ds_write_b128 v122, v[124:127] offset:16384
    ds_write_b128 v122, v[124:127] offset:32768
    v_cmpx_gt_u32 vcc, 1792, v123
    ds_write_b128 v122, v[124:127] offset:49152
    s_mov_b64 exec, -1
    s_mov_b32 s19, 0
    s_cmp_eq_u32 s21, 2
    s_cselect_b64 s[66:67], -1, 0
    s_waitcnt vmcnt(3) lgkmcnt(0)
    s_barrier
    s_mov_b32 m0, s23
    v_mov_b32 v53, 0x70000000
    s_movk_i32 s44, 512
    v_sub_u32_sdwa v4, v88, v86 dst_sel:DWORD dst_unused:UNUSED_PAD src0_sel:WORD_0 src1_sel:WORD_0
    v_sub_u32_sdwa v5, v89, v87 dst_sel:DWORD dst_unused:UNUSED_PAD src0_sel:WORD_0 src1_sel:WORD_0
    v_med3_i32 v4, v4, 0, s44
    v_med3_i32 v5, v5, 0, s44
    v_add_u32 v48, v4, v5
    ds_write_addtid_b32 v53 offset:0
    ds_write_addtid_b32 v53 offset:256
    ds_write_addtid_b32 v53 offset:512
    ds_write_addtid_b32 v53 offset:768
    ds_write_addtid_b32 v53 offset:1024
    ds_write_addtid_b32 v53 offset:1280
    ds_write_addtid_b32 v53 offset:1536
    ds_write_addtid_b32 v53 offset:1792
    v_mul_u32_u24 v53, 20096, v116
    v_add_u32 v53, s41, v53
    s_nop 1
    v_add_u32_dpp v48, v48, v48 row_shr:1 row_mask:0xf bank_mask:0xf bound_ctrl:0
    s_nop 1
    v_add_u32_dpp v48, v48, v48 row_shr:2 row_mask:0xf bank_mask:0xf bound_ctrl:0
    s_nop 1
    v_add_u32_dpp v48, v48, v48 row_shr:4 row_mask:0xf bank_mask:0xf bound_ctrl:0
    s_nop 1
    v_add_u32_dpp v48, v48, v48 row_shr:8 row_mask:0xf bank_mask:0xf bound_ctrl:0
    s_nop 1
    v_add_u32_dpp v48, v48, v48 row_bcast:15 row_mask:0xa bank_mask:0xf
    s_nop 1
    v_add_u32_dpp v48, v48, v48 row_bcast:31 row_mask:0xc bank_mask:0xf
    s_nop 1
    s_nop 0
    v_readlane_b32 s38, v48, 63
    v_sub_u32 v50, v48, v5
    v_sub_u32 v49, v50, v4
    v_sub_u32 v10, 512, v49
    v_mad_u32_u16 v51, v86, 16, v53
    v_med3_i32 v10, v10, 0, v4
    v_lshl_add_u32 v49, v49, 2, s23
    v_add_u32 v86, v86, v10
    v_sub_u32 v11, 512, v50
    v_mad_u32_u16 v52, v87, 16, v53
    v_med3_i32 v11, v11, 0, v5
    v_lshl_add_u32 v50, v50, 2, s23
    v_add_u32 v87, v87, v11
    v_add_u32 v52, 160768, v52
    s_min_u32 s17, s38, 512
    s_add_u32 s17, s17, 63
    s_lshr_b32 s17, s17, 6
p2_xa_0:
    v_cmpx_lt_i32 vcc, 0, v10
    s_cbranch_execz p2_ya_0
    ds_write_b32 v49, v51 offset:0
    v_add_u32 v51, 16, v51
    v_cmpx_lt_i32 vcc, 1, v10
    s_cbranch_execz p2_ya_0
    ds_write_b32 v49, v51 offset:4
    v_add_u32 v51, 16, v51
    v_cmpx_lt_i32 vcc, 2, v10
    s_cbranch_execz p2_ya_0
    ds_write_b32 v49, v51 offset:8
    v_add_u32 v51, 16, v51
    v_cmpx_lt_i32 vcc, 3, v10
    s_cbranch_execz p2_ya_0
    ds_write_b32 v49, v51 offset:12
    v_add_u32 v51, 16, v51
    v_cmpx_lt_i32 vcc, 4, v10
    s_cbranch_execz p2_ya_0
    ds_write_b32 v49, v51 offset:16
    v_add_u32 v51, 16, v51
    v_cmpx_lt_i32 vcc, 5, v10
    s_cbranch_execz p2_ya_0
    ds_write_b32 v49, v51 offset:20
    v_add_u32 v51, 16, v51
    v_cmpx_lt_i32 vcc, 6, v10
    s_cbranch_execz p2_ya_0
    ds_write_b32 v49, v51 offset:24
    v_add_u32 v51, 16, v51
    v_cmpx_lt_i32 vcc, 7, v10
    s_cbranch_execz p2_ya_0
    ds_write_b32 v49, v51 offset:28
    v_add_u32 v51, 16, v51
    v_subrev_u32 v10, 8, v10
    v_add_u32 v49, 32, v49
    s_branch p2_xa_0
p2_ya_0:
    s_mov_b64 exec, -1
p2_xa_1:
    v_cmpx_lt_i32 vcc, 0, v11
    s_cbranch_execz p2_ya_1
    ds_write_b32 v50, v52 offset:0
    v_add_u32 v52, 16, v52
    v_cmpx_lt_i32 vcc, 1, v11
    s_cbranch_execz p2_ya_1
    ds_write_b32 v50, v52 offset:4
    v_add_u32 v52, 16, v52
    v_cmpx_lt_i32 vcc, 2, v11
    s_cbranch_execz p2_ya_1
    ds_write_b32 v50, v52 offset:8
    v_add_u32 v52, 16, v52
    v_cmpx_lt_i32 vcc, 3, v11
    s_cbranch_execz p2_ya_1
    ds_write_b32 v50, v52 offset:12
    v_add_u32 v52, 16, v52
    v_cmpx_lt_i32 vcc, 4, v11
    s_cbranch_execz p2_ya_1
    ds_write_b32 v50, v52 offset:16
    v_add_u32 v52, 16, v52
    v_cmpx_lt_i32 vcc, 5, v11
    s_cbranch_execz p2_ya_1
    ds_write_b32 v50, v52 offset:20
    v_add_u32 v52, 16, v52
    v_cmpx_lt_i32 vcc, 6, v11
    s_cbranch_execz p2_ya_1
    ds_write_b32 v50, v52 offset:24
    v_add_u32 v52, 16, v52
    v_cmpx_lt_i32 vcc, 7, v11
    s_cbranch_execz p2_ya_1
    ds_write_b32 v50, v52 offset:28
    v_add_u32 v52, 16, v52
    v_subrev_u32 v11, 8, v11
    v_add_u32 v50, 32, v50
    s_branch p2_xa_1
p2_ya_1:
    s_mov_b64 exec, -1
    s_cmp_lt_u32 s38, 512
    s_cbranch_scc1 p2_nomorea
    v_cmp_lt_u32_sdwa s[44:45], v86, v88 src0_sel:WORD_0 src1_sel:WORD_0
    v_cmp_lt_u32_sdwa s[46:47], v87, v89 src0_sel:WORD_0 src1_sel:WORD_0
    s_nop 0
    s_or_b64 s[44:45], s[44:45], s[46:47]
    s_cbranch_scc0 p2_nomorea
    v_mov_b32 v49, s19
    v_mov_b32 v50, 1
    ds_write_b32 v49, v50 offset:53760
p2_nomorea:
    ds_read_addtid_b32 v114 offset:0
    ds_read_addtid_b32 v115 offset:256
    ds_read_addtid_b32 v90 offset:512
    ds_read_addtid_b32 v94 offset:768
    ds_read_addtid_b32 v98 offset:1024
    ds_read_addtid_b32 v102 offset:1280
    ds_read_addtid_b32 v106 offset:1536
    ds_read_addtid_b32 v110 offset:1792
    s_waitcnt lgkmcnt(0)
    s_cmp_lg_u32 s10, 0
    s_cbranch_scc1 p2_ntp
    s_lshr_b32 s44, s2, 3
    s_mul_i32 s44, s44, 5120
    s_add_u32 s44, s44, s20
    s_add_u32 s44, s44, 53760
    v_lshlrev_b32 v126, 3, v116
    s_mov_b32 exec_hi, 0xff
    buffer_load_dword v126, v126, s[4:7], s44 offen
    s_mov_b64 exec, -1
p2_ntp:
    buffer_load_dwordx4 v[0:3], v114, s[4:7], 0 offen
    buffer_load_dwordx4 v[6:9], v115, s[4:7], 0 offen
    buffer_load_dwordx4 v[90:93], v90, s[4:7], 0 offen
    buffer_load_dwordx4 v[94:97], v94, s[4:7], 0 offen
    buffer_load_dwordx4 v[98:101], v98, s[4:7], 0 offen
    buffer_load_dwordx4 v[102:105], v102, s[4:7], 0 offen
    buffer_load_dwordx4 v[106:109], v106, s[4:7], 0 offen
    buffer_load_dwordx4 v[110:113], v110, s[4:7], 0 offen
    s_mov_b32 s16, s17
    s_cmp_lg_u32 s21, 0
    s_cbranch_scc1 p2_nostat1
    v_max3_u32 v60, v60, v62, v64
    v_max_u32 v60, v60, v66
    v_add_f32 v61, v61, v63
    v_add_f32 v65, v65, v67
    v_add_f32 v61, v61, v65
    s_nop 1
    v_max_u32_dpp v60, v60, v60 row_shr:1 row_mask:0xf bank_mask:0xf bound_ctrl:0
    v_add_f32_dpp v61, v61, v61 row_shr:1 row_mask:0xf bank_mask:0xf bound_ctrl:0
    s_nop 0
    v_max_u32_dpp v60, v60, v60 row_shr:2 row_mask:0xf bank_mask:0xf bound_ctrl:0
    v_add_f32_dpp v61, v61, v61 row_shr:2 row_mask:0xf bank_mask:0xf bound_ctrl:0
    s_nop 0
    v_max_u32_dpp v60, v60, v60 row_shr:4 row_mask:0xf bank_mask:0xf bound_ctrl:0
    v_add_f32_dpp v61, v61, v61 row_shr:4 row_mask:0xf bank_mask:0xf bound_ctrl:0
    s_nop 0
    v_max_u32_dpp v60, v60, v60 row_shr:8 row_mask:0xf bank_mask:0xf bound_ctrl:0
    v_add_f32_dpp v61, v61, v61 row_shr:8 row_mask:0xf bank_mask:0xf bound_ctrl:0
    s_nop 0
    v_max_u32_dpp v60, v60, v60 row_bcast:15 row_mask:0xa bank_mask:0xf
    v_add_f32_dpp v61, v61, v61 row_bcast:15 row_mask:0xa bank_mask:0xf
    s_nop 0
    v_max_u32_dpp v60, v60, v60 row_bcast:31 row_mask:0xc bank_mask:0xf
    v_add_f32_dpp v61, v61, v61 row_bcast:31 row_mask:0xc bank_mask:0xf
    s_nop 0
    s_nop 0
    s_lshl_b32 s44, s10, 3
    v_mov_b32 v62, s44
    s_mov_b64 exec, 1
    s_lshl_b64 exec, exec, 63
    ds_write_b64 v62, v[60:61] offset:53824
    s_mov_b64 exec, -1
p2_nostat1:
    s_waitcnt lgkmcnt(0)
    s_barrier
    v_mov_b32 v122, s19
    s_xor_b32 s19, s19, 4
    ds_read_b32 v127, v122 offset:53760
    s_cmp_lg_u32 s21, 0
    s_cbranch_scc1 p2_nostat2
    v_bfe_u32 v62, v116, 1, 7
    ds_read_b64 v[60:61], v62 offset:53824
    s_waitcnt lgkmcnt(0)
    s_nop 1
    v_max_u32_dpp v60, v60, v60 row_shr:1 row_mask:0xf bank_mask:0xf bound_ctrl:0
    v_add_f32_dpp v61, v61, v61 row_shr:1 row_mask:0xf bank_mask:0xf bound_ctrl:0
    s_nop 0
    v_max_u32_dpp v60, v60, v60 row_shr:2 row_mask:0xf bank_mask:0xf bound_ctrl:0
    v_add_f32_dpp v61, v61, v61 row_shr:2 row_mask:0xf bank_mask:0xf bound_ctrl:0
    s_nop 0
    v_max_u32_dpp v60, v60, v60 row_shr:4 row_mask:0xf bank_mask:0xf bound_ctrl:0
    v_add_f32_dpp v61, v61, v61 row_shr:4 row_mask:0xf bank_mask:0xf bound_ctrl:0
    s_nop 0
    v_max_u32_dpp v60, v60, v60 row_shr:8 row_mask:0xf bank_mask:0xf bound_ctrl:0
    v_add_f32_dpp v61, v61, v61 row_shr:8 row_mask:0xf bank_mask:0xf bound_ctrl:0
    s_nop 0
    v_max_u32_dpp v60, v60, v60 row_bcast:15 row_mask:0xa bank_mask:0xf
    v_add_f32_dpp v61, v61, v61 row_bcast:15 row_mask:0xa bank_mask:0xf
    s_nop 0
    v_max_u32_dpp v60, v60, v60 row_bcast:31 row_mask:0xc bank_mask:0xf
    v_add_f32_dpp v61, v61, v61 row_bcast:31 row_mask:0xc bank_mask:0xf
    s_nop 0
    s_nop 0
    v_readlane_b32 s44, v60, 15
    v_readlane_b32 s45, v61, 15
    s_nop 1
    s_lshl_b32 s44, s44, 16
    s_lshr_b32 s46, s44, 23
    s_sub_u32 s47, s46, 80
    s_cmp_lt_u32 s47, 100
    s_cselect_b32 s21, 0, 1
    v_mov_b32 v60, s45
    v_mul_f32 v60, 0x34a7c5ac, v60
    v_sqrt_f32 v60, v60
    v_mov_b32 v61, s44
    v_mul_f32 v62, 0x41800000, v60
    v_cmp_nle_f32 vcc, v61, v62
    v_mul_f32 v60, 0x3a924925, v60
    v_mul_f32 v61, 0x3901742e, v61
    v_max_f32 v60, v60, v61
    s_cmp_lg_u64 vcc, 0
    s_cselect_b32 s21, 1, s21
    v_readfirstlane_b32 s44, v60
    s_nop 0
    s_and_b32 s47, s44, 0x7fffff
    s_or_b32 s47, s47, 0x3f000000
    s_and_b32 s48, s44, 0x7f800000
    s_add_u32 s48, s48, 0x800000
    v_rcp_f32 v60, s47
    s_nop 0
    v_rcp_f32 v61, v60
    v_mul_f32 v60, 0x7b800000, v60
    v_mul_f32 v61, s48, v61
    s_nop 0
    v_readfirstlane_b32 s26, v60
    v_readfirstlane_b32 s30, v61
    s_add_u32 s34, s48, 197132288
    s_mov_b32 s35, s34
    s_sub_u32 s36, 0, s34
    s_subb_u32 s37, 0, s34
    s_cmp_eq_u32 s21, 0
    s_cbranch_scc1 p2_nostat2
    s_waitcnt vmcnt(0) lgkmcnt(0)
    s_branch p2_restart
p2_nostat2:
    s_cmp_eq_u32 s21, 0
    s_cselect_b32 s26, s26, 0x7b800000
    s_waitcnt lgkmcnt(0)
    v_readfirstlane_b32 s62, v127
    s_mov_b32 s63, 0
    s_cmp_lg_u32 s62, 0
    s_cbranch_scc1 p2_adva_done
    s_add_u32 s13, s13, 1
    s_cmp_ge_u32 s13, s14
    s_cselect_b32 s63, 1, 0
    s_or_b32 s44, s13, s63
    s_bitcmp0_b32 s44, 0
    s_cbranch_scc1 p2_newdesca
    v_lshrrev_b32 v86, 16, v86
    v_lshrrev_b32 v87, 16, v87
    v_lshrrev_b32 v88, 16, v88
    v_lshrrev_b32 v89, 16, v89
    s_branch p2_adva_done
p2_newdesca:
    s_lshr_b32 s44, s13, 2
    s_mul_i32 s44, s44, 1064960
    s_add_u32 s44, s44, s40
    s_and_b32 s45, s13, 2
    s_lshl_b32 s45, s45, 1
    s_add_u32 s44, s44, s45
    buffer_load_dword v86, v116, s[4:7], s44 offen offset:0
    buffer_load_dword v87, v116, s[4:7], s44 offen offset:8
    s_add_u32 s44, s44, 16384
    buffer_load_dword v88, v116, s[4:7], s44 offen offset:0
    buffer_load_dword v89, v116, s[4:7], s44 offen offset:8
    s_waitcnt vmcnt(0)
p2_adva_done:
    s_mov_b32 m0, s23
    v_mov_b32 v53, 0x70000000
    s_movk_i32 s44, 512
    v_sub_u32_sdwa v4, v88, v86 dst_sel:DWORD dst_unused:UNUSED_PAD src0_sel:WORD_0 src1_sel:WORD_0
    v_sub_u32_sdwa v5, v89, v87 dst_sel:DWORD dst_unused:UNUSED_PAD src0_sel:WORD_0 src1_sel:WORD_0
    v_med3_i32 v4, v4, 0, s44
    v_med3_i32 v5, v5, 0, s44
    v_add_u32 v48, v4, v5
    ds_write_addtid_b32 v53 offset:0
    ds_write_addtid_b32 v53 offset:256
    ds_write_addtid_b32 v53 offset:512
    ds_write_addtid_b32 v53 offset:768
    ds_write_addtid_b32 v53 offset:1024
    ds_write_addtid_b32 v53 offset:1280
    ds_write_addtid_b32 v53 offset:1536
    ds_write_addtid_b32 v53 offset:1792
    v_mul_u32_u24 v53, 20096, v116
    v_add_u32 v53, s41, v53
    s_nop 1
    v_add_u32_dpp v48, v48, v48 row_shr:1 row_mask:0xf bank_mask:0xf bound_ctrl:0
    s_nop 1
    v_add_u32_dpp v48, v48, v48 row_shr:2 row_mask:0xf bank_mask:0xf bound_ctrl:0
    s_nop 1
    v_add_u32_dpp v48, v48, v48 row_shr:4 row_mask:0xf bank_mask:0xf bound_ctrl:0
    s_nop 1
    v_add_u32_dpp v48, v48, v48 row_shr:8 row_mask:0xf bank_mask:0xf bound_ctrl:0
    s_nop 1
    v_add_u32_dpp v48, v48, v48 row_bcast:15 row_mask:0xa bank_mask:0xf
    s_nop 1
    v_add_u32_dpp v48, v48, v48 row_bcast:31 row_mask:0xc bank_mask:0xf
    s_nop 1
    s_nop 0
    v_readlane_b32 s38, v48, 63
    v_sub_u32 v50, v48, v5
    v_sub_u32 v49, v50, v4
    v_sub_u32 v10, 512, v49
    v_mad_u32_u16 v51, v86, 16, v53
    v_med3_i32 v10, v10, 0, v4
    v_lshl_add_u32 v49, v49, 2, s23
    v_add_u32 v86, v86, v10
    v_sub_u32 v11, 512, v50
    v_mad_u32_u16 v52, v87, 16, v53
    v_med3_i32 v11, v11, 0, v5
    v_lshl_add_u32 v50, v50, 2, s23
    v_add_u32 v87, v87, v11
    v_add_u32 v52, 160768, v52
    s_min_u32 s17, s38, 512
    s_add_u32 s17, s17, 63
    s_lshr_b32 s17, s17, 6
p2_xb_0:
    v_cmpx_lt_i32 vcc, 0, v10
    s_cbranch_execz p2_yb_0
    ds_write_b32 v49, v51 offset:0
    v_add_u32 v51, 16, v51
    v_cmpx_lt_i32 vcc, 1, v10
    s_cbranch_execz p2_yb_0
    ds_write_b32 v49, v51 offset:4
    v_add_u32 v51, 16, v51
    v_cmpx_lt_i32 vcc, 2, v10
    s_cbranch_execz p2_yb_0
    ds_write_b32 v49, v51 offset:8
    v_add_u32 v51, 16, v51
    v_cmpx_lt_i32 vcc, 3, v10
    s_cbranch_execz p2_yb_0
    ds_write_b32 v49, v51 offset:12
    v_add_u32 v51, 16, v51
    v_cmpx_lt_i32 vcc, 4, v10
    s_cbranch_execz p2_yb_0
    ds_write_b32 v49, v51 offset:16
    v_add_u32 v51, 16, v51
    v_cmpx_lt_i32 vcc, 5, v10
    s_cbranch_execz p2_yb_0
    ds_write_b32 v49, v51 offset:20
    v_add_u32 v51, 16, v51
    v_cmpx_lt_i32 vcc, 6, v10
    s_cbranch_execz p2_yb_0
    ds_write_b32 v49, v51 offset:24
    v_add_u32 v51, 16, v51
    v_cmpx_lt_i32 vcc, 7, v10
    s_cbranch_execz p2_yb_0
    ds_write_b32 v49, v51 offset:28
    v_add_u32 v51, 16, v51
    v_subrev_u32 v10, 8, v10
    v_add_u32 v49, 32, v49
    s_branch p2_xb_0
p2_yb_0:
    s_mov_b64 exec, -1
p2_xb_1:
    v_cmpx_lt_i32 vcc, 0, v11
    s_cbranch_execz p2_yb_1
    ds_write_b32 v50, v52 offset:0
    v_add_u32 v52, 16, v52
    v_cmpx_lt_i32 vcc, 1, v11
    s_cbranch_execz p2_yb_1
    ds_write_b32 v50, v52 offset:4
    v_add_u32 v52, 16, v52
    v_cmpx_lt_i32 vcc, 2, v11
    s_cbranch_execz p2_yb_1
    ds_write_b32 v50, v52 offset:8
    v_add_u32 v52, 16, v52
    v_cmpx_lt_i32 vcc, 3, v11
    s_cbranch_execz p2_yb_1
    ds_write_b32 v50, v52 offset:12
    v_add_u32 v52, 16, v52
    v_cmpx_lt_i32 vcc, 4, v11
    s_cbranch_execz p2_yb_1
    ds_write_b32 v50, v52 offset:16
    v_add_u32 v52, 16, v52
    v_cmpx_lt_i32 vcc, 5, v11
    s_cbranch_execz p2_yb_1
    ds_write_b32 v50, v52 offset:20
    v_add_u32 v52, 16, v52
    v_cmpx_lt_i32 vcc, 6, v11
    s_cbranch_execz p2_yb_1
    ds_write_b32 v50, v52 offset:24
    v_add_u32 v52, 16, v52
    v_cmpx_lt_i32 vcc, 7, v11
    s_cbranch_execz p2_yb_1
    ds_write_b32 v50, v52 offset:28
    v_add_u32 v52, 16, v52
    v_subrev_u32 v11, 8, v11
    v_add_u32 v50, 32, v50
    s_branch p2_xb_1
p2_yb_1:
    s_mov_b64 exec, -1
    s_cmp_lt_u32 s38, 512
    s_cbranch_scc1 p2_nomoreb
    v_cmp_lt_u32_sdwa s[44:45], v86, v88 src0_sel:WORD_0 src1_sel:WORD_0
    v_cmp_lt_u32_sdwa s[46:47], v87, v89 src0_sel:WORD_0 src1_sel:WORD_0
    s_nop 0
    s_or_b64 s[44:45], s[44:45], s[46:47]
    s_cbranch_scc0 p2_nomoreb
    v_mov_b32 v49, s19
    v_mov_b32 v50, 1
    ds_write_b32 v49, v50 offset:53760
p2_nomoreb:
    s_waitcnt vmcnt(0)
    v_perm_b32 v54, v93, v90, s31
    v_perm_b32 v55, v93, v91, s32
    v_perm_b32 v56, v93, v92, s33
    v_lshlrev_b16 v16, 3, v92
    v_lshlrev_b16 v14, 3, v91
    v_lshlrev_b16 v12, 3, v90
    v_perm_b32 v57, v97, v94, s31
    v_perm_b32 v58, v97, v95, s32
    v_perm_b32 v59, v97, v96, s33
    v_lshlrev_b16 v22, 3, v96
    v_lshlrev_b16 v20, 3, v95
    v_lshlrev_b16 v18, 3, v94
    v_perm_b32 v60, v101, v98, s31
    v_perm_b32 v61, v101, v99, s32
    v_perm_b32 v62, v101, v100, s33
    v_lshlrev_b16 v28, 3, v100
    v_lshlrev_b16 v26, 3, v99
    v_lshlrev_b16 v24, 3, v98
    v_perm_b32 v63, v105, v102, s31
    v_perm_b32 v64, v105, v103, s32
    v_perm_b32 v65, v105, v104, s33
    v_lshlrev_b16 v34, 3, v104
    v_lshlrev_b16 v32, 3, v103
    v_lshlrev_b16 v30, 3, v102
    v_perm_b32 v66, v109, v106, s31
    v_perm_b32 v67, v109, v107, s32
    v_perm_b32 v68, v109, v108, s33
    v_lshlrev_b16 v40, 3, v108
    v_lshlrev_b16 v38, 3, v107
    v_lshlrev_b16 v36, 3, v106
    v_perm_b32 v69, v113, v110, s31
    v_perm_b32 v70, v113, v111, s32
    v_perm_b32 v71, v113, v112, s33
    v_lshlrev_b16 v46, 3, v112
    v_lshlrev_b16 v44, 3, v111
    v_lshlrev_b16 v42, 3, v110
    ds_read_addtid_b32 v114 offset:0
    ds_read_addtid_b32 v115 offset:256
    ds_read_addtid_b32 v90 offset:512
    ds_read_addtid_b32 v94 offset:768
    ds_read_addtid_b32 v98 offset:1024
    ds_read_addtid_b32 v102 offset:1280
    ds_read_addtid_b32 v106 offset:1536
    ds_read_addtid_b32 v110 offset:1792
    s_waitcnt lgkmcnt(0)
    buffer_load_dwordx4 v[90:93], v90, s[4:7], 0 offen
    s_branch p2_tail
p2_add:
    s_setprio 2
    s_cmp_lg_u32 s21, 0
    s_cbranch_scc1 p2_addf
    v_lshlrev_b32_sdwa v122, 11, sext(v48) dst_sel:DWORD dst_unused:UNUSED_PAD src0_sel:DWORD src1_sel:WORD_0
    v_bfe_u32 v123, v48, 16, 14
    v_lshlrev_b32 v124, 16, v0
    v_bfi_b32 v122, v122, 0, s27
    v_and_b32 v125, s28, v0
    v_lshlrev_b32 v126, 16, v1
    v_mul_f32 v122, s26, v122
    v_and_b32 v127, s28, v1
    v_lshl_add_u32 v123, v123, 3, s25
    v_pk_fma_f32 v[124:125], v[124:125], v[122:123], s[34:35] op_sel_hi:[1,0,1]
    v_pk_fma_f32 v[126:127], v[126:127], v[122:123], s[34:35] op_sel_hi:[1,0,1]
    v_lshl_add_u32 v124, v125, 16, v124
    v_lshl_add_u32 v125, v127, 16, v126
    v_lshl_add_u64 v[124:125], v[124:125], 0, s[36:37]
    v_cmpx_ne_u32_sdwa vcc, v48, 0 src0_sel:BYTE_1 src1_sel:DWORD
    ds_add_rtn_u64 v[118:119], v123, v[124:125]
    s_mov_b64 exec, -1
    v_lshlrev_b32_sdwa v122, 11, sext(v49) dst_sel:DWORD dst_unused:UNUSED_PAD src0_sel:DWORD src1_sel:WORD_0
    v_bfe_u32 v123, v49, 16, 14
    v_lshlrev_b32 v124, 16, v2
    v_bfi_b32 v122, v122, 0, s27
    v_and_b32 v125, s28, v2
    v_lshlrev_b32 v126, 16, v3
    v_mul_f32 v122, s26, v122
    v_and_b32 v127, s28, v3
    v_lshl_add_u32 v123, v123, 3, s25
    v_pk_fma_f32 v[124:125], v[124:125], v[122:123], s[34:35] op_sel_hi:[1,0,1]
    v_pk_fma_f32 v[126:127], v[126:127], v[122:123], s[34:35] op_sel_hi:[1,0,1]
    v_lshl_add_u32 v124, v125, 16, v124
    v_lshl_add_u32 v125, v127, 16, v126
    v_lshl_add_u64 v[124:125], v[124:125], 0, s[36:37]
    v_cmpx_ne_u32_sdwa vcc, v49, 0 src0_sel:BYTE_1 src1_sel:DWORD
    ds_add_rtn_u64 v[120:121], v123, v[124:125]
    s_mov_b64 exec, -1
    v_lshlrev_b32_sdwa v122, 11, sext(v50) dst_sel:DWORD dst_unused:UNUSED_PAD src0_sel:DWORD src1_sel:WORD_0
    v_bfe_u32 v123, v50, 16, 14
    v_lshlrev_b32 v124, 16, v4
    v_bfi_b32 v122, v122, 0, s27
    v_and_b32 v125, s28, v4
    v_lshlrev_b32 v126, 16, v5
    v_mul_f32 v122, s26, v122
    v_and_b32 v127, s28, v5
    v_lshl_add_u32 v123, v123, 3, s25
    v_pk_fma_f32 v[124:125], v[124:125], v[122:123], s[34:35] op_sel_hi:[1,0,1]
    v_pk_fma_f32 v[126:127], v[126:127], v[122:123], s[34:35] op_sel_hi:[1,0,1]
    s_waitcnt lgkmcnt(1)
    v_pk_max_u16 v117, v117, v118
    v_lshl_add_u32 v124, v125, 16, v124
    v_lshl_add_u32 v125, v127, 16, v126
    v_pk_max_u16 v117, v117, v119
    v_lshl_add_u64 v[124:125], v[124:125], 0, s[36:37]
    v_cmpx_ne_u32_sdwa vcc, v50, 0 src0_sel:BYTE_1 src1_sel:DWORD
    ds_add_rtn_u64 v[118:119], v123, v[124:125]
    s_mov_b64 exec, -1
    buffer_load_dwordx4 v[0:3], v114, s[4:7], 0 offen
    v_lshlrev_b32_sdwa v122, 11, sext(v51) dst_sel:DWORD dst_unused:UNUSED_PAD src0_sel:DWORD src1_sel:WORD_0
    v_bfe_u32 v123, v51, 16, 14
    v_lshlrev_b32 v124, 16, v6
    v_bfi_b32 v122, v122, 0, s27
    v_and_b32 v125, s28, v6
    v_lshlrev_b32 v126, 16, v7
    v_mul_f32 v122, s26, v122
    v_and_b32 v127, s28, v7
    v_lshl_add_u32 v123, v123, 3, s25
    v_pk_fma_f32 v[124:125], v[124:125], v[122:123], s[34:35] op_sel_hi:[1,0,1]
    v_pk_fma_f32 v[126:127], v[126:127], v[122:123], s[34:35] op_sel_hi:[1,0,1]
    s_waitcnt lgkmcnt(1)
    v_pk_max_u16 v117, v117, v120
    v_lshl_add_u32 v124, v125, 16, v124
    v_lshl_add_u32 v125, v127, 16, v126
    v_pk_max_u16 v117, v117, v121
    v_lshl_add_u64 v[124:125], v[124:125], 0, s[36:37]
    v_cmpx_ne_u32_sdwa vcc, v51, 0 src0_sel:BYTE_1 src1_sel:DWORD
    ds_add_rtn_u64 v[120:121], v123, v[124:125]
    s_mov_b64 exec, -1
    v_lshlrev_b32_sdwa v122, 11, sext(v52) dst_sel:DWORD dst_unused:UNUSED_PAD src0_sel:DWORD src1_sel:WORD_0
    v_bfe_u32 v123, v52, 16, 14
    v_lshlrev_b32 v124, 16, v8
    v_bfi_b32 v122, v122, 0, s27
    v_and_b32 v125, s28, v8
    v_lshlrev_b32 v126, 16, v9
    v_mul_f32 v122, s26, v122
    v_and_b32 v127, s28, v9
    v_lshl_add_u32 v123, v123, 3, s25
    v_pk_fma_f32 v[124:125], v[124:125], v[122:123], s[34:35] op_sel_hi:[1,0,1]
    v_pk_fma_f32 v[126:127], v[126:127], v[122:123], s[34:35] op_sel_hi:[1,0,1]
    s_waitcnt lgkmcnt(1)
    v_pk_max_u16 v117, v117, v118
    v_lshl_add_u32 v124, v125, 16, v124
    v_lshl_add_u32 v125, v127, 16, v126
    v_pk_max_u16 v117, v117, v119
    v_lshl_add_u64 v[124:125], v[124:125], 0, s[36:37]
    v_cmpx_ne_u32_sdwa vcc, v52, 0 src0_sel:BYTE_1 src1_sel:DWORD
    ds_add_rtn_u64 v[118:119], v123, v[124:125]
    s_mov_b64 exec, -1
    v_lshlrev_b32_sdwa v122, 11, sext(v53) dst_sel:DWORD dst_unused:UNUSED_PAD src0_sel:DWORD src1_sel:WORD_0
    v_bfe_u32 v123, v53, 16, 14
    v_lshlrev_b32 v124, 16, v10
    v_bfi_b32 v122, v122, 0, s27
    v_and_b32 v125, s28, v10
    v_lshlrev_b32 v126, 16, v11
    v_mul_f32 v122, s26, v122
    v_and_b32 v127, s28, v11
    v_lshl_add_u32 v123, v123, 3, s25
    v_pk_fma_f32 v[124:125], v[124:125], v[122:123], s[34:35] op_sel_hi:[1,0,1]
    v_pk_fma_f32 v[126:127], v[126:127], v[122:123], s[34:35] op_sel_hi:[1,0,1]
    s_waitcnt lgkmcnt(1)
    v_pk_max_u16 v117, v117, v120
    v_lshl_add_u32 v124, v125, 16, v124
    v_lshl_add_u32 v125, v127, 16, v126
    v_pk_max_u16 v117, v117, v121
    v_lshl_add_u64 v[124:125], v[124:125], 0, s[36:37]
    v_cmpx_ne_u32_sdwa vcc, v53, 0 src0_sel:BYTE_1 src1_sel:DWORD
    ds_add_rtn_u64 v[120:121], v123, v[124:125]
    s_mov_b64 exec, -1
    buffer_load_dwordx4 v[6:9], v115, s[4:7], 0 offen
    s_mov_b32 m0, s23
    v_mov_b32 v53, 0x70000000
    s_movk_i32 s44, 512
    v_sub_u32_sdwa v4, v88, v86 dst_sel:DWORD dst_unused:UNUSED_PAD src0_sel:WORD_0 src1_sel:WORD_0
    v_sub_u32_sdwa v5, v89, v87 dst_sel:DWORD dst_unused:UNUSED_PAD src0_sel:WORD_0 src1_sel:WORD_0
    v_med3_i32 v4, v4, 0, s44
    v_med3_i32 v5, v5, 0, s44
    v_add_u32 v48, v4, v5
    ds_write_addtid_b32 v53 offset:0
    ds_write_addtid_b32 v53 offset:256
    ds_write_addtid_b32 v53 offset:512
    ds_write_addtid_b32 v53 offset:768
    ds_write_addtid_b32 v53 offset:1024
    ds_write_addtid_b32 v53 offset:1280
    ds_write_addtid_b32 v53 offset:1536
    ds_write_addtid_b32 v53 offset:1792
    v_mul_u32_u24 v53, 20096, v116
    v_add_u32 v53, s41, v53
    s_nop 1
    v_add_u32_dpp v48, v48, v48 row_shr:1 row_mask:0xf bank_mask:0xf bound_ctrl:0
    s_nop 1
    v_add_u32_dpp v48, v48, v48 row_shr:2 row_mask:0xf bank_mask:0xf bound_ctrl:0
    s_nop 1
    v_add_u32_dpp v48, v48, v48 row_shr:4 row_mask:0xf bank_mask:0xf bound_ctrl:0
    s_nop 1
    v_add_u32_dpp v48, v48, v48 row_shr:8 row_mask:0xf bank_mask:0xf bound_ctrl:0
    s_nop 1
    v_add_u32_dpp v48, v48, v48 row_bcast:15 row_mask:0xa bank_mask:0xf
    s_nop 1
    v_add_u32_dpp v48, v48, v48 row_bcast:31 row_mask:0xc bank_mask:0xf
    s_nop 1
    s_nop 0
    v_readlane_b32 s38, v48, 63
    v_sub_u32 v50, v48, v5
    v_sub_u32 v49, v50, v4
    v_sub_u32 v10, 512, v49
    v_mad_u32_u16 v51, v86, 16, v53
    v_med3_i32 v10, v10, 0, v4
    v_lshl_add_u32 v49, v49, 2, s23
    v_add_u32 v86, v86, v10
    v_sub_u32 v11, 512, v50
    v_mad_u32_u16 v52, v87, 16, v53
    v_med3_i32 v11, v11, 0, v5
    v_lshl_add_u32 v50, v50, 2, s23
    v_add_u32 v87, v87, v11
    v_add_u32 v52, 160768, v52
    s_min_u32 s17, s38, 512
    s_add_u32 s17, s17, 63
    s_lshr_b32 s17, s17, 6
p2_xc0_0:
    v_cmpx_lt_i32 vcc, 0, v10
    s_cbranch_execz p2_yc0_0
    ds_write_b32 v49, v51 offset:0
    v_add_u32 v51, 16, v51
    v_cmpx_lt_i32 vcc, 1, v10
    s_cbranch_execz p2_yc0_0
    ds_write_b32 v49, v51 offset:4
    v_add_u32 v51, 16, v51
    v_cmpx_lt_i32 vcc, 2, v10
    s_cbranch_execz p2_yc0_0
    ds_write_b32 v49, v51 offset:8
    v_add_u32 v51, 16, v51
    v_cmpx_lt_i32 vcc, 3, v10
    s_cbranch_execz p2_yc0_0
    ds_write_b32 v49, v51 offset:12
    v_add_u32 v51, 16, v51
    v_cmpx_lt_i32 vcc, 4, v10
    s_cbranch_execz p2_yc0_0
    ds_write_b32 v49, v51 offset:16
    v_add_u32 v51, 16, v51
    v_cmpx_lt_i32 vcc, 5, v10
    s_cbranch_execz p2_yc0_0
    ds_write_b32 v49, v51 offset:20
    v_add_u32 v51, 16, v51
    v_cmpx_lt_i32 vcc, 6, v10
    s_cbranch_execz p2_yc0_0
    ds_write_b32 v49, v51 offset:24
    v_add_u32 v51, 16, v51
    v_cmpx_lt_i32 vcc, 7, v10
    s_cbranch_execz p2_yc0_0
    ds_write_b32 v49, v51 offset:28
    v_add_u32 v51, 16, v51
    v_subrev_u32 v10, 8, v10
    v_add_u32 v49, 32, v49
    s_branch p2_xc0_0
p2_yc0_0:
    s_mov_b64 exec, -1
p2_xc0_1:
    v_cmpx_lt_i32 vcc, 0, v11
    s_cbranch_execz p2_yc0_1
    ds_write_b32 v50, v52 offset:0
    v_add_u32 v52, 16, v52
    v_cmpx_lt_i32 vcc, 1, v11
    s_cbranch_execz p2_yc0_1
    ds_write_b32 v50, v52 offset:4
    v_add_u32 v52, 16, v52
    v_cmpx_lt_i32 vcc, 2, v11
    s_cbranch_execz p2_yc0_1
    ds_write_b32 v50, v52 offset:8
    v_add_u32 v52, 16, v52
    v_cmpx_lt_i32 vcc, 3, v11
    s_cbranch_execz p2_yc0_1
    ds_write_b32 v50, v52 offset:12
    v_add_u32 v52, 16, v52
    v_cmpx_lt_i32 vcc, 4, v11
    s_cbranch_execz p2_yc0_1
    ds_write_b32 v50, v52 offset:16
    v_add_u32 v52, 16, v52
    v_cmpx_lt_i32 vcc, 5, v11
    s_cbranch_execz p2_yc0_1
    ds_write_b32 v50, v52 offset:20
    v_add_u32 v52, 16, v52
    v_cmpx_lt_i32 vcc, 6, v11
    s_cbranch_execz p2_yc0_1
    ds_write_b32 v50, v52 offset:24
    v_add_u32 v52, 16, v52
    v_cmpx_lt_i32 vcc, 7, v11
    s_cbranch_execz p2_yc0_1
    ds_write_b32 v50, v52 offset:28
    v_add_u32 v52, 16, v52
    v_subrev_u32 v11, 8, v11
    v_add_u32 v50, 32, v50
    s_branch p2_xc0_1
p2_yc0_1:
    s_mov_b64 exec, -1
    s_cmp_lt_u32 s38, 512
    s_cbranch_scc1 p2_nomorec0
    v_cmp_lt_u32_sdwa s[44:45], v86, v88 src0_sel:WORD_0 src1_sel:WORD_0
    v_cmp_lt_u32_sdwa s[46:47], v87, v89 src0_sel:WORD_0 src1_sel:WORD_0
    s_nop 0
    s_or_b64 s[44:45], s[44:45], s[46:47]
    s_cbranch_scc0 p2_nomorec0
    v_mov_b32 v49, s19
    v_mov_b32 v50, 1
    ds_write_b32 v49, v50 offset:53760
p2_nomorec0:
    ds_read_addtid_b32 v114 offset:0
    ds_read_addtid_b32 v115 offset:256
    v_lshlrev_b32_sdwa v122, 11, sext(v54) dst_sel:DWORD dst_unused:UNUSED_PAD src0_sel:DWORD src1_sel:WORD_0
    v_bfe_u32 v123, v54, 16, 14
    v_lshlrev_b32 v124, 16, v12
    v_bfi_b32 v122, v122, 0, s27
    v_and_b32 v125, s28, v12
    v_lshlrev_b32 v126, 16, v13
    v_mul_f32 v122, s26, v122
    v_and_b32 v127, s28, v13
    v_lshl_add_u32 v123, v123, 3, s25
    v_pk_fma_f32 v[124:125], v[124:125], v[122:123], s[34:35] op_sel_hi:[1,0,1]
    v_pk_fma_f32 v[126:127], v[126:127], v[122:123], s[34:35] op_sel_hi:[1,0,1]
    s_waitcnt lgkmcnt(11)
    v_pk_max_u16 v117, v117, v118
    v_lshl_add_u32 v124, v125, 16, v124
    v_lshl_add_u32 v125, v127, 16, v126
    v_pk_max_u16 v117, v117, v119
    v_lshl_add_u64 v[124:125], v[124:125], 0, s[36:37]
    v_cmpx_ne_u32_sdwa vcc, v54, 0 src0_sel:BYTE_1 src1_sel:DWORD
    ds_add_rtn_u64 v[118:119], v123, v[124:125]
    s_mov_b64 exec, -1
    v_lshlrev_b32_sdwa v122, 11, sext(v55) dst_sel:DWORD dst_unused:UNUSED_PAD src0_sel:DWORD src1_sel:WORD_0
    v_bfe_u32 v123, v55, 16, 14
    v_lshlrev_b32 v124, 16, v14
    v_bfi_b32 v122, v122, 0, s27
    v_and_b32 v125, s28, v14
    v_lshlrev_b32 v126, 16, v15
    v_mul_f32 v122, s26, v122
    v_and_b32 v127, s28, v15
    v_lshl_add_u32 v123, v123, 3, s25
    v_pk_fma_f32 v[124:125], v[124:125], v[122:123], s[34:35] op_sel_hi:[1,0,1]
    v_pk_fma_f32 v[126:127], v[126:127], v[122:123], s[34:35] op_sel_hi:[1,0,1]
    s_waitcnt lgkmcnt(11)
    v_pk_max_u16 v117, v117, v120
    v_lshl_add_u32 v124, v125, 16, v124
    v_lshl_add_u32 v125, v127, 16, v126
    v_pk_max_u16 v117, v117, v121
    v_lshl_add_u64 v[124:125], v[124:125], 0, s[36:37]
    v_cmpx_ne_u32_sdwa vcc, v55, 0 src0_sel:BYTE_1 src1_sel:DWORD
    ds_add_rtn_u64 v[120:121], v123, v[124:125]
    s_mov_b64 exec, -1
    v_lshlrev_b32_sdwa v122, 11, sext(v56) dst_sel:DWORD dst_unused:UNUSED_PAD src0_sel:DWORD src1_sel:WORD_0
    v_bfe_u32 v123, v56, 16, 14
    v_lshlrev_b32 v124, 16, v16
    v_bfi_b32 v122, v122, 0, s27
    v_and_b32 v125, s28, v16
    v_lshlrev_b32 v126, 16, v17
    v_mul_f32 v122, s26, v122
    v_and_b32 v127, s28, v17
    v_lshl_add_u32 v123, v123, 3, s25
    v_pk_fma_f32 v[124:125], v[124:125], v[122:123], s[34:35] op_sel_hi:[1,0,1]
    v_pk_fma_f32 v[126:127], v[126:127], v[122:123], s[34:35] op_sel_hi:[1,0,1]
    s_waitcnt lgkmcnt(1)
    v_pk_max_u16 v117, v117, v118
    v_lshl_add_u32 v124, v125, 16, v124
    v_lshl_add_u32 v125, v127, 16, v126
    v_pk_max_u16 v117, v117, v119
    v_lshl_add_u64 v[124:125], v[124:125], 0, s[36:37]
    v_cmpx_ne_u32_sdwa vcc, v56, 0 src0_sel:BYTE_1 src1_sel:DWORD
    ds_add_rtn_u64 v[118:119], v123, v[124:125]
    s_mov_b64 exec, -1
    s_setprio 0
    s_waitcnt vmcnt(16)
    v_perm_b32 v54, v93, v90, s31
    v_perm_b32 v55, v93, v91, s32
    v_perm_b32 v56, v93, v92, s33
    v_lshlrev_b16 v16, 3, v92
    v_lshlrev_b16 v14, 3, v91
    v_lshlrev_b16 v12, 3, v90
    ds_read_addtid_b32 v90 offset:512
    v_lshlrev_b32_sdwa v122, 11, sext(v57) dst_sel:DWORD dst_unused:UNUSED_PAD src0_sel:DWORD src1_sel:WORD_0
    v_bfe_u32 v123, v57, 16, 14
    v_lshlrev_b32 v124, 16, v18
    v_bfi_b32 v122, v122, 0, s27
    v_and_b32 v125, s28, v18
    v_lshlrev_b32 v126, 16, v19
    v_mul_f32 v122, s26, v122
    v_and_b32 v127, s28, v19
    v_lshl_add_u32 v123, v123, 3, s25
    v_pk_fma_f32 v[124:125], v[124:125], v[122:123], s[34:35] op_sel_hi:[1,0,1]
    v_pk_fma_f32 v[126:127], v[126:127], v[122:123], s[34:35] op_sel_hi:[1,0,1]
    s_waitcnt lgkmcnt(2)
    v_pk_max_u16 v117, v117, v120
    v_lshl_add_u32 v124, v125, 16, v124
    v_lshl_add_u32 v125, v127, 16, v126
    v_pk_max_u16 v117, v117, v121
    v_lshl_add_u64 v[124:125], v[124:125], 0, s[36:37]
    v_cmpx_ne_u32_sdwa vcc, v57, 0 src0_sel:BYTE_1 src1_sel:DWORD
    ds_add_rtn_u64 v[120:121], v123, v[124:125]
    s_mov_b64 exec, -1
    v_lshlrev_b32_sdwa v122, 11, sext(v58) dst_sel:DWORD dst_unused:UNUSED_PAD src0_sel:DWORD src1_sel:WORD_0
    v_bfe_u32 v123, v58, 16, 14
    v_lshlrev_b32 v124, 16, v20
    v_bfi_b32 v122, v122, 0, s27
    v_and_b32 v125, s28, v20
    v_lshlrev_b32 v126, 16, v21
    v_mul_f32 v122, s26, v122
    v_and_b32 v127, s28, v21
    v_lshl_add_u32 v123, v123, 3, s25
    v_pk_fma_f32 v[124:125], v[124:125], v[122:123], s[34:35] op_sel_hi:[1,0,1]
    v_pk_fma_f32 v[126:127], v[126:127], v[122:123], s[34:35] op_sel_hi:[1,0,1]
    s_waitcnt lgkmcnt(2)
    v_pk_max_u16 v117, v117, v118
    v_lshl_add_u32 v124, v125, 16, v124
    v_lshl_add_u32 v125, v127, 16, v126
    v_pk_max_u16 v117, v117, v119
    v_lshl_add_u64 v[124:125], v[124:125], 0, s[36:37]
    v_cmpx_ne_u32_sdwa vcc, v58, 0 src0_sel:BYTE_1 src1_sel:DWORD
    ds_add_rtn_u64 v[118:119], v123, v[124:125]
    s_mov_b64 exec, -1
    v_lshlrev_b32_sdwa v122, 11, sext(v59) dst_sel:DWORD dst_unused:UNUSED_PAD src0_sel:DWORD src1_sel:WORD_0
    v_bfe_u32 v123, v59, 16, 14
    v_lshlrev_b32 v124, 16, v22
    v_bfi_b32 v122, v122, 0, s27
    v_and_b32 v125, s28, v22
    v_lshlrev_b32 v126, 16, v23
    v_mul_f32 v122, s26, v122
    v_and_b32 v127, s28, v23
    v_lshl_add_u32 v123, v123, 3, s25
    v_pk_fma_f32 v[124:125], v[124:125], v[122:123], s[34:35] op_sel_hi:[1,0,1]
    v_pk_fma_f32 v[126:127], v[126:127], v[122:123], s[34:35] op_sel_hi:[1,0,1]
    s_waitcnt lgkmcnt(1)
    v_pk_max_u16 v117, v117, v120
    v_lshl_add_u32 v124, v125, 16, v124
    v_lshl_add_u32 v125, v127, 16, v126
    v_pk_max_u16 v117, v117, v121
    v_lshl_add_u64 v[124:125], v[124:125], 0, s[36:37]
    v_cmpx_ne_u32_sdwa vcc, v59, 0 src0_sel:BYTE_1 src1_sel:DWORD
    ds_add_rtn_u64 v[120:121], v123, v[124:125]
    s_mov_b64 exec, -1
    s_waitcnt vmcnt(15)
    v_perm_b32 v57, v97, v94, s31
    v_perm_b32 v58, v97, v95, s32
    v_perm_b32 v59, v97, v96, s33
    v_lshlrev_b16 v22, 3, v96
    v_lshlrev_b16 v20, 3, v95
    v_lshlrev_b16 v18, 3, v94
    ds_read_addtid_b32 v94 offset:768
    v_lshlrev_b32_sdwa v122, 11, sext(v60) dst_sel:DWORD dst_unused:UNUSED_PAD src0_sel:DWORD src1_sel:WORD_0
    v_bfe_u32 v123, v60, 16, 14
    v_lshlrev_b32 v124, 16, v24
    v_bfi_b32 v122, v122, 0, s27
    v_and_b32 v125, s28, v24
    v_lshlrev_b32 v126, 16, v25
    v_mul_f32 v122, s26, v122
    v_and_b32 v127, s28, v25
    v_lshl_add_u32 v123, v123, 3, s25
    v_pk_fma_f32 v[124:125], v[124:125], v[122:123], s[34:35] op_sel_hi:[1,0,1]
    v_pk_fma_f32 v[126:127], v[126:127], v[122:123], s[34:35] op_sel_hi:[1,0,1]
    s_waitcnt lgkmcnt(2)
    v_pk_max_u16 v117, v117, v118
    v_lshl_add_u32 v124, v125, 16, v124
    v_lshl_add_u32 v125, v127, 16, v126
    v_pk_max_u16 v117, v117, v119
    v_lshl_add_u64 v[124:125], v[124:125], 0, s[36:37]
    v_cmpx_ne_u32_sdwa vcc, v60, 0 src0_sel:BYTE_1 src1_sel:DWORD
    ds_add_rtn_u64 v[118:119], v123, v[124:125]
    s_mov_b64 exec, -1
    v_lshlrev_b32_sdwa v122, 11, sext(v61) dst_sel:DWORD dst_unused:UNUSED_PAD src0_sel:DWORD src1_sel:WORD_0
    v_bfe_u32 v123, v61, 16, 14
    v_lshlrev_b32 v124, 16, v26
    v_bfi_b32 v122, v122, 0, s27
    v_and_b32 v125, s28, v26
    v_lshlrev_b32 v126, 16, v27
    v_mul_f32 v122, s26, v122
    v_and_b32 v127, s28, v27
    v_lshl_add_u32 v123, v123, 3, s25
    v_pk_fma_f32 v[124:125], v[124:125], v[122:123], s[34:35] op_sel_hi:[1,0,1]
    v_pk_fma_f32 v[126:127], v[126:127], v[122:123], s[34:35] op_sel_hi:[1,0,1]
    s_waitcnt lgkmcnt(2)
    v_pk_max_u16 v117, v117, v120
    v_lshl_add_u32 v124, v125, 16, v124
    v_lshl_add_u32 v125, v127, 16, v126
    v_pk_max_u16 v117, v117, v121
    v_lshl_add_u64 v[124:125], v[124:125], 0, s[36:37]
    v_cmpx_ne_u32_sdwa vcc, v61, 0 src0_sel:BYTE_1 src1_sel:DWORD
    ds_add_rtn_u64 v[120:121], v123, v[124:125]
    s_mov_b64 exec, -1
    v_lshlrev_b32_sdwa v122, 11, sext(v62) dst_sel:DWORD dst_unused:UNUSED_PAD src0_sel:DWORD src1_sel:WORD_0
    v_bfe_u32 v123, v62, 16, 14
    v_lshlrev_b32 v124, 16, v28
    v_bfi_b32 v122, v122, 0, s27
    v_and_b32 v125, s28, v28
    v_lshlrev_b32 v126, 16, v29
    v_mul_f32 v122, s26, v122
    v_and_b32 v127, s28, v29
    v_lshl_add_u32 v123, v123, 3, s25
    v_pk_fma_f32 v[124:125], v[124:125], v[122:123], s[34:35] op_sel_hi:[1,0,1]
    v_pk_fma_f32 v[126:127], v[126:127], v[122:123], s[34:35] op_sel_hi:[1,0,1]
    s_waitcnt lgkmcnt(1)
    v_pk_max_u16 v117, v117, v118
    v_lshl_add_u32 v124, v125, 16, v124
    v_lshl_add_u32 v125, v127, 16, v126
    v_pk_max_u16 v117, v117, v119
    v_lshl_add_u64 v[124:125], v[124:125], 0, s[36:37]
    v_cmpx_ne_u32_sdwa vcc, v62, 0 src0_sel:BYTE_1 src1_sel:DWORD
    ds_add_rtn_u64 v[118:119], v123, v[124:125]
    s_mov_b64 exec, -1
    s_waitcnt vmcnt(11)
    v_perm_b32 v60, v101, v98, s31
    v_perm_b32 v61, v101, v99, s32
    v_perm_b32 v62, v101, v100, s33
    v_lshlrev_b16 v28, 3, v100
    v_lshlrev_b16 v26, 3, v99
    v_lshlrev_b16 v24, 3, v98
    ds_read_addtid_b32 v98 offset:1024
    v_lshlrev_b32_sdwa v122, 11, sext(v63) dst_sel:DWORD dst_unused:UNUSED_PAD src0_sel:DWORD src1_sel:WORD_0
    v_bfe_u32 v123, v63, 16, 14
    v_lshlrev_b32 v124, 16, v30
    v_bfi_b32 v122, v122, 0, s27
    v_and_b32 v125, s28, v30
    v_lshlrev_b32 v126, 16, v31
    v_mul_f32 v122, s26, v122
    v_and_b32 v127, s28, v31
    v_lshl_add_u32 v123, v123, 3, s25
    v_pk_fma_f32 v[124:125], v[124:125], v[122:123], s[34:35] op_sel_hi:[1,0,1]
    v_pk_fma_f32 v[126:127], v[126:127], v[122:123], s[34:35] op_sel_hi:[1,0,1]
    s_waitcnt lgkmcnt(2)
    v_pk_max_u16 v117, v117, v120
    v_lshl_add_u32 v124, v125, 16, v124
    v_lshl_add_u32 v125, v127, 16, v126
    v_pk_max_u16 v117, v117, v121
    v_lshl_add_u64 v[124:125], v[124:125], 0, s[36:37]
    v_cmpx_ne_u32_sdwa vcc, v63, 0 src0_sel:BYTE_1 src1_sel:DWORD
    ds_add_rtn_u64 v[120:121], v123, v[124:125]
    s_mov_b64 exec, -1
    v_lshlrev_b32_sdwa v122, 11, sext(v64) dst_sel:DWORD dst_unused:UNUSED_PAD src0_sel:DWORD src1_sel:WORD_0
    v_bfe_u32 v123, v64, 16, 14
    v_lshlrev_b32 v124, 16, v32
    v_bfi_b32 v122, v122, 0, s27
    v_and_b32 v125, s28, v32
    v_lshlrev_b32 v126, 16, v33
    v_mul_f32 v122, s26, v122
    v_and_b32 v127, s28, v33
    v_lshl_add_u32 v123, v123, 3, s25
    v_pk_fma_f32 v[124:125], v[124:125], v[122:123], s[34:35] op_sel_hi:[1,0,1]
    v_pk_fma_f32 v[126:127], v[126:127], v[122:123], s[34:35] op_sel_hi:[1,0,1]
    s_waitcnt lgkmcnt(2)
    v_pk_max_u16 v117, v117, v118
    v_lshl_add_u32 v124, v125, 16, v124
    v_lshl_add_u32 v125, v127, 16, v126
    v_pk_max_u16 v117, v117, v119
    v_lshl_add_u64 v[124:125], v[124:125], 0, s[36:37]
    v_cmpx_ne_u32_sdwa vcc, v64, 0 src0_sel:BYTE_1 src1_sel:DWORD
    ds_add_rtn_u64 v[118:119], v123, v[124:125]
    s_mov_b64 exec, -1
    v_lshlrev_b32_sdwa v122, 11, sext(v65) dst_sel:DWORD dst_unused:UNUSED_PAD src0_sel:DWORD src1_sel:WORD_0
    v_bfe_u32 v123, v65, 16, 14
    v_lshlrev_b32 v124, 16, v34
    v_bfi_b32 v122, v122, 0, s27
    v_and_b32 v125, s28, v34
    v_lshlrev_b32 v126, 16, v35
    v_mul_f32 v122, s26, v122
    v_and_b32 v127, s28, v35
    v_lshl_add_u32 v123, v123, 3, s25
    v_pk_fma_f32 v[124:125], v[124:125], v[122:123], s[34:35] op_sel_hi:[1,0,1]
    v_pk_fma_f32 v[126:127], v[126:127], v[122:123], s[34:35] op_sel_hi:[1,0,1]
    s_waitcnt lgkmcnt(1)
    v_pk_max_u16 v117, v117, v120
    v_lshl_add_u32 v124, v125, 16, v124
    v_lshl_add_u32 v125, v127, 16, v126
    v_pk_max_u16 v117, v117, v121
    v_lshl_add_u64 v[124:125], v[124:125], 0, s[36:37]
    v_cmpx_ne_u32_sdwa vcc, v65, 0 src0_sel:BYTE_1 src1_sel:DWORD
    ds_add_rtn_u64 v[120:121], v123, v[124:125]
    s_mov_b64 exec, -1
    s_waitcnt vmcnt(7)
    v_perm_b32 v63, v105, v102, s31
    v_perm_b32 v64, v105, v103, s32
    v_perm_b32 v65, v105, v104, s33
    v_lshlrev_b16 v34, 3, v104
    v_lshlrev_b16 v32, 3, v103
    v_lshlrev_b16 v30, 3, v102
    ds_read_addtid_b32 v102 offset:1280
    s_waitcnt lgkmcnt(12)
    buffer_load_dwordx4 v[90:93], v90, s[4:7], 0 offen
    v_lshlrev_b32_sdwa v122, 11, sext(v66) dst_sel:DWORD dst_unused:UNUSED_PAD src0_sel:DWORD src1_sel:WORD_0
    v_bfe_u32 v123, v66, 16, 14
    v_lshlrev_b32 v124, 16, v36
    v_bfi_b32 v122, v122, 0, s27
    v_and_b32 v125, s28, v36
    v_lshlrev_b32 v126, 16, v37
    v_mul_f32 v122, s26, v122
    v_and_b32 v127, s28, v37
    v_lshl_add_u32 v123, v123, 3, s25
    v_pk_fma_f32 v[124:125], v[124:125], v[122:123], s[34:35] op_sel_hi:[1,0,1]
    v_pk_fma_f32 v[126:127], v[126:127], v[122:123], s[34:35] op_sel_hi:[1,0,1]
    s_waitcnt lgkmcnt(2)
    v_pk_max_u16 v117, v117, v118
    v_lshl_add_u32 v124, v125, 16, v124
    v_lshl_add_u32 v125, v127, 16, v126
    v_pk_max_u16 v117, v117, v119
    v_lshl_add_u64 v[124:125], v[124:125], 0, s[36:37]
    v_cmpx_ne_u32_sdwa vcc, v66, 0 src0_sel:BYTE_1 src1_sel:DWORD
    ds_add_rtn_u64 v[118:119], v123, v[124:125]
    s_mov_b64 exec, -1
    v_lshlrev_b32_sdwa v122, 11, sext(v67) dst_sel:DWORD dst_unused:UNUSED_PAD src0_sel:DWORD src1_sel:WORD_0
    v_bfe_u32 v123, v67, 16, 14
    v_lshlrev_b32 v124, 16, v38
    v_bfi_b32 v122, v122, 0, s27
    v_and_b32 v125, s28, v38
    v_lshlrev_b32 v126, 16, v39
    v_mul_f32 v122, s26, v122
    v_and_b32 v127, s28, v39
    v_lshl_add_u32 v123, v123, 3, s25
    v_pk_fma_f32 v[124:125], v[124:125], v[122:123], s[34:35] op_sel_hi:[1,0,1]
    v_pk_fma_f32 v[126:127], v[126:127], v[122:123], s[34:35] op_sel_hi:[1,0,1]
    s_waitcnt lgkmcnt(2)
    v_pk_max_u16 v117, v117, v120
    v_lshl_add_u32 v124, v125, 16, v124
    v_lshl_add_u32 v125, v127, 16, v126
    v_pk_max_u16 v117, v117, v121
    v_lshl_add_u64 v[124:125], v[124:125], 0, s[36:37]
    v_cmpx_ne_u32_sdwa vcc, v67, 0 src0_sel:BYTE_1 src1_sel:DWORD
    ds_add_rtn_u64 v[120:121], v123, v[124:125]
    s_mov_b64 exec, -1
    v_lshlrev_b32_sdwa v122, 11, sext(v68) dst_sel:DWORD dst_unused:UNUSED_PAD src0_sel:DWORD src1_sel:WORD_0
    v_bfe_u32 v123, v68, 16, 14
    v_lshlrev_b32 v124, 16, v40
    v_bfi_b32 v122, v122, 0, s27
    v_and_b32 v125, s28, v40
    v_lshlrev_b32 v126, 16, v41
    v_mul_f32 v122, s26, v122
    v_and_b32 v127, s28, v41
    v_lshl_add_u32 v123, v123, 3, s25
    v_pk_fma_f32 v[124:125], v[124:125], v[122:123], s[34:35] op_sel_hi:[1,0,1]
    v_pk_fma_f32 v[126:127], v[126:127], v[122:123], s[34:35] op_sel_hi:[1,0,1]
    s_waitcnt lgkmcnt(1)
    v_pk_max_u16 v117, v117, v118
    v_lshl_add_u32 v124, v125, 16, v124
    v_lshl_add_u32 v125, v127, 16, v126
    v_pk_max_u16 v117, v117, v119
    v_lshl_add_u64 v[124:125], v[124:125], 0, s[36:37]
    v_cmpx_ne_u32_sdwa vcc, v68, 0 src0_sel:BYTE_1 src1_sel:DWORD
    ds_add_rtn_u64 v[118:119], v123, v[124:125]
    s_mov_b64 exec, -1
    s_waitcnt vmcnt(4)
    v_perm_b32 v66, v109, v106, s31
    v_perm_b32 v67, v109, v107, s32
    v_perm_b32 v68, v109, v108, s33
    v_lshlrev_b16 v40, 3, v108
    v_lshlrev_b16 v38, 3, v107
    v_lshlrev_b16 v36, 3, v106
    ds_read_addtid_b32 v106 offset:1536
    s_cmp_le_u32 s15, 7
    s_cbranch_scc1 p2_na0
    v_lshlrev_b32_sdwa v122, 11, sext(v69) dst_sel:DWORD dst_unused:UNUSED_PAD src0_sel:DWORD src1_sel:WORD_0
    v_bfe_u32 v123, v69, 16, 14
    v_lshlrev_b32 v124, 16, v42
    v_bfi_b32 v122, v122, 0, s27
    v_and_b32 v125, s28, v42
    v_lshlrev_b32 v126, 16, v43
    v_mul_f32 v122, s26, v122
    v_and_b32 v127, s28, v43
    v_lshl_add_u32 v123, v123, 3, s25
    v_pk_fma_f32 v[124:125], v[124:125], v[122:123], s[34:35] op_sel_hi:[1,0,1]
    v_pk_fma_f32 v[126:127], v[126:127], v[122:123], s[34:35] op_sel_hi:[1,0,1]
    s_waitcnt lgkmcnt(2)
    v_pk_max_u16 v117, v117, v120
    v_lshl_add_u32 v124, v125, 16, v124
    v_lshl_add_u32 v125, v127, 16, v126
    v_pk_max_u16 v117, v117, v121
    v_lshl_add_u64 v[124:125], v[124:125], 0, s[36:37]
    v_cmpx_ne_u32_sdwa vcc, v69, 0 src0_sel:BYTE_1 src1_sel:DWORD
    ds_add_rtn_u64 v[120:121], v123, v[124:125]
    s_mov_b64 exec, -1
    v_lshlrev_b32_sdwa v122, 11, sext(v70) dst_sel:DWORD dst_unused:UNUSED_PAD src0_sel:DWORD src1_sel:WORD_0
    v_bfe_u32 v123, v70, 16, 14
    v_lshlrev_b32 v124, 16, v44
    v_bfi_b32 v122, v122, 0, s27
    v_and_b32 v125, s28, v44
    v_lshlrev_b32 v126, 16, v45
    v_mul_f32 v122, s26, v122
    v_and_b32 v127, s28, v45
    v_lshl_add_u32 v123, v123, 3, s25
    v_pk_fma_f32 v[124:125], v[124:125], v[122:123], s[34:35] op_sel_hi:[1,0,1]
    v_pk_fma_f32 v[126:127], v[126:127], v[122:123], s[34:35] op_sel_hi:[1,0,1]
    s_waitcnt lgkmcnt(2)
    v_pk_max_u16 v117, v117, v118
    v_lshl_add_u32 v124, v125, 16, v124
    v_lshl_add_u32 v125, v127, 16, v126
    v_pk_max_u16 v117, v117, v119
    v_lshl_add_u64 v[124:125], v[124:125], 0, s[36:37]
    v_cmpx_ne_u32_sdwa vcc, v70, 0 src0_sel:BYTE_1 src1_sel:DWORD
    ds_add_rtn_u64 v[118:119], v123, v[124:125]
    s_mov_b64 exec, -1
    v_lshlrev_b32_sdwa v122, 11, sext(v71) dst_sel:DWORD dst_unused:UNUSED_PAD src0_sel:DWORD src1_sel:WORD_0
    v_bfe_u32 v123, v71, 16, 14
    v_lshlrev_b32 v124, 16, v46
    v_bfi_b32 v122, v122, 0, s27
    v_and_b32 v125, s28, v46
    v_lshlrev_b32 v126, 16, v47
    v_mul_f32 v122, s26, v122
    v_and_b32 v127, s28, v47
    v_lshl_add_u32 v123, v123, 3, s25
    v_pk_fma_f32 v[124:125], v[124:125], v[122:123], s[34:35] op_sel_hi:[1,0,1]
    v_pk_fma_f32 v[126:127], v[126:127], v[122:123], s[34:35] op_sel_hi:[1,0,1]
    s_waitcnt lgkmcnt(1)
    v_pk_max_u16 v117, v117, v120
    v_lshl_add_u32 v124, v125, 16, v124
    v_lshl_add_u32 v125, v127, 16, v126
    v_pk_max_u16 v117, v117, v121
    v_lshl_add_u64 v[124:125], v[124:125], 0, s[36:37]
    v_cmpx_ne_u32_sdwa vcc, v71, 0 src0_sel:BYTE_1 src1_sel:DWORD
    ds_add_rtn_u64 v[120:121], v123, v[124:125]
    s_mov_b64 exec, -1
p2_na0:
    s_waitcnt vmcnt(3)
    v_perm_b32 v69, v113, v110, s31
    v_perm_b32 v70, v113, v111, s32
    v_perm_b32 v71, v113, v112, s33
    v_lshlrev_b16 v46, 3, v112
    v_lshlrev_b16 v44, 3, v111
    v_lshlrev_b16 v42, 3, v110
    ds_read_addtid_b32 v110 offset:1792
    s_waitcnt lgkmcnt(0)
    v_pk_max_u16 v117, v117, v118
    v_pk_max_u16 v117, v117, v119
    v_pk_max_u16 v117, v117, v120
    v_pk_max_u16 v117, v117, v121
    s_branch p2_added
p2_addf:
    v_lshlrev_b32_sdwa v122, 11, sext(v48) dst_sel:DWORD dst_unused:UNUSED_PAD src0_sel:DWORD src1_sel:WORD_0
    v_bfe_u32 v123, v48, 16, 14
    v_cndmask_b32 v126, v0, v1, s[66:67]
    v_bfi_b32 v122, v122, 0, s27
    v_lshlrev_b32 v124, 16, v126
    v_mul_f32 v122, s26, v122
    v_and_b32 v125, s28, v126
    v_lshl_add_u32 v123, v123, 3, s25
    v_mul_f32 v124, v122, v124
    v_mul_f32 v125, v122, v125
    v_cmpx_ne_u32_sdwa vcc, v48, 0 src0_sel:BYTE_1 src1_sel:DWORD
    ds_add_f32 v123, v124 offset:0
    ds_add_f32 v123, v125 offset:4
    s_mov_b64 exec, -1
    v_lshlrev_b32_sdwa v122, 11, sext(v49) dst_sel:DWORD dst_unused:UNUSED_PAD src0_sel:DWORD src1_sel:WORD_0
    v_bfe_u32 v123, v49, 16, 14
    v_cndmask_b32 v126, v2, v3, s[66:67]
    v_bfi_b32 v122, v122, 0, s27
    v_lshlrev_b32 v124, 16, v126
    v_mul_f32 v122, s26, v122
    v_and_b32 v125, s28, v126
    v_lshl_add_u32 v123, v123, 3, s25
    v_mul_f32 v124, v122, v124
    v_mul_f32 v125, v122, v125
    v_cmpx_ne_u32_sdwa vcc, v49, 0 src0_sel:BYTE_1 src1_sel:DWORD
    ds_add_f32 v123, v124 offset:0
    ds_add_f32 v123, v125 offset:4
    s_mov_b64 exec, -1
    v_lshlrev_b32_sdwa v122, 11, sext(v50) dst_sel:DWORD dst_unused:UNUSED_PAD src0_sel:DWORD src1_sel:WORD_0
    v_bfe_u32 v123, v50, 16, 14
    v_cndmask_b32 v126, v4, v5, s[66:67]
    v_bfi_b32 v122, v122, 0, s27
    v_lshlrev_b32 v124, 16, v126
    v_mul_f32 v122, s26, v122
    v_and_b32 v125, s28, v126
    v_lshl_add_u32 v123, v123, 3, s25
    v_mul_f32 v124, v122, v124
    v_mul_f32 v125, v122, v125
    v_cmpx_ne_u32_sdwa vcc, v50, 0 src0_sel:BYTE_1 src1_sel:DWORD
    ds_add_f32 v123, v124 offset:0
    ds_add_f32 v123, v125 offset:4
    s_mov_b64 exec, -1
    buffer_load_dwordx4 v[0:3], v114, s[4:7], 0 offen
    v_lshlrev_b32_sdwa v122, 11, sext(v51) dst_sel:DWORD dst_unused:UNUSED_PAD src0_sel:DWORD src1_sel:WORD_0
    v_bfe_u32 v123, v51, 16, 14
    v_cndmask_b32 v126, v6, v7, s[66:67]
    v_bfi_b32 v122, v122, 0, s27
    v_lshlrev_b32 v124, 16, v126
    v_mul_f32 v122, s26, v122
    v_and_b32 v125, s28, v126
    v_lshl_add_u32 v123, v123, 3, s25
    v_mul_f32 v124, v122, v124
    v_mul_f32 v125, v122, v125
    v_cmpx_ne_u32_sdwa vcc, v51, 0 src0_sel:BYTE_1 src1_sel:DWORD
    ds_add_f32 v123, v124 offset:0
    ds_add_f32 v123, v125 offset:4
    s_mov_b64 exec, -1
    v_lshlrev_b32_sdwa v122, 11, sext(v52) dst_sel:DWORD dst_unused:UNUSED_PAD src0_sel:DWORD src1_sel:WORD_0
    v_bfe_u32 v123, v52, 16, 14
    v_cndmask_b32 v126, v8, v9, s[66:67]
    v_bfi_b32 v122, v122, 0, s27
    v_lshlrev_b32 v124, 16, v126
    v_mul_f32 v122, s26, v122
    v_and_b32 v125, s28, v126
    v_lshl_add_u32 v123, v123, 3, s25
    v_mul_f32 v124, v122, v124
    v_mul_f32 v125, v122, v125
    v_cmpx_ne_u32_sdwa vcc, v52, 0 src0_sel:BYTE_1 src1_sel:DWORD
    ds_add_f32 v123, v124 offset:0
    ds_add_f32 v123, v125 offset:4
    s_mov_b64 exec, -1
    v_lshlrev_b32_sdwa v122, 11, sext(v53) dst_sel:DWORD dst_unused:UNUSED_PAD src0_sel:DWORD src1_sel:WORD_0
    v_bfe_u32 v123, v53, 16, 14
    v_cndmask_b32 v126, v10, v11, s[66:67]
    v_bfi_b32 v122, v122, 0, s27
    v_lshlrev_b32 v124, 16, v126
    v_mul_f32 v122, s26, v122
    v_and_b32 v125, s28, v126
    v_lshl_add_u32 v123, v123, 3, s25
    v_mul_f32 v124, v122, v124
    v_mul_f32 v125, v122, v125
    v_cmpx_ne_u32_sdwa vcc, v53, 0 src0_sel:BYTE_1 src1_sel:DWORD
    ds_add_f32 v123, v124 offset:0
    ds_add_f32 v123, v125 offset:4
    s_mov_b64 exec, -1
    buffer_load_dwordx4 v[6:9], v115, s[4:7], 0 offen
    s_mov_b32 m0, s23
    v_mov_b32 v53, 0x70000000
    s_movk_i32 s44, 512
    v_sub_u32_sdwa v4, v88, v86 dst_sel:DWORD dst_unused:UNUSED_PAD src0_sel:WORD_0 src1_sel:WORD_0
    v_sub_u32_sdwa v5, v89, v87 dst_sel:DWORD dst_unused:UNUSED_PAD src0_sel:WORD_0 src1_sel:WORD_0
    v_med3_i32 v4, v4, 0, s44
    v_med3_i32 v5, v5, 0, s44
    v_add_u32 v48, v4, v5
    ds_write_addtid_b32 v53 offset:0
    ds_write_addtid_b32 v53 offset:256
    ds_write_addtid_b32 v53 offset:512
    ds_write_addtid_b32 v53 offset:768
    ds_write_addtid_b32 v53 offset:1024
    ds_write_addtid_b32 v53 offset:1280
    ds_write_addtid_b32 v53 offset:1536
    ds_write_addtid_b32 v53 offset:1792
    v_mul_u32_u24 v53, 20096, v116
    v_add_u32 v53, s41, v53
    s_nop 1
    v_add_u32_dpp v48, v48, v48 row_shr:1 row_mask:0xf bank_mask:0xf bound_ctrl:0
    s_nop 1
    v_add_u32_dpp v48, v48, v48 row_shr:2 row_mask:0xf bank_mask:0xf bound_ctrl:0
    s_nop 1
    v_add_u32_dpp v48, v48, v48 row_shr:4 row_mask:0xf bank_mask:0xf bound_ctrl:0
    s_nop 1
    v_add_u32_dpp v48, v48, v48 row_shr:8 row_mask:0xf bank_mask:0xf bound_ctrl:0
    s_nop 1
    v_add_u32_dpp v48, v48, v48 row_bcast:15 row_mask:0xa bank_mask:0xf
    s_nop 1
    v_add_u32_dpp v48, v48, v48 row_bcast:31 row_mask:0xc bank_mask:0xf
    s_nop 1
    s_nop 0
    v_readlane_b32 s38, v48, 63
    v_sub_u32 v50, v48, v5
    v_sub_u32 v49, v50, v4
    v_sub_u32 v10, 512, v49
    v_mad_u32_u16 v51, v86, 16, v53
    v_med3_i32 v10, v10, 0, v4
    v_lshl_add_u32 v49, v49, 2, s23
    v_add_u32 v86, v86, v10
    v_sub_u32 v11, 512, v50
    v_mad_u32_u16 v52, v87, 16, v53
    v_med3_i32 v11, v11, 0, v5
    v_lshl_add_u32 v50, v50, 2, s23
    v_add_u32 v87, v87, v11
    v_add_u32 v52, 160768, v52
    s_min_u32 s17, s38, 512
    s_add_u32 s17, s17, 63
    s_lshr_b32 s17, s17, 6
p2_xc1_0:
    v_cmpx_lt_i32 vcc, 0, v10
    s_cbranch_execz p2_yc1_0
    ds_write_b32 v49, v51 offset:0
    v_add_u32 v51, 16, v51
    v_cmpx_lt_i32 vcc, 1, v10
    s_cbranch_execz p2_yc1_0
    ds_write_b32 v49, v51 offset:4
    v_add_u32 v51, 16, v51
    v_cmpx_lt_i32 vcc, 2, v10
    s_cbranch_execz p2_yc1_0
    ds_write_b32 v49, v51 offset:8
    v_add_u32 v51, 16, v51
    v_cmpx_lt_i32 vcc, 3, v10
    s_cbranch_execz p2_yc1_0
    ds_write_b32 v49, v51 offset:12
    v_add_u32 v51, 16, v51
    v_cmpx_lt_i32 vcc, 4, v10
    s_cbranch_execz p2_yc1_0
    ds_write_b32 v49, v51 offset:16
    v_add_u32 v51, 16, v51
    v_cmpx_lt_i32 vcc, 5, v10
    s_cbranch_execz p2_yc1_0
    ds_write_b32 v49, v51 offset:20
    v_add_u32 v51, 16, v51
    v_cmpx_lt_i32 vcc, 6, v10
    s_cbranch_execz p2_yc1_0
    ds_write_b32 v49, v51 offset:24
    v_add_u32 v51, 16, v51
    v_cmpx_lt_i32 vcc, 7, v10
    s_cbranch_execz p2_yc1_0
    ds_write_b32 v49, v51 offset:28
    v_add_u32 v51, 16, v51
    v_subrev_u32 v10, 8, v10
    v_add_u32 v49, 32, v49
    s_branch p2_xc1_0
p2_yc1_0:
    s_mov_b64 exec, -1
p2_xc1_1:
    v_cmpx_lt_i32 vcc, 0, v11
    s_cbranch_execz p2_yc1_1
    ds_write_b32 v50, v52 offset:0
    v_add_u32 v52, 16, v52
    v_cmpx_lt_i32 vcc, 1, v11
    s_cbranch_execz p2_yc1_1
    ds_write_b32 v50, v52 offset:4
    v_add_u32 v52, 16, v52
    v_cmpx_lt_i32 vcc, 2, v11
    s_cbranch_execz p2_yc1_1
    ds_write_b32 v50, v52 offset:8
    v_add_u32 v52, 16, v52
    v_cmpx_lt_i32 vcc, 3, v11
    s_cbranch_execz p2_yc1_1
    ds_write_b32 v50, v52 offset:12
    v_add_u32 v52, 16, v52
    v_cmpx_lt_i32 vcc, 4, v11
    s_cbranch_execz p2_yc1_1
    ds_write_b32 v50, v52 offset:16
    v_add_u32 v52, 16, v52
    v_cmpx_lt_i32 vcc, 5, v11
    s_cbranch_execz p2_yc1_1
    ds_write_b32 v50, v52 offset:20
    v_add_u32 v52, 16, v52
    v_cmpx_lt_i32 vcc, 6, v11
    s_cbranch_execz p2_yc1_1
    ds_write_b32 v50, v52 offset:24
    v_add_u32 v52, 16, v52
    v_cmpx_lt_i32 vcc, 7, v11
    s_cbranch_execz p2_yc1_1
    ds_write_b32 v50, v52 offset:28
    v_add_u32 v52, 16, v52
    v_subrev_u32 v11, 8, v11
    v_add_u32 v50, 32, v50
    s_branch p2_xc1_1
p2_yc1_1:
    s_mov_b64 exec, -1
    s_cmp_lt_u32 s38, 512
    s_cbranch_scc1 p2_nomorec1
    v_cmp_lt_u32_sdwa s[44:45], v86, v88 src0_sel:WORD_0 src1_sel:WORD_0
    v_cmp_lt_u32_sdwa s[46:47], v87, v89 src0_sel:WORD_0 src1_sel:WORD_0
    s_nop 0
    s_or_b64 s[44:45], s[44:45], s[46:47]
    s_cbranch_scc0 p2_nomorec1
    v_mov_b32 v49, s19
    v_mov_b32 v50, 1
    ds_write_b32 v49, v50 offset:53760
p2_nomorec1:
    ds_read_addtid_b32 v114 offset:0
    ds_read_addtid_b32 v115 offset:256
    v_lshlrev_b32_sdwa v122, 11, sext(v54) dst_sel:DWORD dst_unused:UNUSED_PAD src0_sel:DWORD src1_sel:WORD_0
    v_bfe_u32 v123, v54, 16, 14
    v_cndmask_b32 v126, v12, v13, s[66:67]
    v_bfi_b32 v122, v122, 0, s27
    v_lshlrev_b32 v124, 16, v126
    v_mul_f32 v122, s26, v122
    v_and_b32 v125, s28, v126
    v_lshl_add_u32 v123, v123, 3, s25
    v_mul_f32 v124, v122, v124
    v_mul_f32 v125, v122, v125
    v_cmpx_ne_u32_sdwa vcc, v54, 0 src0_sel:BYTE_1 src1_sel:DWORD
    ds_add_f32 v123, v124 offset:0
    ds_add_f32 v123, v125 offset:4
    s_mov_b64 exec, -1
    v_lshlrev_b32_sdwa v122, 11, sext(v55) dst_sel:DWORD dst_unused:UNUSED_PAD src0_sel:DWORD src1_sel:WORD_0
    v_bfe_u32 v123, v55, 16, 14
    v_cndmask_b32 v126, v14, v15, s[66:67]
    v_bfi_b32 v122, v122, 0, s27
    v_lshlrev_b32 v124, 16, v126
    v_mul_f32 v122, s26, v122
    v_and_b32 v125, s28, v126
    v_lshl_add_u32 v123, v123, 3, s25
    v_mul_f32 v124, v122, v124
    v_mul_f32 v125, v122, v125
    v_cmpx_ne_u32_sdwa vcc, v55, 0 src0_sel:BYTE_1 src1_sel:DWORD
    ds_add_f32 v123, v124 offset:0
    ds_add_f32 v123, v125 offset:4
    s_mov_b64 exec, -1
    v_lshlrev_b32_sdwa v122, 11, sext(v56) dst_sel:DWORD dst_unused:UNUSED_PAD src0_sel:DWORD src1_sel:WORD_0
    v_bfe_u32 v123, v56, 16, 14
    v_cndmask_b32 v126, v16, v17, s[66:67]
    v_bfi_b32 v122, v122, 0, s27
    v_lshlrev_b32 v124, 16, v126
    v_mul_f32 v122, s26, v122
    v_and_b32 v125, s28, v126
    v_lshl_add_u32 v123, v123, 3, s25
    v_mul_f32 v124, v122, v124
    v_mul_f32 v125, v122, v125
    v_cmpx_ne_u32_sdwa vcc, v56, 0 src0_sel:BYTE_1 src1_sel:DWORD
    ds_add_f32 v123, v124 offset:0
    ds_add_f32 v123, v125 offset:4
    s_mov_b64 exec, -1
    s_setprio 0
    s_waitcnt vmcnt(16)
    v_perm_b32 v54, v93, v90, s31
    v_perm_b32 v55, v93, v91, s32
    v_perm_b32 v56, v93, v92, s33
    v_lshlrev_b16 v16, 3, v92
    v_lshlrev_b16 v14, 3, v91
    v_lshlrev_b16 v12, 3, v90
    ds_read_addtid_b32 v90 offset:512
    v_lshlrev_b32_sdwa v122, 11, sext(v57) dst_sel:DWORD dst_unused:UNUSED_PAD src0_sel:DWORD src1_sel:WORD_0
    v_bfe_u32 v123, v57, 16, 14
    v_cndmask_b32 v126, v18, v19, s[66:67]
    v_bfi_b32 v122, v122, 0, s27
    v_lshlrev_b32 v124, 16, v126
    v_mul_f32 v122, s26, v122
    v_and_b32 v125, s28, v126
    v_lshl_add_u32 v123, v123, 3, s25
    v_mul_f32 v124, v122, v124
    v_mul_f32 v125, v122, v125
    v_cmpx_ne_u32_sdwa vcc, v57, 0 src0_sel:BYTE_1 src1_sel:DWORD
    ds_add_f32 v123, v124 offset:0
    ds_add_f32 v123, v125 offset:4
    s_mov_b64 exec, -1
    v_lshlrev_b32_sdwa v122, 11, sext(v58) dst_sel:DWORD dst_unused:UNUSED_PAD src0_sel:DWORD src1_sel:WORD_0
    v_bfe_u32 v123, v58, 16, 14
    v_cndmask_b32 v126, v20, v21, s[66:67]
    v_bfi_b32 v122, v122, 0, s27
    v_lshlrev_b32 v124, 16, v126
    v_mul_f32 v122, s26, v122
    v_and_b32 v125, s28, v126
    v_lshl_add_u32 v123, v123, 3, s25
    v_mul_f32 v124, v122, v124
    v_mul_f32 v125, v122, v125
    v_cmpx_ne_u32_sdwa vcc, v58, 0 src0_sel:BYTE_1 src1_sel:DWORD
    ds_add_f32 v123, v124 offset:0
    ds_add_f32 v123, v125 offset:4
    s_mov_b64 exec, -1
    v_lshlrev_b32_sdwa v122, 11, sext(v59) dst_sel:DWORD dst_unused:UNUSED_PAD src0_sel:DWORD src1_sel:WORD_0
    v_bfe_u32 v123, v59, 16, 14
    v_cndmask_b32 v126, v22, v23, s[66:67]
    v_bfi_b32 v122, v122, 0, s27
    v_lshlrev_b32 v124, 16, v126
    v_mul_f32 v122, s26, v122
    v_and_b32 v125, s28, v126
    v_lshl_add_u32 v123, v123, 3, s25
    v_mul_f32 v124, v122, v124
    v_mul_f32 v125, v122, v125
    v_cmpx_ne_u32_sdwa vcc, v59, 0 src0_sel:BYTE_1 src1_sel:DWORD
    ds_add_f32 v123, v124 offset:0
    ds_add_f32 v123, v125 offset:4
    s_mov_b64 exec, -1
    s_waitcnt vmcnt(15)
    v_perm_b32 v57, v97, v94, s31
    v_perm_b32 v58, v97, v95, s32
    v_perm_b32 v59, v97, v96, s33
    v_lshlrev_b16 v22, 3, v96
    v_lshlrev_b16 v20, 3, v95
    v_lshlrev_b16 v18, 3, v94
    ds_read_addtid_b32 v94 offset:768
    v_lshlrev_b32_sdwa v122, 11, sext(v60) dst_sel:DWORD dst_unused:UNUSED_PAD src0_sel:DWORD src1_sel:WORD_0
    v_bfe_u32 v123, v60, 16, 14
    v_cndmask_b32 v126, v24, v25, s[66:67]
    v_bfi_b32 v122, v122, 0, s27
    v_lshlrev_b32 v124, 16, v126
    v_mul_f32 v122, s26, v122
    v_and_b32 v125, s28, v126
    v_lshl_add_u32 v123, v123, 3, s25
    v_mul_f32 v124, v122, v124
    v_mul_f32 v125, v122, v125
    v_cmpx_ne_u32_sdwa vcc, v60, 0 src0_sel:BYTE_1 src1_sel:DWORD
    ds_add_f32 v123, v124 offset:0
    ds_add_f32 v123, v125 offset:4
    s_mov_b64 exec, -1
    v_lshlrev_b32_sdwa v122, 11, sext(v61) dst_sel:DWORD dst_unused:UNUSED_PAD src0_sel:DWORD src1_sel:WORD_0
    v_bfe_u32 v123, v61, 16, 14
    v_cndmask_b32 v126, v26, v27, s[66:67]
    v_bfi_b32 v122, v122, 0, s27
    v_lshlrev_b32 v124, 16, v126
    v_mul_f32 v122, s26, v122
    v_and_b32 v125, s28, v126
    v_lshl_add_u32 v123, v123, 3, s25
    v_mul_f32 v124, v122, v124
    v_mul_f32 v125, v122, v125
    v_cmpx_ne_u32_sdwa vcc, v61, 0 src0_sel:BYTE_1 src1_sel:DWORD
    ds_add_f32 v123, v124 offset:0
    ds_add_f32 v123, v125 offset:4
    s_mov_b64 exec, -1
    v_lshlrev_b32_sdwa v122, 11, sext(v62) dst_sel:DWORD dst_unused:UNUSED_PAD src0_sel:DWORD src1_sel:WORD_0
    v_bfe_u32 v123, v62, 16, 14
    v_cndmask_b32 v126, v28, v29, s[66:67]
    v_bfi_b32 v122, v122, 0, s27
    v_lshlrev_b32 v124, 16, v126
    v_mul_f32 v122, s26, v122
    v_and_b32 v125, s28, v126
    v_lshl_add_u32 v123, v123, 3, s25
    v_mul_f32 v124, v122, v124
    v_mul_f32 v125, v122, v125
    v_cmpx_ne_u32_sdwa vcc, v62, 0 src0_sel:BYTE_1 src1_sel:DWORD
    ds_add_f32 v123, v124 offset:0
    ds_add_f32 v123, v125 offset:4
    s_mov_b64 exec, -1
    s_waitcnt vmcnt(11)
    v_perm_b32 v60, v101, v98, s31
    v_perm_b32 v61, v101, v99, s32
    v_perm_b32 v62, v101, v100, s33
    v_lshlrev_b16 v28, 3, v100
    v_lshlrev_b16 v26, 3, v99
    v_lshlrev_b16 v24, 3, v98
    ds_read_addtid_b32 v98 offset:1024
    v_lshlrev_b32_sdwa v122, 11, sext(v63) dst_sel:DWORD dst_unused:UNUSED_PAD src0_sel:DWORD src1_sel:WORD_0
    v_bfe_u32 v123, v63, 16, 14
    v_cndmask_b32 v126, v30, v31, s[66:67]
    v_bfi_b32 v122, v122, 0, s27
    v_lshlrev_b32 v124, 16, v126
    v_mul_f32 v122, s26, v122
    v_and_b32 v125, s28, v126
    v_lshl_add_u32 v123, v123, 3, s25
    v_mul_f32 v124, v122, v124
    v_mul_f32 v125, v122, v125
    v_cmpx_ne_u32_sdwa vcc, v63, 0 src0_sel:BYTE_1 src1_sel:DWORD
    ds_add_f32 v123, v124 offset:0
    ds_add_f32 v123, v125 offset:4
    s_mov_b64 exec, -1
    v_lshlrev_b32_sdwa v122, 11, sext(v64) dst_sel:DWORD dst_unused:UNUSED_PAD src0_sel:DWORD src1_sel:WORD_0
    v_bfe_u32 v123, v64, 16, 14
    v_cndmask_b32 v126, v32, v33, s[66:67]
    v_bfi_b32 v122, v122, 0, s27
    v_lshlrev_b32 v124, 16, v126
    v_mul_f32 v122, s26, v122
    v_and_b32 v125, s28, v126
    v_lshl_add_u32 v123, v123, 3, s25
    v_mul_f32 v124, v122, v124
    v_mul_f32 v125, v122, v125
    v_cmpx_ne_u32_sdwa vcc, v64, 0 src0_sel:BYTE_1 src1_sel:DWORD
    ds_add_f32 v123, v124 offset:0
    ds_add_f32 v123, v125 offset:4
    s_mov_b64 exec, -1
    v_lshlrev_b32_sdwa v122, 11, sext(v65) dst_sel:DWORD dst_unused:UNUSED_PAD src0_sel:DWORD src1_sel:WORD_0
    v_bfe_u32 v123, v65, 16, 14
    v_cndmask_b32 v126, v34, v35, s[66:67]
    v_bfi_b32 v122, v122, 0, s27
    v_lshlrev_b32 v124, 16, v126
    v_mul_f32 v122, s26, v122
    v_and_b32 v125, s28, v126
    v_lshl_add_u32 v123, v123, 3, s25
    v_mul_f32 v124, v122, v124
    v_mul_f32 v125, v122, v125
    v_cmpx_ne_u32_sdwa vcc, v65, 0 src0_sel:BYTE_1 src1_sel:DWORD
    ds_add_f32 v123, v124 offset:0
    ds_add_f32 v123, v125 offset:4
    s_mov_b64 exec, -1
    s_waitcnt vmcnt(7)
    v_perm_b32 v63, v105, v102, s31
    v_perm_b32 v64, v105, v103, s32
    v_perm_b32 v65, v105, v104, s33
    v_lshlrev_b16 v34, 3, v104
    v_lshlrev_b16 v32, 3, v103
    v_lshlrev_b16 v30, 3, v102
    ds_read_addtid_b32 v102 offset:1280
    s_waitcnt lgkmcnt(15)
    buffer_load_dwordx4 v[90:93], v90, s[4:7], 0 offen
    v_lshlrev_b32_sdwa v122, 11, sext(v66) dst_sel:DWORD dst_unused:UNUSED_PAD src0_sel:DWORD src1_sel:WORD_0
    v_bfe_u32 v123, v66, 16, 14
    v_cndmask_b32 v126, v36, v37, s[66:67]
    v_bfi_b32 v122, v122, 0, s27
    v_lshlrev_b32 v124, 16, v126
    v_mul_f32 v122, s26, v122
    v_and_b32 v125, s28, v126
    v_lshl_add_u32 v123, v123, 3, s25
    v_mul_f32 v124, v122, v124
    v_mul_f32 v125, v122, v125
    v_cmpx_ne_u32_sdwa vcc, v66, 0 src0_sel:BYTE_1 src1_sel:DWORD
    ds_add_f32 v123, v124 offset:0
    ds_add_f32 v123, v125 offset:4
    s_mov_b64 exec, -1
    v_lshlrev_b32_sdwa v122, 11, sext(v67) dst_sel:DWORD dst_unused:UNUSED_PAD src0_sel:DWORD src1_sel:WORD_0
    v_bfe_u32 v123, v67, 16, 14
    v_cndmask_b32 v126, v38, v39, s[66:67]
    v_bfi_b32 v122, v122, 0, s27
    v_lshlrev_b32 v124, 16, v126
    v_mul_f32 v122, s26, v122
    v_and_b32 v125, s28, v126
    v_lshl_add_u32 v123, v123, 3, s25
    v_mul_f32 v124, v122, v124
    v_mul_f32 v125, v122, v125
    v_cmpx_ne_u32_sdwa vcc, v67, 0 src0_sel:BYTE_1 src1_sel:DWORD
    ds_add_f32 v123, v124 offset:0
    ds_add_f32 v123, v125 offset:4
    s_mov_b64 exec, -1
    v_lshlrev_b32_sdwa v122, 11, sext(v68) dst_sel:DWORD dst_unused:UNUSED_PAD src0_sel:DWORD src1_sel:WORD_0
    v_bfe_u32 v123, v68, 16, 14
    v_cndmask_b32 v126, v40, v41, s[66:67]
    v_bfi_b32 v122, v122, 0, s27
    v_lshlrev_b32 v124, 16, v126
    v_mul_f32 v122, s26, v122
    v_and_b32 v125, s28, v126
    v_lshl_add_u32 v123, v123, 3, s25
    v_mul_f32 v124, v122, v124
    v_mul_f32 v125, v122, v125
    v_cmpx_ne_u32_sdwa vcc, v68, 0 src0_sel:BYTE_1 src1_sel:DWORD
    ds_add_f32 v123, v124 offset:0
    ds_add_f32 v123, v125 offset:4
    s_mov_b64 exec, -1
    s_waitcnt vmcnt(4)
    v_perm_b32 v66, v109, v106, s31
    v_perm_b32 v67, v109, v107, s32
    v_perm_b32 v68, v109, v108, s33
    v_lshlrev_b16 v40, 3, v108
    v_lshlrev_b16 v38, 3, v107
    v_lshlrev_b16 v36, 3, v106
    ds_read_addtid_b32 v106 offset:1536
    s_cmp_le_u32 s15, 7
    s_cbranch_scc1 p2_na1
    v_lshlrev_b32_sdwa v122, 11, sext(v69) dst_sel:DWORD dst_unused:UNUSED_PAD src0_sel:DWORD src1_sel:WORD_0
    v_bfe_u32 v123, v69, 16, 14
    v_cndmask_b32 v126, v42, v43, s[66:67]
    v_bfi_b32 v122, v122, 0, s27
    v_lshlrev_b32 v124, 16, v126
    v_mul_f32 v122, s26, v122
    v_and_b32 v125, s28, v126
    v_lshl_add_u32 v123, v123, 3, s25
    v_mul_f32 v124, v122, v124
    v_mul_f32 v125, v122, v125
    v_cmpx_ne_u32_sdwa vcc, v69, 0 src0_sel:BYTE_1 src1_sel:DWORD
    ds_add_f32 v123, v124 offset:0
    ds_add_f32 v123, v125 offset:4
    s_mov_b64 exec, -1
    v_lshlrev_b32_sdwa v122, 11, sext(v70) dst_sel:DWORD dst_unused:UNUSED_PAD src0_sel:DWORD src1_sel:WORD_0
    v_bfe_u32 v123, v70, 16, 14
    v_cndmask_b32 v126, v44, v45, s[66:67]
    v_bfi_b32 v122, v122, 0, s27
    v_lshlrev_b32 v124, 16, v126
    v_mul_f32 v122, s26, v122
    v_and_b32 v125, s28, v126
    v_lshl_add_u32 v123, v123, 3, s25
    v_mul_f32 v124, v122, v124
    v_mul_f32 v125, v122, v125
    v_cmpx_ne_u32_sdwa vcc, v70, 0 src0_sel:BYTE_1 src1_sel:DWORD
    ds_add_f32 v123, v124 offset:0
    ds_add_f32 v123, v125 offset:4
    s_mov_b64 exec, -1
    v_lshlrev_b32_sdwa v122, 11, sext(v71) dst_sel:DWORD dst_unused:UNUSED_PAD src0_sel:DWORD src1_sel:WORD_0
    v_bfe_u32 v123, v71, 16, 14
    v_cndmask_b32 v126, v46, v47, s[66:67]
    v_bfi_b32 v122, v122, 0, s27
    v_lshlrev_b32 v124, 16, v126
    v_mul_f32 v122, s26, v122
    v_and_b32 v125, s28, v126
    v_lshl_add_u32 v123, v123, 3, s25
    v_mul_f32 v124, v122, v124
    v_mul_f32 v125, v122, v125
    v_cmpx_ne_u32_sdwa vcc, v71, 0 src0_sel:BYTE_1 src1_sel:DWORD
    ds_add_f32 v123, v124 offset:0
    ds_add_f32 v123, v125 offset:4
    s_mov_b64 exec, -1
p2_na1:
    s_waitcnt vmcnt(3)
    v_perm_b32 v69, v113, v110, s31
    v_perm_b32 v70, v113, v111, s32
    v_perm_b32 v71, v113, v112, s33
    v_lshlrev_b16 v46, 3, v112
    v_lshlrev_b16 v44, 3, v111
    v_lshlrev_b16 v42, 3, v110
    ds_read_addtid_b32 v110 offset:1792
    s_waitcnt lgkmcnt(0)
p2_added:
    s_setprio 0
    s_cmp_lg_u32 s61, 0
    s_cbranch_scc1 p2_fin
p2_tail:
    s_mov_b32 s60, s62
    s_mov_b32 s61, s63
    s_mov_b32 s15, s16
    s_mov_b32 s16, s17
    buffer_load_dwordx4 v[94:97], v94, s[4:7], 0 offen
    s_waitcnt vmcnt(3)
    v_perm_b32 v48, v3, v0, s31
    v_perm_b32 v49, v3, v1, s32
    v_perm_b32 v50, v3, v2, s33
    v_lshlrev_b16 v4, 3, v2
    v_lshlrev_b16 v2, 3, v1
    v_lshlrev_b16 v0, 3, v0
    s_waitcnt vmcnt(2)
    v_perm_b32 v51, v9, v6, s31
    v_perm_b32 v52, v9, v7, s32
    v_perm_b32 v53, v9, v8, s33
    v_lshlrev_b16 v10, 3, v8
    v_lshlrev_b16 v8, 3, v7
    v_lshlrev_b16 v6, 3, v6
    s_mov_b32 m0, s23
    s_nop 0
    ds_write_addtid_b32 v72 offset:0
    ds_write_addtid_b32 v73 offset:256
    ds_write_addtid_b32 v74 offset:512
    ds_write_addtid_b32 v75 offset:768
    ds_write_addtid_b32 v76 offset:1024
    ds_write_addtid_b32 v77 offset:1280
    ds_write_addtid_b32 v78 offset:1536
    ds_write_addtid_b32 v79 offset:1792
    ds_write_addtid_b32 v80 offset:2048
    ds_write_addtid_b32 v81 offset:2304
    ds_write_addtid_b32 v82 offset:2560
    ds_write_addtid_b32 v83 offset:2816
    s_cmp_ge_u32 s10, 9
    s_cbranch_scc1 p2_notail0
    s_mov_b32 m0, s24
    s_nop 0
    ds_write_addtid_b32 v84 offset:49152
    ds_write_addtid_b32 v85 offset:49408
p2_notail0:
    s_add_u32 s20, s20, 53760
    s_waitcnt lgkmcnt(0)
    s_barrier
    v_mov_b32 v122, s19
    s_xor_b32 s19, s19, 4
    ds_read_b32 v127, v122 offset:53760
    v_mov_b32 v123, s19
    v_mov_b32 v124, 0
    ds_write_b32 v123, v124 offset:53760
    buffer_load_dwordx4 v[72:75], v116, s[4:7], s20 offen offset:0
    v_cmpx_gt_u32 vcc, 2.0, v48
    ds_read_b64 v[0:1], v0
    s_mov_b64 exec, -1
    v_cmpx_gt_u32 vcc, 2.0, v49
    ds_read_b64 v[2:3], v2
    s_mov_b64 exec, -1
    v_cmpx_gt_u32 vcc, 2.0, v50
    ds_read_b64 v[4:5], v4
    s_mov_b64 exec, -1
    buffer_load_dwordx4 v[76:79], v116, s[4:7], s20 offen offset:1024
    v_cmpx_gt_u32 vcc, 2.0, v51
    ds_read_b64 v[6:7], v6
    s_mov_b64 exec, -1
    v_cmpx_gt_u32 vcc, 2.0, v52
    ds_read_b64 v[8:9], v8
    s_mov_b64 exec, -1
    v_cmpx_gt_u32 vcc, 2.0, v53
    ds_read_b64 v[10:11], v10
    s_mov_b64 exec, -1
    buffer_load_dwordx4 v[80:83], v116, s[4:7], s20 offen offset:2048
    v_cmpx_gt_u32 vcc, 2.0, v54
    ds_read_b64 v[12:13], v12
    s_mov_b64 exec, -1
    v_cmpx_gt_u32 vcc, 2.0, v55
    ds_read_b64 v[14:15], v14
    s_mov_b64 exec, -1
    v_cmpx_gt_u32 vcc, 2.0, v56
    ds_read_b64 v[16:17], v16
    s_mov_b64 exec, -1
    s_cmp_ge_u32 s10, 9
    s_cbranch_scc1 p2_nms0
    v_lshrrev_b32 v84, 1, v116
    s_add_u32 s44, s20, s42
    buffer_load_dwordx2 v[84:85], v84, s[4:7], s44 offen
p2_nms0:
    v_cmpx_gt_u32 vcc, 2.0, v57
    ds_read_b64 v[18:19], v18
    s_mov_b64 exec, -1
    v_cmpx_gt_u32 vcc, 2.0, v58
    ds_read_b64 v[20:21], v20
    s_mov_b64 exec, -1
    v_cmpx_gt_u32 vcc, 2.0, v59
    ds_read_b64 v[22:23], v22
    s_mov_b64 exec, -1
    v_cmpx_gt_u32 vcc, 2.0, v60
    ds_read_b64 v[24:25], v24
    s_mov_b64 exec, -1
    v_cmpx_gt_u32 vcc, 2.0, v61
    ds_read_b64 v[26:27], v26
    s_mov_b64 exec, -1
    v_cmpx_gt_u32 vcc, 2.0, v62
    ds_read_b64 v[28:29], v28
    s_mov_b64 exec, -1
    v_cmpx_gt_u32 vcc, 2.0, v63
    ds_read_b64 v[30:31], v30
    s_mov_b64 exec, -1
    v_cmpx_gt_u32 vcc, 2.0, v64
    ds_read_b64 v[32:33], v32
    s_mov_b64 exec, -1
    v_cmpx_gt_u32 vcc, 2.0, v65
    ds_read_b64 v[34:35], v34
    s_mov_b64 exec, -1
    v_cmpx_gt_u32 vcc, 2.0, v66
    ds_read_b64 v[36:37], v36
    s_mov_b64 exec, -1
    v_cmpx_gt_u32 vcc, 2.0, v67
    ds_read_b64 v[38:39], v38
    s_mov_b64 exec, -1
    v_cmpx_gt_u32 vcc, 2.0, v68
    ds_read_b64 v[40:41], v40
    s_mov_b64 exec, -1
    s_cmp_le_u32 s15, 7
    s_cbranch_scc1 p2_g0
    v_cmpx_gt_u32 vcc, 2.0, v69
    ds_read_b64 v[42:43], v42
    s_mov_b64 exec, -1
    v_cmpx_gt_u32 vcc, 2.0, v70
    ds_read_b64 v[44:45], v44
    s_mov_b64 exec, -1
    v_cmpx_gt_u32 vcc, 2.0, v71
    ds_read_b64 v[46:47], v46
    s_mov_b64 exec, -1
p2_g0:
    buffer_load_dwordx4 v[98:101], v98, s[4:7], 0 offen
    s_waitcnt lgkmcnt(0)
    s_barrier
    s_waitcnt vmcnt(1)
    s_mov_b32 m0, s23
    s_nop 0
    ds_write_addtid_b32 v72 offset:0
    ds_write_addtid_b32 v73 offset:256
    ds_write_addtid_b32 v74 offset:512
    ds_write_addtid_b32 v75 offset:768
    ds_write_addtid_b32 v76 offset:1024
    ds_write_addtid_b32 v77 offset:1280
    ds_write_addtid_b32 v78 offset:1536
    ds_write_addtid_b32 v79 offset:1792
    ds_write_addtid_b32 v80 offset:2048
    ds_write_addtid_b32 v81 offset:2304
    ds_write_addtid_b32 v82 offset:2560
    ds_write_addtid_b32 v83 offset:2816
    s_cmp_ge_u32 s10, 9
    s_cbranch_scc1 p2_notail1
    s_mov_b32 m0, s24
    s_nop 0
    ds_write_addtid_b32 v84 offset:49152
    ds_write_addtid_b32 v85 offset:49408
p2_notail1:
    s_add_u32 s20, s20, 53760
    s_waitcnt lgkmcnt(0)
    s_barrier
    v_readfirstlane_b32 s62, v127
    s_mov_b32 s63, 0
    s_cmp_lg_u32 s62, 0
    s_cbranch_scc1 p2_advb_done
    s_add_u32 s13, s13, 1
    s_cmp_ge_u32 s13, s14
    s_cselect_b32 s63, 1, 0
    s_or_b32 s44, s13, s63
    s_bitcmp0_b32 s44, 0
    s_cbranch_scc1 p2_newdescb
    v_lshrrev_b32 v86, 16, v86
    v_lshrrev_b32 v87, 16, v87
    v_lshrrev_b32 v88, 16, v88
    v_lshrrev_b32 v89, 16, v89
    s_branch p2_advb_done
p2_newdescb:
    s_lshr_b32 s44, s13, 2
    s_mul_i32 s44, s44, 1064960
    s_add_u32 s44, s44, s40
    s_and_b32 s45, s13, 2
    s_lshl_b32 s45, s45, 1
    s_add_u32 s44, s44, s45
    buffer_load_dword v86, v116, s[4:7], s44 offen offset:0
    buffer_load_dword v87, v116, s[4:7], s44 offen offset:8
    s_add_u32 s44, s44, 16384
    buffer_load_dword v88, v116, s[4:7], s44 offen offset:0
    buffer_load_dword v89, v116, s[4:7], s44 offen offset:8
p2_advb_done:
    s_cmp_lg_u32 s10, 0
    s_cbranch_scc1 p2_ntg
    s_lshr_b32 s44, s2, 3
    s_mul_i32 s44, s44, 5120
    s_add_u32 s44, s44, s20
    s_add_u32 s44, s44, 107520
    v_lshlrev_b32 v126, 3, v116
    s_mov_b32 exec_hi, 0xff
    buffer_load_dword v126, v126, s[4:7], s44 offen
    s_mov_b64 exec, -1
p2_ntg:
    buffer_load_dwordx4 v[72:75], v116, s[4:7], s20 offen offset:0
    v_cmpx_le_i32 vcc, 2.0, v48
    ds_read_b64 v[0:1], v0
    s_mov_b64 exec, -1
    v_cmpx_le_i32 vcc, 2.0, v49
    ds_read_b64 v[2:3], v2
    s_mov_b64 exec, -1
    v_cmpx_le_i32 vcc, 2.0, v50
    ds_read_b64 v[4:5], v4
    s_mov_b64 exec, -1
    buffer_load_dwordx4 v[76:79], v116, s[4:7], s20 offen offset:1024
    v_cmpx_le_i32 vcc, 2.0, v51
    ds_read_b64 v[6:7], v6
    s_mov_b64 exec, -1
    v_cmpx_le_i32 vcc, 2.0, v52
    ds_read_b64 v[8:9], v8
    s_mov_b64 exec, -1
    v_cmpx_le_i32 vcc, 2.0, v53
    ds_read_b64 v[10:11], v10
    s_mov_b64 exec, -1
    buffer_load_dwordx4 v[80:83], v116, s[4:7], s20 offen offset:2048
    v_cmpx_le_i32 vcc, 2.0, v54
    ds_read_b64 v[12:13], v12
    s_mov_b64 exec, -1
    v_cmpx_le_i32 vcc, 2.0, v55
    ds_read_b64 v[14:15], v14
    s_mov_b64 exec, -1
    v_cmpx_le_i32 vcc, 2.0, v56
    ds_read_b64 v[16:17], v16
    s_mov_b64 exec, -1
    s_cmp_ge_u32 s10, 9
    s_cbranch_scc1 p2_nms1
    v_lshrrev_b32 v84, 1, v116
    s_add_u32 s44, s20, s42
    buffer_load_dwordx2 v[84:85], v84, s[4:7], s44 offen
p2_nms1:
    v_cmpx_le_i32 vcc, 2.0, v57
    ds_read_b64 v[18:19], v18
    s_mov_b64 exec, -1
    v_cmpx_le_i32 vcc, 2.0, v58
    ds_read_b64 v[20:21], v20
    s_mov_b64 exec, -1
    v_cmpx_le_i32 vcc, 2.0, v59
    ds_read_b64 v[22:23], v22
    s_mov_b64 exec, -1
    v_cmpx_le_i32 vcc, 2.0, v60
    ds_read_b64 v[24:25], v24
    s_mov_b64 exec, -1
    v_cmpx_le_i32 vcc, 2.0, v61
    ds_read_b64 v[26:27], v26
    s_mov_b64 exec, -1
    v_cmpx_le_i32 vcc, 2.0, v62
    ds_read_b64 v[28:29], v28
    s_mov_b64 exec, -1
    v_cmpx_le_i32 vcc, 2.0, v63
    ds_read_b64 v[30:31], v30
    s_mov_b64 exec, -1
    v_cmpx_le_i32 vcc, 2.0, v64
    ds_read_b64 v[32:33], v32
    s_mov_b64 exec, -1
    v_cmpx_le_i32 vcc, 2.0, v65
    ds_read_b64 v[34:35], v34
    s_mov_b64 exec, -1
    v_cmpx_le_i32 vcc, 2.0, v66
    ds_read_b64 v[36:37], v36
    s_mov_b64 exec, -1
    v_cmpx_le_i32 vcc, 2.0, v67
    ds_read_b64 v[38:39], v38
    s_mov_b64 exec, -1
    v_cmpx_le_i32 vcc, 2.0, v68
    ds_read_b64 v[40:41], v40
    s_mov_b64 exec, -1
    s_cmp_le_u32 s15, 7
    s_cbranch_scc1 p2_g1
    v_cmpx_le_i32 vcc, 2.0, v69
    ds_read_b64 v[42:43], v42
    s_mov_b64 exec, -1
    v_cmpx_le_i32 vcc, 2.0, v70
    ds_read_b64 v[44:45], v44
    s_mov_b64 exec, -1
    v_cmpx_le_i32 vcc, 2.0, v71
    ds_read_b64 v[46:47], v46
    s_mov_b64 exec, -1
p2_g1:
    buffer_load_dwordx4 v[102:105], v102, s[4:7], 0 offen
    s_waitcnt lgkmcnt(0)
    s_barrier
    s_waitcnt vmcnt(1)
    s_mov_b32 m0, s23
    s_nop 0
    ds_write_addtid_b32 v72 offset:0
    ds_write_addtid_b32 v73 offset:256
    ds_write_addtid_b32 v74 offset:512
    ds_write_addtid_b32 v75 offset:768
    ds_write_addtid_b32 v76 offset:1024
    ds_write_addtid_b32 v77 offset:1280
    ds_write_addtid_b32 v78 offset:1536
    ds_write_addtid_b32 v79 offset:1792
    ds_write_addtid_b32 v80 offset:2048
    ds_write_addtid_b32 v81 offset:2304
    ds_write_addtid_b32 v82 offset:2560
    ds_write_addtid_b32 v83 offset:2816
    s_cmp_ge_u32 s10, 9
    s_cbranch_scc1 p2_notail2
    s_mov_b32 m0, s24
    s_nop 0
    ds_write_addtid_b32 v84 offset:49152
    ds_write_addtid_b32 v85 offset:49408
p2_notail2:
    s_add_u32 s20, s20, 53760
    s_mul_i32 s44, s60, 161280
    s_sub_u32 s20, s20, s44
    s_waitcnt lgkmcnt(0)
    s_barrier
    buffer_load_dwordx4 v[72:75], v116, s[4:7], s20 offen offset:0
    v_cmpx_gt_i32 vcc, 0, v48
    ds_read_b64 v[0:1], v0
    s_mov_b64 exec, -1
    v_cmpx_gt_i32 vcc, 0, v49
    ds_read_b64 v[2:3], v2
    s_mov_b64 exec, -1
    v_cmpx_gt_i32 vcc, 0, v50
    ds_read_b64 v[4:5], v4
    s_mov_b64 exec, -1
    buffer_load_dwordx4 v[76:79], v116, s[4:7], s20 offen offset:1024
    v_cmpx_gt_i32 vcc, 0, v51
    ds_read_b64 v[6:7], v6
    s_mov_b64 exec, -1
    v_cmpx_gt_i32 vcc, 0, v52
    ds_read_b64 v[8:9], v8
    s_mov_b64 exec, -1
    v_cmpx_gt_i32 vcc, 0, v53
    ds_read_b64 v[10:11], v10
    s_mov_b64 exec, -1
    buffer_load_dwordx4 v[80:83], v116, s[4:7], s20 offen offset:2048
    v_cmpx_gt_i32 vcc, 0, v54
    ds_read_b64 v[12:13], v12
    s_mov_b64 exec, -1
    v_cmpx_gt_i32 vcc, 0, v55
    ds_read_b64 v[14:15], v14
    s_mov_b64 exec, -1
    v_cmpx_gt_i32 vcc, 0, v56
    ds_read_b64 v[16:17], v16
    s_mov_b64 exec, -1
    s_cmp_ge_u32 s10, 9
    s_cbranch_scc1 p2_nms2
    v_lshrrev_b32 v84, 1, v116
    s_add_u32 s44, s20, s42
    buffer_load_dwordx2 v[84:85], v84, s[4:7], s44 offen
p2_nms2:
    v_cmpx_gt_i32 vcc, 0, v57
    ds_read_b64 v[18:19], v18
    s_mov_b64 exec, -1
    v_cmpx_gt_i32 vcc, 0, v58
    ds_read_b64 v[20:21], v20
    s_mov_b64 exec, -1
    v_cmpx_gt_i32 vcc, 0, v59
    ds_read_b64 v[22:23], v22
    s_mov_b64 exec, -1
    v_cmpx_gt_i32 vcc, 0, v60
    ds_read_b64 v[24:25], v24
    s_mov_b64 exec, -1
    v_cmpx_gt_i32 vcc, 0, v61
    ds_read_b64 v[26:27], v26
    s_mov_b64 exec, -1
    v_cmpx_gt_i32 vcc, 0, v62
    ds_read_b64 v[28:29], v28
    s_mov_b64 exec, -1
    v_cmpx_gt_i32 vcc, 0, v63
    ds_read_b64 v[30:31], v30
    s_mov_b64 exec, -1
    v_cmpx_gt_i32 vcc, 0, v64
    ds_read_b64 v[32:33], v32
    s_mov_b64 exec, -1
    v_cmpx_gt_i32 vcc, 0, v65
    ds_read_b64 v[34:35], v34
    s_mov_b64 exec, -1
    v_cmpx_gt_i32 vcc, 0, v66
    ds_read_b64 v[36:37], v36
    s_mov_b64 exec, -1
    v_cmpx_gt_i32 vcc, 0, v67
    ds_read_b64 v[38:39], v38
    s_mov_b64 exec, -1
    v_cmpx_gt_i32 vcc, 0, v68
    ds_read_b64 v[40:41], v40
    s_mov_b64 exec, -1
    s_cmp_le_u32 s15, 7
    s_cbranch_scc1 p2_g2
    v_cmpx_gt_i32 vcc, 0, v69
    ds_read_b64 v[42:43], v42
    s_mov_b64 exec, -1
    v_cmpx_gt_i32 vcc, 0, v70
    ds_read_b64 v[44:45], v44
    s_mov_b64 exec, -1
    v_cmpx_gt_i32 vcc, 0, v71
    ds_read_b64 v[46:47], v46
    s_mov_b64 exec, -1
p2_g2:
    buffer_load_dwordx4 v[106:109], v106, s[4:7], 0 offen
    buffer_load_dwordx4 v[110:113], v110, s[4:7], 0 offen
    s_waitcnt lgkmcnt(0)
    s_barrier
    s_branch p2_add
p2_fin:
    s_waitcnt vmcnt(0) lgkmcnt(0)
    s_barrier
    s_mul_i32 s44, s11, 6406144
    s_mul_i32 s45, s12, 100096
    s_add_u32 s44, s44, s45
    s_add_u32 s44, s44, 357134336
    v_add_u32 v123, s64, v116
    v_add_u32 v122, s25, v123
    v_mov_b32 v24, 0
    v_mov_b32 v25, 0
    v_mov_b32 v26, 0
    v_mov_b32 v27, 0
    ds_read_b128 v[0:3], v122 offset:0
    ds_read_b128 v[4:7], v122 offset:16384
    ds_read_b128 v[8:11], v122 offset:32768
    v_add_u32 v122, 49152, v122
    ds_read_b128 v[12:15], v122 offset:0
    ds_read_b128 v[16:19], v122 offset:16384
    ds_read_b128 v[20:23], v122 offset:32768
    v_cmpx_gt_u32 vcc, 1792, v123
    ds_read_b128 v[24:27], v122 offset:49152
    s_mov_b64 exec, -1
    s_waitcnt lgkmcnt(0)
    s_cmp_lg_u32 s21, 0
    s_cbranch_scc1 p2_finf
    v_pk_max_u16 v117, v117, v0
    v_pk_max_u16 v117, v117, v1
    v_pk_max_u16 v117, v117, v2
    v_pk_max_u16 v117, v117, v3
    v_pk_max_u16 v117, v117, v4
    v_pk_max_u16 v117, v117, v5
    v_pk_max_u16 v117, v117, v6
    v_pk_max_u16 v117, v117, v7
    v_pk_max_u16 v117, v117, v8
    v_pk_max_u16 v117, v117, v9
    v_pk_max_u16 v117, v117, v10
    v_pk_max_u16 v117, v117, v11
    v_pk_max_u16 v117, v117, v12
    v_pk_max_u16 v117, v117, v13
    v_pk_max_u16 v117, v117, v14
    v_pk_max_u16 v117, v117, v15
    v_pk_max_u16 v117, v117, v16
    v_pk_max_u16 v117, v117, v17
    v_pk_max_u16 v117, v117, v18
    v_pk_max_u16 v117, v117, v19
    v_pk_max_u16 v117, v117, v20
    v_pk_max_u16 v117, v117, v21
    v_pk_max_u16 v117, v117, v22
    v_pk_max_u16 v117, v117, v23
    v_pk_max_u16 v117, v117, v24
    v_pk_max_u16 v117, v117, v25
    v_pk_max_u16 v117, v117, v26
    v_pk_max_u16 v117, v117, v27
    v_lshrrev_b32 v124, 16, v117
    v_and_b32 v117, 0xffff, v117
    v_max_u32 v117, v117, v124
    v_mov_b32 v124, 0
    v_cmpx_le_u32 vcc, 57344, v117
    ds_write_b32 v124, v117 offset:53768
    s_mov_b64 exec, -1
    v_mov_b32 v125, s30
    v_mul_f32 v125, 0xc6e00000, v125
    v_cvt_f32_u32_sdwa v126, v0 dst_sel:DWORD dst_unused:UNUSED_PAD src0_sel:WORD_0
    v_cvt_f32_u32_sdwa v127, v0 dst_sel:DWORD dst_unused:UNUSED_PAD src0_sel:WORD_1
    v_fma_f32 v126, v126, s30, v125
    v_fma_f32 v127, v127, s30, v125
    v_cvt_pk_bf16_f32 v0, v126, v127
    v_cvt_f32_u32_sdwa v126, v1 dst_sel:DWORD dst_unused:UNUSED_PAD src0_sel:WORD_0
    v_cvt_f32_u32_sdwa v127, v1 dst_sel:DWORD dst_unused:UNUSED_PAD src0_sel:WORD_1
    v_fma_f32 v126, v126, s30, v125
    v_fma_f32 v127, v127, s30, v125
    v_cvt_pk_bf16_f32 v1, v126, v127
    v_cvt_f32_u32_sdwa v126, v2 dst_sel:DWORD dst_unused:UNUSED_PAD src0_sel:WORD_0
    v_cvt_f32_u32_sdwa v127, v2 dst_sel:DWORD dst_unused:UNUSED_PAD src0_sel:WORD_1
    v_fma_f32 v126, v126, s30, v125
    v_fma_f32 v127, v127, s30, v125
    v_cvt_pk_bf16_f32 v2, v126, v127
    v_cvt_f32_u32_sdwa v126, v3 dst_sel:DWORD dst_unused:UNUSED_PAD src0_sel:WORD_0
    v_cvt_f32_u32_sdwa v127, v3 dst_sel:DWORD dst_unused:UNUSED_PAD src0_sel:WORD_1
    v_fma_f32 v126, v126, s30, v125
    v_fma_f32 v127, v127, s30, v125
    v_cvt_pk_bf16_f32 v3, v126, v127
    v_cvt_f32_u32_sdwa v126, v4 dst_sel:DWORD dst_unused:UNUSED_PAD src0_sel:WORD_0
    v_cvt_f32_u32_sdwa v127, v4 dst_sel:DWORD dst_unused:UNUSED_PAD src0_sel:WORD_1
    v_fma_f32 v126, v126, s30, v125
    v_fma_f32 v127, v127, s30, v125
    v_cvt_pk_bf16_f32 v4, v126, v127
    v_cvt_f32_u32_sdwa v126, v5 dst_sel:DWORD dst_unused:UNUSED_PAD src0_sel:WORD_0
    v_cvt_f32_u32_sdwa v127, v5 dst_sel:DWORD dst_unused:UNUSED_PAD src0_sel:WORD_1
    v_fma_f32 v126, v126, s30, v125
    v_fma_f32 v127, v127, s30, v125
    v_cvt_pk_bf16_f32 v5, v126, v127
    v_cvt_f32_u32_sdwa v126, v6 dst_sel:DWORD dst_unused:UNUSED_PAD src0_sel:WORD_0
    v_cvt_f32_u32_sdwa v127, v6 dst_sel:DWORD dst_unused:UNUSED_PAD src0_sel:WORD_1
    v_fma_f32 v126, v126, s30, v125
    v_fma_f32 v127, v127, s30, v125
    v_cvt_pk_bf16_f32 v6, v126, v127
    v_cvt_f32_u32_sdwa v126, v7 dst_sel:DWORD dst_unused:UNUSED_PAD src0_sel:WORD_0
    v_cvt_f32_u32_sdwa v127, v7 dst_sel:DWORD dst_unused:UNUSED_PAD src0_sel:WORD_1
    v_fma_f32 v126, v126, s30, v125
    v_fma_f32 v127, v127, s30, v125
    v_cvt_pk_bf16_f32 v7, v126, v127
    v_cvt_f32_u32_sdwa v126, v8 dst_sel:DWORD dst_unused:UNUSED_PAD src0_sel:WORD_0
    v_cvt_f32_u32_sdwa v127, v8 dst_sel:DWORD dst_unused:UNUSED_PAD src0_sel:WORD_1
    v_fma_f32 v126, v126, s30, v125
    v_fma_f32 v127, v127, s30, v125
    v_cvt_pk_bf16_f32 v8, v126, v127
    v_cvt_f32_u32_sdwa v126, v9 dst_sel:DWORD dst_unused:UNUSED_PAD src0_sel:WORD_0
    v_cvt_f32_u32_sdwa v127, v9 dst_sel:DWORD dst_unused:UNUSED_PAD src0_sel:WORD_1
    v_fma_f32 v126, v126, s30, v125
    v_fma_f32 v127, v127, s30, v125
    v_cvt_pk_bf16_f32 v9, v126, v127
    v_cvt_f32_u32_sdwa v126, v10 dst_sel:DWORD dst_unused:UNUSED_PAD src0_sel:WORD_0
    v_cvt_f32_u32_sdwa v127, v10 dst_sel:DWORD dst_unused:UNUSED_PAD src0_sel:WORD_1
    v_fma_f32 v126, v126, s30, v125
    v_fma_f32 v127, v127, s30, v125
    v_cvt_pk_bf16_f32 v10, v126, v127
    v_cvt_f32_u32_sdwa v126, v11 dst_sel:DWORD dst_unused:UNUSED_PAD src0_sel:WORD_0
    v_cvt_f32_u32_sdwa v127, v11 dst_sel:DWORD dst_unused:UNUSED_PAD src0_sel:WORD_1
    v_fma_f32 v126, v126, s30, v125
    v_fma_f32 v127, v127, s30, v125
    v_cvt_pk_bf16_f32 v11, v126, v127
    v_cvt_f32_u32_sdwa v126, v12 dst_sel:DWORD dst_unused:UNUSED_PAD src0_sel:WORD_0
    v_cvt_f32_u32_sdwa v127, v12 dst_sel:DWORD dst_unused:UNUSED_PAD src0_sel:WORD_1
    v_fma_f32 v126, v126, s30, v125
    v_fma_f32 v127, v127, s30, v125
    v_cvt_pk_bf16_f32 v12, v126, v127
    v_cvt_f32_u32_sdwa v126, v13 dst_sel:DWORD dst_unused:UNUSED_PAD src0_sel:WORD_0
    v_cvt_f32_u32_sdwa v127, v13 dst_sel:DWORD dst_unused:UNUSED_PAD src0_sel:WORD_1
    v_fma_f32 v126, v126, s30, v125
    v_fma_f32 v127, v127, s30, v125
    v_cvt_pk_bf16_f32 v13, v126, v127
    v_cvt_f32_u32_sdwa v126, v14 dst_sel:DWORD dst_unused:UNUSED_PAD src0_sel:WORD_0
    v_cvt_f32_u32_sdwa v127, v14 dst_sel:DWORD dst_unused:UNUSED_PAD src0_sel:WORD_1
    v_fma_f32 v126, v126, s30, v125
    v_fma_f32 v127, v127, s30, v125
    v_cvt_pk_bf16_f32 v14, v126, v127
    v_cvt_f32_u32_sdwa v126, v15 dst_sel:DWORD dst_unused:UNUSED_PAD src0_sel:WORD_0
    v_cvt_f32_u32_sdwa v127, v15 dst_sel:DWORD dst_unused:UNUSED_PAD src0_sel:WORD_1
    v_fma_f32 v126, v126, s30, v125
    v_fma_f32 v127, v127, s30, v125
    v_cvt_pk_bf16_f32 v15, v126, v127
    v_cvt_f32_u32_sdwa v126, v16 dst_sel:DWORD dst_unused:UNUSED_PAD src0_sel:WORD_0
    v_cvt_f32_u32_sdwa v127, v16 dst_sel:DWORD dst_unused:UNUSED_PAD src0_sel:WORD_1
    v_fma_f32 v126, v126, s30, v125
    v_fma_f32 v127, v127, s30, v125
    v_cvt_pk_bf16_f32 v16, v126, v127
    v_cvt_f32_u32_sdwa v126, v17 dst_sel:DWORD dst_unused:UNUSED_PAD src0_sel:WORD_0
    v_cvt_f32_u32_sdwa v127, v17 dst_sel:DWORD dst_unused:UNUSED_PAD src0_sel:WORD_1
    v_fma_f32 v126, v126, s30, v125
    v_fma_f32 v127, v127, s30, v125
    v_cvt_pk_bf16_f32 v17, v126, v127
    v_cvt_f32_u32_sdwa v126, v18 dst_sel:DWORD dst_unused:UNUSED_PAD src0_sel:WORD_0
    v_cvt_f32_u32_sdwa v127, v18 dst_sel:DWORD dst_unused:UNUSED_PAD src0_sel:WORD_1
    v_fma_f32 v126, v126, s30, v125
    v_fma_f32 v127, v127, s30, v125
    v_cvt_pk_bf16_f32 v18, v126, v127
    v_cvt_f32_u32_sdwa v126, v19 dst_sel:DWORD dst_unused:UNUSED_PAD src0_sel:WORD_0
    v_cvt_f32_u32_sdwa v127, v19 dst_sel:DWORD dst_unused:UNUSED_PAD src0_sel:WORD_1
    v_fma_f32 v126, v126, s30, v125
    v_fma_f32 v127, v127, s30, v125
    v_cvt_pk_bf16_f32 v19, v126, v127
    v_cvt_f32_u32_sdwa v126, v20 dst_sel:DWORD dst_unused:UNUSED_PAD src0_sel:WORD_0
    v_cvt_f32_u32_sdwa v127, v20 dst_sel:DWORD dst_unused:UNUSED_PAD src0_sel:WORD_1
    v_fma_f32 v126, v126, s30, v125
    v_fma_f32 v127, v127, s30, v125
    v_cvt_pk_bf16_f32 v20, v126, v127
    v_cvt_f32_u32_sdwa v126, v21 dst_sel:DWORD dst_unused:UNUSED_PAD src0_sel:WORD_0
    v_cvt_f32_u32_sdwa v127, v21 dst_sel:DWORD dst_unused:UNUSED_PAD src0_sel:WORD_1
    v_fma_f32 v126, v126, s30, v125
    v_fma_f32 v127, v127, s30, v125
    v_cvt_pk_bf16_f32 v21, v126, v127
    v_cvt_f32_u32_sdwa v126, v22 dst_sel:DWORD dst_unused:UNUSED_PAD src0_sel:WORD_0
    v_cvt_f32_u32_sdwa v127, v22 dst_sel:DWORD dst_unused:UNUSED_PAD src0_sel:WORD_1
    v_fma_f32 v126, v126, s30, v125
    v_fma_f32 v127, v127, s30, v125
    v_cvt_pk_bf16_f32 v22, v126, v127
    v_cvt_f32_u32_sdwa v126, v23 dst_sel:DWORD dst_unused:UNUSED_PAD src0_sel:WORD_0
    v_cvt_f32_u32_sdwa v127, v23 dst_sel:DWORD dst_unused:UNUSED_PAD src0_sel:WORD_1
    v_fma_f32 v126, v126, s30, v125
    v_fma_f32 v127, v127, s30, v125
    v_cvt_pk_bf16_f32 v23, v126, v127
    v_cvt_f32_u32_sdwa v126, v24 dst_sel:DWORD dst_unused:UNUSED_PAD src0_sel:WORD_0
    v_cvt_f32_u32_sdwa v127, v24 dst_sel:DWORD dst_unused:UNUSED_PAD src0_sel:WORD_1
    v_fma_f32 v126, v126, s30, v125
    v_fma_f32 v127, v127, s30, v125
    v_cvt_pk_bf16_f32 v24, v126, v127
    v_cvt_f32_u32_sdwa v126, v25 dst_sel:DWORD dst_unused:UNUSED_PAD src0_sel:WORD_0
    v_cvt_f32_u32_sdwa v127, v25 dst_sel:DWORD dst_unused:UNUSED_PAD src0_sel:WORD_1
    v_fma_f32 v126, v126, s30, v125
    v_fma_f32 v127, v127, s30, v125
    v_cvt_pk_bf16_f32 v25, v126, v127
    v_cvt_f32_u32_sdwa v126, v26 dst_sel:DWORD dst_unused:UNUSED_PAD src0_sel:WORD_0
    v_cvt_f32_u32_sdwa v127, v26 dst_sel:DWORD dst_unused:UNUSED_PAD src0_sel:WORD_1
    v_fma_f32 v126, v126, s30, v125
    v_fma_f32 v127, v127, s30, v125
    v_cvt_pk_bf16_f32 v26, v126, v127
    v_cvt_f32_u32_sdwa v126, v27 dst_sel:DWORD dst_unused:UNUSED_PAD src0_sel:WORD_0
    v_cvt_f32_u32_sdwa v127, v27 dst_sel:DWORD dst_unused:UNUSED_PAD src0_sel:WORD_1
    v_fma_f32 v126, v126, s30, v125
    v_fma_f32 v127, v127, s30, v125
    v_cvt_pk_bf16_f32 v27, v126, v127
    s_waitcnt lgkmcnt(0)
    s_barrier
    ds_read_b32 v125, v124 offset:53768
    s_waitcnt lgkmcnt(0)
    v_readfirstlane_b32 s45, v125
    s_nop 0
    s_cmp_lg_u32 s45, 0
    s_cselect_b32 s21, 1, 0
    s_cbranch_scc1 p2_restart
    buffer_store_dwordx4 v[0:3], v123, s[4:7], s44 offen
    s_add_u32 s44, s44, 16384
    buffer_store_dwordx4 v[4:7], v123, s[4:7], s44 offen
    s_add_u32 s44, s44, 16384
    buffer_store_dwordx4 v[8:11], v123, s[4:7], s44 offen
    s_add_u32 s44, s44, 16384
    buffer_store_dwordx4 v[12:15], v123, s[4:7], s44 offen
    s_add_u32 s44, s44, 16384
    buffer_store_dwordx4 v[16:19], v123, s[4:7], s44 offen
    s_add_u32 s44, s44, 16384
    buffer_store_dwordx4 v[20:23], v123, s[4:7], s44 offen
    s_add_u32 s44, s44, 16384
    v_cmp_gt_u32 vcc, 1792, v123
    s_and_saveexec_b64 s[46:47], vcc
    s_cbranch_execz p2_end
    buffer_store_dwordx4 v[24:27], v123, s[4:7], s44 offen
    s_add_u32 s44, s44, 16384
    s_endpgm
p2_finf:
    s_lshl_b32 s45, s21, 2
    s_add_u32 s44, s44, s45
    s_sub_u32 s44, s44, 4
    v_cvt_pk_bf16_f32 v0, v0, v1
    v_cvt_pk_bf16_f32 v2, v2, v3
    v_cvt_pk_bf16_f32 v4, v4, v5
    v_cvt_pk_bf16_f32 v6, v6, v7
    v_cvt_pk_bf16_f32 v8, v8, v9
    v_cvt_pk_bf16_f32 v10, v10, v11
    v_cvt_pk_bf16_f32 v12, v12, v13
    v_cvt_pk_bf16_f32 v14, v14, v15
    v_cvt_pk_bf16_f32 v16, v16, v17
    v_cvt_pk_bf16_f32 v18, v18, v19
    v_cvt_pk_bf16_f32 v20, v20, v21
    v_cvt_pk_bf16_f32 v22, v22, v23
    v_cvt_pk_bf16_f32 v24, v24, v25
    v_cvt_pk_bf16_f32 v26, v26, v27
    buffer_store_dword v0, v123, s[4:7], s44 offen
    buffer_store_dword v2, v123, s[4:7], s44 offen offset:8
    s_add_u32 s44, s44, 16384
    buffer_store_dword v4, v123, s[4:7], s44 offen
    buffer_store_dword v6, v123, s[4:7], s44 offen offset:8
    s_add_u32 s44, s44, 16384
    buffer_store_dword v8, v123, s[4:7], s44 offen
    buffer_store_dword v10, v123, s[4:7], s44 offen offset:8
    s_add_u32 s44, s44, 16384
    buffer_store_dword v12, v123, s[4:7], s44 offen
    buffer_store_dword v14, v123, s[4:7], s44 offen offset:8
    s_add_u32 s44, s44, 16384
    buffer_store_dword v16, v123, s[4:7], s44 offen
    buffer_store_dword v18, v123, s[4:7], s44 offen offset:8
    s_add_u32 s44, s44, 16384
    buffer_store_dword v20, v123, s[4:7], s44 offen
    buffer_store_dword v22, v123, s[4:7], s44 offen offset:8
    s_add_u32 s44, s44, 16384
    v_cmp_gt_u32 vcc, 1792, v123
    s_and_saveexec_b64 s[46:47], vcc
    s_cbranch_execz p2_finf2
    buffer_store_dword v24, v123, s[4:7], s44 offen
    buffer_store_dword v26, v123, s[4:7], s44 offen offset:8
    s_add_u32 s44, s44, 16384
p2_finf2:
    s_mov_b64 exec, -1
    s_add_u32 s21, s21, 1
    s_waitcnt vmcnt(0)
    s_cmp_eq_u32 s21, 2
    s_cbranch_scc1 p2_restart
p2_end:
    s_endpgm
.globl p3_kernel
.p2align 8
.type p3_kernel,@function
p3_kernel:
    s_cmp_ge_u32 s2, 3125
    s_cbranch_scc1 p3_end
    s_load_dwordx2 s[4:5], s[0:1], 0
    s_load_dwordx2 s[6:7], s[0:1], 24
    s_load_dwordx2 s[8:9], s[0:1], 40
    s_load_dwordx8 s[12:19], s[0:1], 56
    s_load_dwordx2 s[10:11], s[0:1], 88
    s_load_dwordx2 s[20:21], s[0:1], 104
    s_lshl_b32 s3, s2, 8
    v_add_u32 v0, s3, v0
    v_lshlrev_b32 v2, 3, v0
    v_lshlrev_b32 v3, 1, v0
    s_waitcnt lgkmcnt(0)
    s_load_dwordx4 s[40:43], s[8:9], 0
    s_load_dwordx16 s[44:59], s[12:13], 0
    s_load_dwordx16 s[60:75], s[14:15], 0
    s_load_dwordx8 s[76:83], s[16:17], 0
    s_load_dwordx8 s[84:91], s[18:19], 0
    s_mov_b32 s24, s4
    s_and_b32 s25, s5, 0xffff
    s_mov_b32 s26, 6400000
    s_mov_b32 s27, 0x20000
    s_mov_b32 s28, s6
    s_and_b32 s29, s7, 0xffff
    s_mov_b32 s30, 1600000
    s_mov_b32 s31, 0x20000
    s_mov_b32 s32, s10
    s_and_b32 s33, s11, 0xffff
    s_mov_b32 s34, 6400000
    s_mov_b32 s35, 0x20000
    s_mov_b32 s36, s20
    s_and_b32 s37, s21, 0xffff
    s_mov_b32 s38, 819200000
    s_mov_b32 s39, 0x20000
    buffer_load_ushort v14, v3, s[28:31], 0 offen
    s_mov_b32 s22, 357134336
    buffer_load_dwordx2 v[32:33], v2, s[36:39], s22 offen
    s_mov_b32 s22, 363540480
    buffer_load_dwordx2 v[34:35], v2, s[36:39], s22 offen
    s_mov_b32 s22, 369946624
    buffer_load_dwordx2 v[36:37], v2, s[36:39], s22 offen
    s_mov_b32 s22, 376352768
    buffer_load_dwordx2 v[38:39], v2, s[36:39], s22 offen
    buffer_load_dwordx2 v[12:13], v2, s[24:27], 0 offen
    s_mov_b32 s92, 0xffff0000
    s_waitcnt vmcnt(5) lgkmcnt(0)
    v_lshlrev_b32 v14, 16, v14
    s_lshl_b32 s94, s40, 16
    v_subrev_f32 v16, s94, v14
    s_and_b32 s95, s40, s92
    v_subrev_f32 v17, s95, v14
    s_lshl_b32 s96, s41, 16
    v_subrev_f32 v18, s96, v14
    s_and_b32 s93, s41, s92
    v_subrev_f32 v19, s93, v14
    s_lshl_b32 s94, s42, 16
    v_subrev_f32 v20, s94, v14
    s_and_b32 s95, s42, s92
    v_subrev_f32 v21, s95, v14
    s_lshl_b32 s96, s43, 16
    v_subrev_f32 v22, s96, v14
    s_and_b32 s93, s43, s92
    v_subrev_f32 v23, s93, v14
    v_cvt_pk_bf16_f32 v16, v16, v17
    v_cvt_pk_bf16_f32 v18, v18, v19
    v_cvt_pk_bf16_f32 v20, v20, v21
    v_cvt_pk_bf16_f32 v22, v22, v23
    v_and_b32 v17, s92, v16
    v_lshlrev_b32 v16, 16, v16
    v_and_b32 v19, s92, v18
    v_lshlrev_b32 v18, 16, v18
    v_and_b32 v21, s92, v20
    v_lshlrev_b32 v20, 16, v20
    v_and_b32 v23, s92, v22
    v_lshlrev_b32 v22, 16, v22
    v_mul_f32 v16, v16, v16
    v_mul_f32 v17, v17, v17
    v_mul_f32 v18, v18, v18
    v_mul_f32 v19, v19, v19
    v_mul_f32 v20, v20, v20
    v_mul_f32 v21, v21, v21
    v_mul_f32 v22, v22, v22
    v_mul_f32 v23, v23, v23
    v_cvt_pk_bf16_f32 v16, v16, v17
    v_cvt_pk_bf16_f32 v18, v18, v19
    v_cvt_pk_bf16_f32 v20, v20, v21
    v_cvt_pk_bf16_f32 v22, v22, v23
    v_and_b32 v17, s92, v16
    v_lshlrev_b32 v16, 16, v16
    v_and_b32 v19, s92, v18
    v_lshlrev_b32 v18, 16, v18
    v_and_b32 v21, s92, v20
    v_lshlrev_b32 v20, 16, v20
    v_and_b32 v23, s92, v22
    v_lshlrev_b32 v22, 16, v22
    v_mul_f32 v16, 0xc1200000, v16
    v_mul_f32 v17, 0xc1200000, v17
    v_mul_f32 v18, 0xc1200000, v18
    v_mul_f32 v19, 0xc1200000, v19
    v_mul_f32 v20, 0xc1200000, v20
    v_mul_f32 v21, 0xc1200000, v21
    v_mul_f32 v22, 0xc1200000, v22
    v_mul_f32 v23, 0xc1200000, v23
    v_cvt_pk_bf16_f32 v16, v16, v17
    v_cvt_pk_bf16_f32 v18, v18, v19
    v_cvt_pk_bf16_f32 v20, v20, v21
    v_cvt_pk_bf16_f32 v22, v22, v23
    v_and_b32 v17, s92, v16
    v_lshlrev_b32 v16, 16, v16
    v_and_b32 v19, s92, v18
    v_lshlrev_b32 v18, 16, v18
    v_and_b32 v21, s92, v20
    v_lshlrev_b32 v20, 16, v20
    v_and_b32 v23, s92, v22
    v_lshlrev_b32 v22, 16, v22
    v_mul_f32 v16, 0x3fb8aa3b, v16
    v_mul_f32 v17, 0x3fb8aa3b, v17
    v_mul_f32 v18, 0x3fb8aa3b, v18
    v_mul_f32 v19, 0x3fb8aa3b, v19
    v_mul_f32 v20, 0x3fb8aa3b, v20
    v_mul_f32 v21, 0x3fb8aa3b, v21
    v_mul_f32 v22, 0x3fb8aa3b, v22
    v_mul_f32 v23, 0x3fb8aa3b, v23
    v_exp_f32 v16, v16
    v_exp_f32 v17, v17
    v_exp_f32 v18, v18
    v_exp_f32 v19, v19
    v_exp_f32 v20, v20
    v_exp_f32 v21, v21
    v_exp_f32 v22, v22
    v_exp_f32 v23, v23
    s_nop 0
    v_cvt_pk_bf16_f32 v16, v16, v17
    v_cvt_pk_bf16_f32 v18, v18, v19
    v_cvt_pk_bf16_f32 v20, v20, v21
    v_cvt_pk_bf16_f32 v22, v22, v23
    v_and_b32 v17, s92, v16
    v_lshlrev_b32 v16, 16, v16
    v_and_b32 v19, s92, v18
    v_lshlrev_b32 v18, 16, v18
    v_and_b32 v21, s92, v20
    v_lshlrev_b32 v20, 16, v20
    v_and_b32 v23, s92, v22
    v_lshlrev_b32 v22, 16, v22
    s_lshl_b32 s94, s60, 16
    v_mul_f32 v24, s94, v16
    s_and_b32 s95, s60, s92
    v_mul_f32 v25, s95, v16
    s_lshl_b32 s96, s61, 16
    v_mul_f32 v26, s96, v16
    s_and_b32 s93, s61, s92
    v_mul_f32 v27, s93, v16
    s_lshl_b32 s94, s62, 16
    v_fmac_f32 v24, s94, v17
    s_and_b32 s95, s62, s92
    v_fmac_f32 v25, s95, v17
    s_lshl_b32 s96, s63, 16
    v_fmac_f32 v26, s96, v17
    s_and_b32 s93, s63, s92
    v_fmac_f32 v27, s93, v17
    s_lshl_b32 s94, s64, 16
    v_fmac_f32 v24, s94, v18
    s_and_b32 s95, s64, s92
    v_fmac_f32 v25, s95, v18
    s_lshl_b32 s96, s65, 16
    v_fmac_f32 v26, s96, v18
    s_and_b32 s93, s65, s92
    v_fmac_f32 v27, s93, v18
    s_lshl_b32 s94, s66, 16
    v_fmac_f32 v24, s94, v19
    s_and_b32 s95, s66, s92
    v_fmac_f32 v25, s95, v19
    s_lshl_b32 s96, s67, 16
    v_fmac_f32 v26, s96, v19
    s_and_b32 s93, s67, s92
    v_fmac_f32 v27, s93, v19
    s_lshl_b32 s94, s68, 16
    v_fmac_f32 v24, s94, v20
    s_and_b32 s95, s68, s92
    v_fmac_f32 v25, s95, v20
    s_lshl_b32 s96, s69, 16
    v_fmac_f32 v26, s96, v20
    s_and_b32 s93, s69, s92
    v_fmac_f32 v27, s93, v20
    s_lshl_b32 s94, s70, 16
    v_fmac_f32 v24, s94, v21
    s_and_b32 s95, s70, s92
    v_fmac_f32 v25, s95, v21
    s_lshl_b32 s96, s71, 16
    v_fmac_f32 v26, s96, v21
    s_and_b32 s93, s71, s92
    v_fmac_f32 v27, s93, v21
    s_lshl_b32 s94, s72, 16
    v_fmac_f32 v24, s94, v22
    s_and_b32 s95, s72, s92
    v_fmac_f32 v25, s95, v22
    s_lshl_b32 s96, s73, 16
    v_fmac_f32 v26, s96, v22
    s_and_b32 s93, s73, s92
    v_fmac_f32 v27, s93, v22
    s_lshl_b32 s94, s74, 16
    v_fmac_f32 v24, s94, v23
    s_and_b32 s95, s74, s92
    v_fmac_f32 v25, s95, v23
    s_lshl_b32 s96, s75, 16
    v_fmac_f32 v26, s96, v23
    s_and_b32 s93, s75, s92
    v_fmac_f32 v27, s93, v23
    s_lshl_b32 s94, s44, 16
    v_mul_f32 v28, s94, v16
    s_and_b32 s95, s44, s92
    v_mul_f32 v29, s95, v16
    s_lshl_b32 s96, s45, 16
    v_mul_f32 v30, s96, v16
    s_and_b32 s93, s45, s92
    v_mul_f32 v31, s93, v16
    s_lshl_b32 s94, s46, 16
    v_fmac_f32 v28, s94, v17
    s_and_b32 s95, s46, s92
    v_fmac_f32 v29, s95, v17
    s_lshl_b32 s96, s47, 16
    v_fmac_f32 v30, s96, v17
    s_and_b32 s93, s47, s92
    v_fmac_f32 v31, s93, v17
    s_lshl_b32 s94, s48, 16
    v_fmac_f32 v28, s94, v18
    s_and_b32 s95, s48, s92
    v_fmac_f32 v29, s95, v18
    s_lshl_b32 s96, s49, 16
    v_fmac_f32 v30, s96, v18
    s_and_b32 s93, s49, s92
    v_fmac_f32 v31, s93, v18
    s_lshl_b32 s94, s50, 16
    v_fmac_f32 v28, s94, v19
    s_and_b32 s95, s50, s92
    v_fmac_f32 v29, s95, v19
    s_lshl_b32 s96, s51, 16
    v_fmac_f32 v30, s96, v19
    s_and_b32 s93, s51, s92
    v_fmac_f32 v31, s93, v19
    s_lshl_b32 s94, s52, 16
    v_fmac_f32 v28, s94, v20
    s_and_b32 s95, s52, s92
    v_fmac_f32 v29, s95, v20
    s_lshl_b32 s96, s53, 16
    v_fmac_f32 v30, s96, v20
    s_and_b32 s93, s53, s92
    v_fmac_f32 v31, s93, v20
    s_lshl_b32 s94, s54, 16
    v_fmac_f32 v28, s94, v21
    s_and_b32 s95, s54, s92
    v_fmac_f32 v29, s95, v21
    s_lshl_b32 s96, s55, 16
    v_fmac_f32 v30, s96, v21
    s_and_b32 s93, s55, s92
    v_fmac_f32 v31, s93, v21
    s_lshl_b32 s94, s56, 16
    v_fmac_f32 v28, s94, v22
    s_and_b32 s95, s56, s92
    v_fmac_f32 v29, s95, v22
    s_lshl_b32 s96, s57, 16
    v_fmac_f32 v30, s96, v22
    s_and_b32 s93, s57, s92
    v_fmac_f32 v31, s93, v22
    s_lshl_b32 s94, s58, 16
    v_fmac_f32 v28, s94, v23
    s_and_b32 s95, s58, s92
    v_fmac_f32 v29, s95, v23
    s_lshl_b32 s96, s59, 16
    v_fmac_f32 v30, s96, v23
    s_and_b32 s93, s59, s92
    v_fmac_f32 v31, s93, v23
    v_cvt_pk_bf16_f32 v28, v28, v29
    v_cvt_pk_bf16_f32 v30, v30, v31
    v_and_b32 v29, s92, v28
    v_lshlrev_b32 v28, 16, v28
    v_and_b32 v31, s92, v30
    v_lshlrev_b32 v30, 16, v30
    s_waitcnt vmcnt(0)
    v_lshlrev_b32 v4, 16, v32
    v_and_b32 v5, s92, v32
    v_lshlrev_b32 v6, 16, v33
    v_and_b32 v7, s92, v33
    v_lshlrev_b32 v8, 16, v34
    v_and_b32 v9, s92, v34
    v_lshlrev_b32 v10, 16, v35
    v_and_b32 v11, s92, v35
    v_add_f32 v4, v4, v8
    v_add_f32 v5, v5, v9
    v_add_f32 v6, v6, v10
    v_add_f32 v7, v7, v11
    v_lshlrev_b32 v8, 16, v36
    v_and_b32 v9, s92, v36
    v_lshlrev_b32 v10, 16, v37
    v_and_b32 v11, s92, v37
    v_add_f32 v4, v4, v8
    v_add_f32 v5, v5, v9
    v_add_f32 v6, v6, v10
    v_add_f32 v7, v7, v11
    v_lshlrev_b32 v8, 16, v38
    v_and_b32 v9, s92, v38
    v_lshlrev_b32 v10, 16, v39
    v_and_b32 v11, s92, v39
    v_add_f32 v4, v4, v8
    v_add_f32 v5, v5, v9
    v_add_f32 v6, v6, v10
    v_add_f32 v7, v7, v11
    s_lshl_b32 s94, s76, 16
    v_mul_f32 v8, s94, v4
    s_and_b32 s95, s76, s92
    v_mul_f32 v9, s95, v4
    s_lshl_b32 s96, s77, 16
    v_mul_f32 v10, s96, v4
    s_and_b32 s93, s77, s92
    v_mul_f32 v11, s93, v4
    s_lshl_b32 s94, s78, 16
    v_fmac_f32 v8, s94, v5
    s_and_b32 s95, s78, s92
    v_fmac_f32 v9, s95, v5
    s_lshl_b32 s96, s79, 16
    v_fmac_f32 v10, s96, v5
    s_and_b32 s93, s79, s92
    v_fmac_f32 v11, s93, v5
    s_lshl_b32 s94, s80, 16
    v_fmac_f32 v8, s94, v6
    s_and_b32 s95, s80, s92
    v_fmac_f32 v9, s95, v6
    s_lshl_b32 s96, s81, 16
    v_fmac_f32 v10, s96, v6
    s_and_b32 s93, s81, s92
    v_fmac_f32 v11, s93, v6
    s_lshl_b32 s94, s82, 16
    v_fmac_f32 v8, s94, v7
    s_and_b32 s95, s82, s92
    v_fmac_f32 v9, s95, v7
    s_lshl_b32 s96, s83, 16
    v_fmac_f32 v10, s96, v7
    s_and_b32 s93, s83, s92
    v_fmac_f32 v11, s93, v7
    v_mul_f32 v24, v24, v8
    v_mul_f32 v25, v25, v9
    v_mul_f32 v26, v26, v10
    v_mul_f32 v27, v27, v11
    v_cvt_pk_bf16_f32 v24, v24, v25
    v_cvt_pk_bf16_f32 v26, v26, v27
    v_and_b32 v25, s92, v24
    v_lshlrev_b32 v24, 16, v24
    v_and_b32 v27, s92, v26
    v_lshlrev_b32 v26, 16, v26
    s_lshl_b32 s94, s84, 16
    v_mul_f32 v8, s94, v24
    s_and_b32 s95, s84, s92
    v_mul_f32 v9, s95, v24
    s_lshl_b32 s96, s85, 16
    v_mul_f32 v10, s96, v24
    s_and_b32 s93, s85, s92
    v_mul_f32 v11, s93, v24
    s_lshl_b32 s94, s86, 16
    v_fmac_f32 v8, s94, v25
    s_and_b32 s95, s86, s92
    v_fmac_f32 v9, s95, v25
    s_lshl_b32 s96, s87, 16
    v_fmac_f32 v10, s96, v25
    s_and_b32 s93, s87, s92
    v_fmac_f32 v11, s93, v25
    s_lshl_b32 s94, s88, 16
    v_fmac_f32 v8, s94, v26
    s_and_b32 s95, s88, s92
    v_fmac_f32 v9, s95, v26
    s_lshl_b32 s96, s89, 16
    v_fmac_f32 v10, s96, v26
    s_and_b32 s93, s89, s92
    v_fmac_f32 v11, s93, v26
    s_lshl_b32 s94, s90, 16
    v_fmac_f32 v8, s94, v27
    s_and_b32 s95, s90, s92
    v_fmac_f32 v9, s95, v27
    s_lshl_b32 s96, s91, 16
    v_fmac_f32 v10, s96, v27
    s_and_b32 s93, s91, s92
    v_fmac_f32 v11, s93, v27
    v_cvt_pk_bf16_f32 v8, v8, v9
    v_cvt_pk_bf16_f32 v10, v10, v11
    v_and_b32 v9, s92, v8
    v_lshlrev_b32 v8, 16, v8
    v_and_b32 v11, s92, v10
    v_lshlrev_b32 v10, 16, v10
    v_mul_f32 v8, v8, v28
    v_mul_f32 v9, v9, v29
    v_mul_f32 v10, v10, v30
    v_mul_f32 v11, v11, v31
    v_cvt_pk_bf16_f32 v8, v8, v9
    v_cvt_pk_bf16_f32 v10, v10, v11
    v_and_b32 v9, s92, v8
    v_lshlrev_b32 v8, 16, v8
    v_and_b32 v11, s92, v10
    v_lshlrev_b32 v10, 16, v10
    v_lshlrev_b32 v4, 16, v12
    v_and_b32 v5, s92, v12
    v_lshlrev_b32 v6, 16, v13
    v_and_b32 v7, s92, v13
    v_add_f32 v4, v4, v8
    v_add_f32 v5, v5, v9
    v_add_f32 v6, v6, v10
    v_add_f32 v7, v7, v11
    v_cvt_pk_bf16_f32 v4, v4, v5
    v_cvt_pk_bf16_f32 v5, v6, v7
    buffer_store_dwordx2 v[4:5], v2, s[32:35], 0 offen
p3_end:
    s_endpgm
.section .rodata,"a"
.p2align 6
.amdhsa_kernel p1_kernel
  .amdhsa_next_free_vgpr 128
  .amdhsa_next_free_sgpr 72
  .amdhsa_accum_offset 128
  .amdhsa_group_segment_fixed_size 0
  .amdhsa_kernarg_size 112
  .amdhsa_user_sgpr_count 2
  .amdhsa_user_sgpr_kernarg_segment_ptr 1
  .amdhsa_system_sgpr_workgroup_id_x 1
  .amdhsa_float_denorm_mode_32 3
.end_amdhsa_kernel
.p2align 6
.amdhsa_kernel p2_kernel
  .amdhsa_next_free_vgpr 128
  .amdhsa_next_free_sgpr 72
  .amdhsa_accum_offset 128
  .amdhsa_group_segment_fixed_size 0
  .amdhsa_kernarg_size 112
  .amdhsa_user_sgpr_count 2
  .amdhsa_user_sgpr_kernarg_segment_ptr 1
  .amdhsa_system_sgpr_workgroup_id_x 1
  .amdhsa_float_denorm_mode_32 3
.end_amdhsa_kernel
.p2align 6
.amdhsa_kernel p3_kernel
  .amdhsa_next_free_vgpr 40
  .amdhsa_next_free_sgpr 100
  .amdhsa_accum_offset 40
  .amdhsa_group_segment_fixed_size 0
  .amdhsa_kernarg_size 112
  .amdhsa_user_sgpr_count 2
  .amdhsa_user_sgpr_kernarg_segment_ptr 1
  .amdhsa_system_sgpr_workgroup_id_x 1
  .amdhsa_float_denorm_mode_32 3
.end_amdhsa_kernel
```

```asm
; @launch kernel=p1_kernel grid=(256,1,1) block=(1024,1,1) lds=161280
; @launch kernel=p2_kernel grid=(256,1,1) block=(1024,1,1) lds=154368
; @launch kernel=p3_kernel grid=(3125,1,1) block=(256,1,1) lds=0
.amdgcn_target "amdgcn-amd-amdhsa--gfx950"
.text
.globl p1_kernel
.p2align 8
.type p1_kernel,@function
p1_kernel:
    s_cmp_ge_u32 s2, 256
    s_cbranch_scc1 p1_end
    s_load_dwordx2 s[52:53], s[0:1], 0
    s_load_dwordx4 s[56:59], s[0:1], 8
    s_load_dwordx2 s[54:55], s[0:1], 32
    s_load_dwordx2 s[60:61], s[0:1], 48
    s_load_dwordx2 s[48:49], s[0:1], 104
    v_lshlrev_b32 v1, 4, v0
    v_lshlrev_b32 v2, 3, v0
    v_mov_b32 v3, 1
    v_lshrrev_b32 v117, 6, v0
    s_nop 0
    v_readfirstlane_b32 s28, v117
    s_waitcnt lgkmcnt(0)
    s_load_dword s41, s[60:61], 0
    s_mov_b32 s24, s52
    s_and_b32 s25, s53, 0xffff
    s_mov_b32 s26, 6400000
    s_mov_b32 s27, 0x20000
    s_mov_b32 s4, s56
    s_and_b32 s5, s57, 0xffff
    s_mov_b32 s6, 204800000
    s_mov_b32 s7, 0x20000
    s_mov_b32 s8, s58
    s_and_b32 s9, s59, 0xffff
    s_mov_b32 s10, 204800000
    s_mov_b32 s11, 0x20000
    s_mov_b32 s12, s54
    s_and_b32 s13, s55, 0xffff
    s_mov_b32 s14, 102400000
    s_mov_b32 s15, 0x20000
    s_mov_b32 s16, s48
    s_and_b32 s17, s49, 0xffff
    s_mov_b32 s18, 819200000
    s_mov_b32 s19, 0x20000
    s_mov_b32 s20, s48
    s_and_b32 s21, s49, 0xffff
    s_mov_b32 s22, 0
    s_mov_b32 s23, 0x20000
    s_mov_b32 s36, 643827
    s_mov_b32 s37, 214609
    s_mov_b32 s38, 343268
    s_mov_b32 s39, -6671
    s_mov_b32 s40, -12512
    s_mov_b32 s42, 0x03800000
    s_mov_b32 s43, 8323199
    s_mov_b32 s44, 4294901760
    s_mov_b32 s45, 57344
    s_waitcnt lgkmcnt(0)
    s_lshl_b32 s41, s41, 16
    s_and_b32 s68, s2, 7
    s_lshl_b32 s68, s68, 8
    s_and_b32 s46, s2, 0xf8
    s_or_b32 s68, s68, s46
    s_mov_b32 s46, 0
    s_cmp_lt_u32 s46, 5
    s_cselect_b32 s34, 7, 6
    s_mul_i32 s47, s46, 391
    s_sub_i32 s50, s46, 5
    s_max_i32 s50, s50, 0
    s_sub_u32 s47, s47, s50
    s_lshl_b32 s47, s47, 8
    s_add_u32 s50, s34, 384
    s_mul_i32 s50, s50, s2
    s_add_u32 s47, s47, s50
    s_lshl_b32 s30, s47, 8
    s_lshl_b32 s31, s47, 7
    s_add_u32 s32, s30, 0
    buffer_load_dwordx4 v[4:7], v1, s[4:7], s32 offen nt
    buffer_load_dwordx4 v[28:31], v1, s[8:11], s32 offen nt
    s_add_u32 s32, s31, 0
    buffer_load_dwordx2 v[52:53], v2, s[12:15], s32 offen nt
    s_add_u32 s32, s30, 16384
    buffer_load_dwordx4 v[8:11], v1, s[4:7], s32 offen nt
    buffer_load_dwordx4 v[32:35], v1, s[8:11], s32 offen nt
    s_add_u32 s32, s31, 8192
    buffer_load_dwordx2 v[54:55], v2, s[12:15], s32 offen nt
    s_add_u32 s32, s30, 32768
    buffer_load_dwordx4 v[12:15], v1, s[4:7], s32 offen nt
    buffer_load_dwordx4 v[36:39], v1, s[8:11], s32 offen nt
    s_add_u32 s32, s31, 16384
    buffer_load_dwordx2 v[56:57], v2, s[12:15], s32 offen nt
    s_add_u32 s32, s30, 49152
    buffer_load_dwordx4 v[16:19], v1, s[4:7], s32 offen nt
    buffer_load_dwordx4 v[40:43], v1, s[8:11], s32 offen nt
    s_add_u32 s32, s31, 24576
    buffer_load_dwordx2 v[58:59], v2, s[12:15], s32 offen nt
    s_add_u32 s32, s30, 65536
    buffer_load_dwordx4 v[20:23], v1, s[4:7], s32 offen nt
    buffer_load_dwordx4 v[44:47], v1, s[8:11], s32 offen nt
    s_add_u32 s32, s31, 32768
    buffer_load_dwordx2 v[60:61], v2, s[12:15], s32 offen nt
    s_add_u32 s32, s30, 81920
    buffer_load_dwordx4 v[24:27], v1, s[4:7], s32 offen nt
    buffer_load_dwordx4 v[48:51], v1, s[8:11], s32 offen nt
    s_add_u32 s32, s31, 40960
    buffer_load_dwordx2 v[62:63], v2, s[12:15], s32 offen nt
    s_cmp_lt_u32 s28, s34
    s_cselect_b32 s46, 0, 0x40000000
    v_lshl_add_u32 v117, v0, 2, s46
    s_add_u32 s32, s30, 98304
    buffer_load_dword v64, v117, s[4:7], s32 offen nt
    buffer_load_dword v65, v117, s[8:11], s32 offen nt
    v_lshrrev_b32 v117, 1, v117
    s_add_u32 s32, s31, 49152
    buffer_load_ushort v66, v117, s[12:15], s32 offen nt
    v_mov_b32 v68, 0
    v_mov_b32 v69, 0
    v_mov_b32 v70, 0
    v_mov_b32 v71, 0
    ds_write_b128 v1, v[68:71] offset:0
    v_and_b32 v118, 63, v0
    v_mov_b32 v121, 0
    v_mov_b32 v122, 0
    s_lshl_b32 s52, s2, 4
    s_add_u32 s52, s52, s28
    s_mov_b32 s57, 0x7fff7fff
    s_mul_hi_u32 s54, s52, 89478486
    s_mul_i32 s55, s54, 48
    s_sub_u32 s55, s52, s55
    s_mul_i32 s55, s55, 1024
    s_add_u32 s55, s55, 0
    s_mul_i32 s56, s54, 53368
    s_add_u32 s56, s56, s55
    v_lshl_add_u32 v119, v118, 2, s56
    s_mul_i32 s56, s54, 53760
    s_add_u32 s56, s56, s55
    s_add_u32 s56, s56, 350650368
    v_lshl_add_u32 v120, v118, 4, s56
    buffer_load_dword v72, v119, s[24:27], 0 offen offset:0
    buffer_load_dword v73, v119, s[24:27], 0 offen offset:256
    buffer_load_dword v74, v119, s[24:27], 0 offen offset:512
    buffer_load_dword v75, v119, s[24:27], 0 offen offset:768
    s_waitcnt vmcnt(0)
    buffer_store_dwordx4 v[72:75], v120, s[16:19], 0 offen
    v_and_b32 v123, s57, v72
    v_pk_max_u16 v121, v121, v123
    v_lshlrev_b32 v124, 16, v123
    v_and_b32 v123, s44, v123
    v_fmac_f32 v122, v124, v124
    v_fmac_f32 v122, v123, v123
    v_and_b32 v123, s57, v73
    v_pk_max_u16 v121, v121, v123
    v_lshlrev_b32 v124, 16, v123
    v_and_b32 v123, s44, v123
    v_fmac_f32 v122, v124, v124
    v_fmac_f32 v122, v123, v123
    v_and_b32 v123, s57, v74
    v_pk_max_u16 v121, v121, v123
    v_lshlrev_b32 v124, 16, v123
    v_and_b32 v123, s44, v123
    v_fmac_f32 v122, v124, v124
    v_fmac_f32 v122, v123, v123
    v_and_b32 v123, s57, v75
    v_pk_max_u16 v121, v121, v123
    v_lshlrev_b32 v124, 16, v123
    v_and_b32 v123, s44, v123
    v_fmac_f32 v122, v124, v124
    v_fmac_f32 v122, v123, v123
    s_cmp_ge_u32 s52, 1664
    s_cbranch_scc1 p1_m2
    s_add_u32 s53, s52, 4096
    s_mul_hi_u32 s54, s53, 89478486
    s_mul_i32 s55, s54, 48
    s_sub_u32 s55, s53, s55
    s_mul_i32 s55, s55, 1024
    s_add_u32 s55, s55, 0
    s_mul_i32 s56, s54, 53368
    s_add_u32 s56, s56, s55
    v_lshl_add_u32 v119, v118, 2, s56
    s_mul_i32 s56, s54, 53760
    s_add_u32 s56, s56, s55
    s_add_u32 s56, s56, 350650368
    v_lshl_add_u32 v120, v118, 4, s56
    buffer_load_dword v72, v119, s[24:27], 0 offen offset:0
    buffer_load_dword v73, v119, s[24:27], 0 offen offset:256
    buffer_load_dword v74, v119, s[24:27], 0 offen offset:512
    buffer_load_dword v75, v119, s[24:27], 0 offen offset:768
    s_waitcnt vmcnt(0)
    buffer_store_dwordx4 v[72:75], v120, s[16:19], 0 offen
    v_and_b32 v123, s57, v72
    v_pk_max_u16 v121, v121, v123
    v_lshlrev_b32 v124, 16, v123
    v_and_b32 v123, s44, v123
    v_fmac_f32 v122, v124, v124
    v_fmac_f32 v122, v123, v123
    v_and_b32 v123, s57, v73
    v_pk_max_u16 v121, v121, v123
    v_lshlrev_b32 v124, 16, v123
    v_and_b32 v123, s44, v123
    v_fmac_f32 v122, v124, v124
    v_fmac_f32 v122, v123, v123
    v_and_b32 v123, s57, v74
    v_pk_max_u16 v121, v121, v123
    v_lshlrev_b32 v124, 16, v123
    v_and_b32 v123, s44, v123
    v_fmac_f32 v122, v124, v124
    v_fmac_f32 v122, v123, v123
    v_and_b32 v123, s57, v75
    v_pk_max_u16 v121, v121, v123
    v_lshlrev_b32 v124, 16, v123
    v_and_b32 v123, s44, v123
    v_fmac_f32 v122, v124, v124
    v_fmac_f32 v122, v123, v123
    s_branch p1_m3
p1_m2:
    s_sub_u32 s53, s52, 1664
    s_cmp_ge_u32 s53, 1080
    s_cbranch_scc1 p1_m3
    s_mul_hi_u32 s54, s53, 477218589
    s_mul_i32 s55, s54, 9
    s_sub_u32 s55, s53, s55
    s_mul_i32 s55, s55, 512
    s_add_u32 s55, s55, 49152
    s_mul_i32 s56, s54, 53368
    s_add_u32 s56, s56, s55
    v_lshl_add_u32 v119, v118, 2, s56
    s_mul_i32 s56, s54, 53760
    s_add_u32 s56, s56, s55
    s_add_u32 s56, s56, 350650368
    v_lshl_add_u32 v120, v118, 3, s56
    buffer_load_dword v72, v119, s[24:27], 0 offen offset:0
    buffer_load_dword v73, v119, s[24:27], 0 offen offset:256
    s_waitcnt vmcnt(0)
    buffer_store_dwordx2 v[72:73], v120, s[16:19], 0 offen
    v_and_b32 v123, s57, v72
    v_pk_max_u16 v121, v121, v123
    v_lshlrev_b32 v124, 16, v123
    v_and_b32 v123, s44, v123
    v_fmac_f32 v122, v124, v124
    v_fmac_f32 v122, v123, v123
    v_and_b32 v123, s57, v73
    v_pk_max_u16 v121, v121, v123
    v_lshlrev_b32 v124, 16, v123
    v_and_b32 v123, s44, v123
    v_fmac_f32 v122, v124, v124
    v_fmac_f32 v122, v123, v123
p1_m3:
    v_lshrrev_b32 v123, 16, v121
    v_and_b32 v121, 0xffff, v121
    v_max_u32 v121, v121, v123
    s_nop 1
    v_max_u32_dpp v121, v121, v121 row_shr:1 row_mask:0xf bank_mask:0xf bound_ctrl:0
    v_add_f32_dpp v122, v122, v122 row_shr:1 row_mask:0xf bank_mask:0xf bound_ctrl:0
    s_nop 0
    v_max_u32_dpp v121, v121, v121 row_shr:2 row_mask:0xf bank_mask:0xf bound_ctrl:0
    v_add_f32_dpp v122, v122, v122 row_shr:2 row_mask:0xf bank_mask:0xf bound_ctrl:0
    s_nop 0
    v_max_u32_dpp v121, v121, v121 row_shr:4 row_mask:0xf bank_mask:0xf bound_ctrl:0
    v_add_f32_dpp v122, v122, v122 row_shr:4 row_mask:0xf bank_mask:0xf bound_ctrl:0
    s_nop 0
    v_max_u32_dpp v121, v121, v121 row_shr:8 row_mask:0xf bank_mask:0xf bound_ctrl:0
    v_add_f32_dpp v122, v122, v122 row_shr:8 row_mask:0xf bank_mask:0xf bound_ctrl:0
    s_nop 0
    v_max_u32_dpp v121, v121, v121 row_bcast:15 row_mask:0xa bank_mask:0xf
    v_add_f32_dpp v122, v122, v122 row_bcast:15 row_mask:0xa bank_mask:0xf
    s_nop 0
    v_max_u32_dpp v121, v121, v121 row_bcast:31 row_mask:0xc bank_mask:0xf
    v_add_f32_dpp v122, v122, v122 row_bcast:31 row_mask:0xc bank_mask:0xf
    s_nop 0
    s_nop 0
    v_mov_b32 v72, v121
    v_mov_b32 v73, v122
    s_lshl_b32 s52, s52, 3
    s_add_u32 s52, s52, 357101568
    v_mov_b32 v120, s52
    v_cmp_eq_u32 vcc, 63, v118
    s_and_saveexec_b64 s[54:55], vcc
    buffer_store_dwordx2 v[72:73], v120, s[16:19], 0 offen
    s_mov_b64 exec, -1
    s_mov_b32 s29, 0
    s_waitcnt vmcnt(0) lgkmcnt(0)
    s_barrier
p1_tile:
    s_mov_b32 s33, s34
    s_add_u32 s46, s29, 1
    s_cmp_lt_u32 s46, 5
    s_cselect_b32 s34, 7, 6
    s_mul_i32 s47, s46, 391
    s_sub_i32 s50, s46, 5
    s_max_i32 s50, s50, 0
    s_sub_u32 s47, s47, s50
    s_lshl_b32 s47, s47, 8
    s_add_u32 s50, s34, 384
    s_mul_i32 s50, s50, s2
    s_add_u32 s47, s47, s50
    s_lshl_b32 s30, s47, 8
    s_lshl_b32 s31, s47, 7
    s_cmp_lt_u32 s46, 8
    s_cselect_b32 s6, 204800000, 0
    s_cselect_b32 s10, 204800000, 0
    s_cselect_b32 s14, 102400000, 0
    s_cselect_b32 s30, s30, 0
    s_cselect_b32 s31, s31, 0
    v_mov_b32 v68, 0
    v_mov_b32 v69, 0
    v_mov_b32 v70, 0
    v_mov_b32 v71, 0
    ds_write_b128 v1, v[68:71] offset:10496
    ds_write_b128 v1, v[68:71] offset:26880
    s_waitcnt vmcnt(10)
    v_lshlrev_b32 v117, 16, v52
    v_and_b32 v118, s44, v52
    v_mul_f32 v117, s41, v117
    v_mul_f32 v118, s41, v118
    v_cvt_pk_bf16_f32 v117, v117, v118
    v_and_b32 v118, s44, v117
    v_lshlrev_b32 v117, 16, v117
    v_mul_f32 v117, 0.15915494, v117
    v_mul_f32 v118, 0.15915494, v118
    v_fract_f32 v117, v117
    v_fract_f32 v118, v118
    v_cos_f32 v117, v117
    v_cos_f32 v118, v118
    v_mul_hi_u32_u24 v120, s36, v4
    v_mul_hi_u32_u24 v121, s37, v4
    v_mul_hi_u32_u24 v122, s38, v28
    v_mad_i32_i24 v67, v120, s39, v4
    v_mad_u32_u24 v92, v122, 40, v121
    v_mad_i32_i24 v120, v121, -3, v120
    v_lshlrev_b32 v92, 2, v92
    v_mad_i32_i24 v122, v122, s40, v28
    ds_add_u32 v92, v3 offset:0
    v_lshl_or_b32 v67, v120, 30, v67
    v_lshl_or_b32 v67, v122, 16, v67
    v_mul_f32 v117, s42, v117
    v_mul_f32 v118, s42, v118
    v_cvt_pk_bf16_f32 v117, v117, v118
    v_mul_hi_u32_u24 v123, s36, v5
    v_mul_hi_u32_u24 v124, s37, v5
    v_mul_hi_u32_u24 v125, s38, v29
    v_mad_i32_i24 v68, v123, s39, v5
    v_mad_u32_u24 v93, v125, 40, v124
    v_mad_i32_i24 v123, v124, -3, v123
    v_lshlrev_b32 v93, 2, v93
    v_mad_i32_i24 v125, v125, s40, v29
    ds_add_u32 v93, v3 offset:0
    v_lshl_or_b32 v68, v123, 30, v68
    v_lshl_or_b32 v68, v125, 16, v68
    v_lshrrev_b32 v118, 3, v117
    v_lshrrev_b32 v119, 8, v117
    v_lshlrev_b32 v117, 13, v117
    v_bitop3_b32 v119, v118, v119, s43 bitop3:0x1b
    v_bitop3_b32 v67, v117, s45, v67 bitop3:0xae
    v_lshl_or_b32 v92, v119, 16, v92
    v_bitop3_b32 v68, v118, s45, v68 bitop3:0xae
    v_and_or_b32 v93, v119, s44, v93
    v_lshlrev_b32 v117, 16, v53
    v_and_b32 v118, s44, v53
    v_mul_f32 v117, s41, v117
    v_mul_f32 v118, s41, v118
    v_cvt_pk_bf16_f32 v117, v117, v118
    v_and_b32 v118, s44, v117
    v_lshlrev_b32 v117, 16, v117
    v_mul_f32 v117, 0.15915494, v117
    v_mul_f32 v118, 0.15915494, v118
    v_fract_f32 v117, v117
    v_fract_f32 v118, v118
    v_cos_f32 v117, v117
    v_cos_f32 v118, v118
    v_mul_hi_u32_u24 v120, s36, v6
    v_mul_hi_u32_u24 v121, s37, v6
    v_mul_hi_u32_u24 v122, s38, v30
    v_mad_i32_i24 v69, v120, s39, v6
    v_mad_u32_u24 v94, v122, 40, v121
    v_mad_i32_i24 v120, v121, -3, v120
    v_lshlrev_b32 v94, 2, v94
    v_mad_i32_i24 v122, v122, s40, v30
    ds_add_u32 v94, v3 offset:0
    v_lshl_or_b32 v69, v120, 30, v69
    v_lshl_or_b32 v69, v122, 16, v69
    v_mul_f32 v117, s42, v117
    v_mul_f32 v118, s42, v118
    v_cvt_pk_bf16_f32 v117, v117, v118
    v_mul_hi_u32_u24 v123, s36, v7
    v_mul_hi_u32_u24 v124, s37, v7
    v_mul_hi_u32_u24 v125, s38, v31
    v_mad_i32_i24 v70, v123, s39, v7
    v_mad_u32_u24 v95, v125, 40, v124
    v_mad_i32_i24 v123, v124, -3, v123
    v_lshlrev_b32 v95, 2, v95
    v_mad_i32_i24 v125, v125, s40, v31
    ds_add_u32 v95, v3 offset:0
    v_lshl_or_b32 v70, v123, 30, v70
    v_lshl_or_b32 v70, v125, 16, v70
    v_lshrrev_b32 v118, 3, v117
    v_lshrrev_b32 v119, 8, v117
    v_lshlrev_b32 v117, 13, v117
    v_bitop3_b32 v119, v118, v119, s43 bitop3:0x1b
    v_bitop3_b32 v69, v117, s45, v69 bitop3:0xae
    v_lshl_or_b32 v94, v119, 16, v94
    v_bitop3_b32 v70, v118, s45, v70 bitop3:0xae
    v_and_or_b32 v95, v119, s44, v95
    v_lshlrev_b32 v117, 16, v54
    v_and_b32 v118, s44, v54
    v_mul_f32 v117, s41, v117
    v_mul_f32 v118, s41, v118
    v_cvt_pk_bf16_f32 v117, v117, v118
    v_and_b32 v118, s44, v117
    v_lshlrev_b32 v117, 16, v117
    v_mul_f32 v117, 0.15915494, v117
    v_mul_f32 v118, 0.15915494, v118
    v_fract_f32 v117, v117
    v_fract_f32 v118, v118
    v_cos_f32 v117, v117
    v_cos_f32 v118, v118
    v_mul_hi_u32_u24 v120, s36, v8
    v_mul_hi_u32_u24 v121, s37, v8
    v_mul_hi_u32_u24 v122, s38, v32
    v_mad_i32_i24 v71, v120, s39, v8
    v_mad_u32_u24 v96, v122, 40, v121
    v_mad_i32_i24 v120, v121, -3, v120
    v_lshlrev_b32 v96, 2, v96
    v_mad_i32_i24 v122, v122, s40, v32
    ds_add_u32 v96, v3 offset:0
    v_lshl_or_b32 v71, v120, 30, v71
    v_lshl_or_b32 v71, v122, 16, v71
    v_mul_f32 v117, s42, v117
    v_mul_f32 v118, s42, v118
    v_cvt_pk_bf16_f32 v117, v117, v118
    v_mul_hi_u32_u24 v123, s36, v9
    v_mul_hi_u32_u24 v124, s37, v9
    v_mul_hi_u32_u24 v125, s38, v33
    v_mad_i32_i24 v72, v123, s39, v9
    v_mad_u32_u24 v97, v125, 40, v124
    v_mad_i32_i24 v123, v124, -3, v123
    v_lshlrev_b32 v97, 2, v97
    v_mad_i32_i24 v125, v125, s40, v33
    ds_add_u32 v97, v3 offset:0
    v_lshl_or_b32 v72, v123, 30, v72
    v_lshl_or_b32 v72, v125, 16, v72
    v_lshrrev_b32 v118, 3, v117
    v_lshrrev_b32 v119, 8, v117
    v_lshlrev_b32 v117, 13, v117
    v_bitop3_b32 v119, v118, v119, s43 bitop3:0x1b
    v_bitop3_b32 v71, v117, s45, v71 bitop3:0xae
    v_lshl_or_b32 v96, v119, 16, v96
    v_bitop3_b32 v72, v118, s45, v72 bitop3:0xae
    v_and_or_b32 v97, v119, s44, v97
    v_lshlrev_b32 v117, 16, v55
    v_and_b32 v118, s44, v55
    v_mul_f32 v117, s41, v117
    v_mul_f32 v118, s41, v118
    v_cvt_pk_bf16_f32 v117, v117, v118
    v_and_b32 v118, s44, v117
    v_lshlrev_b32 v117, 16, v117
    v_mul_f32 v117, 0.15915494, v117
    v_mul_f32 v118, 0.15915494, v118
    v_fract_f32 v117, v117
    v_fract_f32 v118, v118
    v_cos_f32 v117, v117
    v_cos_f32 v118, v118
    v_mul_hi_u32_u24 v120, s36, v10
    v_mul_hi_u32_u24 v121, s37, v10
    v_mul_hi_u32_u24 v122, s38, v34
    v_mad_i32_i24 v73, v120, s39, v10
    v_mad_u32_u24 v98, v122, 40, v121
    v_mad_i32_i24 v120, v121, -3, v120
    v_lshlrev_b32 v98, 2, v98
    v_mad_i32_i24 v122, v122, s40, v34
    ds_add_u32 v98, v3 offset:0
    v_lshl_or_b32 v73, v120, 30, v73
    v_lshl_or_b32 v73, v122, 16, v73
    v_mul_f32 v117, s42, v117
    v_mul_f32 v118, s42, v118
    v_cvt_pk_bf16_f32 v117, v117, v118
    v_mul_hi_u32_u24 v123, s36, v11
    v_mul_hi_u32_u24 v124, s37, v11
    v_mul_hi_u32_u24 v125, s38, v35
    v_mad_i32_i24 v74, v123, s39, v11
    v_mad_u32_u24 v99, v125, 40, v124
    v_mad_i32_i24 v123, v124, -3, v123
    v_lshlrev_b32 v99, 2, v99
    v_mad_i32_i24 v125, v125, s40, v35
    ds_add_u32 v99, v3 offset:0
    v_lshl_or_b32 v74, v123, 30, v74
    v_lshl_or_b32 v74, v125, 16, v74
    v_lshrrev_b32 v118, 3, v117
    v_lshrrev_b32 v119, 8, v117
    v_lshlrev_b32 v117, 13, v117
    v_bitop3_b32 v119, v118, v119, s43 bitop3:0x1b
    v_bitop3_b32 v73, v117, s45, v73 bitop3:0xae
    v_lshl_or_b32 v98, v119, 16, v98
    v_bitop3_b32 v74, v118, s45, v74 bitop3:0xae
    v_and_or_b32 v99, v119, s44, v99
    s_waitcnt lgkmcnt(4)
    v_lshlrev_b32 v117, 16, v56
    v_and_b32 v118, s44, v56
    v_mul_f32 v117, s41, v117
    v_mul_f32 v118, s41, v118
    v_cvt_pk_bf16_f32 v117, v117, v118
    v_and_b32 v118, s44, v117
    v_lshlrev_b32 v117, 16, v117
    v_mul_f32 v117, 0.15915494, v117
    v_mul_f32 v118, 0.15915494, v118
    v_fract_f32 v117, v117
    v_fract_f32 v118, v118
    v_cos_f32 v117, v117
    v_cos_f32 v118, v118
    v_mul_hi_u32_u24 v120, s36, v12
    v_mul_hi_u32_u24 v121, s37, v12
    v_mul_hi_u32_u24 v122, s38, v36
    v_mad_i32_i24 v75, v120, s39, v12
    v_mad_u32_u24 v100, v122, 40, v121
    v_mad_i32_i24 v120, v121, -3, v120
    v_lshlrev_b32 v100, 2, v100
    v_mad_i32_i24 v122, v122, s40, v36
    ds_add_u32 v100, v3 offset:0
    v_lshl_or_b32 v75, v120, 30, v75
    v_lshl_or_b32 v75, v122, 16, v75
    v_mul_f32 v117, s42, v117
    v_mul_f32 v118, s42, v118
    v_cvt_pk_bf16_f32 v117, v117, v118
    v_mul_hi_u32_u24 v123, s36, v13
    v_mul_hi_u32_u24 v124, s37, v13
    v_mul_hi_u32_u24 v125, s38, v37
    v_mad_i32_i24 v76, v123, s39, v13
    v_mad_u32_u24 v101, v125, 40, v124
    v_mad_i32_i24 v123, v124, -3, v123
    v_lshlrev_b32 v101, 2, v101
    v_mad_i32_i24 v125, v125, s40, v37
    ds_add_u32 v101, v3 offset:0
    v_lshl_or_b32 v76, v123, 30, v76
    v_lshl_or_b32 v76, v125, 16, v76
    v_lshrrev_b32 v118, 3, v117
    v_lshrrev_b32 v119, 8, v117
    v_lshlrev_b32 v117, 13, v117
    v_bitop3_b32 v119, v118, v119, s43 bitop3:0x1b
    v_bitop3_b32 v75, v117, s45, v75 bitop3:0xae
    v_lshl_or_b32 v100, v119, 16, v100
    v_bitop3_b32 v76, v118, s45, v76 bitop3:0xae
    v_and_or_b32 v101, v119, s44, v101
    v_lshlrev_b32 v117, 16, v57
    v_and_b32 v118, s44, v57
    v_mul_f32 v117, s41, v117
    v_mul_f32 v118, s41, v118
    v_cvt_pk_bf16_f32 v117, v117, v118
    v_and_b32 v118, s44, v117
    v_lshlrev_b32 v117, 16, v117
    v_mul_f32 v117, 0.15915494, v117
    v_mul_f32 v118, 0.15915494, v118
    v_fract_f32 v117, v117
    v_fract_f32 v118, v118
    v_cos_f32 v117, v117
    v_cos_f32 v118, v118
    v_mul_hi_u32_u24 v120, s36, v14
    v_mul_hi_u32_u24 v121, s37, v14
    v_mul_hi_u32_u24 v122, s38, v38
    v_mad_i32_i24 v77, v120, s39, v14
    v_mad_u32_u24 v102, v122, 40, v121
    v_mad_i32_i24 v120, v121, -3, v120
    v_lshlrev_b32 v102, 2, v102
    v_mad_i32_i24 v122, v122, s40, v38
    ds_add_u32 v102, v3 offset:0
    v_lshl_or_b32 v77, v120, 30, v77
    v_lshl_or_b32 v77, v122, 16, v77
    v_mul_f32 v117, s42, v117
    v_mul_f32 v118, s42, v118
    v_cvt_pk_bf16_f32 v117, v117, v118
    v_mul_hi_u32_u24 v123, s36, v15
    v_mul_hi_u32_u24 v124, s37, v15
    v_mul_hi_u32_u24 v125, s38, v39
    v_mad_i32_i24 v78, v123, s39, v15
    v_mad_u32_u24 v103, v125, 40, v124
    v_mad_i32_i24 v123, v124, -3, v123
    v_lshlrev_b32 v103, 2, v103
    v_mad_i32_i24 v125, v125, s40, v39
    ds_add_u32 v103, v3 offset:0
    v_lshl_or_b32 v78, v123, 30, v78
    v_lshl_or_b32 v78, v125, 16, v78
    v_lshrrev_b32 v118, 3, v117
    v_lshrrev_b32 v119, 8, v117
    v_lshlrev_b32 v117, 13, v117
    v_bitop3_b32 v119, v118, v119, s43 bitop3:0x1b
    v_bitop3_b32 v77, v117, s45, v77 bitop3:0xae
    v_lshl_or_b32 v102, v119, 16, v102
    v_bitop3_b32 v78, v118, s45, v78 bitop3:0xae
    v_and_or_b32 v103, v119, s44, v103
    s_add_u32 s32, s30, 0
    buffer_load_dwordx4 v[4:7], v1, s[4:7], s32 offen nt
    buffer_load_dwordx4 v[28:31], v1, s[8:11], s32 offen nt
    s_add_u32 s32, s31, 0
    buffer_load_dwordx2 v[52:53], v2, s[12:15], s32 offen nt
    v_lshlrev_b32 v117, 16, v58
    v_and_b32 v118, s44, v58
    v_mul_f32 v117, s41, v117
    v_mul_f32 v118, s41, v118
    v_cvt_pk_bf16_f32 v117, v117, v118
    v_and_b32 v118, s44, v117
    v_lshlrev_b32 v117, 16, v117
    v_mul_f32 v117, 0.15915494, v117
    v_mul_f32 v118, 0.15915494, v118
    v_fract_f32 v117, v117
    v_fract_f32 v118, v118
    v_cos_f32 v117, v117
    v_cos_f32 v118, v118
    v_mul_hi_u32_u24 v120, s36, v16
    v_mul_hi_u32_u24 v121, s37, v16
    v_mul_hi_u32_u24 v122, s38, v40
    v_mad_i32_i24 v79, v120, s39, v16
    v_mad_u32_u24 v104, v122, 40, v121
    v_mad_i32_i24 v120, v121, -3, v120
    v_lshlrev_b32 v104, 2, v104
    v_mad_i32_i24 v122, v122, s40, v40
    ds_add_u32 v104, v3 offset:0
    v_lshl_or_b32 v79, v120, 30, v79
    v_lshl_or_b32 v79, v122, 16, v79
    v_mul_f32 v117, s42, v117
    v_mul_f32 v118, s42, v118
    v_cvt_pk_bf16_f32 v117, v117, v118
    v_mul_hi_u32_u24 v123, s36, v17
    v_mul_hi_u32_u24 v124, s37, v17
    v_mul_hi_u32_u24 v125, s38, v41
    v_mad_i32_i24 v80, v123, s39, v17
    v_mad_u32_u24 v105, v125, 40, v124
    v_mad_i32_i24 v123, v124, -3, v123
    v_lshlrev_b32 v105, 2, v105
    v_mad_i32_i24 v125, v125, s40, v41
    ds_add_u32 v105, v3 offset:0
    v_lshl_or_b32 v80, v123, 30, v80
    v_lshl_or_b32 v80, v125, 16, v80
    v_lshrrev_b32 v118, 3, v117
    v_lshrrev_b32 v119, 8, v117
    v_lshlrev_b32 v117, 13, v117
    v_bitop3_b32 v119, v118, v119, s43 bitop3:0x1b
    v_bitop3_b32 v79, v117, s45, v79 bitop3:0xae
    v_lshl_or_b32 v104, v119, 16, v104
    v_bitop3_b32 v80, v118, s45, v80 bitop3:0xae
    v_and_or_b32 v105, v119, s44, v105
    v_lshlrev_b32 v117, 16, v59
    v_and_b32 v118, s44, v59
    v_mul_f32 v117, s41, v117
    v_mul_f32 v118, s41, v118
    v_cvt_pk_bf16_f32 v117, v117, v118
    v_and_b32 v118, s44, v117
    v_lshlrev_b32 v117, 16, v117
    v_mul_f32 v117, 0.15915494, v117
    v_mul_f32 v118, 0.15915494, v118
    v_fract_f32 v117, v117
    v_fract_f32 v118, v118
    v_cos_f32 v117, v117
    v_cos_f32 v118, v118
    v_mul_hi_u32_u24 v120, s36, v18
    v_mul_hi_u32_u24 v121, s37, v18
    v_mul_hi_u32_u24 v122, s38, v42
    v_mad_i32_i24 v81, v120, s39, v18
    v_mad_u32_u24 v106, v122, 40, v121
    v_mad_i32_i24 v120, v121, -3, v120
    v_lshlrev_b32 v106, 2, v106
    v_mad_i32_i24 v122, v122, s40, v42
    ds_add_u32 v106, v3 offset:0
    v_lshl_or_b32 v81, v120, 30, v81
    v_lshl_or_b32 v81, v122, 16, v81
    v_mul_f32 v117, s42, v117
    v_mul_f32 v118, s42, v118
    v_cvt_pk_bf16_f32 v117, v117, v118
    v_mul_hi_u32_u24 v123, s36, v19
    v_mul_hi_u32_u24 v124, s37, v19
    v_mul_hi_u32_u24 v125, s38, v43
    v_mad_i32_i24 v82, v123, s39, v19
    v_mad_u32_u24 v107, v125, 40, v124
    v_mad_i32_i24 v123, v124, -3, v123
    v_lshlrev_b32 v107, 2, v107
    v_mad_i32_i24 v125, v125, s40, v43
    ds_add_u32 v107, v3 offset:0
    v_lshl_or_b32 v82, v123, 30, v82
    v_lshl_or_b32 v82, v125, 16, v82
    v_lshrrev_b32 v118, 3, v117
    v_lshrrev_b32 v119, 8, v117
    v_lshlrev_b32 v117, 13, v117
    v_bitop3_b32 v119, v118, v119, s43 bitop3:0x1b
    v_bitop3_b32 v81, v117, s45, v81 bitop3:0xae
    v_lshl_or_b32 v106, v119, 16, v106
    v_bitop3_b32 v82, v118, s45, v82 bitop3:0xae
    v_and_or_b32 v107, v119, s44, v107
    s_waitcnt lgkmcnt(4)
    v_lshlrev_b32 v117, 16, v60
    v_and_b32 v118, s44, v60
    v_mul_f32 v117, s41, v117
    v_mul_f32 v118, s41, v118
    v_cvt_pk_bf16_f32 v117, v117, v118
    v_and_b32 v118, s44, v117
    v_lshlrev_b32 v117, 16, v117
    v_mul_f32 v117, 0.15915494, v117
    v_mul_f32 v118, 0.15915494, v118
    v_fract_f32 v117, v117
    v_fract_f32 v118, v118
    v_cos_f32 v117, v117
    v_cos_f32 v118, v118
    v_mul_hi_u32_u24 v120, s36, v20
    v_mul_hi_u32_u24 v121, s37, v20
    v_mul_hi_u32_u24 v122, s38, v44
    v_mad_i32_i24 v83, v120, s39, v20
    v_mad_u32_u24 v108, v122, 40, v121
    v_mad_i32_i24 v120, v121, -3, v120
    v_lshlrev_b32 v108, 2, v108
    v_mad_i32_i24 v122, v122, s40, v44
    ds_add_u32 v108, v3 offset:0
    v_lshl_or_b32 v83, v120, 30, v83
    v_lshl_or_b32 v83, v122, 16, v83
    v_mul_f32 v117, s42, v117
    v_mul_f32 v118, s42, v118
    v_cvt_pk_bf16_f32 v117, v117, v118
    v_mul_hi_u32_u24 v123, s36, v21
    v_mul_hi_u32_u24 v124, s37, v21
    v_mul_hi_u32_u24 v125, s38, v45
    v_mad_i32_i24 v84, v123, s39, v21
    v_mad_u32_u24 v109, v125, 40, v124
    v_mad_i32_i24 v123, v124, -3, v123
    v_lshlrev_b32 v109, 2, v109
    v_mad_i32_i24 v125, v125, s40, v45
    ds_add_u32 v109, v3 offset:0
    v_lshl_or_b32 v84, v123, 30, v84
    v_lshl_or_b32 v84, v125, 16, v84
    v_lshrrev_b32 v118, 3, v117
    v_lshrrev_b32 v119, 8, v117
    v_lshlrev_b32 v117, 13, v117
    v_bitop3_b32 v119, v118, v119, s43 bitop3:0x1b
    v_bitop3_b32 v83, v117, s45, v83 bitop3:0xae
    v_lshl_or_b32 v108, v119, 16, v108
    v_bitop3_b32 v84, v118, s45, v84 bitop3:0xae
    v_and_or_b32 v109, v119, s44, v109
    v_lshlrev_b32 v117, 16, v61
    v_and_b32 v118, s44, v61
    v_mul_f32 v117, s41, v117
    v_mul_f32 v118, s41, v118
    v_cvt_pk_bf16_f32 v117, v117, v118
    v_and_b32 v118, s44, v117
    v_lshlrev_b32 v117, 16, v117
    v_mul_f32 v117, 0.15915494, v117
    v_mul_f32 v118, 0.15915494, v118
    v_fract_f32 v117, v117
    v_fract_f32 v118, v118
    v_cos_f32 v117, v117
    v_cos_f32 v118, v118
    v_mul_hi_u32_u24 v120, s36, v22
    v_mul_hi_u32_u24 v121, s37, v22
    v_mul_hi_u32_u24 v122, s38, v46
    v_mad_i32_i24 v85, v120, s39, v22
    v_mad_u32_u24 v110, v122, 40, v121
    v_mad_i32_i24 v120, v121, -3, v120
    v_lshlrev_b32 v110, 2, v110
    v_mad_i32_i24 v122, v122, s40, v46
    ds_add_u32 v110, v3 offset:0
    v_lshl_or_b32 v85, v120, 30, v85
    v_lshl_or_b32 v85, v122, 16, v85
    v_mul_f32 v117, s42, v117
    v_mul_f32 v118, s42, v118
    v_cvt_pk_bf16_f32 v117, v117, v118
    v_mul_hi_u32_u24 v123, s36, v23
    v_mul_hi_u32_u24 v124, s37, v23
    v_mul_hi_u32_u24 v125, s38, v47
    v_mad_i32_i24 v86, v123, s39, v23
    v_mad_u32_u24 v111, v125, 40, v124
    v_mad_i32_i24 v123, v124, -3, v123
    v_lshlrev_b32 v111, 2, v111
    v_mad_i32_i24 v125, v125, s40, v47
    ds_add_u32 v111, v3 offset:0
    v_lshl_or_b32 v86, v123, 30, v86
    v_lshl_or_b32 v86, v125, 16, v86
    v_lshrrev_b32 v118, 3, v117
    v_lshrrev_b32 v119, 8, v117
    v_lshlrev_b32 v117, 13, v117
    v_bitop3_b32 v119, v118, v119, s43 bitop3:0x1b
    v_bitop3_b32 v85, v117, s45, v85 bitop3:0xae
    v_lshl_or_b32 v110, v119, 16, v110
    v_bitop3_b32 v86, v118, s45, v86 bitop3:0xae
    v_and_or_b32 v111, v119, s44, v111
    v_lshlrev_b32 v117, 16, v62
    v_and_b32 v118, s44, v62
    v_mul_f32 v117, s41, v117
    v_mul_f32 v118, s41, v118
    v_cvt_pk_bf16_f32 v117, v117, v118
    v_and_b32 v118, s44, v117
    v_lshlrev_b32 v117, 16, v117
    v_mul_f32 v117, 0.15915494, v117
    v_mul_f32 v118, 0.15915494, v118
    v_fract_f32 v117, v117
    v_fract_f32 v118, v118
    v_cos_f32 v117, v117
    v_cos_f32 v118, v118
    v_mul_hi_u32_u24 v120, s36, v24
    v_mul_hi_u32_u24 v121, s37, v24
    v_mul_hi_u32_u24 v122, s38, v48
    v_mad_i32_i24 v87, v120, s39, v24
    v_mad_u32_u24 v112, v122, 40, v121
    v_mad_i32_i24 v120, v121, -3, v120
    v_lshlrev_b32 v112, 2, v112
    v_mad_i32_i24 v122, v122, s40, v48
    ds_add_u32 v112, v3 offset:0
    v_lshl_or_b32 v87, v120, 30, v87
    v_lshl_or_b32 v87, v122, 16, v87
    v_mul_f32 v117, s42, v117
    v_mul_f32 v118, s42, v118
    v_cvt_pk_bf16_f32 v117, v117, v118
    v_mul_hi_u32_u24 v123, s36, v25
    v_mul_hi_u32_u24 v124, s37, v25
    v_mul_hi_u32_u24 v125, s38, v49
    v_mad_i32_i24 v88, v123, s39, v25
    v_mad_u32_u24 v113, v125, 40, v124
    v_mad_i32_i24 v123, v124, -3, v123
    v_lshlrev_b32 v113, 2, v113
    v_mad_i32_i24 v125, v125, s40, v49
    ds_add_u32 v113, v3 offset:0
    v_lshl_or_b32 v88, v123, 30, v88
    v_lshl_or_b32 v88, v125, 16, v88
    v_lshrrev_b32 v118, 3, v117
    v_lshrrev_b32 v119, 8, v117
    v_lshlrev_b32 v117, 13, v117
    v_bitop3_b32 v119, v118, v119, s43 bitop3:0x1b
    v_bitop3_b32 v87, v117, s45, v87 bitop3:0xae
    v_lshl_or_b32 v112, v119, 16, v112
    v_bitop3_b32 v88, v118, s45, v88 bitop3:0xae
    v_and_or_b32 v113, v119, s44, v113
    v_lshlrev_b32 v117, 16, v63
    v_and_b32 v118, s44, v63
    v_mul_f32 v117, s41, v117
    v_mul_f32 v118, s41, v118
    v_cvt_pk_bf16_f32 v117, v117, v118
    v_and_b32 v118, s44, v117
    v_lshlrev_b32 v117, 16, v117
    v_mul_f32 v117, 0.15915494, v117
    v_mul_f32 v118, 0.15915494, v118
    v_fract_f32 v117, v117
    v_fract_f32 v118, v118
    v_cos_f32 v117, v117
    v_cos_f32 v118, v118
    v_mul_hi_u32_u24 v120, s36, v26
    v_mul_hi_u32_u24 v121, s37, v26
    v_mul_hi_u32_u24 v122, s38, v50
    v_mad_i32_i24 v89, v120, s39, v26
    v_mad_u32_u24 v114, v122, 40, v121
    v_mad_i32_i24 v120, v121, -3, v120
    v_lshlrev_b32 v114, 2, v114
    v_mad_i32_i24 v122, v122, s40, v50
    ds_add_u32 v114, v3 offset:0
    v_lshl_or_b32 v89, v120, 30, v89
    v_lshl_or_b32 v89, v122, 16, v89
    v_mul_f32 v117, s42, v117
    v_mul_f32 v118, s42, v118
    v_cvt_pk_bf16_f32 v117, v117, v118
    v_mul_hi_u32_u24 v123, s36, v27
    v_mul_hi_u32_u24 v124, s37, v27
    v_mul_hi_u32_u24 v125, s38, v51
    v_mad_i32_i24 v90, v123, s39, v27
    v_mad_u32_u24 v115, v125, 40, v124
    v_mad_i32_i24 v123, v124, -3, v123
    v_lshlrev_b32 v115, 2, v115
    v_mad_i32_i24 v125, v125, s40, v51
    ds_add_u32 v115, v3 offset:0
    v_lshl_or_b32 v90, v123, 30, v90
    v_lshl_or_b32 v90, v125, 16, v90
    v_lshrrev_b32 v118, 3, v117
    v_lshrrev_b32 v119, 8, v117
    v_lshlrev_b32 v117, 13, v117
    v_bitop3_b32 v119, v118, v119, s43 bitop3:0x1b
    v_bitop3_b32 v89, v117, s45, v89 bitop3:0xae
    v_lshl_or_b32 v114, v119, 16, v114
    v_bitop3_b32 v90, v118, s45, v90 bitop3:0xae
    v_and_or_b32 v115, v119, s44, v115
    s_waitcnt lgkmcnt(4)
    s_add_u32 s32, s30, 16384
    buffer_load_dwordx4 v[8:11], v1, s[4:7], s32 offen nt
    buffer_load_dwordx4 v[32:35], v1, s[8:11], s32 offen nt
    s_add_u32 s32, s31, 8192
    buffer_load_dwordx2 v[54:55], v2, s[12:15], s32 offen nt
    s_cmp_ge_u32 s28, s33
    s_cbranch_scc1 p1_r_done
    v_lshlrev_b32 v117, 16, v66
    v_and_b32 v118, s44, v66
    v_mul_f32 v117, s41, v117
    v_mul_f32 v118, s41, v118
    v_cvt_pk_bf16_f32 v117, v117, v118
    v_and_b32 v118, s44, v117
    v_lshlrev_b32 v117, 16, v117
    v_mul_f32 v117, 0.15915494, v117
    v_mul_f32 v118, 0.15915494, v118
    v_fract_f32 v117, v117
    v_fract_f32 v118, v118
    v_cos_f32 v117, v117
    v_cos_f32 v118, v118
    v_mul_hi_u32_u24 v120, s36, v64
    v_mul_hi_u32_u24 v121, s37, v64
    v_mul_hi_u32_u24 v122, s38, v65
    v_mad_i32_i24 v91, v120, s39, v64
    v_mad_u32_u24 v116, v122, 40, v121
    v_mad_i32_i24 v120, v121, -3, v120
    v_lshlrev_b32 v116, 2, v116
    v_mad_i32_i24 v122, v122, s40, v65
    ds_add_u32 v116, v3 offset:0
    v_lshl_or_b32 v91, v120, 30, v91
    v_lshl_or_b32 v91, v122, 16, v91
    v_mul_f32 v117, s42, v117
    v_mul_f32 v118, s42, v118
    v_cvt_pk_bf16_f32 v117, v117, v118
    v_lshrrev_b32 v118, 3, v117
    v_lshrrev_b32 v119, 8, v117
    v_lshlrev_b32 v117, 13, v117
    v_bitop3_b32 v119, v118, v119, s43 bitop3:0x1b
    v_bitop3_b32 v91, v117, s45, v91 bitop3:0xae
    v_lshl_or_b32 v116, v119, 16, v116
p1_r_done:
    s_waitcnt lgkmcnt(0)
    s_barrier
    s_cmp_ge_u32 s28, 10
    s_cbranch_scc1 p1_s1_skip
    v_and_b32 v126, 63, v0
    s_lshl_b32 s54, s28, 4
    v_mul_u32_u24 v117, 160, v126
    v_add_u32 v117, s54, v117
    ds_read_b128 v[118:121], v117 offset:0
    s_mov_b32 s55, 43691
    s_waitcnt lgkmcnt(0)
    v_add_u32 v118, 2, v118
    v_add_u32 v119, 2, v119
    v_add_u32 v120, 2, v120
    v_add_u32 v121, 2, v121
    v_mul_u32_u24 v118, s55, v118
    v_mul_u32_u24 v119, s55, v119
    v_mul_u32_u24 v120, s55, v120
    v_mul_u32_u24 v121, s55, v121
    v_lshrrev_b32 v118, 17, v118
    v_lshrrev_b32 v119, 17, v119
    v_lshrrev_b32 v120, 17, v120
    v_lshrrev_b32 v121, 17, v121
    v_lshl_or_b32 v122, v119, 16, v118
    v_lshl_or_b32 v123, v121, 16, v120
    v_mov_b32 v124, v122
    v_mov_b32 v125, v123
    s_nop 1
    v_add_u32_dpp v124, v124, v124 row_shr:1 row_mask:0xf bank_mask:0xf bound_ctrl:0
    v_add_u32_dpp v125, v125, v125 row_shr:1 row_mask:0xf bank_mask:0xf bound_ctrl:0
    s_nop 0
    v_add_u32_dpp v124, v124, v124 row_shr:2 row_mask:0xf bank_mask:0xf bound_ctrl:0
    v_add_u32_dpp v125, v125, v125 row_shr:2 row_mask:0xf bank_mask:0xf bound_ctrl:0
    s_nop 0
    v_add_u32_dpp v124, v124, v124 row_shr:4 row_mask:0xf bank_mask:0xf bound_ctrl:0
    v_add_u32_dpp v125, v125, v125 row_shr:4 row_mask:0xf bank_mask:0xf bound_ctrl:0
    s_nop 0
    v_add_u32_dpp v124, v124, v124 row_shr:8 row_mask:0xf bank_mask:0xf bound_ctrl:0
    v_add_u32_dpp v125, v125, v125 row_shr:8 row_mask:0xf bank_mask:0xf bound_ctrl:0
    s_nop 0
    v_add_u32_dpp v124, v124, v124 row_bcast:15 row_mask:0xa bank_mask:0xf
    v_add_u32_dpp v125, v125, v125 row_bcast:15 row_mask:0xa bank_mask:0xf
    s_nop 0
    v_add_u32_dpp v124, v124, v124 row_bcast:31 row_mask:0xc bank_mask:0xf
    v_add_u32_dpp v125, v125, v125 row_bcast:31 row_mask:0xc bank_mask:0xf
    s_nop 0
    s_nop 0
    v_mov_b32 v127, s54
    v_and_b32 v118, 0xffff, v124
    v_lshrrev_b32 v119, 16, v124
    v_and_b32 v120, 0xffff, v125
    v_lshrrev_b32 v121, 16, v125
    s_mov_b64 exec, 1
    s_lshl_b64 exec, exec, 63
    ds_write_b128 v127, v[118:121] offset:10240
    s_mov_b64 exec, -1
p1_s1_skip:
    s_waitcnt lgkmcnt(0)
    s_barrier
    v_and_b32 v127, 63, v0
    v_lshlrev_b32 v118, 2, v127
    v_cmp_gt_u32 vcc, 40, v127
    ds_read_b32 v119, v118 offset:10240
    s_waitcnt lgkmcnt(0)
    v_cndmask_b32 v119, 0, v119, vcc
    v_mov_b32 v120, v119
    s_nop 1
    v_add_u32_dpp v120, v120, v120 row_shr:1 row_mask:0xf bank_mask:0xf bound_ctrl:0
    s_nop 1
    v_add_u32_dpp v120, v120, v120 row_shr:2 row_mask:0xf bank_mask:0xf bound_ctrl:0
    s_nop 1
    v_add_u32_dpp v120, v120, v120 row_shr:4 row_mask:0xf bank_mask:0xf bound_ctrl:0
    s_nop 1
    v_add_u32_dpp v120, v120, v120 row_shr:8 row_mask:0xf bank_mask:0xf bound_ctrl:0
    s_nop 1
    v_add_u32_dpp v120, v120, v120 row_bcast:15 row_mask:0xa bank_mask:0xf
    s_nop 1
    v_add_u32_dpp v120, v120, v120 row_bcast:31 row_mask:0xc bank_mask:0xf
    s_nop 1
    s_nop 0
    v_sub_u32 v119, v120, v119
    v_readlane_b32 s35, v120, 63
    s_add_u32 s51, s68, s29
    s_cmp_ge_u32 s28, 10
    s_cbranch_scc1 p1_s2_skip
    s_lshl_b32 s54, s28, 2
    s_add_u32 s55, s54, 0
    v_readlane_b32 s56, v119, s55
    s_add_u32 s55, s54, 1
    v_readlane_b32 s57, v119, s55
    s_add_u32 s55, s54, 2
    v_readlane_b32 s58, v119, s55
    s_add_u32 s55, s54, 3
    v_readlane_b32 s59, v119, s55
    s_nop 0
    s_lshl_b32 s57, s57, 16
    s_or_b32 s56, s56, s57
    s_lshl_b32 s59, s59, 16
    s_or_b32 s58, s58, s59
    v_add_u32 v124, s56, v124
    v_add_u32 v125, s58, v125
    v_sub_u32 v122, v124, v122
    v_sub_u32 v123, v125, v123
    s_mul_i32 s55, s51, 5248
    s_mul_i32 s56, s28, 520
    s_add_u32 s55, s55, s56
    s_add_u32 s55, s55, 329252864
    v_lshl_add_u32 v127, v126, 3, s55
    buffer_store_dwordx2 v[122:123], v127, s[16:19], 0 offen
    v_and_b32 v118, 0xffff, v122
    v_lshrrev_b32 v119, 16, v122
    v_and_b32 v120, 0xffff, v123
    v_lshrrev_b32 v121, 16, v123
    v_mul_u32_u24 v118, 3, v118
    v_mul_u32_u24 v119, 3, v119
    v_mul_u32_u24 v120, 3, v120
    v_mul_u32_u24 v121, 3, v121
    ds_write_b128 v117, v[118:121] offset:0
    s_mov_b64 exec, 1
    s_lshl_b64 exec, exec, 63
    buffer_store_dwordx2 v[124:125], v127, s[16:19], 0 offen offset:8
    s_mov_b64 exec, -1
p1_s2_skip:
    s_mul_i32 s52, s51, 160768
    s_add_u32 s20, s48, s52
    s_addc_u32 s21, s49, 0
    s_and_b32 s21, s21, 0xffff
    s_lshl_b32 s22, s35, 4
    s_waitcnt lgkmcnt(0)
    s_barrier
    v_and_b32 v117, 0xffff, v92
    ds_add_rtn_u32 v117, v117, v3 offset:0
    v_and_b32 v118, 0xffff, v93
    ds_add_rtn_u32 v118, v118, v3 offset:0
    v_and_b32 v119, 0xffff, v94
    ds_add_rtn_u32 v119, v119, v3 offset:0
    v_and_b32 v120, 0xffff, v95
    ds_add_rtn_u32 v120, v120, v3 offset:0
    s_add_u32 s32, s30, 32768
    buffer_load_dwordx4 v[12:15], v1, s[4:7], s32 offen nt
    buffer_load_dwordx4 v[36:39], v1, s[8:11], s32 offen nt
    s_add_u32 s32, s31, 16384
    buffer_load_dwordx2 v[56:57], v2, s[12:15], s32 offen nt
    v_and_b32 v121, 0xffff, v96
    ds_add_rtn_u32 v121, v121, v3 offset:0
    v_and_b32 v122, 0xffff, v97
    ds_add_rtn_u32 v122, v122, v3 offset:0
    v_and_b32 v123, 0xffff, v98
    ds_add_rtn_u32 v123, v123, v3 offset:0
    v_and_b32 v124, 0xffff, v99
    ds_add_rtn_u32 v124, v124, v3 offset:0
    s_waitcnt lgkmcnt(4)
    ds_write_b8_d16_hi v117, v92 offset:10496
    v_lshlrev_b32 v117, 2, v117
    ds_write_b32 v117, v67 offset:40704
    ds_write_b8_d16_hi v118, v93 offset:10496
    v_lshlrev_b32 v118, 2, v118
    ds_write_b32 v118, v68 offset:40704
    ds_write_b8_d16_hi v119, v94 offset:10496
    v_lshlrev_b32 v119, 2, v119
    ds_write_b32 v119, v69 offset:40704
    ds_write_b8_d16_hi v120, v95 offset:10496
    v_lshlrev_b32 v120, 2, v120
    ds_write_b32 v120, v70 offset:40704
    s_add_u32 s32, s30, 49152
    buffer_load_dwordx4 v[16:19], v1, s[4:7], s32 offen nt
    buffer_load_dwordx4 v[40:43], v1, s[8:11], s32 offen nt
    s_add_u32 s32, s31, 24576
    buffer_load_dwordx2 v[58:59], v2, s[12:15], s32 offen nt
    v_and_b32 v117, 0xffff, v100
    ds_add_rtn_u32 v117, v117, v3 offset:0
    v_and_b32 v118, 0xffff, v101
    ds_add_rtn_u32 v118, v118, v3 offset:0
    v_and_b32 v119, 0xffff, v102
    ds_add_rtn_u32 v119, v119, v3 offset:0
    v_and_b32 v120, 0xffff, v103
    ds_add_rtn_u32 v120, v120, v3 offset:0
    s_waitcnt lgkmcnt(4)
    ds_write_b8_d16_hi v121, v96 offset:10496
    v_lshlrev_b32 v121, 2, v121
    ds_write_b32 v121, v71 offset:40704
    ds_write_b8_d16_hi v122, v97 offset:10496
    v_lshlrev_b32 v122, 2, v122
    ds_write_b32 v122, v72 offset:40704
    ds_write_b8_d16_hi v123, v98 offset:10496
    v_lshlrev_b32 v123, 2, v123
    ds_write_b32 v123, v73 offset:40704
    ds_write_b8_d16_hi v124, v99 offset:10496
    v_lshlrev_b32 v124, 2, v124
    ds_write_b32 v124, v74 offset:40704
    s_add_u32 s32, s30, 65536
    buffer_load_dwordx4 v[20:23], v1, s[4:7], s32 offen nt
    buffer_load_dwordx4 v[44:47], v1, s[8:11], s32 offen nt
    s_add_u32 s32, s31, 32768
    buffer_load_dwordx2 v[60:61], v2, s[12:15], s32 offen nt
    v_and_b32 v121, 0xffff, v104
    ds_add_rtn_u32 v121, v121, v3 offset:0
    v_and_b32 v122, 0xffff, v105
    ds_add_rtn_u32 v122, v122, v3 offset:0
    v_and_b32 v123, 0xffff, v106
    ds_add_rtn_u32 v123, v123, v3 offset:0
    v_and_b32 v124, 0xffff, v107
    ds_add_rtn_u32 v124, v124, v3 offset:0
    s_waitcnt lgkmcnt(4)
    ds_write_b8_d16_hi v117, v100 offset:10496
    v_lshlrev_b32 v117, 2, v117
    ds_write_b32 v117, v75 offset:40704
    ds_write_b8_d16_hi v118, v101 offset:10496
    v_lshlrev_b32 v118, 2, v118
    ds_write_b32 v118, v76 offset:40704
    ds_write_b8_d16_hi v119, v102 offset:10496
    v_lshlrev_b32 v119, 2, v119
    ds_write_b32 v119, v77 offset:40704
    ds_write_b8_d16_hi v120, v103 offset:10496
    v_lshlrev_b32 v120, 2, v120
    ds_write_b32 v120, v78 offset:40704
    s_add_u32 s32, s30, 81920
    buffer_load_dwordx4 v[24:27], v1, s[4:7], s32 offen nt
    buffer_load_dwordx4 v[48:51], v1, s[8:11], s32 offen nt
    s_add_u32 s32, s31, 40960
    buffer_load_dwordx2 v[62:63], v2, s[12:15], s32 offen nt
    v_and_b32 v117, 0xffff, v108
    ds_add_rtn_u32 v117, v117, v3 offset:0
    v_and_b32 v118, 0xffff, v109
    ds_add_rtn_u32 v118, v118, v3 offset:0
    v_and_b32 v119, 0xffff, v110
    ds_add_rtn_u32 v119, v119, v3 offset:0
    v_and_b32 v120, 0xffff, v111
    ds_add_rtn_u32 v120, v120, v3 offset:0
    s_waitcnt lgkmcnt(4)
    ds_write_b8_d16_hi v121, v104 offset:10496
    v_lshlrev_b32 v121, 2, v121
    ds_write_b32 v121, v79 offset:40704
    ds_write_b8_d16_hi v122, v105 offset:10496
    v_lshlrev_b32 v122, 2, v122
    ds_write_b32 v122, v80 offset:40704
    ds_write_b8_d16_hi v123, v106 offset:10496
    v_lshlrev_b32 v123, 2, v123
    ds_write_b32 v123, v81 offset:40704
    ds_write_b8_d16_hi v124, v107 offset:10496
    v_lshlrev_b32 v124, 2, v124
    ds_write_b32 v124, v82 offset:40704
    s_cmp_lt_u32 s28, s34
    s_cselect_b32 s46, 0, 0x40000000
    v_lshl_add_u32 v126, v0, 2, s46
    s_add_u32 s32, s30, 98304
    buffer_load_dword v64, v126, s[4:7], s32 offen nt
    buffer_load_dword v65, v126, s[8:11], s32 offen nt
    v_lshrrev_b32 v126, 1, v126
    s_add_u32 s32, s31, 49152
    buffer_load_ushort v66, v126, s[12:15], s32 offen nt
    v_and_b32 v121, 0xffff, v112
    ds_add_rtn_u32 v121, v121, v3 offset:0
    v_and_b32 v122, 0xffff, v113
    ds_add_rtn_u32 v122, v122, v3 offset:0
    v_and_b32 v123, 0xffff, v114
    ds_add_rtn_u32 v123, v123, v3 offset:0
    v_and_b32 v124, 0xffff, v115
    ds_add_rtn_u32 v124, v124, v3 offset:0
    s_waitcnt lgkmcnt(4)
    ds_write_b8_d16_hi v117, v108 offset:10496
    v_lshlrev_b32 v117, 2, v117
    ds_write_b32 v117, v83 offset:40704
    ds_write_b8_d16_hi v118, v109 offset:10496
    v_lshlrev_b32 v118, 2, v118
    ds_write_b32 v118, v84 offset:40704
    ds_write_b8_d16_hi v119, v110 offset:10496
    v_lshlrev_b32 v119, 2, v119
    ds_write_b32 v119, v85 offset:40704
    ds_write_b8_d16_hi v120, v111 offset:10496
    v_lshlrev_b32 v120, 2, v120
    ds_write_b32 v120, v86 offset:40704
    s_waitcnt lgkmcnt(0)
    ds_write_b8_d16_hi v121, v112 offset:10496
    v_lshlrev_b32 v121, 2, v121
    ds_write_b32 v121, v87 offset:40704
    ds_write_b8_d16_hi v122, v113 offset:10496
    v_lshlrev_b32 v122, 2, v122
    ds_write_b32 v122, v88 offset:40704
    ds_write_b8_d16_hi v123, v114 offset:10496
    v_lshlrev_b32 v123, 2, v123
    ds_write_b32 v123, v89 offset:40704
    ds_write_b8_d16_hi v124, v115 offset:10496
    v_lshlrev_b32 v124, 2, v124
    ds_write_b32 v124, v90 offset:40704
    s_cmp_ge_u32 s28, s33
    s_cbranch_scc1 p1_p_done
    v_and_b32 v125, 0xffff, v116
    ds_add_rtn_u32 v125, v125, v3 offset:0
    s_waitcnt lgkmcnt(0)
    ds_write_b8_d16_hi v125, v116 offset:10496
    v_lshlrev_b32 v125, 2, v125
    ds_write_b32 v125, v91 offset:40704
p1_p_done:
    s_waitcnt lgkmcnt(0)
    s_barrier
    v_mul_u32_u24 v119, 3, v0
    v_lshlrev_b32 v117, 2, v119
    v_add_u32 v117, 40704, v117
    v_and_b32 v118, -4, v119
    v_mov_b32 v120, v1
    v_mov_b32 v122, 0
    v_mov_b32 v123, 0
    v_mov_b32 v124, 0
    v_mov_b32 v125, 0
    v_cmp_gt_u32 vcc, 640, v0
    s_and_saveexec_b64 s[52:53], vcc
    ds_write_b128 v1, v[122:125] offset:0
    s_mov_b64 exec, -1
    ds_read_b32 v68, v117 offset:0
    ds_read_b32 v69, v117 offset:4
    ds_read_b32 v70, v117 offset:8
    ds_read_b32 v71, v118 offset:10496
    ds_read_b32 v72, v118 offset:10500
    ds_read_b32 v74, v117 offset:12288
    ds_read_b32 v75, v117 offset:12292
    ds_read_b32 v76, v117 offset:12296
    ds_read_b32 v77, v118 offset:13568
    ds_read_b32 v78, v118 offset:13572
    s_waitcnt lgkmcnt(5)
    ds_read_b32 v80, v117 offset:24576
    ds_read_b32 v81, v117 offset:24580
    ds_read_b32 v82, v117 offset:24584
    ds_read_b32 v83, v118 offset:16640
    ds_read_b32 v84, v118 offset:16644
    v_alignbyte_b32 v71, v72, v71, v119
    buffer_store_dwordx4 v[68:71], v120, s[20:23], 0 offen
    v_add_u32 v120, 16384, v120
    s_waitcnt lgkmcnt(5)
    ds_read_b32 v86, v117 offset:36864
    ds_read_b32 v87, v117 offset:36868
    ds_read_b32 v88, v117 offset:36872
    ds_read_b32 v89, v118 offset:19712
    ds_read_b32 v90, v118 offset:19716
    v_alignbyte_b32 v77, v78, v77, v119
    buffer_store_dwordx4 v[74:77], v120, s[20:23], 0 offen
    v_add_u32 v120, 16384, v120
    s_waitcnt lgkmcnt(5)
    ds_read_b32 v92, v117 offset:49152
    ds_read_b32 v93, v117 offset:49156
    ds_read_b32 v94, v117 offset:49160
    ds_read_b32 v95, v118 offset:22784
    ds_read_b32 v96, v118 offset:22788
    v_alignbyte_b32 v83, v84, v83, v119
    buffer_store_dwordx4 v[80:83], v120, s[20:23], 0 offen
    v_add_u32 v120, 16384, v120
    s_waitcnt lgkmcnt(5)
    v_add_u32 v117, 61440, v117
    ds_read_b32 v98, v117 offset:0
    ds_read_b32 v99, v117 offset:4
    ds_read_b32 v100, v117 offset:8
    ds_read_b32 v101, v118 offset:25856
    ds_read_b32 v102, v118 offset:25860
    v_alignbyte_b32 v89, v90, v89, v119
    buffer_store_dwordx4 v[86:89], v120, s[20:23], 0 offen
    v_add_u32 v120, 16384, v120
    s_waitcnt lgkmcnt(5)
    ds_read_b32 v104, v117 offset:12288
    ds_read_b32 v105, v117 offset:12292
    ds_read_b32 v106, v117 offset:12296
    ds_read_b32 v107, v118 offset:28928
    ds_read_b32 v108, v118 offset:28932
    v_alignbyte_b32 v95, v96, v95, v119
    buffer_store_dwordx4 v[92:95], v120, s[20:23], 0 offen
    v_add_u32 v120, 16384, v120
    s_waitcnt lgkmcnt(5)
    ds_read_b32 v110, v117 offset:24576
    ds_read_b32 v111, v117 offset:24580
    ds_read_b32 v112, v117 offset:24584
    ds_read_b32 v113, v118 offset:32000
    ds_read_b32 v114, v118 offset:32004
    v_alignbyte_b32 v101, v102, v101, v119
    buffer_store_dwordx4 v[98:101], v120, s[20:23], 0 offen nt
    v_add_u32 v120, 16384, v120
    s_waitcnt lgkmcnt(5)
    ds_read_b32 v68, v117 offset:36864
    ds_read_b32 v69, v117 offset:36868
    ds_read_b32 v70, v117 offset:36872
    ds_read_b32 v71, v118 offset:35072
    ds_read_b32 v72, v118 offset:35076
    v_alignbyte_b32 v107, v108, v107, v119
    buffer_store_dwordx4 v[104:107], v120, s[20:23], 0 offen nt
    v_add_u32 v120, 16384, v120
    s_waitcnt lgkmcnt(5)
    ds_read_b32 v74, v117 offset:49152
    ds_read_b32 v75, v117 offset:49156
    ds_read_b32 v76, v117 offset:49160
    ds_read_b32 v77, v118 offset:38144
    ds_read_b32 v78, v118 offset:38148
    v_alignbyte_b32 v113, v114, v113, v119
    buffer_store_dwordx4 v[110:113], v120, s[20:23], 0 offen nt
    v_add_u32 v120, 16384, v120
    s_waitcnt lgkmcnt(5)
    v_alignbyte_b32 v71, v72, v71, v119
    buffer_store_dwordx4 v[68:71], v120, s[20:23], 0 offen nt
    v_add_u32 v120, 16384, v120
    s_waitcnt lgkmcnt(0)
    v_alignbyte_b32 v77, v78, v77, v119
    buffer_store_dwordx4 v[74:77], v120, s[20:23], 0 offen nt
    s_barrier
    s_add_u32 s29, s29, 1
    s_cmp_lt_u32 s29, 8
    s_cbranch_scc1 p1_tile
    s_cmp_ge_u32 s28, 10
    s_cbranch_scc1 p1_tr_done
    s_mul_i32 s52, s68, 5248
    s_mul_i32 s53, s28, 520
    s_add_u32 s52, s52, s53
    s_add_u32 s52, s52, 329252864
    s_mul_i32 s53, s28, 1064960
    s_lshl_b32 s54, s68, 3
    s_add_u32 s53, s53, s54
    s_add_u32 s53, s53, 340000768
    s_waitcnt vmcnt(10)
    v_and_b32 v4, 63, v0
    v_lshlrev_b32 v5, 3, v4
    v_lshlrev_b32 v6, 14, v4
    buffer_load_dwordx4 v[8:11], v5, s[16:19], s52 offen sc1
    s_add_u32 s52, s52, 5248
    buffer_load_dwordx4 v[12:15], v5, s[16:19], s52 offen sc1
    s_add_u32 s52, s52, 5248
    buffer_load_dwordx4 v[16:19], v5, s[16:19], s52 offen sc1
    s_add_u32 s52, s52, 5248
    buffer_load_dwordx4 v[20:23], v5, s[16:19], s52 offen sc1
    s_add_u32 s52, s52, 5248
    buffer_load_dwordx4 v[24:27], v5, s[16:19], s52 offen sc1
    s_add_u32 s52, s52, 5248
    buffer_load_dwordx4 v[28:31], v5, s[16:19], s52 offen sc1
    s_add_u32 s52, s52, 5248
    buffer_load_dwordx4 v[32:35], v5, s[16:19], s52 offen sc1
    s_add_u32 s52, s52, 5248
    buffer_load_dwordx4 v[36:39], v5, s[16:19], s52 offen sc1
    s_add_u32 s52, s52, 5248
    s_waitcnt vmcnt(0)
    v_mov_b32 v40, v10
    v_mov_b32 v41, v11
    v_mov_b32 v42, v14
    v_mov_b32 v43, v15
    v_mov_b32 v10, v12
    v_mov_b32 v11, v13
    v_mov_b32 v44, v18
    v_mov_b32 v45, v19
    v_mov_b32 v12, v16
    v_mov_b32 v13, v17
    v_mov_b32 v46, v22
    v_mov_b32 v47, v23
    v_mov_b32 v14, v20
    v_mov_b32 v15, v21
    v_mov_b32 v48, v26
    v_mov_b32 v49, v27
    v_mov_b32 v16, v24
    v_mov_b32 v17, v25
    v_mov_b32 v50, v30
    v_mov_b32 v51, v31
    v_mov_b32 v18, v28
    v_mov_b32 v19, v29
    v_mov_b32 v52, v34
    v_mov_b32 v53, v35
    v_mov_b32 v20, v32
    v_mov_b32 v21, v33
    v_mov_b32 v54, v38
    v_mov_b32 v55, v39
    v_mov_b32 v22, v36
    v_mov_b32 v23, v37
    buffer_store_dwordx4 v[8:11], v6, s[16:19], s53 offen offset:0
    buffer_store_dwordx4 v[12:15], v6, s[16:19], s53 offen offset:16
    buffer_store_dwordx4 v[16:19], v6, s[16:19], s53 offen offset:32
    buffer_store_dwordx4 v[20:23], v6, s[16:19], s53 offen offset:48
    s_add_u32 s53, s53, 16384
    s_mov_b64 exec, 1
    s_lshl_b64 exec, exec, 63
    buffer_store_dwordx4 v[40:43], v6, s[16:19], s53 offen offset:0
    buffer_store_dwordx4 v[44:47], v6, s[16:19], s53 offen offset:16
    buffer_store_dwordx4 v[48:51], v6, s[16:19], s53 offen offset:32
    buffer_store_dwordx4 v[52:55], v6, s[16:19], s53 offen offset:48
    s_mov_b64 exec, -1
p1_tr_done:
p1_end:
    s_endpgm
.globl p2_kernel
.p2align 8
.type p2_kernel,@function
p2_kernel:
    s_cmp_ge_u32 s2, 256
    s_cbranch_scc1 p2_end
    s_load_dwordx2 s[8:9], s[0:1], 104
    v_and_b32 v116, 63, v0
    v_lshrrev_b32 v122, 6, v0
    v_lshlrev_b32 v123, 5, v0
    v_lshlrev_b32 v116, 4, v116
    v_readfirstlane_b32 s10, v122
    s_and_b32 s44, s2, 7
    s_lshr_b32 s11, s44, 1
    s_and_b32 s44, s44, 1
    s_lshl_b32 s12, s44, 5
    s_lshr_b32 s44, s2, 3
    s_add_u32 s12, s12, s44
    s_mov_b32 s25, 54272
    s_mov_b32 s27, 2214526976
    s_mov_b32 s28, 4294901760
    s_mov_b32 s31, 50463745
    s_mov_b32 s32, 50464001
    s_mov_b32 s33, 50464257
    s_mov_b32 s21, 0
    s_mul_i32 s23, s10, 3072
    s_lshl_b32 s24, s10, 9
    s_lshl_b32 s64, s10, 10
    s_sub_u32 s42, s24, s23
    s_add_u32 s42, s42, 49152
    s_mul_i32 s41, s10, 20578304
    s_lshl_b32 s44, s11, 2
    s_lshr_b32 s65, 0x0000, s44
    s_and_b32 s65, s65, 15
    s_mul_i32 s70, s11, 161280
    s_add_u32 s70, s70, 350650368
    s_add_u32 s70, s70, s23
    s_mul_i32 s40, s12, 16384
    s_add_u32 s40, s40, 340000768
    s_add_u32 s40, s40, s64
    s_lshl_b32 s44, s11, 1
    s_add_u32 s40, s40, s44
    s_waitcnt lgkmcnt(0)
    s_mov_b32 s4, s8
    s_and_b32 s5, s9, 0xffff
    s_mov_b32 s6, 819200000
    s_mov_b32 s7, 0x20000
    s_mov_b32 s44, 357101568
    buffer_load_dwordx4 v[60:63], v123, s[4:7], s44 offen
    buffer_load_dwordx4 v[64:67], v123, s[4:7], s44 offen offset:16
p2_restart:
    s_mov_b32 s13, 0
    s_mov_b32 s14, 10
    s_add_u32 s44, s13, s65
    s_cmp_ge_u32 s44, 10
    s_cselect_b32 s45, 10, 0
    s_sub_u32 s69, s44, s45
    s_mul_i32 s44, s69, 1064960
    s_add_u32 s44, s44, s40
    buffer_load_ushort v86, v116, s[4:7], s44 offen offset:0
    buffer_load_ushort v87, v116, s[4:7], s44 offen offset:8
    s_add_u32 s44, s44, 16384
    buffer_load_ushort v88, v116, s[4:7], s44 offen offset:0
    buffer_load_ushort v89, v116, s[4:7], s44 offen offset:8
    s_mul_i32 s20, s69, 645120
    s_add_u32 s20, s20, s70
    s_cmp_ge_u32 s10, 9
    s_cbranch_scc1 p2_nmp
    v_lshrrev_b32 v84, 1, v116
    s_add_u32 s44, s20, s42
    buffer_load_dwordx2 v[84:85], v84, s[4:7], s44 offen
p2_nmp:
    buffer_load_dwordx4 v[72:75], v116, s[4:7], s20 offen offset:0
    buffer_load_dwordx4 v[76:79], v116, s[4:7], s20 offen offset:1024
    buffer_load_dwordx4 v[80:83], v116, s[4:7], s20 offen offset:2048
    s_barrier
    v_mov_b32 v117, 0
    v_mov_b32 v118, 0
    v_mov_b32 v119, 0
    v_mov_b32 v120, 0
    v_mov_b32 v121, 0
    ds_write_b128 v117, v[118:121] offset:53760
    s_cmp_eq_u32 s21, 0
    s_cselect_b32 s44, 1879076864, 0
    v_mov_b32 v124, s44
    v_mov_b32 v125, s44
    v_mov_b32 v126, s44
    v_mov_b32 v127, s44
    v_add_u32 v123, s64, v116
    v_add_u32 v122, s25, v123
    ds_write_b128 v122, v[124:127] offset:0
    ds_write_b128 v122, v[124:127] offset:16384
    ds_write_b128 v122, v[124:127] offset:32768
    v_add_u32 v122, 49152, v122
    ds_write_b128 v122, v[124:127] offset:0
    ds_write_b128 v122, v[124:127] offset:16384
    ds_write_b128 v122, v[124:127] offset:32768
    v_cmpx_gt_u32 vcc, 1792, v123
    ds_write_b128 v122, v[124:127] offset:49152
    s_mov_b64 exec, -1
    s_mov_b32 s19, 0
    s_cmp_eq_u32 s21, 2
    s_cselect_b64 s[66:67], -1, 0
    s_waitcnt vmcnt(3) lgkmcnt(0)
    s_barrier
    s_mov_b32 m0, s23
    v_mov_b32 v53, 0x70000000
    s_movk_i32 s44, 512
    v_sub_u32_sdwa v4, v88, v86 dst_sel:DWORD dst_unused:UNUSED_PAD src0_sel:WORD_0 src1_sel:WORD_0
    v_sub_u32_sdwa v5, v89, v87 dst_sel:DWORD dst_unused:UNUSED_PAD src0_sel:WORD_0 src1_sel:WORD_0
    v_med3_i32 v4, v4, 0, s44
    v_med3_i32 v5, v5, 0, s44
    v_add_u32 v48, v4, v5
    ds_write_addtid_b32 v53 offset:0
    ds_write_addtid_b32 v53 offset:256
    ds_write_addtid_b32 v53 offset:512
    ds_write_addtid_b32 v53 offset:768
    ds_write_addtid_b32 v53 offset:1024
    ds_write_addtid_b32 v53 offset:1280
    ds_write_addtid_b32 v53 offset:1536
    ds_write_addtid_b32 v53 offset:1792
    v_mul_u32_u24 v53, 20096, v116
    v_add_u32 v53, s41, v53
    s_nop 1
    v_add_u32_dpp v48, v48, v48 row_shr:1 row_mask:0xf bank_mask:0xf bound_ctrl:0
    s_nop 1
    v_add_u32_dpp v48, v48, v48 row_shr:2 row_mask:0xf bank_mask:0xf bound_ctrl:0
    s_nop 1
    v_add_u32_dpp v48, v48, v48 row_shr:4 row_mask:0xf bank_mask:0xf bound_ctrl:0
    s_nop 1
    v_add_u32_dpp v48, v48, v48 row_shr:8 row_mask:0xf bank_mask:0xf bound_ctrl:0
    s_nop 1
    v_add_u32_dpp v48, v48, v48 row_bcast:15 row_mask:0xa bank_mask:0xf
    s_nop 1
    v_add_u32_dpp v48, v48, v48 row_bcast:31 row_mask:0xc bank_mask:0xf
    s_nop 1
    s_nop 0
    v_readlane_b32 s38, v48, 63
    v_sub_u32 v50, v48, v5
    v_sub_u32 v49, v50, v4
    v_sub_u32 v10, 512, v49
    v_mad_u32_u16 v51, v86, 16, v53
    v_med3_i32 v10, v10, 0, v4
    v_lshl_add_u32 v49, v49, 2, s23
    v_add_u32 v86, v86, v10
    v_sub_u32 v11, 512, v50
    v_mad_u32_u16 v52, v87, 16, v53
    v_med3_i32 v11, v11, 0, v5
    v_lshl_add_u32 v50, v50, 2, s23
    v_add_u32 v87, v87, v11
    v_add_u32 v52, 160768, v52
    s_min_u32 s17, s38, 512
    s_add_u32 s17, s17, 63
    s_lshr_b32 s17, s17, 6
p2_xa_0:
    v_cmpx_lt_i32 vcc, 0, v10
    s_cbranch_execz p2_ya_0
    ds_write_b32 v49, v51 offset:0
    v_add_u32 v51, 16, v51
    v_cmpx_lt_i32 vcc, 1, v10
    s_cbranch_execz p2_ya_0
    ds_write_b32 v49, v51 offset:4
    v_add_u32 v51, 16, v51
    v_cmpx_lt_i32 vcc, 2, v10
    s_cbranch_execz p2_ya_0
    ds_write_b32 v49, v51 offset:8
    v_add_u32 v51, 16, v51
    v_cmpx_lt_i32 vcc, 3, v10
    s_cbranch_execz p2_ya_0
    ds_write_b32 v49, v51 offset:12
    v_add_u32 v51, 16, v51
    v_cmpx_lt_i32 vcc, 4, v10
    s_cbranch_execz p2_ya_0
    ds_write_b32 v49, v51 offset:16
    v_add_u32 v51, 16, v51
    v_cmpx_lt_i32 vcc, 5, v10
    s_cbranch_execz p2_ya_0
    ds_write_b32 v49, v51 offset:20
    v_add_u32 v51, 16, v51
    v_cmpx_lt_i32 vcc, 6, v10
    s_cbranch_execz p2_ya_0
    ds_write_b32 v49, v51 offset:24
    v_add_u32 v51, 16, v51
    v_cmpx_lt_i32 vcc, 7, v10
    s_cbranch_execz p2_ya_0
    ds_write_b32 v49, v51 offset:28
    v_add_u32 v51, 16, v51
    v_subrev_u32 v10, 8, v10
    v_add_u32 v49, 32, v49
    s_branch p2_xa_0
p2_ya_0:
    s_mov_b64 exec, -1
p2_xa_1:
    v_cmpx_lt_i32 vcc, 0, v11
    s_cbranch_execz p2_ya_1
    ds_write_b32 v50, v52 offset:0
    v_add_u32 v52, 16, v52
    v_cmpx_lt_i32 vcc, 1, v11
    s_cbranch_execz p2_ya_1
    ds_write_b32 v50, v52 offset:4
    v_add_u32 v52, 16, v52
    v_cmpx_lt_i32 vcc, 2, v11
    s_cbranch_execz p2_ya_1
    ds_write_b32 v50, v52 offset:8
    v_add_u32 v52, 16, v52
    v_cmpx_lt_i32 vcc, 3, v11
    s_cbranch_execz p2_ya_1
    ds_write_b32 v50, v52 offset:12
    v_add_u32 v52, 16, v52
    v_cmpx_lt_i32 vcc, 4, v11
    s_cbranch_execz p2_ya_1
    ds_write_b32 v50, v52 offset:16
    v_add_u32 v52, 16, v52
    v_cmpx_lt_i32 vcc, 5, v11
    s_cbranch_execz p2_ya_1
    ds_write_b32 v50, v52 offset:20
    v_add_u32 v52, 16, v52
    v_cmpx_lt_i32 vcc, 6, v11
    s_cbranch_execz p2_ya_1
    ds_write_b32 v50, v52 offset:24
    v_add_u32 v52, 16, v52
    v_cmpx_lt_i32 vcc, 7, v11
    s_cbranch_execz p2_ya_1
    ds_write_b32 v50, v52 offset:28
    v_add_u32 v52, 16, v52
    v_subrev_u32 v11, 8, v11
    v_add_u32 v50, 32, v50
    s_branch p2_xa_1
p2_ya_1:
    s_mov_b64 exec, -1
    s_cmp_lt_u32 s38, 512
    s_cbranch_scc1 p2_nomorea
    v_cmp_lt_u32_sdwa s[44:45], v86, v88 src0_sel:WORD_0 src1_sel:WORD_0
    v_cmp_lt_u32_sdwa s[46:47], v87, v89 src0_sel:WORD_0 src1_sel:WORD_0
    s_nop 0
    s_or_b64 s[44:45], s[44:45], s[46:47]
    s_cbranch_scc0 p2_nomorea
    v_mov_b32 v49, s19
    v_mov_b32 v50, 1
    ds_write_b32 v49, v50 offset:53760
p2_nomorea:
    ds_read_addtid_b32 v114 offset:0
    ds_read_addtid_b32 v115 offset:256
    ds_read_addtid_b32 v90 offset:512
    ds_read_addtid_b32 v94 offset:768
    ds_read_addtid_b32 v98 offset:1024
    ds_read_addtid_b32 v102 offset:1280
    ds_read_addtid_b32 v106 offset:1536
    ds_read_addtid_b32 v110 offset:1792
    s_waitcnt lgkmcnt(0)
    s_cmp_lg_u32 s10, 0
    s_cbranch_scc1 p2_ntp
    s_lshr_b32 s44, s2, 3
    s_mul_i32 s44, s44, 5120
    s_mul_i32 s45, s69, 645120
    s_add_u32 s44, s44, s45
    s_add_u32 s44, s44, s70
    v_lshlrev_b32 v126, 3, v116
    s_mov_b32 exec_hi, 0xff
    buffer_load_dword v126, v126, s[4:7], s44 offen
    s_mov_b64 exec, -1
p2_ntp:
    buffer_load_dwordx4 v[0:3], v114, s[4:7], 0 offen
    buffer_load_dwordx4 v[6:9], v115, s[4:7], 0 offen
    buffer_load_dwordx4 v[90:93], v90, s[4:7], 0 offen
    buffer_load_dwordx4 v[94:97], v94, s[4:7], 0 offen
    buffer_load_dwordx4 v[98:101], v98, s[4:7], 0 offen
    buffer_load_dwordx4 v[102:105], v102, s[4:7], 0 offen
    buffer_load_dwordx4 v[106:109], v106, s[4:7], 0 offen
    buffer_load_dwordx4 v[110:113], v110, s[4:7], 0 offen
    s_mov_b32 s16, s17
    s_cmp_lg_u32 s21, 0
    s_cbranch_scc1 p2_nostat1
    v_max3_u32 v60, v60, v62, v64
    v_max_u32 v60, v60, v66
    v_add_f32 v61, v61, v63
    v_add_f32 v65, v65, v67
    v_add_f32 v61, v61, v65
    s_nop 1
    v_max_u32_dpp v60, v60, v60 row_shr:1 row_mask:0xf bank_mask:0xf bound_ctrl:0
    v_add_f32_dpp v61, v61, v61 row_shr:1 row_mask:0xf bank_mask:0xf bound_ctrl:0
    s_nop 0
    v_max_u32_dpp v60, v60, v60 row_shr:2 row_mask:0xf bank_mask:0xf bound_ctrl:0
    v_add_f32_dpp v61, v61, v61 row_shr:2 row_mask:0xf bank_mask:0xf bound_ctrl:0
    s_nop 0
    v_max_u32_dpp v60, v60, v60 row_shr:4 row_mask:0xf bank_mask:0xf bound_ctrl:0
    v_add_f32_dpp v61, v61, v61 row_shr:4 row_mask:0xf bank_mask:0xf bound_ctrl:0
    s_nop 0
    v_max_u32_dpp v60, v60, v60 row_shr:8 row_mask:0xf bank_mask:0xf bound_ctrl:0
    v_add_f32_dpp v61, v61, v61 row_shr:8 row_mask:0xf bank_mask:0xf bound_ctrl:0
    s_nop 0
    v_max_u32_dpp v60, v60, v60 row_bcast:15 row_mask:0xa bank_mask:0xf
    v_add_f32_dpp v61, v61, v61 row_bcast:15 row_mask:0xa bank_mask:0xf
    s_nop 0
    v_max_u32_dpp v60, v60, v60 row_bcast:31 row_mask:0xc bank_mask:0xf
    v_add_f32_dpp v61, v61, v61 row_bcast:31 row_mask:0xc bank_mask:0xf
    s_nop 0
    s_nop 0
    s_lshl_b32 s44, s10, 3
    v_mov_b32 v62, s44
    s_mov_b64 exec, 1
    s_lshl_b64 exec, exec, 63
    ds_write_b64 v62, v[60:61] offset:53824
    s_mov_b64 exec, -1
p2_nostat1:
    s_waitcnt lgkmcnt(0)
    s_barrier
    v_mov_b32 v122, s19
    s_xor_b32 s19, s19, 4
    ds_read_b32 v127, v122 offset:53760
    s_cmp_lg_u32 s21, 0
    s_cbranch_scc1 p2_nostat2
    v_bfe_u32 v62, v116, 1, 7
    ds_read_b64 v[60:61], v62 offset:53824
    s_waitcnt lgkmcnt(0)
    s_nop 1
    v_max_u32_dpp v60, v60, v60 row_shr:1 row_mask:0xf bank_mask:0xf bound_ctrl:0
    v_add_f32_dpp v61, v61, v61 row_shr:1 row_mask:0xf bank_mask:0xf bound_ctrl:0
    s_nop 0
    v_max_u32_dpp v60, v60, v60 row_shr:2 row_mask:0xf bank_mask:0xf bound_ctrl:0
    v_add_f32_dpp v61, v61, v61 row_shr:2 row_mask:0xf bank_mask:0xf bound_ctrl:0
    s_nop 0
    v_max_u32_dpp v60, v60, v60 row_shr:4 row_mask:0xf bank_mask:0xf bound_ctrl:0
    v_add_f32_dpp v61, v61, v61 row_shr:4 row_mask:0xf bank_mask:0xf bound_ctrl:0
    s_nop 0
    v_max_u32_dpp v60, v60, v60 row_shr:8 row_mask:0xf bank_mask:0xf bound_ctrl:0
    v_add_f32_dpp v61, v61, v61 row_shr:8 row_mask:0xf bank_mask:0xf bound_ctrl:0
    s_nop 0
    v_max_u32_dpp v60, v60, v60 row_bcast:15 row_mask:0xa bank_mask:0xf
    v_add_f32_dpp v61, v61, v61 row_bcast:15 row_mask:0xa bank_mask:0xf
    s_nop 0
    v_max_u32_dpp v60, v60, v60 row_bcast:31 row_mask:0xc bank_mask:0xf
    v_add_f32_dpp v61, v61, v61 row_bcast:31 row_mask:0xc bank_mask:0xf
    s_nop 0
    s_nop 0
    v_readlane_b32 s44, v60, 15
    v_readlane_b32 s45, v61, 15
    s_nop 1
    s_lshl_b32 s44, s44, 16
    s_lshr_b32 s46, s44, 23
    s_sub_u32 s47, s46, 80
    s_cmp_lt_u32 s47, 100
    s_cselect_b32 s21, 0, 1
    v_mov_b32 v60, s45
    v_mul_f32 v60, 0x34a7c5ac, v60
    v_sqrt_f32 v60, v60
    v_mov_b32 v61, s44
    v_mul_f32 v62, 0x41800000, v60
    v_cmp_nle_f32 vcc, v61, v62
    v_mul_f32 v60, 0x3a924925, v60
    v_mul_f32 v61, 0x3901742e, v61
    v_max_f32 v60, v60, v61
    s_cmp_lg_u64 vcc, 0
    s_cselect_b32 s21, 1, s21
    v_readfirstlane_b32 s44, v60
    s_nop 0
    s_and_b32 s47, s44, 0x7fffff
    s_or_b32 s47, s47, 0x3f000000
    s_and_b32 s48, s44, 0x7f800000
    s_add_u32 s48, s48, 0x800000
    v_rcp_f32 v60, s47
    s_nop 0
    v_rcp_f32 v61, v60
    v_mul_f32 v60, 0x7b800000, v60
    v_mul_f32 v61, s48, v61
    s_nop 0
    v_readfirstlane_b32 s26, v60
    v_readfirstlane_b32 s30, v61
    s_add_u32 s34, s48, 197132288
    s_mov_b32 s35, s34
    s_sub_u32 s36, 0, s34
    s_subb_u32 s37, 0, s34
    s_cmp_eq_u32 s21, 0
    s_cbranch_scc1 p2_nostat2
    s_waitcnt vmcnt(0) lgkmcnt(0)
    s_branch p2_restart
p2_nostat2:
    s_cmp_eq_u32 s21, 0
    s_cselect_b32 s26, s26, 0x7b800000
    s_waitcnt lgkmcnt(0)
    v_readfirstlane_b32 s62, v127
    s_mov_b32 s63, 0
    s_cmp_lg_u32 s62, 0
    s_cbranch_scc1 p2_adva_done
    s_add_u32 s13, s13, 1
    s_cmp_ge_u32 s13, s14
    s_cselect_b32 s63, 1, 0
    s_cbranch_scc0 p2_newdesca
    v_lshrrev_b32 v86, 16, v86
    v_lshrrev_b32 v87, 16, v87
    v_lshrrev_b32 v88, 16, v88
    v_lshrrev_b32 v89, 16, v89
    s_branch p2_adva_done
p2_newdesca:
    s_add_u32 s44, s13, s65
    s_cmp_ge_u32 s44, 10
    s_cselect_b32 s45, 10, 0
    s_sub_u32 s69, s44, s45
    s_mul_i32 s44, s69, 1064960
    s_add_u32 s44, s44, s40
    buffer_load_ushort v86, v116, s[4:7], s44 offen offset:0
    buffer_load_ushort v87, v116, s[4:7], s44 offen offset:8
    s_add_u32 s44, s44, 16384
    buffer_load_ushort v88, v116, s[4:7], s44 offen offset:0
    buffer_load_ushort v89, v116, s[4:7], s44 offen offset:8
    s_waitcnt vmcnt(0)
p2_adva_done:
    s_mov_b32 m0, s23
    v_mov_b32 v53, 0x70000000
    s_movk_i32 s44, 512
    v_sub_u32_sdwa v4, v88, v86 dst_sel:DWORD dst_unused:UNUSED_PAD src0_sel:WORD_0 src1_sel:WORD_0
    v_sub_u32_sdwa v5, v89, v87 dst_sel:DWORD dst_unused:UNUSED_PAD src0_sel:WORD_0 src1_sel:WORD_0
    v_med3_i32 v4, v4, 0, s44
    v_med3_i32 v5, v5, 0, s44
    v_add_u32 v48, v4, v5
    ds_write_addtid_b32 v53 offset:0
    ds_write_addtid_b32 v53 offset:256
    ds_write_addtid_b32 v53 offset:512
    ds_write_addtid_b32 v53 offset:768
    ds_write_addtid_b32 v53 offset:1024
    ds_write_addtid_b32 v53 offset:1280
    ds_write_addtid_b32 v53 offset:1536
    ds_write_addtid_b32 v53 offset:1792
    v_mul_u32_u24 v53, 20096, v116
    v_add_u32 v53, s41, v53
    s_nop 1
    v_add_u32_dpp v48, v48, v48 row_shr:1 row_mask:0xf bank_mask:0xf bound_ctrl:0
    s_nop 1
    v_add_u32_dpp v48, v48, v48 row_shr:2 row_mask:0xf bank_mask:0xf bound_ctrl:0
    s_nop 1
    v_add_u32_dpp v48, v48, v48 row_shr:4 row_mask:0xf bank_mask:0xf bound_ctrl:0
    s_nop 1
    v_add_u32_dpp v48, v48, v48 row_shr:8 row_mask:0xf bank_mask:0xf bound_ctrl:0
    s_nop 1
    v_add_u32_dpp v48, v48, v48 row_bcast:15 row_mask:0xa bank_mask:0xf
    s_nop 1
    v_add_u32_dpp v48, v48, v48 row_bcast:31 row_mask:0xc bank_mask:0xf
    s_nop 1
    s_nop 0
    v_readlane_b32 s38, v48, 63
    v_sub_u32 v50, v48, v5
    v_sub_u32 v49, v50, v4
    v_sub_u32 v10, 512, v49
    v_mad_u32_u16 v51, v86, 16, v53
    v_med3_i32 v10, v10, 0, v4
    v_lshl_add_u32 v49, v49, 2, s23
    v_add_u32 v86, v86, v10
    v_sub_u32 v11, 512, v50
    v_mad_u32_u16 v52, v87, 16, v53
    v_med3_i32 v11, v11, 0, v5
    v_lshl_add_u32 v50, v50, 2, s23
    v_add_u32 v87, v87, v11
    v_add_u32 v52, 160768, v52
    s_min_u32 s17, s38, 512
    s_add_u32 s17, s17, 63
    s_lshr_b32 s17, s17, 6
p2_xb_0:
    v_cmpx_lt_i32 vcc, 0, v10
    s_cbranch_execz p2_yb_0
    ds_write_b32 v49, v51 offset:0
    v_add_u32 v51, 16, v51
    v_cmpx_lt_i32 vcc, 1, v10
    s_cbranch_execz p2_yb_0
    ds_write_b32 v49, v51 offset:4
    v_add_u32 v51, 16, v51
    v_cmpx_lt_i32 vcc, 2, v10
    s_cbranch_execz p2_yb_0
    ds_write_b32 v49, v51 offset:8
    v_add_u32 v51, 16, v51
    v_cmpx_lt_i32 vcc, 3, v10
    s_cbranch_execz p2_yb_0
    ds_write_b32 v49, v51 offset:12
    v_add_u32 v51, 16, v51
    v_cmpx_lt_i32 vcc, 4, v10
    s_cbranch_execz p2_yb_0
    ds_write_b32 v49, v51 offset:16
    v_add_u32 v51, 16, v51
    v_cmpx_lt_i32 vcc, 5, v10
    s_cbranch_execz p2_yb_0
    ds_write_b32 v49, v51 offset:20
    v_add_u32 v51, 16, v51
    v_cmpx_lt_i32 vcc, 6, v10
    s_cbranch_execz p2_yb_0
    ds_write_b32 v49, v51 offset:24
    v_add_u32 v51, 16, v51
    v_cmpx_lt_i32 vcc, 7, v10
    s_cbranch_execz p2_yb_0
    ds_write_b32 v49, v51 offset:28
    v_add_u32 v51, 16, v51
    v_subrev_u32 v10, 8, v10
    v_add_u32 v49, 32, v49
    s_branch p2_xb_0
p2_yb_0:
    s_mov_b64 exec, -1
p2_xb_1:
    v_cmpx_lt_i32 vcc, 0, v11
    s_cbranch_execz p2_yb_1
    ds_write_b32 v50, v52 offset:0
    v_add_u32 v52, 16, v52
    v_cmpx_lt_i32 vcc, 1, v11
    s_cbranch_execz p2_yb_1
    ds_write_b32 v50, v52 offset:4
    v_add_u32 v52, 16, v52
    v_cmpx_lt_i32 vcc, 2, v11
    s_cbranch_execz p2_yb_1
    ds_write_b32 v50, v52 offset:8
    v_add_u32 v52, 16, v52
    v_cmpx_lt_i32 vcc, 3, v11
    s_cbranch_execz p2_yb_1
    ds_write_b32 v50, v52 offset:12
    v_add_u32 v52, 16, v52
    v_cmpx_lt_i32 vcc, 4, v11
    s_cbranch_execz p2_yb_1
    ds_write_b32 v50, v52 offset:16
    v_add_u32 v52, 16, v52
    v_cmpx_lt_i32 vcc, 5, v11
    s_cbranch_execz p2_yb_1
    ds_write_b32 v50, v52 offset:20
    v_add_u32 v52, 16, v52
    v_cmpx_lt_i32 vcc, 6, v11
    s_cbranch_execz p2_yb_1
    ds_write_b32 v50, v52 offset:24
    v_add_u32 v52, 16, v52
    v_cmpx_lt_i32 vcc, 7, v11
    s_cbranch_execz p2_yb_1
    ds_write_b32 v50, v52 offset:28
    v_add_u32 v52, 16, v52
    v_subrev_u32 v11, 8, v11
    v_add_u32 v50, 32, v50
    s_branch p2_xb_1
p2_yb_1:
    s_mov_b64 exec, -1
    s_cmp_lt_u32 s38, 512
    s_cbranch_scc1 p2_nomoreb
    v_cmp_lt_u32_sdwa s[44:45], v86, v88 src0_sel:WORD_0 src1_sel:WORD_0
    v_cmp_lt_u32_sdwa s[46:47], v87, v89 src0_sel:WORD_0 src1_sel:WORD_0
    s_nop 0
    s_or_b64 s[44:45], s[44:45], s[46:47]
    s_cbranch_scc0 p2_nomoreb
    v_mov_b32 v49, s19
    v_mov_b32 v50, 1
    ds_write_b32 v49, v50 offset:53760
p2_nomoreb:
    s_waitcnt vmcnt(0)
    v_perm_b32 v54, v93, v90, s31
    v_perm_b32 v55, v93, v91, s32
    v_perm_b32 v56, v93, v92, s33
    v_lshlrev_b16 v16, 3, v92
    v_lshlrev_b16 v14, 3, v91
    v_lshlrev_b16 v12, 3, v90
    v_perm_b32 v57, v97, v94, s31
    v_perm_b32 v58, v97, v95, s32
    v_perm_b32 v59, v97, v96, s33
    v_lshlrev_b16 v22, 3, v96
    v_lshlrev_b16 v20, 3, v95
    v_lshlrev_b16 v18, 3, v94
    v_perm_b32 v60, v101, v98, s31
    v_perm_b32 v61, v101, v99, s32
    v_perm_b32 v62, v101, v100, s33
    v_lshlrev_b16 v28, 3, v100
    v_lshlrev_b16 v26, 3, v99
    v_lshlrev_b16 v24, 3, v98
    v_perm_b32 v63, v105, v102, s31
    v_perm_b32 v64, v105, v103, s32
    v_perm_b32 v65, v105, v104, s33
    v_lshlrev_b16 v34, 3, v104
    v_lshlrev_b16 v32, 3, v103
    v_lshlrev_b16 v30, 3, v102
    v_perm_b32 v66, v109, v106, s31
    v_perm_b32 v67, v109, v107, s32
    v_perm_b32 v68, v109, v108, s33
    v_lshlrev_b16 v40, 3, v108
    v_lshlrev_b16 v38, 3, v107
    v_lshlrev_b16 v36, 3, v106
    v_perm_b32 v69, v113, v110, s31
    v_perm_b32 v70, v113, v111, s32
    v_perm_b32 v71, v113, v112, s33
    v_lshlrev_b16 v46, 3, v112
    v_lshlrev_b16 v44, 3, v111
    v_lshlrev_b16 v42, 3, v110
    ds_read_addtid_b32 v114 offset:0
    ds_read_addtid_b32 v115 offset:256
    ds_read_addtid_b32 v90 offset:512
    ds_read_addtid_b32 v94 offset:768
    ds_read_addtid_b32 v98 offset:1024
    ds_read_addtid_b32 v102 offset:1280
    ds_read_addtid_b32 v106 offset:1536
    ds_read_addtid_b32 v110 offset:1792
    s_waitcnt lgkmcnt(0)
    buffer_load_dwordx4 v[90:93], v90, s[4:7], 0 offen
    s_branch p2_tail
p2_add:
    s_setprio 2
    s_cmp_lg_u32 s21, 0
    s_cbranch_scc1 p2_addf
    v_lshlrev_b32_sdwa v122, 11, sext(v48) dst_sel:DWORD dst_unused:UNUSED_PAD src0_sel:DWORD src1_sel:WORD_0
    v_bfe_u32 v123, v48, 16, 14
    v_lshlrev_b32 v124, 16, v0
    v_bfi_b32 v122, v122, 0, s27
    v_and_b32 v125, s28, v0
    v_lshlrev_b32 v126, 16, v1
    v_mul_f32 v122, s26, v122
    v_and_b32 v127, s28, v1
    v_lshl_add_u32 v123, v123, 3, s25
    v_pk_fma_f32 v[124:125], v[124:125], v[122:123], s[34:35] op_sel_hi:[1,0,1]
    v_pk_fma_f32 v[126:127], v[126:127], v[122:123], s[34:35] op_sel_hi:[1,0,1]
    v_lshl_add_u32 v124, v125, 16, v124
    v_lshl_add_u32 v125, v127, 16, v126
    v_lshl_add_u64 v[124:125], v[124:125], 0, s[36:37]
    v_cmpx_ne_u32_sdwa vcc, v48, 0 src0_sel:BYTE_1 src1_sel:DWORD
    ds_add_rtn_u64 v[118:119], v123, v[124:125]
    s_mov_b64 exec, -1
    v_lshlrev_b32_sdwa v122, 11, sext(v49) dst_sel:DWORD dst_unused:UNUSED_PAD src0_sel:DWORD src1_sel:WORD_0
    v_bfe_u32 v123, v49, 16, 14
    v_lshlrev_b32 v124, 16, v2
    v_bfi_b32 v122, v122, 0, s27
    v_and_b32 v125, s28, v2
    v_lshlrev_b32 v126, 16, v3
    v_mul_f32 v122, s26, v122
    v_and_b32 v127, s28, v3
    v_lshl_add_u32 v123, v123, 3, s25
    v_pk_fma_f32 v[124:125], v[124:125], v[122:123], s[34:35] op_sel_hi:[1,0,1]
    v_pk_fma_f32 v[126:127], v[126:127], v[122:123], s[34:35] op_sel_hi:[1,0,1]
    v_lshl_add_u32 v124, v125, 16, v124
    v_lshl_add_u32 v125, v127, 16, v126
    v_lshl_add_u64 v[124:125], v[124:125], 0, s[36:37]
    v_cmpx_ne_u32_sdwa vcc, v49, 0 src0_sel:BYTE_1 src1_sel:DWORD
    ds_add_rtn_u64 v[120:121], v123, v[124:125]
    s_mov_b64 exec, -1
    v_lshlrev_b32_sdwa v122, 11, sext(v50) dst_sel:DWORD dst_unused:UNUSED_PAD src0_sel:DWORD src1_sel:WORD_0
    v_bfe_u32 v123, v50, 16, 14
    v_lshlrev_b32 v124, 16, v4
    v_bfi_b32 v122, v122, 0, s27
    v_and_b32 v125, s28, v4
    v_lshlrev_b32 v126, 16, v5
    v_mul_f32 v122, s26, v122
    v_and_b32 v127, s28, v5
    v_lshl_add_u32 v123, v123, 3, s25
    v_pk_fma_f32 v[124:125], v[124:125], v[122:123], s[34:35] op_sel_hi:[1,0,1]
    v_pk_fma_f32 v[126:127], v[126:127], v[122:123], s[34:35] op_sel_hi:[1,0,1]
    s_waitcnt lgkmcnt(1)
    v_pk_max_u16 v117, v117, v118
    v_lshl_add_u32 v124, v125, 16, v124
    v_lshl_add_u32 v125, v127, 16, v126
    v_pk_max_u16 v117, v117, v119
    v_lshl_add_u64 v[124:125], v[124:125], 0, s[36:37]
    v_cmpx_ne_u32_sdwa vcc, v50, 0 src0_sel:BYTE_1 src1_sel:DWORD
    ds_add_rtn_u64 v[118:119], v123, v[124:125]
    s_mov_b64 exec, -1
    buffer_load_dwordx4 v[0:3], v114, s[4:7], 0 offen
    v_lshlrev_b32_sdwa v122, 11, sext(v51) dst_sel:DWORD dst_unused:UNUSED_PAD src0_sel:DWORD src1_sel:WORD_0
    v_bfe_u32 v123, v51, 16, 14
    v_lshlrev_b32 v124, 16, v6
    v_bfi_b32 v122, v122, 0, s27
    v_and_b32 v125, s28, v6
    v_lshlrev_b32 v126, 16, v7
    v_mul_f32 v122, s26, v122
    v_and_b32 v127, s28, v7
    v_lshl_add_u32 v123, v123, 3, s25
    v_pk_fma_f32 v[124:125], v[124:125], v[122:123], s[34:35] op_sel_hi:[1,0,1]
    v_pk_fma_f32 v[126:127], v[126:127], v[122:123], s[34:35] op_sel_hi:[1,0,1]
    s_waitcnt lgkmcnt(1)
    v_pk_max_u16 v117, v117, v120
    v_lshl_add_u32 v124, v125, 16, v124
    v_lshl_add_u32 v125, v127, 16, v126
    v_pk_max_u16 v117, v117, v121
    v_lshl_add_u64 v[124:125], v[124:125], 0, s[36:37]
    v_cmpx_ne_u32_sdwa vcc, v51, 0 src0_sel:BYTE_1 src1_sel:DWORD
    ds_add_rtn_u64 v[120:121], v123, v[124:125]
    s_mov_b64 exec, -1
    v_lshlrev_b32_sdwa v122, 11, sext(v52) dst_sel:DWORD dst_unused:UNUSED_PAD src0_sel:DWORD src1_sel:WORD_0
    v_bfe_u32 v123, v52, 16, 14
    v_lshlrev_b32 v124, 16, v8
    v_bfi_b32 v122, v122, 0, s27
    v_and_b32 v125, s28, v8
    v_lshlrev_b32 v126, 16, v9
    v_mul_f32 v122, s26, v122
    v_and_b32 v127, s28, v9
    v_lshl_add_u32 v123, v123, 3, s25
    v_pk_fma_f32 v[124:125], v[124:125], v[122:123], s[34:35] op_sel_hi:[1,0,1]
    v_pk_fma_f32 v[126:127], v[126:127], v[122:123], s[34:35] op_sel_hi:[1,0,1]
    s_waitcnt lgkmcnt(1)
    v_pk_max_u16 v117, v117, v118
    v_lshl_add_u32 v124, v125, 16, v124
    v_lshl_add_u32 v125, v127, 16, v126
    v_pk_max_u16 v117, v117, v119
    v_lshl_add_u64 v[124:125], v[124:125], 0, s[36:37]
    v_cmpx_ne_u32_sdwa vcc, v52, 0 src0_sel:BYTE_1 src1_sel:DWORD
    ds_add_rtn_u64 v[118:119], v123, v[124:125]
    s_mov_b64 exec, -1
    v_lshlrev_b32_sdwa v122, 11, sext(v53) dst_sel:DWORD dst_unused:UNUSED_PAD src0_sel:DWORD src1_sel:WORD_0
    v_bfe_u32 v123, v53, 16, 14
    v_lshlrev_b32 v124, 16, v10
    v_bfi_b32 v122, v122, 0, s27
    v_and_b32 v125, s28, v10
    v_lshlrev_b32 v126, 16, v11
    v_mul_f32 v122, s26, v122
    v_and_b32 v127, s28, v11
    v_lshl_add_u32 v123, v123, 3, s25
    v_pk_fma_f32 v[124:125], v[124:125], v[122:123], s[34:35] op_sel_hi:[1,0,1]
    v_pk_fma_f32 v[126:127], v[126:127], v[122:123], s[34:35] op_sel_hi:[1,0,1]
    s_waitcnt lgkmcnt(1)
    v_pk_max_u16 v117, v117, v120
    v_lshl_add_u32 v124, v125, 16, v124
    v_lshl_add_u32 v125, v127, 16, v126
    v_pk_max_u16 v117, v117, v121
    v_lshl_add_u64 v[124:125], v[124:125], 0, s[36:37]
    v_cmpx_ne_u32_sdwa vcc, v53, 0 src0_sel:BYTE_1 src1_sel:DWORD
    ds_add_rtn_u64 v[120:121], v123, v[124:125]
    s_mov_b64 exec, -1
    buffer_load_dwordx4 v[6:9], v115, s[4:7], 0 offen
    s_mov_b32 m0, s23
    v_mov_b32 v53, 0x70000000
    s_movk_i32 s44, 512
    v_sub_u32_sdwa v4, v88, v86 dst_sel:DWORD dst_unused:UNUSED_PAD src0_sel:WORD_0 src1_sel:WORD_0
    v_sub_u32_sdwa v5, v89, v87 dst_sel:DWORD dst_unused:UNUSED_PAD src0_sel:WORD_0 src1_sel:WORD_0
    v_med3_i32 v4, v4, 0, s44
    v_med3_i32 v5, v5, 0, s44
    v_add_u32 v48, v4, v5
    ds_write_addtid_b32 v53 offset:0
    ds_write_addtid_b32 v53 offset:256
    ds_write_addtid_b32 v53 offset:512
    ds_write_addtid_b32 v53 offset:768
    ds_write_addtid_b32 v53 offset:1024
    ds_write_addtid_b32 v53 offset:1280
    ds_write_addtid_b32 v53 offset:1536
    ds_write_addtid_b32 v53 offset:1792
    v_mul_u32_u24 v53, 20096, v116
    v_add_u32 v53, s41, v53
    s_nop 1
    v_add_u32_dpp v48, v48, v48 row_shr:1 row_mask:0xf bank_mask:0xf bound_ctrl:0
    s_nop 1
    v_add_u32_dpp v48, v48, v48 row_shr:2 row_mask:0xf bank_mask:0xf bound_ctrl:0
    s_nop 1
    v_add_u32_dpp v48, v48, v48 row_shr:4 row_mask:0xf bank_mask:0xf bound_ctrl:0
    s_nop 1
    v_add_u32_dpp v48, v48, v48 row_shr:8 row_mask:0xf bank_mask:0xf bound_ctrl:0
    s_nop 1
    v_add_u32_dpp v48, v48, v48 row_bcast:15 row_mask:0xa bank_mask:0xf
    s_nop 1
    v_add_u32_dpp v48, v48, v48 row_bcast:31 row_mask:0xc bank_mask:0xf
    s_nop 1
    s_nop 0
    v_readlane_b32 s38, v48, 63
    v_sub_u32 v50, v48, v5
    v_sub_u32 v49, v50, v4
    v_sub_u32 v10, 512, v49
    v_mad_u32_u16 v51, v86, 16, v53
    v_med3_i32 v10, v10, 0, v4
    v_lshl_add_u32 v49, v49, 2, s23
    v_add_u32 v86, v86, v10
    v_sub_u32 v11, 512, v50
    v_mad_u32_u16 v52, v87, 16, v53
    v_med3_i32 v11, v11, 0, v5
    v_lshl_add_u32 v50, v50, 2, s23
    v_add_u32 v87, v87, v11
    v_add_u32 v52, 160768, v52
    s_min_u32 s17, s38, 512
    s_add_u32 s17, s17, 63
    s_lshr_b32 s17, s17, 6
p2_xc0_0:
    v_cmpx_lt_i32 vcc, 0, v10
    s_cbranch_execz p2_yc0_0
    ds_write_b32 v49, v51 offset:0
    v_add_u32 v51, 16, v51
    v_cmpx_lt_i32 vcc, 1, v10
    s_cbranch_execz p2_yc0_0
    ds_write_b32 v49, v51 offset:4
    v_add_u32 v51, 16, v51
    v_cmpx_lt_i32 vcc, 2, v10
    s_cbranch_execz p2_yc0_0
    ds_write_b32 v49, v51 offset:8
    v_add_u32 v51, 16, v51
    v_cmpx_lt_i32 vcc, 3, v10
    s_cbranch_execz p2_yc0_0
    ds_write_b32 v49, v51 offset:12
    v_add_u32 v51, 16, v51
    v_cmpx_lt_i32 vcc, 4, v10
    s_cbranch_execz p2_yc0_0
    ds_write_b32 v49, v51 offset:16
    v_add_u32 v51, 16, v51
    v_cmpx_lt_i32 vcc, 5, v10
    s_cbranch_execz p2_yc0_0
    ds_write_b32 v49, v51 offset:20
    v_add_u32 v51, 16, v51
    v_cmpx_lt_i32 vcc, 6, v10
    s_cbranch_execz p2_yc0_0
    ds_write_b32 v49, v51 offset:24
    v_add_u32 v51, 16, v51
    v_cmpx_lt_i32 vcc, 7, v10
    s_cbranch_execz p2_yc0_0
    ds_write_b32 v49, v51 offset:28
    v_add_u32 v51, 16, v51
    v_subrev_u32 v10, 8, v10
    v_add_u32 v49, 32, v49
    s_branch p2_xc0_0
p2_yc0_0:
    s_mov_b64 exec, -1
p2_xc0_1:
    v_cmpx_lt_i32 vcc, 0, v11
    s_cbranch_execz p2_yc0_1
    ds_write_b32 v50, v52 offset:0
    v_add_u32 v52, 16, v52
    v_cmpx_lt_i32 vcc, 1, v11
    s_cbranch_execz p2_yc0_1
    ds_write_b32 v50, v52 offset:4
    v_add_u32 v52, 16, v52
    v_cmpx_lt_i32 vcc, 2, v11
    s_cbranch_execz p2_yc0_1
    ds_write_b32 v50, v52 offset:8
    v_add_u32 v52, 16, v52
    v_cmpx_lt_i32 vcc, 3, v11
    s_cbranch_execz p2_yc0_1
    ds_write_b32 v50, v52 offset:12
    v_add_u32 v52, 16, v52
    v_cmpx_lt_i32 vcc, 4, v11
    s_cbranch_execz p2_yc0_1
    ds_write_b32 v50, v52 offset:16
    v_add_u32 v52, 16, v52
    v_cmpx_lt_i32 vcc, 5, v11
    s_cbranch_execz p2_yc0_1
    ds_write_b32 v50, v52 offset:20
    v_add_u32 v52, 16, v52
    v_cmpx_lt_i32 vcc, 6, v11
    s_cbranch_execz p2_yc0_1
    ds_write_b32 v50, v52 offset:24
    v_add_u32 v52, 16, v52
    v_cmpx_lt_i32 vcc, 7, v11
    s_cbranch_execz p2_yc0_1
    ds_write_b32 v50, v52 offset:28
    v_add_u32 v52, 16, v52
    v_subrev_u32 v11, 8, v11
    v_add_u32 v50, 32, v50
    s_branch p2_xc0_1
p2_yc0_1:
    s_mov_b64 exec, -1
    s_cmp_lt_u32 s38, 512
    s_cbranch_scc1 p2_nomorec0
    v_cmp_lt_u32_sdwa s[44:45], v86, v88 src0_sel:WORD_0 src1_sel:WORD_0
    v_cmp_lt_u32_sdwa s[46:47], v87, v89 src0_sel:WORD_0 src1_sel:WORD_0
    s_nop 0
    s_or_b64 s[44:45], s[44:45], s[46:47]
    s_cbranch_scc0 p2_nomorec0
    v_mov_b32 v49, s19
    v_mov_b32 v50, 1
    ds_write_b32 v49, v50 offset:53760
p2_nomorec0:
    ds_read_addtid_b32 v114 offset:0
    ds_read_addtid_b32 v115 offset:256
    v_lshlrev_b32_sdwa v122, 11, sext(v54) dst_sel:DWORD dst_unused:UNUSED_PAD src0_sel:DWORD src1_sel:WORD_0
    v_bfe_u32 v123, v54, 16, 14
    v_lshlrev_b32 v124, 16, v12
    v_bfi_b32 v122, v122, 0, s27
    v_and_b32 v125, s28, v12
    v_lshlrev_b32 v126, 16, v13
    v_mul_f32 v122, s26, v122
    v_and_b32 v127, s28, v13
    v_lshl_add_u32 v123, v123, 3, s25
    v_pk_fma_f32 v[124:125], v[124:125], v[122:123], s[34:35] op_sel_hi:[1,0,1]
    v_pk_fma_f32 v[126:127], v[126:127], v[122:123], s[34:35] op_sel_hi:[1,0,1]
    s_waitcnt lgkmcnt(11)
    v_pk_max_u16 v117, v117, v118
    v_lshl_add_u32 v124, v125, 16, v124
    v_lshl_add_u32 v125, v127, 16, v126
    v_pk_max_u16 v117, v117, v119
    v_lshl_add_u64 v[124:125], v[124:125], 0, s[36:37]
    v_cmpx_ne_u32_sdwa vcc, v54, 0 src0_sel:BYTE_1 src1_sel:DWORD
    ds_add_rtn_u64 v[118:119], v123, v[124:125]
    s_mov_b64 exec, -1
    v_lshlrev_b32_sdwa v122, 11, sext(v55) dst_sel:DWORD dst_unused:UNUSED_PAD src0_sel:DWORD src1_sel:WORD_0
    v_bfe_u32 v123, v55, 16, 14
    v_lshlrev_b32 v124, 16, v14
    v_bfi_b32 v122, v122, 0, s27
    v_and_b32 v125, s28, v14
    v_lshlrev_b32 v126, 16, v15
    v_mul_f32 v122, s26, v122
    v_and_b32 v127, s28, v15
    v_lshl_add_u32 v123, v123, 3, s25
    v_pk_fma_f32 v[124:125], v[124:125], v[122:123], s[34:35] op_sel_hi:[1,0,1]
    v_pk_fma_f32 v[126:127], v[126:127], v[122:123], s[34:35] op_sel_hi:[1,0,1]
    s_waitcnt lgkmcnt(11)
    v_pk_max_u16 v117, v117, v120
    v_lshl_add_u32 v124, v125, 16, v124
    v_lshl_add_u32 v125, v127, 16, v126
    v_pk_max_u16 v117, v117, v121
    v_lshl_add_u64 v[124:125], v[124:125], 0, s[36:37]
    v_cmpx_ne_u32_sdwa vcc, v55, 0 src0_sel:BYTE_1 src1_sel:DWORD
    ds_add_rtn_u64 v[120:121], v123, v[124:125]
    s_mov_b64 exec, -1
    v_lshlrev_b32_sdwa v122, 11, sext(v56) dst_sel:DWORD dst_unused:UNUSED_PAD src0_sel:DWORD src1_sel:WORD_0
    v_bfe_u32 v123, v56, 16, 14
    v_lshlrev_b32 v124, 16, v16
    v_bfi_b32 v122, v122, 0, s27
    v_and_b32 v125, s28, v16
    v_lshlrev_b32 v126, 16, v17
    v_mul_f32 v122, s26, v122
    v_and_b32 v127, s28, v17
    v_lshl_add_u32 v123, v123, 3, s25
    v_pk_fma_f32 v[124:125], v[124:125], v[122:123], s[34:35] op_sel_hi:[1,0,1]
    v_pk_fma_f32 v[126:127], v[126:127], v[122:123], s[34:35] op_sel_hi:[1,0,1]
    s_waitcnt lgkmcnt(1)
    v_pk_max_u16 v117, v117, v118
    v_lshl_add_u32 v124, v125, 16, v124
    v_lshl_add_u32 v125, v127, 16, v126
    v_pk_max_u16 v117, v117, v119
    v_lshl_add_u64 v[124:125], v[124:125], 0, s[36:37]
    v_cmpx_ne_u32_sdwa vcc, v56, 0 src0_sel:BYTE_1 src1_sel:DWORD
    ds_add_rtn_u64 v[118:119], v123, v[124:125]
    s_mov_b64 exec, -1
    s_setprio 0
    s_waitcnt vmcnt(16)
    v_perm_b32 v54, v93, v90, s31
    v_perm_b32 v55, v93, v91, s32
    v_perm_b32 v56, v93, v92, s33
    v_lshlrev_b16 v16, 3, v92
    v_lshlrev_b16 v14, 3, v91
    v_lshlrev_b16 v12, 3, v90
    ds_read_addtid_b32 v90 offset:512
    v_lshlrev_b32_sdwa v122, 11, sext(v57) dst_sel:DWORD dst_unused:UNUSED_PAD src0_sel:DWORD src1_sel:WORD_0
    v_bfe_u32 v123, v57, 16, 14
    v_lshlrev_b32 v124, 16, v18
    v_bfi_b32 v122, v122, 0, s27
    v_and_b32 v125, s28, v18
    v_lshlrev_b32 v126, 16, v19
    v_mul_f32 v122, s26, v122
    v_and_b32 v127, s28, v19
    v_lshl_add_u32 v123, v123, 3, s25
    v_pk_fma_f32 v[124:125], v[124:125], v[122:123], s[34:35] op_sel_hi:[1,0,1]
    v_pk_fma_f32 v[126:127], v[126:127], v[122:123], s[34:35] op_sel_hi:[1,0,1]
    s_waitcnt lgkmcnt(2)
    v_pk_max_u16 v117, v117, v120
    v_lshl_add_u32 v124, v125, 16, v124
    v_lshl_add_u32 v125, v127, 16, v126
    v_pk_max_u16 v117, v117, v121
    v_lshl_add_u64 v[124:125], v[124:125], 0, s[36:37]
    v_cmpx_ne_u32_sdwa vcc, v57, 0 src0_sel:BYTE_1 src1_sel:DWORD
    ds_add_rtn_u64 v[120:121], v123, v[124:125]
    s_mov_b64 exec, -1
    v_lshlrev_b32_sdwa v122, 11, sext(v58) dst_sel:DWORD dst_unused:UNUSED_PAD src0_sel:DWORD src1_sel:WORD_0
    v_bfe_u32 v123, v58, 16, 14
    v_lshlrev_b32 v124, 16, v20
    v_bfi_b32 v122, v122, 0, s27
    v_and_b32 v125, s28, v20
    v_lshlrev_b32 v126, 16, v21
    v_mul_f32 v122, s26, v122
    v_and_b32 v127, s28, v21
    v_lshl_add_u32 v123, v123, 3, s25
    v_pk_fma_f32 v[124:125], v[124:125], v[122:123], s[34:35] op_sel_hi:[1,0,1]
    v_pk_fma_f32 v[126:127], v[126:127], v[122:123], s[34:35] op_sel_hi:[1,0,1]
    s_waitcnt lgkmcnt(2)
    v_pk_max_u16 v117, v117, v118
    v_lshl_add_u32 v124, v125, 16, v124
    v_lshl_add_u32 v125, v127, 16, v126
    v_pk_max_u16 v117, v117, v119
    v_lshl_add_u64 v[124:125], v[124:125], 0, s[36:37]
    v_cmpx_ne_u32_sdwa vcc, v58, 0 src0_sel:BYTE_1 src1_sel:DWORD
    ds_add_rtn_u64 v[118:119], v123, v[124:125]
    s_mov_b64 exec, -1
    v_lshlrev_b32_sdwa v122, 11, sext(v59) dst_sel:DWORD dst_unused:UNUSED_PAD src0_sel:DWORD src1_sel:WORD_0
    v_bfe_u32 v123, v59, 16, 14
    v_lshlrev_b32 v124, 16, v22
    v_bfi_b32 v122, v122, 0, s27
    v_and_b32 v125, s28, v22
    v_lshlrev_b32 v126, 16, v23
    v_mul_f32 v122, s26, v122
    v_and_b32 v127, s28, v23
    v_lshl_add_u32 v123, v123, 3, s25
    v_pk_fma_f32 v[124:125], v[124:125], v[122:123], s[34:35] op_sel_hi:[1,0,1]
    v_pk_fma_f32 v[126:127], v[126:127], v[122:123], s[34:35] op_sel_hi:[1,0,1]
    s_waitcnt lgkmcnt(1)
    v_pk_max_u16 v117, v117, v120
    v_lshl_add_u32 v124, v125, 16, v124
    v_lshl_add_u32 v125, v127, 16, v126
    v_pk_max_u16 v117, v117, v121
    v_lshl_add_u64 v[124:125], v[124:125], 0, s[36:37]
    v_cmpx_ne_u32_sdwa vcc, v59, 0 src0_sel:BYTE_1 src1_sel:DWORD
    ds_add_rtn_u64 v[120:121], v123, v[124:125]
    s_mov_b64 exec, -1
    s_waitcnt vmcnt(15)
    v_perm_b32 v57, v97, v94, s31
    v_perm_b32 v58, v97, v95, s32
    v_perm_b32 v59, v97, v96, s33
    v_lshlrev_b16 v22, 3, v96
    v_lshlrev_b16 v20, 3, v95
    v_lshlrev_b16 v18, 3, v94
    ds_read_addtid_b32 v94 offset:768
    v_lshlrev_b32_sdwa v122, 11, sext(v60) dst_sel:DWORD dst_unused:UNUSED_PAD src0_sel:DWORD src1_sel:WORD_0
    v_bfe_u32 v123, v60, 16, 14
    v_lshlrev_b32 v124, 16, v24
    v_bfi_b32 v122, v122, 0, s27
    v_and_b32 v125, s28, v24
    v_lshlrev_b32 v126, 16, v25
    v_mul_f32 v122, s26, v122
    v_and_b32 v127, s28, v25
    v_lshl_add_u32 v123, v123, 3, s25
    v_pk_fma_f32 v[124:125], v[124:125], v[122:123], s[34:35] op_sel_hi:[1,0,1]
    v_pk_fma_f32 v[126:127], v[126:127], v[122:123], s[34:35] op_sel_hi:[1,0,1]
    s_waitcnt lgkmcnt(2)
    v_pk_max_u16 v117, v117, v118
    v_lshl_add_u32 v124, v125, 16, v124
    v_lshl_add_u32 v125, v127, 16, v126
    v_pk_max_u16 v117, v117, v119
    v_lshl_add_u64 v[124:125], v[124:125], 0, s[36:37]
    v_cmpx_ne_u32_sdwa vcc, v60, 0 src0_sel:BYTE_1 src1_sel:DWORD
    ds_add_rtn_u64 v[118:119], v123, v[124:125]
    s_mov_b64 exec, -1
    v_lshlrev_b32_sdwa v122, 11, sext(v61) dst_sel:DWORD dst_unused:UNUSED_PAD src0_sel:DWORD src1_sel:WORD_0
    v_bfe_u32 v123, v61, 16, 14
    v_lshlrev_b32 v124, 16, v26
    v_bfi_b32 v122, v122, 0, s27
    v_and_b32 v125, s28, v26
    v_lshlrev_b32 v126, 16, v27
    v_mul_f32 v122, s26, v122
    v_and_b32 v127, s28, v27
    v_lshl_add_u32 v123, v123, 3, s25
    v_pk_fma_f32 v[124:125], v[124:125], v[122:123], s[34:35] op_sel_hi:[1,0,1]
    v_pk_fma_f32 v[126:127], v[126:127], v[122:123], s[34:35] op_sel_hi:[1,0,1]
    s_waitcnt lgkmcnt(2)
    v_pk_max_u16 v117, v117, v120
    v_lshl_add_u32 v124, v125, 16, v124
    v_lshl_add_u32 v125, v127, 16, v126
    v_pk_max_u16 v117, v117, v121
    v_lshl_add_u64 v[124:125], v[124:125], 0, s[36:37]
    v_cmpx_ne_u32_sdwa vcc, v61, 0 src0_sel:BYTE_1 src1_sel:DWORD
    ds_add_rtn_u64 v[120:121], v123, v[124:125]
    s_mov_b64 exec, -1
    v_lshlrev_b32_sdwa v122, 11, sext(v62) dst_sel:DWORD dst_unused:UNUSED_PAD src0_sel:DWORD src1_sel:WORD_0
    v_bfe_u32 v123, v62, 16, 14
    v_lshlrev_b32 v124, 16, v28
    v_bfi_b32 v122, v122, 0, s27
    v_and_b32 v125, s28, v28
    v_lshlrev_b32 v126, 16, v29
    v_mul_f32 v122, s26, v122
    v_and_b32 v127, s28, v29
    v_lshl_add_u32 v123, v123, 3, s25
    v_pk_fma_f32 v[124:125], v[124:125], v[122:123], s[34:35] op_sel_hi:[1,0,1]
    v_pk_fma_f32 v[126:127], v[126:127], v[122:123], s[34:35] op_sel_hi:[1,0,1]
    s_waitcnt lgkmcnt(1)
    v_pk_max_u16 v117, v117, v118
    v_lshl_add_u32 v124, v125, 16, v124
    v_lshl_add_u32 v125, v127, 16, v126
    v_pk_max_u16 v117, v117, v119
    v_lshl_add_u64 v[124:125], v[124:125], 0, s[36:37]
    v_cmpx_ne_u32_sdwa vcc, v62, 0 src0_sel:BYTE_1 src1_sel:DWORD
    ds_add_rtn_u64 v[118:119], v123, v[124:125]
    s_mov_b64 exec, -1
    s_waitcnt vmcnt(11)
    v_perm_b32 v60, v101, v98, s31
    v_perm_b32 v61, v101, v99, s32
    v_perm_b32 v62, v101, v100, s33
    v_lshlrev_b16 v28, 3, v100
    v_lshlrev_b16 v26, 3, v99
    v_lshlrev_b16 v24, 3, v98
    ds_read_addtid_b32 v98 offset:1024
    v_lshlrev_b32_sdwa v122, 11, sext(v63) dst_sel:DWORD dst_unused:UNUSED_PAD src0_sel:DWORD src1_sel:WORD_0
    v_bfe_u32 v123, v63, 16, 14
    v_lshlrev_b32 v124, 16, v30
    v_bfi_b32 v122, v122, 0, s27
    v_and_b32 v125, s28, v30
    v_lshlrev_b32 v126, 16, v31
    v_mul_f32 v122, s26, v122
    v_and_b32 v127, s28, v31
    v_lshl_add_u32 v123, v123, 3, s25
    v_pk_fma_f32 v[124:125], v[124:125], v[122:123], s[34:35] op_sel_hi:[1,0,1]
    v_pk_fma_f32 v[126:127], v[126:127], v[122:123], s[34:35] op_sel_hi:[1,0,1]
    s_waitcnt lgkmcnt(2)
    v_pk_max_u16 v117, v117, v120
    v_lshl_add_u32 v124, v125, 16, v124
    v_lshl_add_u32 v125, v127, 16, v126
    v_pk_max_u16 v117, v117, v121
    v_lshl_add_u64 v[124:125], v[124:125], 0, s[36:37]
    v_cmpx_ne_u32_sdwa vcc, v63, 0 src0_sel:BYTE_1 src1_sel:DWORD
    ds_add_rtn_u64 v[120:121], v123, v[124:125]
    s_mov_b64 exec, -1
    v_lshlrev_b32_sdwa v122, 11, sext(v64) dst_sel:DWORD dst_unused:UNUSED_PAD src0_sel:DWORD src1_sel:WORD_0
    v_bfe_u32 v123, v64, 16, 14
    v_lshlrev_b32 v124, 16, v32
    v_bfi_b32 v122, v122, 0, s27
    v_and_b32 v125, s28, v32
    v_lshlrev_b32 v126, 16, v33
    v_mul_f32 v122, s26, v122
    v_and_b32 v127, s28, v33
    v_lshl_add_u32 v123, v123, 3, s25
    v_pk_fma_f32 v[124:125], v[124:125], v[122:123], s[34:35] op_sel_hi:[1,0,1]
    v_pk_fma_f32 v[126:127], v[126:127], v[122:123], s[34:35] op_sel_hi:[1,0,1]
    s_waitcnt lgkmcnt(2)
    v_pk_max_u16 v117, v117, v118
    v_lshl_add_u32 v124, v125, 16, v124
    v_lshl_add_u32 v125, v127, 16, v126
    v_pk_max_u16 v117, v117, v119
    v_lshl_add_u64 v[124:125], v[124:125], 0, s[36:37]
    v_cmpx_ne_u32_sdwa vcc, v64, 0 src0_sel:BYTE_1 src1_sel:DWORD
    ds_add_rtn_u64 v[118:119], v123, v[124:125]
    s_mov_b64 exec, -1
    v_lshlrev_b32_sdwa v122, 11, sext(v65) dst_sel:DWORD dst_unused:UNUSED_PAD src0_sel:DWORD src1_sel:WORD_0
    v_bfe_u32 v123, v65, 16, 14
    v_lshlrev_b32 v124, 16, v34
    v_bfi_b32 v122, v122, 0, s27
    v_and_b32 v125, s28, v34
    v_lshlrev_b32 v126, 16, v35
    v_mul_f32 v122, s26, v122
    v_and_b32 v127, s28, v35
    v_lshl_add_u32 v123, v123, 3, s25
    v_pk_fma_f32 v[124:125], v[124:125], v[122:123], s[34:35] op_sel_hi:[1,0,1]
    v_pk_fma_f32 v[126:127], v[126:127], v[122:123], s[34:35] op_sel_hi:[1,0,1]
    s_waitcnt lgkmcnt(1)
    v_pk_max_u16 v117, v117, v120
    v_lshl_add_u32 v124, v125, 16, v124
    v_lshl_add_u32 v125, v127, 16, v126
    v_pk_max_u16 v117, v117, v121
    v_lshl_add_u64 v[124:125], v[124:125], 0, s[36:37]
    v_cmpx_ne_u32_sdwa vcc, v65, 0 src0_sel:BYTE_1 src1_sel:DWORD
    ds_add_rtn_u64 v[120:121], v123, v[124:125]
    s_mov_b64 exec, -1
    s_waitcnt vmcnt(7)
    v_perm_b32 v63, v105, v102, s31
    v_perm_b32 v64, v105, v103, s32
    v_perm_b32 v65, v105, v104, s33
    v_lshlrev_b16 v34, 3, v104
    v_lshlrev_b16 v32, 3, v103
    v_lshlrev_b16 v30, 3, v102
    ds_read_addtid_b32 v102 offset:1280
    s_waitcnt lgkmcnt(12)
    buffer_load_dwordx4 v[90:93], v90, s[4:7], 0 offen
    v_lshlrev_b32_sdwa v122, 11, sext(v66) dst_sel:DWORD dst_unused:UNUSED_PAD src0_sel:DWORD src1_sel:WORD_0
    v_bfe_u32 v123, v66, 16, 14
    v_lshlrev_b32 v124, 16, v36
    v_bfi_b32 v122, v122, 0, s27
    v_and_b32 v125, s28, v36
    v_lshlrev_b32 v126, 16, v37
    v_mul_f32 v122, s26, v122
    v_and_b32 v127, s28, v37
    v_lshl_add_u32 v123, v123, 3, s25
    v_pk_fma_f32 v[124:125], v[124:125], v[122:123], s[34:35] op_sel_hi:[1,0,1]
    v_pk_fma_f32 v[126:127], v[126:127], v[122:123], s[34:35] op_sel_hi:[1,0,1]
    s_waitcnt lgkmcnt(2)
    v_pk_max_u16 v117, v117, v118
    v_lshl_add_u32 v124, v125, 16, v124
    v_lshl_add_u32 v125, v127, 16, v126
    v_pk_max_u16 v117, v117, v119
    v_lshl_add_u64 v[124:125], v[124:125], 0, s[36:37]
    v_cmpx_ne_u32_sdwa vcc, v66, 0 src0_sel:BYTE_1 src1_sel:DWORD
    ds_add_rtn_u64 v[118:119], v123, v[124:125]
    s_mov_b64 exec, -1
    v_lshlrev_b32_sdwa v122, 11, sext(v67) dst_sel:DWORD dst_unused:UNUSED_PAD src0_sel:DWORD src1_sel:WORD_0
    v_bfe_u32 v123, v67, 16, 14
    v_lshlrev_b32 v124, 16, v38
    v_bfi_b32 v122, v122, 0, s27
    v_and_b32 v125, s28, v38
    v_lshlrev_b32 v126, 16, v39
    v_mul_f32 v122, s26, v122
    v_and_b32 v127, s28, v39
    v_lshl_add_u32 v123, v123, 3, s25
    v_pk_fma_f32 v[124:125], v[124:125], v[122:123], s[34:35] op_sel_hi:[1,0,1]
    v_pk_fma_f32 v[126:127], v[126:127], v[122:123], s[34:35] op_sel_hi:[1,0,1]
    s_waitcnt lgkmcnt(2)
    v_pk_max_u16 v117, v117, v120
    v_lshl_add_u32 v124, v125, 16, v124
    v_lshl_add_u32 v125, v127, 16, v126
    v_pk_max_u16 v117, v117, v121
    v_lshl_add_u64 v[124:125], v[124:125], 0, s[36:37]
    v_cmpx_ne_u32_sdwa vcc, v67, 0 src0_sel:BYTE_1 src1_sel:DWORD
    ds_add_rtn_u64 v[120:121], v123, v[124:125]
    s_mov_b64 exec, -1
    v_lshlrev_b32_sdwa v122, 11, sext(v68) dst_sel:DWORD dst_unused:UNUSED_PAD src0_sel:DWORD src1_sel:WORD_0
    v_bfe_u32 v123, v68, 16, 14
    v_lshlrev_b32 v124, 16, v40
    v_bfi_b32 v122, v122, 0, s27
    v_and_b32 v125, s28, v40
    v_lshlrev_b32 v126, 16, v41
    v_mul_f32 v122, s26, v122
    v_and_b32 v127, s28, v41
    v_lshl_add_u32 v123, v123, 3, s25
    v_pk_fma_f32 v[124:125], v[124:125], v[122:123], s[34:35] op_sel_hi:[1,0,1]
    v_pk_fma_f32 v[126:127], v[126:127], v[122:123], s[34:35] op_sel_hi:[1,0,1]
    s_waitcnt lgkmcnt(1)
    v_pk_max_u16 v117, v117, v118
    v_lshl_add_u32 v124, v125, 16, v124
    v_lshl_add_u32 v125, v127, 16, v126
    v_pk_max_u16 v117, v117, v119
    v_lshl_add_u64 v[124:125], v[124:125], 0, s[36:37]
    v_cmpx_ne_u32_sdwa vcc, v68, 0 src0_sel:BYTE_1 src1_sel:DWORD
    ds_add_rtn_u64 v[118:119], v123, v[124:125]
    s_mov_b64 exec, -1
    s_waitcnt vmcnt(4)
    v_perm_b32 v66, v109, v106, s31
    v_perm_b32 v67, v109, v107, s32
    v_perm_b32 v68, v109, v108, s33
    v_lshlrev_b16 v40, 3, v108
    v_lshlrev_b16 v38, 3, v107
    v_lshlrev_b16 v36, 3, v106
    ds_read_addtid_b32 v106 offset:1536
    s_cmp_le_u32 s15, 7
    s_cbranch_scc1 p2_na0
    v_lshlrev_b32_sdwa v122, 11, sext(v69) dst_sel:DWORD dst_unused:UNUSED_PAD src0_sel:DWORD src1_sel:WORD_0
    v_bfe_u32 v123, v69, 16, 14
    v_lshlrev_b32 v124, 16, v42
    v_bfi_b32 v122, v122, 0, s27
    v_and_b32 v125, s28, v42
    v_lshlrev_b32 v126, 16, v43
    v_mul_f32 v122, s26, v122
    v_and_b32 v127, s28, v43
    v_lshl_add_u32 v123, v123, 3, s25
    v_pk_fma_f32 v[124:125], v[124:125], v[122:123], s[34:35] op_sel_hi:[1,0,1]
    v_pk_fma_f32 v[126:127], v[126:127], v[122:123], s[34:35] op_sel_hi:[1,0,1]
    s_waitcnt lgkmcnt(2)
    v_pk_max_u16 v117, v117, v120
    v_lshl_add_u32 v124, v125, 16, v124
    v_lshl_add_u32 v125, v127, 16, v126
    v_pk_max_u16 v117, v117, v121
    v_lshl_add_u64 v[124:125], v[124:125], 0, s[36:37]
    v_cmpx_ne_u32_sdwa vcc, v69, 0 src0_sel:BYTE_1 src1_sel:DWORD
    ds_add_rtn_u64 v[120:121], v123, v[124:125]
    s_mov_b64 exec, -1
    v_lshlrev_b32_sdwa v122, 11, sext(v70) dst_sel:DWORD dst_unused:UNUSED_PAD src0_sel:DWORD src1_sel:WORD_0
    v_bfe_u32 v123, v70, 16, 14
    v_lshlrev_b32 v124, 16, v44
    v_bfi_b32 v122, v122, 0, s27
    v_and_b32 v125, s28, v44
    v_lshlrev_b32 v126, 16, v45
    v_mul_f32 v122, s26, v122
    v_and_b32 v127, s28, v45
    v_lshl_add_u32 v123, v123, 3, s25
    v_pk_fma_f32 v[124:125], v[124:125], v[122:123], s[34:35] op_sel_hi:[1,0,1]
    v_pk_fma_f32 v[126:127], v[126:127], v[122:123], s[34:35] op_sel_hi:[1,0,1]
    s_waitcnt lgkmcnt(2)
    v_pk_max_u16 v117, v117, v118
    v_lshl_add_u32 v124, v125, 16, v124
    v_lshl_add_u32 v125, v127, 16, v126
    v_pk_max_u16 v117, v117, v119
    v_lshl_add_u64 v[124:125], v[124:125], 0, s[36:37]
    v_cmpx_ne_u32_sdwa vcc, v70, 0 src0_sel:BYTE_1 src1_sel:DWORD
    ds_add_rtn_u64 v[118:119], v123, v[124:125]
    s_mov_b64 exec, -1
    v_lshlrev_b32_sdwa v122, 11, sext(v71) dst_sel:DWORD dst_unused:UNUSED_PAD src0_sel:DWORD src1_sel:WORD_0
    v_bfe_u32 v123, v71, 16, 14
    v_lshlrev_b32 v124, 16, v46
    v_bfi_b32 v122, v122, 0, s27
    v_and_b32 v125, s28, v46
    v_lshlrev_b32 v126, 16, v47
    v_mul_f32 v122, s26, v122
    v_and_b32 v127, s28, v47
    v_lshl_add_u32 v123, v123, 3, s25
    v_pk_fma_f32 v[124:125], v[124:125], v[122:123], s[34:35] op_sel_hi:[1,0,1]
    v_pk_fma_f32 v[126:127], v[126:127], v[122:123], s[34:35] op_sel_hi:[1,0,1]
    s_waitcnt lgkmcnt(1)
    v_pk_max_u16 v117, v117, v120
    v_lshl_add_u32 v124, v125, 16, v124
    v_lshl_add_u32 v125, v127, 16, v126
    v_pk_max_u16 v117, v117, v121
    v_lshl_add_u64 v[124:125], v[124:125], 0, s[36:37]
    v_cmpx_ne_u32_sdwa vcc, v71, 0 src0_sel:BYTE_1 src1_sel:DWORD
    ds_add_rtn_u64 v[120:121], v123, v[124:125]
    s_mov_b64 exec, -1
p2_na0:
    s_waitcnt vmcnt(3)
    v_perm_b32 v69, v113, v110, s31
    v_perm_b32 v70, v113, v111, s32
    v_perm_b32 v71, v113, v112, s33
    v_lshlrev_b16 v46, 3, v112
    v_lshlrev_b16 v44, 3, v111
    v_lshlrev_b16 v42, 3, v110
    ds_read_addtid_b32 v110 offset:1792
    s_waitcnt lgkmcnt(0)
    v_pk_max_u16 v117, v117, v118
    v_pk_max_u16 v117, v117, v119
    v_pk_max_u16 v117, v117, v120
    v_pk_max_u16 v117, v117, v121
    s_branch p2_added
p2_addf:
    v_lshlrev_b32_sdwa v122, 11, sext(v48) dst_sel:DWORD dst_unused:UNUSED_PAD src0_sel:DWORD src1_sel:WORD_0
    v_bfe_u32 v123, v48, 16, 14
    v_cndmask_b32 v126, v0, v1, s[66:67]
    v_bfi_b32 v122, v122, 0, s27
    v_lshlrev_b32 v124, 16, v126
    v_mul_f32 v122, s26, v122
    v_and_b32 v125, s28, v126
    v_lshl_add_u32 v123, v123, 3, s25
    v_mul_f32 v124, v122, v124
    v_mul_f32 v125, v122, v125
    v_cmpx_ne_u32_sdwa vcc, v48, 0 src0_sel:BYTE_1 src1_sel:DWORD
    ds_add_f32 v123, v124 offset:0
    ds_add_f32 v123, v125 offset:4
    s_mov_b64 exec, -1
    v_lshlrev_b32_sdwa v122, 11, sext(v49) dst_sel:DWORD dst_unused:UNUSED_PAD src0_sel:DWORD src1_sel:WORD_0
    v_bfe_u32 v123, v49, 16, 14
    v_cndmask_b32 v126, v2, v3, s[66:67]
    v_bfi_b32 v122, v122, 0, s27
    v_lshlrev_b32 v124, 16, v126
    v_mul_f32 v122, s26, v122
    v_and_b32 v125, s28, v126
    v_lshl_add_u32 v123, v123, 3, s25
    v_mul_f32 v124, v122, v124
    v_mul_f32 v125, v122, v125
    v_cmpx_ne_u32_sdwa vcc, v49, 0 src0_sel:BYTE_1 src1_sel:DWORD
    ds_add_f32 v123, v124 offset:0
    ds_add_f32 v123, v125 offset:4
    s_mov_b64 exec, -1
    v_lshlrev_b32_sdwa v122, 11, sext(v50) dst_sel:DWORD dst_unused:UNUSED_PAD src0_sel:DWORD src1_sel:WORD_0
    v_bfe_u32 v123, v50, 16, 14
    v_cndmask_b32 v126, v4, v5, s[66:67]
    v_bfi_b32 v122, v122, 0, s27
    v_lshlrev_b32 v124, 16, v126
    v_mul_f32 v122, s26, v122
    v_and_b32 v125, s28, v126
    v_lshl_add_u32 v123, v123, 3, s25
    v_mul_f32 v124, v122, v124
    v_mul_f32 v125, v122, v125
    v_cmpx_ne_u32_sdwa vcc, v50, 0 src0_sel:BYTE_1 src1_sel:DWORD
    ds_add_f32 v123, v124 offset:0
    ds_add_f32 v123, v125 offset:4
    s_mov_b64 exec, -1
    buffer_load_dwordx4 v[0:3], v114, s[4:7], 0 offen
    v_lshlrev_b32_sdwa v122, 11, sext(v51) dst_sel:DWORD dst_unused:UNUSED_PAD src0_sel:DWORD src1_sel:WORD_0
    v_bfe_u32 v123, v51, 16, 14
    v_cndmask_b32 v126, v6, v7, s[66:67]
    v_bfi_b32 v122, v122, 0, s27
    v_lshlrev_b32 v124, 16, v126
    v_mul_f32 v122, s26, v122
    v_and_b32 v125, s28, v126
    v_lshl_add_u32 v123, v123, 3, s25
    v_mul_f32 v124, v122, v124
    v_mul_f32 v125, v122, v125
    v_cmpx_ne_u32_sdwa vcc, v51, 0 src0_sel:BYTE_1 src1_sel:DWORD
    ds_add_f32 v123, v124 offset:0
    ds_add_f32 v123, v125 offset:4
    s_mov_b64 exec, -1
    v_lshlrev_b32_sdwa v122, 11, sext(v52) dst_sel:DWORD dst_unused:UNUSED_PAD src0_sel:DWORD src1_sel:WORD_0
    v_bfe_u32 v123, v52, 16, 14
    v_cndmask_b32 v126, v8, v9, s[66:67]
    v_bfi_b32 v122, v122, 0, s27
    v_lshlrev_b32 v124, 16, v126
    v_mul_f32 v122, s26, v122
    v_and_b32 v125, s28, v126
    v_lshl_add_u32 v123, v123, 3, s25
    v_mul_f32 v124, v122, v124
    v_mul_f32 v125, v122, v125
    v_cmpx_ne_u32_sdwa vcc, v52, 0 src0_sel:BYTE_1 src1_sel:DWORD
    ds_add_f32 v123, v124 offset:0
    ds_add_f32 v123, v125 offset:4
    s_mov_b64 exec, -1
    v_lshlrev_b32_sdwa v122, 11, sext(v53) dst_sel:DWORD dst_unused:UNUSED_PAD src0_sel:DWORD src1_sel:WORD_0
    v_bfe_u32 v123, v53, 16, 14
    v_cndmask_b32 v126, v10, v11, s[66:67]
    v_bfi_b32 v122, v122, 0, s27
    v_lshlrev_b32 v124, 16, v126
    v_mul_f32 v122, s26, v122
    v_and_b32 v125, s28, v126
    v_lshl_add_u32 v123, v123, 3, s25
    v_mul_f32 v124, v122, v124
    v_mul_f32 v125, v122, v125
    v_cmpx_ne_u32_sdwa vcc, v53, 0 src0_sel:BYTE_1 src1_sel:DWORD
    ds_add_f32 v123, v124 offset:0
    ds_add_f32 v123, v125 offset:4
    s_mov_b64 exec, -1
    buffer_load_dwordx4 v[6:9], v115, s[4:7], 0 offen
    s_mov_b32 m0, s23
    v_mov_b32 v53, 0x70000000
    s_movk_i32 s44, 512
    v_sub_u32_sdwa v4, v88, v86 dst_sel:DWORD dst_unused:UNUSED_PAD src0_sel:WORD_0 src1_sel:WORD_0
    v_sub_u32_sdwa v5, v89, v87 dst_sel:DWORD dst_unused:UNUSED_PAD src0_sel:WORD_0 src1_sel:WORD_0
    v_med3_i32 v4, v4, 0, s44
    v_med3_i32 v5, v5, 0, s44
    v_add_u32 v48, v4, v5
    ds_write_addtid_b32 v53 offset:0
    ds_write_addtid_b32 v53 offset:256
    ds_write_addtid_b32 v53 offset:512
    ds_write_addtid_b32 v53 offset:768
    ds_write_addtid_b32 v53 offset:1024
    ds_write_addtid_b32 v53 offset:1280
    ds_write_addtid_b32 v53 offset:1536
    ds_write_addtid_b32 v53 offset:1792
    v_mul_u32_u24 v53, 20096, v116
    v_add_u32 v53, s41, v53
    s_nop 1
    v_add_u32_dpp v48, v48, v48 row_shr:1 row_mask:0xf bank_mask:0xf bound_ctrl:0
    s_nop 1
    v_add_u32_dpp v48, v48, v48 row_shr:2 row_mask:0xf bank_mask:0xf bound_ctrl:0
    s_nop 1
    v_add_u32_dpp v48, v48, v48 row_shr:4 row_mask:0xf bank_mask:0xf bound_ctrl:0
    s_nop 1
    v_add_u32_dpp v48, v48, v48 row_shr:8 row_mask:0xf bank_mask:0xf bound_ctrl:0
    s_nop 1
    v_add_u32_dpp v48, v48, v48 row_bcast:15 row_mask:0xa bank_mask:0xf
    s_nop 1
    v_add_u32_dpp v48, v48, v48 row_bcast:31 row_mask:0xc bank_mask:0xf
    s_nop 1
    s_nop 0
    v_readlane_b32 s38, v48, 63
    v_sub_u32 v50, v48, v5
    v_sub_u32 v49, v50, v4
    v_sub_u32 v10, 512, v49
    v_mad_u32_u16 v51, v86, 16, v53
    v_med3_i32 v10, v10, 0, v4
    v_lshl_add_u32 v49, v49, 2, s23
    v_add_u32 v86, v86, v10
    v_sub_u32 v11, 512, v50
    v_mad_u32_u16 v52, v87, 16, v53
    v_med3_i32 v11, v11, 0, v5
    v_lshl_add_u32 v50, v50, 2, s23
    v_add_u32 v87, v87, v11
    v_add_u32 v52, 160768, v52
    s_min_u32 s17, s38, 512
    s_add_u32 s17, s17, 63
    s_lshr_b32 s17, s17, 6
p2_xc1_0:
    v_cmpx_lt_i32 vcc, 0, v10
    s_cbranch_execz p2_yc1_0
    ds_write_b32 v49, v51 offset:0
    v_add_u32 v51, 16, v51
    v_cmpx_lt_i32 vcc, 1, v10
    s_cbranch_execz p2_yc1_0
    ds_write_b32 v49, v51 offset:4
    v_add_u32 v51, 16, v51
    v_cmpx_lt_i32 vcc, 2, v10
    s_cbranch_execz p2_yc1_0
    ds_write_b32 v49, v51 offset:8
    v_add_u32 v51, 16, v51
    v_cmpx_lt_i32 vcc, 3, v10
    s_cbranch_execz p2_yc1_0
    ds_write_b32 v49, v51 offset:12
    v_add_u32 v51, 16, v51
    v_cmpx_lt_i32 vcc, 4, v10
    s_cbranch_execz p2_yc1_0
    ds_write_b32 v49, v51 offset:16
    v_add_u32 v51, 16, v51
    v_cmpx_lt_i32 vcc, 5, v10
    s_cbranch_execz p2_yc1_0
    ds_write_b32 v49, v51 offset:20
    v_add_u32 v51, 16, v51
    v_cmpx_lt_i32 vcc, 6, v10
    s_cbranch_execz p2_yc1_0
    ds_write_b32 v49, v51 offset:24
    v_add_u32 v51, 16, v51
    v_cmpx_lt_i32 vcc, 7, v10
    s_cbranch_execz p2_yc1_0
    ds_write_b32 v49, v51 offset:28
    v_add_u32 v51, 16, v51
    v_subrev_u32 v10, 8, v10
    v_add_u32 v49, 32, v49
    s_branch p2_xc1_0
p2_yc1_0:
    s_mov_b64 exec, -1
p2_xc1_1:
    v_cmpx_lt_i32 vcc, 0, v11
    s_cbranch_execz p2_yc1_1
    ds_write_b32 v50, v52 offset:0
    v_add_u32 v52, 16, v52
    v_cmpx_lt_i32 vcc, 1, v11
    s_cbranch_execz p2_yc1_1
    ds_write_b32 v50, v52 offset:4
    v_add_u32 v52, 16, v52
    v_cmpx_lt_i32 vcc, 2, v11
    s_cbranch_execz p2_yc1_1
    ds_write_b32 v50, v52 offset:8
    v_add_u32 v52, 16, v52
    v_cmpx_lt_i32 vcc, 3, v11
    s_cbranch_execz p2_yc1_1
    ds_write_b32 v50, v52 offset:12
    v_add_u32 v52, 16, v52
    v_cmpx_lt_i32 vcc, 4, v11
    s_cbranch_execz p2_yc1_1
    ds_write_b32 v50, v52 offset:16
    v_add_u32 v52, 16, v52
    v_cmpx_lt_i32 vcc, 5, v11
    s_cbranch_execz p2_yc1_1
    ds_write_b32 v50, v52 offset:20
    v_add_u32 v52, 16, v52
    v_cmpx_lt_i32 vcc, 6, v11
    s_cbranch_execz p2_yc1_1
    ds_write_b32 v50, v52 offset:24
    v_add_u32 v52, 16, v52
    v_cmpx_lt_i32 vcc, 7, v11
    s_cbranch_execz p2_yc1_1
    ds_write_b32 v50, v52 offset:28
    v_add_u32 v52, 16, v52
    v_subrev_u32 v11, 8, v11
    v_add_u32 v50, 32, v50
    s_branch p2_xc1_1
p2_yc1_1:
    s_mov_b64 exec, -1
    s_cmp_lt_u32 s38, 512
    s_cbranch_scc1 p2_nomorec1
    v_cmp_lt_u32_sdwa s[44:45], v86, v88 src0_sel:WORD_0 src1_sel:WORD_0
    v_cmp_lt_u32_sdwa s[46:47], v87, v89 src0_sel:WORD_0 src1_sel:WORD_0
    s_nop 0
    s_or_b64 s[44:45], s[44:45], s[46:47]
    s_cbranch_scc0 p2_nomorec1
    v_mov_b32 v49, s19
    v_mov_b32 v50, 1
    ds_write_b32 v49, v50 offset:53760
p2_nomorec1:
    ds_read_addtid_b32 v114 offset:0
    ds_read_addtid_b32 v115 offset:256
    v_lshlrev_b32_sdwa v122, 11, sext(v54) dst_sel:DWORD dst_unused:UNUSED_PAD src0_sel:DWORD src1_sel:WORD_0
    v_bfe_u32 v123, v54, 16, 14
    v_cndmask_b32 v126, v12, v13, s[66:67]
    v_bfi_b32 v122, v122, 0, s27
    v_lshlrev_b32 v124, 16, v126
    v_mul_f32 v122, s26, v122
    v_and_b32 v125, s28, v126
    v_lshl_add_u32 v123, v123, 3, s25
    v_mul_f32 v124, v122, v124
    v_mul_f32 v125, v122, v125
    v_cmpx_ne_u32_sdwa vcc, v54, 0 src0_sel:BYTE_1 src1_sel:DWORD
    ds_add_f32 v123, v124 offset:0
    ds_add_f32 v123, v125 offset:4
    s_mov_b64 exec, -1
    v_lshlrev_b32_sdwa v122, 11, sext(v55) dst_sel:DWORD dst_unused:UNUSED_PAD src0_sel:DWORD src1_sel:WORD_0
    v_bfe_u32 v123, v55, 16, 14
    v_cndmask_b32 v126, v14, v15, s[66:67]
    v_bfi_b32 v122, v122, 0, s27
    v_lshlrev_b32 v124, 16, v126
    v_mul_f32 v122, s26, v122
    v_and_b32 v125, s28, v126
    v_lshl_add_u32 v123, v123, 3, s25
    v_mul_f32 v124, v122, v124
    v_mul_f32 v125, v122, v125
    v_cmpx_ne_u32_sdwa vcc, v55, 0 src0_sel:BYTE_1 src1_sel:DWORD
    ds_add_f32 v123, v124 offset:0
    ds_add_f32 v123, v125 offset:4
    s_mov_b64 exec, -1
    v_lshlrev_b32_sdwa v122, 11, sext(v56) dst_sel:DWORD dst_unused:UNUSED_PAD src0_sel:DWORD src1_sel:WORD_0
    v_bfe_u32 v123, v56, 16, 14
    v_cndmask_b32 v126, v16, v17, s[66:67]
    v_bfi_b32 v122, v122, 0, s27
    v_lshlrev_b32 v124, 16, v126
    v_mul_f32 v122, s26, v122
    v_and_b32 v125, s28, v126
    v_lshl_add_u32 v123, v123, 3, s25
    v_mul_f32 v124, v122, v124
    v_mul_f32 v125, v122, v125
    v_cmpx_ne_u32_sdwa vcc, v56, 0 src0_sel:BYTE_1 src1_sel:DWORD
    ds_add_f32 v123, v124 offset:0
    ds_add_f32 v123, v125 offset:4
    s_mov_b64 exec, -1
    s_setprio 0
    s_waitcnt vmcnt(16)
    v_perm_b32 v54, v93, v90, s31
    v_perm_b32 v55, v93, v91, s32
    v_perm_b32 v56, v93, v92, s33
    v_lshlrev_b16 v16, 3, v92
    v_lshlrev_b16 v14, 3, v91
    v_lshlrev_b16 v12, 3, v90
    ds_read_addtid_b32 v90 offset:512
    v_lshlrev_b32_sdwa v122, 11, sext(v57) dst_sel:DWORD dst_unused:UNUSED_PAD src0_sel:DWORD src1_sel:WORD_0
    v_bfe_u32 v123, v57, 16, 14
    v_cndmask_b32 v126, v18, v19, s[66:67]
    v_bfi_b32 v122, v122, 0, s27
    v_lshlrev_b32 v124, 16, v126
    v_mul_f32 v122, s26, v122
    v_and_b32 v125, s28, v126
    v_lshl_add_u32 v123, v123, 3, s25
    v_mul_f32 v124, v122, v124
    v_mul_f32 v125, v122, v125
    v_cmpx_ne_u32_sdwa vcc, v57, 0 src0_sel:BYTE_1 src1_sel:DWORD
    ds_add_f32 v123, v124 offset:0
    ds_add_f32 v123, v125 offset:4
    s_mov_b64 exec, -1
    v_lshlrev_b32_sdwa v122, 11, sext(v58) dst_sel:DWORD dst_unused:UNUSED_PAD src0_sel:DWORD src1_sel:WORD_0
    v_bfe_u32 v123, v58, 16, 14
    v_cndmask_b32 v126, v20, v21, s[66:67]
    v_bfi_b32 v122, v122, 0, s27
    v_lshlrev_b32 v124, 16, v126
    v_mul_f32 v122, s26, v122
    v_and_b32 v125, s28, v126
    v_lshl_add_u32 v123, v123, 3, s25
    v_mul_f32 v124, v122, v124
    v_mul_f32 v125, v122, v125
    v_cmpx_ne_u32_sdwa vcc, v58, 0 src0_sel:BYTE_1 src1_sel:DWORD
    ds_add_f32 v123, v124 offset:0
    ds_add_f32 v123, v125 offset:4
    s_mov_b64 exec, -1
    v_lshlrev_b32_sdwa v122, 11, sext(v59) dst_sel:DWORD dst_unused:UNUSED_PAD src0_sel:DWORD src1_sel:WORD_0
    v_bfe_u32 v123, v59, 16, 14
    v_cndmask_b32 v126, v22, v23, s[66:67]
    v_bfi_b32 v122, v122, 0, s27
    v_lshlrev_b32 v124, 16, v126
    v_mul_f32 v122, s26, v122
    v_and_b32 v125, s28, v126
    v_lshl_add_u32 v123, v123, 3, s25
    v_mul_f32 v124, v122, v124
    v_mul_f32 v125, v122, v125
    v_cmpx_ne_u32_sdwa vcc, v59, 0 src0_sel:BYTE_1 src1_sel:DWORD
    ds_add_f32 v123, v124 offset:0
    ds_add_f32 v123, v125 offset:4
    s_mov_b64 exec, -1
    s_waitcnt vmcnt(15)
    v_perm_b32 v57, v97, v94, s31
    v_perm_b32 v58, v97, v95, s32
    v_perm_b32 v59, v97, v96, s33
    v_lshlrev_b16 v22, 3, v96
    v_lshlrev_b16 v20, 3, v95
    v_lshlrev_b16 v18, 3, v94
    ds_read_addtid_b32 v94 offset:768
    v_lshlrev_b32_sdwa v122, 11, sext(v60) dst_sel:DWORD dst_unused:UNUSED_PAD src0_sel:DWORD src1_sel:WORD_0
    v_bfe_u32 v123, v60, 16, 14
    v_cndmask_b32 v126, v24, v25, s[66:67]
    v_bfi_b32 v122, v122, 0, s27
    v_lshlrev_b32 v124, 16, v126
    v_mul_f32 v122, s26, v122
    v_and_b32 v125, s28, v126
    v_lshl_add_u32 v123, v123, 3, s25
    v_mul_f32 v124, v122, v124
    v_mul_f32 v125, v122, v125
    v_cmpx_ne_u32_sdwa vcc, v60, 0 src0_sel:BYTE_1 src1_sel:DWORD
    ds_add_f32 v123, v124 offset:0
    ds_add_f32 v123, v125 offset:4
    s_mov_b64 exec, -1
    v_lshlrev_b32_sdwa v122, 11, sext(v61) dst_sel:DWORD dst_unused:UNUSED_PAD src0_sel:DWORD src1_sel:WORD_0
    v_bfe_u32 v123, v61, 16, 14
    v_cndmask_b32 v126, v26, v27, s[66:67]
    v_bfi_b32 v122, v122, 0, s27
    v_lshlrev_b32 v124, 16, v126
    v_mul_f32 v122, s26, v122
    v_and_b32 v125, s28, v126
    v_lshl_add_u32 v123, v123, 3, s25
    v_mul_f32 v124, v122, v124
    v_mul_f32 v125, v122, v125
    v_cmpx_ne_u32_sdwa vcc, v61, 0 src0_sel:BYTE_1 src1_sel:DWORD
    ds_add_f32 v123, v124 offset:0
    ds_add_f32 v123, v125 offset:4
    s_mov_b64 exec, -1
    v_lshlrev_b32_sdwa v122, 11, sext(v62) dst_sel:DWORD dst_unused:UNUSED_PAD src0_sel:DWORD src1_sel:WORD_0
    v_bfe_u32 v123, v62, 16, 14
    v_cndmask_b32 v126, v28, v29, s[66:67]
    v_bfi_b32 v122, v122, 0, s27
    v_lshlrev_b32 v124, 16, v126
    v_mul_f32 v122, s26, v122
    v_and_b32 v125, s28, v126
    v_lshl_add_u32 v123, v123, 3, s25
    v_mul_f32 v124, v122, v124
    v_mul_f32 v125, v122, v125
    v_cmpx_ne_u32_sdwa vcc, v62, 0 src0_sel:BYTE_1 src1_sel:DWORD
    ds_add_f32 v123, v124 offset:0
    ds_add_f32 v123, v125 offset:4
    s_mov_b64 exec, -1
    s_waitcnt vmcnt(11)
    v_perm_b32 v60, v101, v98, s31
    v_perm_b32 v61, v101, v99, s32
    v_perm_b32 v62, v101, v100, s33
    v_lshlrev_b16 v28, 3, v100
    v_lshlrev_b16 v26, 3, v99
    v_lshlrev_b16 v24, 3, v98
    ds_read_addtid_b32 v98 offset:1024
    v_lshlrev_b32_sdwa v122, 11, sext(v63) dst_sel:DWORD dst_unused:UNUSED_PAD src0_sel:DWORD src1_sel:WORD_0
    v_bfe_u32 v123, v63, 16, 14
    v_cndmask_b32 v126, v30, v31, s[66:67]
    v_bfi_b32 v122, v122, 0, s27
    v_lshlrev_b32 v124, 16, v126
    v_mul_f32 v122, s26, v122
    v_and_b32 v125, s28, v126
    v_lshl_add_u32 v123, v123, 3, s25
    v_mul_f32 v124, v122, v124
    v_mul_f32 v125, v122, v125
    v_cmpx_ne_u32_sdwa vcc, v63, 0 src0_sel:BYTE_1 src1_sel:DWORD
    ds_add_f32 v123, v124 offset:0
    ds_add_f32 v123, v125 offset:4
    s_mov_b64 exec, -1
    v_lshlrev_b32_sdwa v122, 11, sext(v64) dst_sel:DWORD dst_unused:UNUSED_PAD src0_sel:DWORD src1_sel:WORD_0
    v_bfe_u32 v123, v64, 16, 14
    v_cndmask_b32 v126, v32, v33, s[66:67]
    v_bfi_b32 v122, v122, 0, s27
    v_lshlrev_b32 v124, 16, v126
    v_mul_f32 v122, s26, v122
    v_and_b32 v125, s28, v126
    v_lshl_add_u32 v123, v123, 3, s25
    v_mul_f32 v124, v122, v124
    v_mul_f32 v125, v122, v125
    v_cmpx_ne_u32_sdwa vcc, v64, 0 src0_sel:BYTE_1 src1_sel:DWORD
    ds_add_f32 v123, v124 offset:0
    ds_add_f32 v123, v125 offset:4
    s_mov_b64 exec, -1
    v_lshlrev_b32_sdwa v122, 11, sext(v65) dst_sel:DWORD dst_unused:UNUSED_PAD src0_sel:DWORD src1_sel:WORD_0
    v_bfe_u32 v123, v65, 16, 14
    v_cndmask_b32 v126, v34, v35, s[66:67]
    v_bfi_b32 v122, v122, 0, s27
    v_lshlrev_b32 v124, 16, v126
    v_mul_f32 v122, s26, v122
    v_and_b32 v125, s28, v126
    v_lshl_add_u32 v123, v123, 3, s25
    v_mul_f32 v124, v122, v124
    v_mul_f32 v125, v122, v125
    v_cmpx_ne_u32_sdwa vcc, v65, 0 src0_sel:BYTE_1 src1_sel:DWORD
    ds_add_f32 v123, v124 offset:0
    ds_add_f32 v123, v125 offset:4
    s_mov_b64 exec, -1
    s_waitcnt vmcnt(7)
    v_perm_b32 v63, v105, v102, s31
    v_perm_b32 v64, v105, v103, s32
    v_perm_b32 v65, v105, v104, s33
    v_lshlrev_b16 v34, 3, v104
    v_lshlrev_b16 v32, 3, v103
    v_lshlrev_b16 v30, 3, v102
    ds_read_addtid_b32 v102 offset:1280
    s_waitcnt lgkmcnt(15)
    buffer_load_dwordx4 v[90:93], v90, s[4:7], 0 offen
    v_lshlrev_b32_sdwa v122, 11, sext(v66) dst_sel:DWORD dst_unused:UNUSED_PAD src0_sel:DWORD src1_sel:WORD_0
    v_bfe_u32 v123, v66, 16, 14
    v_cndmask_b32 v126, v36, v37, s[66:67]
    v_bfi_b32 v122, v122, 0, s27
    v_lshlrev_b32 v124, 16, v126
    v_mul_f32 v122, s26, v122
    v_and_b32 v125, s28, v126
    v_lshl_add_u32 v123, v123, 3, s25
    v_mul_f32 v124, v122, v124
    v_mul_f32 v125, v122, v125
    v_cmpx_ne_u32_sdwa vcc, v66, 0 src0_sel:BYTE_1 src1_sel:DWORD
    ds_add_f32 v123, v124 offset:0
    ds_add_f32 v123, v125 offset:4
    s_mov_b64 exec, -1
    v_lshlrev_b32_sdwa v122, 11, sext(v67) dst_sel:DWORD dst_unused:UNUSED_PAD src0_sel:DWORD src1_sel:WORD_0
    v_bfe_u32 v123, v67, 16, 14
    v_cndmask_b32 v126, v38, v39, s[66:67]
    v_bfi_b32 v122, v122, 0, s27
    v_lshlrev_b32 v124, 16, v126
    v_mul_f32 v122, s26, v122
    v_and_b32 v125, s28, v126
    v_lshl_add_u32 v123, v123, 3, s25
    v_mul_f32 v124, v122, v124
    v_mul_f32 v125, v122, v125
    v_cmpx_ne_u32_sdwa vcc, v67, 0 src0_sel:BYTE_1 src1_sel:DWORD
    ds_add_f32 v123, v124 offset:0
    ds_add_f32 v123, v125 offset:4
    s_mov_b64 exec, -1
    v_lshlrev_b32_sdwa v122, 11, sext(v68) dst_sel:DWORD dst_unused:UNUSED_PAD src0_sel:DWORD src1_sel:WORD_0
    v_bfe_u32 v123, v68, 16, 14
    v_cndmask_b32 v126, v40, v41, s[66:67]
    v_bfi_b32 v122, v122, 0, s27
    v_lshlrev_b32 v124, 16, v126
    v_mul_f32 v122, s26, v122
    v_and_b32 v125, s28, v126
    v_lshl_add_u32 v123, v123, 3, s25
    v_mul_f32 v124, v122, v124
    v_mul_f32 v125, v122, v125
    v_cmpx_ne_u32_sdwa vcc, v68, 0 src0_sel:BYTE_1 src1_sel:DWORD
    ds_add_f32 v123, v124 offset:0
    ds_add_f32 v123, v125 offset:4
    s_mov_b64 exec, -1
    s_waitcnt vmcnt(4)
    v_perm_b32 v66, v109, v106, s31
    v_perm_b32 v67, v109, v107, s32
    v_perm_b32 v68, v109, v108, s33
    v_lshlrev_b16 v40, 3, v108
    v_lshlrev_b16 v38, 3, v107
    v_lshlrev_b16 v36, 3, v106
    ds_read_addtid_b32 v106 offset:1536
    s_cmp_le_u32 s15, 7
    s_cbranch_scc1 p2_na1
    v_lshlrev_b32_sdwa v122, 11, sext(v69) dst_sel:DWORD dst_unused:UNUSED_PAD src0_sel:DWORD src1_sel:WORD_0
    v_bfe_u32 v123, v69, 16, 14
    v_cndmask_b32 v126, v42, v43, s[66:67]
    v_bfi_b32 v122, v122, 0, s27
    v_lshlrev_b32 v124, 16, v126
    v_mul_f32 v122, s26, v122
    v_and_b32 v125, s28, v126
    v_lshl_add_u32 v123, v123, 3, s25
    v_mul_f32 v124, v122, v124
    v_mul_f32 v125, v122, v125
    v_cmpx_ne_u32_sdwa vcc, v69, 0 src0_sel:BYTE_1 src1_sel:DWORD
    ds_add_f32 v123, v124 offset:0
    ds_add_f32 v123, v125 offset:4
    s_mov_b64 exec, -1
    v_lshlrev_b32_sdwa v122, 11, sext(v70) dst_sel:DWORD dst_unused:UNUSED_PAD src0_sel:DWORD src1_sel:WORD_0
    v_bfe_u32 v123, v70, 16, 14
    v_cndmask_b32 v126, v44, v45, s[66:67]
    v_bfi_b32 v122, v122, 0, s27
    v_lshlrev_b32 v124, 16, v126
    v_mul_f32 v122, s26, v122
    v_and_b32 v125, s28, v126
    v_lshl_add_u32 v123, v123, 3, s25
    v_mul_f32 v124, v122, v124
    v_mul_f32 v125, v122, v125
    v_cmpx_ne_u32_sdwa vcc, v70, 0 src0_sel:BYTE_1 src1_sel:DWORD
    ds_add_f32 v123, v124 offset:0
    ds_add_f32 v123, v125 offset:4
    s_mov_b64 exec, -1
    v_lshlrev_b32_sdwa v122, 11, sext(v71) dst_sel:DWORD dst_unused:UNUSED_PAD src0_sel:DWORD src1_sel:WORD_0
    v_bfe_u32 v123, v71, 16, 14
    v_cndmask_b32 v126, v46, v47, s[66:67]
    v_bfi_b32 v122, v122, 0, s27
    v_lshlrev_b32 v124, 16, v126
    v_mul_f32 v122, s26, v122
    v_and_b32 v125, s28, v126
    v_lshl_add_u32 v123, v123, 3, s25
    v_mul_f32 v124, v122, v124
    v_mul_f32 v125, v122, v125
    v_cmpx_ne_u32_sdwa vcc, v71, 0 src0_sel:BYTE_1 src1_sel:DWORD
    ds_add_f32 v123, v124 offset:0
    ds_add_f32 v123, v125 offset:4
    s_mov_b64 exec, -1
p2_na1:
    s_waitcnt vmcnt(3)
    v_perm_b32 v69, v113, v110, s31
    v_perm_b32 v70, v113, v111, s32
    v_perm_b32 v71, v113, v112, s33
    v_lshlrev_b16 v46, 3, v112
    v_lshlrev_b16 v44, 3, v111
    v_lshlrev_b16 v42, 3, v110
    ds_read_addtid_b32 v110 offset:1792
    s_waitcnt lgkmcnt(0)
p2_added:
    s_setprio 0
    s_cmp_lg_u32 s61, 0
    s_cbranch_scc1 p2_fin
p2_tail:
    s_mov_b32 s68, s69
    s_mov_b32 s61, s63
    s_mov_b32 s15, s16
    s_mov_b32 s16, s17
    buffer_load_dwordx4 v[94:97], v94, s[4:7], 0 offen
    s_waitcnt vmcnt(3)
    v_perm_b32 v48, v3, v0, s31
    v_perm_b32 v49, v3, v1, s32
    v_perm_b32 v50, v3, v2, s33
    v_lshlrev_b16 v4, 3, v2
    v_lshlrev_b16 v2, 3, v1
    v_lshlrev_b16 v0, 3, v0
    s_waitcnt vmcnt(2)
    v_perm_b32 v51, v9, v6, s31
    v_perm_b32 v52, v9, v7, s32
    v_perm_b32 v53, v9, v8, s33
    v_lshlrev_b16 v10, 3, v8
    v_lshlrev_b16 v8, 3, v7
    v_lshlrev_b16 v6, 3, v6
    s_mov_b32 m0, s23
    s_nop 0
    ds_write_addtid_b32 v72 offset:0
    ds_write_addtid_b32 v73 offset:256
    ds_write_addtid_b32 v74 offset:512
    ds_write_addtid_b32 v75 offset:768
    ds_write_addtid_b32 v76 offset:1024
    ds_write_addtid_b32 v77 offset:1280
    ds_write_addtid_b32 v78 offset:1536
    ds_write_addtid_b32 v79 offset:1792
    ds_write_addtid_b32 v80 offset:2048
    ds_write_addtid_b32 v81 offset:2304
    ds_write_addtid_b32 v82 offset:2560
    ds_write_addtid_b32 v83 offset:2816
    s_cmp_ge_u32 s10, 9
    s_cbranch_scc1 p2_notail0
    s_mov_b32 m0, s24
    s_nop 0
    ds_write_addtid_b32 v84 offset:49152
    ds_write_addtid_b32 v85 offset:49408
p2_notail0:
    s_add_u32 s20, s20, 53760
    s_waitcnt lgkmcnt(0)
    s_barrier
    v_mov_b32 v122, s19
    s_xor_b32 s19, s19, 4
    ds_read_b32 v127, v122 offset:53760
    v_mov_b32 v123, s19
    v_mov_b32 v124, 0
    ds_write_b32 v123, v124 offset:53760
    buffer_load_dwordx4 v[72:75], v116, s[4:7], s20 offen offset:0
    v_cmpx_gt_u32 vcc, 2.0, v48
    ds_read_b64 v[0:1], v0
    s_mov_b64 exec, -1
    v_cmpx_gt_u32 vcc, 2.0, v49
    ds_read_b64 v[2:3], v2
    s_mov_b64 exec, -1
    v_cmpx_gt_u32 vcc, 2.0, v50
    ds_read_b64 v[4:5], v4
    s_mov_b64 exec, -1
    buffer_load_dwordx4 v[76:79], v116, s[4:7], s20 offen offset:1024
    v_cmpx_gt_u32 vcc, 2.0, v51
    ds_read_b64 v[6:7], v6
    s_mov_b64 exec, -1
    v_cmpx_gt_u32 vcc, 2.0, v52
    ds_read_b64 v[8:9], v8
    s_mov_b64 exec, -1
    v_cmpx_gt_u32 vcc, 2.0, v53
    ds_read_b64 v[10:11], v10
    s_mov_b64 exec, -1
    buffer_load_dwordx4 v[80:83], v116, s[4:7], s20 offen offset:2048
    v_cmpx_gt_u32 vcc, 2.0, v54
    ds_read_b64 v[12:13], v12
    s_mov_b64 exec, -1
    v_cmpx_gt_u32 vcc, 2.0, v55
    ds_read_b64 v[14:15], v14
    s_mov_b64 exec, -1
    v_cmpx_gt_u32 vcc, 2.0, v56
    ds_read_b64 v[16:17], v16
    s_mov_b64 exec, -1
    s_cmp_ge_u32 s10, 9
    s_cbranch_scc1 p2_nms0
    v_lshrrev_b32 v84, 1, v116
    s_add_u32 s44, s20, s42
    buffer_load_dwordx2 v[84:85], v84, s[4:7], s44 offen
p2_nms0:
    v_cmpx_gt_u32 vcc, 2.0, v57
    ds_read_b64 v[18:19], v18
    s_mov_b64 exec, -1
    v_cmpx_gt_u32 vcc, 2.0, v58
    ds_read_b64 v[20:21], v20
    s_mov_b64 exec, -1
    v_cmpx_gt_u32 vcc, 2.0, v59
    ds_read_b64 v[22:23], v22
    s_mov_b64 exec, -1
    v_cmpx_gt_u32 vcc, 2.0, v60
    ds_read_b64 v[24:25], v24
    s_mov_b64 exec, -1
    v_cmpx_gt_u32 vcc, 2.0, v61
    ds_read_b64 v[26:27], v26
    s_mov_b64 exec, -1
    v_cmpx_gt_u32 vcc, 2.0, v62
    ds_read_b64 v[28:29], v28
    s_mov_b64 exec, -1
    v_cmpx_gt_u32 vcc, 2.0, v63
    ds_read_b64 v[30:31], v30
    s_mov_b64 exec, -1
    v_cmpx_gt_u32 vcc, 2.0, v64
    ds_read_b64 v[32:33], v32
    s_mov_b64 exec, -1
    v_cmpx_gt_u32 vcc, 2.0, v65
    ds_read_b64 v[34:35], v34
    s_mov_b64 exec, -1
    v_cmpx_gt_u32 vcc, 2.0, v66
    ds_read_b64 v[36:37], v36
    s_mov_b64 exec, -1
    v_cmpx_gt_u32 vcc, 2.0, v67
    ds_read_b64 v[38:39], v38
    s_mov_b64 exec, -1
    v_cmpx_gt_u32 vcc, 2.0, v68
    ds_read_b64 v[40:41], v40
    s_mov_b64 exec, -1
    s_cmp_le_u32 s15, 7
    s_cbranch_scc1 p2_g0
    v_cmpx_gt_u32 vcc, 2.0, v69
    ds_read_b64 v[42:43], v42
    s_mov_b64 exec, -1
    v_cmpx_gt_u32 vcc, 2.0, v70
    ds_read_b64 v[44:45], v44
    s_mov_b64 exec, -1
    v_cmpx_gt_u32 vcc, 2.0, v71
    ds_read_b64 v[46:47], v46
    s_mov_b64 exec, -1
p2_g0:
    buffer_load_dwordx4 v[98:101], v98, s[4:7], 0 offen
    s_waitcnt lgkmcnt(0)
    s_barrier
    s_waitcnt vmcnt(1)
    s_mov_b32 m0, s23
    s_nop 0
    ds_write_addtid_b32 v72 offset:0
    ds_write_addtid_b32 v73 offset:256
    ds_write_addtid_b32 v74 offset:512
    ds_write_addtid_b32 v75 offset:768
    ds_write_addtid_b32 v76 offset:1024
    ds_write_addtid_b32 v77 offset:1280
    ds_write_addtid_b32 v78 offset:1536
    ds_write_addtid_b32 v79 offset:1792
    ds_write_addtid_b32 v80 offset:2048
    ds_write_addtid_b32 v81 offset:2304
    ds_write_addtid_b32 v82 offset:2560
    ds_write_addtid_b32 v83 offset:2816
    s_cmp_ge_u32 s10, 9
    s_cbranch_scc1 p2_notail1
    s_mov_b32 m0, s24
    s_nop 0
    ds_write_addtid_b32 v84 offset:49152
    ds_write_addtid_b32 v85 offset:49408
p2_notail1:
    s_add_u32 s20, s20, 53760
    s_waitcnt lgkmcnt(0)
    s_barrier
    v_readfirstlane_b32 s62, v127
    s_mov_b32 s63, 0
    s_cmp_lg_u32 s62, 0
    s_cbranch_scc1 p2_advb_done
    s_add_u32 s13, s13, 1
    s_cmp_ge_u32 s13, s14
    s_cselect_b32 s63, 1, 0
    s_cbranch_scc0 p2_newdescb
    v_lshrrev_b32 v86, 16, v86
    v_lshrrev_b32 v87, 16, v87
    v_lshrrev_b32 v88, 16, v88
    v_lshrrev_b32 v89, 16, v89
    s_branch p2_advb_done
p2_newdescb:
    s_add_u32 s44, s13, s65
    s_cmp_ge_u32 s44, 10
    s_cselect_b32 s45, 10, 0
    s_sub_u32 s69, s44, s45
    s_mul_i32 s44, s69, 1064960
    s_add_u32 s44, s44, s40
    buffer_load_ushort v86, v116, s[4:7], s44 offen offset:0
    buffer_load_ushort v87, v116, s[4:7], s44 offen offset:8
    s_add_u32 s44, s44, 16384
    buffer_load_ushort v88, v116, s[4:7], s44 offen offset:0
    buffer_load_ushort v89, v116, s[4:7], s44 offen offset:8
p2_advb_done:
    s_cmp_lg_u32 s10, 0
    s_cbranch_scc1 p2_ntg
    s_lshr_b32 s44, s2, 3
    s_mul_i32 s44, s44, 5120
    s_mul_i32 s45, s68, 645120
    s_add_u32 s44, s44, s45
    s_add_u32 s44, s44, s70
    v_lshlrev_b32 v126, 3, v116
    s_mov_b32 exec_hi, 0xff
    buffer_load_dword v126, v126, s[4:7], s44 offen
    s_mov_b64 exec, -1
p2_ntg:
    buffer_load_dwordx4 v[72:75], v116, s[4:7], s20 offen offset:0
    v_cmpx_le_i32 vcc, 2.0, v48
    ds_read_b64 v[0:1], v0
    s_mov_b64 exec, -1
    v_cmpx_le_i32 vcc, 2.0, v49
    ds_read_b64 v[2:3], v2
    s_mov_b64 exec, -1
    v_cmpx_le_i32 vcc, 2.0, v50
    ds_read_b64 v[4:5], v4
    s_mov_b64 exec, -1
    buffer_load_dwordx4 v[76:79], v116, s[4:7], s20 offen offset:1024
    v_cmpx_le_i32 vcc, 2.0, v51
    ds_read_b64 v[6:7], v6
    s_mov_b64 exec, -1
    v_cmpx_le_i32 vcc, 2.0, v52
    ds_read_b64 v[8:9], v8
    s_mov_b64 exec, -1
    v_cmpx_le_i32 vcc, 2.0, v53
    ds_read_b64 v[10:11], v10
    s_mov_b64 exec, -1
    buffer_load_dwordx4 v[80:83], v116, s[4:7], s20 offen offset:2048
    v_cmpx_le_i32 vcc, 2.0, v54
    ds_read_b64 v[12:13], v12
    s_mov_b64 exec, -1
    v_cmpx_le_i32 vcc, 2.0, v55
    ds_read_b64 v[14:15], v14
    s_mov_b64 exec, -1
    v_cmpx_le_i32 vcc, 2.0, v56
    ds_read_b64 v[16:17], v16
    s_mov_b64 exec, -1
    s_cmp_ge_u32 s10, 9
    s_cbranch_scc1 p2_nms1
    v_lshrrev_b32 v84, 1, v116
    s_add_u32 s44, s20, s42
    buffer_load_dwordx2 v[84:85], v84, s[4:7], s44 offen
p2_nms1:
    v_cmpx_le_i32 vcc, 2.0, v57
    ds_read_b64 v[18:19], v18
    s_mov_b64 exec, -1
    v_cmpx_le_i32 vcc, 2.0, v58
    ds_read_b64 v[20:21], v20
    s_mov_b64 exec, -1
    v_cmpx_le_i32 vcc, 2.0, v59
    ds_read_b64 v[22:23], v22
    s_mov_b64 exec, -1
    v_cmpx_le_i32 vcc, 2.0, v60
    ds_read_b64 v[24:25], v24
    s_mov_b64 exec, -1
    v_cmpx_le_i32 vcc, 2.0, v61
    ds_read_b64 v[26:27], v26
    s_mov_b64 exec, -1
    v_cmpx_le_i32 vcc, 2.0, v62
    ds_read_b64 v[28:29], v28
    s_mov_b64 exec, -1
    v_cmpx_le_i32 vcc, 2.0, v63
    ds_read_b64 v[30:31], v30
    s_mov_b64 exec, -1
    v_cmpx_le_i32 vcc, 2.0, v64
    ds_read_b64 v[32:33], v32
    s_mov_b64 exec, -1
    v_cmpx_le_i32 vcc, 2.0, v65
    ds_read_b64 v[34:35], v34
    s_mov_b64 exec, -1
    v_cmpx_le_i32 vcc, 2.0, v66
    ds_read_b64 v[36:37], v36
    s_mov_b64 exec, -1
    v_cmpx_le_i32 vcc, 2.0, v67
    ds_read_b64 v[38:39], v38
    s_mov_b64 exec, -1
    v_cmpx_le_i32 vcc, 2.0, v68
    ds_read_b64 v[40:41], v40
    s_mov_b64 exec, -1
    s_cmp_le_u32 s15, 7
    s_cbranch_scc1 p2_g1
    v_cmpx_le_i32 vcc, 2.0, v69
    ds_read_b64 v[42:43], v42
    s_mov_b64 exec, -1
    v_cmpx_le_i32 vcc, 2.0, v70
    ds_read_b64 v[44:45], v44
    s_mov_b64 exec, -1
    v_cmpx_le_i32 vcc, 2.0, v71
    ds_read_b64 v[46:47], v46
    s_mov_b64 exec, -1
p2_g1:
    buffer_load_dwordx4 v[102:105], v102, s[4:7], 0 offen
    s_waitcnt lgkmcnt(0)
    s_barrier
    s_waitcnt vmcnt(1)
    s_mov_b32 m0, s23
    s_nop 0
    ds_write_addtid_b32 v72 offset:0
    ds_write_addtid_b32 v73 offset:256
    ds_write_addtid_b32 v74 offset:512
    ds_write_addtid_b32 v75 offset:768
    ds_write_addtid_b32 v76 offset:1024
    ds_write_addtid_b32 v77 offset:1280
    ds_write_addtid_b32 v78 offset:1536
    ds_write_addtid_b32 v79 offset:1792
    ds_write_addtid_b32 v80 offset:2048
    ds_write_addtid_b32 v81 offset:2304
    ds_write_addtid_b32 v82 offset:2560
    ds_write_addtid_b32 v83 offset:2816
    s_cmp_ge_u32 s10, 9
    s_cbranch_scc1 p2_notail2
    s_mov_b32 m0, s24
    s_nop 0
    ds_write_addtid_b32 v84 offset:49152
    ds_write_addtid_b32 v85 offset:49408
p2_notail2:
    s_add_u32 s20, s20, 53760
    s_mul_i32 s20, s68, 645120
    s_add_u32 s20, s20, s70
    s_waitcnt lgkmcnt(0)
    s_barrier
    buffer_load_dwordx4 v[72:75], v116, s[4:7], s20 offen offset:0
    v_cmpx_gt_i32 vcc, 0, v48
    ds_read_b64 v[0:1], v0
    s_mov_b64 exec, -1
    v_cmpx_gt_i32 vcc, 0, v49
    ds_read_b64 v[2:3], v2
    s_mov_b64 exec, -1
    v_cmpx_gt_i32 vcc, 0, v50
    ds_read_b64 v[4:5], v4
    s_mov_b64 exec, -1
    buffer_load_dwordx4 v[76:79], v116, s[4:7], s20 offen offset:1024
    v_cmpx_gt_i32 vcc, 0, v51
    ds_read_b64 v[6:7], v6
    s_mov_b64 exec, -1
    v_cmpx_gt_i32 vcc, 0, v52
    ds_read_b64 v[8:9], v8
    s_mov_b64 exec, -1
    v_cmpx_gt_i32 vcc, 0, v53
    ds_read_b64 v[10:11], v10
    s_mov_b64 exec, -1
    buffer_load_dwordx4 v[80:83], v116, s[4:7], s20 offen offset:2048
    v_cmpx_gt_i32 vcc, 0, v54
    ds_read_b64 v[12:13], v12
    s_mov_b64 exec, -1
    v_cmpx_gt_i32 vcc, 0, v55
    ds_read_b64 v[14:15], v14
    s_mov_b64 exec, -1
    v_cmpx_gt_i32 vcc, 0, v56
    ds_read_b64 v[16:17], v16
    s_mov_b64 exec, -1
    s_cmp_ge_u32 s10, 9
    s_cbranch_scc1 p2_nms2
    v_lshrrev_b32 v84, 1, v116
    s_add_u32 s44, s20, s42
    buffer_load_dwordx2 v[84:85], v84, s[4:7], s44 offen
p2_nms2:
    v_cmpx_gt_i32 vcc, 0, v57
    ds_read_b64 v[18:19], v18
    s_mov_b64 exec, -1
    v_cmpx_gt_i32 vcc, 0, v58
    ds_read_b64 v[20:21], v20
    s_mov_b64 exec, -1
    v_cmpx_gt_i32 vcc, 0, v59
    ds_read_b64 v[22:23], v22
    s_mov_b64 exec, -1
    v_cmpx_gt_i32 vcc, 0, v60
    ds_read_b64 v[24:25], v24
    s_mov_b64 exec, -1
    v_cmpx_gt_i32 vcc, 0, v61
    ds_read_b64 v[26:27], v26
    s_mov_b64 exec, -1
    v_cmpx_gt_i32 vcc, 0, v62
    ds_read_b64 v[28:29], v28
    s_mov_b64 exec, -1
    v_cmpx_gt_i32 vcc, 0, v63
    ds_read_b64 v[30:31], v30
    s_mov_b64 exec, -1
    v_cmpx_gt_i32 vcc, 0, v64
    ds_read_b64 v[32:33], v32
    s_mov_b64 exec, -1
    v_cmpx_gt_i32 vcc, 0, v65
    ds_read_b64 v[34:35], v34
    s_mov_b64 exec, -1
    v_cmpx_gt_i32 vcc, 0, v66
    ds_read_b64 v[36:37], v36
    s_mov_b64 exec, -1
    v_cmpx_gt_i32 vcc, 0, v67
    ds_read_b64 v[38:39], v38
    s_mov_b64 exec, -1
    v_cmpx_gt_i32 vcc, 0, v68
    ds_read_b64 v[40:41], v40
    s_mov_b64 exec, -1
    s_cmp_le_u32 s15, 7
    s_cbranch_scc1 p2_g2
    v_cmpx_gt_i32 vcc, 0, v69
    ds_read_b64 v[42:43], v42
    s_mov_b64 exec, -1
    v_cmpx_gt_i32 vcc, 0, v70
    ds_read_b64 v[44:45], v44
    s_mov_b64 exec, -1
    v_cmpx_gt_i32 vcc, 0, v71
    ds_read_b64 v[46:47], v46
    s_mov_b64 exec, -1
p2_g2:
    buffer_load_dwordx4 v[106:109], v106, s[4:7], 0 offen
    buffer_load_dwordx4 v[110:113], v110, s[4:7], 0 offen
    s_waitcnt lgkmcnt(0)
    s_barrier
    s_branch p2_add
p2_fin:
    s_waitcnt vmcnt(0) lgkmcnt(0)
    s_barrier
    s_mul_i32 s44, s11, 6406144
    s_mul_i32 s45, s12, 100096
    s_add_u32 s44, s44, s45
    s_add_u32 s44, s44, 357134336
    v_add_u32 v123, s64, v116
    v_add_u32 v122, s25, v123
    v_mov_b32 v24, 0
    v_mov_b32 v25, 0
    v_mov_b32 v26, 0
    v_mov_b32 v27, 0
    ds_read_b128 v[0:3], v122 offset:0
    ds_read_b128 v[4:7], v122 offset:16384
    ds_read_b128 v[8:11], v122 offset:32768
    v_add_u32 v122, 49152, v122
    ds_read_b128 v[12:15], v122 offset:0
    ds_read_b128 v[16:19], v122 offset:16384
    ds_read_b128 v[20:23], v122 offset:32768
    v_cmpx_gt_u32 vcc, 1792, v123
    ds_read_b128 v[24:27], v122 offset:49152
    s_mov_b64 exec, -1
    s_waitcnt lgkmcnt(0)
    s_cmp_lg_u32 s21, 0
    s_cbranch_scc1 p2_finf
    v_pk_max_u16 v117, v117, v0
    v_pk_max_u16 v117, v117, v1
    v_pk_max_u16 v117, v117, v2
    v_pk_max_u16 v117, v117, v3
    v_pk_max_u16 v117, v117, v4
    v_pk_max_u16 v117, v117, v5
    v_pk_max_u16 v117, v117, v6
    v_pk_max_u16 v117, v117, v7
    v_pk_max_u16 v117, v117, v8
    v_pk_max_u16 v117, v117, v9
    v_pk_max_u16 v117, v117, v10
    v_pk_max_u16 v117, v117, v11
    v_pk_max_u16 v117, v117, v12
    v_pk_max_u16 v117, v117, v13
    v_pk_max_u16 v117, v117, v14
    v_pk_max_u16 v117, v117, v15
    v_pk_max_u16 v117, v117, v16
    v_pk_max_u16 v117, v117, v17
    v_pk_max_u16 v117, v117, v18
    v_pk_max_u16 v117, v117, v19
    v_pk_max_u16 v117, v117, v20
    v_pk_max_u16 v117, v117, v21
    v_pk_max_u16 v117, v117, v22
    v_pk_max_u16 v117, v117, v23
    v_pk_max_u16 v117, v117, v24
    v_pk_max_u16 v117, v117, v25
    v_pk_max_u16 v117, v117, v26
    v_pk_max_u16 v117, v117, v27
    v_lshrrev_b32 v124, 16, v117
    v_and_b32 v117, 0xffff, v117
    v_max_u32 v117, v117, v124
    v_mov_b32 v124, 0
    v_cmpx_le_u32 vcc, 57344, v117
    ds_write_b32 v124, v117 offset:53768
    s_mov_b64 exec, -1
    v_mov_b32 v125, s30
    v_mul_f32 v125, 0xc6e00000, v125
    v_cvt_f32_u32_sdwa v126, v0 dst_sel:DWORD dst_unused:UNUSED_PAD src0_sel:WORD_0
    v_cvt_f32_u32_sdwa v127, v0 dst_sel:DWORD dst_unused:UNUSED_PAD src0_sel:WORD_1
    v_fma_f32 v126, v126, s30, v125
    v_fma_f32 v127, v127, s30, v125
    v_cvt_pk_bf16_f32 v0, v126, v127
    v_cvt_f32_u32_sdwa v126, v1 dst_sel:DWORD dst_unused:UNUSED_PAD src0_sel:WORD_0
    v_cvt_f32_u32_sdwa v127, v1 dst_sel:DWORD dst_unused:UNUSED_PAD src0_sel:WORD_1
    v_fma_f32 v126, v126, s30, v125
    v_fma_f32 v127, v127, s30, v125
    v_cvt_pk_bf16_f32 v1, v126, v127
    v_cvt_f32_u32_sdwa v126, v2 dst_sel:DWORD dst_unused:UNUSED_PAD src0_sel:WORD_0
    v_cvt_f32_u32_sdwa v127, v2 dst_sel:DWORD dst_unused:UNUSED_PAD src0_sel:WORD_1
    v_fma_f32 v126, v126, s30, v125
    v_fma_f32 v127, v127, s30, v125
    v_cvt_pk_bf16_f32 v2, v126, v127
    v_cvt_f32_u32_sdwa v126, v3 dst_sel:DWORD dst_unused:UNUSED_PAD src0_sel:WORD_0
    v_cvt_f32_u32_sdwa v127, v3 dst_sel:DWORD dst_unused:UNUSED_PAD src0_sel:WORD_1
    v_fma_f32 v126, v126, s30, v125
    v_fma_f32 v127, v127, s30, v125
    v_cvt_pk_bf16_f32 v3, v126, v127
    v_cvt_f32_u32_sdwa v126, v4 dst_sel:DWORD dst_unused:UNUSED_PAD src0_sel:WORD_0
    v_cvt_f32_u32_sdwa v127, v4 dst_sel:DWORD dst_unused:UNUSED_PAD src0_sel:WORD_1
    v_fma_f32 v126, v126, s30, v125
    v_fma_f32 v127, v127, s30, v125
    v_cvt_pk_bf16_f32 v4, v126, v127
    v_cvt_f32_u32_sdwa v126, v5 dst_sel:DWORD dst_unused:UNUSED_PAD src0_sel:WORD_0
    v_cvt_f32_u32_sdwa v127, v5 dst_sel:DWORD dst_unused:UNUSED_PAD src0_sel:WORD_1
    v_fma_f32 v126, v126, s30, v125
    v_fma_f32 v127, v127, s30, v125
    v_cvt_pk_bf16_f32 v5, v126, v127
    v_cvt_f32_u32_sdwa v126, v6 dst_sel:DWORD dst_unused:UNUSED_PAD src0_sel:WORD_0
    v_cvt_f32_u32_sdwa v127, v6 dst_sel:DWORD dst_unused:UNUSED_PAD src0_sel:WORD_1
    v_fma_f32 v126, v126, s30, v125
    v_fma_f32 v127, v127, s30, v125
    v_cvt_pk_bf16_f32 v6, v126, v127
    v_cvt_f32_u32_sdwa v126, v7 dst_sel:DWORD dst_unused:UNUSED_PAD src0_sel:WORD_0
    v_cvt_f32_u32_sdwa v127, v7 dst_sel:DWORD dst_unused:UNUSED_PAD src0_sel:WORD_1
    v_fma_f32 v126, v126, s30, v125
    v_fma_f32 v127, v127, s30, v125
    v_cvt_pk_bf16_f32 v7, v126, v127
    v_cvt_f32_u32_sdwa v126, v8 dst_sel:DWORD dst_unused:UNUSED_PAD src0_sel:WORD_0
    v_cvt_f32_u32_sdwa v127, v8 dst_sel:DWORD dst_unused:UNUSED_PAD src0_sel:WORD_1
    v_fma_f32 v126, v126, s30, v125
    v_fma_f32 v127, v127, s30, v125
    v_cvt_pk_bf16_f32 v8, v126, v127
    v_cvt_f32_u32_sdwa v126, v9 dst_sel:DWORD dst_unused:UNUSED_PAD src0_sel:WORD_0
    v_cvt_f32_u32_sdwa v127, v9 dst_sel:DWORD dst_unused:UNUSED_PAD src0_sel:WORD_1
    v_fma_f32 v126, v126, s30, v125
    v_fma_f32 v127, v127, s30, v125
    v_cvt_pk_bf16_f32 v9, v126, v127
    v_cvt_f32_u32_sdwa v126, v10 dst_sel:DWORD dst_unused:UNUSED_PAD src0_sel:WORD_0
    v_cvt_f32_u32_sdwa v127, v10 dst_sel:DWORD dst_unused:UNUSED_PAD src0_sel:WORD_1
    v_fma_f32 v126, v126, s30, v125
    v_fma_f32 v127, v127, s30, v125
    v_cvt_pk_bf16_f32 v10, v126, v127
    v_cvt_f32_u32_sdwa v126, v11 dst_sel:DWORD dst_unused:UNUSED_PAD src0_sel:WORD_0
    v_cvt_f32_u32_sdwa v127, v11 dst_sel:DWORD dst_unused:UNUSED_PAD src0_sel:WORD_1
    v_fma_f32 v126, v126, s30, v125
    v_fma_f32 v127, v127, s30, v125
    v_cvt_pk_bf16_f32 v11, v126, v127
    v_cvt_f32_u32_sdwa v126, v12 dst_sel:DWORD dst_unused:UNUSED_PAD src0_sel:WORD_0
    v_cvt_f32_u32_sdwa v127, v12 dst_sel:DWORD dst_unused:UNUSED_PAD src0_sel:WORD_1
    v_fma_f32 v126, v126, s30, v125
    v_fma_f32 v127, v127, s30, v125
    v_cvt_pk_bf16_f32 v12, v126, v127
    v_cvt_f32_u32_sdwa v126, v13 dst_sel:DWORD dst_unused:UNUSED_PAD src0_sel:WORD_0
    v_cvt_f32_u32_sdwa v127, v13 dst_sel:DWORD dst_unused:UNUSED_PAD src0_sel:WORD_1
    v_fma_f32 v126, v126, s30, v125
    v_fma_f32 v127, v127, s30, v125
    v_cvt_pk_bf16_f32 v13, v126, v127
    v_cvt_f32_u32_sdwa v126, v14 dst_sel:DWORD dst_unused:UNUSED_PAD src0_sel:WORD_0
    v_cvt_f32_u32_sdwa v127, v14 dst_sel:DWORD dst_unused:UNUSED_PAD src0_sel:WORD_1
    v_fma_f32 v126, v126, s30, v125
    v_fma_f32 v127, v127, s30, v125
    v_cvt_pk_bf16_f32 v14, v126, v127
    v_cvt_f32_u32_sdwa v126, v15 dst_sel:DWORD dst_unused:UNUSED_PAD src0_sel:WORD_0
    v_cvt_f32_u32_sdwa v127, v15 dst_sel:DWORD dst_unused:UNUSED_PAD src0_sel:WORD_1
    v_fma_f32 v126, v126, s30, v125
    v_fma_f32 v127, v127, s30, v125
    v_cvt_pk_bf16_f32 v15, v126, v127
    v_cvt_f32_u32_sdwa v126, v16 dst_sel:DWORD dst_unused:UNUSED_PAD src0_sel:WORD_0
    v_cvt_f32_u32_sdwa v127, v16 dst_sel:DWORD dst_unused:UNUSED_PAD src0_sel:WORD_1
    v_fma_f32 v126, v126, s30, v125
    v_fma_f32 v127, v127, s30, v125
    v_cvt_pk_bf16_f32 v16, v126, v127
    v_cvt_f32_u32_sdwa v126, v17 dst_sel:DWORD dst_unused:UNUSED_PAD src0_sel:WORD_0
    v_cvt_f32_u32_sdwa v127, v17 dst_sel:DWORD dst_unused:UNUSED_PAD src0_sel:WORD_1
    v_fma_f32 v126, v126, s30, v125
    v_fma_f32 v127, v127, s30, v125
    v_cvt_pk_bf16_f32 v17, v126, v127
    v_cvt_f32_u32_sdwa v126, v18 dst_sel:DWORD dst_unused:UNUSED_PAD src0_sel:WORD_0
    v_cvt_f32_u32_sdwa v127, v18 dst_sel:DWORD dst_unused:UNUSED_PAD src0_sel:WORD_1
    v_fma_f32 v126, v126, s30, v125
    v_fma_f32 v127, v127, s30, v125
    v_cvt_pk_bf16_f32 v18, v126, v127
    v_cvt_f32_u32_sdwa v126, v19 dst_sel:DWORD dst_unused:UNUSED_PAD src0_sel:WORD_0
    v_cvt_f32_u32_sdwa v127, v19 dst_sel:DWORD dst_unused:UNUSED_PAD src0_sel:WORD_1
    v_fma_f32 v126, v126, s30, v125
    v_fma_f32 v127, v127, s30, v125
    v_cvt_pk_bf16_f32 v19, v126, v127
    v_cvt_f32_u32_sdwa v126, v20 dst_sel:DWORD dst_unused:UNUSED_PAD src0_sel:WORD_0
    v_cvt_f32_u32_sdwa v127, v20 dst_sel:DWORD dst_unused:UNUSED_PAD src0_sel:WORD_1
    v_fma_f32 v126, v126, s30, v125
    v_fma_f32 v127, v127, s30, v125
    v_cvt_pk_bf16_f32 v20, v126, v127
    v_cvt_f32_u32_sdwa v126, v21 dst_sel:DWORD dst_unused:UNUSED_PAD src0_sel:WORD_0
    v_cvt_f32_u32_sdwa v127, v21 dst_sel:DWORD dst_unused:UNUSED_PAD src0_sel:WORD_1
    v_fma_f32 v126, v126, s30, v125
    v_fma_f32 v127, v127, s30, v125
    v_cvt_pk_bf16_f32 v21, v126, v127
    v_cvt_f32_u32_sdwa v126, v22 dst_sel:DWORD dst_unused:UNUSED_PAD src0_sel:WORD_0
    v_cvt_f32_u32_sdwa v127, v22 dst_sel:DWORD dst_unused:UNUSED_PAD src0_sel:WORD_1
    v_fma_f32 v126, v126, s30, v125
    v_fma_f32 v127, v127, s30, v125
    v_cvt_pk_bf16_f32 v22, v126, v127
    v_cvt_f32_u32_sdwa v126, v23 dst_sel:DWORD dst_unused:UNUSED_PAD src0_sel:WORD_0
    v_cvt_f32_u32_sdwa v127, v23 dst_sel:DWORD dst_unused:UNUSED_PAD src0_sel:WORD_1
    v_fma_f32 v126, v126, s30, v125
    v_fma_f32 v127, v127, s30, v125
    v_cvt_pk_bf16_f32 v23, v126, v127
    v_cvt_f32_u32_sdwa v126, v24 dst_sel:DWORD dst_unused:UNUSED_PAD src0_sel:WORD_0
    v_cvt_f32_u32_sdwa v127, v24 dst_sel:DWORD dst_unused:UNUSED_PAD src0_sel:WORD_1
    v_fma_f32 v126, v126, s30, v125
    v_fma_f32 v127, v127, s30, v125
    v_cvt_pk_bf16_f32 v24, v126, v127
    v_cvt_f32_u32_sdwa v126, v25 dst_sel:DWORD dst_unused:UNUSED_PAD src0_sel:WORD_0
    v_cvt_f32_u32_sdwa v127, v25 dst_sel:DWORD dst_unused:UNUSED_PAD src0_sel:WORD_1
    v_fma_f32 v126, v126, s30, v125
    v_fma_f32 v127, v127, s30, v125
    v_cvt_pk_bf16_f32 v25, v126, v127
    v_cvt_f32_u32_sdwa v126, v26 dst_sel:DWORD dst_unused:UNUSED_PAD src0_sel:WORD_0
    v_cvt_f32_u32_sdwa v127, v26 dst_sel:DWORD dst_unused:UNUSED_PAD src0_sel:WORD_1
    v_fma_f32 v126, v126, s30, v125
    v_fma_f32 v127, v127, s30, v125
    v_cvt_pk_bf16_f32 v26, v126, v127
    v_cvt_f32_u32_sdwa v126, v27 dst_sel:DWORD dst_unused:UNUSED_PAD src0_sel:WORD_0
    v_cvt_f32_u32_sdwa v127, v27 dst_sel:DWORD dst_unused:UNUSED_PAD src0_sel:WORD_1
    v_fma_f32 v126, v126, s30, v125
    v_fma_f32 v127, v127, s30, v125
    v_cvt_pk_bf16_f32 v27, v126, v127
    s_waitcnt lgkmcnt(0)
    s_barrier
    ds_read_b32 v125, v124 offset:53768
    s_waitcnt lgkmcnt(0)
    v_readfirstlane_b32 s45, v125
    s_nop 0
    s_cmp_lg_u32 s45, 0
    s_cselect_b32 s21, 1, 0
    s_cbranch_scc1 p2_restart
    buffer_store_dwordx4 v[0:3], v123, s[4:7], s44 offen
    s_add_u32 s44, s44, 16384
    buffer_store_dwordx4 v[4:7], v123, s[4:7], s44 offen
    s_add_u32 s44, s44, 16384
    buffer_store_dwordx4 v[8:11], v123, s[4:7], s44 offen
    s_add_u32 s44, s44, 16384
    buffer_store_dwordx4 v[12:15], v123, s[4:7], s44 offen
    s_add_u32 s44, s44, 16384
    buffer_store_dwordx4 v[16:19], v123, s[4:7], s44 offen
    s_add_u32 s44, s44, 16384
    buffer_store_dwordx4 v[20:23], v123, s[4:7], s44 offen
    s_add_u32 s44, s44, 16384
    v_cmp_gt_u32 vcc, 1792, v123
    s_and_saveexec_b64 s[46:47], vcc
    s_cbranch_execz p2_end
    buffer_store_dwordx4 v[24:27], v123, s[4:7], s44 offen
    s_add_u32 s44, s44, 16384
    s_endpgm
p2_finf:
    s_lshl_b32 s45, s21, 2
    s_add_u32 s44, s44, s45
    s_sub_u32 s44, s44, 4
    v_cvt_pk_bf16_f32 v0, v0, v1
    v_cvt_pk_bf16_f32 v2, v2, v3
    v_cvt_pk_bf16_f32 v4, v4, v5
    v_cvt_pk_bf16_f32 v6, v6, v7
    v_cvt_pk_bf16_f32 v8, v8, v9
    v_cvt_pk_bf16_f32 v10, v10, v11
    v_cvt_pk_bf16_f32 v12, v12, v13
    v_cvt_pk_bf16_f32 v14, v14, v15
    v_cvt_pk_bf16_f32 v16, v16, v17
    v_cvt_pk_bf16_f32 v18, v18, v19
    v_cvt_pk_bf16_f32 v20, v20, v21
    v_cvt_pk_bf16_f32 v22, v22, v23
    v_cvt_pk_bf16_f32 v24, v24, v25
    v_cvt_pk_bf16_f32 v26, v26, v27
    buffer_store_dword v0, v123, s[4:7], s44 offen
    buffer_store_dword v2, v123, s[4:7], s44 offen offset:8
    s_add_u32 s44, s44, 16384
    buffer_store_dword v4, v123, s[4:7], s44 offen
    buffer_store_dword v6, v123, s[4:7], s44 offen offset:8
    s_add_u32 s44, s44, 16384
    buffer_store_dword v8, v123, s[4:7], s44 offen
    buffer_store_dword v10, v123, s[4:7], s44 offen offset:8
    s_add_u32 s44, s44, 16384
    buffer_store_dword v12, v123, s[4:7], s44 offen
    buffer_store_dword v14, v123, s[4:7], s44 offen offset:8
    s_add_u32 s44, s44, 16384
    buffer_store_dword v16, v123, s[4:7], s44 offen
    buffer_store_dword v18, v123, s[4:7], s44 offen offset:8
    s_add_u32 s44, s44, 16384
    buffer_store_dword v20, v123, s[4:7], s44 offen
    buffer_store_dword v22, v123, s[4:7], s44 offen offset:8
    s_add_u32 s44, s44, 16384
    v_cmp_gt_u32 vcc, 1792, v123
    s_and_saveexec_b64 s[46:47], vcc
    s_cbranch_execz p2_finf2
    buffer_store_dword v24, v123, s[4:7], s44 offen
    buffer_store_dword v26, v123, s[4:7], s44 offen offset:8
    s_add_u32 s44, s44, 16384
p2_finf2:
    s_mov_b64 exec, -1
    s_add_u32 s21, s21, 1
    s_waitcnt vmcnt(0)
    s_cmp_eq_u32 s21, 2
    s_cbranch_scc1 p2_restart
p2_end:
    s_endpgm
.globl p3_kernel
.p2align 8
.type p3_kernel,@function
p3_kernel:
    s_cmp_ge_u32 s2, 3125
    s_cbranch_scc1 p3_end
    s_load_dwordx2 s[4:5], s[0:1], 0
    s_load_dwordx2 s[6:7], s[0:1], 24
    s_load_dwordx2 s[8:9], s[0:1], 40
    s_load_dwordx8 s[12:19], s[0:1], 56
    s_load_dwordx2 s[10:11], s[0:1], 88
    s_load_dwordx2 s[20:21], s[0:1], 104
    s_lshl_b32 s3, s2, 8
    v_add_u32 v0, s3, v0
    v_lshlrev_b32 v2, 3, v0
    v_lshlrev_b32 v3, 1, v0
    s_waitcnt lgkmcnt(0)
    s_load_dwordx4 s[40:43], s[8:9], 0
    s_load_dwordx16 s[44:59], s[12:13], 0
    s_load_dwordx16 s[60:75], s[14:15], 0
    s_load_dwordx8 s[76:83], s[16:17], 0
    s_load_dwordx8 s[84:91], s[18:19], 0
    s_mov_b32 s24, s4
    s_and_b32 s25, s5, 0xffff
    s_mov_b32 s26, 6400000
    s_mov_b32 s27, 0x20000
    s_mov_b32 s28, s6
    s_and_b32 s29, s7, 0xffff
    s_mov_b32 s30, 1600000
    s_mov_b32 s31, 0x20000
    s_mov_b32 s32, s10
    s_and_b32 s33, s11, 0xffff
    s_mov_b32 s34, 6400000
    s_mov_b32 s35, 0x20000
    s_mov_b32 s36, s20
    s_and_b32 s37, s21, 0xffff
    s_mov_b32 s38, 819200000
    s_mov_b32 s39, 0x20000
    buffer_load_ushort v14, v3, s[28:31], 0 offen
    s_mov_b32 s22, 357134336
    buffer_load_dwordx2 v[32:33], v2, s[36:39], s22 offen
    s_mov_b32 s22, 363540480
    buffer_load_dwordx2 v[34:35], v2, s[36:39], s22 offen
    s_mov_b32 s22, 369946624
    buffer_load_dwordx2 v[36:37], v2, s[36:39], s22 offen
    s_mov_b32 s22, 376352768
    buffer_load_dwordx2 v[38:39], v2, s[36:39], s22 offen
    buffer_load_dwordx2 v[12:13], v2, s[24:27], 0 offen
    s_mov_b32 s92, 0xffff0000
    s_waitcnt vmcnt(5) lgkmcnt(0)
    v_lshlrev_b32 v14, 16, v14
    s_lshl_b32 s94, s40, 16
    v_subrev_f32 v16, s94, v14
    s_and_b32 s95, s40, s92
    v_subrev_f32 v17, s95, v14
    s_lshl_b32 s96, s41, 16
    v_subrev_f32 v18, s96, v14
    s_and_b32 s93, s41, s92
    v_subrev_f32 v19, s93, v14
    s_lshl_b32 s94, s42, 16
    v_subrev_f32 v20, s94, v14
    s_and_b32 s95, s42, s92
    v_subrev_f32 v21, s95, v14
    s_lshl_b32 s96, s43, 16
    v_subrev_f32 v22, s96, v14
    s_and_b32 s93, s43, s92
    v_subrev_f32 v23, s93, v14
    v_cvt_pk_bf16_f32 v16, v16, v17
    v_cvt_pk_bf16_f32 v18, v18, v19
    v_cvt_pk_bf16_f32 v20, v20, v21
    v_cvt_pk_bf16_f32 v22, v22, v23
    v_and_b32 v17, s92, v16
    v_lshlrev_b32 v16, 16, v16
    v_and_b32 v19, s92, v18
    v_lshlrev_b32 v18, 16, v18
    v_and_b32 v21, s92, v20
    v_lshlrev_b32 v20, 16, v20
    v_and_b32 v23, s92, v22
    v_lshlrev_b32 v22, 16, v22
    v_mul_f32 v16, v16, v16
    v_mul_f32 v17, v17, v17
    v_mul_f32 v18, v18, v18
    v_mul_f32 v19, v19, v19
    v_mul_f32 v20, v20, v20
    v_mul_f32 v21, v21, v21
    v_mul_f32 v22, v22, v22
    v_mul_f32 v23, v23, v23
    v_cvt_pk_bf16_f32 v16, v16, v17
    v_cvt_pk_bf16_f32 v18, v18, v19
    v_cvt_pk_bf16_f32 v20, v20, v21
    v_cvt_pk_bf16_f32 v22, v22, v23
    v_and_b32 v17, s92, v16
    v_lshlrev_b32 v16, 16, v16
    v_and_b32 v19, s92, v18
    v_lshlrev_b32 v18, 16, v18
    v_and_b32 v21, s92, v20
    v_lshlrev_b32 v20, 16, v20
    v_and_b32 v23, s92, v22
    v_lshlrev_b32 v22, 16, v22
    v_mul_f32 v16, 0xc1200000, v16
    v_mul_f32 v17, 0xc1200000, v17
    v_mul_f32 v18, 0xc1200000, v18
    v_mul_f32 v19, 0xc1200000, v19
    v_mul_f32 v20, 0xc1200000, v20
    v_mul_f32 v21, 0xc1200000, v21
    v_mul_f32 v22, 0xc1200000, v22
    v_mul_f32 v23, 0xc1200000, v23
    v_cvt_pk_bf16_f32 v16, v16, v17
    v_cvt_pk_bf16_f32 v18, v18, v19
    v_cvt_pk_bf16_f32 v20, v20, v21
    v_cvt_pk_bf16_f32 v22, v22, v23
    v_and_b32 v17, s92, v16
    v_lshlrev_b32 v16, 16, v16
    v_and_b32 v19, s92, v18
    v_lshlrev_b32 v18, 16, v18
    v_and_b32 v21, s92, v20
    v_lshlrev_b32 v20, 16, v20
    v_and_b32 v23, s92, v22
    v_lshlrev_b32 v22, 16, v22
    v_mul_f32 v16, 0x3fb8aa3b, v16
    v_mul_f32 v17, 0x3fb8aa3b, v17
    v_mul_f32 v18, 0x3fb8aa3b, v18
    v_mul_f32 v19, 0x3fb8aa3b, v19
    v_mul_f32 v20, 0x3fb8aa3b, v20
    v_mul_f32 v21, 0x3fb8aa3b, v21
    v_mul_f32 v22, 0x3fb8aa3b, v22
    v_mul_f32 v23, 0x3fb8aa3b, v23
    v_exp_f32 v16, v16
    v_exp_f32 v17, v17
    v_exp_f32 v18, v18
    v_exp_f32 v19, v19
    v_exp_f32 v20, v20
    v_exp_f32 v21, v21
    v_exp_f32 v22, v22
    v_exp_f32 v23, v23
    s_nop 0
    v_cvt_pk_bf16_f32 v16, v16, v17
    v_cvt_pk_bf16_f32 v18, v18, v19
    v_cvt_pk_bf16_f32 v20, v20, v21
    v_cvt_pk_bf16_f32 v22, v22, v23
    v_and_b32 v17, s92, v16
    v_lshlrev_b32 v16, 16, v16
    v_and_b32 v19, s92, v18
    v_lshlrev_b32 v18, 16, v18
    v_and_b32 v21, s92, v20
    v_lshlrev_b32 v20, 16, v20
    v_and_b32 v23, s92, v22
    v_lshlrev_b32 v22, 16, v22
    s_lshl_b32 s94, s60, 16
    v_mul_f32 v24, s94, v16
    s_and_b32 s95, s60, s92
    v_mul_f32 v25, s95, v16
    s_lshl_b32 s96, s61, 16
    v_mul_f32 v26, s96, v16
    s_and_b32 s93, s61, s92
    v_mul_f32 v27, s93, v16
    s_lshl_b32 s94, s62, 16
    v_fmac_f32 v24, s94, v17
    s_and_b32 s95, s62, s92
    v_fmac_f32 v25, s95, v17
    s_lshl_b32 s96, s63, 16
    v_fmac_f32 v26, s96, v17
    s_and_b32 s93, s63, s92
    v_fmac_f32 v27, s93, v17
    s_lshl_b32 s94, s64, 16
    v_fmac_f32 v24, s94, v18
    s_and_b32 s95, s64, s92
    v_fmac_f32 v25, s95, v18
    s_lshl_b32 s96, s65, 16
    v_fmac_f32 v26, s96, v18
    s_and_b32 s93, s65, s92
    v_fmac_f32 v27, s93, v18
    s_lshl_b32 s94, s66, 16
    v_fmac_f32 v24, s94, v19
    s_and_b32 s95, s66, s92
    v_fmac_f32 v25, s95, v19
    s_lshl_b32 s96, s67, 16
    v_fmac_f32 v26, s96, v19
    s_and_b32 s93, s67, s92
    v_fmac_f32 v27, s93, v19
    s_lshl_b32 s94, s68, 16
    v_fmac_f32 v24, s94, v20
    s_and_b32 s95, s68, s92
    v_fmac_f32 v25, s95, v20
    s_lshl_b32 s96, s69, 16
    v_fmac_f32 v26, s96, v20
    s_and_b32 s93, s69, s92
    v_fmac_f32 v27, s93, v20
    s_lshl_b32 s94, s70, 16
    v_fmac_f32 v24, s94, v21
    s_and_b32 s95, s70, s92
    v_fmac_f32 v25, s95, v21
    s_lshl_b32 s96, s71, 16
    v_fmac_f32 v26, s96, v21
    s_and_b32 s93, s71, s92
    v_fmac_f32 v27, s93, v21
    s_lshl_b32 s94, s72, 16
    v_fmac_f32 v24, s94, v22
    s_and_b32 s95, s72, s92
    v_fmac_f32 v25, s95, v22
    s_lshl_b32 s96, s73, 16
    v_fmac_f32 v26, s96, v22
    s_and_b32 s93, s73, s92
    v_fmac_f32 v27, s93, v22
    s_lshl_b32 s94, s74, 16
    v_fmac_f32 v24, s94, v23
    s_and_b32 s95, s74, s92
    v_fmac_f32 v25, s95, v23
    s_lshl_b32 s96, s75, 16
    v_fmac_f32 v26, s96, v23
    s_and_b32 s93, s75, s92
    v_fmac_f32 v27, s93, v23
    s_lshl_b32 s94, s44, 16
    v_mul_f32 v28, s94, v16
    s_and_b32 s95, s44, s92
    v_mul_f32 v29, s95, v16
    s_lshl_b32 s96, s45, 16
    v_mul_f32 v30, s96, v16
    s_and_b32 s93, s45, s92
    v_mul_f32 v31, s93, v16
    s_lshl_b32 s94, s46, 16
    v_fmac_f32 v28, s94, v17
    s_and_b32 s95, s46, s92
    v_fmac_f32 v29, s95, v17
    s_lshl_b32 s96, s47, 16
    v_fmac_f32 v30, s96, v17
    s_and_b32 s93, s47, s92
    v_fmac_f32 v31, s93, v17
    s_lshl_b32 s94, s48, 16
    v_fmac_f32 v28, s94, v18
    s_and_b32 s95, s48, s92
    v_fmac_f32 v29, s95, v18
    s_lshl_b32 s96, s49, 16
    v_fmac_f32 v30, s96, v18
    s_and_b32 s93, s49, s92
    v_fmac_f32 v31, s93, v18
    s_lshl_b32 s94, s50, 16
    v_fmac_f32 v28, s94, v19
    s_and_b32 s95, s50, s92
    v_fmac_f32 v29, s95, v19
    s_lshl_b32 s96, s51, 16
    v_fmac_f32 v30, s96, v19
    s_and_b32 s93, s51, s92
    v_fmac_f32 v31, s93, v19
    s_lshl_b32 s94, s52, 16
    v_fmac_f32 v28, s94, v20
    s_and_b32 s95, s52, s92
    v_fmac_f32 v29, s95, v20
    s_lshl_b32 s96, s53, 16
    v_fmac_f32 v30, s96, v20
    s_and_b32 s93, s53, s92
    v_fmac_f32 v31, s93, v20
    s_lshl_b32 s94, s54, 16
    v_fmac_f32 v28, s94, v21
    s_and_b32 s95, s54, s92
    v_fmac_f32 v29, s95, v21
    s_lshl_b32 s96, s55, 16
    v_fmac_f32 v30, s96, v21
    s_and_b32 s93, s55, s92
    v_fmac_f32 v31, s93, v21
    s_lshl_b32 s94, s56, 16
    v_fmac_f32 v28, s94, v22
    s_and_b32 s95, s56, s92
    v_fmac_f32 v29, s95, v22
    s_lshl_b32 s96, s57, 16
    v_fmac_f32 v30, s96, v22
    s_and_b32 s93, s57, s92
    v_fmac_f32 v31, s93, v22
    s_lshl_b32 s94, s58, 16
    v_fmac_f32 v28, s94, v23
    s_and_b32 s95, s58, s92
    v_fmac_f32 v29, s95, v23
    s_lshl_b32 s96, s59, 16
    v_fmac_f32 v30, s96, v23
    s_and_b32 s93, s59, s92
    v_fmac_f32 v31, s93, v23
    v_cvt_pk_bf16_f32 v28, v28, v29
    v_cvt_pk_bf16_f32 v30, v30, v31
    v_and_b32 v29, s92, v28
    v_lshlrev_b32 v28, 16, v28
    v_and_b32 v31, s92, v30
    v_lshlrev_b32 v30, 16, v30
    s_waitcnt vmcnt(0)
    v_lshlrev_b32 v4, 16, v32
    v_and_b32 v5, s92, v32
    v_lshlrev_b32 v6, 16, v33
    v_and_b32 v7, s92, v33
    v_lshlrev_b32 v8, 16, v34
    v_and_b32 v9, s92, v34
    v_lshlrev_b32 v10, 16, v35
    v_and_b32 v11, s92, v35
    v_add_f32 v4, v4, v8
    v_add_f32 v5, v5, v9
    v_add_f32 v6, v6, v10
    v_add_f32 v7, v7, v11
    v_lshlrev_b32 v8, 16, v36
    v_and_b32 v9, s92, v36
    v_lshlrev_b32 v10, 16, v37
    v_and_b32 v11, s92, v37
    v_add_f32 v4, v4, v8
    v_add_f32 v5, v5, v9
    v_add_f32 v6, v6, v10
    v_add_f32 v7, v7, v11
    v_lshlrev_b32 v8, 16, v38
    v_and_b32 v9, s92, v38
    v_lshlrev_b32 v10, 16, v39
    v_and_b32 v11, s92, v39
    v_add_f32 v4, v4, v8
    v_add_f32 v5, v5, v9
    v_add_f32 v6, v6, v10
    v_add_f32 v7, v7, v11
    s_lshl_b32 s94, s76, 16
    v_mul_f32 v8, s94, v4
    s_and_b32 s95, s76, s92
    v_mul_f32 v9, s95, v4
    s_lshl_b32 s96, s77, 16
    v_mul_f32 v10, s96, v4
    s_and_b32 s93, s77, s92
    v_mul_f32 v11, s93, v4
    s_lshl_b32 s94, s78, 16
    v_fmac_f32 v8, s94, v5
    s_and_b32 s95, s78, s92
    v_fmac_f32 v9, s95, v5
    s_lshl_b32 s96, s79, 16
    v_fmac_f32 v10, s96, v5
    s_and_b32 s93, s79, s92
    v_fmac_f32 v11, s93, v5
    s_lshl_b32 s94, s80, 16
    v_fmac_f32 v8, s94, v6
    s_and_b32 s95, s80, s92
    v_fmac_f32 v9, s95, v6
    s_lshl_b32 s96, s81, 16
    v_fmac_f32 v10, s96, v6
    s_and_b32 s93, s81, s92
    v_fmac_f32 v11, s93, v6
    s_lshl_b32 s94, s82, 16
    v_fmac_f32 v8, s94, v7
    s_and_b32 s95, s82, s92
    v_fmac_f32 v9, s95, v7
    s_lshl_b32 s96, s83, 16
    v_fmac_f32 v10, s96, v7
    s_and_b32 s93, s83, s92
    v_fmac_f32 v11, s93, v7
    v_mul_f32 v24, v24, v8
    v_mul_f32 v25, v25, v9
    v_mul_f32 v26, v26, v10
    v_mul_f32 v27, v27, v11
    v_cvt_pk_bf16_f32 v24, v24, v25
    v_cvt_pk_bf16_f32 v26, v26, v27
    v_and_b32 v25, s92, v24
    v_lshlrev_b32 v24, 16, v24
    v_and_b32 v27, s92, v26
    v_lshlrev_b32 v26, 16, v26
    s_lshl_b32 s94, s84, 16
    v_mul_f32 v8, s94, v24
    s_and_b32 s95, s84, s92
    v_mul_f32 v9, s95, v24
    s_lshl_b32 s96, s85, 16
    v_mul_f32 v10, s96, v24
    s_and_b32 s93, s85, s92
    v_mul_f32 v11, s93, v24
    s_lshl_b32 s94, s86, 16
    v_fmac_f32 v8, s94, v25
    s_and_b32 s95, s86, s92
    v_fmac_f32 v9, s95, v25
    s_lshl_b32 s96, s87, 16
    v_fmac_f32 v10, s96, v25
    s_and_b32 s93, s87, s92
    v_fmac_f32 v11, s93, v25
    s_lshl_b32 s94, s88, 16
    v_fmac_f32 v8, s94, v26
    s_and_b32 s95, s88, s92
    v_fmac_f32 v9, s95, v26
    s_lshl_b32 s96, s89, 16
    v_fmac_f32 v10, s96, v26
    s_and_b32 s93, s89, s92
    v_fmac_f32 v11, s93, v26
    s_lshl_b32 s94, s90, 16
    v_fmac_f32 v8, s94, v27
    s_and_b32 s95, s90, s92
    v_fmac_f32 v9, s95, v27
    s_lshl_b32 s96, s91, 16
    v_fmac_f32 v10, s96, v27
    s_and_b32 s93, s91, s92
    v_fmac_f32 v11, s93, v27
    v_cvt_pk_bf16_f32 v8, v8, v9
    v_cvt_pk_bf16_f32 v10, v10, v11
    v_and_b32 v9, s92, v8
    v_lshlrev_b32 v8, 16, v8
    v_and_b32 v11, s92, v10
    v_lshlrev_b32 v10, 16, v10
    v_mul_f32 v8, v8, v28
    v_mul_f32 v9, v9, v29
    v_mul_f32 v10, v10, v30
    v_mul_f32 v11, v11, v31
    v_cvt_pk_bf16_f32 v8, v8, v9
    v_cvt_pk_bf16_f32 v10, v10, v11
    v_and_b32 v9, s92, v8
    v_lshlrev_b32 v8, 16, v8
    v_and_b32 v11, s92, v10
    v_lshlrev_b32 v10, 16, v10
    v_lshlrev_b32 v4, 16, v12
    v_and_b32 v5, s92, v12
    v_lshlrev_b32 v6, 16, v13
    v_and_b32 v7, s92, v13
    v_add_f32 v4, v4, v8
    v_add_f32 v5, v5, v9
    v_add_f32 v6, v6, v10
    v_add_f32 v7, v7, v11
    v_cvt_pk_bf16_f32 v4, v4, v5
    v_cvt_pk_bf16_f32 v5, v6, v7
    buffer_store_dwordx2 v[4:5], v2, s[32:35], 0 offen
p3_end:
    s_endpgm
.section .rodata,"a"
.p2align 6
.amdhsa_kernel p1_kernel
  .amdhsa_next_free_vgpr 128
  .amdhsa_next_free_sgpr 72
  .amdhsa_accum_offset 128
  .amdhsa_group_segment_fixed_size 0
  .amdhsa_kernarg_size 112
  .amdhsa_user_sgpr_count 2
  .amdhsa_user_sgpr_kernarg_segment_ptr 1
  .amdhsa_system_sgpr_workgroup_id_x 1
  .amdhsa_float_denorm_mode_32 3
.end_amdhsa_kernel
.p2align 6
.amdhsa_kernel p2_kernel
  .amdhsa_next_free_vgpr 128
  .amdhsa_next_free_sgpr 72
  .amdhsa_accum_offset 128
  .amdhsa_group_segment_fixed_size 0
  .amdhsa_kernarg_size 112
  .amdhsa_user_sgpr_count 2
  .amdhsa_user_sgpr_kernarg_segment_ptr 1
  .amdhsa_system_sgpr_workgroup_id_x 1
  .amdhsa_float_denorm_mode_32 3
.end_amdhsa_kernel
.p2align 6
.amdhsa_kernel p3_kernel
  .amdhsa_next_free_vgpr 40
  .amdhsa_next_free_sgpr 100
  .amdhsa_accum_offset 40
  .amdhsa_group_segment_fixed_size 0
  .amdhsa_kernarg_size 112
  .amdhsa_user_sgpr_count 2
  .amdhsa_user_sgpr_kernarg_segment_ptr 1
  .amdhsa_system_sgpr_workgroup_id_x 1
  .amdhsa_float_denorm_mode_32 3
.end_amdhsa_kernel
```

```asm
; @launch kernel=p1_kernel grid=(256,1,1) block=(1024,1,1) lds=161280
; @launch kernel=p2_kernel grid=(256,1,1) block=(1024,1,1) lds=154368
; @launch kernel=p3_kernel grid=(3125,1,1) block=(256,1,1) lds=0
.amdgcn_target "amdgcn-amd-amdhsa--gfx950"
.text
.globl p1_kernel
.p2align 8
.type p1_kernel,@function
p1_kernel:
    s_cmp_ge_u32 s2, 256
    s_cbranch_scc1 p1_end
    s_load_dwordx2 s[52:53], s[0:1], 0
    s_load_dwordx4 s[56:59], s[0:1], 8
    s_load_dwordx2 s[54:55], s[0:1], 32
    s_load_dwordx2 s[60:61], s[0:1], 48
    s_load_dwordx2 s[48:49], s[0:1], 104
    v_lshlrev_b32 v1, 4, v0
    v_lshlrev_b32 v2, 3, v0
    v_mov_b32 v3, 1
    v_lshrrev_b32 v117, 6, v0
    s_nop 0
    v_readfirstlane_b32 s28, v117
    s_waitcnt lgkmcnt(0)
    s_load_dword s41, s[60:61], 0
    s_mov_b32 s24, s52
    s_and_b32 s25, s53, 0xffff
    s_mov_b32 s26, 6400000
    s_mov_b32 s27, 0x20000
    s_mov_b32 s4, s56
    s_and_b32 s5, s57, 0xffff
    s_mov_b32 s6, 204800000
    s_mov_b32 s7, 0x20000
    s_mov_b32 s8, s58
    s_and_b32 s9, s59, 0xffff
    s_mov_b32 s10, 204800000
    s_mov_b32 s11, 0x20000
    s_mov_b32 s12, s54
    s_and_b32 s13, s55, 0xffff
    s_mov_b32 s14, 102400000
    s_mov_b32 s15, 0x20000
    s_mov_b32 s16, s48
    s_and_b32 s17, s49, 0xffff
    s_mov_b32 s18, 819200000
    s_mov_b32 s19, 0x20000
    s_mov_b32 s20, s48
    s_and_b32 s21, s49, 0xffff
    s_mov_b32 s22, 0
    s_mov_b32 s23, 0x20000
    s_mov_b32 s36, 643827
    s_mov_b32 s37, 214609
    s_mov_b32 s38, 343268
    s_mov_b32 s39, -6671
    s_mov_b32 s40, -12512
    s_mov_b32 s42, 0x03800000
    s_mov_b32 s43, 8323199
    s_mov_b32 s44, 4294901760
    s_mov_b32 s45, 57344
    s_waitcnt lgkmcnt(0)
    s_lshl_b32 s41, s41, 16
    s_and_b32 s68, s2, 7
    s_lshl_b32 s68, s68, 8
    s_and_b32 s46, s2, 0xf8
    s_or_b32 s68, s68, s46
    s_mov_b32 s46, 0
    s_cmp_lt_u32 s46, 5
    s_cselect_b32 s34, 7, 6
    s_mul_i32 s47, s46, 391
    s_sub_i32 s50, s46, 5
    s_max_i32 s50, s50, 0
    s_sub_u32 s47, s47, s50
    s_lshl_b32 s47, s47, 8
    s_add_u32 s50, s34, 384
    s_mul_i32 s50, s50, s2
    s_add_u32 s47, s47, s50
    s_lshl_b32 s30, s47, 8
    s_lshl_b32 s31, s47, 7
    s_add_u32 s32, s30, 0
    buffer_load_dwordx4 v[4:7], v1, s[4:7], s32 offen nt
    buffer_load_dwordx4 v[28:31], v1, s[8:11], s32 offen nt
    s_add_u32 s32, s31, 0
    buffer_load_dwordx2 v[52:53], v2, s[12:15], s32 offen nt
    s_add_u32 s32, s30, 16384
    buffer_load_dwordx4 v[8:11], v1, s[4:7], s32 offen nt
    buffer_load_dwordx4 v[32:35], v1, s[8:11], s32 offen nt
    s_add_u32 s32, s31, 8192
    buffer_load_dwordx2 v[54:55], v2, s[12:15], s32 offen nt
    s_add_u32 s32, s30, 32768
    buffer_load_dwordx4 v[12:15], v1, s[4:7], s32 offen nt
    buffer_load_dwordx4 v[36:39], v1, s[8:11], s32 offen nt
    s_add_u32 s32, s31, 16384
    buffer_load_dwordx2 v[56:57], v2, s[12:15], s32 offen nt
    s_add_u32 s32, s30, 49152
    buffer_load_dwordx4 v[16:19], v1, s[4:7], s32 offen nt
    buffer_load_dwordx4 v[40:43], v1, s[8:11], s32 offen nt
    s_add_u32 s32, s31, 24576
    buffer_load_dwordx2 v[58:59], v2, s[12:15], s32 offen nt
    s_add_u32 s32, s30, 65536
    buffer_load_dwordx4 v[20:23], v1, s[4:7], s32 offen nt
    buffer_load_dwordx4 v[44:47], v1, s[8:11], s32 offen nt
    s_add_u32 s32, s31, 32768
    buffer_load_dwordx2 v[60:61], v2, s[12:15], s32 offen nt
    s_add_u32 s32, s30, 81920
    buffer_load_dwordx4 v[24:27], v1, s[4:7], s32 offen nt
    buffer_load_dwordx4 v[48:51], v1, s[8:11], s32 offen nt
    s_add_u32 s32, s31, 40960
    buffer_load_dwordx2 v[62:63], v2, s[12:15], s32 offen nt
    s_cmp_lt_u32 s28, s34
    s_cselect_b32 s46, 0, 0x40000000
    v_lshl_add_u32 v117, v0, 2, s46
    s_add_u32 s32, s30, 98304
    buffer_load_dword v64, v117, s[4:7], s32 offen nt
    buffer_load_dword v65, v117, s[8:11], s32 offen nt
    v_lshrrev_b32 v117, 1, v117
    s_add_u32 s32, s31, 49152
    buffer_load_ushort v66, v117, s[12:15], s32 offen nt
    v_mov_b32 v68, 0
    v_mov_b32 v69, 0
    v_mov_b32 v70, 0
    v_mov_b32 v71, 0
    ds_write_b128 v1, v[68:71] offset:0
    v_and_b32 v118, 63, v0
    v_mov_b32 v121, 0
    v_mov_b32 v122, 0
    s_lshl_b32 s52, s2, 4
    s_add_u32 s52, s52, s28
    s_mov_b32 s57, 0x7fff7fff
    s_mul_hi_u32 s54, s52, 89478486
    s_mul_i32 s55, s54, 48
    s_sub_u32 s55, s52, s55
    s_mul_i32 s55, s55, 1024
    s_add_u32 s55, s55, 0
    s_mul_i32 s56, s54, 53368
    s_add_u32 s56, s56, s55
    v_lshl_add_u32 v119, v118, 2, s56
    s_mul_i32 s56, s54, 53760
    s_add_u32 s56, s56, s55
    s_add_u32 s56, s56, 356941824
    v_lshl_add_u32 v120, v118, 4, s56
    buffer_load_dword v72, v119, s[24:27], 0 offen offset:0
    buffer_load_dword v73, v119, s[24:27], 0 offen offset:256
    buffer_load_dword v74, v119, s[24:27], 0 offen offset:512
    buffer_load_dword v75, v119, s[24:27], 0 offen offset:768
    s_waitcnt vmcnt(0)
    buffer_store_dwordx4 v[72:75], v120, s[16:19], 0 offen
    v_and_b32 v123, s57, v72
    v_pk_max_u16 v121, v121, v123
    v_lshlrev_b32 v124, 16, v123
    v_and_b32 v123, s44, v123
    v_fmac_f32 v122, v124, v124
    v_fmac_f32 v122, v123, v123
    v_and_b32 v123, s57, v73
    v_pk_max_u16 v121, v121, v123
    v_lshlrev_b32 v124, 16, v123
    v_and_b32 v123, s44, v123
    v_fmac_f32 v122, v124, v124
    v_fmac_f32 v122, v123, v123
    v_and_b32 v123, s57, v74
    v_pk_max_u16 v121, v121, v123
    v_lshlrev_b32 v124, 16, v123
    v_and_b32 v123, s44, v123
    v_fmac_f32 v122, v124, v124
    v_fmac_f32 v122, v123, v123
    v_and_b32 v123, s57, v75
    v_pk_max_u16 v121, v121, v123
    v_lshlrev_b32 v124, 16, v123
    v_and_b32 v123, s44, v123
    v_fmac_f32 v122, v124, v124
    v_fmac_f32 v122, v123, v123
    s_cmp_ge_u32 s52, 1664
    s_cbranch_scc1 p1_m2
    s_add_u32 s53, s52, 4096
    s_mul_hi_u32 s54, s53, 89478486
    s_mul_i32 s55, s54, 48
    s_sub_u32 s55, s53, s55
    s_mul_i32 s55, s55, 1024
    s_add_u32 s55, s55, 0
    s_mul_i32 s56, s54, 53368
    s_add_u32 s56, s56, s55
    v_lshl_add_u32 v119, v118, 2, s56
    s_mul_i32 s56, s54, 53760
    s_add_u32 s56, s56, s55
    s_add_u32 s56, s56, 356941824
    v_lshl_add_u32 v120, v118, 4, s56
    buffer_load_dword v72, v119, s[24:27], 0 offen offset:0
    buffer_load_dword v73, v119, s[24:27], 0 offen offset:256
    buffer_load_dword v74, v119, s[24:27], 0 offen offset:512
    buffer_load_dword v75, v119, s[24:27], 0 offen offset:768
    s_waitcnt vmcnt(0)
    buffer_store_dwordx4 v[72:75], v120, s[16:19], 0 offen
    v_and_b32 v123, s57, v72
    v_pk_max_u16 v121, v121, v123
    v_lshlrev_b32 v124, 16, v123
    v_and_b32 v123, s44, v123
    v_fmac_f32 v122, v124, v124
    v_fmac_f32 v122, v123, v123
    v_and_b32 v123, s57, v73
    v_pk_max_u16 v121, v121, v123
    v_lshlrev_b32 v124, 16, v123
    v_and_b32 v123, s44, v123
    v_fmac_f32 v122, v124, v124
    v_fmac_f32 v122, v123, v123
    v_and_b32 v123, s57, v74
    v_pk_max_u16 v121, v121, v123
    v_lshlrev_b32 v124, 16, v123
    v_and_b32 v123, s44, v123
    v_fmac_f32 v122, v124, v124
    v_fmac_f32 v122, v123, v123
    v_and_b32 v123, s57, v75
    v_pk_max_u16 v121, v121, v123
    v_lshlrev_b32 v124, 16, v123
    v_and_b32 v123, s44, v123
    v_fmac_f32 v122, v124, v124
    v_fmac_f32 v122, v123, v123
    s_branch p1_m3
p1_m2:
    s_sub_u32 s53, s52, 1664
    s_cmp_ge_u32 s53, 1080
    s_cbranch_scc1 p1_m3
    s_mul_hi_u32 s54, s53, 477218589
    s_mul_i32 s55, s54, 9
    s_sub_u32 s55, s53, s55
    s_mul_i32 s55, s55, 512
    s_add_u32 s55, s55, 49152
    s_mul_i32 s56, s54, 53368
    s_add_u32 s56, s56, s55
    v_lshl_add_u32 v119, v118, 2, s56
    s_mul_i32 s56, s54, 53760
    s_add_u32 s56, s56, s55
    s_add_u32 s56, s56, 356941824
    v_lshl_add_u32 v120, v118, 3, s56
    buffer_load_dword v72, v119, s[24:27], 0 offen offset:0
    buffer_load_dword v73, v119, s[24:27], 0 offen offset:256
    s_waitcnt vmcnt(0)
    buffer_store_dwordx2 v[72:73], v120, s[16:19], 0 offen
    v_and_b32 v123, s57, v72
    v_pk_max_u16 v121, v121, v123
    v_lshlrev_b32 v124, 16, v123
    v_and_b32 v123, s44, v123
    v_fmac_f32 v122, v124, v124
    v_fmac_f32 v122, v123, v123
    v_and_b32 v123, s57, v73
    v_pk_max_u16 v121, v121, v123
    v_lshlrev_b32 v124, 16, v123
    v_and_b32 v123, s44, v123
    v_fmac_f32 v122, v124, v124
    v_fmac_f32 v122, v123, v123
p1_m3:
    v_lshrrev_b32 v123, 16, v121
    v_and_b32 v121, 0xffff, v121
    v_max_u32 v121, v121, v123
    s_nop 1
    v_max_u32_dpp v121, v121, v121 row_shr:1 row_mask:0xf bank_mask:0xf bound_ctrl:0
    v_add_f32_dpp v122, v122, v122 row_shr:1 row_mask:0xf bank_mask:0xf bound_ctrl:0
    s_nop 0
    v_max_u32_dpp v121, v121, v121 row_shr:2 row_mask:0xf bank_mask:0xf bound_ctrl:0
    v_add_f32_dpp v122, v122, v122 row_shr:2 row_mask:0xf bank_mask:0xf bound_ctrl:0
    s_nop 0
    v_max_u32_dpp v121, v121, v121 row_shr:4 row_mask:0xf bank_mask:0xf bound_ctrl:0
    v_add_f32_dpp v122, v122, v122 row_shr:4 row_mask:0xf bank_mask:0xf bound_ctrl:0
    s_nop 0
    v_max_u32_dpp v121, v121, v121 row_shr:8 row_mask:0xf bank_mask:0xf bound_ctrl:0
    v_add_f32_dpp v122, v122, v122 row_shr:8 row_mask:0xf bank_mask:0xf bound_ctrl:0
    s_nop 0
    v_max_u32_dpp v121, v121, v121 row_bcast:15 row_mask:0xa bank_mask:0xf
    v_add_f32_dpp v122, v122, v122 row_bcast:15 row_mask:0xa bank_mask:0xf
    s_nop 0
    v_max_u32_dpp v121, v121, v121 row_bcast:31 row_mask:0xc bank_mask:0xf
    v_add_f32_dpp v122, v122, v122 row_bcast:31 row_mask:0xc bank_mask:0xf
    s_nop 0
    s_nop 0
    v_mov_b32 v72, v121
    v_mov_b32 v73, v122
    s_lshl_b32 s52, s52, 3
    s_add_u32 s52, s52, 363393024
    v_mov_b32 v120, s52
    v_cmp_eq_u32 vcc, 63, v118
    s_and_saveexec_b64 s[54:55], vcc
    buffer_store_dwordx2 v[72:73], v120, s[16:19], 0 offen
    s_mov_b64 exec, -1
    s_mov_b32 s29, 0
    s_waitcnt vmcnt(0) lgkmcnt(0)
    s_barrier
p1_tile:
    s_mov_b32 s33, s34
    s_add_u32 s46, s29, 1
    s_cmp_lt_u32 s46, 5
    s_cselect_b32 s34, 7, 6
    s_mul_i32 s47, s46, 391
    s_sub_i32 s50, s46, 5
    s_max_i32 s50, s50, 0
    s_sub_u32 s47, s47, s50
    s_lshl_b32 s47, s47, 8
    s_add_u32 s50, s34, 384
    s_mul_i32 s50, s50, s2
    s_add_u32 s47, s47, s50
    s_lshl_b32 s30, s47, 8
    s_lshl_b32 s31, s47, 7
    v_mov_b32 v68, 0
    v_mov_b32 v69, 0
    v_mov_b32 v70, 0
    v_mov_b32 v71, 0
    ds_write_b128 v1, v[68:71] offset:10496
    ds_write_b128 v1, v[68:71] offset:26880
    s_waitcnt vmcnt(10)
    v_lshlrev_b32 v117, 16, v52
    v_and_b32 v118, s44, v52
    v_mul_f32 v117, s41, v117
    v_mul_f32 v118, s41, v118
    v_cvt_pk_bf16_f32 v117, v117, v118
    v_and_b32 v118, s44, v117
    v_lshlrev_b32 v117, 16, v117
    v_mul_f32 v117, 0.15915494, v117
    v_mul_f32 v118, 0.15915494, v118
    v_fract_f32 v117, v117
    v_fract_f32 v118, v118
    v_cos_f32 v117, v117
    v_cos_f32 v118, v118
    v_mul_hi_u32_u24 v120, s36, v4
    v_mul_hi_u32_u24 v121, s37, v4
    v_mul_hi_u32_u24 v122, s38, v28
    v_mad_i32_i24 v67, v120, s39, v4
    v_mad_u32_u24 v92, v122, 40, v121
    v_mad_i32_i24 v120, v121, -3, v120
    v_lshlrev_b32 v92, 2, v92
    v_mad_i32_i24 v122, v122, s40, v28
    ds_add_u32 v92, v3 offset:0
    v_lshl_or_b32 v67, v120, 30, v67
    v_lshl_or_b32 v67, v122, 16, v67
    v_mul_f32 v117, s42, v117
    v_mul_f32 v118, s42, v118
    v_cvt_pk_bf16_f32 v117, v117, v118
    v_mul_hi_u32_u24 v123, s36, v5
    v_mul_hi_u32_u24 v124, s37, v5
    v_mul_hi_u32_u24 v125, s38, v29
    v_mad_i32_i24 v68, v123, s39, v5
    v_mad_u32_u24 v93, v125, 40, v124
    v_mad_i32_i24 v123, v124, -3, v123
    v_lshlrev_b32 v93, 2, v93
    v_mad_i32_i24 v125, v125, s40, v29
    ds_add_u32 v93, v3 offset:0
    v_lshl_or_b32 v68, v123, 30, v68
    v_lshl_or_b32 v68, v125, 16, v68
    v_lshrrev_b32 v118, 3, v117
    v_lshrrev_b32 v119, 8, v117
    v_lshlrev_b32 v117, 13, v117
    v_bitop3_b32 v119, v118, v119, s43 bitop3:0x1b
    v_bitop3_b32 v67, v117, s45, v67 bitop3:0xae
    v_lshl_or_b32 v92, v119, 16, v92
    v_bitop3_b32 v68, v118, s45, v68 bitop3:0xae
    v_and_or_b32 v93, v119, s44, v93
    v_lshlrev_b32 v117, 16, v53
    v_and_b32 v118, s44, v53
    v_mul_f32 v117, s41, v117
    v_mul_f32 v118, s41, v118
    v_cvt_pk_bf16_f32 v117, v117, v118
    v_and_b32 v118, s44, v117
    v_lshlrev_b32 v117, 16, v117
    v_mul_f32 v117, 0.15915494, v117
    v_mul_f32 v118, 0.15915494, v118
    v_fract_f32 v117, v117
    v_fract_f32 v118, v118
    v_cos_f32 v117, v117
    v_cos_f32 v118, v118
    v_mul_hi_u32_u24 v120, s36, v6
    v_mul_hi_u32_u24 v121, s37, v6
    v_mul_hi_u32_u24 v122, s38, v30
    v_mad_i32_i24 v69, v120, s39, v6
    v_mad_u32_u24 v94, v122, 40, v121
    v_mad_i32_i24 v120, v121, -3, v120
    v_lshlrev_b32 v94, 2, v94
    v_mad_i32_i24 v122, v122, s40, v30
    ds_add_u32 v94, v3 offset:0
    v_lshl_or_b32 v69, v120, 30, v69
    v_lshl_or_b32 v69, v122, 16, v69
    v_mul_f32 v117, s42, v117
    v_mul_f32 v118, s42, v118
    v_cvt_pk_bf16_f32 v117, v117, v118
    v_mul_hi_u32_u24 v123, s36, v7
    v_mul_hi_u32_u24 v124, s37, v7
    v_mul_hi_u32_u24 v125, s38, v31
    v_mad_i32_i24 v70, v123, s39, v7
    v_mad_u32_u24 v95, v125, 40, v124
    v_mad_i32_i24 v123, v124, -3, v123
    v_lshlrev_b32 v95, 2, v95
    v_mad_i32_i24 v125, v125, s40, v31
    ds_add_u32 v95, v3 offset:0
    v_lshl_or_b32 v70, v123, 30, v70
    v_lshl_or_b32 v70, v125, 16, v70
    v_lshrrev_b32 v118, 3, v117
    v_lshrrev_b32 v119, 8, v117
    v_lshlrev_b32 v117, 13, v117
    v_bitop3_b32 v119, v118, v119, s43 bitop3:0x1b
    v_bitop3_b32 v69, v117, s45, v69 bitop3:0xae
    v_lshl_or_b32 v94, v119, 16, v94
    v_bitop3_b32 v70, v118, s45, v70 bitop3:0xae
    v_and_or_b32 v95, v119, s44, v95
    v_lshlrev_b32 v117, 16, v54
    v_and_b32 v118, s44, v54
    v_mul_f32 v117, s41, v117
    v_mul_f32 v118, s41, v118
    v_cvt_pk_bf16_f32 v117, v117, v118
    v_and_b32 v118, s44, v117
    v_lshlrev_b32 v117, 16, v117
    v_mul_f32 v117, 0.15915494, v117
    v_mul_f32 v118, 0.15915494, v118
    v_fract_f32 v117, v117
    v_fract_f32 v118, v118
    v_cos_f32 v117, v117
    v_cos_f32 v118, v118
    v_mul_hi_u32_u24 v120, s36, v8
    v_mul_hi_u32_u24 v121, s37, v8
    v_mul_hi_u32_u24 v122, s38, v32
    v_mad_i32_i24 v71, v120, s39, v8
    v_mad_u32_u24 v96, v122, 40, v121
    v_mad_i32_i24 v120, v121, -3, v120
    v_lshlrev_b32 v96, 2, v96
    v_mad_i32_i24 v122, v122, s40, v32
    ds_add_u32 v96, v3 offset:0
    v_lshl_or_b32 v71, v120, 30, v71
    v_lshl_or_b32 v71, v122, 16, v71
    v_mul_f32 v117, s42, v117
    v_mul_f32 v118, s42, v118
    v_cvt_pk_bf16_f32 v117, v117, v118
    v_mul_hi_u32_u24 v123, s36, v9
    v_mul_hi_u32_u24 v124, s37, v9
    v_mul_hi_u32_u24 v125, s38, v33
    v_mad_i32_i24 v72, v123, s39, v9
    v_mad_u32_u24 v97, v125, 40, v124
    v_mad_i32_i24 v123, v124, -3, v123
    v_lshlrev_b32 v97, 2, v97
    v_mad_i32_i24 v125, v125, s40, v33
    ds_add_u32 v97, v3 offset:0
    v_lshl_or_b32 v72, v123, 30, v72
    v_lshl_or_b32 v72, v125, 16, v72
    v_lshrrev_b32 v118, 3, v117
    v_lshrrev_b32 v119, 8, v117
    v_lshlrev_b32 v117, 13, v117
    v_bitop3_b32 v119, v118, v119, s43 bitop3:0x1b
    v_bitop3_b32 v71, v117, s45, v71 bitop3:0xae
    v_lshl_or_b32 v96, v119, 16, v96
    v_bitop3_b32 v72, v118, s45, v72 bitop3:0xae
    v_and_or_b32 v97, v119, s44, v97
    v_lshlrev_b32 v117, 16, v55
    v_and_b32 v118, s44, v55
    v_mul_f32 v117, s41, v117
    v_mul_f32 v118, s41, v118
    v_cvt_pk_bf16_f32 v117, v117, v118
    v_and_b32 v118, s44, v117
    v_lshlrev_b32 v117, 16, v117
    v_mul_f32 v117, 0.15915494, v117
    v_mul_f32 v118, 0.15915494, v118
    v_fract_f32 v117, v117
    v_fract_f32 v118, v118
    v_cos_f32 v117, v117
    v_cos_f32 v118, v118
    v_mul_hi_u32_u24 v120, s36, v10
    v_mul_hi_u32_u24 v121, s37, v10
    v_mul_hi_u32_u24 v122, s38, v34
    v_mad_i32_i24 v73, v120, s39, v10
    v_mad_u32_u24 v98, v122, 40, v121
    v_mad_i32_i24 v120, v121, -3, v120
    v_lshlrev_b32 v98, 2, v98
    v_mad_i32_i24 v122, v122, s40, v34
    ds_add_u32 v98, v3 offset:0
    v_lshl_or_b32 v73, v120, 30, v73
    v_lshl_or_b32 v73, v122, 16, v73
    v_mul_f32 v117, s42, v117
    v_mul_f32 v118, s42, v118
    v_cvt_pk_bf16_f32 v117, v117, v118
    v_mul_hi_u32_u24 v123, s36, v11
    v_mul_hi_u32_u24 v124, s37, v11
    v_mul_hi_u32_u24 v125, s38, v35
    v_mad_i32_i24 v74, v123, s39, v11
    v_mad_u32_u24 v99, v125, 40, v124
    v_mad_i32_i24 v123, v124, -3, v123
    v_lshlrev_b32 v99, 2, v99
    v_mad_i32_i24 v125, v125, s40, v35
    ds_add_u32 v99, v3 offset:0
    v_lshl_or_b32 v74, v123, 30, v74
    v_lshl_or_b32 v74, v125, 16, v74
    v_lshrrev_b32 v118, 3, v117
    v_lshrrev_b32 v119, 8, v117
    v_lshlrev_b32 v117, 13, v117
    v_bitop3_b32 v119, v118, v119, s43 bitop3:0x1b
    v_bitop3_b32 v73, v117, s45, v73 bitop3:0xae
    v_lshl_or_b32 v98, v119, 16, v98
    v_bitop3_b32 v74, v118, s45, v74 bitop3:0xae
    v_and_or_b32 v99, v119, s44, v99
    s_waitcnt lgkmcnt(4)
    v_lshlrev_b32 v117, 16, v56
    v_and_b32 v118, s44, v56
    v_mul_f32 v117, s41, v117
    v_mul_f32 v118, s41, v118
    v_cvt_pk_bf16_f32 v117, v117, v118
    v_and_b32 v118, s44, v117
    v_lshlrev_b32 v117, 16, v117
    v_mul_f32 v117, 0.15915494, v117
    v_mul_f32 v118, 0.15915494, v118
    v_fract_f32 v117, v117
    v_fract_f32 v118, v118
    v_cos_f32 v117, v117
    v_cos_f32 v118, v118
    v_mul_hi_u32_u24 v120, s36, v12
    v_mul_hi_u32_u24 v121, s37, v12
    v_mul_hi_u32_u24 v122, s38, v36
    v_mad_i32_i24 v75, v120, s39, v12
    v_mad_u32_u24 v100, v122, 40, v121
    v_mad_i32_i24 v120, v121, -3, v120
    v_lshlrev_b32 v100, 2, v100
    v_mad_i32_i24 v122, v122, s40, v36
    ds_add_u32 v100, v3 offset:0
    v_lshl_or_b32 v75, v120, 30, v75
    v_lshl_or_b32 v75, v122, 16, v75
    v_mul_f32 v117, s42, v117
    v_mul_f32 v118, s42, v118
    v_cvt_pk_bf16_f32 v117, v117, v118
    v_mul_hi_u32_u24 v123, s36, v13
    v_mul_hi_u32_u24 v124, s37, v13
    v_mul_hi_u32_u24 v125, s38, v37
    v_mad_i32_i24 v76, v123, s39, v13
    v_mad_u32_u24 v101, v125, 40, v124
    v_mad_i32_i24 v123, v124, -3, v123
    v_lshlrev_b32 v101, 2, v101
    v_mad_i32_i24 v125, v125, s40, v37
    ds_add_u32 v101, v3 offset:0
    v_lshl_or_b32 v76, v123, 30, v76
    v_lshl_or_b32 v76, v125, 16, v76
    v_lshrrev_b32 v118, 3, v117
    v_lshrrev_b32 v119, 8, v117
    v_lshlrev_b32 v117, 13, v117
    v_bitop3_b32 v119, v118, v119, s43 bitop3:0x1b
    v_bitop3_b32 v75, v117, s45, v75 bitop3:0xae
    v_lshl_or_b32 v100, v119, 16, v100
    v_bitop3_b32 v76, v118, s45, v76 bitop3:0xae
    v_and_or_b32 v101, v119, s44, v101
    v_lshlrev_b32 v117, 16, v57
    v_and_b32 v118, s44, v57
    v_mul_f32 v117, s41, v117
    v_mul_f32 v118, s41, v118
    v_cvt_pk_bf16_f32 v117, v117, v118
    v_and_b32 v118, s44, v117
    v_lshlrev_b32 v117, 16, v117
    v_mul_f32 v117, 0.15915494, v117
    v_mul_f32 v118, 0.15915494, v118
    v_fract_f32 v117, v117
    v_fract_f32 v118, v118
    v_cos_f32 v117, v117
    v_cos_f32 v118, v118
    v_mul_hi_u32_u24 v120, s36, v14
    v_mul_hi_u32_u24 v121, s37, v14
    v_mul_hi_u32_u24 v122, s38, v38
    v_mad_i32_i24 v77, v120, s39, v14
    v_mad_u32_u24 v102, v122, 40, v121
    v_mad_i32_i24 v120, v121, -3, v120
    v_lshlrev_b32 v102, 2, v102
    v_mad_i32_i24 v122, v122, s40, v38
    ds_add_u32 v102, v3 offset:0
    v_lshl_or_b32 v77, v120, 30, v77
    v_lshl_or_b32 v77, v122, 16, v77
    v_mul_f32 v117, s42, v117
    v_mul_f32 v118, s42, v118
    v_cvt_pk_bf16_f32 v117, v117, v118
    v_mul_hi_u32_u24 v123, s36, v15
    v_mul_hi_u32_u24 v124, s37, v15
    v_mul_hi_u32_u24 v125, s38, v39
    v_mad_i32_i24 v78, v123, s39, v15
    v_mad_u32_u24 v103, v125, 40, v124
    v_mad_i32_i24 v123, v124, -3, v123
    v_lshlrev_b32 v103, 2, v103
    v_mad_i32_i24 v125, v125, s40, v39
    ds_add_u32 v103, v3 offset:0
    v_lshl_or_b32 v78, v123, 30, v78
    v_lshl_or_b32 v78, v125, 16, v78
    v_lshrrev_b32 v118, 3, v117
    v_lshrrev_b32 v119, 8, v117
    v_lshlrev_b32 v117, 13, v117
    v_bitop3_b32 v119, v118, v119, s43 bitop3:0x1b
    v_bitop3_b32 v77, v117, s45, v77 bitop3:0xae
    v_lshl_or_b32 v102, v119, 16, v102
    v_bitop3_b32 v78, v118, s45, v78 bitop3:0xae
    v_and_or_b32 v103, v119, s44, v103
    s_cmp_eq_u32 s29, 7
    s_cbranch_scc1 p1_nl0
    s_add_u32 s32, s30, 0
    buffer_load_dwordx4 v[4:7], v1, s[4:7], s32 offen nt
    buffer_load_dwordx4 v[28:31], v1, s[8:11], s32 offen nt
    s_add_u32 s32, s31, 0
    buffer_load_dwordx2 v[52:53], v2, s[12:15], s32 offen nt
p1_nl0:
    v_lshlrev_b32 v117, 16, v58
    v_and_b32 v118, s44, v58
    v_mul_f32 v117, s41, v117
    v_mul_f32 v118, s41, v118
    v_cvt_pk_bf16_f32 v117, v117, v118
    v_and_b32 v118, s44, v117
    v_lshlrev_b32 v117, 16, v117
    v_mul_f32 v117, 0.15915494, v117
    v_mul_f32 v118, 0.15915494, v118
    v_fract_f32 v117, v117
    v_fract_f32 v118, v118
    v_cos_f32 v117, v117
    v_cos_f32 v118, v118
    v_mul_hi_u32_u24 v120, s36, v16
    v_mul_hi_u32_u24 v121, s37, v16
    v_mul_hi_u32_u24 v122, s38, v40
    v_mad_i32_i24 v79, v120, s39, v16
    v_mad_u32_u24 v104, v122, 40, v121
    v_mad_i32_i24 v120, v121, -3, v120
    v_lshlrev_b32 v104, 2, v104
    v_mad_i32_i24 v122, v122, s40, v40
    ds_add_u32 v104, v3 offset:0
    v_lshl_or_b32 v79, v120, 30, v79
    v_lshl_or_b32 v79, v122, 16, v79
    v_mul_f32 v117, s42, v117
    v_mul_f32 v118, s42, v118
    v_cvt_pk_bf16_f32 v117, v117, v118
    v_mul_hi_u32_u24 v123, s36, v17
    v_mul_hi_u32_u24 v124, s37, v17
    v_mul_hi_u32_u24 v125, s38, v41
    v_mad_i32_i24 v80, v123, s39, v17
    v_mad_u32_u24 v105, v125, 40, v124
    v_mad_i32_i24 v123, v124, -3, v123
    v_lshlrev_b32 v105, 2, v105
    v_mad_i32_i24 v125, v125, s40, v41
    ds_add_u32 v105, v3 offset:0
    v_lshl_or_b32 v80, v123, 30, v80
    v_lshl_or_b32 v80, v125, 16, v80
    v_lshrrev_b32 v118, 3, v117
    v_lshrrev_b32 v119, 8, v117
    v_lshlrev_b32 v117, 13, v117
    v_bitop3_b32 v119, v118, v119, s43 bitop3:0x1b
    v_bitop3_b32 v79, v117, s45, v79 bitop3:0xae
    v_lshl_or_b32 v104, v119, 16, v104
    v_bitop3_b32 v80, v118, s45, v80 bitop3:0xae
    v_and_or_b32 v105, v119, s44, v105
    v_lshlrev_b32 v117, 16, v59
    v_and_b32 v118, s44, v59
    v_mul_f32 v117, s41, v117
    v_mul_f32 v118, s41, v118
    v_cvt_pk_bf16_f32 v117, v117, v118
    v_and_b32 v118, s44, v117
    v_lshlrev_b32 v117, 16, v117
    v_mul_f32 v117, 0.15915494, v117
    v_mul_f32 v118, 0.15915494, v118
    v_fract_f32 v117, v117
    v_fract_f32 v118, v118
    v_cos_f32 v117, v117
    v_cos_f32 v118, v118
    v_mul_hi_u32_u24 v120, s36, v18
    v_mul_hi_u32_u24 v121, s37, v18
    v_mul_hi_u32_u24 v122, s38, v42
    v_mad_i32_i24 v81, v120, s39, v18
    v_mad_u32_u24 v106, v122, 40, v121
    v_mad_i32_i24 v120, v121, -3, v120
    v_lshlrev_b32 v106, 2, v106
    v_mad_i32_i24 v122, v122, s40, v42
    ds_add_u32 v106, v3 offset:0
    v_lshl_or_b32 v81, v120, 30, v81
    v_lshl_or_b32 v81, v122, 16, v81
    v_mul_f32 v117, s42, v117
    v_mul_f32 v118, s42, v118
    v_cvt_pk_bf16_f32 v117, v117, v118
    v_mul_hi_u32_u24 v123, s36, v19
    v_mul_hi_u32_u24 v124, s37, v19
    v_mul_hi_u32_u24 v125, s38, v43
    v_mad_i32_i24 v82, v123, s39, v19
    v_mad_u32_u24 v107, v125, 40, v124
    v_mad_i32_i24 v123, v124, -3, v123
    v_lshlrev_b32 v107, 2, v107
    v_mad_i32_i24 v125, v125, s40, v43
    ds_add_u32 v107, v3 offset:0
    v_lshl_or_b32 v82, v123, 30, v82
    v_lshl_or_b32 v82, v125, 16, v82
    v_lshrrev_b32 v118, 3, v117
    v_lshrrev_b32 v119, 8, v117
    v_lshlrev_b32 v117, 13, v117
    v_bitop3_b32 v119, v118, v119, s43 bitop3:0x1b
    v_bitop3_b32 v81, v117, s45, v81 bitop3:0xae
    v_lshl_or_b32 v106, v119, 16, v106
    v_bitop3_b32 v82, v118, s45, v82 bitop3:0xae
    v_and_or_b32 v107, v119, s44, v107
    s_waitcnt lgkmcnt(4)
    v_lshlrev_b32 v117, 16, v60
    v_and_b32 v118, s44, v60
    v_mul_f32 v117, s41, v117
    v_mul_f32 v118, s41, v118
    v_cvt_pk_bf16_f32 v117, v117, v118
    v_and_b32 v118, s44, v117
    v_lshlrev_b32 v117, 16, v117
    v_mul_f32 v117, 0.15915494, v117
    v_mul_f32 v118, 0.15915494, v118
    v_fract_f32 v117, v117
    v_fract_f32 v118, v118
    v_cos_f32 v117, v117
    v_cos_f32 v118, v118
    v_mul_hi_u32_u24 v120, s36, v20
    v_mul_hi_u32_u24 v121, s37, v20
    v_mul_hi_u32_u24 v122, s38, v44
    v_mad_i32_i24 v83, v120, s39, v20
    v_mad_u32_u24 v108, v122, 40, v121
    v_mad_i32_i24 v120, v121, -3, v120
    v_lshlrev_b32 v108, 2, v108
    v_mad_i32_i24 v122, v122, s40, v44
    ds_add_u32 v108, v3 offset:0
    v_lshl_or_b32 v83, v120, 30, v83
    v_lshl_or_b32 v83, v122, 16, v83
    v_mul_f32 v117, s42, v117
    v_mul_f32 v118, s42, v118
    v_cvt_pk_bf16_f32 v117, v117, v118
    v_mul_hi_u32_u24 v123, s36, v21
    v_mul_hi_u32_u24 v124, s37, v21
    v_mul_hi_u32_u24 v125, s38, v45
    v_mad_i32_i24 v84, v123, s39, v21
    v_mad_u32_u24 v109, v125, 40, v124
    v_mad_i32_i24 v123, v124, -3, v123
    v_lshlrev_b32 v109, 2, v109
    v_mad_i32_i24 v125, v125, s40, v45
    ds_add_u32 v109, v3 offset:0
    v_lshl_or_b32 v84, v123, 30, v84
    v_lshl_or_b32 v84, v125, 16, v84
    v_lshrrev_b32 v118, 3, v117
    v_lshrrev_b32 v119, 8, v117
    v_lshlrev_b32 v117, 13, v117
    v_bitop3_b32 v119, v118, v119, s43 bitop3:0x1b
    v_bitop3_b32 v83, v117, s45, v83 bitop3:0xae
    v_lshl_or_b32 v108, v119, 16, v108
    v_bitop3_b32 v84, v118, s45, v84 bitop3:0xae
    v_and_or_b32 v109, v119, s44, v109
    v_lshlrev_b32 v117, 16, v61
    v_and_b32 v118, s44, v61
    v_mul_f32 v117, s41, v117
    v_mul_f32 v118, s41, v118
    v_cvt_pk_bf16_f32 v117, v117, v118
    v_and_b32 v118, s44, v117
    v_lshlrev_b32 v117, 16, v117
    v_mul_f32 v117, 0.15915494, v117
    v_mul_f32 v118, 0.15915494, v118
    v_fract_f32 v117, v117
    v_fract_f32 v118, v118
    v_cos_f32 v117, v117
    v_cos_f32 v118, v118
    v_mul_hi_u32_u24 v120, s36, v22
    v_mul_hi_u32_u24 v121, s37, v22
    v_mul_hi_u32_u24 v122, s38, v46
    v_mad_i32_i24 v85, v120, s39, v22
    v_mad_u32_u24 v110, v122, 40, v121
    v_mad_i32_i24 v120, v121, -3, v120
    v_lshlrev_b32 v110, 2, v110
    v_mad_i32_i24 v122, v122, s40, v46
    ds_add_u32 v110, v3 offset:0
    v_lshl_or_b32 v85, v120, 30, v85
    v_lshl_or_b32 v85, v122, 16, v85
    v_mul_f32 v117, s42, v117
    v_mul_f32 v118, s42, v118
    v_cvt_pk_bf16_f32 v117, v117, v118
    v_mul_hi_u32_u24 v123, s36, v23
    v_mul_hi_u32_u24 v124, s37, v23
    v_mul_hi_u32_u24 v125, s38, v47
    v_mad_i32_i24 v86, v123, s39, v23
    v_mad_u32_u24 v111, v125, 40, v124
    v_mad_i32_i24 v123, v124, -3, v123
    v_lshlrev_b32 v111, 2, v111
    v_mad_i32_i24 v125, v125, s40, v47
    ds_add_u32 v111, v3 offset:0
    v_lshl_or_b32 v86, v123, 30, v86
    v_lshl_or_b32 v86, v125, 16, v86
    v_lshrrev_b32 v118, 3, v117
    v_lshrrev_b32 v119, 8, v117
    v_lshlrev_b32 v117, 13, v117
    v_bitop3_b32 v119, v118, v119, s43 bitop3:0x1b
    v_bitop3_b32 v85, v117, s45, v85 bitop3:0xae
    v_lshl_or_b32 v110, v119, 16, v110
    v_bitop3_b32 v86, v118, s45, v86 bitop3:0xae
    v_and_or_b32 v111, v119, s44, v111
    v_lshlrev_b32 v117, 16, v62
    v_and_b32 v118, s44, v62
    v_mul_f32 v117, s41, v117
    v_mul_f32 v118, s41, v118
    v_cvt_pk_bf16_f32 v117, v117, v118
    v_and_b32 v118, s44, v117
    v_lshlrev_b32 v117, 16, v117
    v_mul_f32 v117, 0.15915494, v117
    v_mul_f32 v118, 0.15915494, v118
    v_fract_f32 v117, v117
    v_fract_f32 v118, v118
    v_cos_f32 v117, v117
    v_cos_f32 v118, v118
    v_mul_hi_u32_u24 v120, s36, v24
    v_mul_hi_u32_u24 v121, s37, v24
    v_mul_hi_u32_u24 v122, s38, v48
    v_mad_i32_i24 v87, v120, s39, v24
    v_mad_u32_u24 v112, v122, 40, v121
    v_mad_i32_i24 v120, v121, -3, v120
    v_lshlrev_b32 v112, 2, v112
    v_mad_i32_i24 v122, v122, s40, v48
    ds_add_u32 v112, v3 offset:0
    v_lshl_or_b32 v87, v120, 30, v87
    v_lshl_or_b32 v87, v122, 16, v87
    v_mul_f32 v117, s42, v117
    v_mul_f32 v118, s42, v118
    v_cvt_pk_bf16_f32 v117, v117, v118
    v_mul_hi_u32_u24 v123, s36, v25
    v_mul_hi_u32_u24 v124, s37, v25
    v_mul_hi_u32_u24 v125, s38, v49
    v_mad_i32_i24 v88, v123, s39, v25
    v_mad_u32_u24 v113, v125, 40, v124
    v_mad_i32_i24 v123, v124, -3, v123
    v_lshlrev_b32 v113, 2, v113
    v_mad_i32_i24 v125, v125, s40, v49
    ds_add_u32 v113, v3 offset:0
    v_lshl_or_b32 v88, v123, 30, v88
    v_lshl_or_b32 v88, v125, 16, v88
    v_lshrrev_b32 v118, 3, v117
    v_lshrrev_b32 v119, 8, v117
    v_lshlrev_b32 v117, 13, v117
    v_bitop3_b32 v119, v118, v119, s43 bitop3:0x1b
    v_bitop3_b32 v87, v117, s45, v87 bitop3:0xae
    v_lshl_or_b32 v112, v119, 16, v112
    v_bitop3_b32 v88, v118, s45, v88 bitop3:0xae
    v_and_or_b32 v113, v119, s44, v113
    v_lshlrev_b32 v117, 16, v63
    v_and_b32 v118, s44, v63
    v_mul_f32 v117, s41, v117
    v_mul_f32 v118, s41, v118
    v_cvt_pk_bf16_f32 v117, v117, v118
    v_and_b32 v118, s44, v117
    v_lshlrev_b32 v117, 16, v117
    v_mul_f32 v117, 0.15915494, v117
    v_mul_f32 v118, 0.15915494, v118
    v_fract_f32 v117, v117
    v_fract_f32 v118, v118
    v_cos_f32 v117, v117
    v_cos_f32 v118, v118
    v_mul_hi_u32_u24 v120, s36, v26
    v_mul_hi_u32_u24 v121, s37, v26
    v_mul_hi_u32_u24 v122, s38, v50
    v_mad_i32_i24 v89, v120, s39, v26
    v_mad_u32_u24 v114, v122, 40, v121
    v_mad_i32_i24 v120, v121, -3, v120
    v_lshlrev_b32 v114, 2, v114
    v_mad_i32_i24 v122, v122, s40, v50
    ds_add_u32 v114, v3 offset:0
    v_lshl_or_b32 v89, v120, 30, v89
    v_lshl_or_b32 v89, v122, 16, v89
    v_mul_f32 v117, s42, v117
    v_mul_f32 v118, s42, v118
    v_cvt_pk_bf16_f32 v117, v117, v118
    v_mul_hi_u32_u24 v123, s36, v27
    v_mul_hi_u32_u24 v124, s37, v27
    v_mul_hi_u32_u24 v125, s38, v51
    v_mad_i32_i24 v90, v123, s39, v27
    v_mad_u32_u24 v115, v125, 40, v124
    v_mad_i32_i24 v123, v124, -3, v123
    v_lshlrev_b32 v115, 2, v115
    v_mad_i32_i24 v125, v125, s40, v51
    ds_add_u32 v115, v3 offset:0
    v_lshl_or_b32 v90, v123, 30, v90
    v_lshl_or_b32 v90, v125, 16, v90
    v_lshrrev_b32 v118, 3, v117
    v_lshrrev_b32 v119, 8, v117
    v_lshlrev_b32 v117, 13, v117
    v_bitop3_b32 v119, v118, v119, s43 bitop3:0x1b
    v_bitop3_b32 v89, v117, s45, v89 bitop3:0xae
    v_lshl_or_b32 v114, v119, 16, v114
    v_bitop3_b32 v90, v118, s45, v90 bitop3:0xae
    v_and_or_b32 v115, v119, s44, v115
    s_waitcnt lgkmcnt(4)
    s_cmp_eq_u32 s29, 7
    s_cbranch_scc1 p1_nl1
    s_add_u32 s32, s30, 16384
    buffer_load_dwordx4 v[8:11], v1, s[4:7], s32 offen nt
    buffer_load_dwordx4 v[32:35], v1, s[8:11], s32 offen nt
    s_add_u32 s32, s31, 8192
    buffer_load_dwordx2 v[54:55], v2, s[12:15], s32 offen nt
p1_nl1:
    s_cmp_ge_u32 s28, s33
    s_cbranch_scc1 p1_r_done
    v_lshlrev_b32 v117, 16, v66
    v_and_b32 v118, s44, v66
    v_mul_f32 v117, s41, v117
    v_mul_f32 v118, s41, v118
    v_cvt_pk_bf16_f32 v117, v117, v118
    v_and_b32 v118, s44, v117
    v_lshlrev_b32 v117, 16, v117
    v_mul_f32 v117, 0.15915494, v117
    v_mul_f32 v118, 0.15915494, v118
    v_fract_f32 v117, v117
    v_fract_f32 v118, v118
    v_cos_f32 v117, v117
    v_cos_f32 v118, v118
    v_mul_hi_u32_u24 v120, s36, v64
    v_mul_hi_u32_u24 v121, s37, v64
    v_mul_hi_u32_u24 v122, s38, v65
    v_mad_i32_i24 v91, v120, s39, v64
    v_mad_u32_u24 v116, v122, 40, v121
    v_mad_i32_i24 v120, v121, -3, v120
    v_lshlrev_b32 v116, 2, v116
    v_mad_i32_i24 v122, v122, s40, v65
    ds_add_u32 v116, v3 offset:0
    v_lshl_or_b32 v91, v120, 30, v91
    v_lshl_or_b32 v91, v122, 16, v91
    v_mul_f32 v117, s42, v117
    v_mul_f32 v118, s42, v118
    v_cvt_pk_bf16_f32 v117, v117, v118
    v_lshrrev_b32 v118, 3, v117
    v_lshrrev_b32 v119, 8, v117
    v_lshlrev_b32 v117, 13, v117
    v_bitop3_b32 v119, v118, v119, s43 bitop3:0x1b
    v_bitop3_b32 v91, v117, s45, v91 bitop3:0xae
    v_lshl_or_b32 v116, v119, 16, v116
p1_r_done:
    s_waitcnt lgkmcnt(0)
    s_barrier
    s_cmp_ge_u32 s28, 10
    s_cbranch_scc1 p1_s1_skip
    v_and_b32 v126, 63, v0
    s_lshl_b32 s54, s28, 4
    v_mul_u32_u24 v117, 160, v126
    v_add_u32 v117, s54, v117
    ds_read_b128 v[118:121], v117 offset:0
    s_mov_b32 s55, 43691
    s_waitcnt lgkmcnt(0)
    v_add_u32 v118, 2, v118
    v_add_u32 v119, 2, v119
    v_add_u32 v120, 2, v120
    v_add_u32 v121, 2, v121
    v_mul_u32_u24 v118, s55, v118
    v_mul_u32_u24 v119, s55, v119
    v_mul_u32_u24 v120, s55, v120
    v_mul_u32_u24 v121, s55, v121
    v_lshrrev_b32 v118, 17, v118
    v_lshrrev_b32 v119, 17, v119
    v_lshrrev_b32 v120, 17, v120
    v_lshrrev_b32 v121, 17, v121
    v_lshl_or_b32 v122, v119, 16, v118
    v_lshl_or_b32 v123, v121, 16, v120
    v_mov_b32 v124, v122
    v_mov_b32 v125, v123
    s_nop 1
    v_add_u32_dpp v124, v124, v124 row_shr:1 row_mask:0xf bank_mask:0xf bound_ctrl:0
    v_add_u32_dpp v125, v125, v125 row_shr:1 row_mask:0xf bank_mask:0xf bound_ctrl:0
    s_nop 0
    v_add_u32_dpp v124, v124, v124 row_shr:2 row_mask:0xf bank_mask:0xf bound_ctrl:0
    v_add_u32_dpp v125, v125, v125 row_shr:2 row_mask:0xf bank_mask:0xf bound_ctrl:0
    s_nop 0
    v_add_u32_dpp v124, v124, v124 row_shr:4 row_mask:0xf bank_mask:0xf bound_ctrl:0
    v_add_u32_dpp v125, v125, v125 row_shr:4 row_mask:0xf bank_mask:0xf bound_ctrl:0
    s_nop 0
    v_add_u32_dpp v124, v124, v124 row_shr:8 row_mask:0xf bank_mask:0xf bound_ctrl:0
    v_add_u32_dpp v125, v125, v125 row_shr:8 row_mask:0xf bank_mask:0xf bound_ctrl:0
    s_nop 0
    v_add_u32_dpp v124, v124, v124 row_bcast:15 row_mask:0xa bank_mask:0xf
    v_add_u32_dpp v125, v125, v125 row_bcast:15 row_mask:0xa bank_mask:0xf
    s_nop 0
    v_add_u32_dpp v124, v124, v124 row_bcast:31 row_mask:0xc bank_mask:0xf
    v_add_u32_dpp v125, v125, v125 row_bcast:31 row_mask:0xc bank_mask:0xf
    s_nop 0
    s_nop 0
    v_mov_b32 v127, s54
    v_and_b32 v118, 0xffff, v124
    v_lshrrev_b32 v119, 16, v124
    v_and_b32 v120, 0xffff, v125
    v_lshrrev_b32 v121, 16, v125
    s_mov_b64 exec, 1
    s_lshl_b64 exec, exec, 63
    ds_write_b128 v127, v[118:121] offset:10240
    s_mov_b64 exec, -1
p1_s1_skip:
    s_waitcnt lgkmcnt(0)
    s_barrier
    v_and_b32 v127, 63, v0
    v_lshlrev_b32 v118, 2, v127
    v_cmp_gt_u32 vcc, 40, v127
    ds_read_b32 v119, v118 offset:10240
    s_waitcnt lgkmcnt(0)
    v_cndmask_b32 v119, 0, v119, vcc
    v_mov_b32 v120, v119
    s_nop 1
    v_add_u32_dpp v120, v120, v120 row_shr:1 row_mask:0xf bank_mask:0xf bound_ctrl:0
    s_nop 1
    v_add_u32_dpp v120, v120, v120 row_shr:2 row_mask:0xf bank_mask:0xf bound_ctrl:0
    s_nop 1
    v_add_u32_dpp v120, v120, v120 row_shr:4 row_mask:0xf bank_mask:0xf bound_ctrl:0
    s_nop 1
    v_add_u32_dpp v120, v120, v120 row_shr:8 row_mask:0xf bank_mask:0xf bound_ctrl:0
    s_nop 1
    v_add_u32_dpp v120, v120, v120 row_bcast:15 row_mask:0xa bank_mask:0xf
    s_nop 1
    v_add_u32_dpp v120, v120, v120 row_bcast:31 row_mask:0xc bank_mask:0xf
    s_nop 1
    s_nop 0
    v_sub_u32 v119, v120, v119
    v_readlane_b32 s35, v120, 63
    s_add_u32 s51, s68, s29
    s_cmp_ge_u32 s28, 10
    s_cbranch_scc1 p1_s2_skip
    s_lshl_b32 s54, s28, 2
    s_add_u32 s55, s54, 0
    v_readlane_b32 s56, v119, s55
    s_add_u32 s55, s54, 1
    v_readlane_b32 s57, v119, s55
    s_add_u32 s55, s54, 2
    v_readlane_b32 s58, v119, s55
    s_add_u32 s55, s54, 3
    v_readlane_b32 s59, v119, s55
    s_nop 0
    s_lshl_b32 s57, s57, 16
    s_or_b32 s56, s56, s57
    s_lshl_b32 s59, s59, 16
    s_or_b32 s58, s58, s59
    v_add_u32 v124, s56, v124
    v_add_u32 v125, s58, v125
    v_sub_u32 v122, v124, v122
    v_sub_u32 v123, v125, v123
    v_and_b32 v118, 0xffff, v122
    v_lshrrev_b32 v119, 16, v122
    v_and_b32 v120, 0xffff, v123
    v_lshrrev_b32 v121, 16, v123
    v_mul_u32_u24 v118, 3, v118
    v_mul_u32_u24 v119, 3, v119
    v_mul_u32_u24 v120, 3, v120
    v_mul_u32_u24 v121, 3, v121
    ds_write_b128 v117, v[118:121] offset:0
    s_mul_i32 s55, s51, 5248
    s_mul_i32 s56, s28, 520
    s_add_u32 s55, s55, s56
    s_add_u32 s55, s55, 335544320
    v_lshlrev_b32 v127, 3, v126
    s_cmp_eq_u32 s29, 7
    s_cbranch_scc1 p1_s2_last
    buffer_store_dwordx2 v[122:123], v127, s[16:19], s55 offen
    s_mov_b64 exec, 1
    s_lshl_b64 exec, exec, 63
    buffer_store_dwordx2 v[124:125], v127, s[16:19], s55 offen offset:8
    s_mov_b64 exec, -1
    s_branch p1_s2_skip
p1_s2_last:
    v_mov_b32 v32, v122
    v_mov_b32 v33, v123
    v_mov_b32 v34, v124
    v_mov_b32 v35, v125
    s_sub_u32 s55, s55, 5248
    buffer_load_dwordx4 v[28:31], v127, s[16:19], s55 offen sc1
    s_sub_u32 s55, s55, 5248
    buffer_load_dwordx4 v[24:27], v127, s[16:19], s55 offen sc1
    s_sub_u32 s55, s55, 5248
    buffer_load_dwordx4 v[20:23], v127, s[16:19], s55 offen sc1
    s_sub_u32 s55, s55, 5248
    buffer_load_dwordx4 v[16:19], v127, s[16:19], s55 offen sc1
    s_sub_u32 s55, s55, 5248
    buffer_load_dwordx4 v[12:15], v127, s[16:19], s55 offen sc1
    s_sub_u32 s55, s55, 5248
    buffer_load_dwordx4 v[8:11], v127, s[16:19], s55 offen sc1
    s_sub_u32 s55, s55, 5248
    buffer_load_dwordx4 v[4:7], v127, s[16:19], s55 offen sc1
p1_s2_skip:
    s_lshr_b32 s52, s29, 0
    s_lshl_b32 s52, s52, 8
    s_lshr_b32 s53, s68, 3
    s_add_u32 s52, s52, s53
    s_and_b32 s53, s29, 0
    s_add_u32 s52, s52, s53
    s_mul_i32 s52, s52, 16384
    s_add_u32 s20, s48, s52
    s_addc_u32 s21, s49, 0
    s_and_b32 s21, s21, 0xffff
    s_lshr_b32 s52, s35, 10
    s_mul_i32 s52, s52, 33554432
    s_and_b32 s53, s35, 1023
    s_lshl_b32 s53, s53, 4
    s_add_u32 s22, s52, s53
    s_waitcnt lgkmcnt(0)
    s_barrier
    v_and_b32 v117, 0xffff, v92
    ds_add_rtn_u32 v117, v117, v3 offset:0
    v_and_b32 v118, 0xffff, v93
    ds_add_rtn_u32 v118, v118, v3 offset:0
    v_and_b32 v119, 0xffff, v94
    ds_add_rtn_u32 v119, v119, v3 offset:0
    v_and_b32 v120, 0xffff, v95
    ds_add_rtn_u32 v120, v120, v3 offset:0
    s_cmp_eq_u32 s29, 7
    s_cbranch_scc1 p1_nl2
    s_add_u32 s32, s30, 32768
    buffer_load_dwordx4 v[12:15], v1, s[4:7], s32 offen nt
    buffer_load_dwordx4 v[36:39], v1, s[8:11], s32 offen nt
    s_add_u32 s32, s31, 16384
    buffer_load_dwordx2 v[56:57], v2, s[12:15], s32 offen nt
p1_nl2:
    v_and_b32 v121, 0xffff, v96
    ds_add_rtn_u32 v121, v121, v3 offset:0
    v_and_b32 v122, 0xffff, v97
    ds_add_rtn_u32 v122, v122, v3 offset:0
    v_and_b32 v123, 0xffff, v98
    ds_add_rtn_u32 v123, v123, v3 offset:0
    v_and_b32 v124, 0xffff, v99
    ds_add_rtn_u32 v124, v124, v3 offset:0
    s_waitcnt lgkmcnt(4)
    ds_write_b8_d16_hi v117, v92 offset:10496
    v_lshlrev_b32 v117, 2, v117
    ds_write_b32 v117, v67 offset:40704
    ds_write_b8_d16_hi v118, v93 offset:10496
    v_lshlrev_b32 v118, 2, v118
    ds_write_b32 v118, v68 offset:40704
    ds_write_b8_d16_hi v119, v94 offset:10496
    v_lshlrev_b32 v119, 2, v119
    ds_write_b32 v119, v69 offset:40704
    ds_write_b8_d16_hi v120, v95 offset:10496
    v_lshlrev_b32 v120, 2, v120
    ds_write_b32 v120, v70 offset:40704
    s_cmp_eq_u32 s29, 7
    s_cbranch_scc1 p1_nl3
    s_add_u32 s32, s30, 49152
    buffer_load_dwordx4 v[16:19], v1, s[4:7], s32 offen nt
    buffer_load_dwordx4 v[40:43], v1, s[8:11], s32 offen nt
    s_add_u32 s32, s31, 24576
    buffer_load_dwordx2 v[58:59], v2, s[12:15], s32 offen nt
p1_nl3:
    v_and_b32 v117, 0xffff, v100
    ds_add_rtn_u32 v117, v117, v3 offset:0
    v_and_b32 v118, 0xffff, v101
    ds_add_rtn_u32 v118, v118, v3 offset:0
    v_and_b32 v119, 0xffff, v102
    ds_add_rtn_u32 v119, v119, v3 offset:0
    v_and_b32 v120, 0xffff, v103
    ds_add_rtn_u32 v120, v120, v3 offset:0
    s_waitcnt lgkmcnt(4)
    ds_write_b8_d16_hi v121, v96 offset:10496
    v_lshlrev_b32 v121, 2, v121
    ds_write_b32 v121, v71 offset:40704
    ds_write_b8_d16_hi v122, v97 offset:10496
    v_lshlrev_b32 v122, 2, v122
    ds_write_b32 v122, v72 offset:40704
    ds_write_b8_d16_hi v123, v98 offset:10496
    v_lshlrev_b32 v123, 2, v123
    ds_write_b32 v123, v73 offset:40704
    ds_write_b8_d16_hi v124, v99 offset:10496
    v_lshlrev_b32 v124, 2, v124
    ds_write_b32 v124, v74 offset:40704
    s_cmp_eq_u32 s29, 7
    s_cbranch_scc1 p1_nl4
    s_add_u32 s32, s30, 65536
    buffer_load_dwordx4 v[20:23], v1, s[4:7], s32 offen nt
    buffer_load_dwordx4 v[44:47], v1, s[8:11], s32 offen nt
    s_add_u32 s32, s31, 32768
    buffer_load_dwordx2 v[60:61], v2, s[12:15], s32 offen nt
p1_nl4:
    v_and_b32 v121, 0xffff, v104
    ds_add_rtn_u32 v121, v121, v3 offset:0
    v_and_b32 v122, 0xffff, v105
    ds_add_rtn_u32 v122, v122, v3 offset:0
    v_and_b32 v123, 0xffff, v106
    ds_add_rtn_u32 v123, v123, v3 offset:0
    v_and_b32 v124, 0xffff, v107
    ds_add_rtn_u32 v124, v124, v3 offset:0
    s_waitcnt lgkmcnt(4)
    ds_write_b8_d16_hi v117, v100 offset:10496
    v_lshlrev_b32 v117, 2, v117
    ds_write_b32 v117, v75 offset:40704
    ds_write_b8_d16_hi v118, v101 offset:10496
    v_lshlrev_b32 v118, 2, v118
    ds_write_b32 v118, v76 offset:40704
    ds_write_b8_d16_hi v119, v102 offset:10496
    v_lshlrev_b32 v119, 2, v119
    ds_write_b32 v119, v77 offset:40704
    ds_write_b8_d16_hi v120, v103 offset:10496
    v_lshlrev_b32 v120, 2, v120
    ds_write_b32 v120, v78 offset:40704
    s_cmp_eq_u32 s29, 7
    s_cbranch_scc1 p1_nl5
    s_add_u32 s32, s30, 81920
    buffer_load_dwordx4 v[24:27], v1, s[4:7], s32 offen nt
    buffer_load_dwordx4 v[48:51], v1, s[8:11], s32 offen nt
    s_add_u32 s32, s31, 40960
    buffer_load_dwordx2 v[62:63], v2, s[12:15], s32 offen nt
p1_nl5:
    v_and_b32 v117, 0xffff, v108
    ds_add_rtn_u32 v117, v117, v3 offset:0
    v_and_b32 v118, 0xffff, v109
    ds_add_rtn_u32 v118, v118, v3 offset:0
    v_and_b32 v119, 0xffff, v110
    ds_add_rtn_u32 v119, v119, v3 offset:0
    v_and_b32 v120, 0xffff, v111
    ds_add_rtn_u32 v120, v120, v3 offset:0
    s_waitcnt lgkmcnt(4)
    ds_write_b8_d16_hi v121, v104 offset:10496
    v_lshlrev_b32 v121, 2, v121
    ds_write_b32 v121, v79 offset:40704
    ds_write_b8_d16_hi v122, v105 offset:10496
    v_lshlrev_b32 v122, 2, v122
    ds_write_b32 v122, v80 offset:40704
    ds_write_b8_d16_hi v123, v106 offset:10496
    v_lshlrev_b32 v123, 2, v123
    ds_write_b32 v123, v81 offset:40704
    ds_write_b8_d16_hi v124, v107 offset:10496
    v_lshlrev_b32 v124, 2, v124
    ds_write_b32 v124, v82 offset:40704
    s_cmp_eq_u32 s29, 7
    s_cbranch_scc1 p1_nl6
    s_cmp_lt_u32 s28, s34
    s_cselect_b32 s46, 0, 0x40000000
    v_lshl_add_u32 v126, v0, 2, s46
    s_add_u32 s32, s30, 98304
    buffer_load_dword v64, v126, s[4:7], s32 offen nt
    buffer_load_dword v65, v126, s[8:11], s32 offen nt
    v_lshrrev_b32 v126, 1, v126
    s_add_u32 s32, s31, 49152
    buffer_load_ushort v66, v126, s[12:15], s32 offen nt
p1_nl6:
    v_and_b32 v121, 0xffff, v112
    ds_add_rtn_u32 v121, v121, v3 offset:0
    v_and_b32 v122, 0xffff, v113
    ds_add_rtn_u32 v122, v122, v3 offset:0
    v_and_b32 v123, 0xffff, v114
    ds_add_rtn_u32 v123, v123, v3 offset:0
    v_and_b32 v124, 0xffff, v115
    ds_add_rtn_u32 v124, v124, v3 offset:0
    s_waitcnt lgkmcnt(4)
    ds_write_b8_d16_hi v117, v108 offset:10496
    v_lshlrev_b32 v117, 2, v117
    ds_write_b32 v117, v83 offset:40704
    ds_write_b8_d16_hi v118, v109 offset:10496
    v_lshlrev_b32 v118, 2, v118
    ds_write_b32 v118, v84 offset:40704
    ds_write_b8_d16_hi v119, v110 offset:10496
    v_lshlrev_b32 v119, 2, v119
    ds_write_b32 v119, v85 offset:40704
    ds_write_b8_d16_hi v120, v111 offset:10496
    v_lshlrev_b32 v120, 2, v120
    ds_write_b32 v120, v86 offset:40704
    s_waitcnt lgkmcnt(0)
    ds_write_b8_d16_hi v121, v112 offset:10496
    v_lshlrev_b32 v121, 2, v121
    ds_write_b32 v121, v87 offset:40704
    ds_write_b8_d16_hi v122, v113 offset:10496
    v_lshlrev_b32 v122, 2, v122
    ds_write_b32 v122, v88 offset:40704
    ds_write_b8_d16_hi v123, v114 offset:10496
    v_lshlrev_b32 v123, 2, v123
    ds_write_b32 v123, v89 offset:40704
    ds_write_b8_d16_hi v124, v115 offset:10496
    v_lshlrev_b32 v124, 2, v124
    ds_write_b32 v124, v90 offset:40704
    s_cmp_ge_u32 s28, s33
    s_cbranch_scc1 p1_p_done
    v_and_b32 v125, 0xffff, v116
    ds_add_rtn_u32 v125, v125, v3 offset:0
    s_waitcnt lgkmcnt(0)
    ds_write_b8_d16_hi v125, v116 offset:10496
    v_lshlrev_b32 v125, 2, v125
    ds_write_b32 v125, v91 offset:40704
p1_p_done:
    s_cmp_lg_u32 s29, 7
    s_cbranch_scc1 p1_tr_done
    s_cmp_ge_u32 s28, 10
    s_cbranch_scc1 p1_tr_done
    s_mul_i32 s53, s28, 1064960
    s_lshl_b32 s54, s68, 3
    s_add_u32 s53, s53, s54
    s_add_u32 s53, s53, 346292224
    s_mov_b32 s54, 0x05040100
    s_mov_b32 s55, 0x07060302
    v_and_b32 v52, 63, v0
    v_lshlrev_b32 v52, 14, v52
    s_waitcnt vmcnt(0)
    v_perm_b32 v36, v8, v4, s54
    v_perm_b32 v37, v16, v12, s54
    v_perm_b32 v38, v24, v20, s54
    v_perm_b32 v39, v32, v28, s54
    v_perm_b32 v40, v8, v4, s55
    v_perm_b32 v41, v16, v12, s55
    v_perm_b32 v42, v24, v20, s55
    v_perm_b32 v43, v32, v28, s55
    v_perm_b32 v44, v9, v5, s54
    v_perm_b32 v45, v17, v13, s54
    v_perm_b32 v46, v25, v21, s54
    v_perm_b32 v47, v33, v29, s54
    v_perm_b32 v48, v9, v5, s55
    v_perm_b32 v49, v17, v13, s55
    v_perm_b32 v50, v25, v21, s55
    v_perm_b32 v51, v33, v29, s55
    buffer_store_dwordx4 v[36:39], v52, s[16:19], s53 offen offset:0
    buffer_store_dwordx4 v[40:43], v52, s[16:19], s53 offen offset:16
    buffer_store_dwordx4 v[44:47], v52, s[16:19], s53 offen offset:32
    buffer_store_dwordx4 v[48:51], v52, s[16:19], s53 offen offset:48
    s_add_u32 s53, s53, 16384
    s_mov_b64 exec, 1
    s_lshl_b64 exec, exec, 63
    v_perm_b32 v36, v10, v6, s54
    v_perm_b32 v37, v18, v14, s54
    v_perm_b32 v38, v26, v22, s54
    v_perm_b32 v39, v34, v30, s54
    v_perm_b32 v40, v10, v6, s55
    v_perm_b32 v41, v18, v14, s55
    v_perm_b32 v42, v26, v22, s55
    v_perm_b32 v43, v34, v30, s55
    v_perm_b32 v44, v11, v7, s54
    v_perm_b32 v45, v19, v15, s54
    v_perm_b32 v46, v27, v23, s54
    v_perm_b32 v47, v35, v31, s54
    v_perm_b32 v48, v11, v7, s55
    v_perm_b32 v49, v19, v15, s55
    v_perm_b32 v50, v27, v23, s55
    v_perm_b32 v51, v35, v31, s55
    buffer_store_dwordx4 v[36:39], v52, s[16:19], s53 offen offset:0
    buffer_store_dwordx4 v[40:43], v52, s[16:19], s53 offen offset:16
    buffer_store_dwordx4 v[44:47], v52, s[16:19], s53 offen offset:32
    buffer_store_dwordx4 v[48:51], v52, s[16:19], s53 offen offset:48
    s_mov_b64 exec, -1
p1_tr_done:
    s_waitcnt lgkmcnt(0)
    s_barrier
    v_mul_u32_u24 v119, 3, v0
    v_lshlrev_b32 v117, 2, v119
    v_add_u32 v117, 40704, v117
    v_and_b32 v118, -4, v119
    v_mov_b32 v120, v1
    v_mov_b32 v122, 0
    v_mov_b32 v123, 0
    v_mov_b32 v124, 0
    v_mov_b32 v125, 0
    v_cmp_gt_u32 vcc, 640, v0
    s_and_saveexec_b64 s[52:53], vcc
    ds_write_b128 v1, v[122:125] offset:0
    s_mov_b64 exec, -1
    ds_read_b32 v68, v117 offset:0
    ds_read_b32 v69, v117 offset:4
    ds_read_b32 v70, v117 offset:8
    ds_read_b32 v71, v118 offset:10496
    ds_read_b32 v72, v118 offset:10500
    ds_read_b32 v74, v117 offset:12288
    ds_read_b32 v75, v117 offset:12292
    ds_read_b32 v76, v117 offset:12296
    ds_read_b32 v77, v118 offset:13568
    ds_read_b32 v78, v118 offset:13572
    s_waitcnt lgkmcnt(5)
    ds_read_b32 v80, v117 offset:24576
    ds_read_b32 v81, v117 offset:24580
    ds_read_b32 v82, v117 offset:24584
    ds_read_b32 v83, v118 offset:16640
    ds_read_b32 v84, v118 offset:16644
    v_alignbyte_b32 v71, v72, v71, v119
    buffer_store_dwordx4 v[68:71], v120, s[20:23], 0 offen
    v_add_u32 v120, 33554432, v120
    s_waitcnt lgkmcnt(5)
    ds_read_b32 v86, v117 offset:36864
    ds_read_b32 v87, v117 offset:36868
    ds_read_b32 v88, v117 offset:36872
    ds_read_b32 v89, v118 offset:19712
    ds_read_b32 v90, v118 offset:19716
    v_alignbyte_b32 v77, v78, v77, v119
    buffer_store_dwordx4 v[74:77], v120, s[20:23], 0 offen
    v_add_u32 v120, 33554432, v120
    s_waitcnt lgkmcnt(5)
    ds_read_b32 v92, v117 offset:49152
    ds_read_b32 v93, v117 offset:49156
    ds_read_b32 v94, v117 offset:49160
    ds_read_b32 v95, v118 offset:22784
    ds_read_b32 v96, v118 offset:22788
    v_alignbyte_b32 v83, v84, v83, v119
    buffer_store_dwordx4 v[80:83], v120, s[20:23], 0 offen
    v_add_u32 v120, 33554432, v120
    s_waitcnt lgkmcnt(5)
    v_add_u32 v117, 61440, v117
    ds_read_b32 v98, v117 offset:0
    ds_read_b32 v99, v117 offset:4
    ds_read_b32 v100, v117 offset:8
    ds_read_b32 v101, v118 offset:25856
    ds_read_b32 v102, v118 offset:25860
    v_alignbyte_b32 v89, v90, v89, v119
    buffer_store_dwordx4 v[86:89], v120, s[20:23], 0 offen
    v_add_u32 v120, 33554432, v120
    s_waitcnt lgkmcnt(5)
    ds_read_b32 v104, v117 offset:12288
    ds_read_b32 v105, v117 offset:12292
    ds_read_b32 v106, v117 offset:12296
    ds_read_b32 v107, v118 offset:28928
    ds_read_b32 v108, v118 offset:28932
    v_alignbyte_b32 v95, v96, v95, v119
    buffer_store_dwordx4 v[92:95], v120, s[20:23], 0 offen
    v_add_u32 v120, 33554432, v120
    s_waitcnt lgkmcnt(5)
    ds_read_b32 v110, v117 offset:24576
    ds_read_b32 v111, v117 offset:24580
    ds_read_b32 v112, v117 offset:24584
    ds_read_b32 v113, v118 offset:32000
    ds_read_b32 v114, v118 offset:32004
    v_alignbyte_b32 v101, v102, v101, v119
    buffer_store_dwordx4 v[98:101], v120, s[20:23], 0 offen
    v_add_u32 v120, 33554432, v120
    s_waitcnt lgkmcnt(5)
    ds_read_b32 v68, v117 offset:36864
    ds_read_b32 v69, v117 offset:36868
    ds_read_b32 v70, v117 offset:36872
    ds_read_b32 v71, v118 offset:35072
    ds_read_b32 v72, v118 offset:35076
    v_alignbyte_b32 v107, v108, v107, v119
    buffer_store_dwordx4 v[104:107], v120, s[20:23], 0 offen nt
    v_add_u32 v120, 33554432, v120
    s_waitcnt lgkmcnt(5)
    ds_read_b32 v74, v117 offset:49152
    ds_read_b32 v75, v117 offset:49156
    ds_read_b32 v76, v117 offset:49160
    ds_read_b32 v77, v118 offset:38144
    ds_read_b32 v78, v118 offset:38148
    v_alignbyte_b32 v113, v114, v113, v119
    buffer_store_dwordx4 v[110:113], v120, s[20:23], 0 offen nt
    v_add_u32 v120, 33554432, v120
    s_waitcnt lgkmcnt(5)
    v_alignbyte_b32 v71, v72, v71, v119
    buffer_store_dwordx4 v[68:71], v120, s[20:23], 0 offen nt
    v_add_u32 v120, 33554432, v120
    s_waitcnt lgkmcnt(0)
    v_alignbyte_b32 v77, v78, v77, v119
    buffer_store_dwordx4 v[74:77], v120, s[20:23], 0 offen nt
    s_barrier
    s_add_u32 s29, s29, 1
    s_cmp_lt_u32 s29, 8
    s_cbranch_scc1 p1_tile
p1_end:
    s_endpgm
.globl p2_kernel
.p2align 8
.type p2_kernel,@function
p2_kernel:
    s_cmp_ge_u32 s2, 256
    s_cbranch_scc1 p2_end
    s_load_dwordx2 s[8:9], s[0:1], 104
    v_and_b32 v112, 63, v0
    v_lshrrev_b32 v122, 6, v0
    v_lshlrev_b32 v123, 5, v0
    v_lshlrev_b32 v112, 4, v112
    v_readfirstlane_b32 s10, v122
    v_mov_b32 v113, 0x83ff0000
    s_and_b32 s44, s2, 7
    s_lshr_b32 s11, s44, 1
    s_and_b32 s44, s44, 1
    s_lshl_b32 s12, s44, 5
    s_lshr_b32 s44, s2, 3
    s_add_u32 s12, s12, s44
    s_mov_b32 s25, 54272
    s_mov_b32 s31, 67175170
    s_mov_b32 s32, 83952386
    s_mov_b32 s33, 100729602
    s_mov_b32 s21, 0
    s_mul_i32 s23, s10, 3072
    s_lshl_b32 s24, s10, 9
    s_lshl_b32 s64, s10, 10
    s_sub_u32 s42, s24, s23
    s_add_u32 s42, s42, 49152
    s_lshl_b32 s41, s10, 22
    s_mov_b32 s63, 16384
    s_movk_i32 s65, 0x7800
    s_mul_i32 s62, s11, 161280
    s_add_u32 s62, s62, 356941824
    s_add_u32 s62, s62, s23
    s_mul_i32 s40, s12, 16384
    s_add_u32 s40, s40, 346292224
    s_add_u32 s40, s40, s64
    s_lshl_b32 s44, s11, 4
    s_add_u32 s40, s40, s44
    s_waitcnt lgkmcnt(0)
    s_mov_b32 s4, s8
    s_and_b32 s5, s9, 0xffff
    s_mov_b32 s6, 819200000
    s_mov_b32 s7, 0x20000
    s_mov_b32 s68, s8
    s_and_b32 s69, s9, 0xffff
    s_mov_b32 s70, 335544320
    s_mov_b32 s71, 0x20000
    s_mov_b32 s44, 363393024
    buffer_load_dwordx4 v[60:63], v123, s[4:7], s44 offen
    buffer_load_dwordx4 v[64:67], v123, s[4:7], s44 offen offset:16
p2_restart:
    s_mov_b32 s61, 0
    s_mul_i32 s44, s61, 1064960
    s_add_u32 s44, s44, s40
    v_bfe_u32 v110, v112, 4, 2
    v_mad_i32_i24 v111, v110, -12, v112
    buffer_load_dword v110, v111, s[4:7], s44 offen
    s_add_u32 s44, s44, 16384
    buffer_load_dword v111, v111, s[4:7], s44 offen
    s_mul_i32 s20, s61, 645120
    s_add_u32 s20, s20, s62
    s_cmp_ge_u32 s10, 9
    s_cbranch_scc1 p2_nmp
    v_lshrrev_b32 v84, 1, v112
    s_add_u32 s44, s20, s42
    buffer_load_dwordx2 v[84:85], v84, s[4:7], s44 offen
p2_nmp:
    buffer_load_dwordx4 v[72:75], v112, s[4:7], s20 offen offset:0
    buffer_load_dwordx4 v[76:79], v112, s[4:7], s20 offen offset:1024
    buffer_load_dwordx4 v[80:83], v112, s[4:7], s20 offen offset:2048
    s_barrier
    v_mov_b32 v115, 0
    v_mov_b32 v116, 0
    v_mov_b32 v117, 0
    v_mov_b32 v118, 0
    v_mov_b32 v119, 0
    v_mov_b32 v120, 0
    v_mov_b32 v121, 0
    ds_write_b128 v115, v[116:119] offset:53760
    s_cmp_eq_u32 s21, 0
    s_cselect_b32 s44, 1073758208, 0
    v_mov_b32 v124, s44
    v_mov_b32 v125, s44
    v_mov_b32 v126, s44
    v_mov_b32 v127, s44
    v_add_u32 v123, s64, v112
    v_add_u32 v122, s25, v123
    ds_write_b128 v122, v[124:127] offset:0
    ds_write_b128 v122, v[124:127] offset:16384
    ds_write_b128 v122, v[124:127] offset:32768
    v_add_u32 v122, 49152, v122
    ds_write_b128 v122, v[124:127] offset:0
    ds_write_b128 v122, v[124:127] offset:16384
    ds_write_b128 v122, v[124:127] offset:32768
    v_cmpx_gt_u32 vcc, 1792, v123
    ds_write_b128 v122, v[124:127] offset:49152
    s_mov_b64 exec, -1
    s_mov_b32 s19, 0
    s_cmp_eq_u32 s21, 2
    s_cselect_b64 s[66:67], -1, 0
    s_waitcnt vmcnt(3) lgkmcnt(0)
    s_barrier
    s_mov_b32 m0, s23
    v_mov_b32 v53, 0x3c000
    s_movk_i32 s44, 512
    v_sub_u32_sdwa v4, v111, v110 dst_sel:DWORD dst_unused:UNUSED_PAD src0_sel:WORD_0 src1_sel:WORD_0
    v_sub_u32_sdwa v5, v111, v110 dst_sel:DWORD dst_unused:UNUSED_PAD src0_sel:WORD_1 src1_sel:WORD_1
    v_med3_i32 v4, v4, 0, s44
    v_med3_i32 v5, v5, 0, s44
    v_add_u32 v48, v4, v5
    ds_write_addtid_b32 v53 offset:0
    ds_write_addtid_b32 v53 offset:256
    ds_write_addtid_b32 v53 offset:512
    ds_write_addtid_b32 v53 offset:768
    ds_write_addtid_b32 v53 offset:1024
    ds_write_addtid_b32 v53 offset:1280
    ds_write_addtid_b32 v53 offset:1536
    ds_write_addtid_b32 v53 offset:1792
    v_and_b32 v49, 0x30, v112
    v_lshrrev_b32 v53, 6, v112
    v_lshl_or_b32 v53, v49, 5, v53
    v_lshl_add_u32 v53, v53, 18, s41
    s_nop 1
    v_add_u32_dpp v48, v48, v48 row_shr:1 row_mask:0xf bank_mask:0xf bound_ctrl:0
    s_nop 1
    v_add_u32_dpp v48, v48, v48 row_shr:2 row_mask:0xf bank_mask:0xf bound_ctrl:0
    s_nop 1
    v_add_u32_dpp v48, v48, v48 row_shr:4 row_mask:0xf bank_mask:0xf bound_ctrl:0
    s_nop 1
    v_add_u32_dpp v48, v48, v48 row_shr:8 row_mask:0xf bank_mask:0xf bound_ctrl:0
    s_nop 1
    v_add_u32_dpp v48, v48, v48 row_bcast:15 row_mask:0xa bank_mask:0xf
    s_nop 1
    v_add_u32_dpp v48, v48, v48 row_bcast:31 row_mask:0xc bank_mask:0xf
    s_nop 1
    s_nop 0
    v_readlane_b32 s38, v48, 63
    v_sub_u32 v50, v48, v5
    v_sub_u32 v49, v50, v4
    v_sub_u32 v10, 512, v49
    v_mad_u32_u16 v51, v110, 16, v53
    v_med3_i32 v10, v10, 0, v4
    v_lshl_add_u32 v49, v49, 2, s23
    v_sub_u32 v11, 512, v50
    v_mad_u32_u16 v52, v110, 16, v53 op_sel:[1,0,0,0]
    v_med3_i32 v11, v11, 0, v5
    v_lshl_add_u32 v50, v50, 2, s23
    v_lshl_add_u32 v48, v11, 16, v10
    v_add_u32 v52, 67108864, v52
    v_add_u32 v110, v110, v48
    s_min_u32 s17, s38, 512
    s_add_u32 s17, s17, 63
    s_lshr_b32 s17, s17, 6
p2_xa_0:
    v_cmpx_lt_i32 vcc, 0, v10
    s_cbranch_execz p2_ya_0
    ds_write_b32 v49, v51 offset:0
    v_add_u32 v51, 16, v51
    v_cmpx_lt_i32 vcc, 1, v10
    s_cbranch_execz p2_ya_0
    ds_write_b32 v49, v51 offset:4
    v_add_u32 v51, 16, v51
    v_cmpx_lt_i32 vcc, 2, v10
    s_cbranch_execz p2_ya_0
    ds_write_b32 v49, v51 offset:8
    v_add_u32 v51, 16, v51
    v_cmpx_lt_i32 vcc, 3, v10
    s_cbranch_execz p2_ya_0
    ds_write_b32 v49, v51 offset:12
    v_add_u32 v51, 16, v51
    v_cmpx_lt_i32 vcc, 4, v10
    s_cbranch_execz p2_ya_0
    ds_write_b32 v49, v51 offset:16
    v_add_u32 v51, 16, v51
    v_cmpx_lt_i32 vcc, 5, v10
    s_cbranch_execz p2_ya_0
    ds_write_b32 v49, v51 offset:20
    v_add_u32 v51, 16, v51
    v_cmpx_lt_i32 vcc, 6, v10
    s_cbranch_execz p2_ya_0
    ds_write_b32 v49, v51 offset:24
    v_add_u32 v51, 16, v51
    v_cmpx_lt_i32 vcc, 7, v10
    s_cbranch_execz p2_ya_0
    ds_write_b32 v49, v51 offset:28
    v_add_u32 v51, 16, v51
    v_subrev_u32 v10, 8, v10
    v_add_u32 v49, 32, v49
    s_branch p2_xa_0
p2_ya_0:
    s_mov_b64 exec, -1
p2_xa_1:
    v_cmpx_lt_i32 vcc, 0, v11
    s_cbranch_execz p2_ya_1
    ds_write_b32 v50, v52 offset:0
    v_add_u32 v52, 16, v52
    v_cmpx_lt_i32 vcc, 1, v11
    s_cbranch_execz p2_ya_1
    ds_write_b32 v50, v52 offset:4
    v_add_u32 v52, 16, v52
    v_cmpx_lt_i32 vcc, 2, v11
    s_cbranch_execz p2_ya_1
    ds_write_b32 v50, v52 offset:8
    v_add_u32 v52, 16, v52
    v_cmpx_lt_i32 vcc, 3, v11
    s_cbranch_execz p2_ya_1
    ds_write_b32 v50, v52 offset:12
    v_add_u32 v52, 16, v52
    v_cmpx_lt_i32 vcc, 4, v11
    s_cbranch_execz p2_ya_1
    ds_write_b32 v50, v52 offset:16
    v_add_u32 v52, 16, v52
    v_cmpx_lt_i32 vcc, 5, v11
    s_cbranch_execz p2_ya_1
    ds_write_b32 v50, v52 offset:20
    v_add_u32 v52, 16, v52
    v_cmpx_lt_i32 vcc, 6, v11
    s_cbranch_execz p2_ya_1
    ds_write_b32 v50, v52 offset:24
    v_add_u32 v52, 16, v52
    v_cmpx_lt_i32 vcc, 7, v11
    s_cbranch_execz p2_ya_1
    ds_write_b32 v50, v52 offset:28
    v_add_u32 v52, 16, v52
    v_subrev_u32 v11, 8, v11
    v_add_u32 v50, 32, v50
    s_branch p2_xa_1
p2_ya_1:
    s_mov_b64 exec, -1
    s_cmp_lt_u32 s38, 512
    s_cbranch_scc1 p2_nomorea
    v_cmp_lt_u32_sdwa s[44:45], v110, v111 src0_sel:WORD_0 src1_sel:WORD_0
    v_cmp_lt_u32_sdwa s[46:47], v110, v111 src0_sel:WORD_1 src1_sel:WORD_1
    s_nop 0
    s_or_b64 s[44:45], s[44:45], s[46:47]
    s_cbranch_scc0 p2_nomorea
    v_mov_b32 v49, s19
    v_mov_b32 v50, 1
    ds_write_b32 v49, v50 offset:53760
p2_nomorea:
    s_mov_b32 m0, s23
    s_nop 0
    ds_read_addtid_b32 v102 offset:0
    ds_read_addtid_b32 v103 offset:256
    ds_read_addtid_b32 v104 offset:512
    ds_read_addtid_b32 v105 offset:768
    ds_read_addtid_b32 v106 offset:1024
    ds_read_addtid_b32 v107 offset:1280
    ds_read_addtid_b32 v108 offset:1536
    ds_read_addtid_b32 v109 offset:1792
    s_waitcnt lgkmcnt(0)
    s_cmp_lg_u32 s10, 0
    s_cbranch_scc1 p2_ntp
    s_lshr_b32 s44, s2, 3
    s_mul_i32 s44, s44, 5120
    s_mul_i32 s45, s61, 645120
    s_add_u32 s44, s44, s45
    s_add_u32 s44, s44, s62
    v_lshlrev_b32 v127, 3, v112
    s_mov_b32 exec_hi, 0xff
    buffer_load_dword v127, v127, s[4:7], s44 offen
    s_mov_b64 exec, -1
p2_ntp:
    v_lshrrev_b32 v0, 3, v102
    v_lshrrev_b32 v1, 18, v102
    v_and_b32 v102, 0x3fff, v102
    v_and_or_b32 v0, v0, s65, v1
    v_mad_u32_u24 v102, v0, s63, v102
    buffer_load_dwordx4 v[0:3], v102, s[68:71], 0 offen
    v_lshrrev_b32 v6, 3, v103
    v_lshrrev_b32 v7, 18, v103
    v_and_b32 v103, 0x3fff, v103
    v_and_or_b32 v6, v6, s65, v7
    v_mad_u32_u24 v103, v6, s63, v103
    buffer_load_dwordx4 v[6:9], v103, s[68:71], 0 offen
    v_lshrrev_b32 v12, 3, v104
    v_lshrrev_b32 v13, 18, v104
    v_and_b32 v104, 0x3fff, v104
    v_and_or_b32 v12, v12, s65, v13
    v_mad_u32_u24 v104, v12, s63, v104
    buffer_load_dwordx4 v[12:15], v104, s[68:71], 0 offen
    v_lshrrev_b32 v18, 3, v105
    v_lshrrev_b32 v19, 18, v105
    v_and_b32 v105, 0x3fff, v105
    v_and_or_b32 v18, v18, s65, v19
    v_mad_u32_u24 v105, v18, s63, v105
    buffer_load_dwordx4 v[18:21], v105, s[68:71], 0 offen
    v_lshrrev_b32 v86, 3, v106
    v_lshrrev_b32 v87, 18, v106
    v_and_b32 v106, 0x3fff, v106
    v_and_or_b32 v86, v86, s65, v87
    v_mad_u32_u24 v106, v86, s63, v106
    buffer_load_dwordx4 v[86:89], v106, s[68:71], 0 offen
    v_lshrrev_b32 v90, 3, v107
    v_lshrrev_b32 v91, 18, v107
    v_and_b32 v107, 0x3fff, v107
    v_and_or_b32 v90, v90, s65, v91
    v_mad_u32_u24 v107, v90, s63, v107
    buffer_load_dwordx4 v[90:93], v107, s[68:71], 0 offen
    v_lshrrev_b32 v94, 3, v108
    v_lshrrev_b32 v95, 18, v108
    v_and_b32 v108, 0x3fff, v108
    v_and_or_b32 v94, v94, s65, v95
    v_mad_u32_u24 v108, v94, s63, v108
    buffer_load_dwordx4 v[94:97], v108, s[68:71], 0 offen
    v_lshrrev_b32 v98, 3, v109
    v_lshrrev_b32 v99, 18, v109
    v_and_b32 v109, 0x3fff, v109
    v_and_or_b32 v98, v98, s65, v99
    v_mad_u32_u24 v109, v98, s63, v109
    buffer_load_dwordx4 v[98:101], v109, s[68:71], 0 offen
    s_mov_b32 s16, s17
    s_cmp_lg_u32 s21, 0
    s_cbranch_scc1 p2_nostat1
    v_max3_u32 v60, v60, v62, v64
    v_max_u32 v60, v60, v66
    v_add_f32 v61, v61, v63
    v_add_f32 v65, v65, v67
    v_add_f32 v61, v61, v65
    s_nop 1
    v_max_u32_dpp v60, v60, v60 row_shr:1 row_mask:0xf bank_mask:0xf bound_ctrl:0
    v_add_f32_dpp v61, v61, v61 row_shr:1 row_mask:0xf bank_mask:0xf bound_ctrl:0
    s_nop 0
    v_max_u32_dpp v60, v60, v60 row_shr:2 row_mask:0xf bank_mask:0xf bound_ctrl:0
    v_add_f32_dpp v61, v61, v61 row_shr:2 row_mask:0xf bank_mask:0xf bound_ctrl:0
    s_nop 0
    v_max_u32_dpp v60, v60, v60 row_shr:4 row_mask:0xf bank_mask:0xf bound_ctrl:0
    v_add_f32_dpp v61, v61, v61 row_shr:4 row_mask:0xf bank_mask:0xf bound_ctrl:0
    s_nop 0
    v_max_u32_dpp v60, v60, v60 row_shr:8 row_mask:0xf bank_mask:0xf bound_ctrl:0
    v_add_f32_dpp v61, v61, v61 row_shr:8 row_mask:0xf bank_mask:0xf bound_ctrl:0
    s_nop 0
    v_max_u32_dpp v60, v60, v60 row_bcast:15 row_mask:0xa bank_mask:0xf
    v_add_f32_dpp v61, v61, v61 row_bcast:15 row_mask:0xa bank_mask:0xf
    s_nop 0
    v_max_u32_dpp v60, v60, v60 row_bcast:31 row_mask:0xc bank_mask:0xf
    v_add_f32_dpp v61, v61, v61 row_bcast:31 row_mask:0xc bank_mask:0xf
    s_nop 0
    s_nop 0
    s_lshl_b32 s44, s10, 3
    v_mov_b32 v62, s44
    s_mov_b64 exec, 1
    s_lshl_b64 exec, exec, 63
    ds_write_b64 v62, v[60:61] offset:53824
    s_mov_b64 exec, -1
p2_nostat1:
    s_waitcnt lgkmcnt(0)
    s_barrier
    v_mov_b32 v122, s19
    s_xor_b32 s19, s19, 4
    ds_read_b32 v125, v122 offset:53760
    s_cmp_lg_u32 s21, 0
    s_cbranch_scc1 p2_nostat2
    v_bfe_u32 v62, v112, 1, 7
    ds_read_b64 v[60:61], v62 offset:53824
    s_waitcnt lgkmcnt(0)
    s_nop 1
    v_max_u32_dpp v60, v60, v60 row_shr:1 row_mask:0xf bank_mask:0xf bound_ctrl:0
    v_add_f32_dpp v61, v61, v61 row_shr:1 row_mask:0xf bank_mask:0xf bound_ctrl:0
    s_nop 0
    v_max_u32_dpp v60, v60, v60 row_shr:2 row_mask:0xf bank_mask:0xf bound_ctrl:0
    v_add_f32_dpp v61, v61, v61 row_shr:2 row_mask:0xf bank_mask:0xf bound_ctrl:0
    s_nop 0
    v_max_u32_dpp v60, v60, v60 row_shr:4 row_mask:0xf bank_mask:0xf bound_ctrl:0
    v_add_f32_dpp v61, v61, v61 row_shr:4 row_mask:0xf bank_mask:0xf bound_ctrl:0
    s_nop 0
    v_max_u32_dpp v60, v60, v60 row_shr:8 row_mask:0xf bank_mask:0xf bound_ctrl:0
    v_add_f32_dpp v61, v61, v61 row_shr:8 row_mask:0xf bank_mask:0xf bound_ctrl:0
    s_nop 0
    v_max_u32_dpp v60, v60, v60 row_bcast:15 row_mask:0xa bank_mask:0xf
    v_add_f32_dpp v61, v61, v61 row_bcast:15 row_mask:0xa bank_mask:0xf
    s_nop 0
    v_max_u32_dpp v60, v60, v60 row_bcast:31 row_mask:0xc bank_mask:0xf
    v_add_f32_dpp v61, v61, v61 row_bcast:31 row_mask:0xc bank_mask:0xf
    s_nop 0
    s_nop 0
    v_readlane_b32 s44, v60, 15
    v_readlane_b32 s45, v61, 15
    s_nop 1
    s_lshl_b32 s44, s44, 16
    s_lshr_b32 s46, s44, 23
    s_sub_u32 s47, s46, 80
    s_cmp_lt_u32 s47, 100
    s_cselect_b32 s21, 0, 1
    v_mov_b32 v60, s45
    v_mul_f32 v60, 0x34a7c5ac, v60
    v_sqrt_f32 v60, v60
    v_mov_b32 v61, s44
    v_mul_f32 v62, 0x41800000, v60
    v_cmp_nle_f32 vcc, v61, v62
    v_mul_f32 v60, 0x3ac00000, v60
    v_mul_f32 v61, 0x3901742e, v61
    v_max_f32 v60, v60, v61
    s_cmp_lg_u64 vcc, 0
    s_cselect_b32 s21, 1, s21
    v_readfirstlane_b32 s44, v60
    s_nop 0
    s_and_b32 s47, s44, 0x7fffff
    s_or_b32 s47, s47, 0x3f000000
    s_and_b32 s48, s44, 0x7f800000
    s_add_u32 s48, s48, 0x800000
    v_rcp_f32 v60, s47
    s_nop 0
    v_rcp_f32 v61, v60
    v_mul_f32 v60, 0x7b800000, v60
    v_mul_f32 v61, s48, v61
    s_nop 0
    v_readfirstlane_b32 s26, v60
    v_readfirstlane_b32 s30, v61
    s_add_u32 s34, s48, 197132288
    s_mov_b32 s35, s34
    s_sub_u32 s36, 0, s34
    s_subb_u32 s37, 0, s34
    s_cmp_eq_u32 s21, 0
    s_cbranch_scc1 p2_nostat2
    s_waitcnt vmcnt(0) lgkmcnt(0)
    s_branch p2_restart
p2_nostat2:
    s_cmp_eq_u32 s21, 0
    s_cselect_b32 s26, s26, 0x7b800000
    v_mov_b32 v114, s26
    s_waitcnt lgkmcnt(0)
    v_readfirstlane_b32 s44, v125
    s_nop 0
    s_cmp_lg_u32 s44, 0
    s_cbranch_scc1 p2_adva
    s_add_u32 s61, s61, 1
    s_min_u32 s61, s61, 10
    v_mov_b32 v110, 0
    v_mov_b32 v111, 0
    s_cmp_eq_u32 s61, 10
    s_cbranch_scc1 p2_adva
    s_mul_i32 s44, s61, 1064960
    s_add_u32 s44, s44, s40
    v_bfe_u32 v110, v112, 4, 2
    v_mad_i32_i24 v111, v110, -12, v112
    buffer_load_dword v110, v111, s[4:7], s44 offen
    s_add_u32 s44, s44, 16384
    buffer_load_dword v111, v111, s[4:7], s44 offen
p2_adva:
    s_waitcnt vmcnt(0)
    s_mov_b32 m0, s23
    v_mov_b32 v53, 0x3c000
    s_movk_i32 s44, 512
    v_sub_u32_sdwa v4, v111, v110 dst_sel:DWORD dst_unused:UNUSED_PAD src0_sel:WORD_0 src1_sel:WORD_0
    v_sub_u32_sdwa v5, v111, v110 dst_sel:DWORD dst_unused:UNUSED_PAD src0_sel:WORD_1 src1_sel:WORD_1
    v_med3_i32 v4, v4, 0, s44
    v_med3_i32 v5, v5, 0, s44
    v_add_u32 v48, v4, v5
    ds_write_addtid_b32 v53 offset:0
    ds_write_addtid_b32 v53 offset:256
    ds_write_addtid_b32 v53 offset:512
    ds_write_addtid_b32 v53 offset:768
    ds_write_addtid_b32 v53 offset:1024
    ds_write_addtid_b32 v53 offset:1280
    ds_write_addtid_b32 v53 offset:1536
    ds_write_addtid_b32 v53 offset:1792
    v_and_b32 v49, 0x30, v112
    v_lshrrev_b32 v53, 6, v112
    v_lshl_or_b32 v53, v49, 5, v53
    v_lshl_add_u32 v53, v53, 18, s41
    s_nop 1
    v_add_u32_dpp v48, v48, v48 row_shr:1 row_mask:0xf bank_mask:0xf bound_ctrl:0
    s_nop 1
    v_add_u32_dpp v48, v48, v48 row_shr:2 row_mask:0xf bank_mask:0xf bound_ctrl:0
    s_nop 1
    v_add_u32_dpp v48, v48, v48 row_shr:4 row_mask:0xf bank_mask:0xf bound_ctrl:0
    s_nop 1
    v_add_u32_dpp v48, v48, v48 row_shr:8 row_mask:0xf bank_mask:0xf bound_ctrl:0
    s_nop 1
    v_add_u32_dpp v48, v48, v48 row_bcast:15 row_mask:0xa bank_mask:0xf
    s_nop 1
    v_add_u32_dpp v48, v48, v48 row_bcast:31 row_mask:0xc bank_mask:0xf
    s_nop 1
    s_nop 0
    v_readlane_b32 s38, v48, 63
    v_sub_u32 v50, v48, v5
    v_sub_u32 v49, v50, v4
    v_sub_u32 v10, 512, v49
    v_mad_u32_u16 v51, v110, 16, v53
    v_med3_i32 v10, v10, 0, v4
    v_lshl_add_u32 v49, v49, 2, s23
    v_sub_u32 v11, 512, v50
    v_mad_u32_u16 v52, v110, 16, v53 op_sel:[1,0,0,0]
    v_med3_i32 v11, v11, 0, v5
    v_lshl_add_u32 v50, v50, 2, s23
    v_lshl_add_u32 v48, v11, 16, v10
    v_add_u32 v52, 67108864, v52
    v_add_u32 v110, v110, v48
    s_min_u32 s17, s38, 512
    s_add_u32 s17, s17, 63
    s_lshr_b32 s17, s17, 6
p2_xb_0:
    v_cmpx_lt_i32 vcc, 0, v10
    s_cbranch_execz p2_yb_0
    ds_write_b32 v49, v51 offset:0
    v_add_u32 v51, 16, v51
    v_cmpx_lt_i32 vcc, 1, v10
    s_cbranch_execz p2_yb_0
    ds_write_b32 v49, v51 offset:4
    v_add_u32 v51, 16, v51
    v_cmpx_lt_i32 vcc, 2, v10
    s_cbranch_execz p2_yb_0
    ds_write_b32 v49, v51 offset:8
    v_add_u32 v51, 16, v51
    v_cmpx_lt_i32 vcc, 3, v10
    s_cbranch_execz p2_yb_0
    ds_write_b32 v49, v51 offset:12
    v_add_u32 v51, 16, v51
    v_cmpx_lt_i32 vcc, 4, v10
    s_cbranch_execz p2_yb_0
    ds_write_b32 v49, v51 offset:16
    v_add_u32 v51, 16, v51
    v_cmpx_lt_i32 vcc, 5, v10
    s_cbranch_execz p2_yb_0
    ds_write_b32 v49, v51 offset:20
    v_add_u32 v51, 16, v51
    v_cmpx_lt_i32 vcc, 6, v10
    s_cbranch_execz p2_yb_0
    ds_write_b32 v49, v51 offset:24
    v_add_u32 v51, 16, v51
    v_cmpx_lt_i32 vcc, 7, v10
    s_cbranch_execz p2_yb_0
    ds_write_b32 v49, v51 offset:28
    v_add_u32 v51, 16, v51
    v_subrev_u32 v10, 8, v10
    v_add_u32 v49, 32, v49
    s_branch p2_xb_0
p2_yb_0:
    s_mov_b64 exec, -1
p2_xb_1:
    v_cmpx_lt_i32 vcc, 0, v11
    s_cbranch_execz p2_yb_1
    ds_write_b32 v50, v52 offset:0
    v_add_u32 v52, 16, v52
    v_cmpx_lt_i32 vcc, 1, v11
    s_cbranch_execz p2_yb_1
    ds_write_b32 v50, v52 offset:4
    v_add_u32 v52, 16, v52
    v_cmpx_lt_i32 vcc, 2, v11
    s_cbranch_execz p2_yb_1
    ds_write_b32 v50, v52 offset:8
    v_add_u32 v52, 16, v52
    v_cmpx_lt_i32 vcc, 3, v11
    s_cbranch_execz p2_yb_1
    ds_write_b32 v50, v52 offset:12
    v_add_u32 v52, 16, v52
    v_cmpx_lt_i32 vcc, 4, v11
    s_cbranch_execz p2_yb_1
    ds_write_b32 v50, v52 offset:16
    v_add_u32 v52, 16, v52
    v_cmpx_lt_i32 vcc, 5, v11
    s_cbranch_execz p2_yb_1
    ds_write_b32 v50, v52 offset:20
    v_add_u32 v52, 16, v52
    v_cmpx_lt_i32 vcc, 6, v11
    s_cbranch_execz p2_yb_1
    ds_write_b32 v50, v52 offset:24
    v_add_u32 v52, 16, v52
    v_cmpx_lt_i32 vcc, 7, v11
    s_cbranch_execz p2_yb_1
    ds_write_b32 v50, v52 offset:28
    v_add_u32 v52, 16, v52
    v_subrev_u32 v11, 8, v11
    v_add_u32 v50, 32, v50
    s_branch p2_xb_1
p2_yb_1:
    s_mov_b64 exec, -1
    s_cmp_lt_u32 s38, 512
    s_cbranch_scc1 p2_nomoreb
    v_cmp_lt_u32_sdwa s[44:45], v110, v111 src0_sel:WORD_0 src1_sel:WORD_0
    v_cmp_lt_u32_sdwa s[46:47], v110, v111 src0_sel:WORD_1 src1_sel:WORD_1
    s_nop 0
    s_or_b64 s[44:45], s[44:45], s[46:47]
    s_cbranch_scc0 p2_nomoreb
    v_mov_b32 v49, s19
    v_mov_b32 v50, 1
    ds_write_b32 v49, v50 offset:53760
p2_nomoreb:
    s_mov_b32 m0, s23
    s_nop 0
    ds_read_addtid_b32 v102 offset:0
    ds_read_addtid_b32 v103 offset:256
    ds_read_addtid_b32 v104 offset:512
    ds_read_addtid_b32 v105 offset:768
    ds_read_addtid_b32 v106 offset:1024
    ds_read_addtid_b32 v107 offset:1280
    ds_read_addtid_b32 v108 offset:1536
    ds_read_addtid_b32 v109 offset:1792
    s_mov_b32 m0, s24
    s_cmp_ge_u32 s10, 9
    s_cbranch_scc1 p2_stp
    ds_write_addtid_b32 v84 offset:49152
    ds_write_addtid_b32 v85 offset:49408
p2_stp:
    s_mov_b32 m0, s23
    s_add_u32 s20, s20, 53760
    ds_write_addtid_b32 v72 offset:0
    ds_write_addtid_b32 v73 offset:256
    ds_write_addtid_b32 v74 offset:512
    ds_write_addtid_b32 v75 offset:768
    ds_write_addtid_b32 v76 offset:1024
    ds_write_addtid_b32 v77 offset:1280
    ds_write_addtid_b32 v78 offset:1536
    ds_write_addtid_b32 v79 offset:1792
    ds_write_addtid_b32 v80 offset:2048
    ds_write_addtid_b32 v81 offset:2304
    ds_write_addtid_b32 v82 offset:2560
    ds_write_addtid_b32 v83 offset:2816
    v_perm_b32 v48, v3, v0, s31
    v_perm_b32 v49, v3, v1, s32
    v_perm_b32 v50, v3, v2, s33
    v_lshlrev_b16 v4, 3, v2
    v_lshlrev_b16 v2, 3, v1
    v_lshlrev_b16 v0, 3, v0
    v_perm_b32 v51, v9, v6, s31
    v_perm_b32 v52, v9, v7, s32
    v_perm_b32 v53, v9, v8, s33
    v_lshlrev_b16 v10, 3, v8
    v_lshlrev_b16 v8, 3, v7
    v_lshlrev_b16 v6, 3, v6
    v_perm_b32 v54, v15, v12, s31
    v_perm_b32 v55, v15, v13, s32
    v_perm_b32 v56, v15, v14, s33
    v_lshlrev_b16 v16, 3, v14
    v_lshlrev_b16 v14, 3, v13
    v_lshlrev_b16 v12, 3, v12
    v_perm_b32 v57, v21, v18, s31
    v_perm_b32 v58, v21, v19, s32
    v_perm_b32 v59, v21, v20, s33
    v_lshlrev_b16 v22, 3, v20
    v_lshlrev_b16 v20, 3, v19
    v_lshlrev_b16 v18, 3, v18
    v_perm_b32 v60, v89, v86, s31
    v_perm_b32 v61, v89, v87, s32
    v_perm_b32 v62, v89, v88, s33
    v_lshlrev_b16 v28, 3, v88
    v_lshlrev_b16 v26, 3, v87
    v_lshlrev_b16 v24, 3, v86
    v_perm_b32 v63, v93, v90, s31
    v_perm_b32 v64, v93, v91, s32
    v_perm_b32 v65, v93, v92, s33
    v_lshlrev_b16 v34, 3, v92
    v_lshlrev_b16 v32, 3, v91
    v_lshlrev_b16 v30, 3, v90
    v_perm_b32 v66, v97, v94, s31
    v_perm_b32 v67, v97, v95, s32
    v_perm_b32 v68, v97, v96, s33
    v_lshlrev_b16 v40, 3, v96
    v_lshlrev_b16 v38, 3, v95
    v_lshlrev_b16 v36, 3, v94
    v_perm_b32 v69, v101, v98, s31
    v_perm_b32 v70, v101, v99, s32
    v_perm_b32 v71, v101, v100, s33
    v_lshlrev_b16 v46, 3, v100
    v_lshlrev_b16 v44, 3, v99
    v_lshlrev_b16 v42, 3, v98
    s_waitcnt lgkmcnt(0)
    s_barrier
    s_cmp_ge_u32 s10, 9
    s_cbranch_scc1 p2_nmq
    v_lshrrev_b32 v84, 1, v112
    s_add_u32 s44, s20, s42
    buffer_load_dwordx2 v[84:85], v84, s[4:7], s44 offen
p2_nmq:
    buffer_load_dwordx4 v[72:75], v112, s[4:7], s20 offen offset:0
    buffer_load_dwordx4 v[76:79], v112, s[4:7], s20 offen offset:1024
    buffer_load_dwordx4 v[80:83], v112, s[4:7], s20 offen offset:2048
    v_lshrrev_b32 v86, 3, v106
    v_lshrrev_b32 v87, 18, v106
    v_and_b32 v106, 0x3fff, v106
    v_and_or_b32 v86, v86, s65, v87
    v_mad_u32_u24 v106, v86, s63, v106
    buffer_load_dwordx4 v[86:89], v106, s[68:71], 0 offen
    v_lshrrev_b32 v90, 3, v107
    v_lshrrev_b32 v91, 18, v107
    v_and_b32 v107, 0x3fff, v107
    v_and_or_b32 v90, v90, s65, v91
    v_mad_u32_u24 v107, v90, s63, v107
    buffer_load_dwordx4 v[90:93], v107, s[68:71], 0 offen
    v_cmpx_ge_u16 vcc, 0x3fff, v48
    ds_read_b64 v[0:1], v0
    s_mov_b64 exec, -1
    v_cmpx_ge_u16 vcc, 0x3fff, v49
    ds_read_b64 v[2:3], v2
    s_mov_b64 exec, -1
    v_cmpx_ge_u16 vcc, 0x3fff, v50
    ds_read_b64 v[4:5], v4
    s_mov_b64 exec, -1
    v_cmpx_ge_u16 vcc, 0x3fff, v51
    ds_read_b64 v[6:7], v6
    s_mov_b64 exec, -1
    v_cmpx_ge_u16 vcc, 0x3fff, v52
    ds_read_b64 v[8:9], v8
    s_mov_b64 exec, -1
    v_cmpx_ge_u16 vcc, 0x3fff, v53
    ds_read_b64 v[10:11], v10
    s_mov_b64 exec, -1
    v_cmpx_ge_u16 vcc, 0x3fff, v54
    ds_read_b64 v[12:13], v12
    s_mov_b64 exec, -1
    v_cmpx_ge_u16 vcc, 0x3fff, v55
    ds_read_b64 v[14:15], v14
    s_mov_b64 exec, -1
    v_cmpx_ge_u16 vcc, 0x3fff, v56
    ds_read_b64 v[16:17], v16
    s_mov_b64 exec, -1
    v_cmpx_ge_u16 vcc, 0x3fff, v57
    ds_read_b64 v[18:19], v18
    s_mov_b64 exec, -1
    v_cmpx_ge_u16 vcc, 0x3fff, v58
    ds_read_b64 v[20:21], v20
    s_mov_b64 exec, -1
    v_cmpx_ge_u16 vcc, 0x3fff, v59
    ds_read_b64 v[22:23], v22
    s_mov_b64 exec, -1
    v_cmpx_ge_u16 vcc, 0x3fff, v60
    ds_read_b64 v[24:25], v24
    s_mov_b64 exec, -1
    v_cmpx_ge_u16 vcc, 0x3fff, v61
    ds_read_b64 v[26:27], v26
    s_mov_b64 exec, -1
    v_cmpx_ge_u16 vcc, 0x3fff, v62
    ds_read_b64 v[28:29], v28
    s_mov_b64 exec, -1
    v_cmpx_ge_u16 vcc, 0x3fff, v63
    ds_read_b64 v[30:31], v30
    s_mov_b64 exec, -1
    v_cmpx_ge_u16 vcc, 0x3fff, v64
    ds_read_b64 v[32:33], v32
    s_mov_b64 exec, -1
    v_cmpx_ge_u16 vcc, 0x3fff, v65
    ds_read_b64 v[34:35], v34
    s_mov_b64 exec, -1
    v_cmpx_ge_u16 vcc, 0x3fff, v66
    ds_read_b64 v[36:37], v36
    s_mov_b64 exec, -1
    v_cmpx_ge_u16 vcc, 0x3fff, v67
    ds_read_b64 v[38:39], v38
    s_mov_b64 exec, -1
    v_cmpx_ge_u16 vcc, 0x3fff, v68
    ds_read_b64 v[40:41], v40
    s_mov_b64 exec, -1
    s_cmp_le_u32 s16, 7
    s_cbranch_scc1 p2_gp
    v_cmpx_ge_u16 vcc, 0x3fff, v69
    ds_read_b64 v[42:43], v42
    s_mov_b64 exec, -1
    v_cmpx_ge_u16 vcc, 0x3fff, v70
    ds_read_b64 v[44:45], v44
    s_mov_b64 exec, -1
    v_cmpx_ge_u16 vcc, 0x3fff, v71
    ds_read_b64 v[46:47], v46
    s_mov_b64 exec, -1
p2_gp:
    s_waitcnt lgkmcnt(0)
    s_barrier
    s_branch p2_tail
p2_top:
    s_cmp_lg_u32 s21, 0
    s_cbranch_scc1 p2_topf
    s_cmp_eq_u32 s60, 10
    s_cbranch_scc1 p2_drain0
    v_cmpx_gt_i16 vcc, 0, v48
    ds_read_b64 v[0:1], v0
    s_mov_b64 exec, -1
    v_cmpx_gt_i16 vcc, 0, v49
    ds_read_b64 v[2:3], v2
    s_mov_b64 exec, -1
    v_cmpx_gt_i16 vcc, 0, v50
    ds_read_b64 v[4:5], v4
    s_mov_b64 exec, -1
    v_cmpx_gt_i16 vcc, 0, v51
    ds_read_b64 v[6:7], v6
    s_mov_b64 exec, -1
    v_cmpx_gt_i16 vcc, 0, v52
    ds_read_b64 v[8:9], v8
    s_mov_b64 exec, -1
    v_cmpx_gt_i16 vcc, 0, v53
    ds_read_b64 v[10:11], v10
    s_mov_b64 exec, -1
    v_cmpx_gt_i16 vcc, 0, v54
    ds_read_b64 v[12:13], v12
    s_mov_b64 exec, -1
    v_cmpx_gt_i16 vcc, 0, v55
    ds_read_b64 v[14:15], v14
    s_mov_b64 exec, -1
    v_cmpx_gt_i16 vcc, 0, v56
    ds_read_b64 v[16:17], v16
    s_mov_b64 exec, -1
    v_cmpx_gt_i16 vcc, 0, v57
    ds_read_b64 v[18:19], v18
    s_mov_b64 exec, -1
    v_cmpx_gt_i16 vcc, 0, v58
    ds_read_b64 v[20:21], v20
    s_mov_b64 exec, -1
    v_cmpx_gt_i16 vcc, 0, v59
    ds_read_b64 v[22:23], v22
    s_mov_b64 exec, -1
    s_cmp_ge_u32 s10, 9
    s_cbranch_scc1 p2_nm0m0
    v_lshrrev_b32 v84, 1, v112
    s_add_u32 s44, s20, s42
    buffer_load_dwordx2 v[84:85], v84, s[4:7], s44 offen
p2_nm0m0:
    buffer_load_dwordx4 v[72:75], v112, s[4:7], s20 offen offset:0
    buffer_load_dwordx4 v[76:79], v112, s[4:7], s20 offen offset:1024
    buffer_load_dwordx4 v[80:83], v112, s[4:7], s20 offen offset:2048
    v_cmpx_gt_i16 vcc, 0, v60
    ds_read_b64 v[24:25], v24
    s_mov_b64 exec, -1
    v_cmpx_gt_i16 vcc, 0, v61
    ds_read_b64 v[26:27], v26
    s_mov_b64 exec, -1
    v_cmpx_gt_i16 vcc, 0, v62
    ds_read_b64 v[28:29], v28
    s_mov_b64 exec, -1
    v_cmpx_gt_i16 vcc, 0, v63
    ds_read_b64 v[30:31], v30
    s_mov_b64 exec, -1
    v_cmpx_gt_i16 vcc, 0, v64
    ds_read_b64 v[32:33], v32
    s_mov_b64 exec, -1
    v_cmpx_gt_i16 vcc, 0, v65
    ds_read_b64 v[34:35], v34
    s_mov_b64 exec, -1
    v_cmpx_gt_i16 vcc, 0, v66
    ds_read_b64 v[36:37], v36
    s_mov_b64 exec, -1
    v_cmpx_gt_i16 vcc, 0, v67
    ds_read_b64 v[38:39], v38
    s_mov_b64 exec, -1
    v_cmpx_gt_i16 vcc, 0, v68
    ds_read_b64 v[40:41], v40
    s_mov_b64 exec, -1
    s_cmp_le_u32 s15, 7
    s_cbranch_scc1 p2_g0r27
    v_cmpx_gt_i16 vcc, 0, v69
    ds_read_b64 v[42:43], v42
    s_mov_b64 exec, -1
    v_cmpx_gt_i16 vcc, 0, v70
    ds_read_b64 v[44:45], v44
    s_mov_b64 exec, -1
    v_cmpx_gt_i16 vcc, 0, v71
    ds_read_b64 v[46:47], v46
    s_mov_b64 exec, -1
p2_g0r27:
    s_waitcnt lgkmcnt(15)
    v_ashrrev_i32 v122, 5, v48
    v_lshlrev_b16 v123, 2, v48
    v_lshlrev_b32 v124, 16, v0
    v_bitop3_b32 v122, v122, v113, v113 bitop3:0x0c
    v_and_b32 v125, 0xffff0000, v0
    v_lshlrev_b32 v126, 16, v1
    v_mul_f32 v122, v114, v122
    v_and_b32 v127, 0xffff0000, v1
    v_add_u32 v123, v123, v123
    v_pk_fma_f32 v[124:125], v[124:125], v[122:123], s[34:35] op_sel_hi:[1,0,1]
    v_pk_fma_f32 v[126:127], v[126:127], v[122:123], s[34:35] op_sel_hi:[1,0,1]
    v_lshl_add_u32 v124, v125, 16, v124
    v_lshl_add_u32 v125, v127, 16, v126
    s_waitcnt lgkmcnt(15)
    v_bitop3_b32 v115, v115, v116, v117 bitop3:0xfe
    v_lshl_add_u64 v[124:125], v[124:125], 0, s[36:37]
    v_cmpx_le_u32 vcc, 0x1000000, v48
    ds_add_rtn_u64 v[116:117], v123, v[124:125] offset:54272
    s_mov_b64 exec, -1
    v_ashrrev_i32 v122, 5, v49
    v_lshlrev_b16 v123, 2, v49
    v_lshlrev_b32 v124, 16, v2
    v_bitop3_b32 v122, v122, v113, v113 bitop3:0x0c
    v_and_b32 v125, 0xffff0000, v2
    v_lshlrev_b32 v126, 16, v3
    v_mul_f32 v122, v114, v122
    v_and_b32 v127, 0xffff0000, v3
    v_add_u32 v123, v123, v123
    v_pk_fma_f32 v[124:125], v[124:125], v[122:123], s[34:35] op_sel_hi:[1,0,1]
    v_pk_fma_f32 v[126:127], v[126:127], v[122:123], s[34:35] op_sel_hi:[1,0,1]
    v_lshl_add_u32 v124, v125, 16, v124
    v_lshl_add_u32 v125, v127, 16, v126
    s_waitcnt lgkmcnt(15)
    v_bitop3_b32 v115, v115, v118, v119 bitop3:0xfe
    v_lshl_add_u64 v[124:125], v[124:125], 0, s[36:37]
    v_cmpx_le_u32 vcc, 0x1000000, v49
    ds_add_rtn_u64 v[118:119], v123, v[124:125] offset:54272
    s_mov_b64 exec, -1
    v_ashrrev_i32 v122, 5, v50
    v_lshlrev_b16 v123, 2, v50
    v_lshlrev_b32 v124, 16, v4
    v_bitop3_b32 v122, v122, v113, v113 bitop3:0x0c
    v_and_b32 v125, 0xffff0000, v4
    v_lshlrev_b32 v126, 16, v5
    v_mul_f32 v122, v114, v122
    v_and_b32 v127, 0xffff0000, v5
    v_add_u32 v123, v123, v123
    v_pk_fma_f32 v[124:125], v[124:125], v[122:123], s[34:35] op_sel_hi:[1,0,1]
    v_pk_fma_f32 v[126:127], v[126:127], v[122:123], s[34:35] op_sel_hi:[1,0,1]
    v_lshl_add_u32 v124, v125, 16, v124
    v_lshl_add_u32 v125, v127, 16, v126
    s_waitcnt lgkmcnt(15)
    v_bitop3_b32 v115, v115, v120, v121 bitop3:0xfe
    v_lshl_add_u64 v[124:125], v[124:125], 0, s[36:37]
    v_cmpx_le_u32 vcc, 0x1000000, v50
    ds_add_rtn_u64 v[120:121], v123, v[124:125] offset:54272
    s_mov_b64 exec, -1
    v_lshrrev_b32 v0, 3, v102
    v_lshrrev_b32 v1, 18, v102
    v_and_b32 v102, 0x3fff, v102
    v_and_or_b32 v0, v0, s65, v1
    v_mad_u32_u24 v102, v0, s63, v102
    buffer_load_dwordx4 v[0:3], v102, s[68:71], 0 offen
    s_waitcnt lgkmcnt(15)
    v_ashrrev_i32 v122, 5, v51
    v_lshlrev_b16 v123, 2, v51
    v_lshlrev_b32 v124, 16, v6
    v_bitop3_b32 v122, v122, v113, v113 bitop3:0x0c
    v_and_b32 v125, 0xffff0000, v6
    v_lshlrev_b32 v126, 16, v7
    v_mul_f32 v122, v114, v122
    v_and_b32 v127, 0xffff0000, v7
    v_add_u32 v123, v123, v123
    v_pk_fma_f32 v[124:125], v[124:125], v[122:123], s[34:35] op_sel_hi:[1,0,1]
    v_pk_fma_f32 v[126:127], v[126:127], v[122:123], s[34:35] op_sel_hi:[1,0,1]
    v_lshl_add_u32 v124, v125, 16, v124
    v_lshl_add_u32 v125, v127, 16, v126
    s_waitcnt lgkmcnt(2)
    v_bitop3_b32 v115, v115, v116, v117 bitop3:0xfe
    v_lshl_add_u64 v[124:125], v[124:125], 0, s[36:37]
    v_cmpx_le_u32 vcc, 0x1000000, v51
    ds_add_rtn_u64 v[116:117], v123, v[124:125] offset:54272
    s_mov_b64 exec, -1
    v_ashrrev_i32 v122, 5, v52
    v_lshlrev_b16 v123, 2, v52
    v_lshlrev_b32 v124, 16, v8
    v_bitop3_b32 v122, v122, v113, v113 bitop3:0x0c
    v_and_b32 v125, 0xffff0000, v8
    v_lshlrev_b32 v126, 16, v9
    v_mul_f32 v122, v114, v122
    v_and_b32 v127, 0xffff0000, v9
    v_add_u32 v123, v123, v123
    v_pk_fma_f32 v[124:125], v[124:125], v[122:123], s[34:35] op_sel_hi:[1,0,1]
    v_pk_fma_f32 v[126:127], v[126:127], v[122:123], s[34:35] op_sel_hi:[1,0,1]
    v_lshl_add_u32 v124, v125, 16, v124
    v_lshl_add_u32 v125, v127, 16, v126
    s_waitcnt lgkmcnt(2)
    v_bitop3_b32 v115, v115, v118, v119 bitop3:0xfe
    v_lshl_add_u64 v[124:125], v[124:125], 0, s[36:37]
    v_cmpx_le_u32 vcc, 0x1000000, v52
    ds_add_rtn_u64 v[118:119], v123, v[124:125] offset:54272
    s_mov_b64 exec, -1
    v_ashrrev_i32 v122, 5, v53
    v_lshlrev_b16 v123, 2, v53
    v_lshlrev_b32 v124, 16, v10
    v_bitop3_b32 v122, v122, v113, v113 bitop3:0x0c
    v_and_b32 v125, 0xffff0000, v10
    v_lshlrev_b32 v126, 16, v11
    v_mul_f32 v122, v114, v122
    v_and_b32 v127, 0xffff0000, v11
    v_add_u32 v123, v123, v123
    v_pk_fma_f32 v[124:125], v[124:125], v[122:123], s[34:35] op_sel_hi:[1,0,1]
    v_pk_fma_f32 v[126:127], v[126:127], v[122:123], s[34:35] op_sel_hi:[1,0,1]
    v_lshl_add_u32 v124, v125, 16, v124
    v_lshl_add_u32 v125, v127, 16, v126
    s_waitcnt lgkmcnt(2)
    v_bitop3_b32 v115, v115, v120, v121 bitop3:0xfe
    v_lshl_add_u64 v[124:125], v[124:125], 0, s[36:37]
    v_cmpx_le_u32 vcc, 0x1000000, v53
    ds_add_rtn_u64 v[120:121], v123, v[124:125] offset:54272
    s_mov_b64 exec, -1
    v_lshrrev_b32 v6, 3, v103
    v_lshrrev_b32 v7, 18, v103
    v_and_b32 v103, 0x3fff, v103
    v_and_or_b32 v6, v6, s65, v7
    v_mad_u32_u24 v103, v6, s63, v103
    buffer_load_dwordx4 v[6:9], v103, s[68:71], 0 offen
    s_waitcnt lgkmcnt(6)
    s_barrier
    s_waitcnt lgkmcnt(15)
    v_ashrrev_i32 v122, 5, v54
    v_lshlrev_b16 v123, 2, v54
    v_lshlrev_b32 v124, 16, v12
    v_bitop3_b32 v122, v122, v113, v113 bitop3:0x0c
    v_and_b32 v125, 0xffff0000, v12
    v_lshlrev_b32 v126, 16, v13
    v_mul_f32 v122, v114, v122
    v_and_b32 v127, 0xffff0000, v13
    v_add_u32 v123, v123, v123
    v_pk_fma_f32 v[124:125], v[124:125], v[122:123], s[34:35] op_sel_hi:[1,0,1]
    v_pk_fma_f32 v[126:127], v[126:127], v[122:123], s[34:35] op_sel_hi:[1,0,1]
    v_lshl_add_u32 v124, v125, 16, v124
    v_lshl_add_u32 v125, v127, 16, v126
    s_waitcnt lgkmcnt(2)
    v_bitop3_b32 v115, v115, v116, v117 bitop3:0xfe
    v_lshl_add_u64 v[124:125], v[124:125], 0, s[36:37]
    v_cmpx_le_u32 vcc, 0x1000000, v54
    ds_add_rtn_u64 v[116:117], v123, v[124:125] offset:54272
    s_mov_b64 exec, -1
    v_ashrrev_i32 v122, 5, v55
    v_lshlrev_b16 v123, 2, v55
    v_lshlrev_b32 v124, 16, v14
    v_bitop3_b32 v122, v122, v113, v113 bitop3:0x0c
    v_and_b32 v125, 0xffff0000, v14
    v_lshlrev_b32 v126, 16, v15
    v_mul_f32 v122, v114, v122
    v_and_b32 v127, 0xffff0000, v15
    v_add_u32 v123, v123, v123
    v_pk_fma_f32 v[124:125], v[124:125], v[122:123], s[34:35] op_sel_hi:[1,0,1]
    v_pk_fma_f32 v[126:127], v[126:127], v[122:123], s[34:35] op_sel_hi:[1,0,1]
    v_lshl_add_u32 v124, v125, 16, v124
    v_lshl_add_u32 v125, v127, 16, v126
    s_waitcnt lgkmcnt(2)
    v_bitop3_b32 v115, v115, v118, v119 bitop3:0xfe
    v_lshl_add_u64 v[124:125], v[124:125], 0, s[36:37]
    v_cmpx_le_u32 vcc, 0x1000000, v55
    ds_add_rtn_u64 v[118:119], v123, v[124:125] offset:54272
    s_mov_b64 exec, -1
    v_ashrrev_i32 v122, 5, v56
    v_lshlrev_b16 v123, 2, v56
    v_lshlrev_b32 v124, 16, v16
    v_bitop3_b32 v122, v122, v113, v113 bitop3:0x0c
    v_and_b32 v125, 0xffff0000, v16
    v_lshlrev_b32 v126, 16, v17
    v_mul_f32 v122, v114, v122
    v_and_b32 v127, 0xffff0000, v17
    v_add_u32 v123, v123, v123
    v_pk_fma_f32 v[124:125], v[124:125], v[122:123], s[34:35] op_sel_hi:[1,0,1]
    v_pk_fma_f32 v[126:127], v[126:127], v[122:123], s[34:35] op_sel_hi:[1,0,1]
    v_lshl_add_u32 v124, v125, 16, v124
    v_lshl_add_u32 v125, v127, 16, v126
    s_waitcnt lgkmcnt(2)
    v_bitop3_b32 v115, v115, v120, v121 bitop3:0xfe
    v_lshl_add_u64 v[124:125], v[124:125], 0, s[36:37]
    v_cmpx_le_u32 vcc, 0x1000000, v56
    ds_add_rtn_u64 v[120:121], v123, v[124:125] offset:54272
    s_mov_b64 exec, -1
    v_lshrrev_b32 v12, 3, v104
    v_lshrrev_b32 v13, 18, v104
    v_and_b32 v104, 0x3fff, v104
    v_and_or_b32 v12, v12, s65, v13
    v_mad_u32_u24 v104, v12, s63, v104
    buffer_load_dwordx4 v[12:15], v104, s[68:71], 0 offen
    s_waitcnt lgkmcnt(15)
    v_ashrrev_i32 v122, 5, v57
    v_lshlrev_b16 v123, 2, v57
    v_lshlrev_b32 v124, 16, v18
    v_bitop3_b32 v122, v122, v113, v113 bitop3:0x0c
    v_and_b32 v125, 0xffff0000, v18
    v_lshlrev_b32 v126, 16, v19
    v_mul_f32 v122, v114, v122
    v_and_b32 v127, 0xffff0000, v19
    v_add_u32 v123, v123, v123
    v_pk_fma_f32 v[124:125], v[124:125], v[122:123], s[34:35] op_sel_hi:[1,0,1]
    v_pk_fma_f32 v[126:127], v[126:127], v[122:123], s[34:35] op_sel_hi:[1,0,1]
    v_lshl_add_u32 v124, v125, 16, v124
    v_lshl_add_u32 v125, v127, 16, v126
    s_waitcnt lgkmcnt(2)
    v_bitop3_b32 v115, v115, v116, v117 bitop3:0xfe
    v_lshl_add_u64 v[124:125], v[124:125], 0, s[36:37]
    v_cmpx_le_u32 vcc, 0x1000000, v57
    ds_add_rtn_u64 v[116:117], v123, v[124:125] offset:54272
    s_mov_b64 exec, -1
    v_ashrrev_i32 v122, 5, v58
    v_lshlrev_b16 v123, 2, v58
    v_lshlrev_b32 v124, 16, v20
    v_bitop3_b32 v122, v122, v113, v113 bitop3:0x0c
    v_and_b32 v125, 0xffff0000, v20
    v_lshlrev_b32 v126, 16, v21
    v_mul_f32 v122, v114, v122
    v_and_b32 v127, 0xffff0000, v21
    v_add_u32 v123, v123, v123
    v_pk_fma_f32 v[124:125], v[124:125], v[122:123], s[34:35] op_sel_hi:[1,0,1]
    v_pk_fma_f32 v[126:127], v[126:127], v[122:123], s[34:35] op_sel_hi:[1,0,1]
    v_lshl_add_u32 v124, v125, 16, v124
    v_lshl_add_u32 v125, v127, 16, v126
    s_waitcnt lgkmcnt(2)
    v_bitop3_b32 v115, v115, v118, v119 bitop3:0xfe
    v_lshl_add_u64 v[124:125], v[124:125], 0, s[36:37]
    v_cmpx_le_u32 vcc, 0x1000000, v58
    ds_add_rtn_u64 v[118:119], v123, v[124:125] offset:54272
    s_mov_b64 exec, -1
    v_ashrrev_i32 v122, 5, v59
    v_lshlrev_b16 v123, 2, v59
    v_lshlrev_b32 v124, 16, v22
    v_bitop3_b32 v122, v122, v113, v113 bitop3:0x0c
    v_and_b32 v125, 0xffff0000, v22
    v_lshlrev_b32 v126, 16, v23
    v_mul_f32 v122, v114, v122
    v_and_b32 v127, 0xffff0000, v23
    v_add_u32 v123, v123, v123
    v_pk_fma_f32 v[124:125], v[124:125], v[122:123], s[34:35] op_sel_hi:[1,0,1]
    v_pk_fma_f32 v[126:127], v[126:127], v[122:123], s[34:35] op_sel_hi:[1,0,1]
    v_lshl_add_u32 v124, v125, 16, v124
    v_lshl_add_u32 v125, v127, 16, v126
    s_waitcnt lgkmcnt(2)
    v_bitop3_b32 v115, v115, v120, v121 bitop3:0xfe
    v_lshl_add_u64 v[124:125], v[124:125], 0, s[36:37]
    v_cmpx_le_u32 vcc, 0x1000000, v59
    ds_add_rtn_u64 v[120:121], v123, v[124:125] offset:54272
    s_mov_b64 exec, -1
    v_lshrrev_b32 v18, 3, v105
    v_lshrrev_b32 v19, 18, v105
    v_and_b32 v105, 0x3fff, v105
    v_and_or_b32 v18, v18, s65, v19
    v_mad_u32_u24 v105, v18, s63, v105
    buffer_load_dwordx4 v[18:21], v105, s[68:71], 0 offen
    s_mov_b32 m0, s23
    v_mov_b32 v53, 0x3c000
    s_movk_i32 s44, 512
    v_sub_u32_sdwa v4, v111, v110 dst_sel:DWORD dst_unused:UNUSED_PAD src0_sel:WORD_0 src1_sel:WORD_0
    v_sub_u32_sdwa v5, v111, v110 dst_sel:DWORD dst_unused:UNUSED_PAD src0_sel:WORD_1 src1_sel:WORD_1
    v_med3_i32 v4, v4, 0, s44
    v_med3_i32 v5, v5, 0, s44
    v_add_u32 v48, v4, v5
    ds_write_addtid_b32 v53 offset:0
    ds_write_addtid_b32 v53 offset:256
    ds_write_addtid_b32 v53 offset:512
    ds_write_addtid_b32 v53 offset:768
    ds_write_addtid_b32 v53 offset:1024
    ds_write_addtid_b32 v53 offset:1280
    ds_write_addtid_b32 v53 offset:1536
    ds_write_addtid_b32 v53 offset:1792
    v_and_b32 v49, 0x30, v112
    v_lshrrev_b32 v53, 6, v112
    v_lshl_or_b32 v53, v49, 5, v53
    v_lshl_add_u32 v53, v53, 18, s41
    s_nop 1
    v_add_u32_dpp v48, v48, v48 row_shr:1 row_mask:0xf bank_mask:0xf bound_ctrl:0
    s_nop 1
    v_add_u32_dpp v48, v48, v48 row_shr:2 row_mask:0xf bank_mask:0xf bound_ctrl:0
    s_nop 1
    v_add_u32_dpp v48, v48, v48 row_shr:4 row_mask:0xf bank_mask:0xf bound_ctrl:0
    s_nop 1
    v_add_u32_dpp v48, v48, v48 row_shr:8 row_mask:0xf bank_mask:0xf bound_ctrl:0
    s_nop 1
    v_add_u32_dpp v48, v48, v48 row_bcast:15 row_mask:0xa bank_mask:0xf
    s_nop 1
    v_add_u32_dpp v48, v48, v48 row_bcast:31 row_mask:0xc bank_mask:0xf
    s_nop 1
    s_nop 0
    v_readlane_b32 s38, v48, 63
    v_sub_u32 v50, v48, v5
    v_sub_u32 v49, v50, v4
    v_sub_u32 v10, 512, v49
    v_mad_u32_u16 v51, v110, 16, v53
    v_med3_i32 v10, v10, 0, v4
    v_lshl_add_u32 v49, v49, 2, s23
    v_sub_u32 v11, 512, v50
    v_mad_u32_u16 v52, v110, 16, v53 op_sel:[1,0,0,0]
    v_med3_i32 v11, v11, 0, v5
    v_lshl_add_u32 v50, v50, 2, s23
    v_lshl_add_u32 v48, v11, 16, v10
    v_add_u32 v52, 67108864, v52
    v_add_u32 v110, v110, v48
    s_min_u32 s17, s38, 512
    s_add_u32 s17, s17, 63
    s_lshr_b32 s17, s17, 6
p2_x0x_0:
    v_cmpx_lt_i32 vcc, 0, v10
    s_cbranch_execz p2_y0x_0
    ds_write_b32 v49, v51 offset:0
    v_add_u32 v51, 16, v51
    v_cmpx_lt_i32 vcc, 1, v10
    s_cbranch_execz p2_y0x_0
    ds_write_b32 v49, v51 offset:4
    v_add_u32 v51, 16, v51
    v_cmpx_lt_i32 vcc, 2, v10
    s_cbranch_execz p2_y0x_0
    ds_write_b32 v49, v51 offset:8
    v_add_u32 v51, 16, v51
    v_cmpx_lt_i32 vcc, 3, v10
    s_cbranch_execz p2_y0x_0
    ds_write_b32 v49, v51 offset:12
    v_add_u32 v51, 16, v51
    v_cmpx_lt_i32 vcc, 4, v10
    s_cbranch_execz p2_y0x_0
    ds_write_b32 v49, v51 offset:16
    v_add_u32 v51, 16, v51
    v_cmpx_lt_i32 vcc, 5, v10
    s_cbranch_execz p2_y0x_0
    ds_write_b32 v49, v51 offset:20
    v_add_u32 v51, 16, v51
    v_cmpx_lt_i32 vcc, 6, v10
    s_cbranch_execz p2_y0x_0
    ds_write_b32 v49, v51 offset:24
    v_add_u32 v51, 16, v51
    v_cmpx_lt_i32 vcc, 7, v10
    s_cbranch_execz p2_y0x_0
    ds_write_b32 v49, v51 offset:28
    v_add_u32 v51, 16, v51
    v_subrev_u32 v10, 8, v10
    v_add_u32 v49, 32, v49
    s_branch p2_x0x_0
p2_y0x_0:
    s_mov_b64 exec, -1
p2_x0x_1:
    v_cmpx_lt_i32 vcc, 0, v11
    s_cbranch_execz p2_y0x_1
    ds_write_b32 v50, v52 offset:0
    v_add_u32 v52, 16, v52
    v_cmpx_lt_i32 vcc, 1, v11
    s_cbranch_execz p2_y0x_1
    ds_write_b32 v50, v52 offset:4
    v_add_u32 v52, 16, v52
    v_cmpx_lt_i32 vcc, 2, v11
    s_cbranch_execz p2_y0x_1
    ds_write_b32 v50, v52 offset:8
    v_add_u32 v52, 16, v52
    v_cmpx_lt_i32 vcc, 3, v11
    s_cbranch_execz p2_y0x_1
    ds_write_b32 v50, v52 offset:12
    v_add_u32 v52, 16, v52
    v_cmpx_lt_i32 vcc, 4, v11
    s_cbranch_execz p2_y0x_1
    ds_write_b32 v50, v52 offset:16
    v_add_u32 v52, 16, v52
    v_cmpx_lt_i32 vcc, 5, v11
    s_cbranch_execz p2_y0x_1
    ds_write_b32 v50, v52 offset:20
    v_add_u32 v52, 16, v52
    v_cmpx_lt_i32 vcc, 6, v11
    s_cbranch_execz p2_y0x_1
    ds_write_b32 v50, v52 offset:24
    v_add_u32 v52, 16, v52
    v_cmpx_lt_i32 vcc, 7, v11
    s_cbranch_execz p2_y0x_1
    ds_write_b32 v50, v52 offset:28
    v_add_u32 v52, 16, v52
    v_subrev_u32 v11, 8, v11
    v_add_u32 v50, 32, v50
    s_branch p2_x0x_1
p2_y0x_1:
    s_mov_b64 exec, -1
    s_cmp_lt_u32 s38, 512
    s_cbranch_scc1 p2_nomore0x
    v_cmp_lt_u32_sdwa s[44:45], v110, v111 src0_sel:WORD_0 src1_sel:WORD_0
    v_cmp_lt_u32_sdwa s[46:47], v110, v111 src0_sel:WORD_1 src1_sel:WORD_1
    s_nop 0
    s_or_b64 s[44:45], s[44:45], s[46:47]
    s_cbranch_scc0 p2_nomore0x
    v_mov_b32 v49, s19
    v_mov_b32 v50, 1
    ds_write_b32 v49, v50 offset:53760
p2_nomore0x:
    s_mov_b32 m0, s23
    s_nop 0
    ds_read_addtid_b32 v102 offset:0
    ds_read_addtid_b32 v103 offset:256
    ds_read_addtid_b32 v104 offset:512
    ds_read_addtid_b32 v105 offset:768
    ds_read_addtid_b32 v106 offset:1024
    ds_read_addtid_b32 v107 offset:1280
    ds_read_addtid_b32 v108 offset:1536
    ds_read_addtid_b32 v109 offset:1792
    s_waitcnt vmcnt(4)
    s_mov_b32 m0, s24
    s_cmp_ge_u32 s10, 9
    s_cbranch_scc1 p2_st0s0
    ds_write_addtid_b32 v84 offset:49152
    ds_write_addtid_b32 v85 offset:49408
p2_st0s0:
    s_mov_b32 m0, s23
    s_add_u32 s20, s20, 53760
    ds_write_addtid_b32 v72 offset:0
    ds_write_addtid_b32 v73 offset:256
    ds_write_addtid_b32 v74 offset:512
    ds_write_addtid_b32 v75 offset:768
    ds_write_addtid_b32 v76 offset:1024
    ds_write_addtid_b32 v77 offset:1280
    ds_write_addtid_b32 v78 offset:1536
    ds_write_addtid_b32 v79 offset:1792
    ds_write_addtid_b32 v80 offset:2048
    ds_write_addtid_b32 v81 offset:2304
    ds_write_addtid_b32 v82 offset:2560
    ds_write_addtid_b32 v83 offset:2816
    s_waitcnt lgkmcnt(15)
    v_ashrrev_i32 v122, 5, v60
    v_lshlrev_b16 v123, 2, v60
    v_lshlrev_b32 v124, 16, v24
    v_bitop3_b32 v122, v122, v113, v113 bitop3:0x0c
    v_and_b32 v125, 0xffff0000, v24
    v_lshlrev_b32 v126, 16, v25
    v_mul_f32 v122, v114, v122
    v_and_b32 v127, 0xffff0000, v25
    v_add_u32 v123, v123, v123
    v_pk_fma_f32 v[124:125], v[124:125], v[122:123], s[34:35] op_sel_hi:[1,0,1]
    v_pk_fma_f32 v[126:127], v[126:127], v[122:123], s[34:35] op_sel_hi:[1,0,1]
    v_lshl_add_u32 v124, v125, 16, v124
    v_lshl_add_u32 v125, v127, 16, v126
    s_waitcnt lgkmcnt(15)
    v_bitop3_b32 v115, v115, v116, v117 bitop3:0xfe
    v_lshl_add_u64 v[124:125], v[124:125], 0, s[36:37]
    v_cmpx_le_u32 vcc, 0x1000000, v60
    ds_add_rtn_u64 v[116:117], v123, v[124:125] offset:54272
    s_mov_b64 exec, -1
    v_ashrrev_i32 v122, 5, v61
    v_lshlrev_b16 v123, 2, v61
    v_lshlrev_b32 v124, 16, v26
    v_bitop3_b32 v122, v122, v113, v113 bitop3:0x0c
    v_and_b32 v125, 0xffff0000, v26
    v_lshlrev_b32 v126, 16, v27
    v_mul_f32 v122, v114, v122
    v_and_b32 v127, 0xffff0000, v27
    v_add_u32 v123, v123, v123
    v_pk_fma_f32 v[124:125], v[124:125], v[122:123], s[34:35] op_sel_hi:[1,0,1]
    v_pk_fma_f32 v[126:127], v[126:127], v[122:123], s[34:35] op_sel_hi:[1,0,1]
    v_lshl_add_u32 v124, v125, 16, v124
    v_lshl_add_u32 v125, v127, 16, v126
    s_waitcnt lgkmcnt(15)
    v_bitop3_b32 v115, v115, v118, v119 bitop3:0xfe
    v_lshl_add_u64 v[124:125], v[124:125], 0, s[36:37]
    v_cmpx_le_u32 vcc, 0x1000000, v61
    ds_add_rtn_u64 v[118:119], v123, v[124:125] offset:54272
    s_mov_b64 exec, -1
    v_ashrrev_i32 v122, 5, v62
    v_lshlrev_b16 v123, 2, v62
    v_lshlrev_b32 v124, 16, v28
    v_bitop3_b32 v122, v122, v113, v113 bitop3:0x0c
    v_and_b32 v125, 0xffff0000, v28
    v_lshlrev_b32 v126, 16, v29
    v_mul_f32 v122, v114, v122
    v_and_b32 v127, 0xffff0000, v29
    v_add_u32 v123, v123, v123
    v_pk_fma_f32 v[124:125], v[124:125], v[122:123], s[34:35] op_sel_hi:[1,0,1]
    v_pk_fma_f32 v[126:127], v[126:127], v[122:123], s[34:35] op_sel_hi:[1,0,1]
    v_lshl_add_u32 v124, v125, 16, v124
    v_lshl_add_u32 v125, v127, 16, v126
    s_waitcnt lgkmcnt(15)
    v_bitop3_b32 v115, v115, v120, v121 bitop3:0xfe
    v_lshl_add_u64 v[124:125], v[124:125], 0, s[36:37]
    v_cmpx_le_u32 vcc, 0x1000000, v62
    ds_add_rtn_u64 v[120:121], v123, v[124:125] offset:54272
    s_mov_b64 exec, -1
    s_waitcnt vmcnt(13)
    v_perm_b32 v60, v89, v86, s31
    v_perm_b32 v61, v89, v87, s32
    v_perm_b32 v62, v89, v88, s33
    v_lshlrev_b16 v28, 3, v88
    v_lshlrev_b16 v26, 3, v87
    v_lshlrev_b16 v24, 3, v86
    s_waitcnt lgkmcnt(3)
    s_barrier
    s_cmp_ge_u32 s10, 9
    s_cbranch_scc1 p2_nm0m1
    v_lshrrev_b32 v84, 1, v112
    s_add_u32 s44, s20, s42
    buffer_load_dwordx2 v[84:85], v84, s[4:7], s44 offen
p2_nm0m1:
    buffer_load_dwordx4 v[72:75], v112, s[4:7], s20 offen offset:0
    buffer_load_dwordx4 v[76:79], v112, s[4:7], s20 offen offset:1024
    buffer_load_dwordx4 v[80:83], v112, s[4:7], s20 offen offset:2048
    v_cmpx_ge_u16 vcc, 0x3fff, v60
    ds_read_b64 v[24:25], v24
    s_mov_b64 exec, -1
    v_cmpx_ge_u16 vcc, 0x3fff, v61
    ds_read_b64 v[26:27], v26
    s_mov_b64 exec, -1
    v_cmpx_ge_u16 vcc, 0x3fff, v62
    ds_read_b64 v[28:29], v28
    s_mov_b64 exec, -1
    s_waitcnt lgkmcnt(15)
    v_ashrrev_i32 v122, 5, v63
    v_lshlrev_b16 v123, 2, v63
    v_lshlrev_b32 v124, 16, v30
    v_bitop3_b32 v122, v122, v113, v113 bitop3:0x0c
    v_and_b32 v125, 0xffff0000, v30
    v_lshlrev_b32 v126, 16, v31
    v_mul_f32 v122, v114, v122
    v_and_b32 v127, 0xffff0000, v31
    v_add_u32 v123, v123, v123
    v_pk_fma_f32 v[124:125], v[124:125], v[122:123], s[34:35] op_sel_hi:[1,0,1]
    v_pk_fma_f32 v[126:127], v[126:127], v[122:123], s[34:35] op_sel_hi:[1,0,1]
    v_lshl_add_u32 v124, v125, 16, v124
    v_lshl_add_u32 v125, v127, 16, v126
    s_waitcnt lgkmcnt(5)
    v_bitop3_b32 v115, v115, v116, v117 bitop3:0xfe
    v_lshl_add_u64 v[124:125], v[124:125], 0, s[36:37]
    v_cmpx_le_u32 vcc, 0x1000000, v63
    ds_add_rtn_u64 v[116:117], v123, v[124:125] offset:54272
    s_mov_b64 exec, -1
    v_ashrrev_i32 v122, 5, v64
    v_lshlrev_b16 v123, 2, v64
    v_lshlrev_b32 v124, 16, v32
    v_bitop3_b32 v122, v122, v113, v113 bitop3:0x0c
    v_and_b32 v125, 0xffff0000, v32
    v_lshlrev_b32 v126, 16, v33
    v_mul_f32 v122, v114, v122
    v_and_b32 v127, 0xffff0000, v33
    v_add_u32 v123, v123, v123
    v_pk_fma_f32 v[124:125], v[124:125], v[122:123], s[34:35] op_sel_hi:[1,0,1]
    v_pk_fma_f32 v[126:127], v[126:127], v[122:123], s[34:35] op_sel_hi:[1,0,1]
    v_lshl_add_u32 v124, v125, 16, v124
    v_lshl_add_u32 v125, v127, 16, v126
    s_waitcnt lgkmcnt(5)
    v_bitop3_b32 v115, v115, v118, v119 bitop3:0xfe
    v_lshl_add_u64 v[124:125], v[124:125], 0, s[36:37]
    v_cmpx_le_u32 vcc, 0x1000000, v64
    ds_add_rtn_u64 v[118:119], v123, v[124:125] offset:54272
    s_mov_b64 exec, -1
    v_ashrrev_i32 v122, 5, v65
    v_lshlrev_b16 v123, 2, v65
    v_lshlrev_b32 v124, 16, v34
    v_bitop3_b32 v122, v122, v113, v113 bitop3:0x0c
    v_and_b32 v125, 0xffff0000, v34
    v_lshlrev_b32 v126, 16, v35
    v_mul_f32 v122, v114, v122
    v_and_b32 v127, 0xffff0000, v35
    v_add_u32 v123, v123, v123
    v_pk_fma_f32 v[124:125], v[124:125], v[122:123], s[34:35] op_sel_hi:[1,0,1]
    v_pk_fma_f32 v[126:127], v[126:127], v[122:123], s[34:35] op_sel_hi:[1,0,1]
    v_lshl_add_u32 v124, v125, 16, v124
    v_lshl_add_u32 v125, v127, 16, v126
    s_waitcnt lgkmcnt(5)
    v_bitop3_b32 v115, v115, v120, v121 bitop3:0xfe
    v_lshl_add_u64 v[124:125], v[124:125], 0, s[36:37]
    v_cmpx_le_u32 vcc, 0x1000000, v65
    ds_add_rtn_u64 v[120:121], v123, v[124:125] offset:54272
    s_mov_b64 exec, -1
    s_waitcnt vmcnt(15)
    v_perm_b32 v63, v93, v90, s31
    v_perm_b32 v64, v93, v91, s32
    v_perm_b32 v65, v93, v92, s33
    v_lshlrev_b16 v34, 3, v92
    v_lshlrev_b16 v32, 3, v91
    v_lshlrev_b16 v30, 3, v90
    v_cmpx_ge_u16 vcc, 0x3fff, v63
    ds_read_b64 v[30:31], v30
    s_mov_b64 exec, -1
    v_cmpx_ge_u16 vcc, 0x3fff, v64
    ds_read_b64 v[32:33], v32
    s_mov_b64 exec, -1
    v_cmpx_ge_u16 vcc, 0x3fff, v65
    ds_read_b64 v[34:35], v34
    s_mov_b64 exec, -1
    s_waitcnt lgkmcnt(15)
    v_lshrrev_b32 v86, 3, v106
    v_lshrrev_b32 v87, 18, v106
    v_and_b32 v106, 0x3fff, v106
    v_and_or_b32 v86, v86, s65, v87
    v_mad_u32_u24 v106, v86, s63, v106
    buffer_load_dwordx4 v[86:89], v106, s[68:71], 0 offen
    s_waitcnt lgkmcnt(15)
    v_ashrrev_i32 v122, 5, v66
    v_lshlrev_b16 v123, 2, v66
    v_lshlrev_b32 v124, 16, v36
    v_bitop3_b32 v122, v122, v113, v113 bitop3:0x0c
    v_and_b32 v125, 0xffff0000, v36
    v_lshlrev_b32 v126, 16, v37
    v_mul_f32 v122, v114, v122
    v_and_b32 v127, 0xffff0000, v37
    v_add_u32 v123, v123, v123
    v_pk_fma_f32 v[124:125], v[124:125], v[122:123], s[34:35] op_sel_hi:[1,0,1]
    v_pk_fma_f32 v[126:127], v[126:127], v[122:123], s[34:35] op_sel_hi:[1,0,1]
    v_lshl_add_u32 v124, v125, 16, v124
    v_lshl_add_u32 v125, v127, 16, v126
    s_waitcnt lgkmcnt(5)
    v_bitop3_b32 v115, v115, v116, v117 bitop3:0xfe
    v_lshl_add_u64 v[124:125], v[124:125], 0, s[36:37]
    v_cmpx_le_u32 vcc, 0x1000000, v66
    ds_add_rtn_u64 v[116:117], v123, v[124:125] offset:54272
    s_mov_b64 exec, -1
    v_ashrrev_i32 v122, 5, v67
    v_lshlrev_b16 v123, 2, v67
    v_lshlrev_b32 v124, 16, v38
    v_bitop3_b32 v122, v122, v113, v113 bitop3:0x0c
    v_and_b32 v125, 0xffff0000, v38
    v_lshlrev_b32 v126, 16, v39
    v_mul_f32 v122, v114, v122
    v_and_b32 v127, 0xffff0000, v39
    v_add_u32 v123, v123, v123
    v_pk_fma_f32 v[124:125], v[124:125], v[122:123], s[34:35] op_sel_hi:[1,0,1]
    v_pk_fma_f32 v[126:127], v[126:127], v[122:123], s[34:35] op_sel_hi:[1,0,1]
    v_lshl_add_u32 v124, v125, 16, v124
    v_lshl_add_u32 v125, v127, 16, v126
    s_waitcnt lgkmcnt(5)
    v_bitop3_b32 v115, v115, v118, v119 bitop3:0xfe
    v_lshl_add_u64 v[124:125], v[124:125], 0, s[36:37]
    v_cmpx_le_u32 vcc, 0x1000000, v67
    ds_add_rtn_u64 v[118:119], v123, v[124:125] offset:54272
    s_mov_b64 exec, -1
    v_ashrrev_i32 v122, 5, v68
    v_lshlrev_b16 v123, 2, v68
    v_lshlrev_b32 v124, 16, v40
    v_bitop3_b32 v122, v122, v113, v113 bitop3:0x0c
    v_and_b32 v125, 0xffff0000, v40
    v_lshlrev_b32 v126, 16, v41
    v_mul_f32 v122, v114, v122
    v_and_b32 v127, 0xffff0000, v41
    v_add_u32 v123, v123, v123
    v_pk_fma_f32 v[124:125], v[124:125], v[122:123], s[34:35] op_sel_hi:[1,0,1]
    v_pk_fma_f32 v[126:127], v[126:127], v[122:123], s[34:35] op_sel_hi:[1,0,1]
    v_lshl_add_u32 v124, v125, 16, v124
    v_lshl_add_u32 v125, v127, 16, v126
    s_waitcnt lgkmcnt(5)
    v_bitop3_b32 v115, v115, v120, v121 bitop3:0xfe
    v_lshl_add_u64 v[124:125], v[124:125], 0, s[36:37]
    v_cmpx_le_u32 vcc, 0x1000000, v68
    ds_add_rtn_u64 v[120:121], v123, v[124:125] offset:54272
    s_mov_b64 exec, -1
    s_waitcnt vmcnt(12)
    v_perm_b32 v66, v97, v94, s31
    v_perm_b32 v67, v97, v95, s32
    v_perm_b32 v68, v97, v96, s33
    v_lshlrev_b16 v40, 3, v96
    v_lshlrev_b16 v38, 3, v95
    v_lshlrev_b16 v36, 3, v94
    v_cmpx_ge_u16 vcc, 0x3fff, v66
    ds_read_b64 v[36:37], v36
    s_mov_b64 exec, -1
    v_cmpx_ge_u16 vcc, 0x3fff, v67
    ds_read_b64 v[38:39], v38
    s_mov_b64 exec, -1
    v_cmpx_ge_u16 vcc, 0x3fff, v68
    ds_read_b64 v[40:41], v40
    s_mov_b64 exec, -1
    s_cmp_le_u32 s15, 7
    s_cbranch_scc1 p2_na0a7
    s_waitcnt lgkmcnt(15)
    v_ashrrev_i32 v122, 5, v69
    v_lshlrev_b16 v123, 2, v69
    v_lshlrev_b32 v124, 16, v42
    v_bitop3_b32 v122, v122, v113, v113 bitop3:0x0c
    v_and_b32 v125, 0xffff0000, v42
    v_lshlrev_b32 v126, 16, v43
    v_mul_f32 v122, v114, v122
    v_and_b32 v127, 0xffff0000, v43
    v_add_u32 v123, v123, v123
    v_pk_fma_f32 v[124:125], v[124:125], v[122:123], s[34:35] op_sel_hi:[1,0,1]
    v_pk_fma_f32 v[126:127], v[126:127], v[122:123], s[34:35] op_sel_hi:[1,0,1]
    v_lshl_add_u32 v124, v125, 16, v124
    v_lshl_add_u32 v125, v127, 16, v126
    s_waitcnt lgkmcnt(5)
    v_bitop3_b32 v115, v115, v116, v117 bitop3:0xfe
    v_lshl_add_u64 v[124:125], v[124:125], 0, s[36:37]
    v_cmpx_le_u32 vcc, 0x1000000, v69
    ds_add_rtn_u64 v[116:117], v123, v[124:125] offset:54272
    s_mov_b64 exec, -1
    v_ashrrev_i32 v122, 5, v70
    v_lshlrev_b16 v123, 2, v70
    v_lshlrev_b32 v124, 16, v44
    v_bitop3_b32 v122, v122, v113, v113 bitop3:0x0c
    v_and_b32 v125, 0xffff0000, v44
    v_lshlrev_b32 v126, 16, v45
    v_mul_f32 v122, v114, v122
    v_and_b32 v127, 0xffff0000, v45
    v_add_u32 v123, v123, v123
    v_pk_fma_f32 v[124:125], v[124:125], v[122:123], s[34:35] op_sel_hi:[1,0,1]
    v_pk_fma_f32 v[126:127], v[126:127], v[122:123], s[34:35] op_sel_hi:[1,0,1]
    v_lshl_add_u32 v124, v125, 16, v124
    v_lshl_add_u32 v125, v127, 16, v126
    s_waitcnt lgkmcnt(5)
    v_bitop3_b32 v115, v115, v118, v119 bitop3:0xfe
    v_lshl_add_u64 v[124:125], v[124:125], 0, s[36:37]
    v_cmpx_le_u32 vcc, 0x1000000, v70
    ds_add_rtn_u64 v[118:119], v123, v[124:125] offset:54272
    s_mov_b64 exec, -1
    v_ashrrev_i32 v122, 5, v71
    v_lshlrev_b16 v123, 2, v71
    v_lshlrev_b32 v124, 16, v46
    v_bitop3_b32 v122, v122, v113, v113 bitop3:0x0c
    v_and_b32 v125, 0xffff0000, v46
    v_lshlrev_b32 v126, 16, v47
    v_mul_f32 v122, v114, v122
    v_and_b32 v127, 0xffff0000, v47
    v_add_u32 v123, v123, v123
    v_pk_fma_f32 v[124:125], v[124:125], v[122:123], s[34:35] op_sel_hi:[1,0,1]
    v_pk_fma_f32 v[126:127], v[126:127], v[122:123], s[34:35] op_sel_hi:[1,0,1]
    v_lshl_add_u32 v124, v125, 16, v124
    v_lshl_add_u32 v125, v127, 16, v126
    s_waitcnt lgkmcnt(5)
    v_bitop3_b32 v115, v115, v120, v121 bitop3:0xfe
    v_lshl_add_u64 v[124:125], v[124:125], 0, s[36:37]
    v_cmpx_le_u32 vcc, 0x1000000, v71
    ds_add_rtn_u64 v[120:121], v123, v[124:125] offset:54272
    s_mov_b64 exec, -1
p2_na0a7:
    s_waitcnt vmcnt(11)
    v_perm_b32 v69, v101, v98, s31
    v_perm_b32 v70, v101, v99, s32
    v_perm_b32 v71, v101, v100, s33
    v_lshlrev_b16 v46, 3, v100
    v_lshlrev_b16 v44, 3, v99
    v_lshlrev_b16 v42, 3, v98
    s_cmp_le_u32 s16, 7
    s_cbranch_scc1 p2_g0r07
    v_cmpx_ge_u16 vcc, 0x3fff, v69
    ds_read_b64 v[42:43], v42
    s_mov_b64 exec, -1
    v_cmpx_ge_u16 vcc, 0x3fff, v70
    ds_read_b64 v[44:45], v44
    s_mov_b64 exec, -1
    v_cmpx_ge_u16 vcc, 0x3fff, v71
    ds_read_b64 v[46:47], v46
    s_mov_b64 exec, -1
p2_g0r07:
    s_waitcnt lgkmcnt(15)
    v_lshrrev_b32 v90, 3, v107
    v_lshrrev_b32 v91, 18, v107
    v_and_b32 v107, 0x3fff, v107
    v_and_or_b32 v90, v90, s65, v91
    v_mad_u32_u24 v107, v90, s63, v107
    buffer_load_dwordx4 v[90:93], v107, s[68:71], 0 offen
    s_waitcnt vmcnt(8)
    v_perm_b32 v48, v3, v0, s31
    v_perm_b32 v49, v3, v1, s32
    v_perm_b32 v50, v3, v2, s33
    v_lshlrev_b16 v4, 3, v2
    v_lshlrev_b16 v2, 3, v1
    v_lshlrev_b16 v0, 3, v0
    v_cmpx_ge_u16 vcc, 0x3fff, v48
    ds_read_b64 v[0:1], v0
    s_mov_b64 exec, -1
    v_cmpx_ge_u16 vcc, 0x3fff, v49
    ds_read_b64 v[2:3], v2
    s_mov_b64 exec, -1
    v_cmpx_ge_u16 vcc, 0x3fff, v50
    ds_read_b64 v[4:5], v4
    s_mov_b64 exec, -1
    s_waitcnt vmcnt(7)
    v_perm_b32 v51, v9, v6, s31
    v_perm_b32 v52, v9, v7, s32
    v_perm_b32 v53, v9, v8, s33
    v_lshlrev_b16 v10, 3, v8
    v_lshlrev_b16 v8, 3, v7
    v_lshlrev_b16 v6, 3, v6
    v_cmpx_ge_u16 vcc, 0x3fff, v51
    ds_read_b64 v[6:7], v6
    s_mov_b64 exec, -1
    v_cmpx_ge_u16 vcc, 0x3fff, v52
    ds_read_b64 v[8:9], v8
    s_mov_b64 exec, -1
    v_cmpx_ge_u16 vcc, 0x3fff, v53
    ds_read_b64 v[10:11], v10
    s_mov_b64 exec, -1
    s_waitcnt vmcnt(6)
    v_perm_b32 v54, v15, v12, s31
    v_perm_b32 v55, v15, v13, s32
    v_perm_b32 v56, v15, v14, s33
    v_lshlrev_b16 v16, 3, v14
    v_lshlrev_b16 v14, 3, v13
    v_lshlrev_b16 v12, 3, v12
    v_cmpx_ge_u16 vcc, 0x3fff, v54
    ds_read_b64 v[12:13], v12
    s_mov_b64 exec, -1
    v_cmpx_ge_u16 vcc, 0x3fff, v55
    ds_read_b64 v[14:15], v14
    s_mov_b64 exec, -1
    v_cmpx_ge_u16 vcc, 0x3fff, v56
    ds_read_b64 v[16:17], v16
    s_mov_b64 exec, -1
    s_waitcnt vmcnt(5)
    v_perm_b32 v57, v21, v18, s31
    v_perm_b32 v58, v21, v19, s32
    v_perm_b32 v59, v21, v20, s33
    v_lshlrev_b16 v22, 3, v20
    v_lshlrev_b16 v20, 3, v19
    v_lshlrev_b16 v18, 3, v18
    v_cmpx_ge_u16 vcc, 0x3fff, v57
    ds_read_b64 v[18:19], v18
    s_mov_b64 exec, -1
    v_cmpx_ge_u16 vcc, 0x3fff, v58
    ds_read_b64 v[20:21], v20
    s_mov_b64 exec, -1
    v_cmpx_ge_u16 vcc, 0x3fff, v59
    ds_read_b64 v[22:23], v22
    s_mov_b64 exec, -1
    s_waitcnt lgkmcnt(0)
    s_barrier
    s_waitcnt lgkmcnt(15)
    s_branch p2_tail
p2_drain0:
    v_cmpx_gt_i16 vcc, 0, v48
    ds_read_b64 v[0:1], v0
    s_mov_b64 exec, -1
    v_cmpx_gt_i16 vcc, 0, v49
    ds_read_b64 v[2:3], v2
    s_mov_b64 exec, -1
    v_cmpx_gt_i16 vcc, 0, v50
    ds_read_b64 v[4:5], v4
    s_mov_b64 exec, -1
    v_cmpx_gt_i16 vcc, 0, v51
    ds_read_b64 v[6:7], v6
    s_mov_b64 exec, -1
    v_cmpx_gt_i16 vcc, 0, v52
    ds_read_b64 v[8:9], v8
    s_mov_b64 exec, -1
    v_cmpx_gt_i16 vcc, 0, v53
    ds_read_b64 v[10:11], v10
    s_mov_b64 exec, -1
    v_cmpx_gt_i16 vcc, 0, v54
    ds_read_b64 v[12:13], v12
    s_mov_b64 exec, -1
    v_cmpx_gt_i16 vcc, 0, v55
    ds_read_b64 v[14:15], v14
    s_mov_b64 exec, -1
    v_cmpx_gt_i16 vcc, 0, v56
    ds_read_b64 v[16:17], v16
    s_mov_b64 exec, -1
    v_cmpx_gt_i16 vcc, 0, v57
    ds_read_b64 v[18:19], v18
    s_mov_b64 exec, -1
    v_cmpx_gt_i16 vcc, 0, v58
    ds_read_b64 v[20:21], v20
    s_mov_b64 exec, -1
    v_cmpx_gt_i16 vcc, 0, v59
    ds_read_b64 v[22:23], v22
    s_mov_b64 exec, -1
    v_cmpx_gt_i16 vcc, 0, v60
    ds_read_b64 v[24:25], v24
    s_mov_b64 exec, -1
    v_cmpx_gt_i16 vcc, 0, v61
    ds_read_b64 v[26:27], v26
    s_mov_b64 exec, -1
    v_cmpx_gt_i16 vcc, 0, v62
    ds_read_b64 v[28:29], v28
    s_mov_b64 exec, -1
    v_cmpx_gt_i16 vcc, 0, v63
    ds_read_b64 v[30:31], v30
    s_mov_b64 exec, -1
    v_cmpx_gt_i16 vcc, 0, v64
    ds_read_b64 v[32:33], v32
    s_mov_b64 exec, -1
    v_cmpx_gt_i16 vcc, 0, v65
    ds_read_b64 v[34:35], v34
    s_mov_b64 exec, -1
    v_cmpx_gt_i16 vcc, 0, v66
    ds_read_b64 v[36:37], v36
    s_mov_b64 exec, -1
    v_cmpx_gt_i16 vcc, 0, v67
    ds_read_b64 v[38:39], v38
    s_mov_b64 exec, -1
    v_cmpx_gt_i16 vcc, 0, v68
    ds_read_b64 v[40:41], v40
    s_mov_b64 exec, -1
    s_cmp_le_u32 s15, 7
    s_cbranch_scc1 p2_gd0
    v_cmpx_gt_i16 vcc, 0, v69
    ds_read_b64 v[42:43], v42
    s_mov_b64 exec, -1
    v_cmpx_gt_i16 vcc, 0, v70
    ds_read_b64 v[44:45], v44
    s_mov_b64 exec, -1
    v_cmpx_gt_i16 vcc, 0, v71
    ds_read_b64 v[46:47], v46
    s_mov_b64 exec, -1
p2_gd0:
    s_waitcnt lgkmcnt(15)
    v_ashrrev_i32 v122, 5, v48
    v_lshlrev_b16 v123, 2, v48
    v_lshlrev_b32 v124, 16, v0
    v_bitop3_b32 v122, v122, v113, v113 bitop3:0x0c
    v_and_b32 v125, 0xffff0000, v0
    v_lshlrev_b32 v126, 16, v1
    v_mul_f32 v122, v114, v122
    v_and_b32 v127, 0xffff0000, v1
    v_add_u32 v123, v123, v123
    v_pk_fma_f32 v[124:125], v[124:125], v[122:123], s[34:35] op_sel_hi:[1,0,1]
    v_pk_fma_f32 v[126:127], v[126:127], v[122:123], s[34:35] op_sel_hi:[1,0,1]
    v_lshl_add_u32 v124, v125, 16, v124
    v_lshl_add_u32 v125, v127, 16, v126
    s_waitcnt lgkmcnt(15)
    v_bitop3_b32 v115, v115, v116, v117 bitop3:0xfe
    v_lshl_add_u64 v[124:125], v[124:125], 0, s[36:37]
    v_cmpx_le_u32 vcc, 0x1000000, v48
    ds_add_rtn_u64 v[116:117], v123, v[124:125] offset:54272
    s_mov_b64 exec, -1
    v_ashrrev_i32 v122, 5, v49
    v_lshlrev_b16 v123, 2, v49
    v_lshlrev_b32 v124, 16, v2
    v_bitop3_b32 v122, v122, v113, v113 bitop3:0x0c
    v_and_b32 v125, 0xffff0000, v2
    v_lshlrev_b32 v126, 16, v3
    v_mul_f32 v122, v114, v122
    v_and_b32 v127, 0xffff0000, v3
    v_add_u32 v123, v123, v123
    v_pk_fma_f32 v[124:125], v[124:125], v[122:123], s[34:35] op_sel_hi:[1,0,1]
    v_pk_fma_f32 v[126:127], v[126:127], v[122:123], s[34:35] op_sel_hi:[1,0,1]
    v_lshl_add_u32 v124, v125, 16, v124
    v_lshl_add_u32 v125, v127, 16, v126
    s_waitcnt lgkmcnt(15)
    v_bitop3_b32 v115, v115, v118, v119 bitop3:0xfe
    v_lshl_add_u64 v[124:125], v[124:125], 0, s[36:37]
    v_cmpx_le_u32 vcc, 0x1000000, v49
    ds_add_rtn_u64 v[118:119], v123, v[124:125] offset:54272
    s_mov_b64 exec, -1
    v_ashrrev_i32 v122, 5, v50
    v_lshlrev_b16 v123, 2, v50
    v_lshlrev_b32 v124, 16, v4
    v_bitop3_b32 v122, v122, v113, v113 bitop3:0x0c
    v_and_b32 v125, 0xffff0000, v4
    v_lshlrev_b32 v126, 16, v5
    v_mul_f32 v122, v114, v122
    v_and_b32 v127, 0xffff0000, v5
    v_add_u32 v123, v123, v123
    v_pk_fma_f32 v[124:125], v[124:125], v[122:123], s[34:35] op_sel_hi:[1,0,1]
    v_pk_fma_f32 v[126:127], v[126:127], v[122:123], s[34:35] op_sel_hi:[1,0,1]
    v_lshl_add_u32 v124, v125, 16, v124
    v_lshl_add_u32 v125, v127, 16, v126
    s_waitcnt lgkmcnt(15)
    v_bitop3_b32 v115, v115, v120, v121 bitop3:0xfe
    v_lshl_add_u64 v[124:125], v[124:125], 0, s[36:37]
    v_cmpx_le_u32 vcc, 0x1000000, v50
    ds_add_rtn_u64 v[120:121], v123, v[124:125] offset:54272
    s_mov_b64 exec, -1
    s_waitcnt lgkmcnt(15)
    v_ashrrev_i32 v122, 5, v51
    v_lshlrev_b16 v123, 2, v51
    v_lshlrev_b32 v124, 16, v6
    v_bitop3_b32 v122, v122, v113, v113 bitop3:0x0c
    v_and_b32 v125, 0xffff0000, v6
    v_lshlrev_b32 v126, 16, v7
    v_mul_f32 v122, v114, v122
    v_and_b32 v127, 0xffff0000, v7
    v_add_u32 v123, v123, v123
    v_pk_fma_f32 v[124:125], v[124:125], v[122:123], s[34:35] op_sel_hi:[1,0,1]
    v_pk_fma_f32 v[126:127], v[126:127], v[122:123], s[34:35] op_sel_hi:[1,0,1]
    v_lshl_add_u32 v124, v125, 16, v124
    v_lshl_add_u32 v125, v127, 16, v126
    s_waitcnt lgkmcnt(2)
    v_bitop3_b32 v115, v115, v116, v117 bitop3:0xfe
    v_lshl_add_u64 v[124:125], v[124:125], 0, s[36:37]
    v_cmpx_le_u32 vcc, 0x1000000, v51
    ds_add_rtn_u64 v[116:117], v123, v[124:125] offset:54272
    s_mov_b64 exec, -1
    v_ashrrev_i32 v122, 5, v52
    v_lshlrev_b16 v123, 2, v52
    v_lshlrev_b32 v124, 16, v8
    v_bitop3_b32 v122, v122, v113, v113 bitop3:0x0c
    v_and_b32 v125, 0xffff0000, v8
    v_lshlrev_b32 v126, 16, v9
    v_mul_f32 v122, v114, v122
    v_and_b32 v127, 0xffff0000, v9
    v_add_u32 v123, v123, v123
    v_pk_fma_f32 v[124:125], v[124:125], v[122:123], s[34:35] op_sel_hi:[1,0,1]
    v_pk_fma_f32 v[126:127], v[126:127], v[122:123], s[34:35] op_sel_hi:[1,0,1]
    v_lshl_add_u32 v124, v125, 16, v124
    v_lshl_add_u32 v125, v127, 16, v126
    s_waitcnt lgkmcnt(2)
    v_bitop3_b32 v115, v115, v118, v119 bitop3:0xfe
    v_lshl_add_u64 v[124:125], v[124:125], 0, s[36:37]
    v_cmpx_le_u32 vcc, 0x1000000, v52
    ds_add_rtn_u64 v[118:119], v123, v[124:125] offset:54272
    s_mov_b64 exec, -1
    v_ashrrev_i32 v122, 5, v53
    v_lshlrev_b16 v123, 2, v53
    v_lshlrev_b32 v124, 16, v10
    v_bitop3_b32 v122, v122, v113, v113 bitop3:0x0c
    v_and_b32 v125, 0xffff0000, v10
    v_lshlrev_b32 v126, 16, v11
    v_mul_f32 v122, v114, v122
    v_and_b32 v127, 0xffff0000, v11
    v_add_u32 v123, v123, v123
    v_pk_fma_f32 v[124:125], v[124:125], v[122:123], s[34:35] op_sel_hi:[1,0,1]
    v_pk_fma_f32 v[126:127], v[126:127], v[122:123], s[34:35] op_sel_hi:[1,0,1]
    v_lshl_add_u32 v124, v125, 16, v124
    v_lshl_add_u32 v125, v127, 16, v126
    s_waitcnt lgkmcnt(2)
    v_bitop3_b32 v115, v115, v120, v121 bitop3:0xfe
    v_lshl_add_u64 v[124:125], v[124:125], 0, s[36:37]
    v_cmpx_le_u32 vcc, 0x1000000, v53
    ds_add_rtn_u64 v[120:121], v123, v[124:125] offset:54272
    s_mov_b64 exec, -1
    s_waitcnt lgkmcnt(15)
    v_ashrrev_i32 v122, 5, v54
    v_lshlrev_b16 v123, 2, v54
    v_lshlrev_b32 v124, 16, v12
    v_bitop3_b32 v122, v122, v113, v113 bitop3:0x0c
    v_and_b32 v125, 0xffff0000, v12
    v_lshlrev_b32 v126, 16, v13
    v_mul_f32 v122, v114, v122
    v_and_b32 v127, 0xffff0000, v13
    v_add_u32 v123, v123, v123
    v_pk_fma_f32 v[124:125], v[124:125], v[122:123], s[34:35] op_sel_hi:[1,0,1]
    v_pk_fma_f32 v[126:127], v[126:127], v[122:123], s[34:35] op_sel_hi:[1,0,1]
    v_lshl_add_u32 v124, v125, 16, v124
    v_lshl_add_u32 v125, v127, 16, v126
    s_waitcnt lgkmcnt(2)
    v_bitop3_b32 v115, v115, v116, v117 bitop3:0xfe
    v_lshl_add_u64 v[124:125], v[124:125], 0, s[36:37]
    v_cmpx_le_u32 vcc, 0x1000000, v54
    ds_add_rtn_u64 v[116:117], v123, v[124:125] offset:54272
    s_mov_b64 exec, -1
    v_ashrrev_i32 v122, 5, v55
    v_lshlrev_b16 v123, 2, v55
    v_lshlrev_b32 v124, 16, v14
    v_bitop3_b32 v122, v122, v113, v113 bitop3:0x0c
    v_and_b32 v125, 0xffff0000, v14
    v_lshlrev_b32 v126, 16, v15
    v_mul_f32 v122, v114, v122
    v_and_b32 v127, 0xffff0000, v15
    v_add_u32 v123, v123, v123
    v_pk_fma_f32 v[124:125], v[124:125], v[122:123], s[34:35] op_sel_hi:[1,0,1]
    v_pk_fma_f32 v[126:127], v[126:127], v[122:123], s[34:35] op_sel_hi:[1,0,1]
    v_lshl_add_u32 v124, v125, 16, v124
    v_lshl_add_u32 v125, v127, 16, v126
    s_waitcnt lgkmcnt(2)
    v_bitop3_b32 v115, v115, v118, v119 bitop3:0xfe
    v_lshl_add_u64 v[124:125], v[124:125], 0, s[36:37]
    v_cmpx_le_u32 vcc, 0x1000000, v55
    ds_add_rtn_u64 v[118:119], v123, v[124:125] offset:54272
    s_mov_b64 exec, -1
    v_ashrrev_i32 v122, 5, v56
    v_lshlrev_b16 v123, 2, v56
    v_lshlrev_b32 v124, 16, v16
    v_bitop3_b32 v122, v122, v113, v113 bitop3:0x0c
    v_and_b32 v125, 0xffff0000, v16
    v_lshlrev_b32 v126, 16, v17
    v_mul_f32 v122, v114, v122
    v_and_b32 v127, 0xffff0000, v17
    v_add_u32 v123, v123, v123
    v_pk_fma_f32 v[124:125], v[124:125], v[122:123], s[34:35] op_sel_hi:[1,0,1]
    v_pk_fma_f32 v[126:127], v[126:127], v[122:123], s[34:35] op_sel_hi:[1,0,1]
    v_lshl_add_u32 v124, v125, 16, v124
    v_lshl_add_u32 v125, v127, 16, v126
    s_waitcnt lgkmcnt(2)
    v_bitop3_b32 v115, v115, v120, v121 bitop3:0xfe
    v_lshl_add_u64 v[124:125], v[124:125], 0, s[36:37]
    v_cmpx_le_u32 vcc, 0x1000000, v56
    ds_add_rtn_u64 v[120:121], v123, v[124:125] offset:54272
    s_mov_b64 exec, -1
    s_waitcnt lgkmcnt(15)
    v_ashrrev_i32 v122, 5, v57
    v_lshlrev_b16 v123, 2, v57
    v_lshlrev_b32 v124, 16, v18
    v_bitop3_b32 v122, v122, v113, v113 bitop3:0x0c
    v_and_b32 v125, 0xffff0000, v18
    v_lshlrev_b32 v126, 16, v19
    v_mul_f32 v122, v114, v122
    v_and_b32 v127, 0xffff0000, v19
    v_add_u32 v123, v123, v123
    v_pk_fma_f32 v[124:125], v[124:125], v[122:123], s[34:35] op_sel_hi:[1,0,1]
    v_pk_fma_f32 v[126:127], v[126:127], v[122:123], s[34:35] op_sel_hi:[1,0,1]
    v_lshl_add_u32 v124, v125, 16, v124
    v_lshl_add_u32 v125, v127, 16, v126
    s_waitcnt lgkmcnt(2)
    v_bitop3_b32 v115, v115, v116, v117 bitop3:0xfe
    v_lshl_add_u64 v[124:125], v[124:125], 0, s[36:37]
    v_cmpx_le_u32 vcc, 0x1000000, v57
    ds_add_rtn_u64 v[116:117], v123, v[124:125] offset:54272
    s_mov_b64 exec, -1
    v_ashrrev_i32 v122, 5, v58
    v_lshlrev_b16 v123, 2, v58
    v_lshlrev_b32 v124, 16, v20
    v_bitop3_b32 v122, v122, v113, v113 bitop3:0x0c
    v_and_b32 v125, 0xffff0000, v20
    v_lshlrev_b32 v126, 16, v21
    v_mul_f32 v122, v114, v122
    v_and_b32 v127, 0xffff0000, v21
    v_add_u32 v123, v123, v123
    v_pk_fma_f32 v[124:125], v[124:125], v[122:123], s[34:35] op_sel_hi:[1,0,1]
    v_pk_fma_f32 v[126:127], v[126:127], v[122:123], s[34:35] op_sel_hi:[1,0,1]
    v_lshl_add_u32 v124, v125, 16, v124
    v_lshl_add_u32 v125, v127, 16, v126
    s_waitcnt lgkmcnt(2)
    v_bitop3_b32 v115, v115, v118, v119 bitop3:0xfe
    v_lshl_add_u64 v[124:125], v[124:125], 0, s[36:37]
    v_cmpx_le_u32 vcc, 0x1000000, v58
    ds_add_rtn_u64 v[118:119], v123, v[124:125] offset:54272
    s_mov_b64 exec, -1
    v_ashrrev_i32 v122, 5, v59
    v_lshlrev_b16 v123, 2, v59
    v_lshlrev_b32 v124, 16, v22
    v_bitop3_b32 v122, v122, v113, v113 bitop3:0x0c
    v_and_b32 v125, 0xffff0000, v22
    v_lshlrev_b32 v126, 16, v23
    v_mul_f32 v122, v114, v122
    v_and_b32 v127, 0xffff0000, v23
    v_add_u32 v123, v123, v123
    v_pk_fma_f32 v[124:125], v[124:125], v[122:123], s[34:35] op_sel_hi:[1,0,1]
    v_pk_fma_f32 v[126:127], v[126:127], v[122:123], s[34:35] op_sel_hi:[1,0,1]
    v_lshl_add_u32 v124, v125, 16, v124
    v_lshl_add_u32 v125, v127, 16, v126
    s_waitcnt lgkmcnt(2)
    v_bitop3_b32 v115, v115, v120, v121 bitop3:0xfe
    v_lshl_add_u64 v[124:125], v[124:125], 0, s[36:37]
    v_cmpx_le_u32 vcc, 0x1000000, v59
    ds_add_rtn_u64 v[120:121], v123, v[124:125] offset:54272
    s_mov_b64 exec, -1
    s_waitcnt lgkmcnt(15)
    v_ashrrev_i32 v122, 5, v60
    v_lshlrev_b16 v123, 2, v60
    v_lshlrev_b32 v124, 16, v24
    v_bitop3_b32 v122, v122, v113, v113 bitop3:0x0c
    v_and_b32 v125, 0xffff0000, v24
    v_lshlrev_b32 v126, 16, v25
    v_mul_f32 v122, v114, v122
    v_and_b32 v127, 0xffff0000, v25
    v_add_u32 v123, v123, v123
    v_pk_fma_f32 v[124:125], v[124:125], v[122:123], s[34:35] op_sel_hi:[1,0,1]
    v_pk_fma_f32 v[126:127], v[126:127], v[122:123], s[34:35] op_sel_hi:[1,0,1]
    v_lshl_add_u32 v124, v125, 16, v124
    v_lshl_add_u32 v125, v127, 16, v126
    s_waitcnt lgkmcnt(2)
    v_bitop3_b32 v115, v115, v116, v117 bitop3:0xfe
    v_lshl_add_u64 v[124:125], v[124:125], 0, s[36:37]
    v_cmpx_le_u32 vcc, 0x1000000, v60
    ds_add_rtn_u64 v[116:117], v123, v[124:125] offset:54272
    s_mov_b64 exec, -1
    v_ashrrev_i32 v122, 5, v61
    v_lshlrev_b16 v123, 2, v61
    v_lshlrev_b32 v124, 16, v26
    v_bitop3_b32 v122, v122, v113, v113 bitop3:0x0c
    v_and_b32 v125, 0xffff0000, v26
    v_lshlrev_b32 v126, 16, v27
    v_mul_f32 v122, v114, v122
    v_and_b32 v127, 0xffff0000, v27
    v_add_u32 v123, v123, v123
    v_pk_fma_f32 v[124:125], v[124:125], v[122:123], s[34:35] op_sel_hi:[1,0,1]
    v_pk_fma_f32 v[126:127], v[126:127], v[122:123], s[34:35] op_sel_hi:[1,0,1]
    v_lshl_add_u32 v124, v125, 16, v124
    v_lshl_add_u32 v125, v127, 16, v126
    s_waitcnt lgkmcnt(2)
    v_bitop3_b32 v115, v115, v118, v119 bitop3:0xfe
    v_lshl_add_u64 v[124:125], v[124:125], 0, s[36:37]
    v_cmpx_le_u32 vcc, 0x1000000, v61
    ds_add_rtn_u64 v[118:119], v123, v[124:125] offset:54272
    s_mov_b64 exec, -1
    v_ashrrev_i32 v122, 5, v62
    v_lshlrev_b16 v123, 2, v62
    v_lshlrev_b32 v124, 16, v28
    v_bitop3_b32 v122, v122, v113, v113 bitop3:0x0c
    v_and_b32 v125, 0xffff0000, v28
    v_lshlrev_b32 v126, 16, v29
    v_mul_f32 v122, v114, v122
    v_and_b32 v127, 0xffff0000, v29
    v_add_u32 v123, v123, v123
    v_pk_fma_f32 v[124:125], v[124:125], v[122:123], s[34:35] op_sel_hi:[1,0,1]
    v_pk_fma_f32 v[126:127], v[126:127], v[122:123], s[34:35] op_sel_hi:[1,0,1]
    v_lshl_add_u32 v124, v125, 16, v124
    v_lshl_add_u32 v125, v127, 16, v126
    s_waitcnt lgkmcnt(2)
    v_bitop3_b32 v115, v115, v120, v121 bitop3:0xfe
    v_lshl_add_u64 v[124:125], v[124:125], 0, s[36:37]
    v_cmpx_le_u32 vcc, 0x1000000, v62
    ds_add_rtn_u64 v[120:121], v123, v[124:125] offset:54272
    s_mov_b64 exec, -1
    s_waitcnt lgkmcnt(15)
    v_ashrrev_i32 v122, 5, v63
    v_lshlrev_b16 v123, 2, v63
    v_lshlrev_b32 v124, 16, v30
    v_bitop3_b32 v122, v122, v113, v113 bitop3:0x0c
    v_and_b32 v125, 0xffff0000, v30
    v_lshlrev_b32 v126, 16, v31
    v_mul_f32 v122, v114, v122
    v_and_b32 v127, 0xffff0000, v31
    v_add_u32 v123, v123, v123
    v_pk_fma_f32 v[124:125], v[124:125], v[122:123], s[34:35] op_sel_hi:[1,0,1]
    v_pk_fma_f32 v[126:127], v[126:127], v[122:123], s[34:35] op_sel_hi:[1,0,1]
    v_lshl_add_u32 v124, v125, 16, v124
    v_lshl_add_u32 v125, v127, 16, v126
    s_waitcnt lgkmcnt(2)
    v_bitop3_b32 v115, v115, v116, v117 bitop3:0xfe
    v_lshl_add_u64 v[124:125], v[124:125], 0, s[36:37]
    v_cmpx_le_u32 vcc, 0x1000000, v63
    ds_add_rtn_u64 v[116:117], v123, v[124:125] offset:54272
    s_mov_b64 exec, -1
    v_ashrrev_i32 v122, 5, v64
    v_lshlrev_b16 v123, 2, v64
    v_lshlrev_b32 v124, 16, v32
    v_bitop3_b32 v122, v122, v113, v113 bitop3:0x0c
    v_and_b32 v125, 0xffff0000, v32
    v_lshlrev_b32 v126, 16, v33
    v_mul_f32 v122, v114, v122
    v_and_b32 v127, 0xffff0000, v33
    v_add_u32 v123, v123, v123
    v_pk_fma_f32 v[124:125], v[124:125], v[122:123], s[34:35] op_sel_hi:[1,0,1]
    v_pk_fma_f32 v[126:127], v[126:127], v[122:123], s[34:35] op_sel_hi:[1,0,1]
    v_lshl_add_u32 v124, v125, 16, v124
    v_lshl_add_u32 v125, v127, 16, v126
    s_waitcnt lgkmcnt(2)
    v_bitop3_b32 v115, v115, v118, v119 bitop3:0xfe
    v_lshl_add_u64 v[124:125], v[124:125], 0, s[36:37]
    v_cmpx_le_u32 vcc, 0x1000000, v64
    ds_add_rtn_u64 v[118:119], v123, v[124:125] offset:54272
    s_mov_b64 exec, -1
    v_ashrrev_i32 v122, 5, v65
    v_lshlrev_b16 v123, 2, v65
    v_lshlrev_b32 v124, 16, v34
    v_bitop3_b32 v122, v122, v113, v113 bitop3:0x0c
    v_and_b32 v125, 0xffff0000, v34
    v_lshlrev_b32 v126, 16, v35
    v_mul_f32 v122, v114, v122
    v_and_b32 v127, 0xffff0000, v35
    v_add_u32 v123, v123, v123
    v_pk_fma_f32 v[124:125], v[124:125], v[122:123], s[34:35] op_sel_hi:[1,0,1]
    v_pk_fma_f32 v[126:127], v[126:127], v[122:123], s[34:35] op_sel_hi:[1,0,1]
    v_lshl_add_u32 v124, v125, 16, v124
    v_lshl_add_u32 v125, v127, 16, v126
    s_waitcnt lgkmcnt(2)
    v_bitop3_b32 v115, v115, v120, v121 bitop3:0xfe
    v_lshl_add_u64 v[124:125], v[124:125], 0, s[36:37]
    v_cmpx_le_u32 vcc, 0x1000000, v65
    ds_add_rtn_u64 v[120:121], v123, v[124:125] offset:54272
    s_mov_b64 exec, -1
    s_waitcnt lgkmcnt(15)
    v_ashrrev_i32 v122, 5, v66
    v_lshlrev_b16 v123, 2, v66
    v_lshlrev_b32 v124, 16, v36
    v_bitop3_b32 v122, v122, v113, v113 bitop3:0x0c
    v_and_b32 v125, 0xffff0000, v36
    v_lshlrev_b32 v126, 16, v37
    v_mul_f32 v122, v114, v122
    v_and_b32 v127, 0xffff0000, v37
    v_add_u32 v123, v123, v123
    v_pk_fma_f32 v[124:125], v[124:125], v[122:123], s[34:35] op_sel_hi:[1,0,1]
    v_pk_fma_f32 v[126:127], v[126:127], v[122:123], s[34:35] op_sel_hi:[1,0,1]
    v_lshl_add_u32 v124, v125, 16, v124
    v_lshl_add_u32 v125, v127, 16, v126
    s_waitcnt lgkmcnt(2)
    v_bitop3_b32 v115, v115, v116, v117 bitop3:0xfe
    v_lshl_add_u64 v[124:125], v[124:125], 0, s[36:37]
    v_cmpx_le_u32 vcc, 0x1000000, v66
    ds_add_rtn_u64 v[116:117], v123, v[124:125] offset:54272
    s_mov_b64 exec, -1
    v_ashrrev_i32 v122, 5, v67
    v_lshlrev_b16 v123, 2, v67
    v_lshlrev_b32 v124, 16, v38
    v_bitop3_b32 v122, v122, v113, v113 bitop3:0x0c
    v_and_b32 v125, 0xffff0000, v38
    v_lshlrev_b32 v126, 16, v39
    v_mul_f32 v122, v114, v122
    v_and_b32 v127, 0xffff0000, v39
    v_add_u32 v123, v123, v123
    v_pk_fma_f32 v[124:125], v[124:125], v[122:123], s[34:35] op_sel_hi:[1,0,1]
    v_pk_fma_f32 v[126:127], v[126:127], v[122:123], s[34:35] op_sel_hi:[1,0,1]
    v_lshl_add_u32 v124, v125, 16, v124
    v_lshl_add_u32 v125, v127, 16, v126
    s_waitcnt lgkmcnt(2)
    v_bitop3_b32 v115, v115, v118, v119 bitop3:0xfe
    v_lshl_add_u64 v[124:125], v[124:125], 0, s[36:37]
    v_cmpx_le_u32 vcc, 0x1000000, v67
    ds_add_rtn_u64 v[118:119], v123, v[124:125] offset:54272
    s_mov_b64 exec, -1
    v_ashrrev_i32 v122, 5, v68
    v_lshlrev_b16 v123, 2, v68
    v_lshlrev_b32 v124, 16, v40
    v_bitop3_b32 v122, v122, v113, v113 bitop3:0x0c
    v_and_b32 v125, 0xffff0000, v40
    v_lshlrev_b32 v126, 16, v41
    v_mul_f32 v122, v114, v122
    v_and_b32 v127, 0xffff0000, v41
    v_add_u32 v123, v123, v123
    v_pk_fma_f32 v[124:125], v[124:125], v[122:123], s[34:35] op_sel_hi:[1,0,1]
    v_pk_fma_f32 v[126:127], v[126:127], v[122:123], s[34:35] op_sel_hi:[1,0,1]
    v_lshl_add_u32 v124, v125, 16, v124
    v_lshl_add_u32 v125, v127, 16, v126
    s_waitcnt lgkmcnt(2)
    v_bitop3_b32 v115, v115, v120, v121 bitop3:0xfe
    v_lshl_add_u64 v[124:125], v[124:125], 0, s[36:37]
    v_cmpx_le_u32 vcc, 0x1000000, v68
    ds_add_rtn_u64 v[120:121], v123, v[124:125] offset:54272
    s_mov_b64 exec, -1
    s_cmp_le_u32 s15, 7
    s_cbranch_scc1 p2_nad0
    s_waitcnt lgkmcnt(15)
    v_ashrrev_i32 v122, 5, v69
    v_lshlrev_b16 v123, 2, v69
    v_lshlrev_b32 v124, 16, v42
    v_bitop3_b32 v122, v122, v113, v113 bitop3:0x0c
    v_and_b32 v125, 0xffff0000, v42
    v_lshlrev_b32 v126, 16, v43
    v_mul_f32 v122, v114, v122
    v_and_b32 v127, 0xffff0000, v43
    v_add_u32 v123, v123, v123
    v_pk_fma_f32 v[124:125], v[124:125], v[122:123], s[34:35] op_sel_hi:[1,0,1]
    v_pk_fma_f32 v[126:127], v[126:127], v[122:123], s[34:35] op_sel_hi:[1,0,1]
    v_lshl_add_u32 v124, v125, 16, v124
    v_lshl_add_u32 v125, v127, 16, v126
    s_waitcnt lgkmcnt(2)
    v_bitop3_b32 v115, v115, v116, v117 bitop3:0xfe
    v_lshl_add_u64 v[124:125], v[124:125], 0, s[36:37]
    v_cmpx_le_u32 vcc, 0x1000000, v69
    ds_add_rtn_u64 v[116:117], v123, v[124:125] offset:54272
    s_mov_b64 exec, -1
    v_ashrrev_i32 v122, 5, v70
    v_lshlrev_b16 v123, 2, v70
    v_lshlrev_b32 v124, 16, v44
    v_bitop3_b32 v122, v122, v113, v113 bitop3:0x0c
    v_and_b32 v125, 0xffff0000, v44
    v_lshlrev_b32 v126, 16, v45
    v_mul_f32 v122, v114, v122
    v_and_b32 v127, 0xffff0000, v45
    v_add_u32 v123, v123, v123
    v_pk_fma_f32 v[124:125], v[124:125], v[122:123], s[34:35] op_sel_hi:[1,0,1]
    v_pk_fma_f32 v[126:127], v[126:127], v[122:123], s[34:35] op_sel_hi:[1,0,1]
    v_lshl_add_u32 v124, v125, 16, v124
    v_lshl_add_u32 v125, v127, 16, v126
    s_waitcnt lgkmcnt(2)
    v_bitop3_b32 v115, v115, v118, v119 bitop3:0xfe
    v_lshl_add_u64 v[124:125], v[124:125], 0, s[36:37]
    v_cmpx_le_u32 vcc, 0x1000000, v70
    ds_add_rtn_u64 v[118:119], v123, v[124:125] offset:54272
    s_mov_b64 exec, -1
    v_ashrrev_i32 v122, 5, v71
    v_lshlrev_b16 v123, 2, v71
    v_lshlrev_b32 v124, 16, v46
    v_bitop3_b32 v122, v122, v113, v113 bitop3:0x0c
    v_and_b32 v125, 0xffff0000, v46
    v_lshlrev_b32 v126, 16, v47
    v_mul_f32 v122, v114, v122
    v_and_b32 v127, 0xffff0000, v47
    v_add_u32 v123, v123, v123
    v_pk_fma_f32 v[124:125], v[124:125], v[122:123], s[34:35] op_sel_hi:[1,0,1]
    v_pk_fma_f32 v[126:127], v[126:127], v[122:123], s[34:35] op_sel_hi:[1,0,1]
    v_lshl_add_u32 v124, v125, 16, v124
    v_lshl_add_u32 v125, v127, 16, v126
    s_waitcnt lgkmcnt(2)
    v_bitop3_b32 v115, v115, v120, v121 bitop3:0xfe
    v_lshl_add_u64 v[124:125], v[124:125], 0, s[36:37]
    v_cmpx_le_u32 vcc, 0x1000000, v71
    ds_add_rtn_u64 v[120:121], v123, v[124:125] offset:54272
    s_mov_b64 exec, -1
p2_nad0:
    s_branch p2_fin
p2_topf:
    s_cmp_eq_u32 s60, 10
    s_cbranch_scc1 p2_drain1
    v_cmpx_gt_i16 vcc, 0, v48
    ds_read_b64 v[0:1], v0
    s_mov_b64 exec, -1
    v_cmpx_gt_i16 vcc, 0, v49
    ds_read_b64 v[2:3], v2
    s_mov_b64 exec, -1
    v_cmpx_gt_i16 vcc, 0, v50
    ds_read_b64 v[4:5], v4
    s_mov_b64 exec, -1
    v_cmpx_gt_i16 vcc, 0, v51
    ds_read_b64 v[6:7], v6
    s_mov_b64 exec, -1
    v_cmpx_gt_i16 vcc, 0, v52
    ds_read_b64 v[8:9], v8
    s_mov_b64 exec, -1
    v_cmpx_gt_i16 vcc, 0, v53
    ds_read_b64 v[10:11], v10
    s_mov_b64 exec, -1
    v_cmpx_gt_i16 vcc, 0, v54
    ds_read_b64 v[12:13], v12
    s_mov_b64 exec, -1
    v_cmpx_gt_i16 vcc, 0, v55
    ds_read_b64 v[14:15], v14
    s_mov_b64 exec, -1
    v_cmpx_gt_i16 vcc, 0, v56
    ds_read_b64 v[16:17], v16
    s_mov_b64 exec, -1
    v_cmpx_gt_i16 vcc, 0, v57
    ds_read_b64 v[18:19], v18
    s_mov_b64 exec, -1
    v_cmpx_gt_i16 vcc, 0, v58
    ds_read_b64 v[20:21], v20
    s_mov_b64 exec, -1
    v_cmpx_gt_i16 vcc, 0, v59
    ds_read_b64 v[22:23], v22
    s_mov_b64 exec, -1
    s_cmp_ge_u32 s10, 9
    s_cbranch_scc1 p2_nm1m0
    v_lshrrev_b32 v84, 1, v112
    s_add_u32 s44, s20, s42
    buffer_load_dwordx2 v[84:85], v84, s[4:7], s44 offen
p2_nm1m0:
    buffer_load_dwordx4 v[72:75], v112, s[4:7], s20 offen offset:0
    buffer_load_dwordx4 v[76:79], v112, s[4:7], s20 offen offset:1024
    buffer_load_dwordx4 v[80:83], v112, s[4:7], s20 offen offset:2048
    v_cmpx_gt_i16 vcc, 0, v60
    ds_read_b64 v[24:25], v24
    s_mov_b64 exec, -1
    v_cmpx_gt_i16 vcc, 0, v61
    ds_read_b64 v[26:27], v26
    s_mov_b64 exec, -1
    v_cmpx_gt_i16 vcc, 0, v62
    ds_read_b64 v[28:29], v28
    s_mov_b64 exec, -1
    v_cmpx_gt_i16 vcc, 0, v63
    ds_read_b64 v[30:31], v30
    s_mov_b64 exec, -1
    v_cmpx_gt_i16 vcc, 0, v64
    ds_read_b64 v[32:33], v32
    s_mov_b64 exec, -1
    v_cmpx_gt_i16 vcc, 0, v65
    ds_read_b64 v[34:35], v34
    s_mov_b64 exec, -1
    v_cmpx_gt_i16 vcc, 0, v66
    ds_read_b64 v[36:37], v36
    s_mov_b64 exec, -1
    v_cmpx_gt_i16 vcc, 0, v67
    ds_read_b64 v[38:39], v38
    s_mov_b64 exec, -1
    v_cmpx_gt_i16 vcc, 0, v68
    ds_read_b64 v[40:41], v40
    s_mov_b64 exec, -1
    s_cmp_le_u32 s15, 7
    s_cbranch_scc1 p2_g1r27
    v_cmpx_gt_i16 vcc, 0, v69
    ds_read_b64 v[42:43], v42
    s_mov_b64 exec, -1
    v_cmpx_gt_i16 vcc, 0, v70
    ds_read_b64 v[44:45], v44
    s_mov_b64 exec, -1
    v_cmpx_gt_i16 vcc, 0, v71
    ds_read_b64 v[46:47], v46
    s_mov_b64 exec, -1
p2_g1r27:
    s_waitcnt lgkmcnt(15)
    v_ashrrev_i32 v122, 5, v48
    v_lshlrev_b16 v123, 2, v48
    v_cndmask_b32 v126, v0, v1, s[66:67]
    v_bitop3_b32 v122, v122, v113, v113 bitop3:0x0c
    v_lshlrev_b32 v124, 16, v126
    v_mul_f32 v122, v114, v122
    v_and_b32 v125, 0xffff0000, v126
    v_add_u32 v123, v123, v123
    v_mul_f32 v124, v122, v124
    v_mul_f32 v125, v122, v125
    v_cmpx_le_u32 vcc, 0x1000000, v48
    ds_add_f32 v123, v124 offset:54272
    ds_add_f32 v123, v125 offset:54276
    s_mov_b64 exec, -1
    v_ashrrev_i32 v122, 5, v49
    v_lshlrev_b16 v123, 2, v49
    v_cndmask_b32 v126, v2, v3, s[66:67]
    v_bitop3_b32 v122, v122, v113, v113 bitop3:0x0c
    v_lshlrev_b32 v124, 16, v126
    v_mul_f32 v122, v114, v122
    v_and_b32 v125, 0xffff0000, v126
    v_add_u32 v123, v123, v123
    v_mul_f32 v124, v122, v124
    v_mul_f32 v125, v122, v125
    v_cmpx_le_u32 vcc, 0x1000000, v49
    ds_add_f32 v123, v124 offset:54272
    ds_add_f32 v123, v125 offset:54276
    s_mov_b64 exec, -1
    v_ashrrev_i32 v122, 5, v50
    v_lshlrev_b16 v123, 2, v50
    v_cndmask_b32 v126, v4, v5, s[66:67]
    v_bitop3_b32 v122, v122, v113, v113 bitop3:0x0c
    v_lshlrev_b32 v124, 16, v126
    v_mul_f32 v122, v114, v122
    v_and_b32 v125, 0xffff0000, v126
    v_add_u32 v123, v123, v123
    v_mul_f32 v124, v122, v124
    v_mul_f32 v125, v122, v125
    v_cmpx_le_u32 vcc, 0x1000000, v50
    ds_add_f32 v123, v124 offset:54272
    ds_add_f32 v123, v125 offset:54276
    s_mov_b64 exec, -1
    v_lshrrev_b32 v0, 3, v102
    v_lshrrev_b32 v1, 18, v102
    v_and_b32 v102, 0x3fff, v102
    v_and_or_b32 v0, v0, s65, v1
    v_mad_u32_u24 v102, v0, s63, v102
    buffer_load_dwordx4 v[0:3], v102, s[68:71], 0 offen
    s_waitcnt lgkmcnt(15)
    v_ashrrev_i32 v122, 5, v51
    v_lshlrev_b16 v123, 2, v51
    v_cndmask_b32 v126, v6, v7, s[66:67]
    v_bitop3_b32 v122, v122, v113, v113 bitop3:0x0c
    v_lshlrev_b32 v124, 16, v126
    v_mul_f32 v122, v114, v122
    v_and_b32 v125, 0xffff0000, v126
    v_add_u32 v123, v123, v123
    v_mul_f32 v124, v122, v124
    v_mul_f32 v125, v122, v125
    v_cmpx_le_u32 vcc, 0x1000000, v51
    ds_add_f32 v123, v124 offset:54272
    ds_add_f32 v123, v125 offset:54276
    s_mov_b64 exec, -1
    v_ashrrev_i32 v122, 5, v52
    v_lshlrev_b16 v123, 2, v52
    v_cndmask_b32 v126, v8, v9, s[66:67]
    v_bitop3_b32 v122, v122, v113, v113 bitop3:0x0c
    v_lshlrev_b32 v124, 16, v126
    v_mul_f32 v122, v114, v122
    v_and_b32 v125, 0xffff0000, v126
    v_add_u32 v123, v123, v123
    v_mul_f32 v124, v122, v124
    v_mul_f32 v125, v122, v125
    v_cmpx_le_u32 vcc, 0x1000000, v52
    ds_add_f32 v123, v124 offset:54272
    ds_add_f32 v123, v125 offset:54276
    s_mov_b64 exec, -1
    v_ashrrev_i32 v122, 5, v53
    v_lshlrev_b16 v123, 2, v53
    v_cndmask_b32 v126, v10, v11, s[66:67]
    v_bitop3_b32 v122, v122, v113, v113 bitop3:0x0c
    v_lshlrev_b32 v124, 16, v126
    v_mul_f32 v122, v114, v122
    v_and_b32 v125, 0xffff0000, v126
    v_add_u32 v123, v123, v123
    v_mul_f32 v124, v122, v124
    v_mul_f32 v125, v122, v125
    v_cmpx_le_u32 vcc, 0x1000000, v53
    ds_add_f32 v123, v124 offset:54272
    ds_add_f32 v123, v125 offset:54276
    s_mov_b64 exec, -1
    v_lshrrev_b32 v6, 3, v103
    v_lshrrev_b32 v7, 18, v103
    v_and_b32 v103, 0x3fff, v103
    v_and_or_b32 v6, v6, s65, v7
    v_mad_u32_u24 v103, v6, s63, v103
    buffer_load_dwordx4 v[6:9], v103, s[68:71], 0 offen
    s_waitcnt lgkmcnt(12)
    s_barrier
    s_waitcnt lgkmcnt(15)
    v_ashrrev_i32 v122, 5, v54
    v_lshlrev_b16 v123, 2, v54
    v_cndmask_b32 v126, v12, v13, s[66:67]
    v_bitop3_b32 v122, v122, v113, v113 bitop3:0x0c
    v_lshlrev_b32 v124, 16, v126
    v_mul_f32 v122, v114, v122
    v_and_b32 v125, 0xffff0000, v126
    v_add_u32 v123, v123, v123
    v_mul_f32 v124, v122, v124
    v_mul_f32 v125, v122, v125
    v_cmpx_le_u32 vcc, 0x1000000, v54
    ds_add_f32 v123, v124 offset:54272
    ds_add_f32 v123, v125 offset:54276
    s_mov_b64 exec, -1
    v_ashrrev_i32 v122, 5, v55
    v_lshlrev_b16 v123, 2, v55
    v_cndmask_b32 v126, v14, v15, s[66:67]
    v_bitop3_b32 v122, v122, v113, v113 bitop3:0x0c
    v_lshlrev_b32 v124, 16, v126
    v_mul_f32 v122, v114, v122
    v_and_b32 v125, 0xffff0000, v126
    v_add_u32 v123, v123, v123
    v_mul_f32 v124, v122, v124
    v_mul_f32 v125, v122, v125
    v_cmpx_le_u32 vcc, 0x1000000, v55
    ds_add_f32 v123, v124 offset:54272
    ds_add_f32 v123, v125 offset:54276
    s_mov_b64 exec, -1
    v_ashrrev_i32 v122, 5, v56
    v_lshlrev_b16 v123, 2, v56
    v_cndmask_b32 v126, v16, v17, s[66:67]
    v_bitop3_b32 v122, v122, v113, v113 bitop3:0x0c
    v_lshlrev_b32 v124, 16, v126
    v_mul_f32 v122, v114, v122
    v_and_b32 v125, 0xffff0000, v126
    v_add_u32 v123, v123, v123
    v_mul_f32 v124, v122, v124
    v_mul_f32 v125, v122, v125
    v_cmpx_le_u32 vcc, 0x1000000, v56
    ds_add_f32 v123, v124 offset:54272
    ds_add_f32 v123, v125 offset:54276
    s_mov_b64 exec, -1
    v_lshrrev_b32 v12, 3, v104
    v_lshrrev_b32 v13, 18, v104
    v_and_b32 v104, 0x3fff, v104
    v_and_or_b32 v12, v12, s65, v13
    v_mad_u32_u24 v104, v12, s63, v104
    buffer_load_dwordx4 v[12:15], v104, s[68:71], 0 offen
    s_waitcnt lgkmcnt(15)
    v_ashrrev_i32 v122, 5, v57
    v_lshlrev_b16 v123, 2, v57
    v_cndmask_b32 v126, v18, v19, s[66:67]
    v_bitop3_b32 v122, v122, v113, v113 bitop3:0x0c
    v_lshlrev_b32 v124, 16, v126
    v_mul_f32 v122, v114, v122
    v_and_b32 v125, 0xffff0000, v126
    v_add_u32 v123, v123, v123
    v_mul_f32 v124, v122, v124
    v_mul_f32 v125, v122, v125
    v_cmpx_le_u32 vcc, 0x1000000, v57
    ds_add_f32 v123, v124 offset:54272
    ds_add_f32 v123, v125 offset:54276
    s_mov_b64 exec, -1
    v_ashrrev_i32 v122, 5, v58
    v_lshlrev_b16 v123, 2, v58
    v_cndmask_b32 v126, v20, v21, s[66:67]
    v_bitop3_b32 v122, v122, v113, v113 bitop3:0x0c
    v_lshlrev_b32 v124, 16, v126
    v_mul_f32 v122, v114, v122
    v_and_b32 v125, 0xffff0000, v126
    v_add_u32 v123, v123, v123
    v_mul_f32 v124, v122, v124
    v_mul_f32 v125, v122, v125
    v_cmpx_le_u32 vcc, 0x1000000, v58
    ds_add_f32 v123, v124 offset:54272
    ds_add_f32 v123, v125 offset:54276
    s_mov_b64 exec, -1
    v_ashrrev_i32 v122, 5, v59
    v_lshlrev_b16 v123, 2, v59
    v_cndmask_b32 v126, v22, v23, s[66:67]
    v_bitop3_b32 v122, v122, v113, v113 bitop3:0x0c
    v_lshlrev_b32 v124, 16, v126
    v_mul_f32 v122, v114, v122
    v_and_b32 v125, 0xffff0000, v126
    v_add_u32 v123, v123, v123
    v_mul_f32 v124, v122, v124
    v_mul_f32 v125, v122, v125
    v_cmpx_le_u32 vcc, 0x1000000, v59
    ds_add_f32 v123, v124 offset:54272
    ds_add_f32 v123, v125 offset:54276
    s_mov_b64 exec, -1
    v_lshrrev_b32 v18, 3, v105
    v_lshrrev_b32 v19, 18, v105
    v_and_b32 v105, 0x3fff, v105
    v_and_or_b32 v18, v18, s65, v19
    v_mad_u32_u24 v105, v18, s63, v105
    buffer_load_dwordx4 v[18:21], v105, s[68:71], 0 offen
    s_mov_b32 m0, s23
    v_mov_b32 v53, 0x3c000
    s_movk_i32 s44, 512
    v_sub_u32_sdwa v4, v111, v110 dst_sel:DWORD dst_unused:UNUSED_PAD src0_sel:WORD_0 src1_sel:WORD_0
    v_sub_u32_sdwa v5, v111, v110 dst_sel:DWORD dst_unused:UNUSED_PAD src0_sel:WORD_1 src1_sel:WORD_1
    v_med3_i32 v4, v4, 0, s44
    v_med3_i32 v5, v5, 0, s44
    v_add_u32 v48, v4, v5
    ds_write_addtid_b32 v53 offset:0
    ds_write_addtid_b32 v53 offset:256
    ds_write_addtid_b32 v53 offset:512
    ds_write_addtid_b32 v53 offset:768
    ds_write_addtid_b32 v53 offset:1024
    ds_write_addtid_b32 v53 offset:1280
    ds_write_addtid_b32 v53 offset:1536
    ds_write_addtid_b32 v53 offset:1792
    v_and_b32 v49, 0x30, v112
    v_lshrrev_b32 v53, 6, v112
    v_lshl_or_b32 v53, v49, 5, v53
    v_lshl_add_u32 v53, v53, 18, s41
    s_nop 1
    v_add_u32_dpp v48, v48, v48 row_shr:1 row_mask:0xf bank_mask:0xf bound_ctrl:0
    s_nop 1
    v_add_u32_dpp v48, v48, v48 row_shr:2 row_mask:0xf bank_mask:0xf bound_ctrl:0
    s_nop 1
    v_add_u32_dpp v48, v48, v48 row_shr:4 row_mask:0xf bank_mask:0xf bound_ctrl:0
    s_nop 1
    v_add_u32_dpp v48, v48, v48 row_shr:8 row_mask:0xf bank_mask:0xf bound_ctrl:0
    s_nop 1
    v_add_u32_dpp v48, v48, v48 row_bcast:15 row_mask:0xa bank_mask:0xf
    s_nop 1
    v_add_u32_dpp v48, v48, v48 row_bcast:31 row_mask:0xc bank_mask:0xf
    s_nop 1
    s_nop 0
    v_readlane_b32 s38, v48, 63
    v_sub_u32 v50, v48, v5
    v_sub_u32 v49, v50, v4
    v_sub_u32 v10, 512, v49
    v_mad_u32_u16 v51, v110, 16, v53
    v_med3_i32 v10, v10, 0, v4
    v_lshl_add_u32 v49, v49, 2, s23
    v_sub_u32 v11, 512, v50
    v_mad_u32_u16 v52, v110, 16, v53 op_sel:[1,0,0,0]
    v_med3_i32 v11, v11, 0, v5
    v_lshl_add_u32 v50, v50, 2, s23
    v_lshl_add_u32 v48, v11, 16, v10
    v_add_u32 v52, 67108864, v52
    v_add_u32 v110, v110, v48
    s_min_u32 s17, s38, 512
    s_add_u32 s17, s17, 63
    s_lshr_b32 s17, s17, 6
p2_x1x_0:
    v_cmpx_lt_i32 vcc, 0, v10
    s_cbranch_execz p2_y1x_0
    ds_write_b32 v49, v51 offset:0
    v_add_u32 v51, 16, v51
    v_cmpx_lt_i32 vcc, 1, v10
    s_cbranch_execz p2_y1x_0
    ds_write_b32 v49, v51 offset:4
    v_add_u32 v51, 16, v51
    v_cmpx_lt_i32 vcc, 2, v10
    s_cbranch_execz p2_y1x_0
    ds_write_b32 v49, v51 offset:8
    v_add_u32 v51, 16, v51
    v_cmpx_lt_i32 vcc, 3, v10
    s_cbranch_execz p2_y1x_0
    ds_write_b32 v49, v51 offset:12
    v_add_u32 v51, 16, v51
    v_cmpx_lt_i32 vcc, 4, v10
    s_cbranch_execz p2_y1x_0
    ds_write_b32 v49, v51 offset:16
    v_add_u32 v51, 16, v51
    v_cmpx_lt_i32 vcc, 5, v10
    s_cbranch_execz p2_y1x_0
    ds_write_b32 v49, v51 offset:20
    v_add_u32 v51, 16, v51
    v_cmpx_lt_i32 vcc, 6, v10
    s_cbranch_execz p2_y1x_0
    ds_write_b32 v49, v51 offset:24
    v_add_u32 v51, 16, v51
    v_cmpx_lt_i32 vcc, 7, v10
    s_cbranch_execz p2_y1x_0
    ds_write_b32 v49, v51 offset:28
    v_add_u32 v51, 16, v51
    v_subrev_u32 v10, 8, v10
    v_add_u32 v49, 32, v49
    s_branch p2_x1x_0
p2_y1x_0:
    s_mov_b64 exec, -1
p2_x1x_1:
    v_cmpx_lt_i32 vcc, 0, v11
    s_cbranch_execz p2_y1x_1
    ds_write_b32 v50, v52 offset:0
    v_add_u32 v52, 16, v52
    v_cmpx_lt_i32 vcc, 1, v11
    s_cbranch_execz p2_y1x_1
    ds_write_b32 v50, v52 offset:4
    v_add_u32 v52, 16, v52
    v_cmpx_lt_i32 vcc, 2, v11
    s_cbranch_execz p2_y1x_1
    ds_write_b32 v50, v52 offset:8
    v_add_u32 v52, 16, v52
    v_cmpx_lt_i32 vcc, 3, v11
    s_cbranch_execz p2_y1x_1
    ds_write_b32 v50, v52 offset:12
    v_add_u32 v52, 16, v52
    v_cmpx_lt_i32 vcc, 4, v11
    s_cbranch_execz p2_y1x_1
    ds_write_b32 v50, v52 offset:16
    v_add_u32 v52, 16, v52
    v_cmpx_lt_i32 vcc, 5, v11
    s_cbranch_execz p2_y1x_1
    ds_write_b32 v50, v52 offset:20
    v_add_u32 v52, 16, v52
    v_cmpx_lt_i32 vcc, 6, v11
    s_cbranch_execz p2_y1x_1
    ds_write_b32 v50, v52 offset:24
    v_add_u32 v52, 16, v52
    v_cmpx_lt_i32 vcc, 7, v11
    s_cbranch_execz p2_y1x_1
    ds_write_b32 v50, v52 offset:28
    v_add_u32 v52, 16, v52
    v_subrev_u32 v11, 8, v11
    v_add_u32 v50, 32, v50
    s_branch p2_x1x_1
p2_y1x_1:
    s_mov_b64 exec, -1
    s_cmp_lt_u32 s38, 512
    s_cbranch_scc1 p2_nomore1x
    v_cmp_lt_u32_sdwa s[44:45], v110, v111 src0_sel:WORD_0 src1_sel:WORD_0
    v_cmp_lt_u32_sdwa s[46:47], v110, v111 src0_sel:WORD_1 src1_sel:WORD_1
    s_nop 0
    s_or_b64 s[44:45], s[44:45], s[46:47]
    s_cbranch_scc0 p2_nomore1x
    v_mov_b32 v49, s19
    v_mov_b32 v50, 1
    ds_write_b32 v49, v50 offset:53760
p2_nomore1x:
    s_mov_b32 m0, s23
    s_nop 0
    ds_read_addtid_b32 v102 offset:0
    ds_read_addtid_b32 v103 offset:256
    ds_read_addtid_b32 v104 offset:512
    ds_read_addtid_b32 v105 offset:768
    ds_read_addtid_b32 v106 offset:1024
    ds_read_addtid_b32 v107 offset:1280
    ds_read_addtid_b32 v108 offset:1536
    ds_read_addtid_b32 v109 offset:1792
    s_waitcnt vmcnt(4)
    s_mov_b32 m0, s24
    s_cmp_ge_u32 s10, 9
    s_cbranch_scc1 p2_st1s0
    ds_write_addtid_b32 v84 offset:49152
    ds_write_addtid_b32 v85 offset:49408
p2_st1s0:
    s_mov_b32 m0, s23
    s_add_u32 s20, s20, 53760
    ds_write_addtid_b32 v72 offset:0
    ds_write_addtid_b32 v73 offset:256
    ds_write_addtid_b32 v74 offset:512
    ds_write_addtid_b32 v75 offset:768
    ds_write_addtid_b32 v76 offset:1024
    ds_write_addtid_b32 v77 offset:1280
    ds_write_addtid_b32 v78 offset:1536
    ds_write_addtid_b32 v79 offset:1792
    ds_write_addtid_b32 v80 offset:2048
    ds_write_addtid_b32 v81 offset:2304
    ds_write_addtid_b32 v82 offset:2560
    ds_write_addtid_b32 v83 offset:2816
    s_waitcnt lgkmcnt(15)
    v_ashrrev_i32 v122, 5, v60
    v_lshlrev_b16 v123, 2, v60
    v_cndmask_b32 v126, v24, v25, s[66:67]
    v_bitop3_b32 v122, v122, v113, v113 bitop3:0x0c
    v_lshlrev_b32 v124, 16, v126
    v_mul_f32 v122, v114, v122
    v_and_b32 v125, 0xffff0000, v126
    v_add_u32 v123, v123, v123
    v_mul_f32 v124, v122, v124
    v_mul_f32 v125, v122, v125
    v_cmpx_le_u32 vcc, 0x1000000, v60
    ds_add_f32 v123, v124 offset:54272
    ds_add_f32 v123, v125 offset:54276
    s_mov_b64 exec, -1
    v_ashrrev_i32 v122, 5, v61
    v_lshlrev_b16 v123, 2, v61
    v_cndmask_b32 v126, v26, v27, s[66:67]
    v_bitop3_b32 v122, v122, v113, v113 bitop3:0x0c
    v_lshlrev_b32 v124, 16, v126
    v_mul_f32 v122, v114, v122
    v_and_b32 v125, 0xffff0000, v126
    v_add_u32 v123, v123, v123
    v_mul_f32 v124, v122, v124
    v_mul_f32 v125, v122, v125
    v_cmpx_le_u32 vcc, 0x1000000, v61
    ds_add_f32 v123, v124 offset:54272
    ds_add_f32 v123, v125 offset:54276
    s_mov_b64 exec, -1
    v_ashrrev_i32 v122, 5, v62
    v_lshlrev_b16 v123, 2, v62
    v_cndmask_b32 v126, v28, v29, s[66:67]
    v_bitop3_b32 v122, v122, v113, v113 bitop3:0x0c
    v_lshlrev_b32 v124, 16, v126
    v_mul_f32 v122, v114, v122
    v_and_b32 v125, 0xffff0000, v126
    v_add_u32 v123, v123, v123
    v_mul_f32 v124, v122, v124
    v_mul_f32 v125, v122, v125
    v_cmpx_le_u32 vcc, 0x1000000, v62
    ds_add_f32 v123, v124 offset:54272
    ds_add_f32 v123, v125 offset:54276
    s_mov_b64 exec, -1
    s_waitcnt vmcnt(13)
    v_perm_b32 v60, v89, v86, s31
    v_perm_b32 v61, v89, v87, s32
    v_perm_b32 v62, v89, v88, s33
    v_lshlrev_b16 v28, 3, v88
    v_lshlrev_b16 v26, 3, v87
    v_lshlrev_b16 v24, 3, v86
    s_waitcnt lgkmcnt(6)
    s_barrier
    s_cmp_ge_u32 s10, 9
    s_cbranch_scc1 p2_nm1m1
    v_lshrrev_b32 v84, 1, v112
    s_add_u32 s44, s20, s42
    buffer_load_dwordx2 v[84:85], v84, s[4:7], s44 offen
p2_nm1m1:
    buffer_load_dwordx4 v[72:75], v112, s[4:7], s20 offen offset:0
    buffer_load_dwordx4 v[76:79], v112, s[4:7], s20 offen offset:1024
    buffer_load_dwordx4 v[80:83], v112, s[4:7], s20 offen offset:2048
    v_cmpx_ge_u16 vcc, 0x3fff, v60
    ds_read_b64 v[24:25], v24
    s_mov_b64 exec, -1
    v_cmpx_ge_u16 vcc, 0x3fff, v61
    ds_read_b64 v[26:27], v26
    s_mov_b64 exec, -1
    v_cmpx_ge_u16 vcc, 0x3fff, v62
    ds_read_b64 v[28:29], v28
    s_mov_b64 exec, -1
    s_waitcnt lgkmcnt(15)
    v_ashrrev_i32 v122, 5, v63
    v_lshlrev_b16 v123, 2, v63
    v_cndmask_b32 v126, v30, v31, s[66:67]
    v_bitop3_b32 v122, v122, v113, v113 bitop3:0x0c
    v_lshlrev_b32 v124, 16, v126
    v_mul_f32 v122, v114, v122
    v_and_b32 v125, 0xffff0000, v126
    v_add_u32 v123, v123, v123
    v_mul_f32 v124, v122, v124
    v_mul_f32 v125, v122, v125
    v_cmpx_le_u32 vcc, 0x1000000, v63
    ds_add_f32 v123, v124 offset:54272
    ds_add_f32 v123, v125 offset:54276
    s_mov_b64 exec, -1
    v_ashrrev_i32 v122, 5, v64
    v_lshlrev_b16 v123, 2, v64
    v_cndmask_b32 v126, v32, v33, s[66:67]
    v_bitop3_b32 v122, v122, v113, v113 bitop3:0x0c
    v_lshlrev_b32 v124, 16, v126
    v_mul_f32 v122, v114, v122
    v_and_b32 v125, 0xffff0000, v126
    v_add_u32 v123, v123, v123
    v_mul_f32 v124, v122, v124
    v_mul_f32 v125, v122, v125
    v_cmpx_le_u32 vcc, 0x1000000, v64
    ds_add_f32 v123, v124 offset:54272
    ds_add_f32 v123, v125 offset:54276
    s_mov_b64 exec, -1
    v_ashrrev_i32 v122, 5, v65
    v_lshlrev_b16 v123, 2, v65
    v_cndmask_b32 v126, v34, v35, s[66:67]
    v_bitop3_b32 v122, v122, v113, v113 bitop3:0x0c
    v_lshlrev_b32 v124, 16, v126
    v_mul_f32 v122, v114, v122
    v_and_b32 v125, 0xffff0000, v126
    v_add_u32 v123, v123, v123
    v_mul_f32 v124, v122, v124
    v_mul_f32 v125, v122, v125
    v_cmpx_le_u32 vcc, 0x1000000, v65
    ds_add_f32 v123, v124 offset:54272
    ds_add_f32 v123, v125 offset:54276
    s_mov_b64 exec, -1
    s_waitcnt vmcnt(15)
    v_perm_b32 v63, v93, v90, s31
    v_perm_b32 v64, v93, v91, s32
    v_perm_b32 v65, v93, v92, s33
    v_lshlrev_b16 v34, 3, v92
    v_lshlrev_b16 v32, 3, v91
    v_lshlrev_b16 v30, 3, v90
    v_cmpx_ge_u16 vcc, 0x3fff, v63
    ds_read_b64 v[30:31], v30
    s_mov_b64 exec, -1
    v_cmpx_ge_u16 vcc, 0x3fff, v64
    ds_read_b64 v[32:33], v32
    s_mov_b64 exec, -1
    v_cmpx_ge_u16 vcc, 0x3fff, v65
    ds_read_b64 v[34:35], v34
    s_mov_b64 exec, -1
    s_waitcnt lgkmcnt(15)
    v_lshrrev_b32 v86, 3, v106
    v_lshrrev_b32 v87, 18, v106
    v_and_b32 v106, 0x3fff, v106
    v_and_or_b32 v86, v86, s65, v87
    v_mad_u32_u24 v106, v86, s63, v106
    buffer_load_dwordx4 v[86:89], v106, s[68:71], 0 offen
    s_waitcnt lgkmcnt(15)
    v_ashrrev_i32 v122, 5, v66
    v_lshlrev_b16 v123, 2, v66
    v_cndmask_b32 v126, v36, v37, s[66:67]
    v_bitop3_b32 v122, v122, v113, v113 bitop3:0x0c
    v_lshlrev_b32 v124, 16, v126
    v_mul_f32 v122, v114, v122
    v_and_b32 v125, 0xffff0000, v126
    v_add_u32 v123, v123, v123
    v_mul_f32 v124, v122, v124
    v_mul_f32 v125, v122, v125
    v_cmpx_le_u32 vcc, 0x1000000, v66
    ds_add_f32 v123, v124 offset:54272
    ds_add_f32 v123, v125 offset:54276
    s_mov_b64 exec, -1
    v_ashrrev_i32 v122, 5, v67
    v_lshlrev_b16 v123, 2, v67
    v_cndmask_b32 v126, v38, v39, s[66:67]
    v_bitop3_b32 v122, v122, v113, v113 bitop3:0x0c
    v_lshlrev_b32 v124, 16, v126
    v_mul_f32 v122, v114, v122
    v_and_b32 v125, 0xffff0000, v126
    v_add_u32 v123, v123, v123
    v_mul_f32 v124, v122, v124
    v_mul_f32 v125, v122, v125
    v_cmpx_le_u32 vcc, 0x1000000, v67
    ds_add_f32 v123, v124 offset:54272
    ds_add_f32 v123, v125 offset:54276
    s_mov_b64 exec, -1
    v_ashrrev_i32 v122, 5, v68
    v_lshlrev_b16 v123, 2, v68
    v_cndmask_b32 v126, v40, v41, s[66:67]
    v_bitop3_b32 v122, v122, v113, v113 bitop3:0x0c
    v_lshlrev_b32 v124, 16, v126
    v_mul_f32 v122, v114, v122
    v_and_b32 v125, 0xffff0000, v126
    v_add_u32 v123, v123, v123
    v_mul_f32 v124, v122, v124
    v_mul_f32 v125, v122, v125
    v_cmpx_le_u32 vcc, 0x1000000, v68
    ds_add_f32 v123, v124 offset:54272
    ds_add_f32 v123, v125 offset:54276
    s_mov_b64 exec, -1
    s_waitcnt vmcnt(12)
    v_perm_b32 v66, v97, v94, s31
    v_perm_b32 v67, v97, v95, s32
    v_perm_b32 v68, v97, v96, s33
    v_lshlrev_b16 v40, 3, v96
    v_lshlrev_b16 v38, 3, v95
    v_lshlrev_b16 v36, 3, v94
    v_cmpx_ge_u16 vcc, 0x3fff, v66
    ds_read_b64 v[36:37], v36
    s_mov_b64 exec, -1
    v_cmpx_ge_u16 vcc, 0x3fff, v67
    ds_read_b64 v[38:39], v38
    s_mov_b64 exec, -1
    v_cmpx_ge_u16 vcc, 0x3fff, v68
    ds_read_b64 v[40:41], v40
    s_mov_b64 exec, -1
    s_cmp_le_u32 s15, 7
    s_cbranch_scc1 p2_na1a7
    s_waitcnt lgkmcnt(15)
    v_ashrrev_i32 v122, 5, v69
    v_lshlrev_b16 v123, 2, v69
    v_cndmask_b32 v126, v42, v43, s[66:67]
    v_bitop3_b32 v122, v122, v113, v113 bitop3:0x0c
    v_lshlrev_b32 v124, 16, v126
    v_mul_f32 v122, v114, v122
    v_and_b32 v125, 0xffff0000, v126
    v_add_u32 v123, v123, v123
    v_mul_f32 v124, v122, v124
    v_mul_f32 v125, v122, v125
    v_cmpx_le_u32 vcc, 0x1000000, v69
    ds_add_f32 v123, v124 offset:54272
    ds_add_f32 v123, v125 offset:54276
    s_mov_b64 exec, -1
    v_ashrrev_i32 v122, 5, v70
    v_lshlrev_b16 v123, 2, v70
    v_cndmask_b32 v126, v44, v45, s[66:67]
    v_bitop3_b32 v122, v122, v113, v113 bitop3:0x0c
    v_lshlrev_b32 v124, 16, v126
    v_mul_f32 v122, v114, v122
    v_and_b32 v125, 0xffff0000, v126
    v_add_u32 v123, v123, v123
    v_mul_f32 v124, v122, v124
    v_mul_f32 v125, v122, v125
    v_cmpx_le_u32 vcc, 0x1000000, v70
    ds_add_f32 v123, v124 offset:54272
    ds_add_f32 v123, v125 offset:54276
    s_mov_b64 exec, -1
    v_ashrrev_i32 v122, 5, v71
    v_lshlrev_b16 v123, 2, v71
    v_cndmask_b32 v126, v46, v47, s[66:67]
    v_bitop3_b32 v122, v122, v113, v113 bitop3:0x0c
    v_lshlrev_b32 v124, 16, v126
    v_mul_f32 v122, v114, v122
    v_and_b32 v125, 0xffff0000, v126
    v_add_u32 v123, v123, v123
    v_mul_f32 v124, v122, v124
    v_mul_f32 v125, v122, v125
    v_cmpx_le_u32 vcc, 0x1000000, v71
    ds_add_f32 v123, v124 offset:54272
    ds_add_f32 v123, v125 offset:54276
    s_mov_b64 exec, -1
p2_na1a7:
    s_waitcnt vmcnt(11)
    v_perm_b32 v69, v101, v98, s31
    v_perm_b32 v70, v101, v99, s32
    v_perm_b32 v71, v101, v100, s33
    v_lshlrev_b16 v46, 3, v100
    v_lshlrev_b16 v44, 3, v99
    v_lshlrev_b16 v42, 3, v98
    s_cmp_le_u32 s16, 7
    s_cbranch_scc1 p2_g1r07
    v_cmpx_ge_u16 vcc, 0x3fff, v69
    ds_read_b64 v[42:43], v42
    s_mov_b64 exec, -1
    v_cmpx_ge_u16 vcc, 0x3fff, v70
    ds_read_b64 v[44:45], v44
    s_mov_b64 exec, -1
    v_cmpx_ge_u16 vcc, 0x3fff, v71
    ds_read_b64 v[46:47], v46
    s_mov_b64 exec, -1
p2_g1r07:
    s_waitcnt lgkmcnt(15)
    v_lshrrev_b32 v90, 3, v107
    v_lshrrev_b32 v91, 18, v107
    v_and_b32 v107, 0x3fff, v107
    v_and_or_b32 v90, v90, s65, v91
    v_mad_u32_u24 v107, v90, s63, v107
    buffer_load_dwordx4 v[90:93], v107, s[68:71], 0 offen
    s_waitcnt vmcnt(8)
    v_perm_b32 v48, v3, v0, s31
    v_perm_b32 v49, v3, v1, s32
    v_perm_b32 v50, v3, v2, s33
    v_lshlrev_b16 v4, 3, v2
    v_lshlrev_b16 v2, 3, v1
    v_lshlrev_b16 v0, 3, v0
    v_cmpx_ge_u16 vcc, 0x3fff, v48
    ds_read_b64 v[0:1], v0
    s_mov_b64 exec, -1
    v_cmpx_ge_u16 vcc, 0x3fff, v49
    ds_read_b64 v[2:3], v2
    s_mov_b64 exec, -1
    v_cmpx_ge_u16 vcc, 0x3fff, v50
    ds_read_b64 v[4:5], v4
    s_mov_b64 exec, -1
    s_waitcnt vmcnt(7)
    v_perm_b32 v51, v9, v6, s31
    v_perm_b32 v52, v9, v7, s32
    v_perm_b32 v53, v9, v8, s33
    v_lshlrev_b16 v10, 3, v8
    v_lshlrev_b16 v8, 3, v7
    v_lshlrev_b16 v6, 3, v6
    v_cmpx_ge_u16 vcc, 0x3fff, v51
    ds_read_b64 v[6:7], v6
    s_mov_b64 exec, -1
    v_cmpx_ge_u16 vcc, 0x3fff, v52
    ds_read_b64 v[8:9], v8
    s_mov_b64 exec, -1
    v_cmpx_ge_u16 vcc, 0x3fff, v53
    ds_read_b64 v[10:11], v10
    s_mov_b64 exec, -1
    s_waitcnt vmcnt(6)
    v_perm_b32 v54, v15, v12, s31
    v_perm_b32 v55, v15, v13, s32
    v_perm_b32 v56, v15, v14, s33
    v_lshlrev_b16 v16, 3, v14
    v_lshlrev_b16 v14, 3, v13
    v_lshlrev_b16 v12, 3, v12
    v_cmpx_ge_u16 vcc, 0x3fff, v54
    ds_read_b64 v[12:13], v12
    s_mov_b64 exec, -1
    v_cmpx_ge_u16 vcc, 0x3fff, v55
    ds_read_b64 v[14:15], v14
    s_mov_b64 exec, -1
    v_cmpx_ge_u16 vcc, 0x3fff, v56
    ds_read_b64 v[16:17], v16
    s_mov_b64 exec, -1
    s_waitcnt vmcnt(5)
    v_perm_b32 v57, v21, v18, s31
    v_perm_b32 v58, v21, v19, s32
    v_perm_b32 v59, v21, v20, s33
    v_lshlrev_b16 v22, 3, v20
    v_lshlrev_b16 v20, 3, v19
    v_lshlrev_b16 v18, 3, v18
    v_cmpx_ge_u16 vcc, 0x3fff, v57
    ds_read_b64 v[18:19], v18
    s_mov_b64 exec, -1
    v_cmpx_ge_u16 vcc, 0x3fff, v58
    ds_read_b64 v[20:21], v20
    s_mov_b64 exec, -1
    v_cmpx_ge_u16 vcc, 0x3fff, v59
    ds_read_b64 v[22:23], v22
    s_mov_b64 exec, -1
    s_waitcnt lgkmcnt(0)
    s_barrier
    s_waitcnt lgkmcnt(15)
    s_branch p2_tail
p2_drain1:
    v_cmpx_gt_i16 vcc, 0, v48
    ds_read_b64 v[0:1], v0
    s_mov_b64 exec, -1
    v_cmpx_gt_i16 vcc, 0, v49
    ds_read_b64 v[2:3], v2
    s_mov_b64 exec, -1
    v_cmpx_gt_i16 vcc, 0, v50
    ds_read_b64 v[4:5], v4
    s_mov_b64 exec, -1
    v_cmpx_gt_i16 vcc, 0, v51
    ds_read_b64 v[6:7], v6
    s_mov_b64 exec, -1
    v_cmpx_gt_i16 vcc, 0, v52
    ds_read_b64 v[8:9], v8
    s_mov_b64 exec, -1
    v_cmpx_gt_i16 vcc, 0, v53
    ds_read_b64 v[10:11], v10
    s_mov_b64 exec, -1
    v_cmpx_gt_i16 vcc, 0, v54
    ds_read_b64 v[12:13], v12
    s_mov_b64 exec, -1
    v_cmpx_gt_i16 vcc, 0, v55
    ds_read_b64 v[14:15], v14
    s_mov_b64 exec, -1
    v_cmpx_gt_i16 vcc, 0, v56
    ds_read_b64 v[16:17], v16
    s_mov_b64 exec, -1
    v_cmpx_gt_i16 vcc, 0, v57
    ds_read_b64 v[18:19], v18
    s_mov_b64 exec, -1
    v_cmpx_gt_i16 vcc, 0, v58
    ds_read_b64 v[20:21], v20
    s_mov_b64 exec, -1
    v_cmpx_gt_i16 vcc, 0, v59
    ds_read_b64 v[22:23], v22
    s_mov_b64 exec, -1
    v_cmpx_gt_i16 vcc, 0, v60
    ds_read_b64 v[24:25], v24
    s_mov_b64 exec, -1
    v_cmpx_gt_i16 vcc, 0, v61
    ds_read_b64 v[26:27], v26
    s_mov_b64 exec, -1
    v_cmpx_gt_i16 vcc, 0, v62
    ds_read_b64 v[28:29], v28
    s_mov_b64 exec, -1
    v_cmpx_gt_i16 vcc, 0, v63
    ds_read_b64 v[30:31], v30
    s_mov_b64 exec, -1
    v_cmpx_gt_i16 vcc, 0, v64
    ds_read_b64 v[32:33], v32
    s_mov_b64 exec, -1
    v_cmpx_gt_i16 vcc, 0, v65
    ds_read_b64 v[34:35], v34
    s_mov_b64 exec, -1
    v_cmpx_gt_i16 vcc, 0, v66
    ds_read_b64 v[36:37], v36
    s_mov_b64 exec, -1
    v_cmpx_gt_i16 vcc, 0, v67
    ds_read_b64 v[38:39], v38
    s_mov_b64 exec, -1
    v_cmpx_gt_i16 vcc, 0, v68
    ds_read_b64 v[40:41], v40
    s_mov_b64 exec, -1
    s_cmp_le_u32 s15, 7
    s_cbranch_scc1 p2_gd1
    v_cmpx_gt_i16 vcc, 0, v69
    ds_read_b64 v[42:43], v42
    s_mov_b64 exec, -1
    v_cmpx_gt_i16 vcc, 0, v70
    ds_read_b64 v[44:45], v44
    s_mov_b64 exec, -1
    v_cmpx_gt_i16 vcc, 0, v71
    ds_read_b64 v[46:47], v46
    s_mov_b64 exec, -1
p2_gd1:
    s_waitcnt lgkmcnt(15)
    v_ashrrev_i32 v122, 5, v48
    v_lshlrev_b16 v123, 2, v48
    v_cndmask_b32 v126, v0, v1, s[66:67]
    v_bitop3_b32 v122, v122, v113, v113 bitop3:0x0c
    v_lshlrev_b32 v124, 16, v126
    v_mul_f32 v122, v114, v122
    v_and_b32 v125, 0xffff0000, v126
    v_add_u32 v123, v123, v123
    v_mul_f32 v124, v122, v124
    v_mul_f32 v125, v122, v125
    v_cmpx_le_u32 vcc, 0x1000000, v48
    ds_add_f32 v123, v124 offset:54272
    ds_add_f32 v123, v125 offset:54276
    s_mov_b64 exec, -1
    v_ashrrev_i32 v122, 5, v49
    v_lshlrev_b16 v123, 2, v49
    v_cndmask_b32 v126, v2, v3, s[66:67]
    v_bitop3_b32 v122, v122, v113, v113 bitop3:0x0c
    v_lshlrev_b32 v124, 16, v126
    v_mul_f32 v122, v114, v122
    v_and_b32 v125, 0xffff0000, v126
    v_add_u32 v123, v123, v123
    v_mul_f32 v124, v122, v124
    v_mul_f32 v125, v122, v125
    v_cmpx_le_u32 vcc, 0x1000000, v49
    ds_add_f32 v123, v124 offset:54272
    ds_add_f32 v123, v125 offset:54276
    s_mov_b64 exec, -1
    v_ashrrev_i32 v122, 5, v50
    v_lshlrev_b16 v123, 2, v50
    v_cndmask_b32 v126, v4, v5, s[66:67]
    v_bitop3_b32 v122, v122, v113, v113 bitop3:0x0c
    v_lshlrev_b32 v124, 16, v126
    v_mul_f32 v122, v114, v122
    v_and_b32 v125, 0xffff0000, v126
    v_add_u32 v123, v123, v123
    v_mul_f32 v124, v122, v124
    v_mul_f32 v125, v122, v125
    v_cmpx_le_u32 vcc, 0x1000000, v50
    ds_add_f32 v123, v124 offset:54272
    ds_add_f32 v123, v125 offset:54276
    s_mov_b64 exec, -1
    s_waitcnt lgkmcnt(15)
    v_ashrrev_i32 v122, 5, v51
    v_lshlrev_b16 v123, 2, v51
    v_cndmask_b32 v126, v6, v7, s[66:67]
    v_bitop3_b32 v122, v122, v113, v113 bitop3:0x0c
    v_lshlrev_b32 v124, 16, v126
    v_mul_f32 v122, v114, v122
    v_and_b32 v125, 0xffff0000, v126
    v_add_u32 v123, v123, v123
    v_mul_f32 v124, v122, v124
    v_mul_f32 v125, v122, v125
    v_cmpx_le_u32 vcc, 0x1000000, v51
    ds_add_f32 v123, v124 offset:54272
    ds_add_f32 v123, v125 offset:54276
    s_mov_b64 exec, -1
    v_ashrrev_i32 v122, 5, v52
    v_lshlrev_b16 v123, 2, v52
    v_cndmask_b32 v126, v8, v9, s[66:67]
    v_bitop3_b32 v122, v122, v113, v113 bitop3:0x0c
    v_lshlrev_b32 v124, 16, v126
    v_mul_f32 v122, v114, v122
    v_and_b32 v125, 0xffff0000, v126
    v_add_u32 v123, v123, v123
    v_mul_f32 v124, v122, v124
    v_mul_f32 v125, v122, v125
    v_cmpx_le_u32 vcc, 0x1000000, v52
    ds_add_f32 v123, v124 offset:54272
    ds_add_f32 v123, v125 offset:54276
    s_mov_b64 exec, -1
    v_ashrrev_i32 v122, 5, v53
    v_lshlrev_b16 v123, 2, v53
    v_cndmask_b32 v126, v10, v11, s[66:67]
    v_bitop3_b32 v122, v122, v113, v113 bitop3:0x0c
    v_lshlrev_b32 v124, 16, v126
    v_mul_f32 v122, v114, v122
    v_and_b32 v125, 0xffff0000, v126
    v_add_u32 v123, v123, v123
    v_mul_f32 v124, v122, v124
    v_mul_f32 v125, v122, v125
    v_cmpx_le_u32 vcc, 0x1000000, v53
    ds_add_f32 v123, v124 offset:54272
    ds_add_f32 v123, v125 offset:54276
    s_mov_b64 exec, -1
    s_waitcnt lgkmcnt(15)
    v_ashrrev_i32 v122, 5, v54
    v_lshlrev_b16 v123, 2, v54
    v_cndmask_b32 v126, v12, v13, s[66:67]
    v_bitop3_b32 v122, v122, v113, v113 bitop3:0x0c
    v_lshlrev_b32 v124, 16, v126
    v_mul_f32 v122, v114, v122
    v_and_b32 v125, 0xffff0000, v126
    v_add_u32 v123, v123, v123
    v_mul_f32 v124, v122, v124
    v_mul_f32 v125, v122, v125
    v_cmpx_le_u32 vcc, 0x1000000, v54
    ds_add_f32 v123, v124 offset:54272
    ds_add_f32 v123, v125 offset:54276
    s_mov_b64 exec, -1
    v_ashrrev_i32 v122, 5, v55
    v_lshlrev_b16 v123, 2, v55
    v_cndmask_b32 v126, v14, v15, s[66:67]
    v_bitop3_b32 v122, v122, v113, v113 bitop3:0x0c
    v_lshlrev_b32 v124, 16, v126
    v_mul_f32 v122, v114, v122
    v_and_b32 v125, 0xffff0000, v126
    v_add_u32 v123, v123, v123
    v_mul_f32 v124, v122, v124
    v_mul_f32 v125, v122, v125
    v_cmpx_le_u32 vcc, 0x1000000, v55
    ds_add_f32 v123, v124 offset:54272
    ds_add_f32 v123, v125 offset:54276
    s_mov_b64 exec, -1
    v_ashrrev_i32 v122, 5, v56
    v_lshlrev_b16 v123, 2, v56
    v_cndmask_b32 v126, v16, v17, s[66:67]
    v_bitop3_b32 v122, v122, v113, v113 bitop3:0x0c
    v_lshlrev_b32 v124, 16, v126
    v_mul_f32 v122, v114, v122
    v_and_b32 v125, 0xffff0000, v126
    v_add_u32 v123, v123, v123
    v_mul_f32 v124, v122, v124
    v_mul_f32 v125, v122, v125
    v_cmpx_le_u32 vcc, 0x1000000, v56
    ds_add_f32 v123, v124 offset:54272
    ds_add_f32 v123, v125 offset:54276
    s_mov_b64 exec, -1
    s_waitcnt lgkmcnt(15)
    v_ashrrev_i32 v122, 5, v57
    v_lshlrev_b16 v123, 2, v57
    v_cndmask_b32 v126, v18, v19, s[66:67]
    v_bitop3_b32 v122, v122, v113, v113 bitop3:0x0c
    v_lshlrev_b32 v124, 16, v126
    v_mul_f32 v122, v114, v122
    v_and_b32 v125, 0xffff0000, v126
    v_add_u32 v123, v123, v123
    v_mul_f32 v124, v122, v124
    v_mul_f32 v125, v122, v125
    v_cmpx_le_u32 vcc, 0x1000000, v57
    ds_add_f32 v123, v124 offset:54272
    ds_add_f32 v123, v125 offset:54276
    s_mov_b64 exec, -1
    v_ashrrev_i32 v122, 5, v58
    v_lshlrev_b16 v123, 2, v58
    v_cndmask_b32 v126, v20, v21, s[66:67]
    v_bitop3_b32 v122, v122, v113, v113 bitop3:0x0c
    v_lshlrev_b32 v124, 16, v126
    v_mul_f32 v122, v114, v122
    v_and_b32 v125, 0xffff0000, v126
    v_add_u32 v123, v123, v123
    v_mul_f32 v124, v122, v124
    v_mul_f32 v125, v122, v125
    v_cmpx_le_u32 vcc, 0x1000000, v58
    ds_add_f32 v123, v124 offset:54272
    ds_add_f32 v123, v125 offset:54276
    s_mov_b64 exec, -1
    v_ashrrev_i32 v122, 5, v59
    v_lshlrev_b16 v123, 2, v59
    v_cndmask_b32 v126, v22, v23, s[66:67]
    v_bitop3_b32 v122, v122, v113, v113 bitop3:0x0c
    v_lshlrev_b32 v124, 16, v126
    v_mul_f32 v122, v114, v122
    v_and_b32 v125, 0xffff0000, v126
    v_add_u32 v123, v123, v123
    v_mul_f32 v124, v122, v124
    v_mul_f32 v125, v122, v125
    v_cmpx_le_u32 vcc, 0x1000000, v59
    ds_add_f32 v123, v124 offset:54272
    ds_add_f32 v123, v125 offset:54276
    s_mov_b64 exec, -1
    s_waitcnt lgkmcnt(15)
    v_ashrrev_i32 v122, 5, v60
    v_lshlrev_b16 v123, 2, v60
    v_cndmask_b32 v126, v24, v25, s[66:67]
    v_bitop3_b32 v122, v122, v113, v113 bitop3:0x0c
    v_lshlrev_b32 v124, 16, v126
    v_mul_f32 v122, v114, v122
    v_and_b32 v125, 0xffff0000, v126
    v_add_u32 v123, v123, v123
    v_mul_f32 v124, v122, v124
    v_mul_f32 v125, v122, v125
    v_cmpx_le_u32 vcc, 0x1000000, v60
    ds_add_f32 v123, v124 offset:54272
    ds_add_f32 v123, v125 offset:54276
    s_mov_b64 exec, -1
    v_ashrrev_i32 v122, 5, v61
    v_lshlrev_b16 v123, 2, v61
    v_cndmask_b32 v126, v26, v27, s[66:67]
    v_bitop3_b32 v122, v122, v113, v113 bitop3:0x0c
    v_lshlrev_b32 v124, 16, v126
    v_mul_f32 v122, v114, v122
    v_and_b32 v125, 0xffff0000, v126
    v_add_u32 v123, v123, v123
    v_mul_f32 v124, v122, v124
    v_mul_f32 v125, v122, v125
    v_cmpx_le_u32 vcc, 0x1000000, v61
    ds_add_f32 v123, v124 offset:54272
    ds_add_f32 v123, v125 offset:54276
    s_mov_b64 exec, -1
    v_ashrrev_i32 v122, 5, v62
    v_lshlrev_b16 v123, 2, v62
    v_cndmask_b32 v126, v28, v29, s[66:67]
    v_bitop3_b32 v122, v122, v113, v113 bitop3:0x0c
    v_lshlrev_b32 v124, 16, v126
    v_mul_f32 v122, v114, v122
    v_and_b32 v125, 0xffff0000, v126
    v_add_u32 v123, v123, v123
    v_mul_f32 v124, v122, v124
    v_mul_f32 v125, v122, v125
    v_cmpx_le_u32 vcc, 0x1000000, v62
    ds_add_f32 v123, v124 offset:54272
    ds_add_f32 v123, v125 offset:54276
    s_mov_b64 exec, -1
    s_waitcnt lgkmcnt(15)
    v_ashrrev_i32 v122, 5, v63
    v_lshlrev_b16 v123, 2, v63
    v_cndmask_b32 v126, v30, v31, s[66:67]
    v_bitop3_b32 v122, v122, v113, v113 bitop3:0x0c
    v_lshlrev_b32 v124, 16, v126
    v_mul_f32 v122, v114, v122
    v_and_b32 v125, 0xffff0000, v126
    v_add_u32 v123, v123, v123
    v_mul_f32 v124, v122, v124
    v_mul_f32 v125, v122, v125
    v_cmpx_le_u32 vcc, 0x1000000, v63
    ds_add_f32 v123, v124 offset:54272
    ds_add_f32 v123, v125 offset:54276
    s_mov_b64 exec, -1
    v_ashrrev_i32 v122, 5, v64
    v_lshlrev_b16 v123, 2, v64
    v_cndmask_b32 v126, v32, v33, s[66:67]
    v_bitop3_b32 v122, v122, v113, v113 bitop3:0x0c
    v_lshlrev_b32 v124, 16, v126
    v_mul_f32 v122, v114, v122
    v_and_b32 v125, 0xffff0000, v126
    v_add_u32 v123, v123, v123
    v_mul_f32 v124, v122, v124
    v_mul_f32 v125, v122, v125
    v_cmpx_le_u32 vcc, 0x1000000, v64
    ds_add_f32 v123, v124 offset:54272
    ds_add_f32 v123, v125 offset:54276
    s_mov_b64 exec, -1
    v_ashrrev_i32 v122, 5, v65
    v_lshlrev_b16 v123, 2, v65
    v_cndmask_b32 v126, v34, v35, s[66:67]
    v_bitop3_b32 v122, v122, v113, v113 bitop3:0x0c
    v_lshlrev_b32 v124, 16, v126
    v_mul_f32 v122, v114, v122
    v_and_b32 v125, 0xffff0000, v126
    v_add_u32 v123, v123, v123
    v_mul_f32 v124, v122, v124
    v_mul_f32 v125, v122, v125
    v_cmpx_le_u32 vcc, 0x1000000, v65
    ds_add_f32 v123, v124 offset:54272
    ds_add_f32 v123, v125 offset:54276
    s_mov_b64 exec, -1
    s_waitcnt lgkmcnt(15)
    v_ashrrev_i32 v122, 5, v66
    v_lshlrev_b16 v123, 2, v66
    v_cndmask_b32 v126, v36, v37, s[66:67]
    v_bitop3_b32 v122, v122, v113, v113 bitop3:0x0c
    v_lshlrev_b32 v124, 16, v126
    v_mul_f32 v122, v114, v122
    v_and_b32 v125, 0xffff0000, v126
    v_add_u32 v123, v123, v123
    v_mul_f32 v124, v122, v124
    v_mul_f32 v125, v122, v125
    v_cmpx_le_u32 vcc, 0x1000000, v66
    ds_add_f32 v123, v124 offset:54272
    ds_add_f32 v123, v125 offset:54276
    s_mov_b64 exec, -1
    v_ashrrev_i32 v122, 5, v67
    v_lshlrev_b16 v123, 2, v67
    v_cndmask_b32 v126, v38, v39, s[66:67]
    v_bitop3_b32 v122, v122, v113, v113 bitop3:0x0c
    v_lshlrev_b32 v124, 16, v126
    v_mul_f32 v122, v114, v122
    v_and_b32 v125, 0xffff0000, v126
    v_add_u32 v123, v123, v123
    v_mul_f32 v124, v122, v124
    v_mul_f32 v125, v122, v125
    v_cmpx_le_u32 vcc, 0x1000000, v67
    ds_add_f32 v123, v124 offset:54272
    ds_add_f32 v123, v125 offset:54276
    s_mov_b64 exec, -1
    v_ashrrev_i32 v122, 5, v68
    v_lshlrev_b16 v123, 2, v68
    v_cndmask_b32 v126, v40, v41, s[66:67]
    v_bitop3_b32 v122, v122, v113, v113 bitop3:0x0c
    v_lshlrev_b32 v124, 16, v126
    v_mul_f32 v122, v114, v122
    v_and_b32 v125, 0xffff0000, v126
    v_add_u32 v123, v123, v123
    v_mul_f32 v124, v122, v124
    v_mul_f32 v125, v122, v125
    v_cmpx_le_u32 vcc, 0x1000000, v68
    ds_add_f32 v123, v124 offset:54272
    ds_add_f32 v123, v125 offset:54276
    s_mov_b64 exec, -1
    s_cmp_le_u32 s15, 7
    s_cbranch_scc1 p2_nad1
    s_waitcnt lgkmcnt(15)
    v_ashrrev_i32 v122, 5, v69
    v_lshlrev_b16 v123, 2, v69
    v_cndmask_b32 v126, v42, v43, s[66:67]
    v_bitop3_b32 v122, v122, v113, v113 bitop3:0x0c
    v_lshlrev_b32 v124, 16, v126
    v_mul_f32 v122, v114, v122
    v_and_b32 v125, 0xffff0000, v126
    v_add_u32 v123, v123, v123
    v_mul_f32 v124, v122, v124
    v_mul_f32 v125, v122, v125
    v_cmpx_le_u32 vcc, 0x1000000, v69
    ds_add_f32 v123, v124 offset:54272
    ds_add_f32 v123, v125 offset:54276
    s_mov_b64 exec, -1
    v_ashrrev_i32 v122, 5, v70
    v_lshlrev_b16 v123, 2, v70
    v_cndmask_b32 v126, v44, v45, s[66:67]
    v_bitop3_b32 v122, v122, v113, v113 bitop3:0x0c
    v_lshlrev_b32 v124, 16, v126
    v_mul_f32 v122, v114, v122
    v_and_b32 v125, 0xffff0000, v126
    v_add_u32 v123, v123, v123
    v_mul_f32 v124, v122, v124
    v_mul_f32 v125, v122, v125
    v_cmpx_le_u32 vcc, 0x1000000, v70
    ds_add_f32 v123, v124 offset:54272
    ds_add_f32 v123, v125 offset:54276
    s_mov_b64 exec, -1
    v_ashrrev_i32 v122, 5, v71
    v_lshlrev_b16 v123, 2, v71
    v_cndmask_b32 v126, v46, v47, s[66:67]
    v_bitop3_b32 v122, v122, v113, v113 bitop3:0x0c
    v_lshlrev_b32 v124, 16, v126
    v_mul_f32 v122, v114, v122
    v_and_b32 v125, 0xffff0000, v126
    v_add_u32 v123, v123, v123
    v_mul_f32 v124, v122, v124
    v_mul_f32 v125, v122, v125
    v_cmpx_le_u32 vcc, 0x1000000, v71
    ds_add_f32 v123, v124 offset:54272
    ds_add_f32 v123, v125 offset:54276
    s_mov_b64 exec, -1
p2_nad1:
    s_branch p2_fin
p2_tail:
    s_mov_b32 s60, s61
    s_mov_b32 s15, s16
    s_mov_b32 s16, s17
    v_mov_b32 v122, s19
    s_xor_b32 s19, s19, 4
    ds_read_b32 v125, v122 offset:53760
    v_mov_b32 v123, s19
    v_mov_b32 v124, 0
    ds_write_b32 v123, v124 offset:53760
    s_waitcnt vmcnt(2)
    s_mov_b32 m0, s24
    s_cmp_ge_u32 s10, 9
    s_cbranch_scc1 p2_st2s1
    ds_write_addtid_b32 v84 offset:49152
    ds_write_addtid_b32 v85 offset:49408
p2_st2s1:
    s_mov_b32 m0, s23
    s_add_u32 s20, s20, 53760
    ds_write_addtid_b32 v72 offset:0
    ds_write_addtid_b32 v73 offset:256
    ds_write_addtid_b32 v74 offset:512
    ds_write_addtid_b32 v75 offset:768
    ds_write_addtid_b32 v76 offset:1024
    ds_write_addtid_b32 v77 offset:1280
    ds_write_addtid_b32 v78 offset:1536
    ds_write_addtid_b32 v79 offset:1792
    ds_write_addtid_b32 v80 offset:2048
    ds_write_addtid_b32 v81 offset:2304
    ds_write_addtid_b32 v82 offset:2560
    ds_write_addtid_b32 v83 offset:2816
    s_waitcnt lgkmcnt(0)
    s_barrier
    s_waitcnt lgkmcnt(13)
    v_readfirstlane_b32 s44, v125
    s_nop 0
    s_cmp_lg_u32 s44, 0
    s_cbranch_scc1 p2_advb
    s_add_u32 s61, s61, 1
    s_min_u32 s61, s61, 10
    v_mov_b32 v110, 0
    v_mov_b32 v111, 0
    s_cmp_eq_u32 s61, 10
    s_cbranch_scc1 p2_advb
    s_mul_i32 s44, s61, 1064960
    s_add_u32 s44, s44, s40
    v_bfe_u32 v110, v112, 4, 2
    v_mad_i32_i24 v111, v110, -12, v112
    buffer_load_dword v110, v111, s[4:7], s44 offen
    s_add_u32 s44, s44, 16384
    buffer_load_dword v111, v111, s[4:7], s44 offen
p2_advb:
    s_cmp_lg_u32 s10, 0
    s_cbranch_scc1 p2_ntg
    s_lshr_b32 s44, s2, 3
    s_mul_i32 s44, s44, 5120
    s_mul_i32 s45, s60, 645120
    s_add_u32 s44, s44, s45
    s_add_u32 s44, s44, s62
    v_lshlrev_b32 v127, 3, v112
    s_mov_b32 exec_hi, 0xff
    buffer_load_dword v127, v127, s[4:7], s44 offen
    s_mov_b64 exec, -1
p2_ntg:
    s_cmp_ge_u32 s10, 9
    s_cbranch_scc1 p2_nm2m2
    v_lshrrev_b32 v84, 1, v112
    s_add_u32 s44, s20, s42
    buffer_load_dwordx2 v[84:85], v84, s[4:7], s44 offen
p2_nm2m2:
    buffer_load_dwordx4 v[72:75], v112, s[4:7], s20 offen offset:0
    buffer_load_dwordx4 v[76:79], v112, s[4:7], s20 offen offset:1024
    buffer_load_dwordx4 v[80:83], v112, s[4:7], s20 offen offset:2048
    v_cmpx_lt_i16 vcc, 0x3fff, v48
    ds_read_b64 v[0:1], v0
    s_mov_b64 exec, -1
    v_cmpx_lt_i16 vcc, 0x3fff, v49
    ds_read_b64 v[2:3], v2
    s_mov_b64 exec, -1
    v_cmpx_lt_i16 vcc, 0x3fff, v50
    ds_read_b64 v[4:5], v4
    s_mov_b64 exec, -1
    v_cmpx_lt_i16 vcc, 0x3fff, v51
    ds_read_b64 v[6:7], v6
    s_mov_b64 exec, -1
    v_cmpx_lt_i16 vcc, 0x3fff, v52
    ds_read_b64 v[8:9], v8
    s_mov_b64 exec, -1
    v_cmpx_lt_i16 vcc, 0x3fff, v53
    ds_read_b64 v[10:11], v10
    s_mov_b64 exec, -1
    v_cmpx_lt_i16 vcc, 0x3fff, v54
    ds_read_b64 v[12:13], v12
    s_mov_b64 exec, -1
    v_cmpx_lt_i16 vcc, 0x3fff, v55
    ds_read_b64 v[14:15], v14
    s_mov_b64 exec, -1
    v_cmpx_lt_i16 vcc, 0x3fff, v56
    ds_read_b64 v[16:17], v16
    s_mov_b64 exec, -1
    v_cmpx_lt_i16 vcc, 0x3fff, v57
    ds_read_b64 v[18:19], v18
    s_mov_b64 exec, -1
    v_cmpx_lt_i16 vcc, 0x3fff, v58
    ds_read_b64 v[20:21], v20
    s_mov_b64 exec, -1
    v_cmpx_lt_i16 vcc, 0x3fff, v59
    ds_read_b64 v[22:23], v22
    s_mov_b64 exec, -1
    v_lshrrev_b32 v94, 3, v108
    v_lshrrev_b32 v95, 18, v108
    v_and_b32 v108, 0x3fff, v108
    v_and_or_b32 v94, v94, s65, v95
    v_mad_u32_u24 v108, v94, s63, v108
    buffer_load_dwordx4 v[94:97], v108, s[68:71], 0 offen
    v_cmpx_lt_i16 vcc, 0x3fff, v60
    ds_read_b64 v[24:25], v24
    s_mov_b64 exec, -1
    v_cmpx_lt_i16 vcc, 0x3fff, v61
    ds_read_b64 v[26:27], v26
    s_mov_b64 exec, -1
    v_cmpx_lt_i16 vcc, 0x3fff, v62
    ds_read_b64 v[28:29], v28
    s_mov_b64 exec, -1
    v_cmpx_lt_i16 vcc, 0x3fff, v63
    ds_read_b64 v[30:31], v30
    s_mov_b64 exec, -1
    v_cmpx_lt_i16 vcc, 0x3fff, v64
    ds_read_b64 v[32:33], v32
    s_mov_b64 exec, -1
    v_cmpx_lt_i16 vcc, 0x3fff, v65
    ds_read_b64 v[34:35], v34
    s_mov_b64 exec, -1
    v_cmpx_lt_i16 vcc, 0x3fff, v66
    ds_read_b64 v[36:37], v36
    s_mov_b64 exec, -1
    v_cmpx_lt_i16 vcc, 0x3fff, v67
    ds_read_b64 v[38:39], v38
    s_mov_b64 exec, -1
    v_cmpx_lt_i16 vcc, 0x3fff, v68
    ds_read_b64 v[40:41], v40
    s_mov_b64 exec, -1
    s_cmp_le_u32 s15, 7
    s_cbranch_scc1 p2_g2r17
    v_cmpx_lt_i16 vcc, 0x3fff, v69
    ds_read_b64 v[42:43], v42
    s_mov_b64 exec, -1
    v_cmpx_lt_i16 vcc, 0x3fff, v70
    ds_read_b64 v[44:45], v44
    s_mov_b64 exec, -1
    v_cmpx_lt_i16 vcc, 0x3fff, v71
    ds_read_b64 v[46:47], v46
    s_mov_b64 exec, -1
p2_g2r17:
    v_lshrrev_b32 v98, 3, v109
    v_lshrrev_b32 v99, 18, v109
    v_and_b32 v109, 0x3fff, v109
    v_and_or_b32 v98, v98, s65, v99
    v_mad_u32_u24 v109, v98, s63, v109
    buffer_load_dwordx4 v[98:101], v109, s[68:71], 0 offen
    s_waitcnt lgkmcnt(0)
    s_barrier
    s_waitcnt vmcnt(2)
    s_mov_b32 m0, s24
    s_cmp_ge_u32 s10, 9
    s_cbranch_scc1 p2_st2s2
    ds_write_addtid_b32 v84 offset:49152
    ds_write_addtid_b32 v85 offset:49408
p2_st2s2:
    s_mov_b32 m0, s23
    s_mul_i32 s20, s60, 645120
    s_add_u32 s20, s20, s62
    ds_write_addtid_b32 v72 offset:0
    ds_write_addtid_b32 v73 offset:256
    ds_write_addtid_b32 v74 offset:512
    ds_write_addtid_b32 v75 offset:768
    ds_write_addtid_b32 v76 offset:1024
    ds_write_addtid_b32 v77 offset:1280
    ds_write_addtid_b32 v78 offset:1536
    ds_write_addtid_b32 v79 offset:1792
    ds_write_addtid_b32 v80 offset:2048
    ds_write_addtid_b32 v81 offset:2304
    ds_write_addtid_b32 v82 offset:2560
    ds_write_addtid_b32 v83 offset:2816
    s_waitcnt lgkmcnt(0)
    s_barrier
    s_branch p2_top
p2_fin:
    s_waitcnt vmcnt(0) lgkmcnt(0)
    s_barrier
    s_mov_b32 s48, s11
    s_mul_i32 s44, s48, 800768
    s_mul_i32 s45, s12, 12512
    s_add_u32 s49, s44, s45
    s_lshl_b32 s44, s49, 3
    s_add_u32 s44, s44, 363426816
    s_lshl_b32 s48, s48, 2
    s_lshl_b32 s45, s12, 4
    s_add_u32 s48, s48, s45
    s_add_u32 s48, s48, 363425792
    v_add_u32 v123, s64, v112
    v_add_u32 v122, s25, v123
    v_mov_b32 v24, 0
    v_mov_b32 v25, 0
    v_mov_b32 v26, 0
    v_mov_b32 v27, 0
    v_cmp_gt_u32 vcc, 1792, v123
    v_mov_b32 v124, 0x38000000
    v_mov_b32 v126, 0
    v_cndmask_b32 v124, v124, v123, vcc
    ds_read_b128 v[0:3], v122 offset:0
    ds_read_b128 v[4:7], v122 offset:16384
    ds_read_b128 v[8:11], v122 offset:32768
    v_add_u32 v122, 49152, v122
    ds_read_b128 v[12:15], v122 offset:0
    ds_read_b128 v[16:19], v122 offset:16384
    ds_read_b128 v[20:23], v122 offset:32768
    s_mov_b64 exec, vcc
    ds_read_b128 v[24:27], v122 offset:49152
    s_mov_b64 exec, -1
    s_cmp_lg_u32 s21, 0
    s_cbranch_scc1 p2_finf
    s_waitcnt lgkmcnt(6)
    buffer_store_dwordx4 v[0:3], v123, s[4:7], s44 offen
    s_add_u32 s44, s44, 16384
    s_waitcnt lgkmcnt(5)
    buffer_store_dwordx4 v[4:7], v123, s[4:7], s44 offen
    s_add_u32 s44, s44, 16384
    s_waitcnt lgkmcnt(4)
    buffer_store_dwordx4 v[8:11], v123, s[4:7], s44 offen
    s_add_u32 s44, s44, 16384
    s_waitcnt lgkmcnt(3)
    buffer_store_dwordx4 v[12:15], v123, s[4:7], s44 offen
    s_add_u32 s44, s44, 16384
    s_waitcnt lgkmcnt(2)
    buffer_store_dwordx4 v[16:19], v123, s[4:7], s44 offen
    s_add_u32 s44, s44, 16384
    s_waitcnt lgkmcnt(1)
    buffer_store_dwordx4 v[20:23], v123, s[4:7], s44 offen
    s_add_u32 s44, s44, 16384
    s_waitcnt lgkmcnt(0)
    buffer_store_dwordx4 v[24:27], v124, s[4:7], s44 offen
    s_add_u32 s44, s44, 16384
    v_bitop3_b32 v115, v115, v0, v1 bitop3:0xfe
    v_bitop3_b32 v115, v115, v2, v3 bitop3:0xfe
    v_bitop3_b32 v115, v115, v4, v5 bitop3:0xfe
    v_bitop3_b32 v115, v115, v6, v7 bitop3:0xfe
    v_bitop3_b32 v115, v115, v8, v9 bitop3:0xfe
    v_bitop3_b32 v115, v115, v10, v11 bitop3:0xfe
    v_bitop3_b32 v115, v115, v12, v13 bitop3:0xfe
    v_bitop3_b32 v115, v115, v14, v15 bitop3:0xfe
    v_bitop3_b32 v115, v115, v16, v17 bitop3:0xfe
    v_bitop3_b32 v115, v115, v18, v19 bitop3:0xfe
    v_bitop3_b32 v115, v115, v20, v21 bitop3:0xfe
    v_bitop3_b32 v115, v115, v22, v23 bitop3:0xfe
    v_bitop3_b32 v115, v115, v24, v25 bitop3:0xfe
    v_bitop3_b32 v115, v115, v26, v27 bitop3:0xfe
    v_bitop3_b32 v115, v115, v116, v117 bitop3:0xfe
    v_bitop3_b32 v115, v115, v118, v119 bitop3:0xfe
    v_bitop3_b32 v115, v115, v120, v121 bitop3:0xfe
    v_and_b32 v115, 0x80008000, v115
    v_cmpx_ne_u32 vcc, 0, v115
    ds_write_b32 v126, v115 offset:53768
    s_mov_b64 exec, -1
    s_waitcnt lgkmcnt(0)
    s_barrier
    ds_read_b32 v125, v126 offset:53768
    s_waitcnt lgkmcnt(0)
    v_readfirstlane_b32 s45, v125
    s_nop 0
    s_cmp_eq_u32 s45, 0
    s_cbranch_scc1 p2_done
    s_mov_b32 s21, 1
    s_waitcnt vmcnt(0)
    s_branch p2_restart
p2_finf:
    s_lshl_b32 s49, s49, 4
    s_lshl_b32 s45, s21, 3
    s_add_u32 s49, s49, s45
    s_add_u32 s49, s49, 389051384
    v_mov_b32 v28, 1073758208
    v_mov_b32 v29, 1073758208
    v_mov_b32 v30, 1073758208
    v_mov_b32 v31, 1073758208
    v_lshlrev_b32 v122, 1, v123
    v_lshlrev_b32 v125, 1, v124
    s_waitcnt lgkmcnt(0)
    buffer_store_dwordx4 v[28:31], v123, s[4:7], s44 offen
    s_add_u32 s44, s44, 16384
    buffer_store_dwordx2 v[0:1], v122, s[4:7], s49 offen offset:0
    buffer_store_dwordx2 v[2:3], v122, s[4:7], s49 offen offset:16
    s_add_u32 s49, s49, 32768
    buffer_store_dwordx4 v[28:31], v123, s[4:7], s44 offen
    s_add_u32 s44, s44, 16384
    buffer_store_dwordx2 v[4:5], v122, s[4:7], s49 offen offset:0
    buffer_store_dwordx2 v[6:7], v122, s[4:7], s49 offen offset:16
    s_add_u32 s49, s49, 32768
    buffer_store_dwordx4 v[28:31], v123, s[4:7], s44 offen
    s_add_u32 s44, s44, 16384
    buffer_store_dwordx2 v[8:9], v122, s[4:7], s49 offen offset:0
    buffer_store_dwordx2 v[10:11], v122, s[4:7], s49 offen offset:16
    s_add_u32 s49, s49, 32768
    buffer_store_dwordx4 v[28:31], v123, s[4:7], s44 offen
    s_add_u32 s44, s44, 16384
    buffer_store_dwordx2 v[12:13], v122, s[4:7], s49 offen offset:0
    buffer_store_dwordx2 v[14:15], v122, s[4:7], s49 offen offset:16
    s_add_u32 s49, s49, 32768
    buffer_store_dwordx4 v[28:31], v123, s[4:7], s44 offen
    s_add_u32 s44, s44, 16384
    buffer_store_dwordx2 v[16:17], v122, s[4:7], s49 offen offset:0
    buffer_store_dwordx2 v[18:19], v122, s[4:7], s49 offen offset:16
    s_add_u32 s49, s49, 32768
    buffer_store_dwordx4 v[28:31], v123, s[4:7], s44 offen
    s_add_u32 s44, s44, 16384
    buffer_store_dwordx2 v[20:21], v122, s[4:7], s49 offen offset:0
    buffer_store_dwordx2 v[22:23], v122, s[4:7], s49 offen offset:16
    s_add_u32 s49, s49, 32768
    buffer_store_dwordx4 v[28:31], v124, s[4:7], s44 offen
    s_add_u32 s44, s44, 16384
    buffer_store_dwordx2 v[24:25], v125, s[4:7], s49 offen offset:0
    buffer_store_dwordx2 v[26:27], v125, s[4:7], s49 offen offset:16
    s_add_u32 s49, s49, 32768
    s_add_u32 s21, s21, 1
    s_mov_b32 s30, 0
    s_waitcnt vmcnt(0)
    s_cmp_eq_u32 s21, 2
    s_cbranch_scc1 p2_restart
p2_done:
    v_mov_b32 v125, s30
    buffer_store_dword v125, v126, s[4:7], s48 offen
p2_end:
    s_endpgm
.globl p3_kernel
.p2align 8
.type p3_kernel,@function
p3_kernel:
    s_cmp_ge_u32 s2, 3125
    s_cbranch_scc1 p3_end
    s_load_dwordx2 s[4:5], s[0:1], 0
    s_load_dwordx2 s[6:7], s[0:1], 24
    s_load_dwordx2 s[8:9], s[0:1], 40
    s_load_dwordx8 s[12:19], s[0:1], 56
    s_load_dwordx2 s[10:11], s[0:1], 88
    s_load_dwordx2 s[20:21], s[0:1], 104
    s_lshl_b32 s3, s2, 8
    v_add_u32 v0, s3, v0
    v_lshlrev_b32 v2, 3, v0
    v_lshlrev_b32 v3, 1, v0
    s_waitcnt lgkmcnt(0)
    s_load_dwordx4 s[40:43], s[8:9], 0
    s_load_dwordx16 s[44:59], s[12:13], 0
    s_load_dwordx16 s[60:75], s[14:15], 0
    s_load_dwordx8 s[76:83], s[16:17], 0
    s_load_dwordx8 s[84:91], s[18:19], 0
    s_mov_b32 s24, s4
    s_and_b32 s25, s5, 0xffff
    s_mov_b32 s26, 6400000
    s_mov_b32 s27, 0x20000
    s_mov_b32 s28, s6
    s_and_b32 s29, s7, 0xffff
    s_mov_b32 s30, 1600000
    s_mov_b32 s31, 0x20000
    s_mov_b32 s32, s10
    s_and_b32 s33, s11, 0xffff
    s_mov_b32 s34, 6400000
    s_mov_b32 s35, 0x20000
    s_mov_b32 s36, s20
    s_and_b32 s37, s21, 0xffff
    s_mov_b32 s38, 819200000
    s_mov_b32 s39, 0x20000
    buffer_load_ushort v14, v3, s[28:31], 0 offen
    s_mov_b32 s22, 343268
    v_mul_hi_u32_u24 v1, s22, v0
    v_lshlrev_b32 v1, 4, v1
    s_mov_b32 s22, 363425792
    buffer_load_dwordx4 v[48:51], v1, s[36:39], s22 offen
    s_mov_b32 s22, 363426816
    buffer_load_dwordx2 v[32:33], v2, s[36:39], s22 offen
    s_mov_b32 s22, 369832960
    buffer_load_dwordx2 v[34:35], v2, s[36:39], s22 offen
    s_mov_b32 s22, 376239104
    buffer_load_dwordx2 v[36:37], v2, s[36:39], s22 offen
    s_mov_b32 s22, 382645248
    buffer_load_dwordx2 v[38:39], v2, s[36:39], s22 offen
    buffer_load_dwordx2 v[12:13], v2, s[24:27], 0 offen
    s_mov_b32 s92, 0xffff0000
    s_waitcnt vmcnt(6) lgkmcnt(0)
    v_lshlrev_b32 v14, 16, v14
    s_lshl_b32 s94, s40, 16
    v_subrev_f32 v16, s94, v14
    s_and_b32 s95, s40, s92
    v_subrev_f32 v17, s95, v14
    s_lshl_b32 s96, s41, 16
    v_subrev_f32 v18, s96, v14
    s_and_b32 s93, s41, s92
    v_subrev_f32 v19, s93, v14
    s_lshl_b32 s94, s42, 16
    v_subrev_f32 v20, s94, v14
    s_and_b32 s95, s42, s92
    v_subrev_f32 v21, s95, v14
    s_lshl_b32 s96, s43, 16
    v_subrev_f32 v22, s96, v14
    s_and_b32 s93, s43, s92
    v_subrev_f32 v23, s93, v14
    v_cvt_pk_bf16_f32 v16, v16, v17
    v_cvt_pk_bf16_f32 v18, v18, v19
    v_cvt_pk_bf16_f32 v20, v20, v21
    v_cvt_pk_bf16_f32 v22, v22, v23
    v_and_b32 v17, s92, v16
    v_lshlrev_b32 v16, 16, v16
    v_and_b32 v19, s92, v18
    v_lshlrev_b32 v18, 16, v18
    v_and_b32 v21, s92, v20
    v_lshlrev_b32 v20, 16, v20
    v_and_b32 v23, s92, v22
    v_lshlrev_b32 v22, 16, v22
    v_mul_f32 v16, v16, v16
    v_mul_f32 v17, v17, v17
    v_mul_f32 v18, v18, v18
    v_mul_f32 v19, v19, v19
    v_mul_f32 v20, v20, v20
    v_mul_f32 v21, v21, v21
    v_mul_f32 v22, v22, v22
    v_mul_f32 v23, v23, v23
    v_cvt_pk_bf16_f32 v16, v16, v17
    v_cvt_pk_bf16_f32 v18, v18, v19
    v_cvt_pk_bf16_f32 v20, v20, v21
    v_cvt_pk_bf16_f32 v22, v22, v23
    v_and_b32 v17, s92, v16
    v_lshlrev_b32 v16, 16, v16
    v_and_b32 v19, s92, v18
    v_lshlrev_b32 v18, 16, v18
    v_and_b32 v21, s92, v20
    v_lshlrev_b32 v20, 16, v20
    v_and_b32 v23, s92, v22
    v_lshlrev_b32 v22, 16, v22
    v_mul_f32 v16, 0xc1200000, v16
    v_mul_f32 v17, 0xc1200000, v17
    v_mul_f32 v18, 0xc1200000, v18
    v_mul_f32 v19, 0xc1200000, v19
    v_mul_f32 v20, 0xc1200000, v20
    v_mul_f32 v21, 0xc1200000, v21
    v_mul_f32 v22, 0xc1200000, v22
    v_mul_f32 v23, 0xc1200000, v23
    v_cvt_pk_bf16_f32 v16, v16, v17
    v_cvt_pk_bf16_f32 v18, v18, v19
    v_cvt_pk_bf16_f32 v20, v20, v21
    v_cvt_pk_bf16_f32 v22, v22, v23
    v_and_b32 v17, s92, v16
    v_lshlrev_b32 v16, 16, v16
    v_and_b32 v19, s92, v18
    v_lshlrev_b32 v18, 16, v18
    v_and_b32 v21, s92, v20
    v_lshlrev_b32 v20, 16, v20
    v_and_b32 v23, s92, v22
    v_lshlrev_b32 v22, 16, v22
    v_mul_f32 v16, 0x3fb8aa3b, v16
    v_mul_f32 v17, 0x3fb8aa3b, v17
    v_mul_f32 v18, 0x3fb8aa3b, v18
    v_mul_f32 v19, 0x3fb8aa3b, v19
    v_mul_f32 v20, 0x3fb8aa3b, v20
    v_mul_f32 v21, 0x3fb8aa3b, v21
    v_mul_f32 v22, 0x3fb8aa3b, v22
    v_mul_f32 v23, 0x3fb8aa3b, v23
    v_exp_f32 v16, v16
    v_exp_f32 v17, v17
    v_exp_f32 v18, v18
    v_exp_f32 v19, v19
    v_exp_f32 v20, v20
    v_exp_f32 v21, v21
    v_exp_f32 v22, v22
    v_exp_f32 v23, v23
    s_nop 0
    v_cvt_pk_bf16_f32 v16, v16, v17
    v_cvt_pk_bf16_f32 v18, v18, v19
    v_cvt_pk_bf16_f32 v20, v20, v21
    v_cvt_pk_bf16_f32 v22, v22, v23
    v_and_b32 v17, s92, v16
    v_lshlrev_b32 v16, 16, v16
    v_and_b32 v19, s92, v18
    v_lshlrev_b32 v18, 16, v18
    v_and_b32 v21, s92, v20
    v_lshlrev_b32 v20, 16, v20
    v_and_b32 v23, s92, v22
    v_lshlrev_b32 v22, 16, v22
    s_lshl_b32 s94, s60, 16
    v_mul_f32 v24, s94, v16
    s_and_b32 s95, s60, s92
    v_mul_f32 v25, s95, v16
    s_lshl_b32 s96, s61, 16
    v_mul_f32 v26, s96, v16
    s_and_b32 s93, s61, s92
    v_mul_f32 v27, s93, v16
    s_lshl_b32 s94, s62, 16
    v_fmac_f32 v24, s94, v17
    s_and_b32 s95, s62, s92
    v_fmac_f32 v25, s95, v17
    s_lshl_b32 s96, s63, 16
    v_fmac_f32 v26, s96, v17
    s_and_b32 s93, s63, s92
    v_fmac_f32 v27, s93, v17
    s_lshl_b32 s94, s64, 16
    v_fmac_f32 v24, s94, v18
    s_and_b32 s95, s64, s92
    v_fmac_f32 v25, s95, v18
    s_lshl_b32 s96, s65, 16
    v_fmac_f32 v26, s96, v18
    s_and_b32 s93, s65, s92
    v_fmac_f32 v27, s93, v18
    s_lshl_b32 s94, s66, 16
    v_fmac_f32 v24, s94, v19
    s_and_b32 s95, s66, s92
    v_fmac_f32 v25, s95, v19
    s_lshl_b32 s96, s67, 16
    v_fmac_f32 v26, s96, v19
    s_and_b32 s93, s67, s92
    v_fmac_f32 v27, s93, v19
    s_lshl_b32 s94, s68, 16
    v_fmac_f32 v24, s94, v20
    s_and_b32 s95, s68, s92
    v_fmac_f32 v25, s95, v20
    s_lshl_b32 s96, s69, 16
    v_fmac_f32 v26, s96, v20
    s_and_b32 s93, s69, s92
    v_fmac_f32 v27, s93, v20
    s_lshl_b32 s94, s70, 16
    v_fmac_f32 v24, s94, v21
    s_and_b32 s95, s70, s92
    v_fmac_f32 v25, s95, v21
    s_lshl_b32 s96, s71, 16
    v_fmac_f32 v26, s96, v21
    s_and_b32 s93, s71, s92
    v_fmac_f32 v27, s93, v21
    s_lshl_b32 s94, s72, 16
    v_fmac_f32 v24, s94, v22
    s_and_b32 s95, s72, s92
    v_fmac_f32 v25, s95, v22
    s_lshl_b32 s96, s73, 16
    v_fmac_f32 v26, s96, v22
    s_and_b32 s93, s73, s92
    v_fmac_f32 v27, s93, v22
    s_lshl_b32 s94, s74, 16
    v_fmac_f32 v24, s94, v23
    s_and_b32 s95, s74, s92
    v_fmac_f32 v25, s95, v23
    s_lshl_b32 s96, s75, 16
    v_fmac_f32 v26, s96, v23
    s_and_b32 s93, s75, s92
    v_fmac_f32 v27, s93, v23
    s_lshl_b32 s94, s44, 16
    v_mul_f32 v28, s94, v16
    s_and_b32 s95, s44, s92
    v_mul_f32 v29, s95, v16
    s_lshl_b32 s96, s45, 16
    v_mul_f32 v30, s96, v16
    s_and_b32 s93, s45, s92
    v_mul_f32 v31, s93, v16
    s_lshl_b32 s94, s46, 16
    v_fmac_f32 v28, s94, v17
    s_and_b32 s95, s46, s92
    v_fmac_f32 v29, s95, v17
    s_lshl_b32 s96, s47, 16
    v_fmac_f32 v30, s96, v17
    s_and_b32 s93, s47, s92
    v_fmac_f32 v31, s93, v17
    s_lshl_b32 s94, s48, 16
    v_fmac_f32 v28, s94, v18
    s_and_b32 s95, s48, s92
    v_fmac_f32 v29, s95, v18
    s_lshl_b32 s96, s49, 16
    v_fmac_f32 v30, s96, v18
    s_and_b32 s93, s49, s92
    v_fmac_f32 v31, s93, v18
    s_lshl_b32 s94, s50, 16
    v_fmac_f32 v28, s94, v19
    s_and_b32 s95, s50, s92
    v_fmac_f32 v29, s95, v19
    s_lshl_b32 s96, s51, 16
    v_fmac_f32 v30, s96, v19
    s_and_b32 s93, s51, s92
    v_fmac_f32 v31, s93, v19
    s_lshl_b32 s94, s52, 16
    v_fmac_f32 v28, s94, v20
    s_and_b32 s95, s52, s92
    v_fmac_f32 v29, s95, v20
    s_lshl_b32 s96, s53, 16
    v_fmac_f32 v30, s96, v20
    s_and_b32 s93, s53, s92
    v_fmac_f32 v31, s93, v20
    s_lshl_b32 s94, s54, 16
    v_fmac_f32 v28, s94, v21
    s_and_b32 s95, s54, s92
    v_fmac_f32 v29, s95, v21
    s_lshl_b32 s96, s55, 16
    v_fmac_f32 v30, s96, v21
    s_and_b32 s93, s55, s92
    v_fmac_f32 v31, s93, v21
    s_lshl_b32 s94, s56, 16
    v_fmac_f32 v28, s94, v22
    s_and_b32 s95, s56, s92
    v_fmac_f32 v29, s95, v22
    s_lshl_b32 s96, s57, 16
    v_fmac_f32 v30, s96, v22
    s_and_b32 s93, s57, s92
    v_fmac_f32 v31, s93, v22
    s_lshl_b32 s94, s58, 16
    v_fmac_f32 v28, s94, v23
    s_and_b32 s95, s58, s92
    v_fmac_f32 v29, s95, v23
    s_lshl_b32 s96, s59, 16
    v_fmac_f32 v30, s96, v23
    s_and_b32 s93, s59, s92
    v_fmac_f32 v31, s93, v23
    v_cvt_pk_bf16_f32 v28, v28, v29
    v_cvt_pk_bf16_f32 v30, v30, v31
    v_and_b32 v29, s92, v28
    v_lshlrev_b32 v28, 16, v28
    v_and_b32 v31, s92, v30
    v_lshlrev_b32 v30, 16, v30
    s_waitcnt vmcnt(0)
    v_mov_b32 v4, -65536
    v_mov_b32 v5, -65536
    v_mov_b32 v6, -65536
    v_mov_b32 v7, -65536
    v_add_u32_sdwa v4, v4, v32 dst_sel:DWORD dst_unused:UNUSED_PAD src0_sel:DWORD src1_sel:WORD_0
    v_add_u32_sdwa v5, v5, v32 dst_sel:DWORD dst_unused:UNUSED_PAD src0_sel:DWORD src1_sel:WORD_1
    v_add_u32_sdwa v6, v6, v33 dst_sel:DWORD dst_unused:UNUSED_PAD src0_sel:DWORD src1_sel:WORD_0
    v_add_u32_sdwa v7, v7, v33 dst_sel:DWORD dst_unused:UNUSED_PAD src0_sel:DWORD src1_sel:WORD_1
    v_add_u32_sdwa v4, v4, v34 dst_sel:DWORD dst_unused:UNUSED_PAD src0_sel:DWORD src1_sel:WORD_0
    v_add_u32_sdwa v5, v5, v34 dst_sel:DWORD dst_unused:UNUSED_PAD src0_sel:DWORD src1_sel:WORD_1
    v_add_u32_sdwa v6, v6, v35 dst_sel:DWORD dst_unused:UNUSED_PAD src0_sel:DWORD src1_sel:WORD_0
    v_add_u32_sdwa v7, v7, v35 dst_sel:DWORD dst_unused:UNUSED_PAD src0_sel:DWORD src1_sel:WORD_1
    v_add_u32_sdwa v4, v4, v36 dst_sel:DWORD dst_unused:UNUSED_PAD src0_sel:DWORD src1_sel:WORD_0
    v_add_u32_sdwa v5, v5, v36 dst_sel:DWORD dst_unused:UNUSED_PAD src0_sel:DWORD src1_sel:WORD_1
    v_add_u32_sdwa v6, v6, v37 dst_sel:DWORD dst_unused:UNUSED_PAD src0_sel:DWORD src1_sel:WORD_0
    v_add_u32_sdwa v7, v7, v37 dst_sel:DWORD dst_unused:UNUSED_PAD src0_sel:DWORD src1_sel:WORD_1
    v_add_u32_sdwa v4, v4, v38 dst_sel:DWORD dst_unused:UNUSED_PAD src0_sel:DWORD src1_sel:WORD_0
    v_add_u32_sdwa v5, v5, v38 dst_sel:DWORD dst_unused:UNUSED_PAD src0_sel:DWORD src1_sel:WORD_1
    v_add_u32_sdwa v6, v6, v39 dst_sel:DWORD dst_unused:UNUSED_PAD src0_sel:DWORD src1_sel:WORD_0
    v_add_u32_sdwa v7, v7, v39 dst_sel:DWORD dst_unused:UNUSED_PAD src0_sel:DWORD src1_sel:WORD_1
    v_max3_u32 v14, v48, v49, v50
    v_min3_u32 v15, v48, v49, v50
    v_max_u32 v14, v14, v51
    v_min_u32 v15, v15, v51
    v_cvt_f32_i32 v4, v4
    v_cvt_f32_i32 v5, v5
    v_cvt_f32_i32 v6, v6
    v_cvt_f32_i32 v7, v7
    v_cmp_eq_u32 vcc, 0, v15
    v_mul_f32 v4, v14, v4
    v_mul_f32 v5, v14, v5
    v_mul_f32 v6, v14, v6
    v_mul_f32 v7, v14, v7
    s_cbranch_vccz p3_nof
    v_lshlrev_b32 v1, 4, v0
    v_mov_b32 v3, 0x70000000
    v_cmp_eq_u32 vcc, 0, v48
    s_mov_b32 s22, 389051392
    s_nop 0
    v_cndmask_b32 v15, v3, v1, vcc
    buffer_load_dwordx4 v[8:11], v15, s[36:39], s22 offen
    s_waitcnt vmcnt(0)
    v_add_f32 v4, v4, v8
    v_add_f32 v5, v5, v9
    v_add_f32 v6, v6, v10
    v_add_f32 v7, v7, v11
    v_cmp_eq_u32 vcc, 0, v49
    s_mov_b32 s22, 401863680
    s_nop 0
    v_cndmask_b32 v15, v3, v1, vcc
    buffer_load_dwordx4 v[8:11], v15, s[36:39], s22 offen
    s_waitcnt vmcnt(0)
    v_add_f32 v4, v4, v8
    v_add_f32 v5, v5, v9
    v_add_f32 v6, v6, v10
    v_add_f32 v7, v7, v11
    v_cmp_eq_u32 vcc, 0, v50
    s_mov_b32 s22, 414675968
    s_nop 0
    v_cndmask_b32 v15, v3, v1, vcc
    buffer_load_dwordx4 v[8:11], v15, s[36:39], s22 offen
    s_waitcnt vmcnt(0)
    v_add_f32 v4, v4, v8
    v_add_f32 v5, v5, v9
    v_add_f32 v6, v6, v10
    v_add_f32 v7, v7, v11
    v_cmp_eq_u32 vcc, 0, v51
    s_mov_b32 s22, 427488256
    s_nop 0
    v_cndmask_b32 v15, v3, v1, vcc
    buffer_load_dwordx4 v[8:11], v15, s[36:39], s22 offen
    s_waitcnt vmcnt(0)
    v_add_f32 v4, v4, v8
    v_add_f32 v5, v5, v9
    v_add_f32 v6, v6, v10
    v_add_f32 v7, v7, v11
p3_nof:
    s_lshl_b32 s94, s76, 16
    v_mul_f32 v8, s94, v4
    s_and_b32 s95, s76, s92
    v_mul_f32 v9, s95, v4
    s_lshl_b32 s96, s77, 16
    v_mul_f32 v10, s96, v4
    s_and_b32 s93, s77, s92
    v_mul_f32 v11, s93, v4
    s_lshl_b32 s94, s78, 16
    v_fmac_f32 v8, s94, v5
    s_and_b32 s95, s78, s92
    v_fmac_f32 v9, s95, v5
    s_lshl_b32 s96, s79, 16
    v_fmac_f32 v10, s96, v5
    s_and_b32 s93, s79, s92
    v_fmac_f32 v11, s93, v5
    s_lshl_b32 s94, s80, 16
    v_fmac_f32 v8, s94, v6
    s_and_b32 s95, s80, s92
    v_fmac_f32 v9, s95, v6
    s_lshl_b32 s96, s81, 16
    v_fmac_f32 v10, s96, v6
    s_and_b32 s93, s81, s92
    v_fmac_f32 v11, s93, v6
    s_lshl_b32 s94, s82, 16
    v_fmac_f32 v8, s94, v7
    s_and_b32 s95, s82, s92
    v_fmac_f32 v9, s95, v7
    s_lshl_b32 s96, s83, 16
    v_fmac_f32 v10, s96, v7
    s_and_b32 s93, s83, s92
    v_fmac_f32 v11, s93, v7
    v_mul_f32 v24, v24, v8
    v_mul_f32 v25, v25, v9
    v_mul_f32 v26, v26, v10
    v_mul_f32 v27, v27, v11
    v_cvt_pk_bf16_f32 v24, v24, v25
    v_cvt_pk_bf16_f32 v26, v26, v27
    v_and_b32 v25, s92, v24
    v_lshlrev_b32 v24, 16, v24
    v_and_b32 v27, s92, v26
    v_lshlrev_b32 v26, 16, v26
    s_lshl_b32 s94, s84, 16
    v_mul_f32 v8, s94, v24
    s_and_b32 s95, s84, s92
    v_mul_f32 v9, s95, v24
    s_lshl_b32 s96, s85, 16
    v_mul_f32 v10, s96, v24
    s_and_b32 s93, s85, s92
    v_mul_f32 v11, s93, v24
    s_lshl_b32 s94, s86, 16
    v_fmac_f32 v8, s94, v25
    s_and_b32 s95, s86, s92
    v_fmac_f32 v9, s95, v25
    s_lshl_b32 s96, s87, 16
    v_fmac_f32 v10, s96, v25
    s_and_b32 s93, s87, s92
    v_fmac_f32 v11, s93, v25
    s_lshl_b32 s94, s88, 16
    v_fmac_f32 v8, s94, v26
    s_and_b32 s95, s88, s92
    v_fmac_f32 v9, s95, v26
    s_lshl_b32 s96, s89, 16
    v_fmac_f32 v10, s96, v26
    s_and_b32 s93, s89, s92
    v_fmac_f32 v11, s93, v26
    s_lshl_b32 s94, s90, 16
    v_fmac_f32 v8, s94, v27
    s_and_b32 s95, s90, s92
    v_fmac_f32 v9, s95, v27
    s_lshl_b32 s96, s91, 16
    v_fmac_f32 v10, s96, v27
    s_and_b32 s93, s91, s92
    v_fmac_f32 v11, s93, v27
    v_cvt_pk_bf16_f32 v8, v8, v9
    v_cvt_pk_bf16_f32 v10, v10, v11
    v_and_b32 v9, s92, v8
    v_lshlrev_b32 v8, 16, v8
    v_and_b32 v11, s92, v10
    v_lshlrev_b32 v10, 16, v10
    v_mul_f32 v8, v8, v28
    v_mul_f32 v9, v9, v29
    v_mul_f32 v10, v10, v30
    v_mul_f32 v11, v11, v31
    v_cvt_pk_bf16_f32 v8, v8, v9
    v_cvt_pk_bf16_f32 v10, v10, v11
    v_and_b32 v9, s92, v8
    v_lshlrev_b32 v8, 16, v8
    v_and_b32 v11, s92, v10
    v_lshlrev_b32 v10, 16, v10
    v_lshlrev_b32 v4, 16, v12
    v_and_b32 v5, s92, v12
    v_lshlrev_b32 v6, 16, v13
    v_and_b32 v7, s92, v13
    v_add_f32 v4, v4, v8
    v_add_f32 v5, v5, v9
    v_add_f32 v6, v6, v10
    v_add_f32 v7, v7, v11
    v_cvt_pk_bf16_f32 v4, v4, v5
    v_cvt_pk_bf16_f32 v5, v6, v7
    buffer_store_dwordx2 v[4:5], v2, s[32:35], 0 offen
p3_end:
    s_endpgm
.section .rodata,"a"
.p2align 6
.amdhsa_kernel p1_kernel
  .amdhsa_next_free_vgpr 128
  .amdhsa_next_free_sgpr 72
  .amdhsa_accum_offset 128
  .amdhsa_group_segment_fixed_size 0
  .amdhsa_kernarg_size 112
  .amdhsa_user_sgpr_count 2
  .amdhsa_user_sgpr_kernarg_segment_ptr 1
  .amdhsa_system_sgpr_workgroup_id_x 1
  .amdhsa_float_denorm_mode_32 3
.end_amdhsa_kernel
.p2align 6
.amdhsa_kernel p2_kernel
  .amdhsa_next_free_vgpr 128
  .amdhsa_next_free_sgpr 72
  .amdhsa_accum_offset 128
  .amdhsa_group_segment_fixed_size 0
  .amdhsa_kernarg_size 112
  .amdhsa_user_sgpr_count 2
  .amdhsa_user_sgpr_kernarg_segment_ptr 1
  .amdhsa_system_sgpr_workgroup_id_x 1
  .amdhsa_float_denorm_mode_32 3
.end_amdhsa_kernel
.p2align 6
.amdhsa_kernel p3_kernel
  .amdhsa_next_free_vgpr 56
  .amdhsa_next_free_sgpr 100
  .amdhsa_accum_offset 56
  .amdhsa_group_segment_fixed_size 0
  .amdhsa_kernarg_size 112
  .amdhsa_user_sgpr_count 2
  .amdhsa_user_sgpr_kernarg_segment_ptr 1
  .amdhsa_system_sgpr_workgroup_id_x 1
  .amdhsa_float_denorm_mode_32 3
.end_amdhsa_kernel
```

```asm
; @launch kernel=p1_kernel grid=(256,1,1) block=(1024,1,1) lds=161600
; @launch kernel=p2_kernel grid=(256,1,1) block=(1024,1,1) lds=154368
; @launch kernel=p3_kernel grid=(3125,1,1) block=(256,1,1) lds=0
.amdgcn_target "amdgcn-amd-amdhsa--gfx950"
.text
.globl p1_kernel
.p2align 8
.type p1_kernel,@function
p1_kernel:
    s_cmp_ge_u32 s2, 256
    s_cbranch_scc1 p1_end
    s_load_dwordx2 s[52:53], s[0:1], 0
    s_load_dwordx4 s[56:59], s[0:1], 8
    s_load_dwordx2 s[54:55], s[0:1], 32
    s_load_dwordx2 s[60:61], s[0:1], 48
    s_load_dwordx2 s[48:49], s[0:1], 104
    s_load_dwordx2 s[62:63], s[0:1], 96
    v_lshlrev_b32 v1, 4, v0
    v_lshlrev_b32 v2, 3, v0
    v_mov_b32 v3, 1
    v_lshrrev_b32 v117, 6, v0
    s_nop 0
    v_readfirstlane_b32 s28, v117
    s_waitcnt lgkmcnt(0)
    s_load_dword s41, s[60:61], 0
    s_mov_b32 s24, s52
    s_and_b32 s25, s53, 0xffff
    s_mov_b32 s26, 6400000
    s_mov_b32 s27, 0x20000
    s_mov_b32 s4, s56
    s_and_b32 s5, s57, 0xffff
    s_mov_b32 s6, 204800000
    s_mov_b32 s7, 0x20000
    s_mov_b32 s8, s58
    s_and_b32 s9, s59, 0xffff
    s_mov_b32 s10, 204800000
    s_mov_b32 s11, 0x20000
    s_mov_b32 s12, s54
    s_and_b32 s13, s55, 0xffff
    s_mov_b32 s14, 102400000
    s_mov_b32 s15, 0x20000
    s_mov_b32 s16, s48
    s_and_b32 s17, s49, 0xffff
    s_mov_b32 s18, 819200000
    s_mov_b32 s19, 0x20000
    s_mov_b32 s20, s48
    s_and_b32 s21, s49, 0xffff
    s_mov_b32 s22, 0
    s_mov_b32 s23, 0x20000
    s_mov_b32 s88, s62
    s_and_b32 s89, s63, 0xffff
    s_mov_b32 s90, 256
    s_mov_b32 s91, 0x20000
    s_mov_b32 s36, 643827
    s_mov_b32 s37, 214609
    s_mov_b32 s38, 343268
    s_mov_b32 s39, -6671
    s_mov_b32 s40, -12512
    s_waitcnt lgkmcnt(0)
    s_lshl_b32 s41, s41, 16
    s_mov_b32 s29, s2
    s_add_u32 s68, s2, 256
    s_cmp_lt_u32 s29, 1696
    s_cselect_b32 s34, 8, 0
    s_mul_i32 s47, s29, 392
    s_sub_i32 s50, s29, 1696
    s_max_i32 s50, s50, 0
    s_lshl_b32 s50, s50, 3
    s_sub_u32 s47, s47, s50
    s_lshl_b32 s30, s47, 8
    s_lshl_b32 s31, s47, 7
    s_add_u32 s32, s30, 0
    buffer_load_dwordx4 v[4:7], v1, s[4:7], s32 offen nt
    buffer_load_dwordx4 v[28:31], v1, s[8:11], s32 offen nt
    s_add_u32 s32, s31, 0
    buffer_load_dwordx2 v[52:53], v2, s[12:15], s32 offen nt
    s_add_u32 s32, s30, 16384
    buffer_load_dwordx4 v[8:11], v1, s[4:7], s32 offen nt
    buffer_load_dwordx4 v[32:35], v1, s[8:11], s32 offen nt
    s_add_u32 s32, s31, 8192
    buffer_load_dwordx2 v[54:55], v2, s[12:15], s32 offen nt
    s_add_u32 s32, s30, 32768
    buffer_load_dwordx4 v[12:15], v1, s[4:7], s32 offen nt
    buffer_load_dwordx4 v[36:39], v1, s[8:11], s32 offen nt
    s_add_u32 s32, s31, 16384
    buffer_load_dwordx2 v[56:57], v2, s[12:15], s32 offen nt
    s_add_u32 s32, s30, 49152
    buffer_load_dwordx4 v[16:19], v1, s[4:7], s32 offen nt
    buffer_load_dwordx4 v[40:43], v1, s[8:11], s32 offen nt
    s_add_u32 s32, s31, 24576
    buffer_load_dwordx2 v[58:59], v2, s[12:15], s32 offen nt
    s_add_u32 s32, s30, 65536
    buffer_load_dwordx4 v[20:23], v1, s[4:7], s32 offen nt
    buffer_load_dwordx4 v[44:47], v1, s[8:11], s32 offen nt
    s_add_u32 s32, s31, 32768
    buffer_load_dwordx2 v[60:61], v2, s[12:15], s32 offen nt
    s_add_u32 s32, s30, 81920
    buffer_load_dwordx4 v[24:27], v1, s[4:7], s32 offen nt
    buffer_load_dwordx4 v[48:51], v1, s[8:11], s32 offen nt
    s_add_u32 s32, s31, 40960
    buffer_load_dwordx2 v[62:63], v2, s[12:15], s32 offen nt
    s_cmp_lt_u32 s28, s34
    s_cselect_b32 s46, 0, 0x40000000
    v_lshl_add_u32 v117, v0, 2, s46
    s_add_u32 s32, s30, 98304
    buffer_load_dword v64, v117, s[4:7], s32 offen nt
    buffer_load_dword v65, v117, s[8:11], s32 offen nt
    v_lshrrev_b32 v117, 1, v117
    s_add_u32 s32, s31, 49152
    buffer_load_ushort v66, v117, s[12:15], s32 offen nt
    v_mov_b32 v68, 0
    v_mov_b32 v69, 0
    v_mov_b32 v70, 0
    v_mov_b32 v71, 0
    ds_write_b128 v1, v[68:71] offset:0
    s_waitcnt vmcnt(0) lgkmcnt(0)
    s_barrier
p1_tile:
    s_mov_b32 s33, s34
    s_cmp_lt_u32 s68, 1696
    s_cselect_b32 s34, 8, 0
    s_mul_i32 s47, s68, 392
    s_sub_i32 s50, s68, 1696
    s_max_i32 s50, s50, 0
    s_lshl_b32 s50, s50, 3
    s_sub_u32 s47, s47, s50
    s_lshl_b32 s30, s47, 8
    s_lshl_b32 s31, s47, 7
    v_mov_b32 v68, 0
    v_mov_b32 v69, 0
    v_mov_b32 v70, 0
    v_mov_b32 v71, 0
    ds_write_b128 v1, v[68:71] offset:10496
    ds_write_b128 v1, v[68:71] offset:26880
    s_waitcnt vmcnt(10)
    v_mov_b32 v123, s41
    v_mov_b32 v124, 0x007f007f
    v_mov_b32 v125, 0xe000
    v_mov_b32 v126, 0xffff0000
    v_lshlrev_b32 v117, 16, v52
    v_and_b32 v118, v126, v52
    v_mul_f32 v117, v123, v117
    v_mul_f32 v118, v123, v118
    v_cvt_pk_bf16_f32 v117, v117, v118
    v_and_b32 v118, v126, v117
    v_lshlrev_b32 v117, 16, v117
    v_mul_f32 v117, 0.15915494, v117
    v_mul_f32 v118, 0.15915494, v118
    v_fract_f32 v117, v117
    v_fract_f32 v118, v118
    v_cos_f32 v117, v117
    v_cos_f32 v118, v118
    v_mul_hi_u32_u24 v120, s36, v4
    v_mul_hi_u32_u24 v121, s37, v4
    v_mul_hi_u32_u24 v122, s38, v28
    v_mad_i32_i24 v67, v120, s39, v4
    v_mad_u32_u24 v92, v122, 40, v121
    v_mad_i32_i24 v120, v121, -3, v120
    v_lshlrev_b16 v92, 2, v92
    v_mad_i32_i24 v122, v122, s40, v28
    ds_add_u32 v92, v3 offset:0
    v_lshl_or_b32 v67, v120, 30, v67
    v_lshl_or_b32 v67, v122, 16, v67
    v_mul_f32 v117, 0x03800000, v117
    v_mul_f32 v118, 0x03800000, v118
    v_cvt_pk_bf16_f32 v117, v117, v118
    v_mul_hi_u32_u24 v120, s36, v5
    v_mul_hi_u32_u24 v121, s37, v5
    v_mul_hi_u32_u24 v122, s38, v29
    v_mad_i32_i24 v68, v120, s39, v5
    v_mad_u32_u24 v93, v122, 40, v121
    v_mad_i32_i24 v120, v121, -3, v120
    v_lshlrev_b16 v93, 2, v93
    v_mad_i32_i24 v122, v122, s40, v29
    ds_add_u32 v93, v3 offset:0
    v_lshl_or_b32 v68, v120, 30, v68
    v_lshl_or_b32 v68, v122, 16, v68
    v_lshrrev_b32 v118, 3, v117
    v_lshrrev_b32 v119, 8, v117
    v_lshlrev_b16 v117, 13, v117
    v_bitop3_b32 v119, v118, v119, v124 bitop3:0x1b
    v_bitop3_b32 v67, v117, v125, v67 bitop3:0xae
    v_lshl_or_b32 v92, v119, 16, v92
    v_bitop3_b32 v68, v118, v125, v68 bitop3:0xae
    v_bitop3_b32 v93, v119, v126, v93 bitop3:0xea
    v_lshlrev_b32 v117, 16, v53
    v_and_b32 v118, v126, v53
    v_mul_f32 v117, v123, v117
    v_mul_f32 v118, v123, v118
    v_cvt_pk_bf16_f32 v117, v117, v118
    v_and_b32 v118, v126, v117
    v_lshlrev_b32 v117, 16, v117
    v_mul_f32 v117, 0.15915494, v117
    v_mul_f32 v118, 0.15915494, v118
    v_fract_f32 v117, v117
    v_fract_f32 v118, v118
    v_cos_f32 v117, v117
    v_cos_f32 v118, v118
    v_mul_hi_u32_u24 v120, s36, v6
    v_mul_hi_u32_u24 v121, s37, v6
    v_mul_hi_u32_u24 v122, s38, v30
    v_mad_i32_i24 v69, v120, s39, v6
    v_mad_u32_u24 v94, v122, 40, v121
    v_mad_i32_i24 v120, v121, -3, v120
    v_lshlrev_b16 v94, 2, v94
    v_mad_i32_i24 v122, v122, s40, v30
    ds_add_u32 v94, v3 offset:0
    v_lshl_or_b32 v69, v120, 30, v69
    v_lshl_or_b32 v69, v122, 16, v69
    v_mul_f32 v117, 0x03800000, v117
    v_mul_f32 v118, 0x03800000, v118
    v_cvt_pk_bf16_f32 v117, v117, v118
    v_mul_hi_u32_u24 v120, s36, v7
    v_mul_hi_u32_u24 v121, s37, v7
    v_mul_hi_u32_u24 v122, s38, v31
    v_mad_i32_i24 v70, v120, s39, v7
    v_mad_u32_u24 v95, v122, 40, v121
    v_mad_i32_i24 v120, v121, -3, v120
    v_lshlrev_b16 v95, 2, v95
    v_mad_i32_i24 v122, v122, s40, v31
    ds_add_u32 v95, v3 offset:0
    v_lshl_or_b32 v70, v120, 30, v70
    v_lshl_or_b32 v70, v122, 16, v70
    v_lshrrev_b32 v118, 3, v117
    v_lshrrev_b32 v119, 8, v117
    v_lshlrev_b16 v117, 13, v117
    v_bitop3_b32 v119, v118, v119, v124 bitop3:0x1b
    v_bitop3_b32 v69, v117, v125, v69 bitop3:0xae
    v_lshl_or_b32 v94, v119, 16, v94
    v_bitop3_b32 v70, v118, v125, v70 bitop3:0xae
    v_bitop3_b32 v95, v119, v126, v95 bitop3:0xea
    v_lshlrev_b32 v117, 16, v54
    v_and_b32 v118, v126, v54
    v_mul_f32 v117, v123, v117
    v_mul_f32 v118, v123, v118
    v_cvt_pk_bf16_f32 v117, v117, v118
    v_and_b32 v118, v126, v117
    v_lshlrev_b32 v117, 16, v117
    v_mul_f32 v117, 0.15915494, v117
    v_mul_f32 v118, 0.15915494, v118
    v_fract_f32 v117, v117
    v_fract_f32 v118, v118
    v_cos_f32 v117, v117
    v_cos_f32 v118, v118
    v_mul_hi_u32_u24 v120, s36, v8
    v_mul_hi_u32_u24 v121, s37, v8
    v_mul_hi_u32_u24 v122, s38, v32
    v_mad_i32_i24 v71, v120, s39, v8
    v_mad_u32_u24 v96, v122, 40, v121
    v_mad_i32_i24 v120, v121, -3, v120
    v_lshlrev_b16 v96, 2, v96
    v_mad_i32_i24 v122, v122, s40, v32
    ds_add_u32 v96, v3 offset:0
    v_lshl_or_b32 v71, v120, 30, v71
    v_lshl_or_b32 v71, v122, 16, v71
    v_mul_f32 v117, 0x03800000, v117
    v_mul_f32 v118, 0x03800000, v118
    v_cvt_pk_bf16_f32 v117, v117, v118
    v_mul_hi_u32_u24 v120, s36, v9
    v_mul_hi_u32_u24 v121, s37, v9
    v_mul_hi_u32_u24 v122, s38, v33
    v_mad_i32_i24 v72, v120, s39, v9
    v_mad_u32_u24 v97, v122, 40, v121
    v_mad_i32_i24 v120, v121, -3, v120
    v_lshlrev_b16 v97, 2, v97
    v_mad_i32_i24 v122, v122, s40, v33
    ds_add_u32 v97, v3 offset:0
    v_lshl_or_b32 v72, v120, 30, v72
    v_lshl_or_b32 v72, v122, 16, v72
    v_lshrrev_b32 v118, 3, v117
    v_lshrrev_b32 v119, 8, v117
    v_lshlrev_b16 v117, 13, v117
    v_bitop3_b32 v119, v118, v119, v124 bitop3:0x1b
    v_bitop3_b32 v71, v117, v125, v71 bitop3:0xae
    v_lshl_or_b32 v96, v119, 16, v96
    v_bitop3_b32 v72, v118, v125, v72 bitop3:0xae
    v_bitop3_b32 v97, v119, v126, v97 bitop3:0xea
    v_lshlrev_b32 v117, 16, v55
    v_and_b32 v118, v126, v55
    v_mul_f32 v117, v123, v117
    v_mul_f32 v118, v123, v118
    v_cvt_pk_bf16_f32 v117, v117, v118
    v_and_b32 v118, v126, v117
    v_lshlrev_b32 v117, 16, v117
    v_mul_f32 v117, 0.15915494, v117
    v_mul_f32 v118, 0.15915494, v118
    v_fract_f32 v117, v117
    v_fract_f32 v118, v118
    v_cos_f32 v117, v117
    v_cos_f32 v118, v118
    v_mul_hi_u32_u24 v120, s36, v10
    v_mul_hi_u32_u24 v121, s37, v10
    v_mul_hi_u32_u24 v122, s38, v34
    v_mad_i32_i24 v73, v120, s39, v10
    v_mad_u32_u24 v98, v122, 40, v121
    v_mad_i32_i24 v120, v121, -3, v120
    v_lshlrev_b16 v98, 2, v98
    v_mad_i32_i24 v122, v122, s40, v34
    ds_add_u32 v98, v3 offset:0
    v_lshl_or_b32 v73, v120, 30, v73
    v_lshl_or_b32 v73, v122, 16, v73
    v_mul_f32 v117, 0x03800000, v117
    v_mul_f32 v118, 0x03800000, v118
    v_cvt_pk_bf16_f32 v117, v117, v118
    v_mul_hi_u32_u24 v120, s36, v11
    v_mul_hi_u32_u24 v121, s37, v11
    v_mul_hi_u32_u24 v122, s38, v35
    v_mad_i32_i24 v74, v120, s39, v11
    v_mad_u32_u24 v99, v122, 40, v121
    v_mad_i32_i24 v120, v121, -3, v120
    v_lshlrev_b16 v99, 2, v99
    v_mad_i32_i24 v122, v122, s40, v35
    ds_add_u32 v99, v3 offset:0
    v_lshl_or_b32 v74, v120, 30, v74
    v_lshl_or_b32 v74, v122, 16, v74
    v_lshrrev_b32 v118, 3, v117
    v_lshrrev_b32 v119, 8, v117
    v_lshlrev_b16 v117, 13, v117
    v_bitop3_b32 v119, v118, v119, v124 bitop3:0x1b
    v_bitop3_b32 v73, v117, v125, v73 bitop3:0xae
    v_lshl_or_b32 v98, v119, 16, v98
    v_bitop3_b32 v74, v118, v125, v74 bitop3:0xae
    v_bitop3_b32 v99, v119, v126, v99 bitop3:0xea
    s_waitcnt lgkmcnt(4)
    s_cmp_ge_u32 s68, 2048
    s_cbranch_scc1 p1_nl0
    s_add_u32 s32, s30, 0
    buffer_load_dwordx4 v[4:7], v1, s[4:7], s32 offen nt
    buffer_load_dwordx4 v[28:31], v1, s[8:11], s32 offen nt
    s_add_u32 s32, s31, 0
    buffer_load_dwordx2 v[52:53], v2, s[12:15], s32 offen nt
p1_nl0:
    v_lshlrev_b32 v117, 16, v56
    v_and_b32 v118, v126, v56
    v_mul_f32 v117, v123, v117
    v_mul_f32 v118, v123, v118
    v_cvt_pk_bf16_f32 v117, v117, v118
    v_and_b32 v118, v126, v117
    v_lshlrev_b32 v117, 16, v117
    v_mul_f32 v117, 0.15915494, v117
    v_mul_f32 v118, 0.15915494, v118
    v_fract_f32 v117, v117
    v_fract_f32 v118, v118
    v_cos_f32 v117, v117
    v_cos_f32 v118, v118
    v_mul_hi_u32_u24 v120, s36, v12
    v_mul_hi_u32_u24 v121, s37, v12
    v_mul_hi_u32_u24 v122, s38, v36
    v_mad_i32_i24 v75, v120, s39, v12
    v_mad_u32_u24 v100, v122, 40, v121
    v_mad_i32_i24 v120, v121, -3, v120
    v_lshlrev_b16 v100, 2, v100
    v_mad_i32_i24 v122, v122, s40, v36
    ds_add_u32 v100, v3 offset:0
    v_lshl_or_b32 v75, v120, 30, v75
    v_lshl_or_b32 v75, v122, 16, v75
    v_mul_f32 v117, 0x03800000, v117
    v_mul_f32 v118, 0x03800000, v118
    v_cvt_pk_bf16_f32 v117, v117, v118
    v_mul_hi_u32_u24 v120, s36, v13
    v_mul_hi_u32_u24 v121, s37, v13
    v_mul_hi_u32_u24 v122, s38, v37
    v_mad_i32_i24 v76, v120, s39, v13
    v_mad_u32_u24 v101, v122, 40, v121
    v_mad_i32_i24 v120, v121, -3, v120
    v_lshlrev_b16 v101, 2, v101
    v_mad_i32_i24 v122, v122, s40, v37
    ds_add_u32 v101, v3 offset:0
    v_lshl_or_b32 v76, v120, 30, v76
    v_lshl_or_b32 v76, v122, 16, v76
    v_lshrrev_b32 v118, 3, v117
    v_lshrrev_b32 v119, 8, v117
    v_lshlrev_b16 v117, 13, v117
    v_bitop3_b32 v119, v118, v119, v124 bitop3:0x1b
    v_bitop3_b32 v75, v117, v125, v75 bitop3:0xae
    v_lshl_or_b32 v100, v119, 16, v100
    v_bitop3_b32 v76, v118, v125, v76 bitop3:0xae
    v_bitop3_b32 v101, v119, v126, v101 bitop3:0xea
    v_lshlrev_b32 v117, 16, v57
    v_and_b32 v118, v126, v57
    v_mul_f32 v117, v123, v117
    v_mul_f32 v118, v123, v118
    v_cvt_pk_bf16_f32 v117, v117, v118
    v_and_b32 v118, v126, v117
    v_lshlrev_b32 v117, 16, v117
    v_mul_f32 v117, 0.15915494, v117
    v_mul_f32 v118, 0.15915494, v118
    v_fract_f32 v117, v117
    v_fract_f32 v118, v118
    v_cos_f32 v117, v117
    v_cos_f32 v118, v118
    v_mul_hi_u32_u24 v120, s36, v14
    v_mul_hi_u32_u24 v121, s37, v14
    v_mul_hi_u32_u24 v122, s38, v38
    v_mad_i32_i24 v77, v120, s39, v14
    v_mad_u32_u24 v102, v122, 40, v121
    v_mad_i32_i24 v120, v121, -3, v120
    v_lshlrev_b16 v102, 2, v102
    v_mad_i32_i24 v122, v122, s40, v38
    ds_add_u32 v102, v3 offset:0
    v_lshl_or_b32 v77, v120, 30, v77
    v_lshl_or_b32 v77, v122, 16, v77
    v_mul_f32 v117, 0x03800000, v117
    v_mul_f32 v118, 0x03800000, v118
    v_cvt_pk_bf16_f32 v117, v117, v118
    v_mul_hi_u32_u24 v120, s36, v15
    v_mul_hi_u32_u24 v121, s37, v15
    v_mul_hi_u32_u24 v122, s38, v39
    v_mad_i32_i24 v78, v120, s39, v15
    v_mad_u32_u24 v103, v122, 40, v121
    v_mad_i32_i24 v120, v121, -3, v120
    v_lshlrev_b16 v103, 2, v103
    v_mad_i32_i24 v122, v122, s40, v39
    ds_add_u32 v103, v3 offset:0
    v_lshl_or_b32 v78, v120, 30, v78
    v_lshl_or_b32 v78, v122, 16, v78
    v_lshrrev_b32 v118, 3, v117
    v_lshrrev_b32 v119, 8, v117
    v_lshlrev_b16 v117, 13, v117
    v_bitop3_b32 v119, v118, v119, v124 bitop3:0x1b
    v_bitop3_b32 v77, v117, v125, v77 bitop3:0xae
    v_lshl_or_b32 v102, v119, 16, v102
    v_bitop3_b32 v78, v118, v125, v78 bitop3:0xae
    v_bitop3_b32 v103, v119, v126, v103 bitop3:0xea
    v_lshlrev_b32 v117, 16, v58
    v_and_b32 v118, v126, v58
    v_mul_f32 v117, v123, v117
    v_mul_f32 v118, v123, v118
    v_cvt_pk_bf16_f32 v117, v117, v118
    v_and_b32 v118, v126, v117
    v_lshlrev_b32 v117, 16, v117
    v_mul_f32 v117, 0.15915494, v117
    v_mul_f32 v118, 0.15915494, v118
    v_fract_f32 v117, v117
    v_fract_f32 v118, v118
    v_cos_f32 v117, v117
    v_cos_f32 v118, v118
    v_mul_hi_u32_u24 v120, s36, v16
    v_mul_hi_u32_u24 v121, s37, v16
    v_mul_hi_u32_u24 v122, s38, v40
    v_mad_i32_i24 v79, v120, s39, v16
    v_mad_u32_u24 v104, v122, 40, v121
    v_mad_i32_i24 v120, v121, -3, v120
    v_lshlrev_b16 v104, 2, v104
    v_mad_i32_i24 v122, v122, s40, v40
    ds_add_u32 v104, v3 offset:0
    v_lshl_or_b32 v79, v120, 30, v79
    v_lshl_or_b32 v79, v122, 16, v79
    v_mul_f32 v117, 0x03800000, v117
    v_mul_f32 v118, 0x03800000, v118
    v_cvt_pk_bf16_f32 v117, v117, v118
    v_mul_hi_u32_u24 v120, s36, v17
    v_mul_hi_u32_u24 v121, s37, v17
    v_mul_hi_u32_u24 v122, s38, v41
    v_mad_i32_i24 v80, v120, s39, v17
    v_mad_u32_u24 v105, v122, 40, v121
    v_mad_i32_i24 v120, v121, -3, v120
    v_lshlrev_b16 v105, 2, v105
    v_mad_i32_i24 v122, v122, s40, v41
    ds_add_u32 v105, v3 offset:0
    v_lshl_or_b32 v80, v120, 30, v80
    v_lshl_or_b32 v80, v122, 16, v80
    v_lshrrev_b32 v118, 3, v117
    v_lshrrev_b32 v119, 8, v117
    v_lshlrev_b16 v117, 13, v117
    v_bitop3_b32 v119, v118, v119, v124 bitop3:0x1b
    v_bitop3_b32 v79, v117, v125, v79 bitop3:0xae
    v_lshl_or_b32 v104, v119, 16, v104
    v_bitop3_b32 v80, v118, v125, v80 bitop3:0xae
    v_bitop3_b32 v105, v119, v126, v105 bitop3:0xea
    v_lshlrev_b32 v117, 16, v59
    v_and_b32 v118, v126, v59
    v_mul_f32 v117, v123, v117
    v_mul_f32 v118, v123, v118
    v_cvt_pk_bf16_f32 v117, v117, v118
    v_and_b32 v118, v126, v117
    v_lshlrev_b32 v117, 16, v117
    v_mul_f32 v117, 0.15915494, v117
    v_mul_f32 v118, 0.15915494, v118
    v_fract_f32 v117, v117
    v_fract_f32 v118, v118
    v_cos_f32 v117, v117
    v_cos_f32 v118, v118
    v_mul_hi_u32_u24 v120, s36, v18
    v_mul_hi_u32_u24 v121, s37, v18
    v_mul_hi_u32_u24 v122, s38, v42
    v_mad_i32_i24 v81, v120, s39, v18
    v_mad_u32_u24 v106, v122, 40, v121
    v_mad_i32_i24 v120, v121, -3, v120
    v_lshlrev_b16 v106, 2, v106
    v_mad_i32_i24 v122, v122, s40, v42
    ds_add_u32 v106, v3 offset:0
    v_lshl_or_b32 v81, v120, 30, v81
    v_lshl_or_b32 v81, v122, 16, v81
    v_mul_f32 v117, 0x03800000, v117
    v_mul_f32 v118, 0x03800000, v118
    v_cvt_pk_bf16_f32 v117, v117, v118
    v_mul_hi_u32_u24 v120, s36, v19
    v_mul_hi_u32_u24 v121, s37, v19
    v_mul_hi_u32_u24 v122, s38, v43
    v_mad_i32_i24 v82, v120, s39, v19
    v_mad_u32_u24 v107, v122, 40, v121
    v_mad_i32_i24 v120, v121, -3, v120
    v_lshlrev_b16 v107, 2, v107
    v_mad_i32_i24 v122, v122, s40, v43
    ds_add_u32 v107, v3 offset:0
    v_lshl_or_b32 v82, v120, 30, v82
    v_lshl_or_b32 v82, v122, 16, v82
    v_lshrrev_b32 v118, 3, v117
    v_lshrrev_b32 v119, 8, v117
    v_lshlrev_b16 v117, 13, v117
    v_bitop3_b32 v119, v118, v119, v124 bitop3:0x1b
    v_bitop3_b32 v81, v117, v125, v81 bitop3:0xae
    v_lshl_or_b32 v106, v119, 16, v106
    v_bitop3_b32 v82, v118, v125, v82 bitop3:0xae
    v_bitop3_b32 v107, v119, v126, v107 bitop3:0xea
    s_waitcnt lgkmcnt(4)
    s_cmp_ge_u32 s68, 2048
    s_cbranch_scc1 p1_nl1
    s_add_u32 s32, s30, 16384
    buffer_load_dwordx4 v[8:11], v1, s[4:7], s32 offen nt
    buffer_load_dwordx4 v[32:35], v1, s[8:11], s32 offen nt
    s_add_u32 s32, s31, 8192
    buffer_load_dwordx2 v[54:55], v2, s[12:15], s32 offen nt
p1_nl1:
    v_lshlrev_b32 v117, 16, v60
    v_and_b32 v118, v126, v60
    v_mul_f32 v117, v123, v117
    v_mul_f32 v118, v123, v118
    v_cvt_pk_bf16_f32 v117, v117, v118
    v_and_b32 v118, v126, v117
    v_lshlrev_b32 v117, 16, v117
    v_mul_f32 v117, 0.15915494, v117
    v_mul_f32 v118, 0.15915494, v118
    v_fract_f32 v117, v117
    v_fract_f32 v118, v118
    v_cos_f32 v117, v117
    v_cos_f32 v118, v118
    v_mul_hi_u32_u24 v120, s36, v20
    v_mul_hi_u32_u24 v121, s37, v20
    v_mul_hi_u32_u24 v122, s38, v44
    v_mad_i32_i24 v83, v120, s39, v20
    v_mad_u32_u24 v108, v122, 40, v121
    v_mad_i32_i24 v120, v121, -3, v120
    v_lshlrev_b16 v108, 2, v108
    v_mad_i32_i24 v122, v122, s40, v44
    ds_add_u32 v108, v3 offset:0
    v_lshl_or_b32 v83, v120, 30, v83
    v_lshl_or_b32 v83, v122, 16, v83
    v_mul_f32 v117, 0x03800000, v117
    v_mul_f32 v118, 0x03800000, v118
    v_cvt_pk_bf16_f32 v117, v117, v118
    v_mul_hi_u32_u24 v120, s36, v21
    v_mul_hi_u32_u24 v121, s37, v21
    v_mul_hi_u32_u24 v122, s38, v45
    v_mad_i32_i24 v84, v120, s39, v21
    v_mad_u32_u24 v109, v122, 40, v121
    v_mad_i32_i24 v120, v121, -3, v120
    v_lshlrev_b16 v109, 2, v109
    v_mad_i32_i24 v122, v122, s40, v45
    ds_add_u32 v109, v3 offset:0
    v_lshl_or_b32 v84, v120, 30, v84
    v_lshl_or_b32 v84, v122, 16, v84
    v_lshrrev_b32 v118, 3, v117
    v_lshrrev_b32 v119, 8, v117
    v_lshlrev_b16 v117, 13, v117
    v_bitop3_b32 v119, v118, v119, v124 bitop3:0x1b
    v_bitop3_b32 v83, v117, v125, v83 bitop3:0xae
    v_lshl_or_b32 v108, v119, 16, v108
    v_bitop3_b32 v84, v118, v125, v84 bitop3:0xae
    v_bitop3_b32 v109, v119, v126, v109 bitop3:0xea
    v_lshlrev_b32 v117, 16, v61
    v_and_b32 v118, v126, v61
    v_mul_f32 v117, v123, v117
    v_mul_f32 v118, v123, v118
    v_cvt_pk_bf16_f32 v117, v117, v118
    v_and_b32 v118, v126, v117
    v_lshlrev_b32 v117, 16, v117
    v_mul_f32 v117, 0.15915494, v117
    v_mul_f32 v118, 0.15915494, v118
    v_fract_f32 v117, v117
    v_fract_f32 v118, v118
    v_cos_f32 v117, v117
    v_cos_f32 v118, v118
    v_mul_hi_u32_u24 v120, s36, v22
    v_mul_hi_u32_u24 v121, s37, v22
    v_mul_hi_u32_u24 v122, s38, v46
    v_mad_i32_i24 v85, v120, s39, v22
    v_mad_u32_u24 v110, v122, 40, v121
    v_mad_i32_i24 v120, v121, -3, v120
    v_lshlrev_b16 v110, 2, v110
    v_mad_i32_i24 v122, v122, s40, v46
    ds_add_u32 v110, v3 offset:0
    v_lshl_or_b32 v85, v120, 30, v85
    v_lshl_or_b32 v85, v122, 16, v85
    v_mul_f32 v117, 0x03800000, v117
    v_mul_f32 v118, 0x03800000, v118
    v_cvt_pk_bf16_f32 v117, v117, v118
    v_mul_hi_u32_u24 v120, s36, v23
    v_mul_hi_u32_u24 v121, s37, v23
    v_mul_hi_u32_u24 v122, s38, v47
    v_mad_i32_i24 v86, v120, s39, v23
    v_mad_u32_u24 v111, v122, 40, v121
    v_mad_i32_i24 v120, v121, -3, v120
    v_lshlrev_b16 v111, 2, v111
    v_mad_i32_i24 v122, v122, s40, v47
    ds_add_u32 v111, v3 offset:0
    v_lshl_or_b32 v86, v120, 30, v86
    v_lshl_or_b32 v86, v122, 16, v86
    v_lshrrev_b32 v118, 3, v117
    v_lshrrev_b32 v119, 8, v117
    v_lshlrev_b16 v117, 13, v117
    v_bitop3_b32 v119, v118, v119, v124 bitop3:0x1b
    v_bitop3_b32 v85, v117, v125, v85 bitop3:0xae
    v_lshl_or_b32 v110, v119, 16, v110
    v_bitop3_b32 v86, v118, v125, v86 bitop3:0xae
    v_bitop3_b32 v111, v119, v126, v111 bitop3:0xea
    v_lshlrev_b32 v117, 16, v62
    v_and_b32 v118, v126, v62
    v_mul_f32 v117, v123, v117
    v_mul_f32 v118, v123, v118
    v_cvt_pk_bf16_f32 v117, v117, v118
    v_and_b32 v118, v126, v117
    v_lshlrev_b32 v117, 16, v117
    v_mul_f32 v117, 0.15915494, v117
    v_mul_f32 v118, 0.15915494, v118
    v_fract_f32 v117, v117
    v_fract_f32 v118, v118
    v_cos_f32 v117, v117
    v_cos_f32 v118, v118
    v_mul_hi_u32_u24 v120, s36, v24
    v_mul_hi_u32_u24 v121, s37, v24
    v_mul_hi_u32_u24 v122, s38, v48
    v_mad_i32_i24 v87, v120, s39, v24
    v_mad_u32_u24 v112, v122, 40, v121
    v_mad_i32_i24 v120, v121, -3, v120
    v_lshlrev_b16 v112, 2, v112
    v_mad_i32_i24 v122, v122, s40, v48
    ds_add_u32 v112, v3 offset:0
    v_lshl_or_b32 v87, v120, 30, v87
    v_lshl_or_b32 v87, v122, 16, v87
    v_mul_f32 v117, 0x03800000, v117
    v_mul_f32 v118, 0x03800000, v118
    v_cvt_pk_bf16_f32 v117, v117, v118
    v_mul_hi_u32_u24 v120, s36, v25
    v_mul_hi_u32_u24 v121, s37, v25
    v_mul_hi_u32_u24 v122, s38, v49
    v_mad_i32_i24 v88, v120, s39, v25
    v_mad_u32_u24 v113, v122, 40, v121
    v_mad_i32_i24 v120, v121, -3, v120
    v_lshlrev_b16 v113, 2, v113
    v_mad_i32_i24 v122, v122, s40, v49
    ds_add_u32 v113, v3 offset:0
    v_lshl_or_b32 v88, v120, 30, v88
    v_lshl_or_b32 v88, v122, 16, v88
    v_lshrrev_b32 v118, 3, v117
    v_lshrrev_b32 v119, 8, v117
    v_lshlrev_b16 v117, 13, v117
    v_bitop3_b32 v119, v118, v119, v124 bitop3:0x1b
    v_bitop3_b32 v87, v117, v125, v87 bitop3:0xae
    v_lshl_or_b32 v112, v119, 16, v112
    v_bitop3_b32 v88, v118, v125, v88 bitop3:0xae
    v_bitop3_b32 v113, v119, v126, v113 bitop3:0xea
    v_lshlrev_b32 v117, 16, v63
    v_and_b32 v118, v126, v63
    v_mul_f32 v117, v123, v117
    v_mul_f32 v118, v123, v118
    v_cvt_pk_bf16_f32 v117, v117, v118
    v_and_b32 v118, v126, v117
    v_lshlrev_b32 v117, 16, v117
    v_mul_f32 v117, 0.15915494, v117
    v_mul_f32 v118, 0.15915494, v118
    v_fract_f32 v117, v117
    v_fract_f32 v118, v118
    v_cos_f32 v117, v117
    v_cos_f32 v118, v118
    v_mul_hi_u32_u24 v120, s36, v26
    v_mul_hi_u32_u24 v121, s37, v26
    v_mul_hi_u32_u24 v122, s38, v50
    v_mad_i32_i24 v89, v120, s39, v26
    v_mad_u32_u24 v114, v122, 40, v121
    v_mad_i32_i24 v120, v121, -3, v120
    v_lshlrev_b16 v114, 2, v114
    v_mad_i32_i24 v122, v122, s40, v50
    ds_add_u32 v114, v3 offset:0
    v_lshl_or_b32 v89, v120, 30, v89
    v_lshl_or_b32 v89, v122, 16, v89
    v_mul_f32 v117, 0x03800000, v117
    v_mul_f32 v118, 0x03800000, v118
    v_cvt_pk_bf16_f32 v117, v117, v118
    v_mul_hi_u32_u24 v120, s36, v27
    v_mul_hi_u32_u24 v121, s37, v27
    v_mul_hi_u32_u24 v122, s38, v51
    v_mad_i32_i24 v90, v120, s39, v27
    v_mad_u32_u24 v115, v122, 40, v121
    v_mad_i32_i24 v120, v121, -3, v120
    v_lshlrev_b16 v115, 2, v115
    v_mad_i32_i24 v122, v122, s40, v51
    ds_add_u32 v115, v3 offset:0
    v_lshl_or_b32 v90, v120, 30, v90
    v_lshl_or_b32 v90, v122, 16, v90
    v_lshrrev_b32 v118, 3, v117
    v_lshrrev_b32 v119, 8, v117
    v_lshlrev_b16 v117, 13, v117
    v_bitop3_b32 v119, v118, v119, v124 bitop3:0x1b
    v_bitop3_b32 v89, v117, v125, v89 bitop3:0xae
    v_lshl_or_b32 v114, v119, 16, v114
    v_bitop3_b32 v90, v118, v125, v90 bitop3:0xae
    v_bitop3_b32 v115, v119, v126, v115 bitop3:0xea
    s_waitcnt lgkmcnt(4)
    s_cmp_ge_u32 s68, 2048
    s_cbranch_scc1 p1_nl2
    s_add_u32 s32, s30, 32768
    buffer_load_dwordx4 v[12:15], v1, s[4:7], s32 offen nt
    buffer_load_dwordx4 v[36:39], v1, s[8:11], s32 offen nt
    s_add_u32 s32, s31, 16384
    buffer_load_dwordx2 v[56:57], v2, s[12:15], s32 offen nt
p1_nl2:
    s_cmp_ge_u32 s28, s33
    s_cbranch_scc1 p1_r_done
    v_lshlrev_b32 v117, 16, v66
    v_and_b32 v118, v126, v66
    v_mul_f32 v117, v123, v117
    v_mul_f32 v118, v123, v118
    v_cvt_pk_bf16_f32 v117, v117, v118
    v_and_b32 v118, v126, v117
    v_lshlrev_b32 v117, 16, v117
    v_mul_f32 v117, 0.15915494, v117
    v_mul_f32 v118, 0.15915494, v118
    v_fract_f32 v117, v117
    v_fract_f32 v118, v118
    v_cos_f32 v117, v117
    v_cos_f32 v118, v118
    v_mul_hi_u32_u24 v120, s36, v64
    v_mul_hi_u32_u24 v121, s37, v64
    v_mul_hi_u32_u24 v122, s38, v65
    v_mad_i32_i24 v91, v120, s39, v64
    v_mad_u32_u24 v116, v122, 40, v121
    v_mad_i32_i24 v120, v121, -3, v120
    v_lshlrev_b16 v116, 2, v116
    v_mad_i32_i24 v122, v122, s40, v65
    ds_add_u32 v116, v3 offset:0
    v_lshl_or_b32 v91, v120, 30, v91
    v_lshl_or_b32 v91, v122, 16, v91
    v_mul_f32 v117, 0x03800000, v117
    v_mul_f32 v118, 0x03800000, v118
    v_cvt_pk_bf16_f32 v117, v117, v118
    v_lshrrev_b32 v118, 3, v117
    v_lshrrev_b32 v119, 8, v117
    v_lshlrev_b16 v117, 13, v117
    v_bitop3_b32 v119, v118, v119, v124 bitop3:0x1b
    v_bitop3_b32 v91, v117, v125, v91 bitop3:0xae
    v_lshl_or_b32 v116, v119, 16, v116
p1_r_done:
    s_waitcnt lgkmcnt(0)
    s_barrier
    s_cmp_ge_u32 s28, 10
    s_cbranch_scc1 p1_s1_skip
    v_and_b32 v126, 63, v0
    s_lshl_b32 s54, s28, 4
    v_mul_u32_u24 v117, 160, v126
    v_add_u32 v117, s54, v117
    ds_read_b128 v[118:121], v117 offset:0
    s_mov_b32 s55, 43691
    s_waitcnt lgkmcnt(0)
    v_add_u32 v118, 2, v118
    v_add_u32 v119, 2, v119
    v_add_u32 v120, 2, v120
    v_add_u32 v121, 2, v121
    v_mul_u32_u24 v118, s55, v118
    v_mul_u32_u24 v119, s55, v119
    v_mul_u32_u24 v120, s55, v120
    v_mul_u32_u24 v121, s55, v121
    v_lshrrev_b32 v118, 17, v118
    v_lshrrev_b32 v119, 17, v119
    v_lshrrev_b32 v120, 17, v120
    v_lshrrev_b32 v121, 17, v121
    v_lshl_or_b32 v122, v119, 16, v118
    v_lshl_or_b32 v123, v121, 16, v120
    v_mov_b32 v124, v122
    v_mov_b32 v125, v123
    s_nop 1
    v_add_u32_dpp v124, v124, v124 row_shr:1 row_mask:0xf bank_mask:0xf bound_ctrl:0
    v_add_u32_dpp v125, v125, v125 row_shr:1 row_mask:0xf bank_mask:0xf bound_ctrl:0
    s_nop 0
    v_add_u32_dpp v124, v124, v124 row_shr:2 row_mask:0xf bank_mask:0xf bound_ctrl:0
    v_add_u32_dpp v125, v125, v125 row_shr:2 row_mask:0xf bank_mask:0xf bound_ctrl:0
    s_nop 0
    v_add_u32_dpp v124, v124, v124 row_shr:4 row_mask:0xf bank_mask:0xf bound_ctrl:0
    v_add_u32_dpp v125, v125, v125 row_shr:4 row_mask:0xf bank_mask:0xf bound_ctrl:0
    s_nop 0
    v_add_u32_dpp v124, v124, v124 row_shr:8 row_mask:0xf bank_mask:0xf bound_ctrl:0
    v_add_u32_dpp v125, v125, v125 row_shr:8 row_mask:0xf bank_mask:0xf bound_ctrl:0
    s_nop 0
    v_add_u32_dpp v124, v124, v124 row_bcast:15 row_mask:0xa bank_mask:0xf
    v_add_u32_dpp v125, v125, v125 row_bcast:15 row_mask:0xa bank_mask:0xf
    s_nop 0
    v_add_u32_dpp v124, v124, v124 row_bcast:31 row_mask:0xc bank_mask:0xf
    v_add_u32_dpp v125, v125, v125 row_bcast:31 row_mask:0xc bank_mask:0xf
    s_nop 0
    s_nop 0
    v_mov_b32 v127, s54
    v_and_b32 v118, 0xffff, v124
    v_lshrrev_b32 v119, 16, v124
    v_and_b32 v120, 0xffff, v125
    v_lshrrev_b32 v121, 16, v125
    s_mov_b64 exec, 1
    s_lshl_b64 exec, exec, 63
    ds_write_b128 v127, v[118:121] offset:10240
    s_mov_b64 exec, -1
p1_s1_skip:
    s_waitcnt lgkmcnt(0)
    s_barrier
    v_and_b32 v127, 63, v0
    v_lshlrev_b32 v118, 2, v127
    v_cmp_gt_u32 vcc, 40, v127
    ds_read_b32 v119, v118 offset:10240
    s_waitcnt lgkmcnt(0)
    v_cndmask_b32 v119, 0, v119, vcc
    v_mov_b32 v120, v119
    s_nop 1
    v_add_u32_dpp v120, v120, v120 row_shr:1 row_mask:0xf bank_mask:0xf bound_ctrl:0
    s_nop 1
    v_add_u32_dpp v120, v120, v120 row_shr:2 row_mask:0xf bank_mask:0xf bound_ctrl:0
    s_nop 1
    v_add_u32_dpp v120, v120, v120 row_shr:4 row_mask:0xf bank_mask:0xf bound_ctrl:0
    s_nop 1
    v_add_u32_dpp v120, v120, v120 row_shr:8 row_mask:0xf bank_mask:0xf bound_ctrl:0
    s_nop 1
    v_add_u32_dpp v120, v120, v120 row_bcast:15 row_mask:0xa bank_mask:0xf
    s_nop 1
    v_add_u32_dpp v120, v120, v120 row_bcast:31 row_mask:0xc bank_mask:0xf
    s_nop 1
    s_nop 0
    v_sub_u32 v119, v120, v119
    v_readlane_b32 s35, v120, 63
    s_cmp_ge_u32 s28, 10
    s_cbranch_scc1 p1_s2_skip
    s_lshl_b32 s54, s28, 2
    s_add_u32 s55, s54, 0
    v_readlane_b32 s56, v119, s55
    s_add_u32 s55, s54, 1
    v_readlane_b32 s57, v119, s55
    s_add_u32 s55, s54, 2
    v_readlane_b32 s58, v119, s55
    s_add_u32 s55, s54, 3
    v_readlane_b32 s59, v119, s55
    s_nop 0
    s_lshl_b32 s57, s57, 16
    s_or_b32 s56, s56, s57
    s_lshl_b32 s59, s59, 16
    s_or_b32 s58, s58, s59
    v_add_u32 v124, s56, v124
    v_add_u32 v125, s58, v125
    v_sub_u32 v122, v124, v122
    v_sub_u32 v123, v125, v123
    v_and_b32 v118, 0xffff, v122
    v_lshrrev_b32 v119, 16, v122
    v_and_b32 v120, 0xffff, v123
    v_lshrrev_b32 v121, 16, v123
    v_mul_u32_u24 v118, 3, v118
    v_mul_u32_u24 v119, 3, v119
    v_mul_u32_u24 v120, 3, v120
    v_mul_u32_u24 v121, 3, v121
    ds_write_b128 v117, v[118:121] offset:0
    s_mul_i32 s55, s29, 5248
    s_mul_i32 s56, s28, 520
    s_add_u32 s55, s55, s56
    s_add_u32 s55, s55, 335544320
    v_lshlrev_b32 v127, 3, v126
    buffer_store_dwordx2 v[122:123], v127, s[16:19], s55 offen sc1
    s_mov_b64 exec, 1
    s_lshl_b64 exec, exec, 63
    buffer_store_dwordx2 v[124:125], v127, s[16:19], s55 offen offset:8 sc1
    s_mov_b64 exec, -1
p1_s2_skip:
    s_mul_i32 s51, s29, 16384
    s_lshr_b32 s52, s35, 10
    s_mul_i32 s52, s52, 33554432
    s_and_b32 s53, s35, 1023
    s_lshl_b32 s53, s53, 4
    s_add_u32 s52, s52, s53
    s_add_u32 s52, s52, s51
    s_min_u32 s22, s52, 335544320
    s_mov_b32 s70, 0
    s_waitcnt lgkmcnt(0)
    s_barrier
    s_cmp_ge_u32 s68, 2048
    s_cbranch_scc1 p1_prep0
    s_cmp_lg_u32 s28, 15
    s_cbranch_scc1 p1_tk0
    v_mov_b32 v127, 1
    s_mov_b64 exec, 1
    buffer_atomic_add v127, off, s[88:91], 0 offset:128 sc0 sc1
    s_mov_b64 exec, -1
    s_branch p1_tk0
p1_prep0:
    s_cmp_lg_u32 s28, 15
    s_cbranch_scc1 p1_hv0
    s_lshl_b32 s58, s68, 2
    s_and_b32 s58, s58, 28
    s_lshl_b32 s52, 1, s58
    v_mov_b32 v127, s52
    s_sub_u32 s52, s68, 2048
    s_lshr_b32 s52, s52, 3
    s_lshl_b32 s52, s52, 2
    s_mov_b64 exec, 1
    buffer_atomic_add v127, off, s[88:91], s52 sc0 sc1
    s_mov_b64 exec, -1
p1_hv0:
    s_cmp_ge_u32 s68, 2168
    s_cbranch_scc1 p1_tk0
    s_sub_u32 s52, s68, 2048
    s_mul_i32 s52, s52, 53368
    s_mul_i32 s53, s28, 3072
    s_add_u32 s53, s53, s52
    v_and_b32 v20, 63, v0
    v_lshl_add_u32 v21, v20, 2, s53
    s_lshl_b32 s53, s28, 9
    s_add_u32 s53, s53, s52
    s_add_u32 s53, s53, 49152
    s_cmp_lt_u32 s28, 9
    s_cselect_b32 s53, s53, 0x40000000
    v_lshl_add_u32 v22, v20, 2, s53
    buffer_load_dword v4, v21, s[24:27], 0 offen offset:0
    buffer_load_dword v5, v21, s[24:27], 0 offen offset:256
    buffer_load_dword v6, v21, s[24:27], 0 offen offset:512
    buffer_load_dword v7, v21, s[24:27], 0 offen offset:768
    buffer_load_dword v8, v21, s[24:27], 0 offen offset:1024
    buffer_load_dword v9, v21, s[24:27], 0 offen offset:1280
    buffer_load_dword v10, v21, s[24:27], 0 offen offset:1536
    buffer_load_dword v11, v21, s[24:27], 0 offen offset:1792
    buffer_load_dword v12, v21, s[24:27], 0 offen offset:2048
    buffer_load_dword v13, v21, s[24:27], 0 offen offset:2304
    buffer_load_dword v14, v21, s[24:27], 0 offen offset:2560
    buffer_load_dword v15, v21, s[24:27], 0 offen offset:2816
    buffer_load_dword v16, v22, s[24:27], 0 offen offset:0
    buffer_load_dword v17, v22, s[24:27], 0 offen offset:256
p1_tk0:
    v_and_b32 v117, 0xffff, v92
    ds_add_rtn_u32 v117, v117, v3 offset:0
    v_and_b32 v118, 0xffff, v93
    ds_add_rtn_u32 v118, v118, v3 offset:0
    v_and_b32 v119, 0xffff, v94
    ds_add_rtn_u32 v119, v119, v3 offset:0
    v_and_b32 v120, 0xffff, v95
    ds_add_rtn_u32 v120, v120, v3 offset:0
    s_cmp_ge_u32 s68, 2048
    s_cbranch_scc1 p1_nl3
    s_add_u32 s32, s30, 49152
    buffer_load_dwordx4 v[16:19], v1, s[4:7], s32 offen nt
    buffer_load_dwordx4 v[40:43], v1, s[8:11], s32 offen nt
    s_add_u32 s32, s31, 24576
    buffer_load_dwordx2 v[58:59], v2, s[12:15], s32 offen nt
p1_nl3:
    v_and_b32 v121, 0xffff, v96
    ds_add_rtn_u32 v121, v121, v3 offset:0
    v_and_b32 v122, 0xffff, v97
    ds_add_rtn_u32 v122, v122, v3 offset:0
    v_and_b32 v123, 0xffff, v98
    ds_add_rtn_u32 v123, v123, v3 offset:0
    v_and_b32 v124, 0xffff, v99
    ds_add_rtn_u32 v124, v124, v3 offset:0
    s_waitcnt lgkmcnt(4)
    ds_write_b8_d16_hi v117, v92 offset:10496
    v_lshlrev_b32 v117, 2, v117
    ds_write_b32 v117, v67 offset:40736
    ds_write_b8_d16_hi v118, v93 offset:10496
    v_lshlrev_b32 v118, 2, v118
    ds_write_b32 v118, v68 offset:40736
    ds_write_b8_d16_hi v119, v94 offset:10496
    v_lshlrev_b32 v119, 2, v119
    ds_write_b32 v119, v69 offset:40736
    ds_write_b8_d16_hi v120, v95 offset:10496
    v_lshlrev_b32 v120, 2, v120
    ds_write_b32 v120, v70 offset:40736
    s_cmp_ge_u32 s68, 2048
    s_cbranch_scc1 p1_nl4
    s_add_u32 s32, s30, 65536
    buffer_load_dwordx4 v[20:23], v1, s[4:7], s32 offen nt
    buffer_load_dwordx4 v[44:47], v1, s[8:11], s32 offen nt
    s_add_u32 s32, s31, 32768
    buffer_load_dwordx2 v[60:61], v2, s[12:15], s32 offen nt
p1_nl4:
    v_and_b32 v117, 0xffff, v100
    ds_add_rtn_u32 v117, v117, v3 offset:0
    v_and_b32 v118, 0xffff, v101
    ds_add_rtn_u32 v118, v118, v3 offset:0
    v_and_b32 v119, 0xffff, v102
    ds_add_rtn_u32 v119, v119, v3 offset:0
    v_and_b32 v120, 0xffff, v103
    ds_add_rtn_u32 v120, v120, v3 offset:0
    s_waitcnt lgkmcnt(4)
    ds_write_b8_d16_hi v121, v96 offset:10496
    v_lshlrev_b32 v121, 2, v121
    ds_write_b32 v121, v71 offset:40736
    ds_write_b8_d16_hi v122, v97 offset:10496
    v_lshlrev_b32 v122, 2, v122
    ds_write_b32 v122, v72 offset:40736
    ds_write_b8_d16_hi v123, v98 offset:10496
    v_lshlrev_b32 v123, 2, v123
    ds_write_b32 v123, v73 offset:40736
    ds_write_b8_d16_hi v124, v99 offset:10496
    v_lshlrev_b32 v124, 2, v124
    ds_write_b32 v124, v74 offset:40736
    v_and_b32 v121, 0xffff, v104
    ds_add_rtn_u32 v121, v121, v3 offset:0
    v_and_b32 v122, 0xffff, v105
    ds_add_rtn_u32 v122, v122, v3 offset:0
    v_and_b32 v123, 0xffff, v106
    ds_add_rtn_u32 v123, v123, v3 offset:0
    v_and_b32 v124, 0xffff, v107
    ds_add_rtn_u32 v124, v124, v3 offset:0
    s_waitcnt lgkmcnt(4)
    ds_write_b8_d16_hi v117, v100 offset:10496
    v_lshlrev_b32 v117, 2, v117
    ds_write_b32 v117, v75 offset:40736
    ds_write_b8_d16_hi v118, v101 offset:10496
    v_lshlrev_b32 v118, 2, v118
    ds_write_b32 v118, v76 offset:40736
    ds_write_b8_d16_hi v119, v102 offset:10496
    v_lshlrev_b32 v119, 2, v119
    ds_write_b32 v119, v77 offset:40736
    ds_write_b8_d16_hi v120, v103 offset:10496
    v_lshlrev_b32 v120, 2, v120
    ds_write_b32 v120, v78 offset:40736
    s_cmp_ge_u32 s68, 2048
    s_cbranch_scc1 p1_nl5
    s_add_u32 s32, s30, 81920
    buffer_load_dwordx4 v[24:27], v1, s[4:7], s32 offen nt
    buffer_load_dwordx4 v[48:51], v1, s[8:11], s32 offen nt
    s_add_u32 s32, s31, 40960
    buffer_load_dwordx2 v[62:63], v2, s[12:15], s32 offen nt
p1_nl5:
    v_and_b32 v117, 0xffff, v108
    ds_add_rtn_u32 v117, v117, v3 offset:0
    v_and_b32 v118, 0xffff, v109
    ds_add_rtn_u32 v118, v118, v3 offset:0
    v_and_b32 v119, 0xffff, v110
    ds_add_rtn_u32 v119, v119, v3 offset:0
    v_and_b32 v120, 0xffff, v111
    ds_add_rtn_u32 v120, v120, v3 offset:0
    s_waitcnt lgkmcnt(4)
    ds_write_b8_d16_hi v121, v104 offset:10496
    v_lshlrev_b32 v121, 2, v121
    ds_write_b32 v121, v79 offset:40736
    ds_write_b8_d16_hi v122, v105 offset:10496
    v_lshlrev_b32 v122, 2, v122
    ds_write_b32 v122, v80 offset:40736
    ds_write_b8_d16_hi v123, v106 offset:10496
    v_lshlrev_b32 v123, 2, v123
    ds_write_b32 v123, v81 offset:40736
    ds_write_b8_d16_hi v124, v107 offset:10496
    v_lshlrev_b32 v124, 2, v124
    ds_write_b32 v124, v82 offset:40736
    s_cmp_ge_u32 s28, 10
    s_cbranch_scc1 p1_jn
    s_cmp_lt_u32 s68, 2048
    s_cbranch_scc1 p1_vwj
    s_waitcnt vmcnt(0)
p1_vwj:
    s_waitcnt vmcnt(9)
    v_mov_b32 v125, 0
    s_mov_b64 exec, 1
    ds_add_rtn_u32 v125, v125, v3 offset:10432
    s_waitcnt lgkmcnt(0)
    v_readfirstlane_b32 s52, v125
    s_lshr_b32 s53, s29, 1
    s_and_b32 s53, s53, 28
    s_cmp_lg_u32 s52, 9
    s_cbranch_scc1 p1_jn1
    s_lshl_b32 s54, 1, s53
    v_mov_b32 v127, s54
    s_lshr_b32 s54, s29, 6
    s_lshl_b32 s54, s54, 2
    s_mov_b32 s70, 1
    buffer_atomic_add v127, off, s[88:91], s54 sc0 sc1
p1_jn1:
    s_mov_b64 exec, -1
p1_jn:
    s_cmp_ge_u32 s68, 2048
    s_cbranch_scc1 p1_nl6
    s_cmp_lt_u32 s28, s34
    s_cselect_b32 s46, 0, 0x40000000
    v_lshl_add_u32 v126, v0, 2, s46
    s_add_u32 s32, s30, 98304
    buffer_load_dword v64, v126, s[4:7], s32 offen nt
    buffer_load_dword v65, v126, s[8:11], s32 offen nt
    v_lshrrev_b32 v126, 1, v126
    s_add_u32 s32, s31, 49152
    buffer_load_ushort v66, v126, s[12:15], s32 offen nt
p1_nl6:
    v_and_b32 v121, 0xffff, v112
    ds_add_rtn_u32 v121, v121, v3 offset:0
    v_and_b32 v122, 0xffff, v113
    ds_add_rtn_u32 v122, v122, v3 offset:0
    v_and_b32 v123, 0xffff, v114
    ds_add_rtn_u32 v123, v123, v3 offset:0
    v_and_b32 v124, 0xffff, v115
    ds_add_rtn_u32 v124, v124, v3 offset:0
    s_waitcnt lgkmcnt(4)
    ds_write_b8_d16_hi v117, v108 offset:10496
    v_lshlrev_b32 v117, 2, v117
    ds_write_b32 v117, v83 offset:40736
    ds_write_b8_d16_hi v118, v109 offset:10496
    v_lshlrev_b32 v118, 2, v118
    ds_write_b32 v118, v84 offset:40736
    ds_write_b8_d16_hi v119, v110 offset:10496
    v_lshlrev_b32 v119, 2, v119
    ds_write_b32 v119, v85 offset:40736
    ds_write_b8_d16_hi v120, v111 offset:10496
    v_lshlrev_b32 v120, 2, v120
    ds_write_b32 v120, v86 offset:40736
    s_waitcnt lgkmcnt(0)
    ds_write_b8_d16_hi v121, v112 offset:10496
    v_lshlrev_b32 v121, 2, v121
    ds_write_b32 v121, v87 offset:40736
    ds_write_b8_d16_hi v122, v113 offset:10496
    v_lshlrev_b32 v122, 2, v122
    ds_write_b32 v122, v88 offset:40736
    ds_write_b8_d16_hi v123, v114 offset:10496
    v_lshlrev_b32 v123, 2, v123
    ds_write_b32 v123, v89 offset:40736
    ds_write_b8_d16_hi v124, v115 offset:10496
    v_lshlrev_b32 v124, 2, v124
    ds_write_b32 v124, v90 offset:40736
    s_cmp_ge_u32 s28, s33
    s_cbranch_scc1 p1_p_done
    v_and_b32 v125, 0xffff, v116
    ds_add_rtn_u32 v125, v125, v3 offset:0
    s_waitcnt lgkmcnt(0)
    ds_write_b8_d16_hi v125, v116 offset:10496
    v_lshlrev_b32 v125, 2, v125
    ds_write_b32 v125, v91 offset:40736
p1_p_done:
    s_cmp_eq_u32 s70, 0
    s_cbranch_scc1 p1_sg
    s_cmp_lt_u32 s68, 2048
    s_cbranch_scc1 p1_vws
    s_waitcnt vmcnt(0)
p1_vws:
    s_waitcnt vmcnt(3)
    v_bfe_u32 v127, v127, s53, 4
    v_mov_b32 v125, 0
    s_mov_b64 exec, 1
    ds_write_b32 v125, v127 offset:10452
    s_mov_b64 exec, -1
p1_sg:
    s_cmp_ge_u32 s68, 2048
    s_cbranch_scc1 p1_prep1
    s_cmp_lg_u32 s28, 15
    s_cbranch_scc1 p1_tk1
    s_waitcnt vmcnt(12)
    v_mov_b32 v125, 0
    s_mov_b64 exec, 1
    ds_write_b32 v125, v127 offset:10448
    s_mov_b64 exec, -1
    s_branch p1_tk1
p1_prep1:
    s_cmp_lg_u32 s28, 15
    s_cbranch_scc1 p1_hv1
    s_waitcnt vmcnt(0)
    v_bfe_u32 v127, v127, s58, 4
    v_mov_b32 v125, 0
    s_mov_b64 exec, 1
    ds_write_b32 v125, v127 offset:10448
    s_mov_b64 exec, -1
p1_hv1:
    s_cmp_ge_u32 s68, 2168
    s_cbranch_scc1 p1_tk1
    s_sub_u32 s52, s68, 2048
    s_mul_i32 s53, s52, 53760
    s_add_u32 s53, s53, 356941824
    s_mul_i32 s54, s28, 3072
    v_lshl_add_u32 v21, v20, 4, s54
    s_lshl_b32 s54, s28, 9
    s_add_u32 s54, s54, 49152
    s_cmp_lt_u32 s28, 9
    s_cselect_b32 s54, s54, 0x40000000
    v_lshl_add_u32 v22, v20, 3, s54
    v_mov_b32 v24, 0
    v_mov_b32 v25, 0
    s_waitcnt vmcnt(0)
    buffer_store_dwordx4 v[4:7], v21, s[16:19], s53 offen offset:0
    buffer_store_dwordx4 v[8:11], v21, s[16:19], s53 offen offset:1024
    buffer_store_dwordx4 v[12:15], v21, s[16:19], s53 offen offset:2048
    buffer_store_dwordx2 v[16:17], v22, s[16:19], s53 offen
    v_and_b32 v26, 0x7fff7fff, v4
    v_pk_max_u16 v24, v24, v26
    v_lshlrev_b32 v27, 16, v26
    v_and_b32 v26, 0xffff0000, v26
    v_fmac_f32 v25, v27, v27
    v_fmac_f32 v25, v26, v26
    v_and_b32 v26, 0x7fff7fff, v5
    v_pk_max_u16 v24, v24, v26
    v_lshlrev_b32 v27, 16, v26
    v_and_b32 v26, 0xffff0000, v26
    v_fmac_f32 v25, v27, v27
    v_fmac_f32 v25, v26, v26
    v_and_b32 v26, 0x7fff7fff, v6
    v_pk_max_u16 v24, v24, v26
    v_lshlrev_b32 v27, 16, v26
    v_and_b32 v26, 0xffff0000, v26
    v_fmac_f32 v25, v27, v27
    v_fmac_f32 v25, v26, v26
    v_and_b32 v26, 0x7fff7fff, v7
    v_pk_max_u16 v24, v24, v26
    v_lshlrev_b32 v27, 16, v26
    v_and_b32 v26, 0xffff0000, v26
    v_fmac_f32 v25, v27, v27
    v_fmac_f32 v25, v26, v26
    v_and_b32 v26, 0x7fff7fff, v8
    v_pk_max_u16 v24, v24, v26
    v_lshlrev_b32 v27, 16, v26
    v_and_b32 v26, 0xffff0000, v26
    v_fmac_f32 v25, v27, v27
    v_fmac_f32 v25, v26, v26
    v_and_b32 v26, 0x7fff7fff, v9
    v_pk_max_u16 v24, v24, v26
    v_lshlrev_b32 v27, 16, v26
    v_and_b32 v26, 0xffff0000, v26
    v_fmac_f32 v25, v27, v27
    v_fmac_f32 v25, v26, v26
    v_and_b32 v26, 0x7fff7fff, v10
    v_pk_max_u16 v24, v24, v26
    v_lshlrev_b32 v27, 16, v26
    v_and_b32 v26, 0xffff0000, v26
    v_fmac_f32 v25, v27, v27
    v_fmac_f32 v25, v26, v26
    v_and_b32 v26, 0x7fff7fff, v11
    v_pk_max_u16 v24, v24, v26
    v_lshlrev_b32 v27, 16, v26
    v_and_b32 v26, 0xffff0000, v26
    v_fmac_f32 v25, v27, v27
    v_fmac_f32 v25, v26, v26
    v_and_b32 v26, 0x7fff7fff, v12
    v_pk_max_u16 v24, v24, v26
    v_lshlrev_b32 v27, 16, v26
    v_and_b32 v26, 0xffff0000, v26
    v_fmac_f32 v25, v27, v27
    v_fmac_f32 v25, v26, v26
    v_and_b32 v26, 0x7fff7fff, v13
    v_pk_max_u16 v24, v24, v26
    v_lshlrev_b32 v27, 16, v26
    v_and_b32 v26, 0xffff0000, v26
    v_fmac_f32 v25, v27, v27
    v_fmac_f32 v25, v26, v26
    v_and_b32 v26, 0x7fff7fff, v14
    v_pk_max_u16 v24, v24, v26
    v_lshlrev_b32 v27, 16, v26
    v_and_b32 v26, 0xffff0000, v26
    v_fmac_f32 v25, v27, v27
    v_fmac_f32 v25, v26, v26
    v_and_b32 v26, 0x7fff7fff, v15
    v_pk_max_u16 v24, v24, v26
    v_lshlrev_b32 v27, 16, v26
    v_and_b32 v26, 0xffff0000, v26
    v_fmac_f32 v25, v27, v27
    v_fmac_f32 v25, v26, v26
    v_and_b32 v26, 0x7fff7fff, v16
    v_pk_max_u16 v24, v24, v26
    v_lshlrev_b32 v27, 16, v26
    v_and_b32 v26, 0xffff0000, v26
    v_fmac_f32 v25, v27, v27
    v_fmac_f32 v25, v26, v26
    v_and_b32 v26, 0x7fff7fff, v17
    v_pk_max_u16 v24, v24, v26
    v_lshlrev_b32 v27, 16, v26
    v_and_b32 v26, 0xffff0000, v26
    v_fmac_f32 v25, v27, v27
    v_fmac_f32 v25, v26, v26
    v_lshrrev_b32 v26, 16, v24
    v_and_b32 v24, 0xffff, v24
    v_max_u32 v24, v24, v26
    s_nop 1
    v_max_u32_dpp v24, v24, v24 row_shr:1 row_mask:0xf bank_mask:0xf bound_ctrl:0
    v_add_f32_dpp v25, v25, v25 row_shr:1 row_mask:0xf bank_mask:0xf bound_ctrl:0
    s_nop 0
    v_max_u32_dpp v24, v24, v24 row_shr:2 row_mask:0xf bank_mask:0xf bound_ctrl:0
    v_add_f32_dpp v25, v25, v25 row_shr:2 row_mask:0xf bank_mask:0xf bound_ctrl:0
    s_nop 0
    v_max_u32_dpp v24, v24, v24 row_shr:4 row_mask:0xf bank_mask:0xf bound_ctrl:0
    v_add_f32_dpp v25, v25, v25 row_shr:4 row_mask:0xf bank_mask:0xf bound_ctrl:0
    s_nop 0
    v_max_u32_dpp v24, v24, v24 row_shr:8 row_mask:0xf bank_mask:0xf bound_ctrl:0
    v_add_f32_dpp v25, v25, v25 row_shr:8 row_mask:0xf bank_mask:0xf bound_ctrl:0
    s_nop 0
    v_max_u32_dpp v24, v24, v24 row_bcast:15 row_mask:0xa bank_mask:0xf
    v_add_f32_dpp v25, v25, v25 row_bcast:15 row_mask:0xa bank_mask:0xf
    s_nop 0
    v_max_u32_dpp v24, v24, v24 row_bcast:31 row_mask:0xc bank_mask:0xf
    v_add_f32_dpp v25, v25, v25 row_bcast:31 row_mask:0xc bank_mask:0xf
    s_nop 0
    s_nop 0
    s_lshl_b32 s52, s52, 4
    s_add_u32 s52, s52, s28
    s_lshl_b32 s52, s52, 3
    s_add_u32 s52, s52, 363393024
    s_mov_b64 exec, 1
    s_lshl_b64 exec, exec, 63
    buffer_store_dwordx2 v[24:25], off, s[16:19], s52
    s_mov_b64 exec, -1
p1_tk1:
    s_waitcnt lgkmcnt(0)
    s_barrier
    v_mul_u32_u24 v119, 3, v0
    v_lshlrev_b32 v117, 2, v119
    v_add_u32 v117, 40736, v117
    v_and_b32 v118, -4, v119
    v_add_u32 v120, s51, v1
    v_mov_b32 v122, 0
    v_mov_b32 v123, 0
    v_mov_b32 v124, 0
    v_mov_b32 v125, 0
    ds_read_b64 v[126:127], v122 offset:10448
    ds_write_b32 v122, v122 offset:10432
    v_cmp_gt_u32 vcc, 640, v0
    s_and_saveexec_b64 s[52:53], vcc
    ds_write_b128 v1, v[122:125] offset:0
    s_mov_b64 exec, -1
    s_waitcnt lgkmcnt(2)
    v_readfirstlane_b32 s69, v126
    v_readfirstlane_b32 s71, v127
    s_cmp_ge_u32 s68, 2048
    s_cselect_b32 s3, s69, 0
    s_cmp_gt_u32 s28, 10
    s_cselect_b32 s71, 0, s71
    s_cselect_b32 s3, 0, s3
    s_add_u32 s69, s69, 512
    s_or_b32 s52, s71, s3
    s_bitcmp0_b32 s52, 3
    s_cbranch_scc1 p1_tr0
    v_and_b32 v116, 63, v0
    s_cmp_eq_u32 s28, 10
    s_cbranch_scc1 p1_tr1
    s_mul_i32 s52, s28, 520
    v_lshl_add_u32 v114, v116, 3, s52
    s_mul_i32 s52, s28, 4160
    v_lshl_add_u32 v115, v116, 4, s52
    s_branch p1_tr2
p1_tr1:
    v_mul_u32_u24 v114, 520, v116
    v_add_u32 v114, 512, v114
    v_mul_u32_u24 v115, 4160, v116
    v_add_u32 v115, 1024, v115
    v_cmp_gt_u32 vcc, 10, v116
    v_mov_b32 v116, 0x40000000
    s_nop 0
    v_cndmask_b32 v114, v116, v114, vcc
    v_cndmask_b32 v115, v116, v115, vcc
p1_tr2:
    s_cmp_lg_u32 s71, 8
    s_cbranch_scc1 p1_tl0
    s_lshr_b32 s52, s29, 3
    s_mul_i32 s52, s52, 41984
    s_add_u32 s52, s52, 335544320
    buffer_load_dwordx2 v[86:87], v114, s[16:19], s52 offen sc1
    s_add_u32 s52, s52, 5248
    buffer_load_dwordx2 v[88:89], v114, s[16:19], s52 offen sc1
    s_add_u32 s52, s52, 5248
    buffer_load_dwordx2 v[90:91], v114, s[16:19], s52 offen sc1
    s_add_u32 s52, s52, 5248
    buffer_load_dwordx2 v[92:93], v114, s[16:19], s52 offen sc1
    s_add_u32 s52, s52, 5248
    buffer_load_dwordx2 v[94:95], v114, s[16:19], s52 offen sc1
    s_add_u32 s52, s52, 5248
    buffer_load_dwordx2 v[96:97], v114, s[16:19], s52 offen sc1
    s_add_u32 s52, s52, 5248
    buffer_load_dwordx2 v[98:99], v114, s[16:19], s52 offen sc1
    s_add_u32 s52, s52, 5248
    buffer_load_dwordx2 v[100:101], v114, s[16:19], s52 offen sc1
    s_add_u32 s52, s52, 5248
p1_tl0:
    s_cmp_lg_u32 s3, 8
    s_cbranch_scc1 p1_tl1
    s_sub_u32 s52, s68, 2048
    s_mul_i32 s52, s52, 41984
    s_add_u32 s52, s52, 335544320
    buffer_load_dwordx2 v[28:29], v114, s[16:19], s52 offen sc1
    s_add_u32 s52, s52, 5248
    buffer_load_dwordx2 v[30:31], v114, s[16:19], s52 offen sc1
    s_add_u32 s52, s52, 5248
    buffer_load_dwordx2 v[32:33], v114, s[16:19], s52 offen sc1
    s_add_u32 s52, s52, 5248
    buffer_load_dwordx2 v[34:35], v114, s[16:19], s52 offen sc1
    s_add_u32 s52, s52, 5248
    buffer_load_dwordx2 v[36:37], v114, s[16:19], s52 offen sc1
    s_add_u32 s52, s52, 5248
    buffer_load_dwordx2 v[38:39], v114, s[16:19], s52 offen sc1
    s_add_u32 s52, s52, 5248
    buffer_load_dwordx2 v[40:41], v114, s[16:19], s52 offen sc1
    s_add_u32 s52, s52, 5248
    buffer_load_dwordx2 v[42:43], v114, s[16:19], s52 offen sc1
    s_add_u32 s52, s52, 5248
p1_tl1:
p1_tr0:
    ds_read_b32 v68, v117 offset:0
    ds_read_b32 v69, v117 offset:4
    ds_read_b32 v70, v117 offset:8
    ds_read_b32 v71, v118 offset:10496
    ds_read_b32 v72, v118 offset:10500
    ds_read_b32 v74, v117 offset:12288
    ds_read_b32 v75, v117 offset:12292
    ds_read_b32 v76, v117 offset:12296
    ds_read_b32 v77, v118 offset:13568
    ds_read_b32 v78, v118 offset:13572
    s_waitcnt lgkmcnt(5)
    ds_read_b32 v80, v117 offset:24576
    ds_read_b32 v81, v117 offset:24580
    ds_read_b32 v82, v117 offset:24584
    ds_read_b32 v83, v118 offset:16640
    ds_read_b32 v84, v118 offset:16644
    v_alignbyte_b32 v71, v72, v71, v119
    buffer_store_dwordx4 v[68:71], v120, s[20:23], 0 offen
    v_add_u32 v120, 33554432, v120
    s_waitcnt lgkmcnt(5)
    ds_read_b32 v68, v117 offset:36864
    ds_read_b32 v69, v117 offset:36868
    ds_read_b32 v70, v117 offset:36872
    ds_read_b32 v71, v118 offset:19712
    ds_read_b32 v72, v118 offset:19716
    v_alignbyte_b32 v77, v78, v77, v119
    buffer_store_dwordx4 v[74:77], v120, s[20:23], 0 offen
    v_add_u32 v120, 33554432, v120
    s_waitcnt lgkmcnt(5)
    ds_read_b32 v74, v117 offset:49152
    ds_read_b32 v75, v117 offset:49156
    ds_read_b32 v76, v117 offset:49160
    ds_read_b32 v77, v118 offset:22784
    ds_read_b32 v78, v118 offset:22788
    v_alignbyte_b32 v83, v84, v83, v119
    buffer_store_dwordx4 v[80:83], v120, s[20:23], 0 offen
    v_add_u32 v120, 33554432, v120
    s_waitcnt lgkmcnt(5)
    v_add_u32 v117, 61440, v117
    ds_read_b32 v80, v117 offset:0
    ds_read_b32 v81, v117 offset:4
    ds_read_b32 v82, v117 offset:8
    ds_read_b32 v83, v118 offset:25856
    ds_read_b32 v84, v118 offset:25860
    v_alignbyte_b32 v71, v72, v71, v119
    buffer_store_dwordx4 v[68:71], v120, s[20:23], 0 offen
    v_add_u32 v120, 33554432, v120
    s_waitcnt lgkmcnt(5)
    ds_read_b32 v68, v117 offset:12288
    ds_read_b32 v69, v117 offset:12292
    ds_read_b32 v70, v117 offset:12296
    ds_read_b32 v71, v118 offset:28928
    ds_read_b32 v72, v118 offset:28932
    v_alignbyte_b32 v77, v78, v77, v119
    buffer_store_dwordx4 v[74:77], v120, s[20:23], 0 offen
    v_add_u32 v120, 33554432, v120
    s_waitcnt lgkmcnt(5)
    ds_read_b32 v74, v117 offset:24576
    ds_read_b32 v75, v117 offset:24580
    ds_read_b32 v76, v117 offset:24584
    ds_read_b32 v77, v118 offset:32000
    ds_read_b32 v78, v118 offset:32004
    v_alignbyte_b32 v83, v84, v83, v119
    buffer_store_dwordx4 v[80:83], v120, s[20:23], 0 offen
    v_add_u32 v120, 33554432, v120
    s_waitcnt lgkmcnt(5)
    ds_read_b32 v80, v117 offset:36864
    ds_read_b32 v81, v117 offset:36868
    ds_read_b32 v82, v117 offset:36872
    ds_read_b32 v83, v118 offset:35072
    ds_read_b32 v84, v118 offset:35076
    v_alignbyte_b32 v71, v72, v71, v119
    buffer_store_dwordx4 v[68:71], v120, s[20:23], 0 offen nt
    v_add_u32 v120, 33554432, v120
    s_waitcnt lgkmcnt(5)
    ds_read_b32 v68, v117 offset:49152
    ds_read_b32 v69, v117 offset:49156
    ds_read_b32 v70, v117 offset:49160
    ds_read_b32 v71, v118 offset:38144
    ds_read_b32 v72, v118 offset:38148
    v_alignbyte_b32 v77, v78, v77, v119
    buffer_store_dwordx4 v[74:77], v120, s[20:23], 0 offen nt
    v_add_u32 v120, 33554432, v120
    s_waitcnt lgkmcnt(5)
    v_alignbyte_b32 v83, v84, v83, v119
    buffer_store_dwordx4 v[80:83], v120, s[20:23], 0 offen nt
    v_add_u32 v120, 33554432, v120
    s_waitcnt lgkmcnt(0)
    v_alignbyte_b32 v71, v72, v71, v119
    buffer_store_dwordx4 v[68:71], v120, s[20:23], 0 offen nt
    s_mov_b32 s54, 0x05040100
    s_mov_b32 s55, 0x07060302
    s_cmp_lg_u32 s71, 8
    s_cbranch_scc1 p1_ts0
    s_lshr_b32 s52, s29, 3
    s_mul_i32 s52, s52, 41600
    s_add_u32 s52, s52, 346292224
    s_waitcnt vmcnt(10)
    v_perm_b32 v102, v88, v86, s54
    v_perm_b32 v103, v92, v90, s54
    v_perm_b32 v104, v96, v94, s54
    v_perm_b32 v105, v100, v98, s54
    buffer_store_dwordx4 v[102:105], v115, s[16:19], s52 offen offset:0
    v_perm_b32 v106, v88, v86, s55
    v_perm_b32 v107, v92, v90, s55
    v_perm_b32 v108, v96, v94, s55
    v_perm_b32 v109, v100, v98, s55
    buffer_store_dwordx4 v[106:109], v115, s[16:19], s52 offen offset:1040
    v_perm_b32 v110, v89, v87, s54
    v_perm_b32 v111, v93, v91, s54
    v_perm_b32 v112, v97, v95, s54
    v_perm_b32 v113, v101, v99, s54
    buffer_store_dwordx4 v[110:113], v115, s[16:19], s52 offen offset:2080
    v_perm_b32 v102, v89, v87, s55
    v_perm_b32 v103, v93, v91, s55
    v_perm_b32 v104, v97, v95, s55
    v_perm_b32 v105, v101, v99, s55
    buffer_store_dwordx4 v[102:105], v115, s[16:19], s52 offen offset:3120
p1_ts0:
    s_cmp_lg_u32 s3, 8
    s_cbranch_scc1 p1_ts1
    s_sub_u32 s52, s68, 2048
    s_mul_i32 s52, s52, 41600
    s_add_u32 s52, s52, 346292224
    s_waitcnt vmcnt(10)
    v_perm_b32 v44, v30, v28, s54
    v_perm_b32 v45, v34, v32, s54
    v_perm_b32 v46, v38, v36, s54
    v_perm_b32 v47, v42, v40, s54
    buffer_store_dwordx4 v[44:47], v115, s[16:19], s52 offen offset:0
    v_perm_b32 v48, v30, v28, s55
    v_perm_b32 v49, v34, v32, s55
    v_perm_b32 v50, v38, v36, s55
    v_perm_b32 v51, v42, v40, s55
    buffer_store_dwordx4 v[48:51], v115, s[16:19], s52 offen offset:1040
    v_perm_b32 v52, v31, v29, s54
    v_perm_b32 v53, v35, v33, s54
    v_perm_b32 v54, v39, v37, s54
    v_perm_b32 v55, v43, v41, s54
    buffer_store_dwordx4 v[52:55], v115, s[16:19], s52 offen offset:2080
    v_perm_b32 v56, v31, v29, s55
    v_perm_b32 v57, v35, v33, s55
    v_perm_b32 v58, v39, v37, s55
    v_perm_b32 v59, v43, v41, s55
    buffer_store_dwordx4 v[56:59], v115, s[16:19], s52 offen offset:3120
p1_ts1:
    s_barrier
    s_mov_b32 s29, s68
    s_mov_b32 s68, s69
    s_cmp_lt_u32 s29, 2048
    s_cbranch_scc1 p1_tile
p1_end:
    s_endpgm
.globl p2_kernel
.p2align 8
.type p2_kernel,@function
p2_kernel:
    s_cmp_ge_u32 s2, 256
    s_cbranch_scc1 p2_end
    s_load_dwordx2 s[8:9], s[0:1], 104
    v_and_b32 v112, 63, v0
    v_lshrrev_b32 v122, 6, v0
    v_lshlrev_b32 v123, 4, v0
    v_lshlrev_b32 v112, 4, v112
    v_readfirstlane_b32 s10, v122
    v_mov_b32 v113, 0x83ff0000
    s_and_b32 s44, s2, 7
    s_lshr_b32 s11, s44, 1
    s_and_b32 s44, s44, 1
    s_lshl_b32 s12, s44, 5
    s_lshr_b32 s44, s2, 3
    s_add_u32 s12, s12, s44
    s_mov_b32 s25, 54272
    s_mov_b32 s31, 67175170
    s_mov_b32 s32, 83952386
    s_mov_b32 s33, 100729602
    s_mov_b32 s21, 0
    s_mul_i32 s23, s10, 3072
    s_lshl_b32 s24, s10, 9
    s_lshl_b32 s64, s10, 10
    s_sub_u32 s42, s24, s23
    s_add_u32 s42, s42, 49152
    s_lshl_b32 s41, s10, 25
    s_mov_b32 s63, 16384
    s_movk_i32 s65, 0x7800
    s_mul_i32 s62, s11, 161280
    s_add_u32 s62, s62, 356941824
    s_add_u32 s62, s62, s23
    s_mul_i32 s40, s10, 665600
    s_add_u32 s40, s40, 346292224
    s_mul_i32 s44, s11, 1040
    s_add_u32 s40, s40, s44
    s_lshl_b32 s44, s12, 4
    s_add_u32 s40, s40, s44
    s_waitcnt lgkmcnt(0)
    s_mov_b32 s4, s8
    s_and_b32 s5, s9, 0xffff
    s_mov_b32 s6, 819200000
    s_mov_b32 s7, 0x20000
    s_mov_b32 s68, s8
    s_and_b32 s69, s9, 0xffff
    s_mov_b32 s70, 335544320
    s_mov_b32 s71, 0x20000
    s_cmp_lt_u32 s10, 15
    s_cselect_b32 s44, 0, 0x40000000
    v_add_u32 v123, s44, v123
    s_mov_b32 s44, 363393024
    buffer_load_dwordx4 v[60:63], v123, s[4:7], s44 offen
p2_restart:
    s_mov_b32 s61, 0
    s_mul_i32 s44, s61, 4160
    s_add_u32 s44, s44, s40
    v_lshrrev_b32 v110, 6, v112
    v_bfe_u32 v111, v112, 2, 4
    v_mul_u32_u24 v110, 41600, v110
    v_add_u32 v111, v110, v111
    buffer_load_dword v110, v111, s[4:7], s44 offen
    buffer_load_dword v111, v111, s[4:7], s44 offen offset:16
    s_mov_b32 s61, 1
    s_mul_i32 s44, s61, 4160
    s_add_u32 s44, s44, s40
    v_lshrrev_b32 v68, 6, v112
    v_bfe_u32 v69, v112, 2, 4
    v_mul_u32_u24 v68, 41600, v68
    v_add_u32 v69, v68, v69
    buffer_load_dword v68, v69, s[4:7], s44 offen
    buffer_load_dword v69, v69, s[4:7], s44 offen offset:16
    s_mov_b32 s61, 0
    s_mul_i32 s20, s61, 645120
    s_add_u32 s20, s20, s62
    s_cmp_ge_u32 s10, 9
    s_cbranch_scc1 p2_nmp
    v_lshrrev_b32 v84, 1, v112
    s_add_u32 s44, s20, s42
    buffer_load_dwordx2 v[84:85], v84, s[4:7], s44 offen
p2_nmp:
    buffer_load_dwordx4 v[72:75], v112, s[4:7], s20 offen offset:0
    buffer_load_dwordx4 v[76:79], v112, s[4:7], s20 offen offset:1024
    buffer_load_dwordx4 v[80:83], v112, s[4:7], s20 offen offset:2048
    s_barrier
    v_mov_b32 v115, 0
    v_mov_b32 v116, 0
    v_mov_b32 v117, 0
    v_mov_b32 v118, 0
    v_mov_b32 v119, 0
    v_mov_b32 v120, 0
    v_mov_b32 v121, 0
    ds_write_b128 v115, v[116:119] offset:53760
    s_cmp_eq_u32 s21, 0
    s_cselect_b32 s44, 1073758208, 0
    v_mov_b32 v124, s44
    v_mov_b32 v125, s44
    v_mov_b32 v126, s44
    v_mov_b32 v127, s44
    v_add_u32 v123, s64, v112
    v_add_u32 v122, s25, v123
    ds_write_b128 v122, v[124:127] offset:0
    ds_write_b128 v122, v[124:127] offset:16384
    ds_write_b128 v122, v[124:127] offset:32768
    v_add_u32 v122, 49152, v122
    ds_write_b128 v122, v[124:127] offset:0
    ds_write_b128 v122, v[124:127] offset:16384
    ds_write_b128 v122, v[124:127] offset:32768
    v_cmpx_gt_u32 vcc, 1792, v123
    ds_write_b128 v122, v[124:127] offset:49152
    s_mov_b64 exec, -1
    s_mov_b32 s19, 0
    s_cmp_eq_u32 s21, 2
    s_cselect_b64 s[66:67], -1, 0
    s_waitcnt vmcnt(3) lgkmcnt(0)
    s_barrier
    s_mov_b32 m0, s23
    v_mov_b32 v53, 0x3c000
    s_movk_i32 s44, 512
    v_sub_u32_sdwa v4, v111, v110 dst_sel:DWORD dst_unused:UNUSED_PAD src0_sel:WORD_0 src1_sel:WORD_0
    v_sub_u32_sdwa v5, v111, v110 dst_sel:DWORD dst_unused:UNUSED_PAD src0_sel:WORD_1 src1_sel:WORD_1
    v_med3_i32 v4, v4, 0, s44
    v_med3_i32 v5, v5, 0, s44
    v_add_u32 v48, v4, v5
    ds_write_addtid_b32 v53 offset:0
    ds_write_addtid_b32 v53 offset:256
    ds_write_addtid_b32 v53 offset:512
    ds_write_addtid_b32 v53 offset:768
    ds_write_addtid_b32 v53 offset:1024
    ds_write_addtid_b32 v53 offset:1280
    ds_write_addtid_b32 v53 offset:1536
    ds_write_addtid_b32 v53 offset:1792
    v_lshl_add_u32 v53, v112, 15, s41
    s_nop 1
    v_add_u32_dpp v48, v48, v48 row_shr:1 row_mask:0xf bank_mask:0xf bound_ctrl:0
    s_nop 1
    v_add_u32_dpp v48, v48, v48 row_shr:2 row_mask:0xf bank_mask:0xf bound_ctrl:0
    s_nop 1
    v_add_u32_dpp v48, v48, v48 row_shr:4 row_mask:0xf bank_mask:0xf bound_ctrl:0
    s_nop 1
    v_add_u32_dpp v48, v48, v48 row_shr:8 row_mask:0xf bank_mask:0xf bound_ctrl:0
    s_nop 1
    v_add_u32_dpp v48, v48, v48 row_bcast:15 row_mask:0xa bank_mask:0xf
    s_nop 1
    v_add_u32_dpp v48, v48, v48 row_bcast:31 row_mask:0xc bank_mask:0xf
    s_nop 1
    s_nop 0
    v_readlane_b32 s38, v48, 63
    v_sub_u32 v50, v48, v5
    v_sub_u32 v49, v50, v4
    v_sub_u32 v10, 512, v49
    v_mad_u32_u16 v51, v110, 16, v53
    v_med3_i32 v10, v10, 0, v4
    v_lshl_add_u32 v49, v49, 2, s23
    v_sub_u32 v11, 512, v50
    v_mad_u32_u16 v52, v110, 16, v53 op_sel:[1,0,0,0]
    v_med3_i32 v11, v11, 0, v5
    v_lshl_add_u32 v50, v50, 2, s23
    v_lshl_add_u32 v48, v11, 16, v10
    v_add_u32 v52, 262144, v52
    v_add_u32 v110, v110, v48
    s_min_u32 s17, s38, 512
    s_add_u32 s17, s17, 63
    s_lshr_b32 s17, s17, 6
p2_xa_0:
    v_cmpx_lt_i32 vcc, 0, v10
    s_cbranch_execz p2_ya_0
    ds_write_b32 v49, v51 offset:0
    v_add_u32 v51, 16, v51
    v_cmpx_lt_i32 vcc, 1, v10
    s_cbranch_execz p2_ya_0
    ds_write_b32 v49, v51 offset:4
    v_add_u32 v51, 16, v51
    v_cmpx_lt_i32 vcc, 2, v10
    s_cbranch_execz p2_ya_0
    ds_write_b32 v49, v51 offset:8
    v_add_u32 v51, 16, v51
    v_cmpx_lt_i32 vcc, 3, v10
    s_cbranch_execz p2_ya_0
    ds_write_b32 v49, v51 offset:12
    v_add_u32 v51, 16, v51
    v_cmpx_lt_i32 vcc, 4, v10
    s_cbranch_execz p2_ya_0
    ds_write_b32 v49, v51 offset:16
    v_add_u32 v51, 16, v51
    v_cmpx_lt_i32 vcc, 5, v10
    s_cbranch_execz p2_ya_0
    ds_write_b32 v49, v51 offset:20
    v_add_u32 v51, 16, v51
    v_cmpx_lt_i32 vcc, 6, v10
    s_cbranch_execz p2_ya_0
    ds_write_b32 v49, v51 offset:24
    v_add_u32 v51, 16, v51
    v_cmpx_lt_i32 vcc, 7, v10
    s_cbranch_execz p2_ya_0
    ds_write_b32 v49, v51 offset:28
    v_add_u32 v51, 16, v51
    v_subrev_u32 v10, 8, v10
    v_add_u32 v49, 32, v49
    s_branch p2_xa_0
p2_ya_0:
    s_mov_b64 exec, -1
p2_xa_1:
    v_cmpx_lt_i32 vcc, 0, v11
    s_cbranch_execz p2_ya_1
    ds_write_b32 v50, v52 offset:0
    v_add_u32 v52, 16, v52
    v_cmpx_lt_i32 vcc, 1, v11
    s_cbranch_execz p2_ya_1
    ds_write_b32 v50, v52 offset:4
    v_add_u32 v52, 16, v52
    v_cmpx_lt_i32 vcc, 2, v11
    s_cbranch_execz p2_ya_1
    ds_write_b32 v50, v52 offset:8
    v_add_u32 v52, 16, v52
    v_cmpx_lt_i32 vcc, 3, v11
    s_cbranch_execz p2_ya_1
    ds_write_b32 v50, v52 offset:12
    v_add_u32 v52, 16, v52
    v_cmpx_lt_i32 vcc, 4, v11
    s_cbranch_execz p2_ya_1
    ds_write_b32 v50, v52 offset:16
    v_add_u32 v52, 16, v52
    v_cmpx_lt_i32 vcc, 5, v11
    s_cbranch_execz p2_ya_1
    ds_write_b32 v50, v52 offset:20
    v_add_u32 v52, 16, v52
    v_cmpx_lt_i32 vcc, 6, v11
    s_cbranch_execz p2_ya_1
    ds_write_b32 v50, v52 offset:24
    v_add_u32 v52, 16, v52
    v_cmpx_lt_i32 vcc, 7, v11
    s_cbranch_execz p2_ya_1
    ds_write_b32 v50, v52 offset:28
    v_add_u32 v52, 16, v52
    v_subrev_u32 v11, 8, v11
    v_add_u32 v50, 32, v50
    s_branch p2_xa_1
p2_ya_1:
    s_mov_b64 exec, -1
    s_cmp_lt_u32 s38, 512
    s_cbranch_scc1 p2_nomorea
    v_cmp_lt_u32_sdwa s[44:45], v110, v111 src0_sel:WORD_0 src1_sel:WORD_0
    v_cmp_lt_u32_sdwa s[46:47], v110, v111 src0_sel:WORD_1 src1_sel:WORD_1
    s_nop 0
    s_or_b64 s[44:45], s[44:45], s[46:47]
    s_cbranch_scc0 p2_nomorea
    v_mov_b32 v49, s19
    v_mov_b32 v50, 1
    ds_write_b32 v49, v50 offset:53760
p2_nomorea:
    s_mov_b32 m0, s23
    s_nop 0
    ds_read_addtid_b32 v102 offset:0
    ds_read_addtid_b32 v103 offset:256
    ds_read_addtid_b32 v104 offset:512
    ds_read_addtid_b32 v105 offset:768
    ds_read_addtid_b32 v106 offset:1024
    ds_read_addtid_b32 v107 offset:1280
    ds_read_addtid_b32 v108 offset:1536
    ds_read_addtid_b32 v109 offset:1792
    s_waitcnt lgkmcnt(0)
    s_cmp_lg_u32 s10, 0
    s_cbranch_scc1 p2_ntp
    s_lshr_b32 s44, s2, 3
    s_mul_i32 s44, s44, 5120
    s_mul_i32 s45, s61, 645120
    s_add_u32 s44, s44, s45
    s_add_u32 s44, s44, s62
    v_lshlrev_b32 v127, 3, v112
    s_mov_b32 exec_hi, 0xff
    buffer_load_dword v127, v127, s[4:7], s44 offen
    s_mov_b64 exec, -1
p2_ntp:
    v_lshrrev_b32 v0, 3, v102
    v_lshrrev_b32 v1, 18, v102
    v_and_b32 v102, 0x3fff, v102
    v_and_or_b32 v0, v0, s65, v1
    v_mad_u32_u24 v102, v0, s63, v102
    buffer_load_dwordx4 v[0:3], v102, s[68:71], 0 offen
    v_lshrrev_b32 v6, 3, v103
    v_lshrrev_b32 v7, 18, v103
    v_and_b32 v103, 0x3fff, v103
    v_and_or_b32 v6, v6, s65, v7
    v_mad_u32_u24 v103, v6, s63, v103
    buffer_load_dwordx4 v[6:9], v103, s[68:71], 0 offen
    v_lshrrev_b32 v12, 3, v104
    v_lshrrev_b32 v13, 18, v104
    v_and_b32 v104, 0x3fff, v104
    v_and_or_b32 v12, v12, s65, v13
    v_mad_u32_u24 v104, v12, s63, v104
    buffer_load_dwordx4 v[12:15], v104, s[68:71], 0 offen
    v_lshrrev_b32 v18, 3, v105
    v_lshrrev_b32 v19, 18, v105
    v_and_b32 v105, 0x3fff, v105
    v_and_or_b32 v18, v18, s65, v19
    v_mad_u32_u24 v105, v18, s63, v105
    buffer_load_dwordx4 v[18:21], v105, s[68:71], 0 offen
    v_lshrrev_b32 v86, 3, v106
    v_lshrrev_b32 v87, 18, v106
    v_and_b32 v106, 0x3fff, v106
    v_and_or_b32 v86, v86, s65, v87
    v_mad_u32_u24 v106, v86, s63, v106
    buffer_load_dwordx4 v[86:89], v106, s[68:71], 0 offen
    v_lshrrev_b32 v90, 3, v107
    v_lshrrev_b32 v91, 18, v107
    v_and_b32 v107, 0x3fff, v107
    v_and_or_b32 v90, v90, s65, v91
    v_mad_u32_u24 v107, v90, s63, v107
    buffer_load_dwordx4 v[90:93], v107, s[68:71], 0 offen
    v_lshrrev_b32 v94, 3, v108
    v_lshrrev_b32 v95, 18, v108
    v_and_b32 v108, 0x3fff, v108
    v_and_or_b32 v94, v94, s65, v95
    v_mad_u32_u24 v108, v94, s63, v108
    buffer_load_dwordx4 v[94:97], v108, s[68:71], 0 offen
    v_lshrrev_b32 v98, 3, v109
    v_lshrrev_b32 v99, 18, v109
    v_and_b32 v109, 0x3fff, v109
    v_and_or_b32 v98, v98, s65, v99
    v_mad_u32_u24 v109, v98, s63, v109
    buffer_load_dwordx4 v[98:101], v109, s[68:71], 0 offen
    s_mov_b32 s16, s17
    s_cmp_lg_u32 s21, 0
    s_cbranch_scc1 p2_nostat1
    v_max_u32 v60, v60, v62
    v_add_f32 v61, v61, v63
    s_nop 1
    v_max_u32_dpp v60, v60, v60 row_shr:1 row_mask:0xf bank_mask:0xf bound_ctrl:0
    v_add_f32_dpp v61, v61, v61 row_shr:1 row_mask:0xf bank_mask:0xf bound_ctrl:0
    s_nop 0
    v_max_u32_dpp v60, v60, v60 row_shr:2 row_mask:0xf bank_mask:0xf bound_ctrl:0
    v_add_f32_dpp v61, v61, v61 row_shr:2 row_mask:0xf bank_mask:0xf bound_ctrl:0
    s_nop 0
    v_max_u32_dpp v60, v60, v60 row_shr:4 row_mask:0xf bank_mask:0xf bound_ctrl:0
    v_add_f32_dpp v61, v61, v61 row_shr:4 row_mask:0xf bank_mask:0xf bound_ctrl:0
    s_nop 0
    v_max_u32_dpp v60, v60, v60 row_shr:8 row_mask:0xf bank_mask:0xf bound_ctrl:0
    v_add_f32_dpp v61, v61, v61 row_shr:8 row_mask:0xf bank_mask:0xf bound_ctrl:0
    s_nop 0
    v_max_u32_dpp v60, v60, v60 row_bcast:15 row_mask:0xa bank_mask:0xf
    v_add_f32_dpp v61, v61, v61 row_bcast:15 row_mask:0xa bank_mask:0xf
    s_nop 0
    v_max_u32_dpp v60, v60, v60 row_bcast:31 row_mask:0xc bank_mask:0xf
    v_add_f32_dpp v61, v61, v61 row_bcast:31 row_mask:0xc bank_mask:0xf
    s_nop 0
    s_nop 0
    s_lshl_b32 s44, s10, 3
    v_mov_b32 v62, s44
    s_mov_b64 exec, 1
    s_lshl_b64 exec, exec, 63
    ds_write_b64 v62, v[60:61] offset:53824
    s_mov_b64 exec, -1
p2_nostat1:
    s_waitcnt lgkmcnt(0)
    s_barrier
    v_mov_b32 v122, s19
    s_xor_b32 s19, s19, 4
    ds_read_b32 v125, v122 offset:53760
    s_cmp_lg_u32 s21, 0
    s_cbranch_scc1 p2_nostat2
    v_bfe_u32 v62, v112, 1, 7
    ds_read_b64 v[60:61], v62 offset:53824
    s_waitcnt lgkmcnt(0)
    s_nop 1
    v_max_u32_dpp v60, v60, v60 row_shr:1 row_mask:0xf bank_mask:0xf bound_ctrl:0
    v_add_f32_dpp v61, v61, v61 row_shr:1 row_mask:0xf bank_mask:0xf bound_ctrl:0
    s_nop 0
    v_max_u32_dpp v60, v60, v60 row_shr:2 row_mask:0xf bank_mask:0xf bound_ctrl:0
    v_add_f32_dpp v61, v61, v61 row_shr:2 row_mask:0xf bank_mask:0xf bound_ctrl:0
    s_nop 0
    v_max_u32_dpp v60, v60, v60 row_shr:4 row_mask:0xf bank_mask:0xf bound_ctrl:0
    v_add_f32_dpp v61, v61, v61 row_shr:4 row_mask:0xf bank_mask:0xf bound_ctrl:0
    s_nop 0
    v_max_u32_dpp v60, v60, v60 row_shr:8 row_mask:0xf bank_mask:0xf bound_ctrl:0
    v_add_f32_dpp v61, v61, v61 row_shr:8 row_mask:0xf bank_mask:0xf bound_ctrl:0
    s_nop 0
    v_max_u32_dpp v60, v60, v60 row_bcast:15 row_mask:0xa bank_mask:0xf
    v_add_f32_dpp v61, v61, v61 row_bcast:15 row_mask:0xa bank_mask:0xf
    s_nop 0
    v_max_u32_dpp v60, v60, v60 row_bcast:31 row_mask:0xc bank_mask:0xf
    v_add_f32_dpp v61, v61, v61 row_bcast:31 row_mask:0xc bank_mask:0xf
    s_nop 0
    s_nop 0
    v_readlane_b32 s44, v60, 15
    v_readlane_b32 s45, v61, 15
    s_nop 1
    s_lshl_b32 s44, s44, 16
    s_lshr_b32 s46, s44, 23
    s_sub_u32 s47, s46, 80
    s_cmp_lt_u32 s47, 100
    s_cselect_b32 s21, 0, 1
    v_mov_b32 v60, s45
    v_mul_f32 v60, 0x34a7c5ac, v60
    v_sqrt_f32 v60, v60
    v_mov_b32 v61, s44
    v_mul_f32 v62, 0x41800000, v60
    v_cmp_nle_f32 vcc, v61, v62
    v_mul_f32 v60, 0x3ac00000, v60
    v_mul_f32 v61, 0x3901742e, v61
    v_max_f32 v60, v60, v61
    s_cmp_lg_u64 vcc, 0
    s_cselect_b32 s21, 1, s21
    v_readfirstlane_b32 s44, v60
    s_nop 0
    s_and_b32 s47, s44, 0x7fffff
    s_or_b32 s47, s47, 0x3f000000
    s_and_b32 s48, s44, 0x7f800000
    s_add_u32 s48, s48, 0x800000
    v_rcp_f32 v60, s47
    s_nop 0
    v_rcp_f32 v61, v60
    v_mul_f32 v60, 0x7b800000, v60
    v_mul_f32 v61, s48, v61
    s_nop 0
    v_readfirstlane_b32 s26, v60
    v_readfirstlane_b32 s30, v61
    s_add_u32 s34, s48, 197132288
    s_mov_b32 s35, s34
    s_sub_u32 s36, 0, s34
    s_subb_u32 s37, 0, s34
    s_cmp_eq_u32 s21, 0
    s_cbranch_scc1 p2_nostat2
    s_waitcnt vmcnt(0) lgkmcnt(0)
    s_branch p2_restart
p2_nostat2:
    s_cmp_eq_u32 s21, 0
    s_cselect_b32 s26, s26, 0x7b800000
    v_mov_b32 v114, s26
    s_waitcnt lgkmcnt(0)
    v_readfirstlane_b32 s44, v125
    s_nop 0
    s_cmp_lg_u32 s44, 0
    s_cbranch_scc1 p2_adva
    s_mov_b32 s61, 1
    v_mov_b32 v110, v68
    v_mov_b32 v111, v69
p2_adva:
    s_mov_b32 m0, s23
    v_mov_b32 v53, 0x3c000
    s_movk_i32 s44, 512
    v_sub_u32_sdwa v4, v111, v110 dst_sel:DWORD dst_unused:UNUSED_PAD src0_sel:WORD_0 src1_sel:WORD_0
    v_sub_u32_sdwa v5, v111, v110 dst_sel:DWORD dst_unused:UNUSED_PAD src0_sel:WORD_1 src1_sel:WORD_1
    v_med3_i32 v4, v4, 0, s44
    v_med3_i32 v5, v5, 0, s44
    v_add_u32 v48, v4, v5
    ds_write_addtid_b32 v53 offset:0
    ds_write_addtid_b32 v53 offset:256
    ds_write_addtid_b32 v53 offset:512
    ds_write_addtid_b32 v53 offset:768
    ds_write_addtid_b32 v53 offset:1024
    ds_write_addtid_b32 v53 offset:1280
    ds_write_addtid_b32 v53 offset:1536
    ds_write_addtid_b32 v53 offset:1792
    v_lshl_add_u32 v53, v112, 15, s41
    s_nop 1
    v_add_u32_dpp v48, v48, v48 row_shr:1 row_mask:0xf bank_mask:0xf bound_ctrl:0
    s_nop 1
    v_add_u32_dpp v48, v48, v48 row_shr:2 row_mask:0xf bank_mask:0xf bound_ctrl:0
    s_nop 1
    v_add_u32_dpp v48, v48, v48 row_shr:4 row_mask:0xf bank_mask:0xf bound_ctrl:0
    s_nop 1
    v_add_u32_dpp v48, v48, v48 row_shr:8 row_mask:0xf bank_mask:0xf bound_ctrl:0
    s_nop 1
    v_add_u32_dpp v48, v48, v48 row_bcast:15 row_mask:0xa bank_mask:0xf
    s_nop 1
    v_add_u32_dpp v48, v48, v48 row_bcast:31 row_mask:0xc bank_mask:0xf
    s_nop 1
    s_nop 0
    v_readlane_b32 s38, v48, 63
    v_sub_u32 v50, v48, v5
    v_sub_u32 v49, v50, v4
    v_sub_u32 v10, 512, v49
    v_mad_u32_u16 v51, v110, 16, v53
    v_med3_i32 v10, v10, 0, v4
    v_lshl_add_u32 v49, v49, 2, s23
    v_sub_u32 v11, 512, v50
    v_mad_u32_u16 v52, v110, 16, v53 op_sel:[1,0,0,0]
    v_med3_i32 v11, v11, 0, v5
    v_lshl_add_u32 v50, v50, 2, s23
    v_lshl_add_u32 v48, v11, 16, v10
    v_add_u32 v52, 262144, v52
    v_add_u32 v110, v110, v48
    s_min_u32 s17, s38, 512
    s_add_u32 s17, s17, 63
    s_lshr_b32 s17, s17, 6
p2_xb_0:
    v_cmpx_lt_i32 vcc, 0, v10
    s_cbranch_execz p2_yb_0
    ds_write_b32 v49, v51 offset:0
    v_add_u32 v51, 16, v51
    v_cmpx_lt_i32 vcc, 1, v10
    s_cbranch_execz p2_yb_0
    ds_write_b32 v49, v51 offset:4
    v_add_u32 v51, 16, v51
    v_cmpx_lt_i32 vcc, 2, v10
    s_cbranch_execz p2_yb_0
    ds_write_b32 v49, v51 offset:8
    v_add_u32 v51, 16, v51
    v_cmpx_lt_i32 vcc, 3, v10
    s_cbranch_execz p2_yb_0
    ds_write_b32 v49, v51 offset:12
    v_add_u32 v51, 16, v51
    v_cmpx_lt_i32 vcc, 4, v10
    s_cbranch_execz p2_yb_0
    ds_write_b32 v49, v51 offset:16
    v_add_u32 v51, 16, v51
    v_cmpx_lt_i32 vcc, 5, v10
    s_cbranch_execz p2_yb_0
    ds_write_b32 v49, v51 offset:20
    v_add_u32 v51, 16, v51
    v_cmpx_lt_i32 vcc, 6, v10
    s_cbranch_execz p2_yb_0
    ds_write_b32 v49, v51 offset:24
    v_add_u32 v51, 16, v51
    v_cmpx_lt_i32 vcc, 7, v10
    s_cbranch_execz p2_yb_0
    ds_write_b32 v49, v51 offset:28
    v_add_u32 v51, 16, v51
    v_subrev_u32 v10, 8, v10
    v_add_u32 v49, 32, v49
    s_branch p2_xb_0
p2_yb_0:
    s_mov_b64 exec, -1
p2_xb_1:
    v_cmpx_lt_i32 vcc, 0, v11
    s_cbranch_execz p2_yb_1
    ds_write_b32 v50, v52 offset:0
    v_add_u32 v52, 16, v52
    v_cmpx_lt_i32 vcc, 1, v11
    s_cbranch_execz p2_yb_1
    ds_write_b32 v50, v52 offset:4
    v_add_u32 v52, 16, v52
    v_cmpx_lt_i32 vcc, 2, v11
    s_cbranch_execz p2_yb_1
    ds_write_b32 v50, v52 offset:8
    v_add_u32 v52, 16, v52
    v_cmpx_lt_i32 vcc, 3, v11
    s_cbranch_execz p2_yb_1
    ds_write_b32 v50, v52 offset:12
    v_add_u32 v52, 16, v52
    v_cmpx_lt_i32 vcc, 4, v11
    s_cbranch_execz p2_yb_1
    ds_write_b32 v50, v52 offset:16
    v_add_u32 v52, 16, v52
    v_cmpx_lt_i32 vcc, 5, v11
    s_cbranch_execz p2_yb_1
    ds_write_b32 v50, v52 offset:20
    v_add_u32 v52, 16, v52
    v_cmpx_lt_i32 vcc, 6, v11
    s_cbranch_execz p2_yb_1
    ds_write_b32 v50, v52 offset:24
    v_add_u32 v52, 16, v52
    v_cmpx_lt_i32 vcc, 7, v11
    s_cbranch_execz p2_yb_1
    ds_write_b32 v50, v52 offset:28
    v_add_u32 v52, 16, v52
    v_subrev_u32 v11, 8, v11
    v_add_u32 v50, 32, v50
    s_branch p2_xb_1
p2_yb_1:
    s_mov_b64 exec, -1
    s_cmp_lt_u32 s38, 512
    s_cbranch_scc1 p2_nomoreb
    v_cmp_lt_u32_sdwa s[44:45], v110, v111 src0_sel:WORD_0 src1_sel:WORD_0
    v_cmp_lt_u32_sdwa s[46:47], v110, v111 src0_sel:WORD_1 src1_sel:WORD_1
    s_nop 0
    s_or_b64 s[44:45], s[44:45], s[46:47]
    s_cbranch_scc0 p2_nomoreb
    v_mov_b32 v49, s19
    v_mov_b32 v50, 1
    ds_write_b32 v49, v50 offset:53760
p2_nomoreb:
    s_mov_b32 m0, s23
    s_nop 0
    ds_read_addtid_b32 v102 offset:0
    ds_read_addtid_b32 v103 offset:256
    ds_read_addtid_b32 v104 offset:512
    ds_read_addtid_b32 v105 offset:768
    ds_read_addtid_b32 v106 offset:1024
    ds_read_addtid_b32 v107 offset:1280
    ds_read_addtid_b32 v108 offset:1536
    ds_read_addtid_b32 v109 offset:1792
    s_waitcnt vmcnt(8)
    s_mov_b32 m0, s24
    s_cmp_ge_u32 s10, 9
    s_cbranch_scc1 p2_stp
    ds_write_addtid_b32 v84 offset:49152
    ds_write_addtid_b32 v85 offset:49408
p2_stp:
    s_mov_b32 m0, s23
    s_add_u32 s20, s20, 53760
    ds_write_addtid_b32 v72 offset:0
    ds_write_addtid_b32 v73 offset:256
    ds_write_addtid_b32 v74 offset:512
    ds_write_addtid_b32 v75 offset:768
    ds_write_addtid_b32 v76 offset:1024
    ds_write_addtid_b32 v77 offset:1280
    ds_write_addtid_b32 v78 offset:1536
    ds_write_addtid_b32 v79 offset:1792
    ds_write_addtid_b32 v80 offset:2048
    ds_write_addtid_b32 v81 offset:2304
    ds_write_addtid_b32 v82 offset:2560
    ds_write_addtid_b32 v83 offset:2816
    s_waitcnt lgkmcnt(0)
    s_barrier
    s_cmp_ge_u32 s10, 9
    s_cbranch_scc1 p2_nmq
    v_lshrrev_b32 v84, 1, v112
    s_add_u32 s44, s20, s42
    buffer_load_dwordx2 v[84:85], v84, s[4:7], s44 offen
p2_nmq:
    buffer_load_dwordx4 v[72:75], v112, s[4:7], s20 offen offset:0
    buffer_load_dwordx4 v[76:79], v112, s[4:7], s20 offen offset:1024
    buffer_load_dwordx4 v[80:83], v112, s[4:7], s20 offen offset:2048
    s_waitcnt vmcnt(10)
    v_perm_b32 v48, v3, v0, s31
    v_perm_b32 v49, v3, v1, s32
    v_perm_b32 v50, v3, v2, s33
    v_lshlrev_b16 v4, 3, v2
    v_lshlrev_b16 v2, 3, v1
    v_lshlrev_b16 v0, 3, v0
    v_cmpx_ge_u16 vcc, 0x3fff, v48
    ds_read_b64 v[0:1], v0
    s_mov_b64 exec, -1
    v_cmpx_ge_u16 vcc, 0x3fff, v49
    ds_read_b64 v[2:3], v2
    s_mov_b64 exec, -1
    v_cmpx_ge_u16 vcc, 0x3fff, v50
    ds_read_b64 v[4:5], v4
    s_mov_b64 exec, -1
    s_waitcnt vmcnt(9)
    v_perm_b32 v51, v9, v6, s31
    v_perm_b32 v52, v9, v7, s32
    v_perm_b32 v53, v9, v8, s33
    v_lshlrev_b16 v10, 3, v8
    v_lshlrev_b16 v8, 3, v7
    v_lshlrev_b16 v6, 3, v6
    v_cmpx_ge_u16 vcc, 0x3fff, v51
    ds_read_b64 v[6:7], v6
    s_mov_b64 exec, -1
    v_cmpx_ge_u16 vcc, 0x3fff, v52
    ds_read_b64 v[8:9], v8
    s_mov_b64 exec, -1
    v_cmpx_ge_u16 vcc, 0x3fff, v53
    ds_read_b64 v[10:11], v10
    s_mov_b64 exec, -1
    s_waitcnt vmcnt(8)
    v_perm_b32 v54, v15, v12, s31
    v_perm_b32 v55, v15, v13, s32
    v_perm_b32 v56, v15, v14, s33
    v_lshlrev_b16 v16, 3, v14
    v_lshlrev_b16 v14, 3, v13
    v_lshlrev_b16 v12, 3, v12
    v_cmpx_ge_u16 vcc, 0x3fff, v54
    ds_read_b64 v[12:13], v12
    s_mov_b64 exec, -1
    v_cmpx_ge_u16 vcc, 0x3fff, v55
    ds_read_b64 v[14:15], v14
    s_mov_b64 exec, -1
    v_cmpx_ge_u16 vcc, 0x3fff, v56
    ds_read_b64 v[16:17], v16
    s_mov_b64 exec, -1
    s_waitcnt vmcnt(7)
    v_perm_b32 v57, v21, v18, s31
    v_perm_b32 v58, v21, v19, s32
    v_perm_b32 v59, v21, v20, s33
    v_lshlrev_b16 v22, 3, v20
    v_lshlrev_b16 v20, 3, v19
    v_lshlrev_b16 v18, 3, v18
    v_cmpx_ge_u16 vcc, 0x3fff, v57
    ds_read_b64 v[18:19], v18
    s_mov_b64 exec, -1
    v_cmpx_ge_u16 vcc, 0x3fff, v58
    ds_read_b64 v[20:21], v20
    s_mov_b64 exec, -1
    v_cmpx_ge_u16 vcc, 0x3fff, v59
    ds_read_b64 v[22:23], v22
    s_mov_b64 exec, -1
    s_waitcnt vmcnt(6)
    v_perm_b32 v60, v89, v86, s31
    v_perm_b32 v61, v89, v87, s32
    v_perm_b32 v62, v89, v88, s33
    v_lshlrev_b16 v28, 3, v88
    v_lshlrev_b16 v26, 3, v87
    v_lshlrev_b16 v24, 3, v86
    v_cmpx_ge_u16 vcc, 0x3fff, v60
    ds_read_b64 v[24:25], v24
    s_mov_b64 exec, -1
    v_cmpx_ge_u16 vcc, 0x3fff, v61
    ds_read_b64 v[26:27], v26
    s_mov_b64 exec, -1
    v_cmpx_ge_u16 vcc, 0x3fff, v62
    ds_read_b64 v[28:29], v28
    s_mov_b64 exec, -1
    v_lshrrev_b32 v86, 3, v106
    v_lshrrev_b32 v87, 18, v106
    v_and_b32 v106, 0x3fff, v106
    v_and_or_b32 v86, v86, s65, v87
    v_mad_u32_u24 v106, v86, s63, v106
    buffer_load_dwordx4 v[86:89], v106, s[68:71], 0 offen
    s_waitcnt vmcnt(6)
    v_perm_b32 v63, v93, v90, s31
    v_perm_b32 v64, v93, v91, s32
    v_perm_b32 v65, v93, v92, s33
    v_lshlrev_b16 v34, 3, v92
    v_lshlrev_b16 v32, 3, v91
    v_lshlrev_b16 v30, 3, v90
    v_cmpx_ge_u16 vcc, 0x3fff, v63
    ds_read_b64 v[30:31], v30
    s_mov_b64 exec, -1
    v_cmpx_ge_u16 vcc, 0x3fff, v64
    ds_read_b64 v[32:33], v32
    s_mov_b64 exec, -1
    v_cmpx_ge_u16 vcc, 0x3fff, v65
    ds_read_b64 v[34:35], v34
    s_mov_b64 exec, -1
    v_lshrrev_b32 v90, 3, v107
    v_lshrrev_b32 v91, 18, v107
    v_and_b32 v107, 0x3fff, v107
    v_and_or_b32 v90, v90, s65, v91
    v_mad_u32_u24 v107, v90, s63, v107
    buffer_load_dwordx4 v[90:93], v107, s[68:71], 0 offen
    s_waitcnt vmcnt(6)
    v_perm_b32 v66, v97, v94, s31
    v_perm_b32 v67, v97, v95, s32
    v_perm_b32 v68, v97, v96, s33
    v_lshlrev_b16 v40, 3, v96
    v_lshlrev_b16 v38, 3, v95
    v_lshlrev_b16 v36, 3, v94
    v_cmpx_ge_u16 vcc, 0x3fff, v66
    ds_read_b64 v[36:37], v36
    s_mov_b64 exec, -1
    v_cmpx_ge_u16 vcc, 0x3fff, v67
    ds_read_b64 v[38:39], v38
    s_mov_b64 exec, -1
    v_cmpx_ge_u16 vcc, 0x3fff, v68
    ds_read_b64 v[40:41], v40
    s_mov_b64 exec, -1
    s_waitcnt vmcnt(5)
    v_perm_b32 v69, v101, v98, s31
    v_perm_b32 v70, v101, v99, s32
    v_perm_b32 v71, v101, v100, s33
    v_lshlrev_b16 v46, 3, v100
    v_lshlrev_b16 v44, 3, v99
    v_lshlrev_b16 v42, 3, v98
    s_cmp_le_u32 s16, 7
    s_cbranch_scc1 p2_gp
    v_cmpx_ge_u16 vcc, 0x3fff, v69
    ds_read_b64 v[42:43], v42
    s_mov_b64 exec, -1
    v_cmpx_ge_u16 vcc, 0x3fff, v70
    ds_read_b64 v[44:45], v44
    s_mov_b64 exec, -1
    v_cmpx_ge_u16 vcc, 0x3fff, v71
    ds_read_b64 v[46:47], v46
    s_mov_b64 exec, -1
p2_gp:
    s_waitcnt lgkmcnt(0)
    s_barrier
    s_branch p2_tail
p2_top:
    s_cmp_lg_u32 s21, 0
    s_cbranch_scc1 p2_topf
    s_cmp_eq_u32 s60, 10
    s_cbranch_scc1 p2_drain0
    v_cmpx_gt_i16 vcc, 0, v48
    ds_read_b64 v[0:1], v0
    s_mov_b64 exec, -1
    v_cmpx_gt_i16 vcc, 0, v49
    ds_read_b64 v[2:3], v2
    s_mov_b64 exec, -1
    v_cmpx_gt_i16 vcc, 0, v50
    ds_read_b64 v[4:5], v4
    s_mov_b64 exec, -1
    v_cmpx_gt_i16 vcc, 0, v51
    ds_read_b64 v[6:7], v6
    s_mov_b64 exec, -1
    v_cmpx_gt_i16 vcc, 0, v52
    ds_read_b64 v[8:9], v8
    s_mov_b64 exec, -1
    v_cmpx_gt_i16 vcc, 0, v53
    ds_read_b64 v[10:11], v10
    s_mov_b64 exec, -1
    v_cmpx_gt_i16 vcc, 0, v54
    ds_read_b64 v[12:13], v12
    s_mov_b64 exec, -1
    v_cmpx_gt_i16 vcc, 0, v55
    ds_read_b64 v[14:15], v14
    s_mov_b64 exec, -1
    v_cmpx_gt_i16 vcc, 0, v56
    ds_read_b64 v[16:17], v16
    s_mov_b64 exec, -1
    v_cmpx_gt_i16 vcc, 0, v57
    ds_read_b64 v[18:19], v18
    s_mov_b64 exec, -1
    v_cmpx_gt_i16 vcc, 0, v58
    ds_read_b64 v[20:21], v20
    s_mov_b64 exec, -1
    v_cmpx_gt_i16 vcc, 0, v59
    ds_read_b64 v[22:23], v22
    s_mov_b64 exec, -1
    s_cmp_ge_u32 s10, 9
    s_cbranch_scc1 p2_nm0m0a
    v_lshrrev_b32 v84, 1, v112
    s_add_u32 s44, s20, s42
    buffer_load_dwordx2 v[84:85], v84, s[4:7], s44 offen
p2_nm0m0a:
    buffer_load_dwordx4 v[72:75], v112, s[4:7], s20 offen offset:0
    buffer_load_dwordx4 v[76:79], v112, s[4:7], s20 offen offset:1024
    buffer_load_dwordx4 v[80:83], v112, s[4:7], s20 offen offset:2048
    v_cmpx_gt_i16 vcc, 0, v60
    ds_read_b64 v[24:25], v24
    s_mov_b64 exec, -1
    v_cmpx_gt_i16 vcc, 0, v61
    ds_read_b64 v[26:27], v26
    s_mov_b64 exec, -1
    v_cmpx_gt_i16 vcc, 0, v62
    ds_read_b64 v[28:29], v28
    s_mov_b64 exec, -1
    v_cmpx_gt_i16 vcc, 0, v63
    ds_read_b64 v[30:31], v30
    s_mov_b64 exec, -1
    v_cmpx_gt_i16 vcc, 0, v64
    ds_read_b64 v[32:33], v32
    s_mov_b64 exec, -1
    v_cmpx_gt_i16 vcc, 0, v65
    ds_read_b64 v[34:35], v34
    s_mov_b64 exec, -1
    v_cmpx_gt_i16 vcc, 0, v66
    ds_read_b64 v[36:37], v36
    s_mov_b64 exec, -1
    v_cmpx_gt_i16 vcc, 0, v67
    ds_read_b64 v[38:39], v38
    s_mov_b64 exec, -1
    v_cmpx_gt_i16 vcc, 0, v68
    ds_read_b64 v[40:41], v40
    s_mov_b64 exec, -1
    s_cmp_le_u32 s15, 7
    s_cbranch_scc1 p2_g0r27
    v_cmpx_gt_i16 vcc, 0, v69
    ds_read_b64 v[42:43], v42
    s_mov_b64 exec, -1
    v_cmpx_gt_i16 vcc, 0, v70
    ds_read_b64 v[44:45], v44
    s_mov_b64 exec, -1
    v_cmpx_gt_i16 vcc, 0, v71
    ds_read_b64 v[46:47], v46
    s_mov_b64 exec, -1
p2_g0r27:
    s_waitcnt lgkmcnt(15)
    v_ashrrev_i32 v122, 5, v48
    v_lshlrev_b16 v123, 2, v48
    v_lshlrev_b32 v124, 16, v0
    v_bitop3_b32 v122, v122, v113, v113 bitop3:0x0c
    v_and_b32 v125, 0xffff0000, v0
    v_lshlrev_b32 v126, 16, v1
    v_mul_f32 v122, v114, v122
    v_and_b32 v127, 0xffff0000, v1
    v_add_u32 v123, v123, v123
    v_pk_fma_f32 v[124:125], v[124:125], v[122:123], s[34:35] op_sel_hi:[1,0,1]
    v_pk_fma_f32 v[126:127], v[126:127], v[122:123], s[34:35] op_sel_hi:[1,0,1]
    v_lshl_add_u32 v124, v125, 16, v124
    v_lshl_add_u32 v125, v127, 16, v126
    s_waitcnt lgkmcnt(15)
    v_bitop3_b32 v115, v115, v116, v117 bitop3:0xfe
    v_lshl_add_u64 v[124:125], v[124:125], 0, s[36:37]
    v_cmpx_le_u32 vcc, 0x1000000, v48
    ds_add_rtn_u64 v[116:117], v123, v[124:125] offset:54272
    s_mov_b64 exec, -1
    v_ashrrev_i32 v122, 5, v49
    v_lshlrev_b16 v123, 2, v49
    v_lshlrev_b32 v124, 16, v2
    v_bitop3_b32 v122, v122, v113, v113 bitop3:0x0c
    v_and_b32 v125, 0xffff0000, v2
    v_lshlrev_b32 v126, 16, v3
    v_mul_f32 v122, v114, v122
    v_and_b32 v127, 0xffff0000, v3
    v_add_u32 v123, v123, v123
    v_pk_fma_f32 v[124:125], v[124:125], v[122:123], s[34:35] op_sel_hi:[1,0,1]
    v_pk_fma_f32 v[126:127], v[126:127], v[122:123], s[34:35] op_sel_hi:[1,0,1]
    v_lshl_add_u32 v124, v125, 16, v124
    v_lshl_add_u32 v125, v127, 16, v126
    s_waitcnt lgkmcnt(15)
    v_bitop3_b32 v115, v115, v118, v119 bitop3:0xfe
    v_lshl_add_u64 v[124:125], v[124:125], 0, s[36:37]
    v_cmpx_le_u32 vcc, 0x1000000, v49
    ds_add_rtn_u64 v[118:119], v123, v[124:125] offset:54272
    s_mov_b64 exec, -1
    v_ashrrev_i32 v122, 5, v50
    v_lshlrev_b16 v123, 2, v50
    v_lshlrev_b32 v124, 16, v4
    v_bitop3_b32 v122, v122, v113, v113 bitop3:0x0c
    v_and_b32 v125, 0xffff0000, v4
    v_lshlrev_b32 v126, 16, v5
    v_mul_f32 v122, v114, v122
    v_and_b32 v127, 0xffff0000, v5
    v_add_u32 v123, v123, v123
    v_pk_fma_f32 v[124:125], v[124:125], v[122:123], s[34:35] op_sel_hi:[1,0,1]
    v_pk_fma_f32 v[126:127], v[126:127], v[122:123], s[34:35] op_sel_hi:[1,0,1]
    v_lshl_add_u32 v124, v125, 16, v124
    v_lshl_add_u32 v125, v127, 16, v126
    s_waitcnt lgkmcnt(15)
    v_bitop3_b32 v115, v115, v120, v121 bitop3:0xfe
    v_lshl_add_u64 v[124:125], v[124:125], 0, s[36:37]
    v_cmpx_le_u32 vcc, 0x1000000, v50
    ds_add_rtn_u64 v[120:121], v123, v[124:125] offset:54272
    s_mov_b64 exec, -1
    v_lshrrev_b32 v0, 3, v102
    v_lshrrev_b32 v1, 18, v102
    v_and_b32 v102, 0x3fff, v102
    v_and_or_b32 v0, v0, s65, v1
    v_mad_u32_u24 v102, v0, s63, v102
    buffer_load_dwordx4 v[0:3], v102, s[68:71], 0 offen
    s_waitcnt lgkmcnt(15)
    v_ashrrev_i32 v122, 5, v51
    v_lshlrev_b16 v123, 2, v51
    v_lshlrev_b32 v124, 16, v6
    v_bitop3_b32 v122, v122, v113, v113 bitop3:0x0c
    v_and_b32 v125, 0xffff0000, v6
    v_lshlrev_b32 v126, 16, v7
    v_mul_f32 v122, v114, v122
    v_and_b32 v127, 0xffff0000, v7
    v_add_u32 v123, v123, v123
    v_pk_fma_f32 v[124:125], v[124:125], v[122:123], s[34:35] op_sel_hi:[1,0,1]
    v_pk_fma_f32 v[126:127], v[126:127], v[122:123], s[34:35] op_sel_hi:[1,0,1]
    v_lshl_add_u32 v124, v125, 16, v124
    v_lshl_add_u32 v125, v127, 16, v126
    s_waitcnt lgkmcnt(2)
    v_bitop3_b32 v115, v115, v116, v117 bitop3:0xfe
    v_lshl_add_u64 v[124:125], v[124:125], 0, s[36:37]
    v_cmpx_le_u32 vcc, 0x1000000, v51
    ds_add_rtn_u64 v[116:117], v123, v[124:125] offset:54272
    s_mov_b64 exec, -1
    v_ashrrev_i32 v122, 5, v52
    v_lshlrev_b16 v123, 2, v52
    v_lshlrev_b32 v124, 16, v8
    v_bitop3_b32 v122, v122, v113, v113 bitop3:0x0c
    v_and_b32 v125, 0xffff0000, v8
    v_lshlrev_b32 v126, 16, v9
    v_mul_f32 v122, v114, v122
    v_and_b32 v127, 0xffff0000, v9
    v_add_u32 v123, v123, v123
    v_pk_fma_f32 v[124:125], v[124:125], v[122:123], s[34:35] op_sel_hi:[1,0,1]
    v_pk_fma_f32 v[126:127], v[126:127], v[122:123], s[34:35] op_sel_hi:[1,0,1]
    v_lshl_add_u32 v124, v125, 16, v124
    v_lshl_add_u32 v125, v127, 16, v126
    s_waitcnt lgkmcnt(2)
    v_bitop3_b32 v115, v115, v118, v119 bitop3:0xfe
    v_lshl_add_u64 v[124:125], v[124:125], 0, s[36:37]
    v_cmpx_le_u32 vcc, 0x1000000, v52
    ds_add_rtn_u64 v[118:119], v123, v[124:125] offset:54272
    s_mov_b64 exec, -1
    v_ashrrev_i32 v122, 5, v53
    v_lshlrev_b16 v123, 2, v53
    v_lshlrev_b32 v124, 16, v10
    v_bitop3_b32 v122, v122, v113, v113 bitop3:0x0c
    v_and_b32 v125, 0xffff0000, v10
    v_lshlrev_b32 v126, 16, v11
    v_mul_f32 v122, v114, v122
    v_and_b32 v127, 0xffff0000, v11
    v_add_u32 v123, v123, v123
    v_pk_fma_f32 v[124:125], v[124:125], v[122:123], s[34:35] op_sel_hi:[1,0,1]
    v_pk_fma_f32 v[126:127], v[126:127], v[122:123], s[34:35] op_sel_hi:[1,0,1]
    v_lshl_add_u32 v124, v125, 16, v124
    v_lshl_add_u32 v125, v127, 16, v126
    s_waitcnt lgkmcnt(2)
    v_bitop3_b32 v115, v115, v120, v121 bitop3:0xfe
    v_lshl_add_u64 v[124:125], v[124:125], 0, s[36:37]
    v_cmpx_le_u32 vcc, 0x1000000, v53
    ds_add_rtn_u64 v[120:121], v123, v[124:125] offset:54272
    s_mov_b64 exec, -1
    v_lshrrev_b32 v6, 3, v103
    v_lshrrev_b32 v7, 18, v103
    v_and_b32 v103, 0x3fff, v103
    v_and_or_b32 v6, v6, s65, v7
    v_mad_u32_u24 v103, v6, s63, v103
    buffer_load_dwordx4 v[6:9], v103, s[68:71], 0 offen
    s_waitcnt lgkmcnt(6)
    s_barrier
    s_waitcnt lgkmcnt(15)
    v_ashrrev_i32 v122, 5, v54
    v_lshlrev_b16 v123, 2, v54
    v_lshlrev_b32 v124, 16, v12
    v_bitop3_b32 v122, v122, v113, v113 bitop3:0x0c
    v_and_b32 v125, 0xffff0000, v12
    v_lshlrev_b32 v126, 16, v13
    v_mul_f32 v122, v114, v122
    v_and_b32 v127, 0xffff0000, v13
    v_add_u32 v123, v123, v123
    v_pk_fma_f32 v[124:125], v[124:125], v[122:123], s[34:35] op_sel_hi:[1,0,1]
    v_pk_fma_f32 v[126:127], v[126:127], v[122:123], s[34:35] op_sel_hi:[1,0,1]
    v_lshl_add_u32 v124, v125, 16, v124
    v_lshl_add_u32 v125, v127, 16, v126
    s_waitcnt lgkmcnt(2)
    v_bitop3_b32 v115, v115, v116, v117 bitop3:0xfe
    v_lshl_add_u64 v[124:125], v[124:125], 0, s[36:37]
    v_cmpx_le_u32 vcc, 0x1000000, v54
    ds_add_rtn_u64 v[116:117], v123, v[124:125] offset:54272
    s_mov_b64 exec, -1
    v_ashrrev_i32 v122, 5, v55
    v_lshlrev_b16 v123, 2, v55
    v_lshlrev_b32 v124, 16, v14
    v_bitop3_b32 v122, v122, v113, v113 bitop3:0x0c
    v_and_b32 v125, 0xffff0000, v14
    v_lshlrev_b32 v126, 16, v15
    v_mul_f32 v122, v114, v122
    v_and_b32 v127, 0xffff0000, v15
    v_add_u32 v123, v123, v123
    v_pk_fma_f32 v[124:125], v[124:125], v[122:123], s[34:35] op_sel_hi:[1,0,1]
    v_pk_fma_f32 v[126:127], v[126:127], v[122:123], s[34:35] op_sel_hi:[1,0,1]
    v_lshl_add_u32 v124, v125, 16, v124
    v_lshl_add_u32 v125, v127, 16, v126
    s_waitcnt lgkmcnt(2)
    v_bitop3_b32 v115, v115, v118, v119 bitop3:0xfe
    v_lshl_add_u64 v[124:125], v[124:125], 0, s[36:37]
    v_cmpx_le_u32 vcc, 0x1000000, v55
    ds_add_rtn_u64 v[118:119], v123, v[124:125] offset:54272
    s_mov_b64 exec, -1
    v_ashrrev_i32 v122, 5, v56
    v_lshlrev_b16 v123, 2, v56
    v_lshlrev_b32 v124, 16, v16
    v_bitop3_b32 v122, v122, v113, v113 bitop3:0x0c
    v_and_b32 v125, 0xffff0000, v16
    v_lshlrev_b32 v126, 16, v17
    v_mul_f32 v122, v114, v122
    v_and_b32 v127, 0xffff0000, v17
    v_add_u32 v123, v123, v123
    v_pk_fma_f32 v[124:125], v[124:125], v[122:123], s[34:35] op_sel_hi:[1,0,1]
    v_pk_fma_f32 v[126:127], v[126:127], v[122:123], s[34:35] op_sel_hi:[1,0,1]
    v_lshl_add_u32 v124, v125, 16, v124
    v_lshl_add_u32 v125, v127, 16, v126
    s_waitcnt lgkmcnt(2)
    v_bitop3_b32 v115, v115, v120, v121 bitop3:0xfe
    v_lshl_add_u64 v[124:125], v[124:125], 0, s[36:37]
    v_cmpx_le_u32 vcc, 0x1000000, v56
    ds_add_rtn_u64 v[120:121], v123, v[124:125] offset:54272
    s_mov_b64 exec, -1
    v_lshrrev_b32 v12, 3, v104
    v_lshrrev_b32 v13, 18, v104
    v_and_b32 v104, 0x3fff, v104
    v_and_or_b32 v12, v12, s65, v13
    v_mad_u32_u24 v104, v12, s63, v104
    buffer_load_dwordx4 v[12:15], v104, s[68:71], 0 offen
    s_waitcnt lgkmcnt(15)
    v_ashrrev_i32 v122, 5, v57
    v_lshlrev_b16 v123, 2, v57
    v_lshlrev_b32 v124, 16, v18
    v_bitop3_b32 v122, v122, v113, v113 bitop3:0x0c
    v_and_b32 v125, 0xffff0000, v18
    v_lshlrev_b32 v126, 16, v19
    v_mul_f32 v122, v114, v122
    v_and_b32 v127, 0xffff0000, v19
    v_add_u32 v123, v123, v123
    v_pk_fma_f32 v[124:125], v[124:125], v[122:123], s[34:35] op_sel_hi:[1,0,1]
    v_pk_fma_f32 v[126:127], v[126:127], v[122:123], s[34:35] op_sel_hi:[1,0,1]
    v_lshl_add_u32 v124, v125, 16, v124
    v_lshl_add_u32 v125, v127, 16, v126
    s_waitcnt lgkmcnt(2)
    v_bitop3_b32 v115, v115, v116, v117 bitop3:0xfe
    v_lshl_add_u64 v[124:125], v[124:125], 0, s[36:37]
    v_cmpx_le_u32 vcc, 0x1000000, v57
    ds_add_rtn_u64 v[116:117], v123, v[124:125] offset:54272
    s_mov_b64 exec, -1
    v_ashrrev_i32 v122, 5, v58
    v_lshlrev_b16 v123, 2, v58
    v_lshlrev_b32 v124, 16, v20
    v_bitop3_b32 v122, v122, v113, v113 bitop3:0x0c
    v_and_b32 v125, 0xffff0000, v20
    v_lshlrev_b32 v126, 16, v21
    v_mul_f32 v122, v114, v122
    v_and_b32 v127, 0xffff0000, v21
    v_add_u32 v123, v123, v123
    v_pk_fma_f32 v[124:125], v[124:125], v[122:123], s[34:35] op_sel_hi:[1,0,1]
    v_pk_fma_f32 v[126:127], v[126:127], v[122:123], s[34:35] op_sel_hi:[1,0,1]
    v_lshl_add_u32 v124, v125, 16, v124
    v_lshl_add_u32 v125, v127, 16, v126
    s_waitcnt lgkmcnt(2)
    v_bitop3_b32 v115, v115, v118, v119 bitop3:0xfe
    v_lshl_add_u64 v[124:125], v[124:125], 0, s[36:37]
    v_cmpx_le_u32 vcc, 0x1000000, v58
    ds_add_rtn_u64 v[118:119], v123, v[124:125] offset:54272
    s_mov_b64 exec, -1
    v_ashrrev_i32 v122, 5, v59
    v_lshlrev_b16 v123, 2, v59
    v_lshlrev_b32 v124, 16, v22
    v_bitop3_b32 v122, v122, v113, v113 bitop3:0x0c
    v_and_b32 v125, 0xffff0000, v22
    v_lshlrev_b32 v126, 16, v23
    v_mul_f32 v122, v114, v122
    v_and_b32 v127, 0xffff0000, v23
    v_add_u32 v123, v123, v123
    v_pk_fma_f32 v[124:125], v[124:125], v[122:123], s[34:35] op_sel_hi:[1,0,1]
    v_pk_fma_f32 v[126:127], v[126:127], v[122:123], s[34:35] op_sel_hi:[1,0,1]
    v_lshl_add_u32 v124, v125, 16, v124
    v_lshl_add_u32 v125, v127, 16, v126
    s_waitcnt lgkmcnt(2)
    v_bitop3_b32 v115, v115, v120, v121 bitop3:0xfe
    v_lshl_add_u64 v[124:125], v[124:125], 0, s[36:37]
    v_cmpx_le_u32 vcc, 0x1000000, v59
    ds_add_rtn_u64 v[120:121], v123, v[124:125] offset:54272
    s_mov_b64 exec, -1
    v_lshrrev_b32 v18, 3, v105
    v_lshrrev_b32 v19, 18, v105
    v_and_b32 v105, 0x3fff, v105
    v_and_or_b32 v18, v18, s65, v19
    v_mad_u32_u24 v105, v18, s63, v105
    buffer_load_dwordx4 v[18:21], v105, s[68:71], 0 offen
    s_mov_b32 m0, s23
    v_mov_b32 v53, 0x3c000
    s_movk_i32 s44, 512
    v_sub_u32_sdwa v4, v111, v110 dst_sel:DWORD dst_unused:UNUSED_PAD src0_sel:WORD_0 src1_sel:WORD_0
    v_sub_u32_sdwa v5, v111, v110 dst_sel:DWORD dst_unused:UNUSED_PAD src0_sel:WORD_1 src1_sel:WORD_1
    v_med3_i32 v4, v4, 0, s44
    v_med3_i32 v5, v5, 0, s44
    v_add_u32 v48, v4, v5
    ds_write_addtid_b32 v53 offset:0
    ds_write_addtid_b32 v53 offset:256
    ds_write_addtid_b32 v53 offset:512
    ds_write_addtid_b32 v53 offset:768
    ds_write_addtid_b32 v53 offset:1024
    ds_write_addtid_b32 v53 offset:1280
    ds_write_addtid_b32 v53 offset:1536
    ds_write_addtid_b32 v53 offset:1792
    v_lshl_add_u32 v53, v112, 15, s41
    s_nop 1
    v_add_u32_dpp v48, v48, v48 row_shr:1 row_mask:0xf bank_mask:0xf bound_ctrl:0
    s_nop 1
    v_add_u32_dpp v48, v48, v48 row_shr:2 row_mask:0xf bank_mask:0xf bound_ctrl:0
    s_nop 1
    v_add_u32_dpp v48, v48, v48 row_shr:4 row_mask:0xf bank_mask:0xf bound_ctrl:0
    s_nop 1
    v_add_u32_dpp v48, v48, v48 row_shr:8 row_mask:0xf bank_mask:0xf bound_ctrl:0
    s_nop 1
    v_add_u32_dpp v48, v48, v48 row_bcast:15 row_mask:0xa bank_mask:0xf
    s_nop 1
    v_add_u32_dpp v48, v48, v48 row_bcast:31 row_mask:0xc bank_mask:0xf
    s_nop 1
    s_nop 0
    v_readlane_b32 s38, v48, 63
    v_sub_u32 v50, v48, v5
    v_sub_u32 v49, v50, v4
    v_sub_u32 v10, 512, v49
    v_mad_u32_u16 v51, v110, 16, v53
    v_med3_i32 v10, v10, 0, v4
    v_lshl_add_u32 v49, v49, 2, s23
    v_sub_u32 v11, 512, v50
    v_mad_u32_u16 v52, v110, 16, v53 op_sel:[1,0,0,0]
    v_med3_i32 v11, v11, 0, v5
    v_lshl_add_u32 v50, v50, 2, s23
    v_lshl_add_u32 v48, v11, 16, v10
    v_add_u32 v52, 262144, v52
    v_add_u32 v110, v110, v48
    s_min_u32 s17, s38, 512
    s_add_u32 s17, s17, 63
    s_lshr_b32 s17, s17, 6
p2_x0x_0:
    v_cmpx_lt_i32 vcc, 0, v10
    s_cbranch_execz p2_y0x_0
    ds_write_b32 v49, v51 offset:0
    v_add_u32 v51, 16, v51
    v_cmpx_lt_i32 vcc, 1, v10
    s_cbranch_execz p2_y0x_0
    ds_write_b32 v49, v51 offset:4
    v_add_u32 v51, 16, v51
    v_cmpx_lt_i32 vcc, 2, v10
    s_cbranch_execz p2_y0x_0
    ds_write_b32 v49, v51 offset:8
    v_add_u32 v51, 16, v51
    v_cmpx_lt_i32 vcc, 3, v10
    s_cbranch_execz p2_y0x_0
    ds_write_b32 v49, v51 offset:12
    v_add_u32 v51, 16, v51
    v_cmpx_lt_i32 vcc, 4, v10
    s_cbranch_execz p2_y0x_0
    ds_write_b32 v49, v51 offset:16
    v_add_u32 v51, 16, v51
    v_cmpx_lt_i32 vcc, 5, v10
    s_cbranch_execz p2_y0x_0
    ds_write_b32 v49, v51 offset:20
    v_add_u32 v51, 16, v51
    v_cmpx_lt_i32 vcc, 6, v10
    s_cbranch_execz p2_y0x_0
    ds_write_b32 v49, v51 offset:24
    v_add_u32 v51, 16, v51
    v_cmpx_lt_i32 vcc, 7, v10
    s_cbranch_execz p2_y0x_0
    ds_write_b32 v49, v51 offset:28
    v_add_u32 v51, 16, v51
    v_subrev_u32 v10, 8, v10
    v_add_u32 v49, 32, v49
    s_branch p2_x0x_0
p2_y0x_0:
    s_mov_b64 exec, -1
p2_x0x_1:
    v_cmpx_lt_i32 vcc, 0, v11
    s_cbranch_execz p2_y0x_1
    ds_write_b32 v50, v52 offset:0
    v_add_u32 v52, 16, v52
    v_cmpx_lt_i32 vcc, 1, v11
    s_cbranch_execz p2_y0x_1
    ds_write_b32 v50, v52 offset:4
    v_add_u32 v52, 16, v52
    v_cmpx_lt_i32 vcc, 2, v11
    s_cbranch_execz p2_y0x_1
    ds_write_b32 v50, v52 offset:8
    v_add_u32 v52, 16, v52
    v_cmpx_lt_i32 vcc, 3, v11
    s_cbranch_execz p2_y0x_1
    ds_write_b32 v50, v52 offset:12
    v_add_u32 v52, 16, v52
    v_cmpx_lt_i32 vcc, 4, v11
    s_cbranch_execz p2_y0x_1
    ds_write_b32 v50, v52 offset:16
    v_add_u32 v52, 16, v52
    v_cmpx_lt_i32 vcc, 5, v11
    s_cbranch_execz p2_y0x_1
    ds_write_b32 v50, v52 offset:20
    v_add_u32 v52, 16, v52
    v_cmpx_lt_i32 vcc, 6, v11
    s_cbranch_execz p2_y0x_1
    ds_write_b32 v50, v52 offset:24
    v_add_u32 v52, 16, v52
    v_cmpx_lt_i32 vcc, 7, v11
    s_cbranch_execz p2_y0x_1
    ds_write_b32 v50, v52 offset:28
    v_add_u32 v52, 16, v52
    v_subrev_u32 v11, 8, v11
    v_add_u32 v50, 32, v50
    s_branch p2_x0x_1
p2_y0x_1:
    s_mov_b64 exec, -1
    s_cmp_lt_u32 s38, 512
    s_cbranch_scc1 p2_nomore0x
    v_cmp_lt_u32_sdwa s[44:45], v110, v111 src0_sel:WORD_0 src1_sel:WORD_0
    v_cmp_lt_u32_sdwa s[46:47], v110, v111 src0_sel:WORD_1 src1_sel:WORD_1
    s_nop 0
    s_or_b64 s[44:45], s[44:45], s[46:47]
    s_cbranch_scc0 p2_nomore0x
    v_mov_b32 v49, s19
    v_mov_b32 v50, 1
    ds_write_b32 v49, v50 offset:53760
p2_nomore0x:
    s_mov_b32 m0, s23
    s_nop 0
    ds_read_addtid_b32 v102 offset:0
    ds_read_addtid_b32 v103 offset:256
    ds_read_addtid_b32 v104 offset:512
    ds_read_addtid_b32 v105 offset:768
    ds_read_addtid_b32 v106 offset:1024
    ds_read_addtid_b32 v107 offset:1280
    ds_read_addtid_b32 v108 offset:1536
    ds_read_addtid_b32 v109 offset:1792
    s_waitcnt vmcnt(4)
    s_mov_b32 m0, s24
    s_cmp_ge_u32 s10, 9
    s_cbranch_scc1 p2_st0s0
    ds_write_addtid_b32 v84 offset:49152
    ds_write_addtid_b32 v85 offset:49408
p2_st0s0:
    s_mov_b32 m0, s23
    s_add_u32 s20, s20, 53760
    ds_write_addtid_b32 v72 offset:0
    ds_write_addtid_b32 v73 offset:256
    ds_write_addtid_b32 v74 offset:512
    ds_write_addtid_b32 v75 offset:768
    ds_write_addtid_b32 v76 offset:1024
    ds_write_addtid_b32 v77 offset:1280
    ds_write_addtid_b32 v78 offset:1536
    ds_write_addtid_b32 v79 offset:1792
    ds_write_addtid_b32 v80 offset:2048
    ds_write_addtid_b32 v81 offset:2304
    ds_write_addtid_b32 v82 offset:2560
    ds_write_addtid_b32 v83 offset:2816
    s_waitcnt lgkmcnt(15)
    v_ashrrev_i32 v122, 5, v60
    v_lshlrev_b16 v123, 2, v60
    v_lshlrev_b32 v124, 16, v24
    v_bitop3_b32 v122, v122, v113, v113 bitop3:0x0c
    v_and_b32 v125, 0xffff0000, v24
    v_lshlrev_b32 v126, 16, v25
    v_mul_f32 v122, v114, v122
    v_and_b32 v127, 0xffff0000, v25
    v_add_u32 v123, v123, v123
    v_pk_fma_f32 v[124:125], v[124:125], v[122:123], s[34:35] op_sel_hi:[1,0,1]
    v_pk_fma_f32 v[126:127], v[126:127], v[122:123], s[34:35] op_sel_hi:[1,0,1]
    v_lshl_add_u32 v124, v125, 16, v124
    v_lshl_add_u32 v125, v127, 16, v126
    s_waitcnt lgkmcnt(15)
    v_bitop3_b32 v115, v115, v116, v117 bitop3:0xfe
    v_lshl_add_u64 v[124:125], v[124:125], 0, s[36:37]
    v_cmpx_le_u32 vcc, 0x1000000, v60
    ds_add_rtn_u64 v[116:117], v123, v[124:125] offset:54272
    s_mov_b64 exec, -1
    v_ashrrev_i32 v122, 5, v61
    v_lshlrev_b16 v123, 2, v61
    v_lshlrev_b32 v124, 16, v26
    v_bitop3_b32 v122, v122, v113, v113 bitop3:0x0c
    v_and_b32 v125, 0xffff0000, v26
    v_lshlrev_b32 v126, 16, v27
    v_mul_f32 v122, v114, v122
    v_and_b32 v127, 0xffff0000, v27
    v_add_u32 v123, v123, v123
    v_pk_fma_f32 v[124:125], v[124:125], v[122:123], s[34:35] op_sel_hi:[1,0,1]
    v_pk_fma_f32 v[126:127], v[126:127], v[122:123], s[34:35] op_sel_hi:[1,0,1]
    v_lshl_add_u32 v124, v125, 16, v124
    v_lshl_add_u32 v125, v127, 16, v126
    s_waitcnt lgkmcnt(15)
    v_bitop3_b32 v115, v115, v118, v119 bitop3:0xfe
    v_lshl_add_u64 v[124:125], v[124:125], 0, s[36:37]
    v_cmpx_le_u32 vcc, 0x1000000, v61
    ds_add_rtn_u64 v[118:119], v123, v[124:125] offset:54272
    s_mov_b64 exec, -1
    v_ashrrev_i32 v122, 5, v62
    v_lshlrev_b16 v123, 2, v62
    v_lshlrev_b32 v124, 16, v28
    v_bitop3_b32 v122, v122, v113, v113 bitop3:0x0c
    v_and_b32 v125, 0xffff0000, v28
    v_lshlrev_b32 v126, 16, v29
    v_mul_f32 v122, v114, v122
    v_and_b32 v127, 0xffff0000, v29
    v_add_u32 v123, v123, v123
    v_pk_fma_f32 v[124:125], v[124:125], v[122:123], s[34:35] op_sel_hi:[1,0,1]
    v_pk_fma_f32 v[126:127], v[126:127], v[122:123], s[34:35] op_sel_hi:[1,0,1]
    v_lshl_add_u32 v124, v125, 16, v124
    v_lshl_add_u32 v125, v127, 16, v126
    s_waitcnt lgkmcnt(15)
    v_bitop3_b32 v115, v115, v120, v121 bitop3:0xfe
    v_lshl_add_u64 v[124:125], v[124:125], 0, s[36:37]
    v_cmpx_le_u32 vcc, 0x1000000, v62
    ds_add_rtn_u64 v[120:121], v123, v[124:125] offset:54272
    s_mov_b64 exec, -1
    s_waitcnt vmcnt(13)
    v_perm_b32 v60, v89, v86, s31
    v_perm_b32 v61, v89, v87, s32
    v_perm_b32 v62, v89, v88, s33
    v_lshlrev_b16 v28, 3, v88
    v_lshlrev_b16 v26, 3, v87
    v_lshlrev_b16 v24, 3, v86
    s_waitcnt lgkmcnt(3)
    s_barrier
    s_cmp_ge_u32 s10, 9
    s_cbranch_scc1 p2_nm0m1a
    v_lshrrev_b32 v84, 1, v112
    s_add_u32 s44, s20, s42
    buffer_load_dwordx2 v[84:85], v84, s[4:7], s44 offen
p2_nm0m1a:
    buffer_load_dwordx4 v[72:75], v112, s[4:7], s20 offen offset:0
    buffer_load_dwordx4 v[76:79], v112, s[4:7], s20 offen offset:1024
    buffer_load_dwordx4 v[80:83], v112, s[4:7], s20 offen offset:2048
    v_cmpx_ge_u16 vcc, 0x3fff, v60
    ds_read_b64 v[24:25], v24
    s_mov_b64 exec, -1
    v_cmpx_ge_u16 vcc, 0x3fff, v61
    ds_read_b64 v[26:27], v26
    s_mov_b64 exec, -1
    v_cmpx_ge_u16 vcc, 0x3fff, v62
    ds_read_b64 v[28:29], v28
    s_mov_b64 exec, -1
    s_waitcnt lgkmcnt(15)
    v_ashrrev_i32 v122, 5, v63
    v_lshlrev_b16 v123, 2, v63
    v_lshlrev_b32 v124, 16, v30
    v_bitop3_b32 v122, v122, v113, v113 bitop3:0x0c
    v_and_b32 v125, 0xffff0000, v30
    v_lshlrev_b32 v126, 16, v31
    v_mul_f32 v122, v114, v122
    v_and_b32 v127, 0xffff0000, v31
    v_add_u32 v123, v123, v123
    v_pk_fma_f32 v[124:125], v[124:125], v[122:123], s[34:35] op_sel_hi:[1,0,1]
    v_pk_fma_f32 v[126:127], v[126:127], v[122:123], s[34:35] op_sel_hi:[1,0,1]
    v_lshl_add_u32 v124, v125, 16, v124
    v_lshl_add_u32 v125, v127, 16, v126
    s_waitcnt lgkmcnt(5)
    v_bitop3_b32 v115, v115, v116, v117 bitop3:0xfe
    v_lshl_add_u64 v[124:125], v[124:125], 0, s[36:37]
    v_cmpx_le_u32 vcc, 0x1000000, v63
    ds_add_rtn_u64 v[116:117], v123, v[124:125] offset:54272
    s_mov_b64 exec, -1
    v_ashrrev_i32 v122, 5, v64
    v_lshlrev_b16 v123, 2, v64
    v_lshlrev_b32 v124, 16, v32
    v_bitop3_b32 v122, v122, v113, v113 bitop3:0x0c
    v_and_b32 v125, 0xffff0000, v32
    v_lshlrev_b32 v126, 16, v33
    v_mul_f32 v122, v114, v122
    v_and_b32 v127, 0xffff0000, v33
    v_add_u32 v123, v123, v123
    v_pk_fma_f32 v[124:125], v[124:125], v[122:123], s[34:35] op_sel_hi:[1,0,1]
    v_pk_fma_f32 v[126:127], v[126:127], v[122:123], s[34:35] op_sel_hi:[1,0,1]
    v_lshl_add_u32 v124, v125, 16, v124
    v_lshl_add_u32 v125, v127, 16, v126
    s_waitcnt lgkmcnt(5)
    v_bitop3_b32 v115, v115, v118, v119 bitop3:0xfe
    v_lshl_add_u64 v[124:125], v[124:125], 0, s[36:37]
    v_cmpx_le_u32 vcc, 0x1000000, v64
    ds_add_rtn_u64 v[118:119], v123, v[124:125] offset:54272
    s_mov_b64 exec, -1
    v_ashrrev_i32 v122, 5, v65
    v_lshlrev_b16 v123, 2, v65
    v_lshlrev_b32 v124, 16, v34
    v_bitop3_b32 v122, v122, v113, v113 bitop3:0x0c
    v_and_b32 v125, 0xffff0000, v34
    v_lshlrev_b32 v126, 16, v35
    v_mul_f32 v122, v114, v122
    v_and_b32 v127, 0xffff0000, v35
    v_add_u32 v123, v123, v123
    v_pk_fma_f32 v[124:125], v[124:125], v[122:123], s[34:35] op_sel_hi:[1,0,1]
    v_pk_fma_f32 v[126:127], v[126:127], v[122:123], s[34:35] op_sel_hi:[1,0,1]
    v_lshl_add_u32 v124, v125, 16, v124
    v_lshl_add_u32 v125, v127, 16, v126
    s_waitcnt lgkmcnt(5)
    v_bitop3_b32 v115, v115, v120, v121 bitop3:0xfe
    v_lshl_add_u64 v[124:125], v[124:125], 0, s[36:37]
    v_cmpx_le_u32 vcc, 0x1000000, v65
    ds_add_rtn_u64 v[120:121], v123, v[124:125] offset:54272
    s_mov_b64 exec, -1
    s_waitcnt vmcnt(15)
    v_perm_b32 v63, v93, v90, s31
    v_perm_b32 v64, v93, v91, s32
    v_perm_b32 v65, v93, v92, s33
    v_lshlrev_b16 v34, 3, v92
    v_lshlrev_b16 v32, 3, v91
    v_lshlrev_b16 v30, 3, v90
    v_cmpx_ge_u16 vcc, 0x3fff, v63
    ds_read_b64 v[30:31], v30
    s_mov_b64 exec, -1
    v_cmpx_ge_u16 vcc, 0x3fff, v64
    ds_read_b64 v[32:33], v32
    s_mov_b64 exec, -1
    v_cmpx_ge_u16 vcc, 0x3fff, v65
    ds_read_b64 v[34:35], v34
    s_mov_b64 exec, -1
    s_waitcnt lgkmcnt(15)
    v_lshrrev_b32 v86, 3, v106
    v_lshrrev_b32 v87, 18, v106
    v_and_b32 v106, 0x3fff, v106
    v_and_or_b32 v86, v86, s65, v87
    v_mad_u32_u24 v106, v86, s63, v106
    buffer_load_dwordx4 v[86:89], v106, s[68:71], 0 offen
    s_waitcnt lgkmcnt(15)
    v_ashrrev_i32 v122, 5, v66
    v_lshlrev_b16 v123, 2, v66
    v_lshlrev_b32 v124, 16, v36
    v_bitop3_b32 v122, v122, v113, v113 bitop3:0x0c
    v_and_b32 v125, 0xffff0000, v36
    v_lshlrev_b32 v126, 16, v37
    v_mul_f32 v122, v114, v122
    v_and_b32 v127, 0xffff0000, v37
    v_add_u32 v123, v123, v123
    v_pk_fma_f32 v[124:125], v[124:125], v[122:123], s[34:35] op_sel_hi:[1,0,1]
    v_pk_fma_f32 v[126:127], v[126:127], v[122:123], s[34:35] op_sel_hi:[1,0,1]
    v_lshl_add_u32 v124, v125, 16, v124
    v_lshl_add_u32 v125, v127, 16, v126
    s_waitcnt lgkmcnt(5)
    v_bitop3_b32 v115, v115, v116, v117 bitop3:0xfe
    v_lshl_add_u64 v[124:125], v[124:125], 0, s[36:37]
    v_cmpx_le_u32 vcc, 0x1000000, v66
    ds_add_rtn_u64 v[116:117], v123, v[124:125] offset:54272
    s_mov_b64 exec, -1
    v_ashrrev_i32 v122, 5, v67
    v_lshlrev_b16 v123, 2, v67
    v_lshlrev_b32 v124, 16, v38
    v_bitop3_b32 v122, v122, v113, v113 bitop3:0x0c
    v_and_b32 v125, 0xffff0000, v38
    v_lshlrev_b32 v126, 16, v39
    v_mul_f32 v122, v114, v122
    v_and_b32 v127, 0xffff0000, v39
    v_add_u32 v123, v123, v123
    v_pk_fma_f32 v[124:125], v[124:125], v[122:123], s[34:35] op_sel_hi:[1,0,1]
    v_pk_fma_f32 v[126:127], v[126:127], v[122:123], s[34:35] op_sel_hi:[1,0,1]
    v_lshl_add_u32 v124, v125, 16, v124
    v_lshl_add_u32 v125, v127, 16, v126
    s_waitcnt lgkmcnt(5)
    v_bitop3_b32 v115, v115, v118, v119 bitop3:0xfe
    v_lshl_add_u64 v[124:125], v[124:125], 0, s[36:37]
    v_cmpx_le_u32 vcc, 0x1000000, v67
    ds_add_rtn_u64 v[118:119], v123, v[124:125] offset:54272
    s_mov_b64 exec, -1
    v_ashrrev_i32 v122, 5, v68
    v_lshlrev_b16 v123, 2, v68
    v_lshlrev_b32 v124, 16, v40
    v_bitop3_b32 v122, v122, v113, v113 bitop3:0x0c
    v_and_b32 v125, 0xffff0000, v40
    v_lshlrev_b32 v126, 16, v41
    v_mul_f32 v122, v114, v122
    v_and_b32 v127, 0xffff0000, v41
    v_add_u32 v123, v123, v123
    v_pk_fma_f32 v[124:125], v[124:125], v[122:123], s[34:35] op_sel_hi:[1,0,1]
    v_pk_fma_f32 v[126:127], v[126:127], v[122:123], s[34:35] op_sel_hi:[1,0,1]
    v_lshl_add_u32 v124, v125, 16, v124
    v_lshl_add_u32 v125, v127, 16, v126
    s_waitcnt lgkmcnt(5)
    v_bitop3_b32 v115, v115, v120, v121 bitop3:0xfe
    v_lshl_add_u64 v[124:125], v[124:125], 0, s[36:37]
    v_cmpx_le_u32 vcc, 0x1000000, v68
    ds_add_rtn_u64 v[120:121], v123, v[124:125] offset:54272
    s_mov_b64 exec, -1
    s_waitcnt vmcnt(12)
    v_perm_b32 v66, v97, v94, s31
    v_perm_b32 v67, v97, v95, s32
    v_perm_b32 v68, v97, v96, s33
    v_lshlrev_b16 v40, 3, v96
    v_lshlrev_b16 v38, 3, v95
    v_lshlrev_b16 v36, 3, v94
    v_cmpx_ge_u16 vcc, 0x3fff, v66
    ds_read_b64 v[36:37], v36
    s_mov_b64 exec, -1
    v_cmpx_ge_u16 vcc, 0x3fff, v67
    ds_read_b64 v[38:39], v38
    s_mov_b64 exec, -1
    v_cmpx_ge_u16 vcc, 0x3fff, v68
    ds_read_b64 v[40:41], v40
    s_mov_b64 exec, -1
    s_cmp_le_u32 s15, 7
    s_cbranch_scc1 p2_na0a7
    s_waitcnt lgkmcnt(15)
    v_ashrrev_i32 v122, 5, v69
    v_lshlrev_b16 v123, 2, v69
    v_lshlrev_b32 v124, 16, v42
    v_bitop3_b32 v122, v122, v113, v113 bitop3:0x0c
    v_and_b32 v125, 0xffff0000, v42
    v_lshlrev_b32 v126, 16, v43
    v_mul_f32 v122, v114, v122
    v_and_b32 v127, 0xffff0000, v43
    v_add_u32 v123, v123, v123
    v_pk_fma_f32 v[124:125], v[124:125], v[122:123], s[34:35] op_sel_hi:[1,0,1]
    v_pk_fma_f32 v[126:127], v[126:127], v[122:123], s[34:35] op_sel_hi:[1,0,1]
    v_lshl_add_u32 v124, v125, 16, v124
    v_lshl_add_u32 v125, v127, 16, v126
    s_waitcnt lgkmcnt(5)
    v_bitop3_b32 v115, v115, v116, v117 bitop3:0xfe
    v_lshl_add_u64 v[124:125], v[124:125], 0, s[36:37]
    v_cmpx_le_u32 vcc, 0x1000000, v69
    ds_add_rtn_u64 v[116:117], v123, v[124:125] offset:54272
    s_mov_b64 exec, -1
    v_ashrrev_i32 v122, 5, v70
    v_lshlrev_b16 v123, 2, v70
    v_lshlrev_b32 v124, 16, v44
    v_bitop3_b32 v122, v122, v113, v113 bitop3:0x0c
    v_and_b32 v125, 0xffff0000, v44
    v_lshlrev_b32 v126, 16, v45
    v_mul_f32 v122, v114, v122
    v_and_b32 v127, 0xffff0000, v45
    v_add_u32 v123, v123, v123
    v_pk_fma_f32 v[124:125], v[124:125], v[122:123], s[34:35] op_sel_hi:[1,0,1]
    v_pk_fma_f32 v[126:127], v[126:127], v[122:123], s[34:35] op_sel_hi:[1,0,1]
    v_lshl_add_u32 v124, v125, 16, v124
    v_lshl_add_u32 v125, v127, 16, v126
    s_waitcnt lgkmcnt(5)
    v_bitop3_b32 v115, v115, v118, v119 bitop3:0xfe
    v_lshl_add_u64 v[124:125], v[124:125], 0, s[36:37]
    v_cmpx_le_u32 vcc, 0x1000000, v70
    ds_add_rtn_u64 v[118:119], v123, v[124:125] offset:54272
    s_mov_b64 exec, -1
    v_ashrrev_i32 v122, 5, v71
    v_lshlrev_b16 v123, 2, v71
    v_lshlrev_b32 v124, 16, v46
    v_bitop3_b32 v122, v122, v113, v113 bitop3:0x0c
    v_and_b32 v125, 0xffff0000, v46
    v_lshlrev_b32 v126, 16, v47
    v_mul_f32 v122, v114, v122
    v_and_b32 v127, 0xffff0000, v47
    v_add_u32 v123, v123, v123
    v_pk_fma_f32 v[124:125], v[124:125], v[122:123], s[34:35] op_sel_hi:[1,0,1]
    v_pk_fma_f32 v[126:127], v[126:127], v[122:123], s[34:35] op_sel_hi:[1,0,1]
    v_lshl_add_u32 v124, v125, 16, v124
    v_lshl_add_u32 v125, v127, 16, v126
    s_waitcnt lgkmcnt(5)
    v_bitop3_b32 v115, v115, v120, v121 bitop3:0xfe
    v_lshl_add_u64 v[124:125], v[124:125], 0, s[36:37]
    v_cmpx_le_u32 vcc, 0x1000000, v71
    ds_add_rtn_u64 v[120:121], v123, v[124:125] offset:54272
    s_mov_b64 exec, -1
p2_na0a7:
    s_waitcnt vmcnt(11)
    v_perm_b32 v69, v101, v98, s31
    v_perm_b32 v70, v101, v99, s32
    v_perm_b32 v71, v101, v100, s33
    v_lshlrev_b16 v46, 3, v100
    v_lshlrev_b16 v44, 3, v99
    v_lshlrev_b16 v42, 3, v98
    s_cmp_le_u32 s16, 7
    s_cbranch_scc1 p2_g0r07
    v_cmpx_ge_u16 vcc, 0x3fff, v69
    ds_read_b64 v[42:43], v42
    s_mov_b64 exec, -1
    v_cmpx_ge_u16 vcc, 0x3fff, v70
    ds_read_b64 v[44:45], v44
    s_mov_b64 exec, -1
    v_cmpx_ge_u16 vcc, 0x3fff, v71
    ds_read_b64 v[46:47], v46
    s_mov_b64 exec, -1
p2_g0r07:
    s_waitcnt lgkmcnt(15)
    v_lshrrev_b32 v90, 3, v107
    v_lshrrev_b32 v91, 18, v107
    v_and_b32 v107, 0x3fff, v107
    v_and_or_b32 v90, v90, s65, v91
    v_mad_u32_u24 v107, v90, s63, v107
    buffer_load_dwordx4 v[90:93], v107, s[68:71], 0 offen
    s_waitcnt vmcnt(8)
    v_perm_b32 v48, v3, v0, s31
    v_perm_b32 v49, v3, v1, s32
    v_perm_b32 v50, v3, v2, s33
    v_lshlrev_b16 v4, 3, v2
    v_lshlrev_b16 v2, 3, v1
    v_lshlrev_b16 v0, 3, v0
    v_cmpx_ge_u16 vcc, 0x3fff, v48
    ds_read_b64 v[0:1], v0
    s_mov_b64 exec, -1
    v_cmpx_ge_u16 vcc, 0x3fff, v49
    ds_read_b64 v[2:3], v2
    s_mov_b64 exec, -1
    v_cmpx_ge_u16 vcc, 0x3fff, v50
    ds_read_b64 v[4:5], v4
    s_mov_b64 exec, -1
    s_waitcnt vmcnt(7)
    v_perm_b32 v51, v9, v6, s31
    v_perm_b32 v52, v9, v7, s32
    v_perm_b32 v53, v9, v8, s33
    v_lshlrev_b16 v10, 3, v8
    v_lshlrev_b16 v8, 3, v7
    v_lshlrev_b16 v6, 3, v6
    v_cmpx_ge_u16 vcc, 0x3fff, v51
    ds_read_b64 v[6:7], v6
    s_mov_b64 exec, -1
    v_cmpx_ge_u16 vcc, 0x3fff, v52
    ds_read_b64 v[8:9], v8
    s_mov_b64 exec, -1
    v_cmpx_ge_u16 vcc, 0x3fff, v53
    ds_read_b64 v[10:11], v10
    s_mov_b64 exec, -1
    s_waitcnt vmcnt(6)
    v_perm_b32 v54, v15, v12, s31
    v_perm_b32 v55, v15, v13, s32
    v_perm_b32 v56, v15, v14, s33
    v_lshlrev_b16 v16, 3, v14
    v_lshlrev_b16 v14, 3, v13
    v_lshlrev_b16 v12, 3, v12
    v_cmpx_ge_u16 vcc, 0x3fff, v54
    ds_read_b64 v[12:13], v12
    s_mov_b64 exec, -1
    v_cmpx_ge_u16 vcc, 0x3fff, v55
    ds_read_b64 v[14:15], v14
    s_mov_b64 exec, -1
    v_cmpx_ge_u16 vcc, 0x3fff, v56
    ds_read_b64 v[16:17], v16
    s_mov_b64 exec, -1
    s_waitcnt vmcnt(5)
    v_perm_b32 v57, v21, v18, s31
    v_perm_b32 v58, v21, v19, s32
    v_perm_b32 v59, v21, v20, s33
    v_lshlrev_b16 v22, 3, v20
    v_lshlrev_b16 v20, 3, v19
    v_lshlrev_b16 v18, 3, v18
    v_cmpx_ge_u16 vcc, 0x3fff, v57
    ds_read_b64 v[18:19], v18
    s_mov_b64 exec, -1
    v_cmpx_ge_u16 vcc, 0x3fff, v58
    ds_read_b64 v[20:21], v20
    s_mov_b64 exec, -1
    v_cmpx_ge_u16 vcc, 0x3fff, v59
    ds_read_b64 v[22:23], v22
    s_mov_b64 exec, -1
    s_waitcnt lgkmcnt(0)
    s_barrier
    s_waitcnt lgkmcnt(15)
    s_branch p2_tail
p2_drain0:
    v_cmpx_gt_i16 vcc, 0, v48
    ds_read_b64 v[0:1], v0
    s_mov_b64 exec, -1
    v_cmpx_gt_i16 vcc, 0, v49
    ds_read_b64 v[2:3], v2
    s_mov_b64 exec, -1
    v_cmpx_gt_i16 vcc, 0, v50
    ds_read_b64 v[4:5], v4
    s_mov_b64 exec, -1
    v_cmpx_gt_i16 vcc, 0, v51
    ds_read_b64 v[6:7], v6
    s_mov_b64 exec, -1
    v_cmpx_gt_i16 vcc, 0, v52
    ds_read_b64 v[8:9], v8
    s_mov_b64 exec, -1
    v_cmpx_gt_i16 vcc, 0, v53
    ds_read_b64 v[10:11], v10
    s_mov_b64 exec, -1
    v_cmpx_gt_i16 vcc, 0, v54
    ds_read_b64 v[12:13], v12
    s_mov_b64 exec, -1
    v_cmpx_gt_i16 vcc, 0, v55
    ds_read_b64 v[14:15], v14
    s_mov_b64 exec, -1
    v_cmpx_gt_i16 vcc, 0, v56
    ds_read_b64 v[16:17], v16
    s_mov_b64 exec, -1
    v_cmpx_gt_i16 vcc, 0, v57
    ds_read_b64 v[18:19], v18
    s_mov_b64 exec, -1
    v_cmpx_gt_i16 vcc, 0, v58
    ds_read_b64 v[20:21], v20
    s_mov_b64 exec, -1
    v_cmpx_gt_i16 vcc, 0, v59
    ds_read_b64 v[22:23], v22
    s_mov_b64 exec, -1
    v_cmpx_gt_i16 vcc, 0, v60
    ds_read_b64 v[24:25], v24
    s_mov_b64 exec, -1
    v_cmpx_gt_i16 vcc, 0, v61
    ds_read_b64 v[26:27], v26
    s_mov_b64 exec, -1
    v_cmpx_gt_i16 vcc, 0, v62
    ds_read_b64 v[28:29], v28
    s_mov_b64 exec, -1
    v_cmpx_gt_i16 vcc, 0, v63
    ds_read_b64 v[30:31], v30
    s_mov_b64 exec, -1
    v_cmpx_gt_i16 vcc, 0, v64
    ds_read_b64 v[32:33], v32
    s_mov_b64 exec, -1
    v_cmpx_gt_i16 vcc, 0, v65
    ds_read_b64 v[34:35], v34
    s_mov_b64 exec, -1
    v_cmpx_gt_i16 vcc, 0, v66
    ds_read_b64 v[36:37], v36
    s_mov_b64 exec, -1
    v_cmpx_gt_i16 vcc, 0, v67
    ds_read_b64 v[38:39], v38
    s_mov_b64 exec, -1
    v_cmpx_gt_i16 vcc, 0, v68
    ds_read_b64 v[40:41], v40
    s_mov_b64 exec, -1
    s_cmp_le_u32 s15, 7
    s_cbranch_scc1 p2_gd0
    v_cmpx_gt_i16 vcc, 0, v69
    ds_read_b64 v[42:43], v42
    s_mov_b64 exec, -1
    v_cmpx_gt_i16 vcc, 0, v70
    ds_read_b64 v[44:45], v44
    s_mov_b64 exec, -1
    v_cmpx_gt_i16 vcc, 0, v71
    ds_read_b64 v[46:47], v46
    s_mov_b64 exec, -1
p2_gd0:
    s_waitcnt lgkmcnt(15)
    v_ashrrev_i32 v122, 5, v48
    v_lshlrev_b16 v123, 2, v48
    v_lshlrev_b32 v124, 16, v0
    v_bitop3_b32 v122, v122, v113, v113 bitop3:0x0c
    v_and_b32 v125, 0xffff0000, v0
    v_lshlrev_b32 v126, 16, v1
    v_mul_f32 v122, v114, v122
    v_and_b32 v127, 0xffff0000, v1
    v_add_u32 v123, v123, v123
    v_pk_fma_f32 v[124:125], v[124:125], v[122:123], s[34:35] op_sel_hi:[1,0,1]
    v_pk_fma_f32 v[126:127], v[126:127], v[122:123], s[34:35] op_sel_hi:[1,0,1]
    v_lshl_add_u32 v124, v125, 16, v124
    v_lshl_add_u32 v125, v127, 16, v126
    s_waitcnt lgkmcnt(15)
    v_bitop3_b32 v115, v115, v116, v117 bitop3:0xfe
    v_lshl_add_u64 v[124:125], v[124:125], 0, s[36:37]
    v_cmpx_le_u32 vcc, 0x1000000, v48
    ds_add_rtn_u64 v[116:117], v123, v[124:125] offset:54272
    s_mov_b64 exec, -1
    v_ashrrev_i32 v122, 5, v49
    v_lshlrev_b16 v123, 2, v49
    v_lshlrev_b32 v124, 16, v2
    v_bitop3_b32 v122, v122, v113, v113 bitop3:0x0c
    v_and_b32 v125, 0xffff0000, v2
    v_lshlrev_b32 v126, 16, v3
    v_mul_f32 v122, v114, v122
    v_and_b32 v127, 0xffff0000, v3
    v_add_u32 v123, v123, v123
    v_pk_fma_f32 v[124:125], v[124:125], v[122:123], s[34:35] op_sel_hi:[1,0,1]
    v_pk_fma_f32 v[126:127], v[126:127], v[122:123], s[34:35] op_sel_hi:[1,0,1]
    v_lshl_add_u32 v124, v125, 16, v124
    v_lshl_add_u32 v125, v127, 16, v126
    s_waitcnt lgkmcnt(15)
    v_bitop3_b32 v115, v115, v118, v119 bitop3:0xfe
    v_lshl_add_u64 v[124:125], v[124:125], 0, s[36:37]
    v_cmpx_le_u32 vcc, 0x1000000, v49
    ds_add_rtn_u64 v[118:119], v123, v[124:125] offset:54272
    s_mov_b64 exec, -1
    v_ashrrev_i32 v122, 5, v50
    v_lshlrev_b16 v123, 2, v50
    v_lshlrev_b32 v124, 16, v4
    v_bitop3_b32 v122, v122, v113, v113 bitop3:0x0c
    v_and_b32 v125, 0xffff0000, v4
    v_lshlrev_b32 v126, 16, v5
    v_mul_f32 v122, v114, v122
    v_and_b32 v127, 0xffff0000, v5
    v_add_u32 v123, v123, v123
    v_pk_fma_f32 v[124:125], v[124:125], v[122:123], s[34:35] op_sel_hi:[1,0,1]
    v_pk_fma_f32 v[126:127], v[126:127], v[122:123], s[34:35] op_sel_hi:[1,0,1]
    v_lshl_add_u32 v124, v125, 16, v124
    v_lshl_add_u32 v125, v127, 16, v126
    s_waitcnt lgkmcnt(15)
    v_bitop3_b32 v115, v115, v120, v121 bitop3:0xfe
    v_lshl_add_u64 v[124:125], v[124:125], 0, s[36:37]
    v_cmpx_le_u32 vcc, 0x1000000, v50
    ds_add_rtn_u64 v[120:121], v123, v[124:125] offset:54272
    s_mov_b64 exec, -1
    s_waitcnt lgkmcnt(15)
    v_ashrrev_i32 v122, 5, v51
    v_lshlrev_b16 v123, 2, v51
    v_lshlrev_b32 v124, 16, v6
    v_bitop3_b32 v122, v122, v113, v113 bitop3:0x0c
    v_and_b32 v125, 0xffff0000, v6
    v_lshlrev_b32 v126, 16, v7
    v_mul_f32 v122, v114, v122
    v_and_b32 v127, 0xffff0000, v7
    v_add_u32 v123, v123, v123
    v_pk_fma_f32 v[124:125], v[124:125], v[122:123], s[34:35] op_sel_hi:[1,0,1]
    v_pk_fma_f32 v[126:127], v[126:127], v[122:123], s[34:35] op_sel_hi:[1,0,1]
    v_lshl_add_u32 v124, v125, 16, v124
    v_lshl_add_u32 v125, v127, 16, v126
    s_waitcnt lgkmcnt(2)
    v_bitop3_b32 v115, v115, v116, v117 bitop3:0xfe
    v_lshl_add_u64 v[124:125], v[124:125], 0, s[36:37]
    v_cmpx_le_u32 vcc, 0x1000000, v51
    ds_add_rtn_u64 v[116:117], v123, v[124:125] offset:54272
    s_mov_b64 exec, -1
    v_ashrrev_i32 v122, 5, v52
    v_lshlrev_b16 v123, 2, v52
    v_lshlrev_b32 v124, 16, v8
    v_bitop3_b32 v122, v122, v113, v113 bitop3:0x0c
    v_and_b32 v125, 0xffff0000, v8
    v_lshlrev_b32 v126, 16, v9
    v_mul_f32 v122, v114, v122
    v_and_b32 v127, 0xffff0000, v9
    v_add_u32 v123, v123, v123
    v_pk_fma_f32 v[124:125], v[124:125], v[122:123], s[34:35] op_sel_hi:[1,0,1]
    v_pk_fma_f32 v[126:127], v[126:127], v[122:123], s[34:35] op_sel_hi:[1,0,1]
    v_lshl_add_u32 v124, v125, 16, v124
    v_lshl_add_u32 v125, v127, 16, v126
    s_waitcnt lgkmcnt(2)
    v_bitop3_b32 v115, v115, v118, v119 bitop3:0xfe
    v_lshl_add_u64 v[124:125], v[124:125], 0, s[36:37]
    v_cmpx_le_u32 vcc, 0x1000000, v52
    ds_add_rtn_u64 v[118:119], v123, v[124:125] offset:54272
    s_mov_b64 exec, -1
    v_ashrrev_i32 v122, 5, v53
    v_lshlrev_b16 v123, 2, v53
    v_lshlrev_b32 v124, 16, v10
    v_bitop3_b32 v122, v122, v113, v113 bitop3:0x0c
    v_and_b32 v125, 0xffff0000, v10
    v_lshlrev_b32 v126, 16, v11
    v_mul_f32 v122, v114, v122
    v_and_b32 v127, 0xffff0000, v11
    v_add_u32 v123, v123, v123
    v_pk_fma_f32 v[124:125], v[124:125], v[122:123], s[34:35] op_sel_hi:[1,0,1]
    v_pk_fma_f32 v[126:127], v[126:127], v[122:123], s[34:35] op_sel_hi:[1,0,1]
    v_lshl_add_u32 v124, v125, 16, v124
    v_lshl_add_u32 v125, v127, 16, v126
    s_waitcnt lgkmcnt(2)
    v_bitop3_b32 v115, v115, v120, v121 bitop3:0xfe
    v_lshl_add_u64 v[124:125], v[124:125], 0, s[36:37]
    v_cmpx_le_u32 vcc, 0x1000000, v53
    ds_add_rtn_u64 v[120:121], v123, v[124:125] offset:54272
    s_mov_b64 exec, -1
    s_waitcnt lgkmcnt(15)
    v_ashrrev_i32 v122, 5, v54
    v_lshlrev_b16 v123, 2, v54
    v_lshlrev_b32 v124, 16, v12
    v_bitop3_b32 v122, v122, v113, v113 bitop3:0x0c
    v_and_b32 v125, 0xffff0000, v12
    v_lshlrev_b32 v126, 16, v13
    v_mul_f32 v122, v114, v122
    v_and_b32 v127, 0xffff0000, v13
    v_add_u32 v123, v123, v123
    v_pk_fma_f32 v[124:125], v[124:125], v[122:123], s[34:35] op_sel_hi:[1,0,1]
    v_pk_fma_f32 v[126:127], v[126:127], v[122:123], s[34:35] op_sel_hi:[1,0,1]
    v_lshl_add_u32 v124, v125, 16, v124
    v_lshl_add_u32 v125, v127, 16, v126
    s_waitcnt lgkmcnt(2)
    v_bitop3_b32 v115, v115, v116, v117 bitop3:0xfe
    v_lshl_add_u64 v[124:125], v[124:125], 0, s[36:37]
    v_cmpx_le_u32 vcc, 0x1000000, v54
    ds_add_rtn_u64 v[116:117], v123, v[124:125] offset:54272
    s_mov_b64 exec, -1
    v_ashrrev_i32 v122, 5, v55
    v_lshlrev_b16 v123, 2, v55
    v_lshlrev_b32 v124, 16, v14
    v_bitop3_b32 v122, v122, v113, v113 bitop3:0x0c
    v_and_b32 v125, 0xffff0000, v14
    v_lshlrev_b32 v126, 16, v15
    v_mul_f32 v122, v114, v122
    v_and_b32 v127, 0xffff0000, v15
    v_add_u32 v123, v123, v123
    v_pk_fma_f32 v[124:125], v[124:125], v[122:123], s[34:35] op_sel_hi:[1,0,1]
    v_pk_fma_f32 v[126:127], v[126:127], v[122:123], s[34:35] op_sel_hi:[1,0,1]
    v_lshl_add_u32 v124, v125, 16, v124
    v_lshl_add_u32 v125, v127, 16, v126
    s_waitcnt lgkmcnt(2)
    v_bitop3_b32 v115, v115, v118, v119 bitop3:0xfe
    v_lshl_add_u64 v[124:125], v[124:125], 0, s[36:37]
    v_cmpx_le_u32 vcc, 0x1000000, v55
    ds_add_rtn_u64 v[118:119], v123, v[124:125] offset:54272
    s_mov_b64 exec, -1
    v_ashrrev_i32 v122, 5, v56
    v_lshlrev_b16 v123, 2, v56
    v_lshlrev_b32 v124, 16, v16
    v_bitop3_b32 v122, v122, v113, v113 bitop3:0x0c
    v_and_b32 v125, 0xffff0000, v16
    v_lshlrev_b32 v126, 16, v17
    v_mul_f32 v122, v114, v122
    v_and_b32 v127, 0xffff0000, v17
    v_add_u32 v123, v123, v123
    v_pk_fma_f32 v[124:125], v[124:125], v[122:123], s[34:35] op_sel_hi:[1,0,1]
    v_pk_fma_f32 v[126:127], v[126:127], v[122:123], s[34:35] op_sel_hi:[1,0,1]
    v_lshl_add_u32 v124, v125, 16, v124
    v_lshl_add_u32 v125, v127, 16, v126
    s_waitcnt lgkmcnt(2)
    v_bitop3_b32 v115, v115, v120, v121 bitop3:0xfe
    v_lshl_add_u64 v[124:125], v[124:125], 0, s[36:37]
    v_cmpx_le_u32 vcc, 0x1000000, v56
    ds_add_rtn_u64 v[120:121], v123, v[124:125] offset:54272
    s_mov_b64 exec, -1
    s_waitcnt lgkmcnt(15)
    v_ashrrev_i32 v122, 5, v57
    v_lshlrev_b16 v123, 2, v57
    v_lshlrev_b32 v124, 16, v18
    v_bitop3_b32 v122, v122, v113, v113 bitop3:0x0c
    v_and_b32 v125, 0xffff0000, v18
    v_lshlrev_b32 v126, 16, v19
    v_mul_f32 v122, v114, v122
    v_and_b32 v127, 0xffff0000, v19
    v_add_u32 v123, v123, v123
    v_pk_fma_f32 v[124:125], v[124:125], v[122:123], s[34:35] op_sel_hi:[1,0,1]
    v_pk_fma_f32 v[126:127], v[126:127], v[122:123], s[34:35] op_sel_hi:[1,0,1]
    v_lshl_add_u32 v124, v125, 16, v124
    v_lshl_add_u32 v125, v127, 16, v126
    s_waitcnt lgkmcnt(2)
    v_bitop3_b32 v115, v115, v116, v117 bitop3:0xfe
    v_lshl_add_u64 v[124:125], v[124:125], 0, s[36:37]
    v_cmpx_le_u32 vcc, 0x1000000, v57
    ds_add_rtn_u64 v[116:117], v123, v[124:125] offset:54272
    s_mov_b64 exec, -1
    v_ashrrev_i32 v122, 5, v58
    v_lshlrev_b16 v123, 2, v58
    v_lshlrev_b32 v124, 16, v20
    v_bitop3_b32 v122, v122, v113, v113 bitop3:0x0c
    v_and_b32 v125, 0xffff0000, v20
    v_lshlrev_b32 v126, 16, v21
    v_mul_f32 v122, v114, v122
    v_and_b32 v127, 0xffff0000, v21
    v_add_u32 v123, v123, v123
    v_pk_fma_f32 v[124:125], v[124:125], v[122:123], s[34:35] op_sel_hi:[1,0,1]
    v_pk_fma_f32 v[126:127], v[126:127], v[122:123], s[34:35] op_sel_hi:[1,0,1]
    v_lshl_add_u32 v124, v125, 16, v124
    v_lshl_add_u32 v125, v127, 16, v126
    s_waitcnt lgkmcnt(2)
    v_bitop3_b32 v115, v115, v118, v119 bitop3:0xfe
    v_lshl_add_u64 v[124:125], v[124:125], 0, s[36:37]
    v_cmpx_le_u32 vcc, 0x1000000, v58
    ds_add_rtn_u64 v[118:119], v123, v[124:125] offset:54272
    s_mov_b64 exec, -1
    v_ashrrev_i32 v122, 5, v59
    v_lshlrev_b16 v123, 2, v59
    v_lshlrev_b32 v124, 16, v22
    v_bitop3_b32 v122, v122, v113, v113 bitop3:0x0c
    v_and_b32 v125, 0xffff0000, v22
    v_lshlrev_b32 v126, 16, v23
    v_mul_f32 v122, v114, v122
    v_and_b32 v127, 0xffff0000, v23
    v_add_u32 v123, v123, v123
    v_pk_fma_f32 v[124:125], v[124:125], v[122:123], s[34:35] op_sel_hi:[1,0,1]
    v_pk_fma_f32 v[126:127], v[126:127], v[122:123], s[34:35] op_sel_hi:[1,0,1]
    v_lshl_add_u32 v124, v125, 16, v124
    v_lshl_add_u32 v125, v127, 16, v126
    s_waitcnt lgkmcnt(2)
    v_bitop3_b32 v115, v115, v120, v121 bitop3:0xfe
    v_lshl_add_u64 v[124:125], v[124:125], 0, s[36:37]
    v_cmpx_le_u32 vcc, 0x1000000, v59
    ds_add_rtn_u64 v[120:121], v123, v[124:125] offset:54272
    s_mov_b64 exec, -1
    s_waitcnt lgkmcnt(15)
    v_ashrrev_i32 v122, 5, v60
    v_lshlrev_b16 v123, 2, v60
    v_lshlrev_b32 v124, 16, v24
    v_bitop3_b32 v122, v122, v113, v113 bitop3:0x0c
    v_and_b32 v125, 0xffff0000, v24
    v_lshlrev_b32 v126, 16, v25
    v_mul_f32 v122, v114, v122
    v_and_b32 v127, 0xffff0000, v25
    v_add_u32 v123, v123, v123
    v_pk_fma_f32 v[124:125], v[124:125], v[122:123], s[34:35] op_sel_hi:[1,0,1]
    v_pk_fma_f32 v[126:127], v[126:127], v[122:123], s[34:35] op_sel_hi:[1,0,1]
    v_lshl_add_u32 v124, v125, 16, v124
    v_lshl_add_u32 v125, v127, 16, v126
    s_waitcnt lgkmcnt(2)
    v_bitop3_b32 v115, v115, v116, v117 bitop3:0xfe
    v_lshl_add_u64 v[124:125], v[124:125], 0, s[36:37]
    v_cmpx_le_u32 vcc, 0x1000000, v60
    ds_add_rtn_u64 v[116:117], v123, v[124:125] offset:54272
    s_mov_b64 exec, -1
    v_ashrrev_i32 v122, 5, v61
    v_lshlrev_b16 v123, 2, v61
    v_lshlrev_b32 v124, 16, v26
    v_bitop3_b32 v122, v122, v113, v113 bitop3:0x0c
    v_and_b32 v125, 0xffff0000, v26
    v_lshlrev_b32 v126, 16, v27
    v_mul_f32 v122, v114, v122
    v_and_b32 v127, 0xffff0000, v27
    v_add_u32 v123, v123, v123
    v_pk_fma_f32 v[124:125], v[124:125], v[122:123], s[34:35] op_sel_hi:[1,0,1]
    v_pk_fma_f32 v[126:127], v[126:127], v[122:123], s[34:35] op_sel_hi:[1,0,1]
    v_lshl_add_u32 v124, v125, 16, v124
    v_lshl_add_u32 v125, v127, 16, v126
    s_waitcnt lgkmcnt(2)
    v_bitop3_b32 v115, v115, v118, v119 bitop3:0xfe
    v_lshl_add_u64 v[124:125], v[124:125], 0, s[36:37]
    v_cmpx_le_u32 vcc, 0x1000000, v61
    ds_add_rtn_u64 v[118:119], v123, v[124:125] offset:54272
    s_mov_b64 exec, -1
    v_ashrrev_i32 v122, 5, v62
    v_lshlrev_b16 v123, 2, v62
    v_lshlrev_b32 v124, 16, v28
    v_bitop3_b32 v122, v122, v113, v113 bitop3:0x0c
    v_and_b32 v125, 0xffff0000, v28
    v_lshlrev_b32 v126, 16, v29
    v_mul_f32 v122, v114, v122
    v_and_b32 v127, 0xffff0000, v29
    v_add_u32 v123, v123, v123
    v_pk_fma_f32 v[124:125], v[124:125], v[122:123], s[34:35] op_sel_hi:[1,0,1]
    v_pk_fma_f32 v[126:127], v[126:127], v[122:123], s[34:35] op_sel_hi:[1,0,1]
    v_lshl_add_u32 v124, v125, 16, v124
    v_lshl_add_u32 v125, v127, 16, v126
    s_waitcnt lgkmcnt(2)
    v_bitop3_b32 v115, v115, v120, v121 bitop3:0xfe
    v_lshl_add_u64 v[124:125], v[124:125], 0, s[36:37]
    v_cmpx_le_u32 vcc, 0x1000000, v62
    ds_add_rtn_u64 v[120:121], v123, v[124:125] offset:54272
    s_mov_b64 exec, -1
    s_waitcnt lgkmcnt(15)
    v_ashrrev_i32 v122, 5, v63
    v_lshlrev_b16 v123, 2, v63
    v_lshlrev_b32 v124, 16, v30
    v_bitop3_b32 v122, v122, v113, v113 bitop3:0x0c
    v_and_b32 v125, 0xffff0000, v30
    v_lshlrev_b32 v126, 16, v31
    v_mul_f32 v122, v114, v122
    v_and_b32 v127, 0xffff0000, v31
    v_add_u32 v123, v123, v123
    v_pk_fma_f32 v[124:125], v[124:125], v[122:123], s[34:35] op_sel_hi:[1,0,1]
    v_pk_fma_f32 v[126:127], v[126:127], v[122:123], s[34:35] op_sel_hi:[1,0,1]
    v_lshl_add_u32 v124, v125, 16, v124
    v_lshl_add_u32 v125, v127, 16, v126
    s_waitcnt lgkmcnt(2)
    v_bitop3_b32 v115, v115, v116, v117 bitop3:0xfe
    v_lshl_add_u64 v[124:125], v[124:125], 0, s[36:37]
    v_cmpx_le_u32 vcc, 0x1000000, v63
    ds_add_rtn_u64 v[116:117], v123, v[124:125] offset:54272
    s_mov_b64 exec, -1
    v_ashrrev_i32 v122, 5, v64
    v_lshlrev_b16 v123, 2, v64
    v_lshlrev_b32 v124, 16, v32
    v_bitop3_b32 v122, v122, v113, v113 bitop3:0x0c
    v_and_b32 v125, 0xffff0000, v32
    v_lshlrev_b32 v126, 16, v33
    v_mul_f32 v122, v114, v122
    v_and_b32 v127, 0xffff0000, v33
    v_add_u32 v123, v123, v123
    v_pk_fma_f32 v[124:125], v[124:125], v[122:123], s[34:35] op_sel_hi:[1,0,1]
    v_pk_fma_f32 v[126:127], v[126:127], v[122:123], s[34:35] op_sel_hi:[1,0,1]
    v_lshl_add_u32 v124, v125, 16, v124
    v_lshl_add_u32 v125, v127, 16, v126
    s_waitcnt lgkmcnt(2)
    v_bitop3_b32 v115, v115, v118, v119 bitop3:0xfe
    v_lshl_add_u64 v[124:125], v[124:125], 0, s[36:37]
    v_cmpx_le_u32 vcc, 0x1000000, v64
    ds_add_rtn_u64 v[118:119], v123, v[124:125] offset:54272
    s_mov_b64 exec, -1
    v_ashrrev_i32 v122, 5, v65
    v_lshlrev_b16 v123, 2, v65
    v_lshlrev_b32 v124, 16, v34
    v_bitop3_b32 v122, v122, v113, v113 bitop3:0x0c
    v_and_b32 v125, 0xffff0000, v34
    v_lshlrev_b32 v126, 16, v35
    v_mul_f32 v122, v114, v122
    v_and_b32 v127, 0xffff0000, v35
    v_add_u32 v123, v123, v123
    v_pk_fma_f32 v[124:125], v[124:125], v[122:123], s[34:35] op_sel_hi:[1,0,1]
    v_pk_fma_f32 v[126:127], v[126:127], v[122:123], s[34:35] op_sel_hi:[1,0,1]
    v_lshl_add_u32 v124, v125, 16, v124
    v_lshl_add_u32 v125, v127, 16, v126
    s_waitcnt lgkmcnt(2)
    v_bitop3_b32 v115, v115, v120, v121 bitop3:0xfe
    v_lshl_add_u64 v[124:125], v[124:125], 0, s[36:37]
    v_cmpx_le_u32 vcc, 0x1000000, v65
    ds_add_rtn_u64 v[120:121], v123, v[124:125] offset:54272
    s_mov_b64 exec, -1
    s_waitcnt lgkmcnt(15)
    v_ashrrev_i32 v122, 5, v66
    v_lshlrev_b16 v123, 2, v66
    v_lshlrev_b32 v124, 16, v36
    v_bitop3_b32 v122, v122, v113, v113 bitop3:0x0c
    v_and_b32 v125, 0xffff0000, v36
    v_lshlrev_b32 v126, 16, v37
    v_mul_f32 v122, v114, v122
    v_and_b32 v127, 0xffff0000, v37
    v_add_u32 v123, v123, v123
    v_pk_fma_f32 v[124:125], v[124:125], v[122:123], s[34:35] op_sel_hi:[1,0,1]
    v_pk_fma_f32 v[126:127], v[126:127], v[122:123], s[34:35] op_sel_hi:[1,0,1]
    v_lshl_add_u32 v124, v125, 16, v124
    v_lshl_add_u32 v125, v127, 16, v126
    s_waitcnt lgkmcnt(2)
    v_bitop3_b32 v115, v115, v116, v117 bitop3:0xfe
    v_lshl_add_u64 v[124:125], v[124:125], 0, s[36:37]
    v_cmpx_le_u32 vcc, 0x1000000, v66
    ds_add_rtn_u64 v[116:117], v123, v[124:125] offset:54272
    s_mov_b64 exec, -1
    v_ashrrev_i32 v122, 5, v67
    v_lshlrev_b16 v123, 2, v67
    v_lshlrev_b32 v124, 16, v38
    v_bitop3_b32 v122, v122, v113, v113 bitop3:0x0c
    v_and_b32 v125, 0xffff0000, v38
    v_lshlrev_b32 v126, 16, v39
    v_mul_f32 v122, v114, v122
    v_and_b32 v127, 0xffff0000, v39
    v_add_u32 v123, v123, v123
    v_pk_fma_f32 v[124:125], v[124:125], v[122:123], s[34:35] op_sel_hi:[1,0,1]
    v_pk_fma_f32 v[126:127], v[126:127], v[122:123], s[34:35] op_sel_hi:[1,0,1]
    v_lshl_add_u32 v124, v125, 16, v124
    v_lshl_add_u32 v125, v127, 16, v126
    s_waitcnt lgkmcnt(2)
    v_bitop3_b32 v115, v115, v118, v119 bitop3:0xfe
    v_lshl_add_u64 v[124:125], v[124:125], 0, s[36:37]
    v_cmpx_le_u32 vcc, 0x1000000, v67
    ds_add_rtn_u64 v[118:119], v123, v[124:125] offset:54272
    s_mov_b64 exec, -1
    v_ashrrev_i32 v122, 5, v68
    v_lshlrev_b16 v123, 2, v68
    v_lshlrev_b32 v124, 16, v40
    v_bitop3_b32 v122, v122, v113, v113 bitop3:0x0c
    v_and_b32 v125, 0xffff0000, v40
    v_lshlrev_b32 v126, 16, v41
    v_mul_f32 v122, v114, v122
    v_and_b32 v127, 0xffff0000, v41
    v_add_u32 v123, v123, v123
    v_pk_fma_f32 v[124:125], v[124:125], v[122:123], s[34:35] op_sel_hi:[1,0,1]
    v_pk_fma_f32 v[126:127], v[126:127], v[122:123], s[34:35] op_sel_hi:[1,0,1]
    v_lshl_add_u32 v124, v125, 16, v124
    v_lshl_add_u32 v125, v127, 16, v126
    s_waitcnt lgkmcnt(2)
    v_bitop3_b32 v115, v115, v120, v121 bitop3:0xfe
    v_lshl_add_u64 v[124:125], v[124:125], 0, s[36:37]
    v_cmpx_le_u32 vcc, 0x1000000, v68
    ds_add_rtn_u64 v[120:121], v123, v[124:125] offset:54272
    s_mov_b64 exec, -1
    s_cmp_le_u32 s15, 7
    s_cbranch_scc1 p2_nad0
    s_waitcnt lgkmcnt(15)
    v_ashrrev_i32 v122, 5, v69
    v_lshlrev_b16 v123, 2, v69
    v_lshlrev_b32 v124, 16, v42
    v_bitop3_b32 v122, v122, v113, v113 bitop3:0x0c
    v_and_b32 v125, 0xffff0000, v42
    v_lshlrev_b32 v126, 16, v43
    v_mul_f32 v122, v114, v122
    v_and_b32 v127, 0xffff0000, v43
    v_add_u32 v123, v123, v123
    v_pk_fma_f32 v[124:125], v[124:125], v[122:123], s[34:35] op_sel_hi:[1,0,1]
    v_pk_fma_f32 v[126:127], v[126:127], v[122:123], s[34:35] op_sel_hi:[1,0,1]
    v_lshl_add_u32 v124, v125, 16, v124
    v_lshl_add_u32 v125, v127, 16, v126
    s_waitcnt lgkmcnt(2)
    v_bitop3_b32 v115, v115, v116, v117 bitop3:0xfe
    v_lshl_add_u64 v[124:125], v[124:125], 0, s[36:37]
    v_cmpx_le_u32 vcc, 0x1000000, v69
    ds_add_rtn_u64 v[116:117], v123, v[124:125] offset:54272
    s_mov_b64 exec, -1
    v_ashrrev_i32 v122, 5, v70
    v_lshlrev_b16 v123, 2, v70
    v_lshlrev_b32 v124, 16, v44
    v_bitop3_b32 v122, v122, v113, v113 bitop3:0x0c
    v_and_b32 v125, 0xffff0000, v44
    v_lshlrev_b32 v126, 16, v45
    v_mul_f32 v122, v114, v122
    v_and_b32 v127, 0xffff0000, v45
    v_add_u32 v123, v123, v123
    v_pk_fma_f32 v[124:125], v[124:125], v[122:123], s[34:35] op_sel_hi:[1,0,1]
    v_pk_fma_f32 v[126:127], v[126:127], v[122:123], s[34:35] op_sel_hi:[1,0,1]
    v_lshl_add_u32 v124, v125, 16, v124
    v_lshl_add_u32 v125, v127, 16, v126
    s_waitcnt lgkmcnt(2)
    v_bitop3_b32 v115, v115, v118, v119 bitop3:0xfe
    v_lshl_add_u64 v[124:125], v[124:125], 0, s[36:37]
    v_cmpx_le_u32 vcc, 0x1000000, v70
    ds_add_rtn_u64 v[118:119], v123, v[124:125] offset:54272
    s_mov_b64 exec, -1
    v_ashrrev_i32 v122, 5, v71
    v_lshlrev_b16 v123, 2, v71
    v_lshlrev_b32 v124, 16, v46
    v_bitop3_b32 v122, v122, v113, v113 bitop3:0x0c
    v_and_b32 v125, 0xffff0000, v46
    v_lshlrev_b32 v126, 16, v47
    v_mul_f32 v122, v114, v122
    v_and_b32 v127, 0xffff0000, v47
    v_add_u32 v123, v123, v123
    v_pk_fma_f32 v[124:125], v[124:125], v[122:123], s[34:35] op_sel_hi:[1,0,1]
    v_pk_fma_f32 v[126:127], v[126:127], v[122:123], s[34:35] op_sel_hi:[1,0,1]
    v_lshl_add_u32 v124, v125, 16, v124
    v_lshl_add_u32 v125, v127, 16, v126
    s_waitcnt lgkmcnt(2)
    v_bitop3_b32 v115, v115, v120, v121 bitop3:0xfe
    v_lshl_add_u64 v[124:125], v[124:125], 0, s[36:37]
    v_cmpx_le_u32 vcc, 0x1000000, v71
    ds_add_rtn_u64 v[120:121], v123, v[124:125] offset:54272
    s_mov_b64 exec, -1
p2_nad0:
    s_branch p2_fin
p2_topf:
    s_cmp_eq_u32 s60, 10
    s_cbranch_scc1 p2_drain1
    v_cmpx_gt_i16 vcc, 0, v48
    ds_read_b64 v[0:1], v0
    s_mov_b64 exec, -1
    v_cmpx_gt_i16 vcc, 0, v49
    ds_read_b64 v[2:3], v2
    s_mov_b64 exec, -1
    v_cmpx_gt_i16 vcc, 0, v50
    ds_read_b64 v[4:5], v4
    s_mov_b64 exec, -1
    v_cmpx_gt_i16 vcc, 0, v51
    ds_read_b64 v[6:7], v6
    s_mov_b64 exec, -1
    v_cmpx_gt_i16 vcc, 0, v52
    ds_read_b64 v[8:9], v8
    s_mov_b64 exec, -1
    v_cmpx_gt_i16 vcc, 0, v53
    ds_read_b64 v[10:11], v10
    s_mov_b64 exec, -1
    v_cmpx_gt_i16 vcc, 0, v54
    ds_read_b64 v[12:13], v12
    s_mov_b64 exec, -1
    v_cmpx_gt_i16 vcc, 0, v55
    ds_read_b64 v[14:15], v14
    s_mov_b64 exec, -1
    v_cmpx_gt_i16 vcc, 0, v56
    ds_read_b64 v[16:17], v16
    s_mov_b64 exec, -1
    v_cmpx_gt_i16 vcc, 0, v57
    ds_read_b64 v[18:19], v18
    s_mov_b64 exec, -1
    v_cmpx_gt_i16 vcc, 0, v58
    ds_read_b64 v[20:21], v20
    s_mov_b64 exec, -1
    v_cmpx_gt_i16 vcc, 0, v59
    ds_read_b64 v[22:23], v22
    s_mov_b64 exec, -1
    s_cmp_ge_u32 s10, 9
    s_cbranch_scc1 p2_nm1m0a
    v_lshrrev_b32 v84, 1, v112
    s_add_u32 s44, s20, s42
    buffer_load_dwordx2 v[84:85], v84, s[4:7], s44 offen
p2_nm1m0a:
    buffer_load_dwordx4 v[72:75], v112, s[4:7], s20 offen offset:0
    buffer_load_dwordx4 v[76:79], v112, s[4:7], s20 offen offset:1024
    buffer_load_dwordx4 v[80:83], v112, s[4:7], s20 offen offset:2048
    v_cmpx_gt_i16 vcc, 0, v60
    ds_read_b64 v[24:25], v24
    s_mov_b64 exec, -1
    v_cmpx_gt_i16 vcc, 0, v61
    ds_read_b64 v[26:27], v26
    s_mov_b64 exec, -1
    v_cmpx_gt_i16 vcc, 0, v62
    ds_read_b64 v[28:29], v28
    s_mov_b64 exec, -1
    v_cmpx_gt_i16 vcc, 0, v63
    ds_read_b64 v[30:31], v30
    s_mov_b64 exec, -1
    v_cmpx_gt_i16 vcc, 0, v64
    ds_read_b64 v[32:33], v32
    s_mov_b64 exec, -1
    v_cmpx_gt_i16 vcc, 0, v65
    ds_read_b64 v[34:35], v34
    s_mov_b64 exec, -1
    v_cmpx_gt_i16 vcc, 0, v66
    ds_read_b64 v[36:37], v36
    s_mov_b64 exec, -1
    v_cmpx_gt_i16 vcc, 0, v67
    ds_read_b64 v[38:39], v38
    s_mov_b64 exec, -1
    v_cmpx_gt_i16 vcc, 0, v68
    ds_read_b64 v[40:41], v40
    s_mov_b64 exec, -1
    s_cmp_le_u32 s15, 7
    s_cbranch_scc1 p2_g1r27
    v_cmpx_gt_i16 vcc, 0, v69
    ds_read_b64 v[42:43], v42
    s_mov_b64 exec, -1
    v_cmpx_gt_i16 vcc, 0, v70
    ds_read_b64 v[44:45], v44
    s_mov_b64 exec, -1
    v_cmpx_gt_i16 vcc, 0, v71
    ds_read_b64 v[46:47], v46
    s_mov_b64 exec, -1
p2_g1r27:
    s_waitcnt lgkmcnt(15)
    v_ashrrev_i32 v122, 5, v48
    v_lshlrev_b16 v123, 2, v48
    v_cndmask_b32 v126, v0, v1, s[66:67]
    v_bitop3_b32 v122, v122, v113, v113 bitop3:0x0c
    v_lshlrev_b32 v124, 16, v126
    v_mul_f32 v122, v114, v122
    v_and_b32 v125, 0xffff0000, v126
    v_add_u32 v123, v123, v123
    v_mul_f32 v124, v122, v124
    v_mul_f32 v125, v122, v125
    v_cmpx_le_u32 vcc, 0x1000000, v48
    ds_add_f32 v123, v124 offset:54272
    ds_add_f32 v123, v125 offset:54276
    s_mov_b64 exec, -1
    v_ashrrev_i32 v122, 5, v49
    v_lshlrev_b16 v123, 2, v49
    v_cndmask_b32 v126, v2, v3, s[66:67]
    v_bitop3_b32 v122, v122, v113, v113 bitop3:0x0c
    v_lshlrev_b32 v124, 16, v126
    v_mul_f32 v122, v114, v122
    v_and_b32 v125, 0xffff0000, v126
    v_add_u32 v123, v123, v123
    v_mul_f32 v124, v122, v124
    v_mul_f32 v125, v122, v125
    v_cmpx_le_u32 vcc, 0x1000000, v49
    ds_add_f32 v123, v124 offset:54272
    ds_add_f32 v123, v125 offset:54276
    s_mov_b64 exec, -1
    v_ashrrev_i32 v122, 5, v50
    v_lshlrev_b16 v123, 2, v50
    v_cndmask_b32 v126, v4, v5, s[66:67]
    v_bitop3_b32 v122, v122, v113, v113 bitop3:0x0c
    v_lshlrev_b32 v124, 16, v126
    v_mul_f32 v122, v114, v122
    v_and_b32 v125, 0xffff0000, v126
    v_add_u32 v123, v123, v123
    v_mul_f32 v124, v122, v124
    v_mul_f32 v125, v122, v125
    v_cmpx_le_u32 vcc, 0x1000000, v50
    ds_add_f32 v123, v124 offset:54272
    ds_add_f32 v123, v125 offset:54276
    s_mov_b64 exec, -1
    v_lshrrev_b32 v0, 3, v102
    v_lshrrev_b32 v1, 18, v102
    v_and_b32 v102, 0x3fff, v102
    v_and_or_b32 v0, v0, s65, v1
    v_mad_u32_u24 v102, v0, s63, v102
    buffer_load_dwordx4 v[0:3], v102, s[68:71], 0 offen
    s_waitcnt lgkmcnt(15)
    v_ashrrev_i32 v122, 5, v51
    v_lshlrev_b16 v123, 2, v51
    v_cndmask_b32 v126, v6, v7, s[66:67]
    v_bitop3_b32 v122, v122, v113, v113 bitop3:0x0c
    v_lshlrev_b32 v124, 16, v126
    v_mul_f32 v122, v114, v122
    v_and_b32 v125, 0xffff0000, v126
    v_add_u32 v123, v123, v123
    v_mul_f32 v124, v122, v124
    v_mul_f32 v125, v122, v125
    v_cmpx_le_u32 vcc, 0x1000000, v51
    ds_add_f32 v123, v124 offset:54272
    ds_add_f32 v123, v125 offset:54276
    s_mov_b64 exec, -1
    v_ashrrev_i32 v122, 5, v52
    v_lshlrev_b16 v123, 2, v52
    v_cndmask_b32 v126, v8, v9, s[66:67]
    v_bitop3_b32 v122, v122, v113, v113 bitop3:0x0c
    v_lshlrev_b32 v124, 16, v126
    v_mul_f32 v122, v114, v122
    v_and_b32 v125, 0xffff0000, v126
    v_add_u32 v123, v123, v123
    v_mul_f32 v124, v122, v124
    v_mul_f32 v125, v122, v125
    v_cmpx_le_u32 vcc, 0x1000000, v52
    ds_add_f32 v123, v124 offset:54272
    ds_add_f32 v123, v125 offset:54276
    s_mov_b64 exec, -1
    v_ashrrev_i32 v122, 5, v53
    v_lshlrev_b16 v123, 2, v53
    v_cndmask_b32 v126, v10, v11, s[66:67]
    v_bitop3_b32 v122, v122, v113, v113 bitop3:0x0c
    v_lshlrev_b32 v124, 16, v126
    v_mul_f32 v122, v114, v122
    v_and_b32 v125, 0xffff0000, v126
    v_add_u32 v123, v123, v123
    v_mul_f32 v124, v122, v124
    v_mul_f32 v125, v122, v125
    v_cmpx_le_u32 vcc, 0x1000000, v53
    ds_add_f32 v123, v124 offset:54272
    ds_add_f32 v123, v125 offset:54276
    s_mov_b64 exec, -1
    v_lshrrev_b32 v6, 3, v103
    v_lshrrev_b32 v7, 18, v103
    v_and_b32 v103, 0x3fff, v103
    v_and_or_b32 v6, v6, s65, v7
    v_mad_u32_u24 v103, v6, s63, v103
    buffer_load_dwordx4 v[6:9], v103, s[68:71], 0 offen
    s_waitcnt lgkmcnt(12)
    s_barrier
    s_waitcnt lgkmcnt(15)
    v_ashrrev_i32 v122, 5, v54
    v_lshlrev_b16 v123, 2, v54
    v_cndmask_b32 v126, v12, v13, s[66:67]
    v_bitop3_b32 v122, v122, v113, v113 bitop3:0x0c
    v_lshlrev_b32 v124, 16, v126
    v_mul_f32 v122, v114, v122
    v_and_b32 v125, 0xffff0000, v126
    v_add_u32 v123, v123, v123
    v_mul_f32 v124, v122, v124
    v_mul_f32 v125, v122, v125
    v_cmpx_le_u32 vcc, 0x1000000, v54
    ds_add_f32 v123, v124 offset:54272
    ds_add_f32 v123, v125 offset:54276
    s_mov_b64 exec, -1
    v_ashrrev_i32 v122, 5, v55
    v_lshlrev_b16 v123, 2, v55
    v_cndmask_b32 v126, v14, v15, s[66:67]
    v_bitop3_b32 v122, v122, v113, v113 bitop3:0x0c
    v_lshlrev_b32 v124, 16, v126
    v_mul_f32 v122, v114, v122
    v_and_b32 v125, 0xffff0000, v126
    v_add_u32 v123, v123, v123
    v_mul_f32 v124, v122, v124
    v_mul_f32 v125, v122, v125
    v_cmpx_le_u32 vcc, 0x1000000, v55
    ds_add_f32 v123, v124 offset:54272
    ds_add_f32 v123, v125 offset:54276
    s_mov_b64 exec, -1
    v_ashrrev_i32 v122, 5, v56
    v_lshlrev_b16 v123, 2, v56
    v_cndmask_b32 v126, v16, v17, s[66:67]
    v_bitop3_b32 v122, v122, v113, v113 bitop3:0x0c
    v_lshlrev_b32 v124, 16, v126
    v_mul_f32 v122, v114, v122
    v_and_b32 v125, 0xffff0000, v126
    v_add_u32 v123, v123, v123
    v_mul_f32 v124, v122, v124
    v_mul_f32 v125, v122, v125
    v_cmpx_le_u32 vcc, 0x1000000, v56
    ds_add_f32 v123, v124 offset:54272
    ds_add_f32 v123, v125 offset:54276
    s_mov_b64 exec, -1
    v_lshrrev_b32 v12, 3, v104
    v_lshrrev_b32 v13, 18, v104
    v_and_b32 v104, 0x3fff, v104
    v_and_or_b32 v12, v12, s65, v13
    v_mad_u32_u24 v104, v12, s63, v104
    buffer_load_dwordx4 v[12:15], v104, s[68:71], 0 offen
    s_waitcnt lgkmcnt(15)
    v_ashrrev_i32 v122, 5, v57
    v_lshlrev_b16 v123, 2, v57
    v_cndmask_b32 v126, v18, v19, s[66:67]
    v_bitop3_b32 v122, v122, v113, v113 bitop3:0x0c
    v_lshlrev_b32 v124, 16, v126
    v_mul_f32 v122, v114, v122
    v_and_b32 v125, 0xffff0000, v126
    v_add_u32 v123, v123, v123
    v_mul_f32 v124, v122, v124
    v_mul_f32 v125, v122, v125
    v_cmpx_le_u32 vcc, 0x1000000, v57
    ds_add_f32 v123, v124 offset:54272
    ds_add_f32 v123, v125 offset:54276
    s_mov_b64 exec, -1
    v_ashrrev_i32 v122, 5, v58
    v_lshlrev_b16 v123, 2, v58
    v_cndmask_b32 v126, v20, v21, s[66:67]
    v_bitop3_b32 v122, v122, v113, v113 bitop3:0x0c
    v_lshlrev_b32 v124, 16, v126
    v_mul_f32 v122, v114, v122
    v_and_b32 v125, 0xffff0000, v126
    v_add_u32 v123, v123, v123
    v_mul_f32 v124, v122, v124
    v_mul_f32 v125, v122, v125
    v_cmpx_le_u32 vcc, 0x1000000, v58
    ds_add_f32 v123, v124 offset:54272
    ds_add_f32 v123, v125 offset:54276
    s_mov_b64 exec, -1
    v_ashrrev_i32 v122, 5, v59
    v_lshlrev_b16 v123, 2, v59
    v_cndmask_b32 v126, v22, v23, s[66:67]
    v_bitop3_b32 v122, v122, v113, v113 bitop3:0x0c
    v_lshlrev_b32 v124, 16, v126
    v_mul_f32 v122, v114, v122
    v_and_b32 v125, 0xffff0000, v126
    v_add_u32 v123, v123, v123
    v_mul_f32 v124, v122, v124
    v_mul_f32 v125, v122, v125
    v_cmpx_le_u32 vcc, 0x1000000, v59
    ds_add_f32 v123, v124 offset:54272
    ds_add_f32 v123, v125 offset:54276
    s_mov_b64 exec, -1
    v_lshrrev_b32 v18, 3, v105
    v_lshrrev_b32 v19, 18, v105
    v_and_b32 v105, 0x3fff, v105
    v_and_or_b32 v18, v18, s65, v19
    v_mad_u32_u24 v105, v18, s63, v105
    buffer_load_dwordx4 v[18:21], v105, s[68:71], 0 offen
    s_mov_b32 m0, s23
    v_mov_b32 v53, 0x3c000
    s_movk_i32 s44, 512
    v_sub_u32_sdwa v4, v111, v110 dst_sel:DWORD dst_unused:UNUSED_PAD src0_sel:WORD_0 src1_sel:WORD_0
    v_sub_u32_sdwa v5, v111, v110 dst_sel:DWORD dst_unused:UNUSED_PAD src0_sel:WORD_1 src1_sel:WORD_1
    v_med3_i32 v4, v4, 0, s44
    v_med3_i32 v5, v5, 0, s44
    v_add_u32 v48, v4, v5
    ds_write_addtid_b32 v53 offset:0
    ds_write_addtid_b32 v53 offset:256
    ds_write_addtid_b32 v53 offset:512
    ds_write_addtid_b32 v53 offset:768
    ds_write_addtid_b32 v53 offset:1024
    ds_write_addtid_b32 v53 offset:1280
    ds_write_addtid_b32 v53 offset:1536
    ds_write_addtid_b32 v53 offset:1792
    v_lshl_add_u32 v53, v112, 15, s41
    s_nop 1
    v_add_u32_dpp v48, v48, v48 row_shr:1 row_mask:0xf bank_mask:0xf bound_ctrl:0
    s_nop 1
    v_add_u32_dpp v48, v48, v48 row_shr:2 row_mask:0xf bank_mask:0xf bound_ctrl:0
    s_nop 1
    v_add_u32_dpp v48, v48, v48 row_shr:4 row_mask:0xf bank_mask:0xf bound_ctrl:0
    s_nop 1
    v_add_u32_dpp v48, v48, v48 row_shr:8 row_mask:0xf bank_mask:0xf bound_ctrl:0
    s_nop 1
    v_add_u32_dpp v48, v48, v48 row_bcast:15 row_mask:0xa bank_mask:0xf
    s_nop 1
    v_add_u32_dpp v48, v48, v48 row_bcast:31 row_mask:0xc bank_mask:0xf
    s_nop 1
    s_nop 0
    v_readlane_b32 s38, v48, 63
    v_sub_u32 v50, v48, v5
    v_sub_u32 v49, v50, v4
    v_sub_u32 v10, 512, v49
    v_mad_u32_u16 v51, v110, 16, v53
    v_med3_i32 v10, v10, 0, v4
    v_lshl_add_u32 v49, v49, 2, s23
    v_sub_u32 v11, 512, v50
    v_mad_u32_u16 v52, v110, 16, v53 op_sel:[1,0,0,0]
    v_med3_i32 v11, v11, 0, v5
    v_lshl_add_u32 v50, v50, 2, s23
    v_lshl_add_u32 v48, v11, 16, v10
    v_add_u32 v52, 262144, v52
    v_add_u32 v110, v110, v48
    s_min_u32 s17, s38, 512
    s_add_u32 s17, s17, 63
    s_lshr_b32 s17, s17, 6
p2_x1x_0:
    v_cmpx_lt_i32 vcc, 0, v10
    s_cbranch_execz p2_y1x_0
    ds_write_b32 v49, v51 offset:0
    v_add_u32 v51, 16, v51
    v_cmpx_lt_i32 vcc, 1, v10
    s_cbranch_execz p2_y1x_0
    ds_write_b32 v49, v51 offset:4
    v_add_u32 v51, 16, v51
    v_cmpx_lt_i32 vcc, 2, v10
    s_cbranch_execz p2_y1x_0
    ds_write_b32 v49, v51 offset:8
    v_add_u32 v51, 16, v51
    v_cmpx_lt_i32 vcc, 3, v10
    s_cbranch_execz p2_y1x_0
    ds_write_b32 v49, v51 offset:12
    v_add_u32 v51, 16, v51
    v_cmpx_lt_i32 vcc, 4, v10
    s_cbranch_execz p2_y1x_0
    ds_write_b32 v49, v51 offset:16
    v_add_u32 v51, 16, v51
    v_cmpx_lt_i32 vcc, 5, v10
    s_cbranch_execz p2_y1x_0
    ds_write_b32 v49, v51 offset:20
    v_add_u32 v51, 16, v51
    v_cmpx_lt_i32 vcc, 6, v10
    s_cbranch_execz p2_y1x_0
    ds_write_b32 v49, v51 offset:24
    v_add_u32 v51, 16, v51
    v_cmpx_lt_i32 vcc, 7, v10
    s_cbranch_execz p2_y1x_0
    ds_write_b32 v49, v51 offset:28
    v_add_u32 v51, 16, v51
    v_subrev_u32 v10, 8, v10
    v_add_u32 v49, 32, v49
    s_branch p2_x1x_0
p2_y1x_0:
    s_mov_b64 exec, -1
p2_x1x_1:
    v_cmpx_lt_i32 vcc, 0, v11
    s_cbranch_execz p2_y1x_1
    ds_write_b32 v50, v52 offset:0
    v_add_u32 v52, 16, v52
    v_cmpx_lt_i32 vcc, 1, v11
    s_cbranch_execz p2_y1x_1
    ds_write_b32 v50, v52 offset:4
    v_add_u32 v52, 16, v52
    v_cmpx_lt_i32 vcc, 2, v11
    s_cbranch_execz p2_y1x_1
    ds_write_b32 v50, v52 offset:8
    v_add_u32 v52, 16, v52
    v_cmpx_lt_i32 vcc, 3, v11
    s_cbranch_execz p2_y1x_1
    ds_write_b32 v50, v52 offset:12
    v_add_u32 v52, 16, v52
    v_cmpx_lt_i32 vcc, 4, v11
    s_cbranch_execz p2_y1x_1
    ds_write_b32 v50, v52 offset:16
    v_add_u32 v52, 16, v52
    v_cmpx_lt_i32 vcc, 5, v11
    s_cbranch_execz p2_y1x_1
    ds_write_b32 v50, v52 offset:20
    v_add_u32 v52, 16, v52
    v_cmpx_lt_i32 vcc, 6, v11
    s_cbranch_execz p2_y1x_1
    ds_write_b32 v50, v52 offset:24
    v_add_u32 v52, 16, v52
    v_cmpx_lt_i32 vcc, 7, v11
    s_cbranch_execz p2_y1x_1
    ds_write_b32 v50, v52 offset:28
    v_add_u32 v52, 16, v52
    v_subrev_u32 v11, 8, v11
    v_add_u32 v50, 32, v50
    s_branch p2_x1x_1
p2_y1x_1:
    s_mov_b64 exec, -1
    s_cmp_lt_u32 s38, 512
    s_cbranch_scc1 p2_nomore1x
    v_cmp_lt_u32_sdwa s[44:45], v110, v111 src0_sel:WORD_0 src1_sel:WORD_0
    v_cmp_lt_u32_sdwa s[46:47], v110, v111 src0_sel:WORD_1 src1_sel:WORD_1
    s_nop 0
    s_or_b64 s[44:45], s[44:45], s[46:47]
    s_cbranch_scc0 p2_nomore1x
    v_mov_b32 v49, s19
    v_mov_b32 v50, 1
    ds_write_b32 v49, v50 offset:53760
p2_nomore1x:
    s_mov_b32 m0, s23
    s_nop 0
    ds_read_addtid_b32 v102 offset:0
    ds_read_addtid_b32 v103 offset:256
    ds_read_addtid_b32 v104 offset:512
    ds_read_addtid_b32 v105 offset:768
    ds_read_addtid_b32 v106 offset:1024
    ds_read_addtid_b32 v107 offset:1280
    ds_read_addtid_b32 v108 offset:1536
    ds_read_addtid_b32 v109 offset:1792
    s_waitcnt vmcnt(4)
    s_mov_b32 m0, s24
    s_cmp_ge_u32 s10, 9
    s_cbranch_scc1 p2_st1s0
    ds_write_addtid_b32 v84 offset:49152
    ds_write_addtid_b32 v85 offset:49408
p2_st1s0:
    s_mov_b32 m0, s23
    s_add_u32 s20, s20, 53760
    ds_write_addtid_b32 v72 offset:0
    ds_write_addtid_b32 v73 offset:256
    ds_write_addtid_b32 v74 offset:512
    ds_write_addtid_b32 v75 offset:768
    ds_write_addtid_b32 v76 offset:1024
    ds_write_addtid_b32 v77 offset:1280
    ds_write_addtid_b32 v78 offset:1536
    ds_write_addtid_b32 v79 offset:1792
    ds_write_addtid_b32 v80 offset:2048
    ds_write_addtid_b32 v81 offset:2304
    ds_write_addtid_b32 v82 offset:2560
    ds_write_addtid_b32 v83 offset:2816
    s_waitcnt lgkmcnt(15)
    v_ashrrev_i32 v122, 5, v60
    v_lshlrev_b16 v123, 2, v60
    v_cndmask_b32 v126, v24, v25, s[66:67]
    v_bitop3_b32 v122, v122, v113, v113 bitop3:0x0c
    v_lshlrev_b32 v124, 16, v126
    v_mul_f32 v122, v114, v122
    v_and_b32 v125, 0xffff0000, v126
    v_add_u32 v123, v123, v123
    v_mul_f32 v124, v122, v124
    v_mul_f32 v125, v122, v125
    v_cmpx_le_u32 vcc, 0x1000000, v60
    ds_add_f32 v123, v124 offset:54272
    ds_add_f32 v123, v125 offset:54276
    s_mov_b64 exec, -1
    v_ashrrev_i32 v122, 5, v61
    v_lshlrev_b16 v123, 2, v61
    v_cndmask_b32 v126, v26, v27, s[66:67]
    v_bitop3_b32 v122, v122, v113, v113 bitop3:0x0c
    v_lshlrev_b32 v124, 16, v126
    v_mul_f32 v122, v114, v122
    v_and_b32 v125, 0xffff0000, v126
    v_add_u32 v123, v123, v123
    v_mul_f32 v124, v122, v124
    v_mul_f32 v125, v122, v125
    v_cmpx_le_u32 vcc, 0x1000000, v61
    ds_add_f32 v123, v124 offset:54272
    ds_add_f32 v123, v125 offset:54276
    s_mov_b64 exec, -1
    v_ashrrev_i32 v122, 5, v62
    v_lshlrev_b16 v123, 2, v62
    v_cndmask_b32 v126, v28, v29, s[66:67]
    v_bitop3_b32 v122, v122, v113, v113 bitop3:0x0c
    v_lshlrev_b32 v124, 16, v126
    v_mul_f32 v122, v114, v122
    v_and_b32 v125, 0xffff0000, v126
    v_add_u32 v123, v123, v123
    v_mul_f32 v124, v122, v124
    v_mul_f32 v125, v122, v125
    v_cmpx_le_u32 vcc, 0x1000000, v62
    ds_add_f32 v123, v124 offset:54272
    ds_add_f32 v123, v125 offset:54276
    s_mov_b64 exec, -1
    s_waitcnt vmcnt(13)
    v_perm_b32 v60, v89, v86, s31
    v_perm_b32 v61, v89, v87, s32
    v_perm_b32 v62, v89, v88, s33
    v_lshlrev_b16 v28, 3, v88
    v_lshlrev_b16 v26, 3, v87
    v_lshlrev_b16 v24, 3, v86
    s_waitcnt lgkmcnt(6)
    s_barrier
    s_cmp_ge_u32 s10, 9
    s_cbranch_scc1 p2_nm1m1a
    v_lshrrev_b32 v84, 1, v112
    s_add_u32 s44, s20, s42
    buffer_load_dwordx2 v[84:85], v84, s[4:7], s44 offen
p2_nm1m1a:
    buffer_load_dwordx4 v[72:75], v112, s[4:7], s20 offen offset:0
    buffer_load_dwordx4 v[76:79], v112, s[4:7], s20 offen offset:1024
    buffer_load_dwordx4 v[80:83], v112, s[4:7], s20 offen offset:2048
    v_cmpx_ge_u16 vcc, 0x3fff, v60
    ds_read_b64 v[24:25], v24
    s_mov_b64 exec, -1
    v_cmpx_ge_u16 vcc, 0x3fff, v61
    ds_read_b64 v[26:27], v26
    s_mov_b64 exec, -1
    v_cmpx_ge_u16 vcc, 0x3fff, v62
    ds_read_b64 v[28:29], v28
    s_mov_b64 exec, -1
    s_waitcnt lgkmcnt(15)
    v_ashrrev_i32 v122, 5, v63
    v_lshlrev_b16 v123, 2, v63
    v_cndmask_b32 v126, v30, v31, s[66:67]
    v_bitop3_b32 v122, v122, v113, v113 bitop3:0x0c
    v_lshlrev_b32 v124, 16, v126
    v_mul_f32 v122, v114, v122
    v_and_b32 v125, 0xffff0000, v126
    v_add_u32 v123, v123, v123
    v_mul_f32 v124, v122, v124
    v_mul_f32 v125, v122, v125
    v_cmpx_le_u32 vcc, 0x1000000, v63
    ds_add_f32 v123, v124 offset:54272
    ds_add_f32 v123, v125 offset:54276
    s_mov_b64 exec, -1
    v_ashrrev_i32 v122, 5, v64
    v_lshlrev_b16 v123, 2, v64
    v_cndmask_b32 v126, v32, v33, s[66:67]
    v_bitop3_b32 v122, v122, v113, v113 bitop3:0x0c
    v_lshlrev_b32 v124, 16, v126
    v_mul_f32 v122, v114, v122
    v_and_b32 v125, 0xffff0000, v126
    v_add_u32 v123, v123, v123
    v_mul_f32 v124, v122, v124
    v_mul_f32 v125, v122, v125
    v_cmpx_le_u32 vcc, 0x1000000, v64
    ds_add_f32 v123, v124 offset:54272
    ds_add_f32 v123, v125 offset:54276
    s_mov_b64 exec, -1
    v_ashrrev_i32 v122, 5, v65
    v_lshlrev_b16 v123, 2, v65
    v_cndmask_b32 v126, v34, v35, s[66:67]
    v_bitop3_b32 v122, v122, v113, v113 bitop3:0x0c
    v_lshlrev_b32 v124, 16, v126
    v_mul_f32 v122, v114, v122
    v_and_b32 v125, 0xffff0000, v126
    v_add_u32 v123, v123, v123
    v_mul_f32 v124, v122, v124
    v_mul_f32 v125, v122, v125
    v_cmpx_le_u32 vcc, 0x1000000, v65
    ds_add_f32 v123, v124 offset:54272
    ds_add_f32 v123, v125 offset:54276
    s_mov_b64 exec, -1
    s_waitcnt vmcnt(15)
    v_perm_b32 v63, v93, v90, s31
    v_perm_b32 v64, v93, v91, s32
    v_perm_b32 v65, v93, v92, s33
    v_lshlrev_b16 v34, 3, v92
    v_lshlrev_b16 v32, 3, v91
    v_lshlrev_b16 v30, 3, v90
    v_cmpx_ge_u16 vcc, 0x3fff, v63
    ds_read_b64 v[30:31], v30
    s_mov_b64 exec, -1
    v_cmpx_ge_u16 vcc, 0x3fff, v64
    ds_read_b64 v[32:33], v32
    s_mov_b64 exec, -1
    v_cmpx_ge_u16 vcc, 0x3fff, v65
    ds_read_b64 v[34:35], v34
    s_mov_b64 exec, -1
    s_waitcnt lgkmcnt(15)
    v_lshrrev_b32 v86, 3, v106
    v_lshrrev_b32 v87, 18, v106
    v_and_b32 v106, 0x3fff, v106
    v_and_or_b32 v86, v86, s65, v87
    v_mad_u32_u24 v106, v86, s63, v106
    buffer_load_dwordx4 v[86:89], v106, s[68:71], 0 offen
    s_waitcnt lgkmcnt(15)
    v_ashrrev_i32 v122, 5, v66
    v_lshlrev_b16 v123, 2, v66
    v_cndmask_b32 v126, v36, v37, s[66:67]
    v_bitop3_b32 v122, v122, v113, v113 bitop3:0x0c
    v_lshlrev_b32 v124, 16, v126
    v_mul_f32 v122, v114, v122
    v_and_b32 v125, 0xffff0000, v126
    v_add_u32 v123, v123, v123
    v_mul_f32 v124, v122, v124
    v_mul_f32 v125, v122, v125
    v_cmpx_le_u32 vcc, 0x1000000, v66
    ds_add_f32 v123, v124 offset:54272
    ds_add_f32 v123, v125 offset:54276
    s_mov_b64 exec, -1
    v_ashrrev_i32 v122, 5, v67
    v_lshlrev_b16 v123, 2, v67
    v_cndmask_b32 v126, v38, v39, s[66:67]
    v_bitop3_b32 v122, v122, v113, v113 bitop3:0x0c
    v_lshlrev_b32 v124, 16, v126
    v_mul_f32 v122, v114, v122
    v_and_b32 v125, 0xffff0000, v126
    v_add_u32 v123, v123, v123
    v_mul_f32 v124, v122, v124
    v_mul_f32 v125, v122, v125
    v_cmpx_le_u32 vcc, 0x1000000, v67
    ds_add_f32 v123, v124 offset:54272
    ds_add_f32 v123, v125 offset:54276
    s_mov_b64 exec, -1
    v_ashrrev_i32 v122, 5, v68
    v_lshlrev_b16 v123, 2, v68
    v_cndmask_b32 v126, v40, v41, s[66:67]
    v_bitop3_b32 v122, v122, v113, v113 bitop3:0x0c
    v_lshlrev_b32 v124, 16, v126
    v_mul_f32 v122, v114, v122
    v_and_b32 v125, 0xffff0000, v126
    v_add_u32 v123, v123, v123
    v_mul_f32 v124, v122, v124
    v_mul_f32 v125, v122, v125
    v_cmpx_le_u32 vcc, 0x1000000, v68
    ds_add_f32 v123, v124 offset:54272
    ds_add_f32 v123, v125 offset:54276
    s_mov_b64 exec, -1
    s_waitcnt vmcnt(12)
    v_perm_b32 v66, v97, v94, s31
    v_perm_b32 v67, v97, v95, s32
    v_perm_b32 v68, v97, v96, s33
    v_lshlrev_b16 v40, 3, v96
    v_lshlrev_b16 v38, 3, v95
    v_lshlrev_b16 v36, 3, v94
    v_cmpx_ge_u16 vcc, 0x3fff, v66
    ds_read_b64 v[36:37], v36
    s_mov_b64 exec, -1
    v_cmpx_ge_u16 vcc, 0x3fff, v67
    ds_read_b64 v[38:39], v38
    s_mov_b64 exec, -1
    v_cmpx_ge_u16 vcc, 0x3fff, v68
    ds_read_b64 v[40:41], v40
    s_mov_b64 exec, -1
    s_cmp_le_u32 s15, 7
    s_cbranch_scc1 p2_na1a7
    s_waitcnt lgkmcnt(15)
    v_ashrrev_i32 v122, 5, v69
    v_lshlrev_b16 v123, 2, v69
    v_cndmask_b32 v126, v42, v43, s[66:67]
    v_bitop3_b32 v122, v122, v113, v113 bitop3:0x0c
    v_lshlrev_b32 v124, 16, v126
    v_mul_f32 v122, v114, v122
    v_and_b32 v125, 0xffff0000, v126
    v_add_u32 v123, v123, v123
    v_mul_f32 v124, v122, v124
    v_mul_f32 v125, v122, v125
    v_cmpx_le_u32 vcc, 0x1000000, v69
    ds_add_f32 v123, v124 offset:54272
    ds_add_f32 v123, v125 offset:54276
    s_mov_b64 exec, -1
    v_ashrrev_i32 v122, 5, v70
    v_lshlrev_b16 v123, 2, v70
    v_cndmask_b32 v126, v44, v45, s[66:67]
    v_bitop3_b32 v122, v122, v113, v113 bitop3:0x0c
    v_lshlrev_b32 v124, 16, v126
    v_mul_f32 v122, v114, v122
    v_and_b32 v125, 0xffff0000, v126
    v_add_u32 v123, v123, v123
    v_mul_f32 v124, v122, v124
    v_mul_f32 v125, v122, v125
    v_cmpx_le_u32 vcc, 0x1000000, v70
    ds_add_f32 v123, v124 offset:54272
    ds_add_f32 v123, v125 offset:54276
    s_mov_b64 exec, -1
    v_ashrrev_i32 v122, 5, v71
    v_lshlrev_b16 v123, 2, v71
    v_cndmask_b32 v126, v46, v47, s[66:67]
    v_bitop3_b32 v122, v122, v113, v113 bitop3:0x0c
    v_lshlrev_b32 v124, 16, v126
    v_mul_f32 v122, v114, v122
    v_and_b32 v125, 0xffff0000, v126
    v_add_u32 v123, v123, v123
    v_mul_f32 v124, v122, v124
    v_mul_f32 v125, v122, v125
    v_cmpx_le_u32 vcc, 0x1000000, v71
    ds_add_f32 v123, v124 offset:54272
    ds_add_f32 v123, v125 offset:54276
    s_mov_b64 exec, -1
p2_na1a7:
    s_waitcnt vmcnt(11)
    v_perm_b32 v69, v101, v98, s31
    v_perm_b32 v70, v101, v99, s32
    v_perm_b32 v71, v101, v100, s33
    v_lshlrev_b16 v46, 3, v100
    v_lshlrev_b16 v44, 3, v99
    v_lshlrev_b16 v42, 3, v98
    s_cmp_le_u32 s16, 7
    s_cbranch_scc1 p2_g1r07
    v_cmpx_ge_u16 vcc, 0x3fff, v69
    ds_read_b64 v[42:43], v42
    s_mov_b64 exec, -1
    v_cmpx_ge_u16 vcc, 0x3fff, v70
    ds_read_b64 v[44:45], v44
    s_mov_b64 exec, -1
    v_cmpx_ge_u16 vcc, 0x3fff, v71
    ds_read_b64 v[46:47], v46
    s_mov_b64 exec, -1
p2_g1r07:
    s_waitcnt lgkmcnt(15)
    v_lshrrev_b32 v90, 3, v107
    v_lshrrev_b32 v91, 18, v107
    v_and_b32 v107, 0x3fff, v107
    v_and_or_b32 v90, v90, s65, v91
    v_mad_u32_u24 v107, v90, s63, v107
    buffer_load_dwordx4 v[90:93], v107, s[68:71], 0 offen
    s_waitcnt vmcnt(8)
    v_perm_b32 v48, v3, v0, s31
    v_perm_b32 v49, v3, v1, s32
    v_perm_b32 v50, v3, v2, s33
    v_lshlrev_b16 v4, 3, v2
    v_lshlrev_b16 v2, 3, v1
    v_lshlrev_b16 v0, 3, v0
    v_cmpx_ge_u16 vcc, 0x3fff, v48
    ds_read_b64 v[0:1], v0
    s_mov_b64 exec, -1
    v_cmpx_ge_u16 vcc, 0x3fff, v49
    ds_read_b64 v[2:3], v2
    s_mov_b64 exec, -1
    v_cmpx_ge_u16 vcc, 0x3fff, v50
    ds_read_b64 v[4:5], v4
    s_mov_b64 exec, -1
    s_waitcnt vmcnt(7)
    v_perm_b32 v51, v9, v6, s31
    v_perm_b32 v52, v9, v7, s32
    v_perm_b32 v53, v9, v8, s33
    v_lshlrev_b16 v10, 3, v8
    v_lshlrev_b16 v8, 3, v7
    v_lshlrev_b16 v6, 3, v6
    v_cmpx_ge_u16 vcc, 0x3fff, v51
    ds_read_b64 v[6:7], v6
    s_mov_b64 exec, -1
    v_cmpx_ge_u16 vcc, 0x3fff, v52
    ds_read_b64 v[8:9], v8
    s_mov_b64 exec, -1
    v_cmpx_ge_u16 vcc, 0x3fff, v53
    ds_read_b64 v[10:11], v10
    s_mov_b64 exec, -1
    s_waitcnt vmcnt(6)
    v_perm_b32 v54, v15, v12, s31
    v_perm_b32 v55, v15, v13, s32
    v_perm_b32 v56, v15, v14, s33
    v_lshlrev_b16 v16, 3, v14
    v_lshlrev_b16 v14, 3, v13
    v_lshlrev_b16 v12, 3, v12
    v_cmpx_ge_u16 vcc, 0x3fff, v54
    ds_read_b64 v[12:13], v12
    s_mov_b64 exec, -1
    v_cmpx_ge_u16 vcc, 0x3fff, v55
    ds_read_b64 v[14:15], v14
    s_mov_b64 exec, -1
    v_cmpx_ge_u16 vcc, 0x3fff, v56
    ds_read_b64 v[16:17], v16
    s_mov_b64 exec, -1
    s_waitcnt vmcnt(5)
    v_perm_b32 v57, v21, v18, s31
    v_perm_b32 v58, v21, v19, s32
    v_perm_b32 v59, v21, v20, s33
    v_lshlrev_b16 v22, 3, v20
    v_lshlrev_b16 v20, 3, v19
    v_lshlrev_b16 v18, 3, v18
    v_cmpx_ge_u16 vcc, 0x3fff, v57
    ds_read_b64 v[18:19], v18
    s_mov_b64 exec, -1
    v_cmpx_ge_u16 vcc, 0x3fff, v58
    ds_read_b64 v[20:21], v20
    s_mov_b64 exec, -1
    v_cmpx_ge_u16 vcc, 0x3fff, v59
    ds_read_b64 v[22:23], v22
    s_mov_b64 exec, -1
    s_waitcnt lgkmcnt(0)
    s_barrier
    s_waitcnt lgkmcnt(15)
    s_branch p2_tail
p2_drain1:
    v_cmpx_gt_i16 vcc, 0, v48
    ds_read_b64 v[0:1], v0
    s_mov_b64 exec, -1
    v_cmpx_gt_i16 vcc, 0, v49
    ds_read_b64 v[2:3], v2
    s_mov_b64 exec, -1
    v_cmpx_gt_i16 vcc, 0, v50
    ds_read_b64 v[4:5], v4
    s_mov_b64 exec, -1
    v_cmpx_gt_i16 vcc, 0, v51
    ds_read_b64 v[6:7], v6
    s_mov_b64 exec, -1
    v_cmpx_gt_i16 vcc, 0, v52
    ds_read_b64 v[8:9], v8
    s_mov_b64 exec, -1
    v_cmpx_gt_i16 vcc, 0, v53
    ds_read_b64 v[10:11], v10
    s_mov_b64 exec, -1
    v_cmpx_gt_i16 vcc, 0, v54
    ds_read_b64 v[12:13], v12
    s_mov_b64 exec, -1
    v_cmpx_gt_i16 vcc, 0, v55
    ds_read_b64 v[14:15], v14
    s_mov_b64 exec, -1
    v_cmpx_gt_i16 vcc, 0, v56
    ds_read_b64 v[16:17], v16
    s_mov_b64 exec, -1
    v_cmpx_gt_i16 vcc, 0, v57
    ds_read_b64 v[18:19], v18
    s_mov_b64 exec, -1
    v_cmpx_gt_i16 vcc, 0, v58
    ds_read_b64 v[20:21], v20
    s_mov_b64 exec, -1
    v_cmpx_gt_i16 vcc, 0, v59
    ds_read_b64 v[22:23], v22
    s_mov_b64 exec, -1
    v_cmpx_gt_i16 vcc, 0, v60
    ds_read_b64 v[24:25], v24
    s_mov_b64 exec, -1
    v_cmpx_gt_i16 vcc, 0, v61
    ds_read_b64 v[26:27], v26
    s_mov_b64 exec, -1
    v_cmpx_gt_i16 vcc, 0, v62
    ds_read_b64 v[28:29], v28
    s_mov_b64 exec, -1
    v_cmpx_gt_i16 vcc, 0, v63
    ds_read_b64 v[30:31], v30
    s_mov_b64 exec, -1
    v_cmpx_gt_i16 vcc, 0, v64
    ds_read_b64 v[32:33], v32
    s_mov_b64 exec, -1
    v_cmpx_gt_i16 vcc, 0, v65
    ds_read_b64 v[34:35], v34
    s_mov_b64 exec, -1
    v_cmpx_gt_i16 vcc, 0, v66
    ds_read_b64 v[36:37], v36
    s_mov_b64 exec, -1
    v_cmpx_gt_i16 vcc, 0, v67
    ds_read_b64 v[38:39], v38
    s_mov_b64 exec, -1
    v_cmpx_gt_i16 vcc, 0, v68
    ds_read_b64 v[40:41], v40
    s_mov_b64 exec, -1
    s_cmp_le_u32 s15, 7
    s_cbranch_scc1 p2_gd1
    v_cmpx_gt_i16 vcc, 0, v69
    ds_read_b64 v[42:43], v42
    s_mov_b64 exec, -1
    v_cmpx_gt_i16 vcc, 0, v70
    ds_read_b64 v[44:45], v44
    s_mov_b64 exec, -1
    v_cmpx_gt_i16 vcc, 0, v71
    ds_read_b64 v[46:47], v46
    s_mov_b64 exec, -1
p2_gd1:
    s_waitcnt lgkmcnt(15)
    v_ashrrev_i32 v122, 5, v48
    v_lshlrev_b16 v123, 2, v48
    v_cndmask_b32 v126, v0, v1, s[66:67]
    v_bitop3_b32 v122, v122, v113, v113 bitop3:0x0c
    v_lshlrev_b32 v124, 16, v126
    v_mul_f32 v122, v114, v122
    v_and_b32 v125, 0xffff0000, v126
    v_add_u32 v123, v123, v123
    v_mul_f32 v124, v122, v124
    v_mul_f32 v125, v122, v125
    v_cmpx_le_u32 vcc, 0x1000000, v48
    ds_add_f32 v123, v124 offset:54272
    ds_add_f32 v123, v125 offset:54276
    s_mov_b64 exec, -1
    v_ashrrev_i32 v122, 5, v49
    v_lshlrev_b16 v123, 2, v49
    v_cndmask_b32 v126, v2, v3, s[66:67]
    v_bitop3_b32 v122, v122, v113, v113 bitop3:0x0c
    v_lshlrev_b32 v124, 16, v126
    v_mul_f32 v122, v114, v122
    v_and_b32 v125, 0xffff0000, v126
    v_add_u32 v123, v123, v123
    v_mul_f32 v124, v122, v124
    v_mul_f32 v125, v122, v125
    v_cmpx_le_u32 vcc, 0x1000000, v49
    ds_add_f32 v123, v124 offset:54272
    ds_add_f32 v123, v125 offset:54276
    s_mov_b64 exec, -1
    v_ashrrev_i32 v122, 5, v50
    v_lshlrev_b16 v123, 2, v50
    v_cndmask_b32 v126, v4, v5, s[66:67]
    v_bitop3_b32 v122, v122, v113, v113 bitop3:0x0c
    v_lshlrev_b32 v124, 16, v126
    v_mul_f32 v122, v114, v122
    v_and_b32 v125, 0xffff0000, v126
    v_add_u32 v123, v123, v123
    v_mul_f32 v124, v122, v124
    v_mul_f32 v125, v122, v125
    v_cmpx_le_u32 vcc, 0x1000000, v50
    ds_add_f32 v123, v124 offset:54272
    ds_add_f32 v123, v125 offset:54276
    s_mov_b64 exec, -1
    s_waitcnt lgkmcnt(15)
    v_ashrrev_i32 v122, 5, v51
    v_lshlrev_b16 v123, 2, v51
    v_cndmask_b32 v126, v6, v7, s[66:67]
    v_bitop3_b32 v122, v122, v113, v113 bitop3:0x0c
    v_lshlrev_b32 v124, 16, v126
    v_mul_f32 v122, v114, v122
    v_and_b32 v125, 0xffff0000, v126
    v_add_u32 v123, v123, v123
    v_mul_f32 v124, v122, v124
    v_mul_f32 v125, v122, v125
    v_cmpx_le_u32 vcc, 0x1000000, v51
    ds_add_f32 v123, v124 offset:54272
    ds_add_f32 v123, v125 offset:54276
    s_mov_b64 exec, -1
    v_ashrrev_i32 v122, 5, v52
    v_lshlrev_b16 v123, 2, v52
    v_cndmask_b32 v126, v8, v9, s[66:67]
    v_bitop3_b32 v122, v122, v113, v113 bitop3:0x0c
    v_lshlrev_b32 v124, 16, v126
    v_mul_f32 v122, v114, v122
    v_and_b32 v125, 0xffff0000, v126
    v_add_u32 v123, v123, v123
    v_mul_f32 v124, v122, v124
    v_mul_f32 v125, v122, v125
    v_cmpx_le_u32 vcc, 0x1000000, v52
    ds_add_f32 v123, v124 offset:54272
    ds_add_f32 v123, v125 offset:54276
    s_mov_b64 exec, -1
    v_ashrrev_i32 v122, 5, v53
    v_lshlrev_b16 v123, 2, v53
    v_cndmask_b32 v126, v10, v11, s[66:67]
    v_bitop3_b32 v122, v122, v113, v113 bitop3:0x0c
    v_lshlrev_b32 v124, 16, v126
    v_mul_f32 v122, v114, v122
    v_and_b32 v125, 0xffff0000, v126
    v_add_u32 v123, v123, v123
    v_mul_f32 v124, v122, v124
    v_mul_f32 v125, v122, v125
    v_cmpx_le_u32 vcc, 0x1000000, v53
    ds_add_f32 v123, v124 offset:54272
    ds_add_f32 v123, v125 offset:54276
    s_mov_b64 exec, -1
    s_waitcnt lgkmcnt(15)
    v_ashrrev_i32 v122, 5, v54
    v_lshlrev_b16 v123, 2, v54
    v_cndmask_b32 v126, v12, v13, s[66:67]
    v_bitop3_b32 v122, v122, v113, v113 bitop3:0x0c
    v_lshlrev_b32 v124, 16, v126
    v_mul_f32 v122, v114, v122
    v_and_b32 v125, 0xffff0000, v126
    v_add_u32 v123, v123, v123
    v_mul_f32 v124, v122, v124
    v_mul_f32 v125, v122, v125
    v_cmpx_le_u32 vcc, 0x1000000, v54
    ds_add_f32 v123, v124 offset:54272
    ds_add_f32 v123, v125 offset:54276
    s_mov_b64 exec, -1
    v_ashrrev_i32 v122, 5, v55
    v_lshlrev_b16 v123, 2, v55
    v_cndmask_b32 v126, v14, v15, s[66:67]
    v_bitop3_b32 v122, v122, v113, v113 bitop3:0x0c
    v_lshlrev_b32 v124, 16, v126
    v_mul_f32 v122, v114, v122
    v_and_b32 v125, 0xffff0000, v126
    v_add_u32 v123, v123, v123
    v_mul_f32 v124, v122, v124
    v_mul_f32 v125, v122, v125
    v_cmpx_le_u32 vcc, 0x1000000, v55
    ds_add_f32 v123, v124 offset:54272
    ds_add_f32 v123, v125 offset:54276
    s_mov_b64 exec, -1
    v_ashrrev_i32 v122, 5, v56
    v_lshlrev_b16 v123, 2, v56
    v_cndmask_b32 v126, v16, v17, s[66:67]
    v_bitop3_b32 v122, v122, v113, v113 bitop3:0x0c
    v_lshlrev_b32 v124, 16, v126
    v_mul_f32 v122, v114, v122
    v_and_b32 v125, 0xffff0000, v126
    v_add_u32 v123, v123, v123
    v_mul_f32 v124, v122, v124
    v_mul_f32 v125, v122, v125
    v_cmpx_le_u32 vcc, 0x1000000, v56
    ds_add_f32 v123, v124 offset:54272
    ds_add_f32 v123, v125 offset:54276
    s_mov_b64 exec, -1
    s_waitcnt lgkmcnt(15)
    v_ashrrev_i32 v122, 5, v57
    v_lshlrev_b16 v123, 2, v57
    v_cndmask_b32 v126, v18, v19, s[66:67]
    v_bitop3_b32 v122, v122, v113, v113 bitop3:0x0c
    v_lshlrev_b32 v124, 16, v126
    v_mul_f32 v122, v114, v122
    v_and_b32 v125, 0xffff0000, v126
    v_add_u32 v123, v123, v123
    v_mul_f32 v124, v122, v124
    v_mul_f32 v125, v122, v125
    v_cmpx_le_u32 vcc, 0x1000000, v57
    ds_add_f32 v123, v124 offset:54272
    ds_add_f32 v123, v125 offset:54276
    s_mov_b64 exec, -1
    v_ashrrev_i32 v122, 5, v58
    v_lshlrev_b16 v123, 2, v58
    v_cndmask_b32 v126, v20, v21, s[66:67]
    v_bitop3_b32 v122, v122, v113, v113 bitop3:0x0c
    v_lshlrev_b32 v124, 16, v126
    v_mul_f32 v122, v114, v122
    v_and_b32 v125, 0xffff0000, v126
    v_add_u32 v123, v123, v123
    v_mul_f32 v124, v122, v124
    v_mul_f32 v125, v122, v125
    v_cmpx_le_u32 vcc, 0x1000000, v58
    ds_add_f32 v123, v124 offset:54272
    ds_add_f32 v123, v125 offset:54276
    s_mov_b64 exec, -1
    v_ashrrev_i32 v122, 5, v59
    v_lshlrev_b16 v123, 2, v59
    v_cndmask_b32 v126, v22, v23, s[66:67]
    v_bitop3_b32 v122, v122, v113, v113 bitop3:0x0c
    v_lshlrev_b32 v124, 16, v126
    v_mul_f32 v122, v114, v122
    v_and_b32 v125, 0xffff0000, v126
    v_add_u32 v123, v123, v123
    v_mul_f32 v124, v122, v124
    v_mul_f32 v125, v122, v125
    v_cmpx_le_u32 vcc, 0x1000000, v59
    ds_add_f32 v123, v124 offset:54272
    ds_add_f32 v123, v125 offset:54276
    s_mov_b64 exec, -1
    s_waitcnt lgkmcnt(15)
    v_ashrrev_i32 v122, 5, v60
    v_lshlrev_b16 v123, 2, v60
    v_cndmask_b32 v126, v24, v25, s[66:67]
    v_bitop3_b32 v122, v122, v113, v113 bitop3:0x0c
    v_lshlrev_b32 v124, 16, v126
    v_mul_f32 v122, v114, v122
    v_and_b32 v125, 0xffff0000, v126
    v_add_u32 v123, v123, v123
    v_mul_f32 v124, v122, v124
    v_mul_f32 v125, v122, v125
    v_cmpx_le_u32 vcc, 0x1000000, v60
    ds_add_f32 v123, v124 offset:54272
    ds_add_f32 v123, v125 offset:54276
    s_mov_b64 exec, -1
    v_ashrrev_i32 v122, 5, v61
    v_lshlrev_b16 v123, 2, v61
    v_cndmask_b32 v126, v26, v27, s[66:67]
    v_bitop3_b32 v122, v122, v113, v113 bitop3:0x0c
    v_lshlrev_b32 v124, 16, v126
    v_mul_f32 v122, v114, v122
    v_and_b32 v125, 0xffff0000, v126
    v_add_u32 v123, v123, v123
    v_mul_f32 v124, v122, v124
    v_mul_f32 v125, v122, v125
    v_cmpx_le_u32 vcc, 0x1000000, v61
    ds_add_f32 v123, v124 offset:54272
    ds_add_f32 v123, v125 offset:54276
    s_mov_b64 exec, -1
    v_ashrrev_i32 v122, 5, v62
    v_lshlrev_b16 v123, 2, v62
    v_cndmask_b32 v126, v28, v29, s[66:67]
    v_bitop3_b32 v122, v122, v113, v113 bitop3:0x0c
    v_lshlrev_b32 v124, 16, v126
    v_mul_f32 v122, v114, v122
    v_and_b32 v125, 0xffff0000, v126
    v_add_u32 v123, v123, v123
    v_mul_f32 v124, v122, v124
    v_mul_f32 v125, v122, v125
    v_cmpx_le_u32 vcc, 0x1000000, v62
    ds_add_f32 v123, v124 offset:54272
    ds_add_f32 v123, v125 offset:54276
    s_mov_b64 exec, -1
    s_waitcnt lgkmcnt(15)
    v_ashrrev_i32 v122, 5, v63
    v_lshlrev_b16 v123, 2, v63
    v_cndmask_b32 v126, v30, v31, s[66:67]
    v_bitop3_b32 v122, v122, v113, v113 bitop3:0x0c
    v_lshlrev_b32 v124, 16, v126
    v_mul_f32 v122, v114, v122
    v_and_b32 v125, 0xffff0000, v126
    v_add_u32 v123, v123, v123
    v_mul_f32 v124, v122, v124
    v_mul_f32 v125, v122, v125
    v_cmpx_le_u32 vcc, 0x1000000, v63
    ds_add_f32 v123, v124 offset:54272
    ds_add_f32 v123, v125 offset:54276
    s_mov_b64 exec, -1
    v_ashrrev_i32 v122, 5, v64
    v_lshlrev_b16 v123, 2, v64
    v_cndmask_b32 v126, v32, v33, s[66:67]
    v_bitop3_b32 v122, v122, v113, v113 bitop3:0x0c
    v_lshlrev_b32 v124, 16, v126
    v_mul_f32 v122, v114, v122
    v_and_b32 v125, 0xffff0000, v126
    v_add_u32 v123, v123, v123
    v_mul_f32 v124, v122, v124
    v_mul_f32 v125, v122, v125
    v_cmpx_le_u32 vcc, 0x1000000, v64
    ds_add_f32 v123, v124 offset:54272
    ds_add_f32 v123, v125 offset:54276
    s_mov_b64 exec, -1
    v_ashrrev_i32 v122, 5, v65
    v_lshlrev_b16 v123, 2, v65
    v_cndmask_b32 v126, v34, v35, s[66:67]
    v_bitop3_b32 v122, v122, v113, v113 bitop3:0x0c
    v_lshlrev_b32 v124, 16, v126
    v_mul_f32 v122, v114, v122
    v_and_b32 v125, 0xffff0000, v126
    v_add_u32 v123, v123, v123
    v_mul_f32 v124, v122, v124
    v_mul_f32 v125, v122, v125
    v_cmpx_le_u32 vcc, 0x1000000, v65
    ds_add_f32 v123, v124 offset:54272
    ds_add_f32 v123, v125 offset:54276
    s_mov_b64 exec, -1
    s_waitcnt lgkmcnt(15)
    v_ashrrev_i32 v122, 5, v66
    v_lshlrev_b16 v123, 2, v66
    v_cndmask_b32 v126, v36, v37, s[66:67]
    v_bitop3_b32 v122, v122, v113, v113 bitop3:0x0c
    v_lshlrev_b32 v124, 16, v126
    v_mul_f32 v122, v114, v122
    v_and_b32 v125, 0xffff0000, v126
    v_add_u32 v123, v123, v123
    v_mul_f32 v124, v122, v124
    v_mul_f32 v125, v122, v125
    v_cmpx_le_u32 vcc, 0x1000000, v66
    ds_add_f32 v123, v124 offset:54272
    ds_add_f32 v123, v125 offset:54276
    s_mov_b64 exec, -1
    v_ashrrev_i32 v122, 5, v67
    v_lshlrev_b16 v123, 2, v67
    v_cndmask_b32 v126, v38, v39, s[66:67]
    v_bitop3_b32 v122, v122, v113, v113 bitop3:0x0c
    v_lshlrev_b32 v124, 16, v126
    v_mul_f32 v122, v114, v122
    v_and_b32 v125, 0xffff0000, v126
    v_add_u32 v123, v123, v123
    v_mul_f32 v124, v122, v124
    v_mul_f32 v125, v122, v125
    v_cmpx_le_u32 vcc, 0x1000000, v67
    ds_add_f32 v123, v124 offset:54272
    ds_add_f32 v123, v125 offset:54276
    s_mov_b64 exec, -1
    v_ashrrev_i32 v122, 5, v68
    v_lshlrev_b16 v123, 2, v68
    v_cndmask_b32 v126, v40, v41, s[66:67]
    v_bitop3_b32 v122, v122, v113, v113 bitop3:0x0c
    v_lshlrev_b32 v124, 16, v126
    v_mul_f32 v122, v114, v122
    v_and_b32 v125, 0xffff0000, v126
    v_add_u32 v123, v123, v123
    v_mul_f32 v124, v122, v124
    v_mul_f32 v125, v122, v125
    v_cmpx_le_u32 vcc, 0x1000000, v68
    ds_add_f32 v123, v124 offset:54272
    ds_add_f32 v123, v125 offset:54276
    s_mov_b64 exec, -1
    s_cmp_le_u32 s15, 7
    s_cbranch_scc1 p2_nad1
    s_waitcnt lgkmcnt(15)
    v_ashrrev_i32 v122, 5, v69
    v_lshlrev_b16 v123, 2, v69
    v_cndmask_b32 v126, v42, v43, s[66:67]
    v_bitop3_b32 v122, v122, v113, v113 bitop3:0x0c
    v_lshlrev_b32 v124, 16, v126
    v_mul_f32 v122, v114, v122
    v_and_b32 v125, 0xffff0000, v126
    v_add_u32 v123, v123, v123
    v_mul_f32 v124, v122, v124
    v_mul_f32 v125, v122, v125
    v_cmpx_le_u32 vcc, 0x1000000, v69
    ds_add_f32 v123, v124 offset:54272
    ds_add_f32 v123, v125 offset:54276
    s_mov_b64 exec, -1
    v_ashrrev_i32 v122, 5, v70
    v_lshlrev_b16 v123, 2, v70
    v_cndmask_b32 v126, v44, v45, s[66:67]
    v_bitop3_b32 v122, v122, v113, v113 bitop3:0x0c
    v_lshlrev_b32 v124, 16, v126
    v_mul_f32 v122, v114, v122
    v_and_b32 v125, 0xffff0000, v126
    v_add_u32 v123, v123, v123
    v_mul_f32 v124, v122, v124
    v_mul_f32 v125, v122, v125
    v_cmpx_le_u32 vcc, 0x1000000, v70
    ds_add_f32 v123, v124 offset:54272
    ds_add_f32 v123, v125 offset:54276
    s_mov_b64 exec, -1
    v_ashrrev_i32 v122, 5, v71
    v_lshlrev_b16 v123, 2, v71
    v_cndmask_b32 v126, v46, v47, s[66:67]
    v_bitop3_b32 v122, v122, v113, v113 bitop3:0x0c
    v_lshlrev_b32 v124, 16, v126
    v_mul_f32 v122, v114, v122
    v_and_b32 v125, 0xffff0000, v126
    v_add_u32 v123, v123, v123
    v_mul_f32 v124, v122, v124
    v_mul_f32 v125, v122, v125
    v_cmpx_le_u32 vcc, 0x1000000, v71
    ds_add_f32 v123, v124 offset:54272
    ds_add_f32 v123, v125 offset:54276
    s_mov_b64 exec, -1
p2_nad1:
    s_branch p2_fin
p2_tail:
    s_mov_b32 s60, s61
    s_mov_b32 s15, s16
    s_mov_b32 s16, s17
    v_mov_b32 v122, s19
    s_xor_b32 s19, s19, 4
    ds_read_b32 v125, v122 offset:53760
    v_mov_b32 v123, s19
    v_mov_b32 v124, 0
    ds_write_b32 v123, v124 offset:53760
    s_waitcnt vmcnt(2)
    s_mov_b32 m0, s24
    s_cmp_ge_u32 s10, 9
    s_cbranch_scc1 p2_st2s1
    ds_write_addtid_b32 v84 offset:49152
    ds_write_addtid_b32 v85 offset:49408
p2_st2s1:
    s_mov_b32 m0, s23
    s_add_u32 s20, s20, 53760
    ds_write_addtid_b32 v72 offset:0
    ds_write_addtid_b32 v73 offset:256
    ds_write_addtid_b32 v74 offset:512
    ds_write_addtid_b32 v75 offset:768
    ds_write_addtid_b32 v76 offset:1024
    ds_write_addtid_b32 v77 offset:1280
    ds_write_addtid_b32 v78 offset:1536
    ds_write_addtid_b32 v79 offset:1792
    ds_write_addtid_b32 v80 offset:2048
    ds_write_addtid_b32 v81 offset:2304
    ds_write_addtid_b32 v82 offset:2560
    ds_write_addtid_b32 v83 offset:2816
    s_waitcnt lgkmcnt(0)
    s_barrier
    s_waitcnt lgkmcnt(13)
    v_readfirstlane_b32 s44, v125
    s_nop 0
    s_cmp_lg_u32 s44, 0
    s_cbranch_scc1 p2_advb
    s_add_u32 s61, s61, 1
    s_min_u32 s61, s61, 10
    v_mov_b32 v110, 0
    v_mov_b32 v111, 0
    s_cmp_eq_u32 s61, 10
    s_cbranch_scc1 p2_advb
    s_mul_i32 s44, s61, 4160
    s_add_u32 s44, s44, s40
    v_lshrrev_b32 v110, 6, v112
    v_bfe_u32 v111, v112, 2, 4
    v_mul_u32_u24 v110, 41600, v110
    v_add_u32 v111, v110, v111
    buffer_load_dword v110, v111, s[4:7], s44 offen
    buffer_load_dword v111, v111, s[4:7], s44 offen offset:16
p2_advb:
    s_cmp_lg_u32 s10, 0
    s_cbranch_scc1 p2_ntg
    s_lshr_b32 s44, s2, 3
    s_mul_i32 s44, s44, 5120
    s_mul_i32 s45, s60, 645120
    s_add_u32 s44, s44, s45
    s_add_u32 s44, s44, s62
    v_lshlrev_b32 v127, 3, v112
    s_mov_b32 exec_hi, 0xff
    buffer_load_dword v127, v127, s[4:7], s44 offen
    s_mov_b64 exec, -1
p2_ntg:
    s_cmp_ge_u32 s10, 9
    s_cbranch_scc1 p2_nm2m2a
    v_lshrrev_b32 v84, 1, v112
    s_add_u32 s44, s20, s42
    buffer_load_dwordx2 v[84:85], v84, s[4:7], s44 offen
p2_nm2m2a:
    buffer_load_dwordx4 v[72:75], v112, s[4:7], s20 offen offset:0
    buffer_load_dwordx4 v[76:79], v112, s[4:7], s20 offen offset:1024
    buffer_load_dwordx4 v[80:83], v112, s[4:7], s20 offen offset:2048
    v_cmpx_lt_i16 vcc, 0x3fff, v48
    ds_read_b64 v[0:1], v0
    s_mov_b64 exec, -1
    v_cmpx_lt_i16 vcc, 0x3fff, v49
    ds_read_b64 v[2:3], v2
    s_mov_b64 exec, -1
    v_cmpx_lt_i16 vcc, 0x3fff, v50
    ds_read_b64 v[4:5], v4
    s_mov_b64 exec, -1
    v_cmpx_lt_i16 vcc, 0x3fff, v51
    ds_read_b64 v[6:7], v6
    s_mov_b64 exec, -1
    v_cmpx_lt_i16 vcc, 0x3fff, v52
    ds_read_b64 v[8:9], v8
    s_mov_b64 exec, -1
    v_cmpx_lt_i16 vcc, 0x3fff, v53
    ds_read_b64 v[10:11], v10
    s_mov_b64 exec, -1
    v_cmpx_lt_i16 vcc, 0x3fff, v54
    ds_read_b64 v[12:13], v12
    s_mov_b64 exec, -1
    v_cmpx_lt_i16 vcc, 0x3fff, v55
    ds_read_b64 v[14:15], v14
    s_mov_b64 exec, -1
    v_cmpx_lt_i16 vcc, 0x3fff, v56
    ds_read_b64 v[16:17], v16
    s_mov_b64 exec, -1
    v_cmpx_lt_i16 vcc, 0x3fff, v57
    ds_read_b64 v[18:19], v18
    s_mov_b64 exec, -1
    v_cmpx_lt_i16 vcc, 0x3fff, v58
    ds_read_b64 v[20:21], v20
    s_mov_b64 exec, -1
    v_cmpx_lt_i16 vcc, 0x3fff, v59
    ds_read_b64 v[22:23], v22
    s_mov_b64 exec, -1
    v_lshrrev_b32 v94, 3, v108
    v_lshrrev_b32 v95, 18, v108
    v_and_b32 v108, 0x3fff, v108
    v_and_or_b32 v94, v94, s65, v95
    v_mad_u32_u24 v108, v94, s63, v108
    buffer_load_dwordx4 v[94:97], v108, s[68:71], 0 offen
    v_cmpx_lt_i16 vcc, 0x3fff, v60
    ds_read_b64 v[24:25], v24
    s_mov_b64 exec, -1
    v_cmpx_lt_i16 vcc, 0x3fff, v61
    ds_read_b64 v[26:27], v26
    s_mov_b64 exec, -1
    v_cmpx_lt_i16 vcc, 0x3fff, v62
    ds_read_b64 v[28:29], v28
    s_mov_b64 exec, -1
    v_cmpx_lt_i16 vcc, 0x3fff, v63
    ds_read_b64 v[30:31], v30
    s_mov_b64 exec, -1
    v_cmpx_lt_i16 vcc, 0x3fff, v64
    ds_read_b64 v[32:33], v32
    s_mov_b64 exec, -1
    v_cmpx_lt_i16 vcc, 0x3fff, v65
    ds_read_b64 v[34:35], v34
    s_mov_b64 exec, -1
    v_cmpx_lt_i16 vcc, 0x3fff, v66
    ds_read_b64 v[36:37], v36
    s_mov_b64 exec, -1
    v_cmpx_lt_i16 vcc, 0x3fff, v67
    ds_read_b64 v[38:39], v38
    s_mov_b64 exec, -1
    v_cmpx_lt_i16 vcc, 0x3fff, v68
    ds_read_b64 v[40:41], v40
    s_mov_b64 exec, -1
    s_cmp_le_u32 s15, 7
    s_cbranch_scc1 p2_g2r17
    v_cmpx_lt_i16 vcc, 0x3fff, v69
    ds_read_b64 v[42:43], v42
    s_mov_b64 exec, -1
    v_cmpx_lt_i16 vcc, 0x3fff, v70
    ds_read_b64 v[44:45], v44
    s_mov_b64 exec, -1
    v_cmpx_lt_i16 vcc, 0x3fff, v71
    ds_read_b64 v[46:47], v46
    s_mov_b64 exec, -1
p2_g2r17:
    v_lshrrev_b32 v98, 3, v109
    v_lshrrev_b32 v99, 18, v109
    v_and_b32 v109, 0x3fff, v109
    v_and_or_b32 v98, v98, s65, v99
    v_mad_u32_u24 v109, v98, s63, v109
    buffer_load_dwordx4 v[98:101], v109, s[68:71], 0 offen
    s_waitcnt lgkmcnt(0)
    s_barrier
    s_waitcnt vmcnt(2)
    s_mov_b32 m0, s24
    s_cmp_ge_u32 s10, 9
    s_cbranch_scc1 p2_st2s2
    ds_write_addtid_b32 v84 offset:49152
    ds_write_addtid_b32 v85 offset:49408
p2_st2s2:
    s_mov_b32 m0, s23
    s_mul_i32 s20, s60, 645120
    s_add_u32 s20, s20, s62
    ds_write_addtid_b32 v72 offset:0
    ds_write_addtid_b32 v73 offset:256
    ds_write_addtid_b32 v74 offset:512
    ds_write_addtid_b32 v75 offset:768
    ds_write_addtid_b32 v76 offset:1024
    ds_write_addtid_b32 v77 offset:1280
    ds_write_addtid_b32 v78 offset:1536
    ds_write_addtid_b32 v79 offset:1792
    ds_write_addtid_b32 v80 offset:2048
    ds_write_addtid_b32 v81 offset:2304
    ds_write_addtid_b32 v82 offset:2560
    ds_write_addtid_b32 v83 offset:2816
    s_waitcnt lgkmcnt(0)
    s_barrier
    s_branch p2_top
p2_fin:
    s_waitcnt vmcnt(0) lgkmcnt(0)
    s_barrier
    s_mov_b32 s48, s11
    s_mul_i32 s44, s48, 800768
    s_mul_i32 s45, s12, 12512
    s_add_u32 s49, s44, s45
    s_lshl_b32 s44, s49, 3
    s_add_u32 s44, s44, 363410432
    s_lshl_b32 s48, s48, 2
    s_lshl_b32 s45, s12, 4
    s_add_u32 s48, s48, s45
    s_add_u32 s48, s48, 363409408
    v_add_u32 v123, s64, v112
    v_add_u32 v122, s25, v123
    v_mov_b32 v24, 0
    v_mov_b32 v25, 0
    v_mov_b32 v26, 0
    v_mov_b32 v27, 0
    v_cmp_gt_u32 vcc, 1792, v123
    v_mov_b32 v124, 0x38000000
    v_mov_b32 v126, 0
    v_cndmask_b32 v124, v124, v123, vcc
    ds_read_b128 v[0:3], v122 offset:0
    ds_read_b128 v[4:7], v122 offset:16384
    ds_read_b128 v[8:11], v122 offset:32768
    v_add_u32 v122, 49152, v122
    ds_read_b128 v[12:15], v122 offset:0
    ds_read_b128 v[16:19], v122 offset:16384
    ds_read_b128 v[20:23], v122 offset:32768
    s_mov_b64 exec, vcc
    ds_read_b128 v[24:27], v122 offset:49152
    s_mov_b64 exec, -1
    s_cmp_lg_u32 s21, 0
    s_cbranch_scc1 p2_finf
    s_waitcnt lgkmcnt(6)
    buffer_store_dwordx4 v[0:3], v123, s[4:7], s44 offen
    s_add_u32 s44, s44, 16384
    s_waitcnt lgkmcnt(5)
    buffer_store_dwordx4 v[4:7], v123, s[4:7], s44 offen
    s_add_u32 s44, s44, 16384
    s_waitcnt lgkmcnt(4)
    buffer_store_dwordx4 v[8:11], v123, s[4:7], s44 offen
    s_add_u32 s44, s44, 16384
    s_waitcnt lgkmcnt(3)
    buffer_store_dwordx4 v[12:15], v123, s[4:7], s44 offen
    s_add_u32 s44, s44, 16384
    s_waitcnt lgkmcnt(2)
    buffer_store_dwordx4 v[16:19], v123, s[4:7], s44 offen
    s_add_u32 s44, s44, 16384
    s_waitcnt lgkmcnt(1)
    buffer_store_dwordx4 v[20:23], v123, s[4:7], s44 offen
    s_add_u32 s44, s44, 16384
    s_waitcnt lgkmcnt(0)
    buffer_store_dwordx4 v[24:27], v124, s[4:7], s44 offen
    s_add_u32 s44, s44, 16384
    v_bitop3_b32 v115, v115, v0, v1 bitop3:0xfe
    v_bitop3_b32 v115, v115, v2, v3 bitop3:0xfe
    v_bitop3_b32 v115, v115, v4, v5 bitop3:0xfe
    v_bitop3_b32 v115, v115, v6, v7 bitop3:0xfe
    v_bitop3_b32 v115, v115, v8, v9 bitop3:0xfe
    v_bitop3_b32 v115, v115, v10, v11 bitop3:0xfe
    v_bitop3_b32 v115, v115, v12, v13 bitop3:0xfe
    v_bitop3_b32 v115, v115, v14, v15 bitop3:0xfe
    v_bitop3_b32 v115, v115, v16, v17 bitop3:0xfe
    v_bitop3_b32 v115, v115, v18, v19 bitop3:0xfe
    v_bitop3_b32 v115, v115, v20, v21 bitop3:0xfe
    v_bitop3_b32 v115, v115, v22, v23 bitop3:0xfe
    v_bitop3_b32 v115, v115, v24, v25 bitop3:0xfe
    v_bitop3_b32 v115, v115, v26, v27 bitop3:0xfe
    v_bitop3_b32 v115, v115, v116, v117 bitop3:0xfe
    v_bitop3_b32 v115, v115, v118, v119 bitop3:0xfe
    v_bitop3_b32 v115, v115, v120, v121 bitop3:0xfe
    v_and_b32 v115, 0x80008000, v115
    v_cmpx_ne_u32 vcc, 0, v115
    ds_write_b32 v126, v115 offset:53768
    s_mov_b64 exec, -1
    s_waitcnt lgkmcnt(0)
    s_barrier
    ds_read_b32 v125, v126 offset:53768
    s_waitcnt lgkmcnt(0)
    v_readfirstlane_b32 s45, v125
    s_nop 0
    s_cmp_eq_u32 s45, 0
    s_cbranch_scc1 p2_done
    s_mov_b32 s21, 1
    s_waitcnt vmcnt(0)
    s_branch p2_restart
p2_finf:
    s_lshl_b32 s49, s49, 4
    s_lshl_b32 s45, s21, 3
    s_add_u32 s49, s49, s45
    s_add_u32 s49, s49, 389035000
    v_mov_b32 v28, 1073758208
    v_mov_b32 v29, 1073758208
    v_mov_b32 v30, 1073758208
    v_mov_b32 v31, 1073758208
    v_lshlrev_b32 v122, 1, v123
    v_lshlrev_b32 v125, 1, v124
    s_waitcnt lgkmcnt(0)
    buffer_store_dwordx4 v[28:31], v123, s[4:7], s44 offen
    s_add_u32 s44, s44, 16384
    buffer_store_dwordx2 v[0:1], v122, s[4:7], s49 offen offset:0
    buffer_store_dwordx2 v[2:3], v122, s[4:7], s49 offen offset:16
    s_add_u32 s49, s49, 32768
    buffer_store_dwordx4 v[28:31], v123, s[4:7], s44 offen
    s_add_u32 s44, s44, 16384
    buffer_store_dwordx2 v[4:5], v122, s[4:7], s49 offen offset:0
    buffer_store_dwordx2 v[6:7], v122, s[4:7], s49 offen offset:16
    s_add_u32 s49, s49, 32768
    buffer_store_dwordx4 v[28:31], v123, s[4:7], s44 offen
    s_add_u32 s44, s44, 16384
    buffer_store_dwordx2 v[8:9], v122, s[4:7], s49 offen offset:0
    buffer_store_dwordx2 v[10:11], v122, s[4:7], s49 offen offset:16
    s_add_u32 s49, s49, 32768
    buffer_store_dwordx4 v[28:31], v123, s[4:7], s44 offen
    s_add_u32 s44, s44, 16384
    buffer_store_dwordx2 v[12:13], v122, s[4:7], s49 offen offset:0
    buffer_store_dwordx2 v[14:15], v122, s[4:7], s49 offen offset:16
    s_add_u32 s49, s49, 32768
    buffer_store_dwordx4 v[28:31], v123, s[4:7], s44 offen
    s_add_u32 s44, s44, 16384
    buffer_store_dwordx2 v[16:17], v122, s[4:7], s49 offen offset:0
    buffer_store_dwordx2 v[18:19], v122, s[4:7], s49 offen offset:16
    s_add_u32 s49, s49, 32768
    buffer_store_dwordx4 v[28:31], v123, s[4:7], s44 offen
    s_add_u32 s44, s44, 16384
    buffer_store_dwordx2 v[20:21], v122, s[4:7], s49 offen offset:0
    buffer_store_dwordx2 v[22:23], v122, s[4:7], s49 offen offset:16
    s_add_u32 s49, s49, 32768
    buffer_store_dwordx4 v[28:31], v124, s[4:7], s44 offen
    s_add_u32 s44, s44, 16384
    buffer_store_dwordx2 v[24:25], v125, s[4:7], s49 offen offset:0
    buffer_store_dwordx2 v[26:27], v125, s[4:7], s49 offen offset:16
    s_add_u32 s49, s49, 32768
    s_add_u32 s21, s21, 1
    s_mov_b32 s30, 0
    s_waitcnt vmcnt(0)
    s_cmp_eq_u32 s21, 2
    s_cbranch_scc1 p2_restart
p2_done:
    v_mov_b32 v125, s30
    buffer_store_dword v125, v126, s[4:7], s48 offen
p2_end:
    s_endpgm
.globl p3_kernel
.p2align 8
.type p3_kernel,@function
p3_kernel:
    s_cmp_ge_u32 s2, 3125
    s_cbranch_scc1 p3_end
    s_load_dwordx2 s[4:5], s[0:1], 0
    s_load_dwordx2 s[6:7], s[0:1], 24
    s_load_dwordx2 s[8:9], s[0:1], 40
    s_load_dwordx8 s[12:19], s[0:1], 56
    s_load_dwordx2 s[10:11], s[0:1], 88
    s_load_dwordx2 s[20:21], s[0:1], 104
    s_lshl_b32 s3, s2, 8
    v_add_u32 v0, s3, v0
    v_lshlrev_b32 v2, 3, v0
    v_lshlrev_b32 v3, 1, v0
    s_waitcnt lgkmcnt(0)
    s_load_dwordx4 s[40:43], s[8:9], 0
    s_load_dwordx16 s[44:59], s[12:13], 0
    s_load_dwordx16 s[60:75], s[14:15], 0
    s_load_dwordx8 s[76:83], s[16:17], 0
    s_load_dwordx8 s[84:91], s[18:19], 0
    s_mov_b32 s24, s4
    s_and_b32 s25, s5, 0xffff
    s_mov_b32 s26, 6400000
    s_mov_b32 s27, 0x20000
    s_mov_b32 s28, s6
    s_and_b32 s29, s7, 0xffff
    s_mov_b32 s30, 1600000
    s_mov_b32 s31, 0x20000
    s_mov_b32 s32, s10
    s_and_b32 s33, s11, 0xffff
    s_mov_b32 s34, 6400000
    s_mov_b32 s35, 0x20000
    s_mov_b32 s36, s20
    s_and_b32 s37, s21, 0xffff
    s_mov_b32 s38, 819200000
    s_mov_b32 s39, 0x20000
    buffer_load_ushort v14, v3, s[28:31], 0 offen
    s_mov_b32 s22, 343268
    v_mul_hi_u32_u24 v1, s22, v0
    v_lshlrev_b32 v1, 4, v1
    s_mov_b32 s22, 363409408
    buffer_load_dwordx4 v[48:51], v1, s[36:39], s22 offen
    s_mov_b32 s22, 363410432
    buffer_load_dwordx2 v[32:33], v2, s[36:39], s22 offen
    s_mov_b32 s22, 369816576
    buffer_load_dwordx2 v[34:35], v2, s[36:39], s22 offen
    s_mov_b32 s22, 376222720
    buffer_load_dwordx2 v[36:37], v2, s[36:39], s22 offen
    s_mov_b32 s22, 382628864
    buffer_load_dwordx2 v[38:39], v2, s[36:39], s22 offen
    buffer_load_dwordx2 v[12:13], v2, s[24:27], 0 offen
    s_mov_b32 s92, 0xffff0000
    s_waitcnt vmcnt(6) lgkmcnt(0)
    v_lshlrev_b32 v14, 16, v14
    s_lshl_b32 s94, s40, 16
    v_subrev_f32 v16, s94, v14
    s_and_b32 s95, s40, s92
    v_subrev_f32 v17, s95, v14
    s_lshl_b32 s96, s41, 16
    v_subrev_f32 v18, s96, v14
    s_and_b32 s93, s41, s92
    v_subrev_f32 v19, s93, v14
    s_lshl_b32 s94, s42, 16
    v_subrev_f32 v20, s94, v14
    s_and_b32 s95, s42, s92
    v_subrev_f32 v21, s95, v14
    s_lshl_b32 s96, s43, 16
    v_subrev_f32 v22, s96, v14
    s_and_b32 s93, s43, s92
    v_subrev_f32 v23, s93, v14
    v_cvt_pk_bf16_f32 v16, v16, v17
    v_cvt_pk_bf16_f32 v18, v18, v19
    v_cvt_pk_bf16_f32 v20, v20, v21
    v_cvt_pk_bf16_f32 v22, v22, v23
    v_and_b32 v17, s92, v16
    v_lshlrev_b32 v16, 16, v16
    v_and_b32 v19, s92, v18
    v_lshlrev_b32 v18, 16, v18
    v_and_b32 v21, s92, v20
    v_lshlrev_b32 v20, 16, v20
    v_and_b32 v23, s92, v22
    v_lshlrev_b32 v22, 16, v22
    v_mul_f32 v16, v16, v16
    v_mul_f32 v17, v17, v17
    v_mul_f32 v18, v18, v18
    v_mul_f32 v19, v19, v19
    v_mul_f32 v20, v20, v20
    v_mul_f32 v21, v21, v21
    v_mul_f32 v22, v22, v22
    v_mul_f32 v23, v23, v23
    v_cvt_pk_bf16_f32 v16, v16, v17
    v_cvt_pk_bf16_f32 v18, v18, v19
    v_cvt_pk_bf16_f32 v20, v20, v21
    v_cvt_pk_bf16_f32 v22, v22, v23
    v_and_b32 v17, s92, v16
    v_lshlrev_b32 v16, 16, v16
    v_and_b32 v19, s92, v18
    v_lshlrev_b32 v18, 16, v18
    v_and_b32 v21, s92, v20
    v_lshlrev_b32 v20, 16, v20
    v_and_b32 v23, s92, v22
    v_lshlrev_b32 v22, 16, v22
    v_mul_f32 v16, 0xc1200000, v16
    v_mul_f32 v17, 0xc1200000, v17
    v_mul_f32 v18, 0xc1200000, v18
    v_mul_f32 v19, 0xc1200000, v19
    v_mul_f32 v20, 0xc1200000, v20
    v_mul_f32 v21, 0xc1200000, v21
    v_mul_f32 v22, 0xc1200000, v22
    v_mul_f32 v23, 0xc1200000, v23
    v_cvt_pk_bf16_f32 v16, v16, v17
    v_cvt_pk_bf16_f32 v18, v18, v19
    v_cvt_pk_bf16_f32 v20, v20, v21
    v_cvt_pk_bf16_f32 v22, v22, v23
    v_and_b32 v17, s92, v16
    v_lshlrev_b32 v16, 16, v16
    v_and_b32 v19, s92, v18
    v_lshlrev_b32 v18, 16, v18
    v_and_b32 v21, s92, v20
    v_lshlrev_b32 v20, 16, v20
    v_and_b32 v23, s92, v22
    v_lshlrev_b32 v22, 16, v22
    v_mul_f32 v16, 0x3fb8aa3b, v16
    v_mul_f32 v17, 0x3fb8aa3b, v17
    v_mul_f32 v18, 0x3fb8aa3b, v18
    v_mul_f32 v19, 0x3fb8aa3b, v19
    v_mul_f32 v20, 0x3fb8aa3b, v20
    v_mul_f32 v21, 0x3fb8aa3b, v21
    v_mul_f32 v22, 0x3fb8aa3b, v22
    v_mul_f32 v23, 0x3fb8aa3b, v23
    v_exp_f32 v16, v16
    v_exp_f32 v17, v17
    v_exp_f32 v18, v18
    v_exp_f32 v19, v19
    v_exp_f32 v20, v20
    v_exp_f32 v21, v21
    v_exp_f32 v22, v22
    v_exp_f32 v23, v23
    s_nop 0
    v_cvt_pk_bf16_f32 v16, v16, v17
    v_cvt_pk_bf16_f32 v18, v18, v19
    v_cvt_pk_bf16_f32 v20, v20, v21
    v_cvt_pk_bf16_f32 v22, v22, v23
    v_and_b32 v17, s92, v16
    v_lshlrev_b32 v16, 16, v16
    v_and_b32 v19, s92, v18
    v_lshlrev_b32 v18, 16, v18
    v_and_b32 v21, s92, v20
    v_lshlrev_b32 v20, 16, v20
    v_and_b32 v23, s92, v22
    v_lshlrev_b32 v22, 16, v22
    s_lshl_b32 s94, s60, 16
    v_mul_f32 v24, s94, v16
    s_and_b32 s95, s60, s92
    v_mul_f32 v25, s95, v16
    s_lshl_b32 s96, s61, 16
    v_mul_f32 v26, s96, v16
    s_and_b32 s93, s61, s92
    v_mul_f32 v27, s93, v16
    s_lshl_b32 s94, s62, 16
    v_fmac_f32 v24, s94, v17
    s_and_b32 s95, s62, s92
    v_fmac_f32 v25, s95, v17
    s_lshl_b32 s96, s63, 16
    v_fmac_f32 v26, s96, v17
    s_and_b32 s93, s63, s92
    v_fmac_f32 v27, s93, v17
    s_lshl_b32 s94, s64, 16
    v_fmac_f32 v24, s94, v18
    s_and_b32 s95, s64, s92
    v_fmac_f32 v25, s95, v18
    s_lshl_b32 s96, s65, 16
    v_fmac_f32 v26, s96, v18
    s_and_b32 s93, s65, s92
    v_fmac_f32 v27, s93, v18
    s_lshl_b32 s94, s66, 16
    v_fmac_f32 v24, s94, v19
    s_and_b32 s95, s66, s92
    v_fmac_f32 v25, s95, v19
    s_lshl_b32 s96, s67, 16
    v_fmac_f32 v26, s96, v19
    s_and_b32 s93, s67, s92
    v_fmac_f32 v27, s93, v19
    s_lshl_b32 s94, s68, 16
    v_fmac_f32 v24, s94, v20
    s_and_b32 s95, s68, s92
    v_fmac_f32 v25, s95, v20
    s_lshl_b32 s96, s69, 16
    v_fmac_f32 v26, s96, v20
    s_and_b32 s93, s69, s92
    v_fmac_f32 v27, s93, v20
    s_lshl_b32 s94, s70, 16
    v_fmac_f32 v24, s94, v21
    s_and_b32 s95, s70, s92
    v_fmac_f32 v25, s95, v21
    s_lshl_b32 s96, s71, 16
    v_fmac_f32 v26, s96, v21
    s_and_b32 s93, s71, s92
    v_fmac_f32 v27, s93, v21
    s_lshl_b32 s94, s72, 16
    v_fmac_f32 v24, s94, v22
    s_and_b32 s95, s72, s92
    v_fmac_f32 v25, s95, v22
    s_lshl_b32 s96, s73, 16
    v_fmac_f32 v26, s96, v22
    s_and_b32 s93, s73, s92
    v_fmac_f32 v27, s93, v22
    s_lshl_b32 s94, s74, 16
    v_fmac_f32 v24, s94, v23
    s_and_b32 s95, s74, s92
    v_fmac_f32 v25, s95, v23
    s_lshl_b32 s96, s75, 16
    v_fmac_f32 v26, s96, v23
    s_and_b32 s93, s75, s92
    v_fmac_f32 v27, s93, v23
    s_lshl_b32 s94, s44, 16
    v_mul_f32 v28, s94, v16
    s_and_b32 s95, s44, s92
    v_mul_f32 v29, s95, v16
    s_lshl_b32 s96, s45, 16
    v_mul_f32 v30, s96, v16
    s_and_b32 s93, s45, s92
    v_mul_f32 v31, s93, v16
    s_lshl_b32 s94, s46, 16
    v_fmac_f32 v28, s94, v17
    s_and_b32 s95, s46, s92
    v_fmac_f32 v29, s95, v17
    s_lshl_b32 s96, s47, 16
    v_fmac_f32 v30, s96, v17
    s_and_b32 s93, s47, s92
    v_fmac_f32 v31, s93, v17
    s_lshl_b32 s94, s48, 16
    v_fmac_f32 v28, s94, v18
    s_and_b32 s95, s48, s92
    v_fmac_f32 v29, s95, v18
    s_lshl_b32 s96, s49, 16
    v_fmac_f32 v30, s96, v18
    s_and_b32 s93, s49, s92
    v_fmac_f32 v31, s93, v18
    s_lshl_b32 s94, s50, 16
    v_fmac_f32 v28, s94, v19
    s_and_b32 s95, s50, s92
    v_fmac_f32 v29, s95, v19
    s_lshl_b32 s96, s51, 16
    v_fmac_f32 v30, s96, v19
    s_and_b32 s93, s51, s92
    v_fmac_f32 v31, s93, v19
    s_lshl_b32 s94, s52, 16
    v_fmac_f32 v28, s94, v20
    s_and_b32 s95, s52, s92
    v_fmac_f32 v29, s95, v20
    s_lshl_b32 s96, s53, 16
    v_fmac_f32 v30, s96, v20
    s_and_b32 s93, s53, s92
    v_fmac_f32 v31, s93, v20
    s_lshl_b32 s94, s54, 16
    v_fmac_f32 v28, s94, v21
    s_and_b32 s95, s54, s92
    v_fmac_f32 v29, s95, v21
    s_lshl_b32 s96, s55, 16
    v_fmac_f32 v30, s96, v21
    s_and_b32 s93, s55, s92
    v_fmac_f32 v31, s93, v21
    s_lshl_b32 s94, s56, 16
    v_fmac_f32 v28, s94, v22
    s_and_b32 s95, s56, s92
    v_fmac_f32 v29, s95, v22
    s_lshl_b32 s96, s57, 16
    v_fmac_f32 v30, s96, v22
    s_and_b32 s93, s57, s92
    v_fmac_f32 v31, s93, v22
    s_lshl_b32 s94, s58, 16
    v_fmac_f32 v28, s94, v23
    s_and_b32 s95, s58, s92
    v_fmac_f32 v29, s95, v23
    s_lshl_b32 s96, s59, 16
    v_fmac_f32 v30, s96, v23
    s_and_b32 s93, s59, s92
    v_fmac_f32 v31, s93, v23
    v_cvt_pk_bf16_f32 v28, v28, v29
    v_cvt_pk_bf16_f32 v30, v30, v31
    v_and_b32 v29, s92, v28
    v_lshlrev_b32 v28, 16, v28
    v_and_b32 v31, s92, v30
    v_lshlrev_b32 v30, 16, v30
    s_waitcnt vmcnt(0)
    v_mov_b32 v4, -65536
    v_mov_b32 v5, -65536
    v_mov_b32 v6, -65536
    v_mov_b32 v7, -65536
    v_add_u32_sdwa v4, v4, v32 dst_sel:DWORD dst_unused:UNUSED_PAD src0_sel:DWORD src1_sel:WORD_0
    v_add_u32_sdwa v5, v5, v32 dst_sel:DWORD dst_unused:UNUSED_PAD src0_sel:DWORD src1_sel:WORD_1
    v_add_u32_sdwa v6, v6, v33 dst_sel:DWORD dst_unused:UNUSED_PAD src0_sel:DWORD src1_sel:WORD_0
    v_add_u32_sdwa v7, v7, v33 dst_sel:DWORD dst_unused:UNUSED_PAD src0_sel:DWORD src1_sel:WORD_1
    v_add_u32_sdwa v4, v4, v34 dst_sel:DWORD dst_unused:UNUSED_PAD src0_sel:DWORD src1_sel:WORD_0
    v_add_u32_sdwa v5, v5, v34 dst_sel:DWORD dst_unused:UNUSED_PAD src0_sel:DWORD src1_sel:WORD_1
    v_add_u32_sdwa v6, v6, v35 dst_sel:DWORD dst_unused:UNUSED_PAD src0_sel:DWORD src1_sel:WORD_0
    v_add_u32_sdwa v7, v7, v35 dst_sel:DWORD dst_unused:UNUSED_PAD src0_sel:DWORD src1_sel:WORD_1
    v_add_u32_sdwa v4, v4, v36 dst_sel:DWORD dst_unused:UNUSED_PAD src0_sel:DWORD src1_sel:WORD_0
    v_add_u32_sdwa v5, v5, v36 dst_sel:DWORD dst_unused:UNUSED_PAD src0_sel:DWORD src1_sel:WORD_1
    v_add_u32_sdwa v6, v6, v37 dst_sel:DWORD dst_unused:UNUSED_PAD src0_sel:DWORD src1_sel:WORD_0
    v_add_u32_sdwa v7, v7, v37 dst_sel:DWORD dst_unused:UNUSED_PAD src0_sel:DWORD src1_sel:WORD_1
    v_add_u32_sdwa v4, v4, v38 dst_sel:DWORD dst_unused:UNUSED_PAD src0_sel:DWORD src1_sel:WORD_0
    v_add_u32_sdwa v5, v5, v38 dst_sel:DWORD dst_unused:UNUSED_PAD src0_sel:DWORD src1_sel:WORD_1
    v_add_u32_sdwa v6, v6, v39 dst_sel:DWORD dst_unused:UNUSED_PAD src0_sel:DWORD src1_sel:WORD_0
    v_add_u32_sdwa v7, v7, v39 dst_sel:DWORD dst_unused:UNUSED_PAD src0_sel:DWORD src1_sel:WORD_1
    v_max3_u32 v14, v48, v49, v50
    v_min3_u32 v15, v48, v49, v50
    v_max_u32 v14, v14, v51
    v_min_u32 v15, v15, v51
    v_cvt_f32_i32 v4, v4
    v_cvt_f32_i32 v5, v5
    v_cvt_f32_i32 v6, v6
    v_cvt_f32_i32 v7, v7
    v_cmp_eq_u32 vcc, 0, v15
    v_mul_f32 v4, v14, v4
    v_mul_f32 v5, v14, v5
    v_mul_f32 v6, v14, v6
    v_mul_f32 v7, v14, v7
    s_cbranch_vccz p3_nof
    v_lshlrev_b32 v1, 4, v0
    v_mov_b32 v3, 0x70000000
    v_cmp_eq_u32 vcc, 0, v48
    s_mov_b32 s22, 389035008
    s_nop 0
    v_cndmask_b32 v15, v3, v1, vcc
    buffer_load_dwordx4 v[8:11], v15, s[36:39], s22 offen
    s_waitcnt vmcnt(0)
    v_add_f32 v4, v4, v8
    v_add_f32 v5, v5, v9
    v_add_f32 v6, v6, v10
    v_add_f32 v7, v7, v11
    v_cmp_eq_u32 vcc, 0, v49
    s_mov_b32 s22, 401847296
    s_nop 0
    v_cndmask_b32 v15, v3, v1, vcc
    buffer_load_dwordx4 v[8:11], v15, s[36:39], s22 offen
    s_waitcnt vmcnt(0)
    v_add_f32 v4, v4, v8
    v_add_f32 v5, v5, v9
    v_add_f32 v6, v6, v10
    v_add_f32 v7, v7, v11
    v_cmp_eq_u32 vcc, 0, v50
    s_mov_b32 s22, 414659584
    s_nop 0
    v_cndmask_b32 v15, v3, v1, vcc
    buffer_load_dwordx4 v[8:11], v15, s[36:39], s22 offen
    s_waitcnt vmcnt(0)
    v_add_f32 v4, v4, v8
    v_add_f32 v5, v5, v9
    v_add_f32 v6, v6, v10
    v_add_f32 v7, v7, v11
    v_cmp_eq_u32 vcc, 0, v51
    s_mov_b32 s22, 427471872
    s_nop 0
    v_cndmask_b32 v15, v3, v1, vcc
    buffer_load_dwordx4 v[8:11], v15, s[36:39], s22 offen
    s_waitcnt vmcnt(0)
    v_add_f32 v4, v4, v8
    v_add_f32 v5, v5, v9
    v_add_f32 v6, v6, v10
    v_add_f32 v7, v7, v11
p3_nof:
    s_lshl_b32 s94, s76, 16
    v_mul_f32 v8, s94, v4
    s_and_b32 s95, s76, s92
    v_mul_f32 v9, s95, v4
    s_lshl_b32 s96, s77, 16
    v_mul_f32 v10, s96, v4
    s_and_b32 s93, s77, s92
    v_mul_f32 v11, s93, v4
    s_lshl_b32 s94, s78, 16
    v_fmac_f32 v8, s94, v5
    s_and_b32 s95, s78, s92
    v_fmac_f32 v9, s95, v5
    s_lshl_b32 s96, s79, 16
    v_fmac_f32 v10, s96, v5
    s_and_b32 s93, s79, s92
    v_fmac_f32 v11, s93, v5
    s_lshl_b32 s94, s80, 16
    v_fmac_f32 v8, s94, v6
    s_and_b32 s95, s80, s92
    v_fmac_f32 v9, s95, v6
    s_lshl_b32 s96, s81, 16
    v_fmac_f32 v10, s96, v6
    s_and_b32 s93, s81, s92
    v_fmac_f32 v11, s93, v6
    s_lshl_b32 s94, s82, 16
    v_fmac_f32 v8, s94, v7
    s_and_b32 s95, s82, s92
    v_fmac_f32 v9, s95, v7
    s_lshl_b32 s96, s83, 16
    v_fmac_f32 v10, s96, v7
    s_and_b32 s93, s83, s92
    v_fmac_f32 v11, s93, v7
    v_mul_f32 v24, v24, v8
    v_mul_f32 v25, v25, v9
    v_mul_f32 v26, v26, v10
    v_mul_f32 v27, v27, v11
    v_cvt_pk_bf16_f32 v24, v24, v25
    v_cvt_pk_bf16_f32 v26, v26, v27
    v_and_b32 v25, s92, v24
    v_lshlrev_b32 v24, 16, v24
    v_and_b32 v27, s92, v26
    v_lshlrev_b32 v26, 16, v26
    s_lshl_b32 s94, s84, 16
    v_mul_f32 v8, s94, v24
    s_and_b32 s95, s84, s92
    v_mul_f32 v9, s95, v24
    s_lshl_b32 s96, s85, 16
    v_mul_f32 v10, s96, v24
    s_and_b32 s93, s85, s92
    v_mul_f32 v11, s93, v24
    s_lshl_b32 s94, s86, 16
    v_fmac_f32 v8, s94, v25
    s_and_b32 s95, s86, s92
    v_fmac_f32 v9, s95, v25
    s_lshl_b32 s96, s87, 16
    v_fmac_f32 v10, s96, v25
    s_and_b32 s93, s87, s92
    v_fmac_f32 v11, s93, v25
    s_lshl_b32 s94, s88, 16
    v_fmac_f32 v8, s94, v26
    s_and_b32 s95, s88, s92
    v_fmac_f32 v9, s95, v26
    s_lshl_b32 s96, s89, 16
    v_fmac_f32 v10, s96, v26
    s_and_b32 s93, s89, s92
    v_fmac_f32 v11, s93, v26
    s_lshl_b32 s94, s90, 16
    v_fmac_f32 v8, s94, v27
    s_and_b32 s95, s90, s92
    v_fmac_f32 v9, s95, v27
    s_lshl_b32 s96, s91, 16
    v_fmac_f32 v10, s96, v27
    s_and_b32 s93, s91, s92
    v_fmac_f32 v11, s93, v27
    v_cvt_pk_bf16_f32 v8, v8, v9
    v_cvt_pk_bf16_f32 v10, v10, v11
    v_and_b32 v9, s92, v8
    v_lshlrev_b32 v8, 16, v8
    v_and_b32 v11, s92, v10
    v_lshlrev_b32 v10, 16, v10
    v_mul_f32 v8, v8, v28
    v_mul_f32 v9, v9, v29
    v_mul_f32 v10, v10, v30
    v_mul_f32 v11, v11, v31
    v_cvt_pk_bf16_f32 v8, v8, v9
    v_cvt_pk_bf16_f32 v10, v10, v11
    v_and_b32 v9, s92, v8
    v_lshlrev_b32 v8, 16, v8
    v_and_b32 v11, s92, v10
    v_lshlrev_b32 v10, 16, v10
    v_lshlrev_b32 v4, 16, v12
    v_and_b32 v5, s92, v12
    v_lshlrev_b32 v6, 16, v13
    v_and_b32 v7, s92, v13
    v_add_f32 v4, v4, v8
    v_add_f32 v5, v5, v9
    v_add_f32 v6, v6, v10
    v_add_f32 v7, v7, v11
    v_cvt_pk_bf16_f32 v4, v4, v5
    v_cvt_pk_bf16_f32 v5, v6, v7
    buffer_store_dwordx2 v[4:5], v2, s[32:35], 0 offen
p3_end:
    s_endpgm
.section .rodata,"a"
.p2align 6
.amdhsa_kernel p1_kernel
  .amdhsa_next_free_vgpr 128
  .amdhsa_next_free_sgpr 92
  .amdhsa_accum_offset 128
  .amdhsa_group_segment_fixed_size 0
  .amdhsa_kernarg_size 112
  .amdhsa_user_sgpr_count 2
  .amdhsa_user_sgpr_kernarg_segment_ptr 1
  .amdhsa_system_sgpr_workgroup_id_x 1
  .amdhsa_float_denorm_mode_32 3
.end_amdhsa_kernel
.p2align 6
.amdhsa_kernel p2_kernel
  .amdhsa_next_free_vgpr 128
  .amdhsa_next_free_sgpr 72
  .amdhsa_accum_offset 128
  .amdhsa_group_segment_fixed_size 0
  .amdhsa_kernarg_size 112
  .amdhsa_user_sgpr_count 2
  .amdhsa_user_sgpr_kernarg_segment_ptr 1
  .amdhsa_system_sgpr_workgroup_id_x 1
  .amdhsa_float_denorm_mode_32 3
.end_amdhsa_kernel
.p2align 6
.amdhsa_kernel p3_kernel
  .amdhsa_next_free_vgpr 56
  .amdhsa_next_free_sgpr 100
  .amdhsa_accum_offset 56
  .amdhsa_group_segment_fixed_size 0
  .amdhsa_kernarg_size 112
  .amdhsa_user_sgpr_count 2
  .amdhsa_user_sgpr_kernarg_segment_ptr 1
  .amdhsa_system_sgpr_workgroup_id_x 1
  .amdhsa_float_denorm_mode_32 3
.end_amdhsa_kernel
```

```asm
; @launch kernel=p1_kernel grid=(256,1,1) block=(1024,1,1) lds=161600
; @launch kernel=p2_kernel grid=(256,1,1) block=(1024,1,1) lds=154368
; @launch kernel=p3_kernel grid=(1563,1,1) block=(256,1,1) lds=0
.amdgcn_target "amdgcn-amd-amdhsa--gfx950"
.text
.globl p1_kernel
.p2align 8
.type p1_kernel,@function
p1_kernel:
    s_cmp_ge_u32 s2, 256
    s_cbranch_scc1 p1_end
    s_load_dwordx2 s[52:53], s[0:1], 0
    s_load_dwordx4 s[56:59], s[0:1], 8
    s_load_dwordx2 s[54:55], s[0:1], 32
    s_load_dwordx2 s[60:61], s[0:1], 48
    s_load_dwordx2 s[48:49], s[0:1], 104
    s_load_dwordx2 s[62:63], s[0:1], 96
    v_lshlrev_b32 v1, 4, v0
    v_lshlrev_b32 v2, 3, v0
    v_mov_b32 v3, 1
    v_lshrrev_b32 v117, 6, v0
    s_nop 0
    v_readfirstlane_b32 s28, v117
    s_waitcnt lgkmcnt(0)
    s_load_dword s45, s[60:61], 0
    s_mov_b32 s24, s52
    s_and_b32 s25, s53, 0xffff
    s_mov_b32 s26, 6400000
    s_mov_b32 s27, 0x20000
    s_mov_b32 s4, s56
    s_and_b32 s5, s57, 0xffff
    s_mov_b32 s6, 204800000
    s_mov_b32 s7, 0x20000
    s_mov_b32 s8, s58
    s_and_b32 s9, s59, 0xffff
    s_mov_b32 s10, 204800000
    s_mov_b32 s11, 0x20000
    s_mov_b32 s12, s54
    s_and_b32 s13, s55, 0xffff
    s_mov_b32 s14, 102400000
    s_mov_b32 s15, 0x20000
    s_mov_b32 s16, s48
    s_and_b32 s17, s49, 0xffff
    s_mov_b32 s18, 819200000
    s_mov_b32 s19, 0x20000
    s_mov_b32 s20, s48
    s_and_b32 s21, s49, 0xffff
    s_mov_b32 s22, 0
    s_mov_b32 s23, 0x20000
    s_mov_b32 s40, s62
    s_and_b32 s41, s63, 0xffff
    s_mov_b32 s42, 256
    s_mov_b32 s43, 0x20000
    s_mov_b32 s36, 643827
    s_mov_b32 s37, 214609
    s_mov_b32 s38, 343268
    s_mov_b32 s39, -6671
    s_mov_b32 s44, -12512
    s_waitcnt lgkmcnt(0)
    s_lshl_b32 s45, s45, 16
    s_mov_b32 s29, s2
    s_add_u32 s68, s2, 256
    s_cmp_lt_u32 s29, 1696
    s_cselect_b32 s34, 8, 0
    s_mul_i32 s47, s29, 392
    s_sub_i32 s50, s29, 1696
    s_max_i32 s50, s50, 0
    s_lshl_b32 s50, s50, 3
    s_sub_u32 s47, s47, s50
    s_lshl_b32 s30, s47, 8
    s_lshl_b32 s31, s47, 7
    s_add_u32 s32, s30, 0
    buffer_load_dwordx4 v[4:7], v1, s[4:7], s32 offen nt
    buffer_load_dwordx4 v[28:31], v1, s[8:11], s32 offen nt
    s_add_u32 s32, s31, 0
    buffer_load_dwordx2 v[52:53], v2, s[12:15], s32 offen nt
    s_add_u32 s32, s30, 16384
    buffer_load_dwordx4 v[8:11], v1, s[4:7], s32 offen nt
    buffer_load_dwordx4 v[32:35], v1, s[8:11], s32 offen nt
    s_add_u32 s32, s31, 8192
    buffer_load_dwordx2 v[54:55], v2, s[12:15], s32 offen nt
    s_add_u32 s32, s30, 32768
    buffer_load_dwordx4 v[12:15], v1, s[4:7], s32 offen nt
    buffer_load_dwordx4 v[36:39], v1, s[8:11], s32 offen nt
    s_add_u32 s32, s31, 16384
    buffer_load_dwordx2 v[56:57], v2, s[12:15], s32 offen nt
    s_add_u32 s32, s30, 49152
    buffer_load_dwordx4 v[16:19], v1, s[4:7], s32 offen nt
    buffer_load_dwordx4 v[40:43], v1, s[8:11], s32 offen nt
    s_add_u32 s32, s31, 24576
    buffer_load_dwordx2 v[58:59], v2, s[12:15], s32 offen nt
    s_add_u32 s32, s30, 65536
    buffer_load_dwordx4 v[20:23], v1, s[4:7], s32 offen nt
    buffer_load_dwordx4 v[44:47], v1, s[8:11], s32 offen nt
    s_add_u32 s32, s31, 32768
    buffer_load_dwordx2 v[60:61], v2, s[12:15], s32 offen nt
    s_add_u32 s32, s30, 81920
    buffer_load_dwordx4 v[24:27], v1, s[4:7], s32 offen nt
    buffer_load_dwordx4 v[48:51], v1, s[8:11], s32 offen nt
    s_add_u32 s32, s31, 40960
    buffer_load_dwordx2 v[62:63], v2, s[12:15], s32 offen nt
    s_cmp_lt_u32 s28, s34
    s_cselect_b32 s46, 0, 0x40000000
    v_lshl_add_u32 v117, v0, 2, s46
    s_add_u32 s32, s30, 98304
    buffer_load_dword v64, v117, s[4:7], s32 offen nt
    buffer_load_dword v65, v117, s[8:11], s32 offen nt
    v_lshrrev_b32 v117, 1, v117
    s_add_u32 s32, s31, 49152
    buffer_load_ushort v66, v117, s[12:15], s32 offen nt
    v_mov_b32 v68, 0
    v_mov_b32 v69, 0
    v_mov_b32 v70, 0
    v_mov_b32 v71, 0
    ds_write_b128 v1, v[68:71] offset:0
    s_waitcnt vmcnt(0) lgkmcnt(0)
    s_barrier
p1_tile:
    s_mov_b32 s33, s34
    s_cmp_lt_u32 s68, 1696
    s_cselect_b32 s34, 8, 0
    s_mul_i32 s47, s68, 392
    s_sub_i32 s50, s68, 1696
    s_max_i32 s50, s50, 0
    s_lshl_b32 s50, s50, 3
    s_sub_u32 s47, s47, s50
    s_lshl_b32 s30, s47, 8
    s_lshl_b32 s31, s47, 7
    v_mov_b32 v68, 0
    v_mov_b32 v69, 0
    v_mov_b32 v70, 0
    v_mov_b32 v71, 0
    ds_write_b128 v1, v[68:71] offset:10496
    ds_write_b128 v1, v[68:71] offset:26880
    s_waitcnt vmcnt(10)
    v_mov_b32 v123, s45
    v_mov_b32 v124, 0x007f007f
    v_mov_b32 v125, 0xe000
    v_mov_b32 v126, 0xffff0000
    v_lshlrev_b32 v117, 16, v52
    v_and_b32 v118, v126, v52
    v_mul_f32 v117, v123, v117
    v_mul_f32 v118, v123, v118
    v_cvt_pk_bf16_f32 v117, v117, v118
    v_and_b32 v118, v126, v117
    v_lshlrev_b32 v117, 16, v117
    v_mul_f32 v117, 0.15915494, v117
    v_mul_f32 v118, 0.15915494, v118
    v_fract_f32 v117, v117
    v_fract_f32 v118, v118
    v_cos_f32 v117, v117
    v_cos_f32 v118, v118
    v_mul_hi_u32_u24 v120, s36, v4
    v_mul_hi_u32_u24 v121, s37, v4
    v_mul_hi_u32_u24 v122, s38, v28
    v_mad_i32_i24 v67, v120, s39, v4
    v_mad_u32_u24 v92, v122, 40, v121
    v_mad_i32_i24 v120, v121, -3, v120
    v_lshlrev_b16 v92, 2, v92
    v_mad_i32_i24 v122, v122, s44, v28
    ds_add_u32 v92, v3 offset:0
    v_lshl_or_b32 v67, v120, 30, v67
    v_lshl_or_b32 v67, v122, 16, v67
    v_mul_f32 v117, 0x03800000, v117
    v_mul_f32 v118, 0x03800000, v118
    v_cvt_pk_bf16_f32 v117, v117, v118
    v_mul_hi_u32_u24 v120, s36, v5
    v_mul_hi_u32_u24 v121, s37, v5
    v_mul_hi_u32_u24 v122, s38, v29
    v_mad_i32_i24 v68, v120, s39, v5
    v_mad_u32_u24 v93, v122, 40, v121
    v_mad_i32_i24 v120, v121, -3, v120
    v_lshlrev_b16 v93, 2, v93
    v_mad_i32_i24 v122, v122, s44, v29
    ds_add_u32 v93, v3 offset:0
    v_lshl_or_b32 v68, v120, 30, v68
    v_lshl_or_b32 v68, v122, 16, v68
    v_lshrrev_b32 v118, 3, v117
    v_lshrrev_b32 v119, 8, v117
    v_lshlrev_b16 v117, 13, v117
    v_bitop3_b32 v119, v118, v119, v124 bitop3:0x1b
    v_bitop3_b32 v67, v117, v125, v67 bitop3:0xae
    v_lshl_or_b32 v92, v119, 16, v92
    v_bitop3_b32 v68, v118, v125, v68 bitop3:0xae
    v_bitop3_b32 v93, v119, v126, v93 bitop3:0xea
    v_lshlrev_b32 v117, 16, v53
    v_and_b32 v118, v126, v53
    v_mul_f32 v117, v123, v117
    v_mul_f32 v118, v123, v118
    v_cvt_pk_bf16_f32 v117, v117, v118
    v_and_b32 v118, v126, v117
    v_lshlrev_b32 v117, 16, v117
    v_mul_f32 v117, 0.15915494, v117
    v_mul_f32 v118, 0.15915494, v118
    v_fract_f32 v117, v117
    v_fract_f32 v118, v118
    v_cos_f32 v117, v117
    v_cos_f32 v118, v118
    v_mul_hi_u32_u24 v120, s36, v6
    v_mul_hi_u32_u24 v121, s37, v6
    v_mul_hi_u32_u24 v122, s38, v30
    v_mad_i32_i24 v69, v120, s39, v6
    v_mad_u32_u24 v94, v122, 40, v121
    v_mad_i32_i24 v120, v121, -3, v120
    v_lshlrev_b16 v94, 2, v94
    v_mad_i32_i24 v122, v122, s44, v30
    ds_add_u32 v94, v3 offset:0
    v_lshl_or_b32 v69, v120, 30, v69
    v_lshl_or_b32 v69, v122, 16, v69
    v_mul_f32 v117, 0x03800000, v117
    v_mul_f32 v118, 0x03800000, v118
    v_cvt_pk_bf16_f32 v117, v117, v118
    v_mul_hi_u32_u24 v120, s36, v7
    v_mul_hi_u32_u24 v121, s37, v7
    v_mul_hi_u32_u24 v122, s38, v31
    v_mad_i32_i24 v70, v120, s39, v7
    v_mad_u32_u24 v95, v122, 40, v121
    v_mad_i32_i24 v120, v121, -3, v120
    v_lshlrev_b16 v95, 2, v95
    v_mad_i32_i24 v122, v122, s44, v31
    ds_add_u32 v95, v3 offset:0
    v_lshl_or_b32 v70, v120, 30, v70
    v_lshl_or_b32 v70, v122, 16, v70
    v_lshrrev_b32 v118, 3, v117
    v_lshrrev_b32 v119, 8, v117
    v_lshlrev_b16 v117, 13, v117
    v_bitop3_b32 v119, v118, v119, v124 bitop3:0x1b
    v_bitop3_b32 v69, v117, v125, v69 bitop3:0xae
    v_lshl_or_b32 v94, v119, 16, v94
    v_bitop3_b32 v70, v118, v125, v70 bitop3:0xae
    v_bitop3_b32 v95, v119, v126, v95 bitop3:0xea
    v_lshlrev_b32 v117, 16, v54
    v_and_b32 v118, v126, v54
    v_mul_f32 v117, v123, v117
    v_mul_f32 v118, v123, v118
    v_cvt_pk_bf16_f32 v117, v117, v118
    v_and_b32 v118, v126, v117
    v_lshlrev_b32 v117, 16, v117
    v_mul_f32 v117, 0.15915494, v117
    v_mul_f32 v118, 0.15915494, v118
    v_fract_f32 v117, v117
    v_fract_f32 v118, v118
    v_cos_f32 v117, v117
    v_cos_f32 v118, v118
    v_mul_hi_u32_u24 v120, s36, v8
    v_mul_hi_u32_u24 v121, s37, v8
    v_mul_hi_u32_u24 v122, s38, v32
    v_mad_i32_i24 v71, v120, s39, v8
    v_mad_u32_u24 v96, v122, 40, v121
    v_mad_i32_i24 v120, v121, -3, v120
    v_lshlrev_b16 v96, 2, v96
    v_mad_i32_i24 v122, v122, s44, v32
    ds_add_u32 v96, v3 offset:0
    v_lshl_or_b32 v71, v120, 30, v71
    v_lshl_or_b32 v71, v122, 16, v71
    v_mul_f32 v117, 0x03800000, v117
    v_mul_f32 v118, 0x03800000, v118
    v_cvt_pk_bf16_f32 v117, v117, v118
    v_mul_hi_u32_u24 v120, s36, v9
    v_mul_hi_u32_u24 v121, s37, v9
    v_mul_hi_u32_u24 v122, s38, v33
    v_mad_i32_i24 v72, v120, s39, v9
    v_mad_u32_u24 v97, v122, 40, v121
    v_mad_i32_i24 v120, v121, -3, v120
    v_lshlrev_b16 v97, 2, v97
    v_mad_i32_i24 v122, v122, s44, v33
    ds_add_u32 v97, v3 offset:0
    v_lshl_or_b32 v72, v120, 30, v72
    v_lshl_or_b32 v72, v122, 16, v72
    v_lshrrev_b32 v118, 3, v117
    v_lshrrev_b32 v119, 8, v117
    v_lshlrev_b16 v117, 13, v117
    v_bitop3_b32 v119, v118, v119, v124 bitop3:0x1b
    v_bitop3_b32 v71, v117, v125, v71 bitop3:0xae
    v_lshl_or_b32 v96, v119, 16, v96
    v_bitop3_b32 v72, v118, v125, v72 bitop3:0xae
    v_bitop3_b32 v97, v119, v126, v97 bitop3:0xea
    v_lshlrev_b32 v117, 16, v55
    v_and_b32 v118, v126, v55
    v_mul_f32 v117, v123, v117
    v_mul_f32 v118, v123, v118
    v_cvt_pk_bf16_f32 v117, v117, v118
    v_and_b32 v118, v126, v117
    v_lshlrev_b32 v117, 16, v117
    v_mul_f32 v117, 0.15915494, v117
    v_mul_f32 v118, 0.15915494, v118
    v_fract_f32 v117, v117
    v_fract_f32 v118, v118
    v_cos_f32 v117, v117
    v_cos_f32 v118, v118
    v_mul_hi_u32_u24 v120, s36, v10
    v_mul_hi_u32_u24 v121, s37, v10
    v_mul_hi_u32_u24 v122, s38, v34
    v_mad_i32_i24 v73, v120, s39, v10
    v_mad_u32_u24 v98, v122, 40, v121
    v_mad_i32_i24 v120, v121, -3, v120
    v_lshlrev_b16 v98, 2, v98
    v_mad_i32_i24 v122, v122, s44, v34
    ds_add_u32 v98, v3 offset:0
    v_lshl_or_b32 v73, v120, 30, v73
    v_lshl_or_b32 v73, v122, 16, v73
    v_mul_f32 v117, 0x03800000, v117
    v_mul_f32 v118, 0x03800000, v118
    v_cvt_pk_bf16_f32 v117, v117, v118
    v_mul_hi_u32_u24 v120, s36, v11
    v_mul_hi_u32_u24 v121, s37, v11
    v_mul_hi_u32_u24 v122, s38, v35
    v_mad_i32_i24 v74, v120, s39, v11
    v_mad_u32_u24 v99, v122, 40, v121
    v_mad_i32_i24 v120, v121, -3, v120
    v_lshlrev_b16 v99, 2, v99
    v_mad_i32_i24 v122, v122, s44, v35
    ds_add_u32 v99, v3 offset:0
    v_lshl_or_b32 v74, v120, 30, v74
    v_lshl_or_b32 v74, v122, 16, v74
    v_lshrrev_b32 v118, 3, v117
    v_lshrrev_b32 v119, 8, v117
    v_lshlrev_b16 v117, 13, v117
    v_bitop3_b32 v119, v118, v119, v124 bitop3:0x1b
    v_bitop3_b32 v73, v117, v125, v73 bitop3:0xae
    v_lshl_or_b32 v98, v119, 16, v98
    v_bitop3_b32 v74, v118, v125, v74 bitop3:0xae
    v_bitop3_b32 v99, v119, v126, v99 bitop3:0xea
    s_waitcnt lgkmcnt(4)
    s_cmp_ge_u32 s68, 2048
    s_cbranch_scc1 p1_nl0
    s_add_u32 s32, s30, 0
    buffer_load_dwordx4 v[4:7], v1, s[4:7], s32 offen nt
    buffer_load_dwordx4 v[28:31], v1, s[8:11], s32 offen nt
    s_add_u32 s32, s31, 0
    buffer_load_dwordx2 v[52:53], v2, s[12:15], s32 offen nt
p1_nl0:
    v_lshlrev_b32 v117, 16, v56
    v_and_b32 v118, v126, v56
    v_mul_f32 v117, v123, v117
    v_mul_f32 v118, v123, v118
    v_cvt_pk_bf16_f32 v117, v117, v118
    v_and_b32 v118, v126, v117
    v_lshlrev_b32 v117, 16, v117
    v_mul_f32 v117, 0.15915494, v117
    v_mul_f32 v118, 0.15915494, v118
    v_fract_f32 v117, v117
    v_fract_f32 v118, v118
    v_cos_f32 v117, v117
    v_cos_f32 v118, v118
    v_mul_hi_u32_u24 v120, s36, v12
    v_mul_hi_u32_u24 v121, s37, v12
    v_mul_hi_u32_u24 v122, s38, v36
    v_mad_i32_i24 v75, v120, s39, v12
    v_mad_u32_u24 v100, v122, 40, v121
    v_mad_i32_i24 v120, v121, -3, v120
    v_lshlrev_b16 v100, 2, v100
    v_mad_i32_i24 v122, v122, s44, v36
    ds_add_u32 v100, v3 offset:0
    v_lshl_or_b32 v75, v120, 30, v75
    v_lshl_or_b32 v75, v122, 16, v75
    v_mul_f32 v117, 0x03800000, v117
    v_mul_f32 v118, 0x03800000, v118
    v_cvt_pk_bf16_f32 v117, v117, v118
    v_mul_hi_u32_u24 v120, s36, v13
    v_mul_hi_u32_u24 v121, s37, v13
    v_mul_hi_u32_u24 v122, s38, v37
    v_mad_i32_i24 v76, v120, s39, v13
    v_mad_u32_u24 v101, v122, 40, v121
    v_mad_i32_i24 v120, v121, -3, v120
    v_lshlrev_b16 v101, 2, v101
    v_mad_i32_i24 v122, v122, s44, v37
    ds_add_u32 v101, v3 offset:0
    v_lshl_or_b32 v76, v120, 30, v76
    v_lshl_or_b32 v76, v122, 16, v76
    v_lshrrev_b32 v118, 3, v117
    v_lshrrev_b32 v119, 8, v117
    v_lshlrev_b16 v117, 13, v117
    v_bitop3_b32 v119, v118, v119, v124 bitop3:0x1b
    v_bitop3_b32 v75, v117, v125, v75 bitop3:0xae
    v_lshl_or_b32 v100, v119, 16, v100
    v_bitop3_b32 v76, v118, v125, v76 bitop3:0xae
    v_bitop3_b32 v101, v119, v126, v101 bitop3:0xea
    v_lshlrev_b32 v117, 16, v57
    v_and_b32 v118, v126, v57
    v_mul_f32 v117, v123, v117
    v_mul_f32 v118, v123, v118
    v_cvt_pk_bf16_f32 v117, v117, v118
    v_and_b32 v118, v126, v117
    v_lshlrev_b32 v117, 16, v117
    v_mul_f32 v117, 0.15915494, v117
    v_mul_f32 v118, 0.15915494, v118
    v_fract_f32 v117, v117
    v_fract_f32 v118, v118
    v_cos_f32 v117, v117
    v_cos_f32 v118, v118
    v_mul_hi_u32_u24 v120, s36, v14
    v_mul_hi_u32_u24 v121, s37, v14
    v_mul_hi_u32_u24 v122, s38, v38
    v_mad_i32_i24 v77, v120, s39, v14
    v_mad_u32_u24 v102, v122, 40, v121
    v_mad_i32_i24 v120, v121, -3, v120
    v_lshlrev_b16 v102, 2, v102
    v_mad_i32_i24 v122, v122, s44, v38
    ds_add_u32 v102, v3 offset:0
    v_lshl_or_b32 v77, v120, 30, v77
    v_lshl_or_b32 v77, v122, 16, v77
    v_mul_f32 v117, 0x03800000, v117
    v_mul_f32 v118, 0x03800000, v118
    v_cvt_pk_bf16_f32 v117, v117, v118
    v_mul_hi_u32_u24 v120, s36, v15
    v_mul_hi_u32_u24 v121, s37, v15
    v_mul_hi_u32_u24 v122, s38, v39
    v_mad_i32_i24 v78, v120, s39, v15
    v_mad_u32_u24 v103, v122, 40, v121
    v_mad_i32_i24 v120, v121, -3, v120
    v_lshlrev_b16 v103, 2, v103
    v_mad_i32_i24 v122, v122, s44, v39
    ds_add_u32 v103, v3 offset:0
    v_lshl_or_b32 v78, v120, 30, v78
    v_lshl_or_b32 v78, v122, 16, v78
    v_lshrrev_b32 v118, 3, v117
    v_lshrrev_b32 v119, 8, v117
    v_lshlrev_b16 v117, 13, v117
    v_bitop3_b32 v119, v118, v119, v124 bitop3:0x1b
    v_bitop3_b32 v77, v117, v125, v77 bitop3:0xae
    v_lshl_or_b32 v102, v119, 16, v102
    v_bitop3_b32 v78, v118, v125, v78 bitop3:0xae
    v_bitop3_b32 v103, v119, v126, v103 bitop3:0xea
    v_lshlrev_b32 v117, 16, v58
    v_and_b32 v118, v126, v58
    v_mul_f32 v117, v123, v117
    v_mul_f32 v118, v123, v118
    v_cvt_pk_bf16_f32 v117, v117, v118
    v_and_b32 v118, v126, v117
    v_lshlrev_b32 v117, 16, v117
    v_mul_f32 v117, 0.15915494, v117
    v_mul_f32 v118, 0.15915494, v118
    v_fract_f32 v117, v117
    v_fract_f32 v118, v118
    v_cos_f32 v117, v117
    v_cos_f32 v118, v118
    v_mul_hi_u32_u24 v120, s36, v16
    v_mul_hi_u32_u24 v121, s37, v16
    v_mul_hi_u32_u24 v122, s38, v40
    v_mad_i32_i24 v79, v120, s39, v16
    v_mad_u32_u24 v104, v122, 40, v121
    v_mad_i32_i24 v120, v121, -3, v120
    v_lshlrev_b16 v104, 2, v104
    v_mad_i32_i24 v122, v122, s44, v40
    ds_add_u32 v104, v3 offset:0
    v_lshl_or_b32 v79, v120, 30, v79
    v_lshl_or_b32 v79, v122, 16, v79
    v_mul_f32 v117, 0x03800000, v117
    v_mul_f32 v118, 0x03800000, v118
    v_cvt_pk_bf16_f32 v117, v117, v118
    v_mul_hi_u32_u24 v120, s36, v17
    v_mul_hi_u32_u24 v121, s37, v17
    v_mul_hi_u32_u24 v122, s38, v41
    v_mad_i32_i24 v80, v120, s39, v17
    v_mad_u32_u24 v105, v122, 40, v121
    v_mad_i32_i24 v120, v121, -3, v120
    v_lshlrev_b16 v105, 2, v105
    v_mad_i32_i24 v122, v122, s44, v41
    ds_add_u32 v105, v3 offset:0
    v_lshl_or_b32 v80, v120, 30, v80
    v_lshl_or_b32 v80, v122, 16, v80
    v_lshrrev_b32 v118, 3, v117
    v_lshrrev_b32 v119, 8, v117
    v_lshlrev_b16 v117, 13, v117
    v_bitop3_b32 v119, v118, v119, v124 bitop3:0x1b
    v_bitop3_b32 v79, v117, v125, v79 bitop3:0xae
    v_lshl_or_b32 v104, v119, 16, v104
    v_bitop3_b32 v80, v118, v125, v80 bitop3:0xae
    v_bitop3_b32 v105, v119, v126, v105 bitop3:0xea
    v_lshlrev_b32 v117, 16, v59
    v_and_b32 v118, v126, v59
    v_mul_f32 v117, v123, v117
    v_mul_f32 v118, v123, v118
    v_cvt_pk_bf16_f32 v117, v117, v118
    v_and_b32 v118, v126, v117
    v_lshlrev_b32 v117, 16, v117
    v_mul_f32 v117, 0.15915494, v117
    v_mul_f32 v118, 0.15915494, v118
    v_fract_f32 v117, v117
    v_fract_f32 v118, v118
    v_cos_f32 v117, v117
    v_cos_f32 v118, v118
    v_mul_hi_u32_u24 v120, s36, v18
    v_mul_hi_u32_u24 v121, s37, v18
    v_mul_hi_u32_u24 v122, s38, v42
    v_mad_i32_i24 v81, v120, s39, v18
    v_mad_u32_u24 v106, v122, 40, v121
    v_mad_i32_i24 v120, v121, -3, v120
    v_lshlrev_b16 v106, 2, v106
    v_mad_i32_i24 v122, v122, s44, v42
    ds_add_u32 v106, v3 offset:0
    v_lshl_or_b32 v81, v120, 30, v81
    v_lshl_or_b32 v81, v122, 16, v81
    v_mul_f32 v117, 0x03800000, v117
    v_mul_f32 v118, 0x03800000, v118
    v_cvt_pk_bf16_f32 v117, v117, v118
    v_mul_hi_u32_u24 v120, s36, v19
    v_mul_hi_u32_u24 v121, s37, v19
    v_mul_hi_u32_u24 v122, s38, v43
    v_mad_i32_i24 v82, v120, s39, v19
    v_mad_u32_u24 v107, v122, 40, v121
    v_mad_i32_i24 v120, v121, -3, v120
    v_lshlrev_b16 v107, 2, v107
    v_mad_i32_i24 v122, v122, s44, v43
    ds_add_u32 v107, v3 offset:0
    v_lshl_or_b32 v82, v120, 30, v82
    v_lshl_or_b32 v82, v122, 16, v82
    v_lshrrev_b32 v118, 3, v117
    v_lshrrev_b32 v119, 8, v117
    v_lshlrev_b16 v117, 13, v117
    v_bitop3_b32 v119, v118, v119, v124 bitop3:0x1b
    v_bitop3_b32 v81, v117, v125, v81 bitop3:0xae
    v_lshl_or_b32 v106, v119, 16, v106
    v_bitop3_b32 v82, v118, v125, v82 bitop3:0xae
    v_bitop3_b32 v107, v119, v126, v107 bitop3:0xea
    s_waitcnt lgkmcnt(4)
    s_cmp_ge_u32 s68, 2048
    s_cbranch_scc1 p1_nl1
    s_add_u32 s32, s30, 16384
    buffer_load_dwordx4 v[8:11], v1, s[4:7], s32 offen nt
    buffer_load_dwordx4 v[32:35], v1, s[8:11], s32 offen nt
    s_add_u32 s32, s31, 8192
    buffer_load_dwordx2 v[54:55], v2, s[12:15], s32 offen nt
p1_nl1:
    v_lshlrev_b32 v117, 16, v60
    v_and_b32 v118, v126, v60
    v_mul_f32 v117, v123, v117
    v_mul_f32 v118, v123, v118
    v_cvt_pk_bf16_f32 v117, v117, v118
    v_and_b32 v118, v126, v117
    v_lshlrev_b32 v117, 16, v117
    v_mul_f32 v117, 0.15915494, v117
    v_mul_f32 v118, 0.15915494, v118
    v_fract_f32 v117, v117
    v_fract_f32 v118, v118
    v_cos_f32 v117, v117
    v_cos_f32 v118, v118
    v_mul_hi_u32_u24 v120, s36, v20
    v_mul_hi_u32_u24 v121, s37, v20
    v_mul_hi_u32_u24 v122, s38, v44
    v_mad_i32_i24 v83, v120, s39, v20
    v_mad_u32_u24 v108, v122, 40, v121
    v_mad_i32_i24 v120, v121, -3, v120
    v_lshlrev_b16 v108, 2, v108
    v_mad_i32_i24 v122, v122, s44, v44
    ds_add_u32 v108, v3 offset:0
    v_lshl_or_b32 v83, v120, 30, v83
    v_lshl_or_b32 v83, v122, 16, v83
    v_mul_f32 v117, 0x03800000, v117
    v_mul_f32 v118, 0x03800000, v118
    v_cvt_pk_bf16_f32 v117, v117, v118
    v_mul_hi_u32_u24 v120, s36, v21
    v_mul_hi_u32_u24 v121, s37, v21
    v_mul_hi_u32_u24 v122, s38, v45
    v_mad_i32_i24 v84, v120, s39, v21
    v_mad_u32_u24 v109, v122, 40, v121
    v_mad_i32_i24 v120, v121, -3, v120
    v_lshlrev_b16 v109, 2, v109
    v_mad_i32_i24 v122, v122, s44, v45
    ds_add_u32 v109, v3 offset:0
    v_lshl_or_b32 v84, v120, 30, v84
    v_lshl_or_b32 v84, v122, 16, v84
    v_lshrrev_b32 v118, 3, v117
    v_lshrrev_b32 v119, 8, v117
    v_lshlrev_b16 v117, 13, v117
    v_bitop3_b32 v119, v118, v119, v124 bitop3:0x1b
    v_bitop3_b32 v83, v117, v125, v83 bitop3:0xae
    v_lshl_or_b32 v108, v119, 16, v108
    v_bitop3_b32 v84, v118, v125, v84 bitop3:0xae
    v_bitop3_b32 v109, v119, v126, v109 bitop3:0xea
    v_lshlrev_b32 v117, 16, v61
    v_and_b32 v118, v126, v61
    v_mul_f32 v117, v123, v117
    v_mul_f32 v118, v123, v118
    v_cvt_pk_bf16_f32 v117, v117, v118
    v_and_b32 v118, v126, v117
    v_lshlrev_b32 v117, 16, v117
    v_mul_f32 v117, 0.15915494, v117
    v_mul_f32 v118, 0.15915494, v118
    v_fract_f32 v117, v117
    v_fract_f32 v118, v118
    v_cos_f32 v117, v117
    v_cos_f32 v118, v118
    v_mul_hi_u32_u24 v120, s36, v22
    v_mul_hi_u32_u24 v121, s37, v22
    v_mul_hi_u32_u24 v122, s38, v46
    v_mad_i32_i24 v85, v120, s39, v22
    v_mad_u32_u24 v110, v122, 40, v121
    v_mad_i32_i24 v120, v121, -3, v120
    v_lshlrev_b16 v110, 2, v110
    v_mad_i32_i24 v122, v122, s44, v46
    ds_add_u32 v110, v3 offset:0
    v_lshl_or_b32 v85, v120, 30, v85
    v_lshl_or_b32 v85, v122, 16, v85
    v_mul_f32 v117, 0x03800000, v117
    v_mul_f32 v118, 0x03800000, v118
    v_cvt_pk_bf16_f32 v117, v117, v118
    v_mul_hi_u32_u24 v120, s36, v23
    v_mul_hi_u32_u24 v121, s37, v23
    v_mul_hi_u32_u24 v122, s38, v47
    v_mad_i32_i24 v86, v120, s39, v23
    v_mad_u32_u24 v111, v122, 40, v121
    v_mad_i32_i24 v120, v121, -3, v120
    v_lshlrev_b16 v111, 2, v111
    v_mad_i32_i24 v122, v122, s44, v47
    ds_add_u32 v111, v3 offset:0
    v_lshl_or_b32 v86, v120, 30, v86
    v_lshl_or_b32 v86, v122, 16, v86
    v_lshrrev_b32 v118, 3, v117
    v_lshrrev_b32 v119, 8, v117
    v_lshlrev_b16 v117, 13, v117
    v_bitop3_b32 v119, v118, v119, v124 bitop3:0x1b
    v_bitop3_b32 v85, v117, v125, v85 bitop3:0xae
    v_lshl_or_b32 v110, v119, 16, v110
    v_bitop3_b32 v86, v118, v125, v86 bitop3:0xae
    v_bitop3_b32 v111, v119, v126, v111 bitop3:0xea
    v_lshlrev_b32 v117, 16, v62
    v_and_b32 v118, v126, v62
    v_mul_f32 v117, v123, v117
    v_mul_f32 v118, v123, v118
    v_cvt_pk_bf16_f32 v117, v117, v118
    v_and_b32 v118, v126, v117
    v_lshlrev_b32 v117, 16, v117
    v_mul_f32 v117, 0.15915494, v117
    v_mul_f32 v118, 0.15915494, v118
    v_fract_f32 v117, v117
    v_fract_f32 v118, v118
    v_cos_f32 v117, v117
    v_cos_f32 v118, v118
    v_mul_hi_u32_u24 v120, s36, v24
    v_mul_hi_u32_u24 v121, s37, v24
    v_mul_hi_u32_u24 v122, s38, v48
    v_mad_i32_i24 v87, v120, s39, v24
    v_mad_u32_u24 v112, v122, 40, v121
    v_mad_i32_i24 v120, v121, -3, v120
    v_lshlrev_b16 v112, 2, v112
    v_mad_i32_i24 v122, v122, s44, v48
    ds_add_u32 v112, v3 offset:0
    v_lshl_or_b32 v87, v120, 30, v87
    v_lshl_or_b32 v87, v122, 16, v87
    v_mul_f32 v117, 0x03800000, v117
    v_mul_f32 v118, 0x03800000, v118
    v_cvt_pk_bf16_f32 v117, v117, v118
    v_mul_hi_u32_u24 v120, s36, v25
    v_mul_hi_u32_u24 v121, s37, v25
    v_mul_hi_u32_u24 v122, s38, v49
    v_mad_i32_i24 v88, v120, s39, v25
    v_mad_u32_u24 v113, v122, 40, v121
    v_mad_i32_i24 v120, v121, -3, v120
    v_lshlrev_b16 v113, 2, v113
    v_mad_i32_i24 v122, v122, s44, v49
    ds_add_u32 v113, v3 offset:0
    v_lshl_or_b32 v88, v120, 30, v88
    v_lshl_or_b32 v88, v122, 16, v88
    v_lshrrev_b32 v118, 3, v117
    v_lshrrev_b32 v119, 8, v117
    v_lshlrev_b16 v117, 13, v117
    v_bitop3_b32 v119, v118, v119, v124 bitop3:0x1b
    v_bitop3_b32 v87, v117, v125, v87 bitop3:0xae
    v_lshl_or_b32 v112, v119, 16, v112
    v_bitop3_b32 v88, v118, v125, v88 bitop3:0xae
    v_bitop3_b32 v113, v119, v126, v113 bitop3:0xea
    v_lshlrev_b32 v117, 16, v63
    v_and_b32 v118, v126, v63
    v_mul_f32 v117, v123, v117
    v_mul_f32 v118, v123, v118
    v_cvt_pk_bf16_f32 v117, v117, v118
    v_and_b32 v118, v126, v117
    v_lshlrev_b32 v117, 16, v117
    v_mul_f32 v117, 0.15915494, v117
    v_mul_f32 v118, 0.15915494, v118
    v_fract_f32 v117, v117
    v_fract_f32 v118, v118
    v_cos_f32 v117, v117
    v_cos_f32 v118, v118
    v_mul_hi_u32_u24 v120, s36, v26
    v_mul_hi_u32_u24 v121, s37, v26
    v_mul_hi_u32_u24 v122, s38, v50
    v_mad_i32_i24 v89, v120, s39, v26
    v_mad_u32_u24 v114, v122, 40, v121
    v_mad_i32_i24 v120, v121, -3, v120
    v_lshlrev_b16 v114, 2, v114
    v_mad_i32_i24 v122, v122, s44, v50
    ds_add_u32 v114, v3 offset:0
    v_lshl_or_b32 v89, v120, 30, v89
    v_lshl_or_b32 v89, v122, 16, v89
    v_mul_f32 v117, 0x03800000, v117
    v_mul_f32 v118, 0x03800000, v118
    v_cvt_pk_bf16_f32 v117, v117, v118
    v_mul_hi_u32_u24 v120, s36, v27
    v_mul_hi_u32_u24 v121, s37, v27
    v_mul_hi_u32_u24 v122, s38, v51
    v_mad_i32_i24 v90, v120, s39, v27
    v_mad_u32_u24 v115, v122, 40, v121
    v_mad_i32_i24 v120, v121, -3, v120
    v_lshlrev_b16 v115, 2, v115
    v_mad_i32_i24 v122, v122, s44, v51
    ds_add_u32 v115, v3 offset:0
    v_lshl_or_b32 v90, v120, 30, v90
    v_lshl_or_b32 v90, v122, 16, v90
    v_lshrrev_b32 v118, 3, v117
    v_lshrrev_b32 v119, 8, v117
    v_lshlrev_b16 v117, 13, v117
    v_bitop3_b32 v119, v118, v119, v124 bitop3:0x1b
    v_bitop3_b32 v89, v117, v125, v89 bitop3:0xae
    v_lshl_or_b32 v114, v119, 16, v114
    v_bitop3_b32 v90, v118, v125, v90 bitop3:0xae
    v_bitop3_b32 v115, v119, v126, v115 bitop3:0xea
    s_waitcnt lgkmcnt(4)
    s_cmp_ge_u32 s68, 2048
    s_cbranch_scc1 p1_nl2
    s_add_u32 s32, s30, 32768
    buffer_load_dwordx4 v[12:15], v1, s[4:7], s32 offen nt
    buffer_load_dwordx4 v[36:39], v1, s[8:11], s32 offen nt
    s_add_u32 s32, s31, 16384
    buffer_load_dwordx2 v[56:57], v2, s[12:15], s32 offen nt
p1_nl2:
    s_cmp_ge_u32 s28, s33
    s_cbranch_scc1 p1_r_done
    v_lshlrev_b32 v117, 16, v66
    v_and_b32 v118, v126, v66
    v_mul_f32 v117, v123, v117
    v_mul_f32 v118, v123, v118
    v_cvt_pk_bf16_f32 v117, v117, v118
    v_and_b32 v118, v126, v117
    v_lshlrev_b32 v117, 16, v117
    v_mul_f32 v117, 0.15915494, v117
    v_mul_f32 v118, 0.15915494, v118
    v_fract_f32 v117, v117
    v_fract_f32 v118, v118
    v_cos_f32 v117, v117
    v_cos_f32 v118, v118
    v_mul_hi_u32_u24 v120, s36, v64
    v_mul_hi_u32_u24 v121, s37, v64
    v_mul_hi_u32_u24 v122, s38, v65
    v_mad_i32_i24 v91, v120, s39, v64
    v_mad_u32_u24 v116, v122, 40, v121
    v_mad_i32_i24 v120, v121, -3, v120
    v_lshlrev_b16 v116, 2, v116
    v_mad_i32_i24 v122, v122, s44, v65
    ds_add_u32 v116, v3 offset:0
    v_lshl_or_b32 v91, v120, 30, v91
    v_lshl_or_b32 v91, v122, 16, v91
    v_mul_f32 v117, 0x03800000, v117
    v_mul_f32 v118, 0x03800000, v118
    v_cvt_pk_bf16_f32 v117, v117, v118
    v_lshrrev_b32 v118, 3, v117
    v_lshrrev_b32 v119, 8, v117
    v_lshlrev_b16 v117, 13, v117
    v_bitop3_b32 v119, v118, v119, v124 bitop3:0x1b
    v_bitop3_b32 v91, v117, v125, v91 bitop3:0xae
    v_lshl_or_b32 v116, v119, 16, v116
p1_r_done:
    s_waitcnt lgkmcnt(0)
    s_barrier
    s_cmp_ge_u32 s28, 10
    s_cbranch_scc1 p1_s1_skip
    v_and_b32 v126, 63, v0
    s_lshl_b32 s54, s28, 4
    v_mul_u32_u24 v117, 160, v126
    v_add_u32 v117, s54, v117
    ds_read_b128 v[118:121], v117 offset:0
    s_mov_b32 s55, 43691
    s_waitcnt lgkmcnt(0)
    v_add_u32 v118, 2, v118
    v_add_u32 v119, 2, v119
    v_add_u32 v120, 2, v120
    v_add_u32 v121, 2, v121
    v_mul_u32_u24 v118, s55, v118
    v_mul_u32_u24 v119, s55, v119
    v_mul_u32_u24 v120, s55, v120
    v_mul_u32_u24 v121, s55, v121
    v_lshrrev_b32 v118, 17, v118
    v_lshrrev_b32 v119, 17, v119
    v_lshrrev_b32 v120, 17, v120
    v_lshrrev_b32 v121, 17, v121
    v_lshl_or_b32 v122, v119, 16, v118
    v_lshl_or_b32 v123, v121, 16, v120
    v_mov_b32 v124, v122
    v_mov_b32 v125, v123
    s_nop 1
    v_add_u32_dpp v124, v124, v124 row_shr:1 row_mask:0xf bank_mask:0xf bound_ctrl:0
    v_add_u32_dpp v125, v125, v125 row_shr:1 row_mask:0xf bank_mask:0xf bound_ctrl:0
    s_nop 0
    v_add_u32_dpp v124, v124, v124 row_shr:2 row_mask:0xf bank_mask:0xf bound_ctrl:0
    v_add_u32_dpp v125, v125, v125 row_shr:2 row_mask:0xf bank_mask:0xf bound_ctrl:0
    s_nop 0
    v_add_u32_dpp v124, v124, v124 row_shr:4 row_mask:0xf bank_mask:0xf bound_ctrl:0
    v_add_u32_dpp v125, v125, v125 row_shr:4 row_mask:0xf bank_mask:0xf bound_ctrl:0
    s_nop 0
    v_add_u32_dpp v124, v124, v124 row_shr:8 row_mask:0xf bank_mask:0xf bound_ctrl:0
    v_add_u32_dpp v125, v125, v125 row_shr:8 row_mask:0xf bank_mask:0xf bound_ctrl:0
    s_nop 0
    v_add_u32_dpp v124, v124, v124 row_bcast:15 row_mask:0xa bank_mask:0xf
    v_add_u32_dpp v125, v125, v125 row_bcast:15 row_mask:0xa bank_mask:0xf
    s_nop 0
    v_add_u32_dpp v124, v124, v124 row_bcast:31 row_mask:0xc bank_mask:0xf
    v_add_u32_dpp v125, v125, v125 row_bcast:31 row_mask:0xc bank_mask:0xf
    s_nop 0
    s_nop 0
    v_mov_b32 v127, s54
    v_and_b32 v118, 0xffff, v124
    v_lshrrev_b32 v119, 16, v124
    v_and_b32 v120, 0xffff, v125
    v_lshrrev_b32 v121, 16, v125
    s_mov_b64 exec, 1
    s_lshl_b64 exec, exec, 63
    ds_write_b128 v127, v[118:121] offset:10240
    s_mov_b64 exec, -1
p1_s1_skip:
    s_waitcnt lgkmcnt(0)
    s_barrier
    v_and_b32 v127, 63, v0
    v_lshlrev_b32 v118, 2, v127
    v_cmp_gt_u32 vcc, 40, v127
    ds_read_b32 v119, v118 offset:10240
    s_waitcnt lgkmcnt(0)
    v_cndmask_b32 v119, 0, v119, vcc
    v_mov_b32 v120, v119
    s_nop 1
    v_add_u32_dpp v120, v120, v120 row_shr:1 row_mask:0xf bank_mask:0xf bound_ctrl:0
    s_nop 1
    v_add_u32_dpp v120, v120, v120 row_shr:2 row_mask:0xf bank_mask:0xf bound_ctrl:0
    s_nop 1
    v_add_u32_dpp v120, v120, v120 row_shr:4 row_mask:0xf bank_mask:0xf bound_ctrl:0
    s_nop 1
    v_add_u32_dpp v120, v120, v120 row_shr:8 row_mask:0xf bank_mask:0xf bound_ctrl:0
    s_nop 1
    v_add_u32_dpp v120, v120, v120 row_bcast:15 row_mask:0xa bank_mask:0xf
    s_nop 1
    v_add_u32_dpp v120, v120, v120 row_bcast:31 row_mask:0xc bank_mask:0xf
    s_nop 1
    s_nop 0
    v_sub_u32 v119, v120, v119
    v_readlane_b32 s35, v120, 63
    s_cmp_ge_u32 s28, 10
    s_cbranch_scc1 p1_s2_skip
    s_lshl_b32 s54, s28, 2
    s_add_u32 s55, s54, 0
    v_readlane_b32 s56, v119, s55
    s_add_u32 s55, s54, 1
    v_readlane_b32 s57, v119, s55
    s_add_u32 s55, s54, 2
    v_readlane_b32 s58, v119, s55
    s_add_u32 s55, s54, 3
    v_readlane_b32 s59, v119, s55
    s_nop 0
    s_lshl_b32 s57, s57, 16
    s_or_b32 s56, s56, s57
    s_lshl_b32 s59, s59, 16
    s_or_b32 s58, s58, s59
    v_add_u32 v124, s56, v124
    v_add_u32 v125, s58, v125
    v_sub_u32 v122, v124, v122
    v_sub_u32 v123, v125, v123
    v_and_b32 v118, 0xffff, v122
    v_lshrrev_b32 v119, 16, v122
    v_and_b32 v120, 0xffff, v123
    v_lshrrev_b32 v121, 16, v123
    v_mul_u32_u24 v118, 3, v118
    v_mul_u32_u24 v119, 3, v119
    v_mul_u32_u24 v120, 3, v120
    v_mul_u32_u24 v121, 3, v121
    ds_write_b128 v117, v[118:121] offset:0
    s_mul_i32 s55, s29, 5248
    s_mul_i32 s56, s28, 520
    s_add_u32 s55, s55, s56
    s_add_u32 s55, s55, 335544320
    v_lshlrev_b32 v127, 3, v126
    buffer_store_dwordx2 v[122:123], v127, s[16:19], s55 offen sc1
    s_mov_b64 exec, 1
    s_lshl_b64 exec, exec, 63
    buffer_store_dwordx2 v[124:125], v127, s[16:19], s55 offen offset:8 sc1
    s_mov_b64 exec, -1
p1_s2_skip:
    s_mul_i32 s51, s29, 16384
    s_lshr_b32 s52, s35, 10
    s_mul_i32 s52, s52, 33554432
    s_and_b32 s53, s35, 1023
    s_lshl_b32 s53, s53, 4
    s_add_u32 s52, s52, s53
    s_add_u32 s52, s52, s51
    s_min_u32 s22, s52, 335544320
    s_mov_b32 s70, 0
    s_waitcnt lgkmcnt(0)
    s_barrier
    s_cmp_ge_u32 s68, 2048
    s_cbranch_scc1 p1_prep0
    s_cmp_lg_u32 s28, 15
    s_cbranch_scc1 p1_tk0
    v_mov_b32 v127, 1
    s_mov_b64 exec, 1
    buffer_atomic_add v127, off, s[40:43], 0 offset:128 sc0 sc1
    s_mov_b64 exec, -1
    s_branch p1_tk0
p1_prep0:
    s_cmp_lg_u32 s28, 15
    s_cbranch_scc1 p1_hv0
    s_lshl_b32 s58, s68, 2
    s_and_b32 s58, s58, 28
    s_lshl_b32 s52, 1, s58
    v_mov_b32 v127, s52
    s_sub_u32 s52, s68, 2048
    s_lshr_b32 s52, s52, 3
    s_lshl_b32 s52, s52, 2
    s_mov_b64 exec, 1
    buffer_atomic_add v127, off, s[40:43], s52 sc0 sc1
    s_mov_b64 exec, -1
p1_hv0:
    s_cmp_ge_u32 s68, 2168
    s_cbranch_scc1 p1_tk0
    s_sub_u32 s52, s68, 2048
    s_mul_i32 s52, s52, 53368
    s_mul_i32 s53, s28, 3072
    s_add_u32 s53, s53, s52
    v_and_b32 v20, 63, v0
    v_lshl_add_u32 v21, v20, 2, s53
    s_lshl_b32 s53, s28, 9
    s_add_u32 s53, s53, s52
    s_add_u32 s53, s53, 49152
    s_cmp_lt_u32 s28, 9
    s_cselect_b32 s53, s53, 0x40000000
    v_lshl_add_u32 v22, v20, 2, s53
    buffer_load_dword v4, v21, s[24:27], 0 offen offset:0
    buffer_load_dword v5, v21, s[24:27], 0 offen offset:256
    buffer_load_dword v6, v21, s[24:27], 0 offen offset:512
    buffer_load_dword v7, v21, s[24:27], 0 offen offset:768
    buffer_load_dword v8, v21, s[24:27], 0 offen offset:1024
    buffer_load_dword v9, v21, s[24:27], 0 offen offset:1280
    buffer_load_dword v10, v21, s[24:27], 0 offen offset:1536
    buffer_load_dword v11, v21, s[24:27], 0 offen offset:1792
    buffer_load_dword v12, v21, s[24:27], 0 offen offset:2048
    buffer_load_dword v13, v21, s[24:27], 0 offen offset:2304
    buffer_load_dword v14, v21, s[24:27], 0 offen offset:2560
    buffer_load_dword v15, v21, s[24:27], 0 offen offset:2816
    buffer_load_dword v16, v22, s[24:27], 0 offen offset:0
    buffer_load_dword v17, v22, s[24:27], 0 offen offset:256
p1_tk0:
    v_and_b32 v117, 0xffff, v92
    ds_add_rtn_u32 v117, v117, v3 offset:0
    v_and_b32 v118, 0xffff, v93
    ds_add_rtn_u32 v118, v118, v3 offset:0
    v_and_b32 v119, 0xffff, v94
    ds_add_rtn_u32 v119, v119, v3 offset:0
    v_and_b32 v120, 0xffff, v95
    ds_add_rtn_u32 v120, v120, v3 offset:0
    s_cmp_ge_u32 s68, 2048
    s_cbranch_scc1 p1_nl3
    s_add_u32 s32, s30, 49152
    buffer_load_dwordx4 v[16:19], v1, s[4:7], s32 offen nt
    buffer_load_dwordx4 v[40:43], v1, s[8:11], s32 offen nt
    s_add_u32 s32, s31, 24576
    buffer_load_dwordx2 v[58:59], v2, s[12:15], s32 offen nt
p1_nl3:
    v_and_b32 v121, 0xffff, v96
    ds_add_rtn_u32 v121, v121, v3 offset:0
    v_and_b32 v122, 0xffff, v97
    ds_add_rtn_u32 v122, v122, v3 offset:0
    v_and_b32 v123, 0xffff, v98
    ds_add_rtn_u32 v123, v123, v3 offset:0
    v_and_b32 v124, 0xffff, v99
    ds_add_rtn_u32 v124, v124, v3 offset:0
    s_waitcnt lgkmcnt(4)
    ds_write_b8_d16_hi v117, v92 offset:10496
    v_lshlrev_b32 v117, 2, v117
    ds_write_b32 v117, v67 offset:40736
    ds_write_b8_d16_hi v118, v93 offset:10496
    v_lshlrev_b32 v118, 2, v118
    ds_write_b32 v118, v68 offset:40736
    ds_write_b8_d16_hi v119, v94 offset:10496
    v_lshlrev_b32 v119, 2, v119
    ds_write_b32 v119, v69 offset:40736
    ds_write_b8_d16_hi v120, v95 offset:10496
    v_lshlrev_b32 v120, 2, v120
    ds_write_b32 v120, v70 offset:40736
    s_cmp_ge_u32 s68, 2048
    s_cbranch_scc1 p1_nl4
    s_add_u32 s32, s30, 65536
    buffer_load_dwordx4 v[20:23], v1, s[4:7], s32 offen nt
    buffer_load_dwordx4 v[44:47], v1, s[8:11], s32 offen nt
    s_add_u32 s32, s31, 32768
    buffer_load_dwordx2 v[60:61], v2, s[12:15], s32 offen nt
p1_nl4:
    v_and_b32 v117, 0xffff, v100
    ds_add_rtn_u32 v117, v117, v3 offset:0
    v_and_b32 v118, 0xffff, v101
    ds_add_rtn_u32 v118, v118, v3 offset:0
    v_and_b32 v119, 0xffff, v102
    ds_add_rtn_u32 v119, v119, v3 offset:0
    v_and_b32 v120, 0xffff, v103
    ds_add_rtn_u32 v120, v120, v3 offset:0
    s_waitcnt lgkmcnt(4)
    ds_write_b8_d16_hi v121, v96 offset:10496
    v_lshlrev_b32 v121, 2, v121
    ds_write_b32 v121, v71 offset:40736
    ds_write_b8_d16_hi v122, v97 offset:10496
    v_lshlrev_b32 v122, 2, v122
    ds_write_b32 v122, v72 offset:40736
    ds_write_b8_d16_hi v123, v98 offset:10496
    v_lshlrev_b32 v123, 2, v123
    ds_write_b32 v123, v73 offset:40736
    ds_write_b8_d16_hi v124, v99 offset:10496
    v_lshlrev_b32 v124, 2, v124
    ds_write_b32 v124, v74 offset:40736
    v_and_b32 v121, 0xffff, v104
    ds_add_rtn_u32 v121, v121, v3 offset:0
    v_and_b32 v122, 0xffff, v105
    ds_add_rtn_u32 v122, v122, v3 offset:0
    v_and_b32 v123, 0xffff, v106
    ds_add_rtn_u32 v123, v123, v3 offset:0
    v_and_b32 v124, 0xffff, v107
    ds_add_rtn_u32 v124, v124, v3 offset:0
    s_waitcnt lgkmcnt(4)
    ds_write_b8_d16_hi v117, v100 offset:10496
    v_lshlrev_b32 v117, 2, v117
    ds_write_b32 v117, v75 offset:40736
    ds_write_b8_d16_hi v118, v101 offset:10496
    v_lshlrev_b32 v118, 2, v118
    ds_write_b32 v118, v76 offset:40736
    ds_write_b8_d16_hi v119, v102 offset:10496
    v_lshlrev_b32 v119, 2, v119
    ds_write_b32 v119, v77 offset:40736
    ds_write_b8_d16_hi v120, v103 offset:10496
    v_lshlrev_b32 v120, 2, v120
    ds_write_b32 v120, v78 offset:40736
    s_cmp_ge_u32 s68, 2048
    s_cbranch_scc1 p1_nl5
    s_add_u32 s32, s30, 81920
    buffer_load_dwordx4 v[24:27], v1, s[4:7], s32 offen nt
    buffer_load_dwordx4 v[48:51], v1, s[8:11], s32 offen nt
    s_add_u32 s32, s31, 40960
    buffer_load_dwordx2 v[62:63], v2, s[12:15], s32 offen nt
p1_nl5:
    v_and_b32 v117, 0xffff, v108
    ds_add_rtn_u32 v117, v117, v3 offset:0
    v_and_b32 v118, 0xffff, v109
    ds_add_rtn_u32 v118, v118, v3 offset:0
    v_and_b32 v119, 0xffff, v110
    ds_add_rtn_u32 v119, v119, v3 offset:0
    v_and_b32 v120, 0xffff, v111
    ds_add_rtn_u32 v120, v120, v3 offset:0
    s_waitcnt lgkmcnt(4)
    ds_write_b8_d16_hi v121, v104 offset:10496
    v_lshlrev_b32 v121, 2, v121
    ds_write_b32 v121, v79 offset:40736
    ds_write_b8_d16_hi v122, v105 offset:10496
    v_lshlrev_b32 v122, 2, v122
    ds_write_b32 v122, v80 offset:40736
    ds_write_b8_d16_hi v123, v106 offset:10496
    v_lshlrev_b32 v123, 2, v123
    ds_write_b32 v123, v81 offset:40736
    ds_write_b8_d16_hi v124, v107 offset:10496
    v_lshlrev_b32 v124, 2, v124
    ds_write_b32 v124, v82 offset:40736
    s_cmp_ge_u32 s28, 10
    s_cbranch_scc1 p1_jn
    s_cmp_lt_u32 s68, 2048
    s_cbranch_scc1 p1_vwj
    s_waitcnt vmcnt(0)
p1_vwj:
    s_waitcnt vmcnt(9)
    v_mov_b32 v125, 0
    s_mov_b64 exec, 1
    ds_add_rtn_u32 v125, v125, v3 offset:10432
    s_waitcnt lgkmcnt(0)
    v_readfirstlane_b32 s52, v125
    s_lshr_b32 s53, s29, 1
    s_and_b32 s53, s53, 28
    s_cmp_lg_u32 s52, 9
    s_cbranch_scc1 p1_jn1
    s_lshl_b32 s54, 1, s53
    v_mov_b32 v127, s54
    s_lshr_b32 s54, s29, 6
    s_lshl_b32 s54, s54, 2
    s_mov_b32 s70, 1
    buffer_atomic_add v127, off, s[40:43], s54 sc0 sc1
p1_jn1:
    s_mov_b64 exec, -1
p1_jn:
    s_cmp_ge_u32 s68, 2048
    s_cbranch_scc1 p1_nl6
    s_cmp_lt_u32 s28, s34
    s_cselect_b32 s46, 0, 0x40000000
    v_lshl_add_u32 v126, v0, 2, s46
    s_add_u32 s32, s30, 98304
    buffer_load_dword v64, v126, s[4:7], s32 offen nt
    buffer_load_dword v65, v126, s[8:11], s32 offen nt
    v_lshrrev_b32 v126, 1, v126
    s_add_u32 s32, s31, 49152
    buffer_load_ushort v66, v126, s[12:15], s32 offen nt
p1_nl6:
    v_and_b32 v121, 0xffff, v112
    ds_add_rtn_u32 v121, v121, v3 offset:0
    v_and_b32 v122, 0xffff, v113
    ds_add_rtn_u32 v122, v122, v3 offset:0
    v_and_b32 v123, 0xffff, v114
    ds_add_rtn_u32 v123, v123, v3 offset:0
    v_and_b32 v124, 0xffff, v115
    ds_add_rtn_u32 v124, v124, v3 offset:0
    s_waitcnt lgkmcnt(4)
    ds_write_b8_d16_hi v117, v108 offset:10496
    v_lshlrev_b32 v117, 2, v117
    ds_write_b32 v117, v83 offset:40736
    ds_write_b8_d16_hi v118, v109 offset:10496
    v_lshlrev_b32 v118, 2, v118
    ds_write_b32 v118, v84 offset:40736
    ds_write_b8_d16_hi v119, v110 offset:10496
    v_lshlrev_b32 v119, 2, v119
    ds_write_b32 v119, v85 offset:40736
    ds_write_b8_d16_hi v120, v111 offset:10496
    v_lshlrev_b32 v120, 2, v120
    ds_write_b32 v120, v86 offset:40736
    s_waitcnt lgkmcnt(0)
    ds_write_b8_d16_hi v121, v112 offset:10496
    v_lshlrev_b32 v121, 2, v121
    ds_write_b32 v121, v87 offset:40736
    ds_write_b8_d16_hi v122, v113 offset:10496
    v_lshlrev_b32 v122, 2, v122
    ds_write_b32 v122, v88 offset:40736
    ds_write_b8_d16_hi v123, v114 offset:10496
    v_lshlrev_b32 v123, 2, v123
    ds_write_b32 v123, v89 offset:40736
    ds_write_b8_d16_hi v124, v115 offset:10496
    v_lshlrev_b32 v124, 2, v124
    ds_write_b32 v124, v90 offset:40736
    s_cmp_ge_u32 s28, s33
    s_cbranch_scc1 p1_p_done
    v_and_b32 v125, 0xffff, v116
    ds_add_rtn_u32 v125, v125, v3 offset:0
    s_waitcnt lgkmcnt(0)
    ds_write_b8_d16_hi v125, v116 offset:10496
    v_lshlrev_b32 v125, 2, v125
    ds_write_b32 v125, v91 offset:40736
p1_p_done:
    s_cmp_eq_u32 s70, 0
    s_cbranch_scc1 p1_sg
    s_cmp_lt_u32 s68, 2048
    s_cbranch_scc1 p1_vws
    s_waitcnt vmcnt(0)
p1_vws:
    s_waitcnt vmcnt(3)
    v_bfe_u32 v127, v127, s53, 4
    v_mov_b32 v125, 0
    s_mov_b64 exec, 1
    ds_write_b32 v125, v127 offset:10452
    s_mov_b64 exec, -1
p1_sg:
    s_cmp_ge_u32 s68, 2048
    s_cbranch_scc1 p1_prep1
    s_cmp_lg_u32 s28, 15
    s_cbranch_scc1 p1_tk1
    s_waitcnt vmcnt(12)
    v_mov_b32 v125, 0
    s_mov_b64 exec, 1
    ds_write_b32 v125, v127 offset:10448
    s_mov_b64 exec, -1
    s_branch p1_tk1
p1_prep1:
    s_cmp_lg_u32 s28, 15
    s_cbranch_scc1 p1_hv1
    s_waitcnt vmcnt(0)
    v_bfe_u32 v127, v127, s58, 4
    v_mov_b32 v125, 0
    s_mov_b64 exec, 1
    ds_write_b32 v125, v127 offset:10448
    s_mov_b64 exec, -1
p1_hv1:
    s_cmp_ge_u32 s68, 2168
    s_cbranch_scc1 p1_tk1
    s_sub_u32 s52, s68, 2048
    s_mul_i32 s53, s52, 53760
    s_add_u32 s53, s53, 356941824
    s_mul_i32 s54, s28, 3072
    v_lshl_add_u32 v21, v20, 4, s54
    s_lshl_b32 s54, s28, 9
    s_add_u32 s54, s54, 49152
    s_cmp_lt_u32 s28, 9
    s_cselect_b32 s54, s54, 0x40000000
    v_lshl_add_u32 v22, v20, 3, s54
    v_mov_b32 v24, 0
    v_mov_b32 v25, 0
    s_waitcnt vmcnt(0)
    buffer_store_dwordx4 v[4:7], v21, s[16:19], s53 offen offset:0
    buffer_store_dwordx4 v[8:11], v21, s[16:19], s53 offen offset:1024
    buffer_store_dwordx4 v[12:15], v21, s[16:19], s53 offen offset:2048
    buffer_store_dwordx2 v[16:17], v22, s[16:19], s53 offen
    v_and_b32 v26, 0x7fff7fff, v4
    v_pk_max_u16 v24, v24, v26
    v_lshlrev_b32 v27, 16, v26
    v_and_b32 v26, 0xffff0000, v26
    v_fmac_f32 v25, v27, v27
    v_fmac_f32 v25, v26, v26
    v_and_b32 v26, 0x7fff7fff, v5
    v_pk_max_u16 v24, v24, v26
    v_lshlrev_b32 v27, 16, v26
    v_and_b32 v26, 0xffff0000, v26
    v_fmac_f32 v25, v27, v27
    v_fmac_f32 v25, v26, v26
    v_and_b32 v26, 0x7fff7fff, v6
    v_pk_max_u16 v24, v24, v26
    v_lshlrev_b32 v27, 16, v26
    v_and_b32 v26, 0xffff0000, v26
    v_fmac_f32 v25, v27, v27
    v_fmac_f32 v25, v26, v26
    v_and_b32 v26, 0x7fff7fff, v7
    v_pk_max_u16 v24, v24, v26
    v_lshlrev_b32 v27, 16, v26
    v_and_b32 v26, 0xffff0000, v26
    v_fmac_f32 v25, v27, v27
    v_fmac_f32 v25, v26, v26
    v_and_b32 v26, 0x7fff7fff, v8
    v_pk_max_u16 v24, v24, v26
    v_lshlrev_b32 v27, 16, v26
    v_and_b32 v26, 0xffff0000, v26
    v_fmac_f32 v25, v27, v27
    v_fmac_f32 v25, v26, v26
    v_and_b32 v26, 0x7fff7fff, v9
    v_pk_max_u16 v24, v24, v26
    v_lshlrev_b32 v27, 16, v26
    v_and_b32 v26, 0xffff0000, v26
    v_fmac_f32 v25, v27, v27
    v_fmac_f32 v25, v26, v26
    v_and_b32 v26, 0x7fff7fff, v10
    v_pk_max_u16 v24, v24, v26
    v_lshlrev_b32 v27, 16, v26
    v_and_b32 v26, 0xffff0000, v26
    v_fmac_f32 v25, v27, v27
    v_fmac_f32 v25, v26, v26
    v_and_b32 v26, 0x7fff7fff, v11
    v_pk_max_u16 v24, v24, v26
    v_lshlrev_b32 v27, 16, v26
    v_and_b32 v26, 0xffff0000, v26
    v_fmac_f32 v25, v27, v27
    v_fmac_f32 v25, v26, v26
    v_and_b32 v26, 0x7fff7fff, v12
    v_pk_max_u16 v24, v24, v26
    v_lshlrev_b32 v27, 16, v26
    v_and_b32 v26, 0xffff0000, v26
    v_fmac_f32 v25, v27, v27
    v_fmac_f32 v25, v26, v26
    v_and_b32 v26, 0x7fff7fff, v13
    v_pk_max_u16 v24, v24, v26
    v_lshlrev_b32 v27, 16, v26
    v_and_b32 v26, 0xffff0000, v26
    v_fmac_f32 v25, v27, v27
    v_fmac_f32 v25, v26, v26
    v_and_b32 v26, 0x7fff7fff, v14
    v_pk_max_u16 v24, v24, v26
    v_lshlrev_b32 v27, 16, v26
    v_and_b32 v26, 0xffff0000, v26
    v_fmac_f32 v25, v27, v27
    v_fmac_f32 v25, v26, v26
    v_and_b32 v26, 0x7fff7fff, v15
    v_pk_max_u16 v24, v24, v26
    v_lshlrev_b32 v27, 16, v26
    v_and_b32 v26, 0xffff0000, v26
    v_fmac_f32 v25, v27, v27
    v_fmac_f32 v25, v26, v26
    v_and_b32 v26, 0x7fff7fff, v16
    v_pk_max_u16 v24, v24, v26
    v_lshlrev_b32 v27, 16, v26
    v_and_b32 v26, 0xffff0000, v26
    v_fmac_f32 v25, v27, v27
    v_fmac_f32 v25, v26, v26
    v_and_b32 v26, 0x7fff7fff, v17
    v_pk_max_u16 v24, v24, v26
    v_lshlrev_b32 v27, 16, v26
    v_and_b32 v26, 0xffff0000, v26
    v_fmac_f32 v25, v27, v27
    v_fmac_f32 v25, v26, v26
    v_lshrrev_b32 v26, 16, v24
    v_and_b32 v24, 0xffff, v24
    v_max_u32 v24, v24, v26
    s_nop 1
    v_max_u32_dpp v24, v24, v24 row_shr:1 row_mask:0xf bank_mask:0xf bound_ctrl:0
    v_add_f32_dpp v25, v25, v25 row_shr:1 row_mask:0xf bank_mask:0xf bound_ctrl:0
    s_nop 0
    v_max_u32_dpp v24, v24, v24 row_shr:2 row_mask:0xf bank_mask:0xf bound_ctrl:0
    v_add_f32_dpp v25, v25, v25 row_shr:2 row_mask:0xf bank_mask:0xf bound_ctrl:0
    s_nop 0
    v_max_u32_dpp v24, v24, v24 row_shr:4 row_mask:0xf bank_mask:0xf bound_ctrl:0
    v_add_f32_dpp v25, v25, v25 row_shr:4 row_mask:0xf bank_mask:0xf bound_ctrl:0
    s_nop 0
    v_max_u32_dpp v24, v24, v24 row_shr:8 row_mask:0xf bank_mask:0xf bound_ctrl:0
    v_add_f32_dpp v25, v25, v25 row_shr:8 row_mask:0xf bank_mask:0xf bound_ctrl:0
    s_nop 0
    v_max_u32_dpp v24, v24, v24 row_bcast:15 row_mask:0xa bank_mask:0xf
    v_add_f32_dpp v25, v25, v25 row_bcast:15 row_mask:0xa bank_mask:0xf
    s_nop 0
    v_max_u32_dpp v24, v24, v24 row_bcast:31 row_mask:0xc bank_mask:0xf
    v_add_f32_dpp v25, v25, v25 row_bcast:31 row_mask:0xc bank_mask:0xf
    s_nop 0
    s_nop 0
    s_lshl_b32 s52, s52, 4
    s_add_u32 s52, s52, s28
    s_lshl_b32 s52, s52, 3
    s_add_u32 s52, s52, 363393024
    s_mov_b64 exec, 1
    s_lshl_b64 exec, exec, 63
    buffer_store_dwordx2 v[24:25], off, s[16:19], s52
    s_mov_b64 exec, -1
p1_tk1:
    s_waitcnt lgkmcnt(0)
    s_barrier
    v_mul_u32_u24 v119, 3, v0
    v_lshlrev_b32 v117, 2, v119
    v_add_u32 v117, 40736, v117
    v_and_b32 v118, -4, v119
    v_add_u32 v120, s51, v1
    v_mov_b32 v122, 0
    v_mov_b32 v123, 0
    v_mov_b32 v124, 0
    v_mov_b32 v125, 0
    ds_read_b64 v[126:127], v122 offset:10448
    ds_write_b32 v122, v122 offset:10432
    v_cmp_gt_u32 vcc, 640, v0
    s_and_saveexec_b64 s[52:53], vcc
    ds_write_b128 v1, v[122:125] offset:0
    s_mov_b64 exec, -1
    s_waitcnt lgkmcnt(2)
    v_readfirstlane_b32 s69, v126
    v_readfirstlane_b32 s71, v127
    s_cmp_ge_u32 s68, 2048
    s_cselect_b32 s3, s69, 0
    s_cmp_gt_u32 s28, 10
    s_cselect_b32 s71, 0, s71
    s_cselect_b32 s3, 0, s3
    s_add_u32 s69, s69, 512
    s_or_b32 s52, s71, s3
    s_bitcmp0_b32 s52, 3
    s_cbranch_scc1 p1_tr0
    v_and_b32 v116, 63, v0
    s_cmp_eq_u32 s28, 10
    s_cbranch_scc1 p1_tr1
    s_mul_i32 s52, s28, 520
    v_lshl_add_u32 v114, v116, 3, s52
    s_mul_i32 s52, s28, 4160
    v_lshl_add_u32 v115, v116, 4, s52
    s_branch p1_tr2
p1_tr1:
    v_mul_u32_u24 v114, 520, v116
    v_add_u32 v114, 512, v114
    v_mul_u32_u24 v115, 4160, v116
    v_add_u32 v115, 1024, v115
    v_cmp_gt_u32 vcc, 10, v116
    v_mov_b32 v116, 0x40000000
    s_nop 0
    v_cndmask_b32 v114, v116, v114, vcc
    v_cndmask_b32 v115, v116, v115, vcc
p1_tr2:
    s_cmp_lg_u32 s71, 8
    s_cbranch_scc1 p1_tl0
    s_lshr_b32 s52, s29, 3
    s_mul_i32 s52, s52, 41984
    s_add_u32 s52, s52, 335544320
    buffer_load_dwordx2 v[86:87], v114, s[16:19], s52 offen sc1
    s_add_u32 s52, s52, 5248
    buffer_load_dwordx2 v[88:89], v114, s[16:19], s52 offen sc1
    s_add_u32 s52, s52, 5248
    buffer_load_dwordx2 v[90:91], v114, s[16:19], s52 offen sc1
    s_add_u32 s52, s52, 5248
    buffer_load_dwordx2 v[92:93], v114, s[16:19], s52 offen sc1
    s_add_u32 s52, s52, 5248
    buffer_load_dwordx2 v[94:95], v114, s[16:19], s52 offen sc1
    s_add_u32 s52, s52, 5248
    buffer_load_dwordx2 v[96:97], v114, s[16:19], s52 offen sc1
    s_add_u32 s52, s52, 5248
    buffer_load_dwordx2 v[98:99], v114, s[16:19], s52 offen sc1
    s_add_u32 s52, s52, 5248
    buffer_load_dwordx2 v[100:101], v114, s[16:19], s52 offen sc1
    s_add_u32 s52, s52, 5248
p1_tl0:
    s_cmp_lg_u32 s3, 8
    s_cbranch_scc1 p1_tl1
    s_sub_u32 s52, s68, 2048
    s_mul_i32 s52, s52, 41984
    s_add_u32 s52, s52, 335544320
    buffer_load_dwordx2 v[28:29], v114, s[16:19], s52 offen sc1
    s_add_u32 s52, s52, 5248
    buffer_load_dwordx2 v[30:31], v114, s[16:19], s52 offen sc1
    s_add_u32 s52, s52, 5248
    buffer_load_dwordx2 v[32:33], v114, s[16:19], s52 offen sc1
    s_add_u32 s52, s52, 5248
    buffer_load_dwordx2 v[34:35], v114, s[16:19], s52 offen sc1
    s_add_u32 s52, s52, 5248
    buffer_load_dwordx2 v[36:37], v114, s[16:19], s52 offen sc1
    s_add_u32 s52, s52, 5248
    buffer_load_dwordx2 v[38:39], v114, s[16:19], s52 offen sc1
    s_add_u32 s52, s52, 5248
    buffer_load_dwordx2 v[40:41], v114, s[16:19], s52 offen sc1
    s_add_u32 s52, s52, 5248
    buffer_load_dwordx2 v[42:43], v114, s[16:19], s52 offen sc1
    s_add_u32 s52, s52, 5248
p1_tl1:
p1_tr0:
    ds_read_b32 v68, v117 offset:0
    ds_read_b32 v69, v117 offset:4
    ds_read_b32 v70, v117 offset:8
    ds_read_b32 v71, v118 offset:10496
    ds_read_b32 v72, v118 offset:10500
    ds_read_b32 v74, v117 offset:12288
    ds_read_b32 v75, v117 offset:12292
    ds_read_b32 v76, v117 offset:12296
    ds_read_b32 v77, v118 offset:13568
    ds_read_b32 v78, v118 offset:13572
    s_waitcnt lgkmcnt(5)
    ds_read_b32 v80, v117 offset:24576
    ds_read_b32 v81, v117 offset:24580
    ds_read_b32 v82, v117 offset:24584
    ds_read_b32 v83, v118 offset:16640
    ds_read_b32 v84, v118 offset:16644
    v_alignbyte_b32 v71, v72, v71, v119
    buffer_store_dwordx4 v[68:71], v120, s[20:23], 0 offen
    v_add_u32 v120, 33554432, v120
    s_waitcnt lgkmcnt(5)
    ds_read_b32 v68, v117 offset:36864
    ds_read_b32 v69, v117 offset:36868
    ds_read_b32 v70, v117 offset:36872
    ds_read_b32 v71, v118 offset:19712
    ds_read_b32 v72, v118 offset:19716
    v_alignbyte_b32 v77, v78, v77, v119
    buffer_store_dwordx4 v[74:77], v120, s[20:23], 0 offen
    v_add_u32 v120, 33554432, v120
    s_waitcnt lgkmcnt(5)
    ds_read_b32 v74, v117 offset:49152
    ds_read_b32 v75, v117 offset:49156
    ds_read_b32 v76, v117 offset:49160
    ds_read_b32 v77, v118 offset:22784
    ds_read_b32 v78, v118 offset:22788
    v_alignbyte_b32 v83, v84, v83, v119
    buffer_store_dwordx4 v[80:83], v120, s[20:23], 0 offen
    v_add_u32 v120, 33554432, v120
    s_waitcnt lgkmcnt(5)
    v_add_u32 v117, 61440, v117
    ds_read_b32 v80, v117 offset:0
    ds_read_b32 v81, v117 offset:4
    ds_read_b32 v82, v117 offset:8
    ds_read_b32 v83, v118 offset:25856
    ds_read_b32 v84, v118 offset:25860
    v_alignbyte_b32 v71, v72, v71, v119
    buffer_store_dwordx4 v[68:71], v120, s[20:23], 0 offen
    v_add_u32 v120, 33554432, v120
    s_waitcnt lgkmcnt(5)
    ds_read_b32 v68, v117 offset:12288
    ds_read_b32 v69, v117 offset:12292
    ds_read_b32 v70, v117 offset:12296
    ds_read_b32 v71, v118 offset:28928
    ds_read_b32 v72, v118 offset:28932
    v_alignbyte_b32 v77, v78, v77, v119
    buffer_store_dwordx4 v[74:77], v120, s[20:23], 0 offen
    v_add_u32 v120, 33554432, v120
    s_waitcnt lgkmcnt(5)
    ds_read_b32 v74, v117 offset:24576
    ds_read_b32 v75, v117 offset:24580
    ds_read_b32 v76, v117 offset:24584
    ds_read_b32 v77, v118 offset:32000
    ds_read_b32 v78, v118 offset:32004
    v_alignbyte_b32 v83, v84, v83, v119
    buffer_store_dwordx4 v[80:83], v120, s[20:23], 0 offen nt
    v_add_u32 v120, 33554432, v120
    s_waitcnt lgkmcnt(5)
    ds_read_b32 v80, v117 offset:36864
    ds_read_b32 v81, v117 offset:36868
    ds_read_b32 v82, v117 offset:36872
    ds_read_b32 v83, v118 offset:35072
    ds_read_b32 v84, v118 offset:35076
    v_alignbyte_b32 v71, v72, v71, v119
    buffer_store_dwordx4 v[68:71], v120, s[20:23], 0 offen nt
    v_add_u32 v120, 33554432, v120
    s_waitcnt lgkmcnt(5)
    ds_read_b32 v68, v117 offset:49152
    ds_read_b32 v69, v117 offset:49156
    ds_read_b32 v70, v117 offset:49160
    ds_read_b32 v71, v118 offset:38144
    ds_read_b32 v72, v118 offset:38148
    v_alignbyte_b32 v77, v78, v77, v119
    buffer_store_dwordx4 v[74:77], v120, s[20:23], 0 offen nt
    v_add_u32 v120, 33554432, v120
    s_waitcnt lgkmcnt(5)
    v_alignbyte_b32 v83, v84, v83, v119
    buffer_store_dwordx4 v[80:83], v120, s[20:23], 0 offen nt
    v_add_u32 v120, 33554432, v120
    s_waitcnt lgkmcnt(0)
    v_alignbyte_b32 v71, v72, v71, v119
    buffer_store_dwordx4 v[68:71], v120, s[20:23], 0 offen nt
    s_mov_b32 s54, 0x05040100
    s_mov_b32 s55, 0x07060302
    s_cmp_lg_u32 s71, 8
    s_cbranch_scc1 p1_ts0
    s_lshr_b32 s52, s29, 3
    s_mul_i32 s52, s52, 41600
    s_add_u32 s52, s52, 346292224
    s_waitcnt vmcnt(10)
    v_perm_b32 v102, v88, v86, s54
    v_perm_b32 v103, v92, v90, s54
    v_perm_b32 v104, v96, v94, s54
    v_perm_b32 v105, v100, v98, s54
    buffer_store_dwordx4 v[102:105], v115, s[16:19], s52 offen offset:0
    v_perm_b32 v106, v88, v86, s55
    v_perm_b32 v107, v92, v90, s55
    v_perm_b32 v108, v96, v94, s55
    v_perm_b32 v109, v100, v98, s55
    buffer_store_dwordx4 v[106:109], v115, s[16:19], s52 offen offset:1040
    v_perm_b32 v110, v89, v87, s54
    v_perm_b32 v111, v93, v91, s54
    v_perm_b32 v112, v97, v95, s54
    v_perm_b32 v113, v101, v99, s54
    buffer_store_dwordx4 v[110:113], v115, s[16:19], s52 offen offset:2080
    v_perm_b32 v102, v89, v87, s55
    v_perm_b32 v103, v93, v91, s55
    v_perm_b32 v104, v97, v95, s55
    v_perm_b32 v105, v101, v99, s55
    buffer_store_dwordx4 v[102:105], v115, s[16:19], s52 offen offset:3120
p1_ts0:
    s_cmp_lg_u32 s3, 8
    s_cbranch_scc1 p1_ts1
    s_sub_u32 s52, s68, 2048
    s_mul_i32 s52, s52, 41600
    s_add_u32 s52, s52, 346292224
    s_waitcnt vmcnt(10)
    v_perm_b32 v44, v30, v28, s54
    v_perm_b32 v45, v34, v32, s54
    v_perm_b32 v46, v38, v36, s54
    v_perm_b32 v47, v42, v40, s54
    buffer_store_dwordx4 v[44:47], v115, s[16:19], s52 offen offset:0
    v_perm_b32 v48, v30, v28, s55
    v_perm_b32 v49, v34, v32, s55
    v_perm_b32 v50, v38, v36, s55
    v_perm_b32 v51, v42, v40, s55
    buffer_store_dwordx4 v[48:51], v115, s[16:19], s52 offen offset:1040
    v_perm_b32 v52, v31, v29, s54
    v_perm_b32 v53, v35, v33, s54
    v_perm_b32 v54, v39, v37, s54
    v_perm_b32 v55, v43, v41, s54
    buffer_store_dwordx4 v[52:55], v115, s[16:19], s52 offen offset:2080
    v_perm_b32 v56, v31, v29, s55
    v_perm_b32 v57, v35, v33, s55
    v_perm_b32 v58, v39, v37, s55
    v_perm_b32 v59, v43, v41, s55
    buffer_store_dwordx4 v[56:59], v115, s[16:19], s52 offen offset:3120
p1_ts1:
    s_barrier
    s_mov_b32 s29, s68
    s_mov_b32 s68, s69
    s_cmp_lt_u32 s29, 2048
    s_cbranch_scc1 p1_tile
p1_end:
    s_endpgm
.globl p2_kernel
.p2align 8
.type p2_kernel,@function
p2_kernel:
    s_cmp_ge_u32 s2, 256
    s_cbranch_scc1 p2_end
    s_load_dwordx2 s[8:9], s[0:1], 104
    v_and_b32 v112, 63, v0
    v_lshrrev_b32 v122, 6, v0
    v_lshlrev_b32 v112, 4, v112
    v_readfirstlane_b32 s10, v122
    v_mov_b32 v113, 0x83ff0000
    s_and_b32 s44, s2, 7
    s_lshr_b32 s11, s44, 1
    s_and_b32 s44, s44, 1
    s_lshl_b32 s12, s44, 5
    s_lshr_b32 s44, s2, 3
    s_add_u32 s12, s12, s44
    s_mov_b32 s25, 54272
    s_mov_b32 s31, 67175170
    s_mov_b32 s32, 83952386
    s_mov_b32 s33, 100729602
    s_mov_b32 s21, 0
    s_mul_i32 s23, s10, 3072
    s_lshl_b32 s24, s10, 9
    s_lshl_b32 s64, s10, 10
    s_sub_u32 s42, s24, s23
    s_add_u32 s42, s42, 49152
    s_lshl_b32 s41, s10, 25
    s_mov_b32 s63, 16384
    s_movk_i32 s65, 0x7800
    s_mul_i32 s62, s11, 161280
    s_add_u32 s62, s62, 356941824
    s_add_u32 s62, s62, s23
    s_mul_i32 s40, s10, 665600
    s_add_u32 s40, s40, 346292224
    s_mul_i32 s44, s11, 1040
    s_add_u32 s40, s40, s44
    s_lshl_b32 s44, s12, 4
    s_add_u32 s40, s40, s44
    s_waitcnt lgkmcnt(0)
    s_mov_b32 s4, s8
    s_and_b32 s5, s9, 0xffff
    s_mov_b32 s6, 819200000
    s_mov_b32 s7, 0x20000
    s_mov_b32 s68, s8
    s_and_b32 s69, s9, 0xffff
    s_mov_b32 s70, 335544320
    s_mov_b32 s71, 0x20000
p2_restart:
    s_mov_b32 s61, 0
    s_mul_i32 s44, s61, 4160
    s_add_u32 s44, s44, s40
    v_lshrrev_b32 v110, 6, v112
    v_bfe_u32 v111, v112, 2, 4
    v_mul_u32_u24 v110, 41600, v110
    v_add_u32 v111, v110, v111
    buffer_load_dword v110, v111, s[4:7], s44 offen
    buffer_load_dword v111, v111, s[4:7], s44 offen offset:16
    s_mov_b32 s61, 1
    s_mul_i32 s44, s61, 4160
    s_add_u32 s44, s44, s40
    v_lshrrev_b32 v68, 6, v112
    v_bfe_u32 v69, v112, 2, 4
    v_mul_u32_u24 v68, 41600, v68
    v_add_u32 v69, v68, v69
    buffer_load_dword v68, v69, s[4:7], s44 offen
    buffer_load_dword v69, v69, s[4:7], s44 offen offset:16
    s_mov_b32 s61, 0
    s_cmp_lt_u32 s10, 15
    s_cselect_b32 s44, s64, 0x40000000
    v_add_u32 v60, s44, v112
    s_mov_b32 s44, 363393024
    buffer_load_dwordx4 v[60:63], v60, s[4:7], s44 offen
    s_mov_b32 s20, s62
    s_cmp_ge_u32 s10, 9
    s_cbranch_scc1 p2_nmp
    v_lshrrev_b32 v84, 1, v112
    s_add_u32 s44, s20, s42
    buffer_load_dwordx2 v[84:85], v84, s[4:7], s44 offen
p2_nmp:
    buffer_load_dwordx4 v[72:75], v112, s[4:7], s20 offen offset:0
    buffer_load_dwordx4 v[76:79], v112, s[4:7], s20 offen offset:1024
    buffer_load_dwordx4 v[80:83], v112, s[4:7], s20 offen offset:2048
    s_barrier
    v_mov_b32 v115, 0
    v_mov_b32 v116, 0
    v_mov_b32 v117, 0
    v_mov_b32 v118, 0
    v_mov_b32 v119, 0
    v_mov_b32 v120, 0
    v_mov_b32 v121, 0
    ds_write_b128 v115, v[116:119] offset:53760
    s_mov_b32 s19, 0
    s_cmp_eq_u32 s21, 2
    s_cselect_b64 s[66:67], -1, 0
    s_waitcnt lgkmcnt(0)
    s_barrier
    s_waitcnt vmcnt(6)
    s_mov_b32 m0, s23
    v_mov_b32 v53, 0x3c000
    s_movk_i32 s44, 512
    v_sub_u32_sdwa v4, v111, v110 dst_sel:DWORD dst_unused:UNUSED_PAD src0_sel:WORD_0 src1_sel:WORD_0
    v_sub_u32_sdwa v5, v111, v110 dst_sel:DWORD dst_unused:UNUSED_PAD src0_sel:WORD_1 src1_sel:WORD_1
    v_med3_i32 v4, v4, 0, s44
    v_med3_i32 v5, v5, 0, s44
    v_add_u32 v48, v4, v5
    ds_write_addtid_b32 v53 offset:0
    ds_write_addtid_b32 v53 offset:256
    ds_write_addtid_b32 v53 offset:512
    ds_write_addtid_b32 v53 offset:768
    ds_write_addtid_b32 v53 offset:1024
    ds_write_addtid_b32 v53 offset:1280
    ds_write_addtid_b32 v53 offset:1536
    ds_write_addtid_b32 v53 offset:1792
    v_lshl_add_u32 v53, v112, 15, s41
    s_nop 1
    v_add_u32_dpp v48, v48, v48 row_shr:1 row_mask:0xf bank_mask:0xf bound_ctrl:0
    s_nop 1
    v_add_u32_dpp v48, v48, v48 row_shr:2 row_mask:0xf bank_mask:0xf bound_ctrl:0
    s_nop 1
    v_add_u32_dpp v48, v48, v48 row_shr:4 row_mask:0xf bank_mask:0xf bound_ctrl:0
    s_nop 1
    v_add_u32_dpp v48, v48, v48 row_shr:8 row_mask:0xf bank_mask:0xf bound_ctrl:0
    s_nop 1
    v_add_u32_dpp v48, v48, v48 row_bcast:15 row_mask:0xa bank_mask:0xf
    s_nop 1
    v_add_u32_dpp v48, v48, v48 row_bcast:31 row_mask:0xc bank_mask:0xf
    s_nop 1
    s_nop 0
    v_readlane_b32 s38, v48, 63
    v_sub_u32 v50, v48, v5
    v_sub_u32 v49, v50, v4
    v_sub_u32 v10, 512, v49
    v_mad_u32_u16 v51, v110, 16, v53
    v_med3_i32 v10, v10, 0, v4
    v_lshl_add_u32 v49, v49, 2, s23
    v_sub_u32 v11, 512, v50
    v_mad_u32_u16 v52, v110, 16, v53 op_sel:[1,0,0,0]
    v_med3_i32 v11, v11, 0, v5
    v_lshl_add_u32 v50, v50, 2, s23
    v_lshl_add_u32 v48, v11, 16, v10
    v_add_u32 v52, 262144, v52
    v_add_u32 v110, v110, v48
    s_min_u32 s17, s38, 512
    s_add_u32 s17, s17, 63
    s_lshr_b32 s17, s17, 6
p2_xa_0:
    v_cmpx_lt_i32 vcc, 0, v10
    s_cbranch_execz p2_ya_0
    ds_write_b32 v49, v51 offset:0
    v_add_u32 v51, 16, v51
    v_cmpx_lt_i32 vcc, 1, v10
    s_cbranch_execz p2_ya_0
    ds_write_b32 v49, v51 offset:4
    v_add_u32 v51, 16, v51
    v_cmpx_lt_i32 vcc, 2, v10
    s_cbranch_execz p2_ya_0
    ds_write_b32 v49, v51 offset:8
    v_add_u32 v51, 16, v51
    v_cmpx_lt_i32 vcc, 3, v10
    s_cbranch_execz p2_ya_0
    ds_write_b32 v49, v51 offset:12
    v_add_u32 v51, 16, v51
    v_cmpx_lt_i32 vcc, 4, v10
    s_cbranch_execz p2_ya_0
    ds_write_b32 v49, v51 offset:16
    v_add_u32 v51, 16, v51
    v_cmpx_lt_i32 vcc, 5, v10
    s_cbranch_execz p2_ya_0
    ds_write_b32 v49, v51 offset:20
    v_add_u32 v51, 16, v51
    v_cmpx_lt_i32 vcc, 6, v10
    s_cbranch_execz p2_ya_0
    ds_write_b32 v49, v51 offset:24
    v_add_u32 v51, 16, v51
    v_cmpx_lt_i32 vcc, 7, v10
    s_cbranch_execz p2_ya_0
    ds_write_b32 v49, v51 offset:28
    v_add_u32 v51, 16, v51
    v_subrev_u32 v10, 8, v10
    v_add_u32 v49, 32, v49
    s_branch p2_xa_0
p2_ya_0:
    s_mov_b64 exec, -1
p2_xa_1:
    v_cmpx_lt_i32 vcc, 0, v11
    s_cbranch_execz p2_ya_1
    ds_write_b32 v50, v52 offset:0
    v_add_u32 v52, 16, v52
    v_cmpx_lt_i32 vcc, 1, v11
    s_cbranch_execz p2_ya_1
    ds_write_b32 v50, v52 offset:4
    v_add_u32 v52, 16, v52
    v_cmpx_lt_i32 vcc, 2, v11
    s_cbranch_execz p2_ya_1
    ds_write_b32 v50, v52 offset:8
    v_add_u32 v52, 16, v52
    v_cmpx_lt_i32 vcc, 3, v11
    s_cbranch_execz p2_ya_1
    ds_write_b32 v50, v52 offset:12
    v_add_u32 v52, 16, v52
    v_cmpx_lt_i32 vcc, 4, v11
    s_cbranch_execz p2_ya_1
    ds_write_b32 v50, v52 offset:16
    v_add_u32 v52, 16, v52
    v_cmpx_lt_i32 vcc, 5, v11
    s_cbranch_execz p2_ya_1
    ds_write_b32 v50, v52 offset:20
    v_add_u32 v52, 16, v52
    v_cmpx_lt_i32 vcc, 6, v11
    s_cbranch_execz p2_ya_1
    ds_write_b32 v50, v52 offset:24
    v_add_u32 v52, 16, v52
    v_cmpx_lt_i32 vcc, 7, v11
    s_cbranch_execz p2_ya_1
    ds_write_b32 v50, v52 offset:28
    v_add_u32 v52, 16, v52
    v_subrev_u32 v11, 8, v11
    v_add_u32 v50, 32, v50
    s_branch p2_xa_1
p2_ya_1:
    s_mov_b64 exec, -1
    s_cmp_lt_u32 s38, 512
    s_cbranch_scc1 p2_nomorea
    v_cmp_lt_u32_sdwa s[44:45], v110, v111 src0_sel:WORD_0 src1_sel:WORD_0
    v_cmp_lt_u32_sdwa s[46:47], v110, v111 src0_sel:WORD_1 src1_sel:WORD_1
    s_nop 0
    s_or_b64 s[44:45], s[44:45], s[46:47]
    s_cbranch_scc0 p2_nomorea
    v_mov_b32 v49, s19
    v_mov_b32 v50, 1
    ds_write_b32 v49, v50 offset:53760
p2_nomorea:
    s_mov_b32 m0, s23
    s_nop 0
    ds_read_addtid_b32 v2 offset:0
    ds_read_addtid_b32 v8 offset:256
    ds_read_addtid_b32 v14 offset:512
    ds_read_addtid_b32 v20 offset:768
    ds_read_addtid_b32 v88 offset:1024
    ds_read_addtid_b32 v92 offset:1280
    ds_read_addtid_b32 v96 offset:1536
    ds_read_addtid_b32 v100 offset:1792
    s_waitcnt lgkmcnt(0)
    v_lshrrev_b32 v0, 3, v2
    v_lshrrev_b32 v1, 18, v2
    v_and_b32 v2, 0x3fff, v2
    v_and_or_b32 v0, v0, s65, v1
    v_mad_u32_u24 v2, v0, s63, v2
    buffer_load_dwordx4 v[0:3], v2, s[68:71], 0 offen
    v_lshrrev_b32 v6, 3, v8
    v_lshrrev_b32 v7, 18, v8
    v_and_b32 v8, 0x3fff, v8
    v_and_or_b32 v6, v6, s65, v7
    v_mad_u32_u24 v8, v6, s63, v8
    buffer_load_dwordx4 v[6:9], v8, s[68:71], 0 offen
    s_cmp_eq_u32 s21, 0
    s_cselect_b32 s44, 1073758208, 0
    v_mov_b32 v124, s44
    v_mov_b32 v125, s44
    v_mov_b32 v126, s44
    v_mov_b32 v127, s44
    v_add_u32 v123, s64, v112
    v_add_u32 v122, s25, v123
    ds_write_b128 v122, v[124:127] offset:0
    ds_write_b128 v122, v[124:127] offset:16384
    ds_write_b128 v122, v[124:127] offset:32768
    v_add_u32 v122, 49152, v122
    ds_write_b128 v122, v[124:127] offset:0
    ds_write_b128 v122, v[124:127] offset:16384
    ds_write_b128 v122, v[124:127] offset:32768
    v_cmpx_gt_u32 vcc, 1792, v123
    ds_write_b128 v122, v[124:127] offset:49152
    s_mov_b64 exec, -1
    v_lshrrev_b32 v12, 3, v14
    v_lshrrev_b32 v13, 18, v14
    v_and_b32 v14, 0x3fff, v14
    v_and_or_b32 v12, v12, s65, v13
    v_mad_u32_u24 v14, v12, s63, v14
    buffer_load_dwordx4 v[12:15], v14, s[68:71], 0 offen
    s_mov_b32 s16, s17
    s_waitcnt vmcnt(6)
    s_cmp_lg_u32 s21, 0
    s_cbranch_scc1 p2_nostat1
    v_max_u32 v60, v60, v62
    v_add_f32 v61, v61, v63
    s_nop 1
    v_max_u32_dpp v60, v60, v60 row_shr:1 row_mask:0xf bank_mask:0xf bound_ctrl:0
    v_add_f32_dpp v61, v61, v61 row_shr:1 row_mask:0xf bank_mask:0xf bound_ctrl:0
    s_nop 0
    v_max_u32_dpp v60, v60, v60 row_shr:2 row_mask:0xf bank_mask:0xf bound_ctrl:0
    v_add_f32_dpp v61, v61, v61 row_shr:2 row_mask:0xf bank_mask:0xf bound_ctrl:0
    s_nop 0
    v_max_u32_dpp v60, v60, v60 row_shr:4 row_mask:0xf bank_mask:0xf bound_ctrl:0
    v_add_f32_dpp v61, v61, v61 row_shr:4 row_mask:0xf bank_mask:0xf bound_ctrl:0
    s_nop 0
    v_max_u32_dpp v60, v60, v60 row_shr:8 row_mask:0xf bank_mask:0xf bound_ctrl:0
    v_add_f32_dpp v61, v61, v61 row_shr:8 row_mask:0xf bank_mask:0xf bound_ctrl:0
    s_nop 0
    v_max_u32_dpp v60, v60, v60 row_bcast:15 row_mask:0xa bank_mask:0xf
    v_add_f32_dpp v61, v61, v61 row_bcast:15 row_mask:0xa bank_mask:0xf
    s_nop 0
    v_max_u32_dpp v60, v60, v60 row_bcast:31 row_mask:0xc bank_mask:0xf
    v_add_f32_dpp v61, v61, v61 row_bcast:31 row_mask:0xc bank_mask:0xf
    s_nop 0
    s_nop 0
    s_lshl_b32 s44, s10, 3
    v_mov_b32 v62, s44
    s_mov_b64 exec, 1
    s_lshl_b64 exec, exec, 63
    ds_write_b64 v62, v[60:61] offset:53824
    s_mov_b64 exec, -1
p2_nostat1:
    s_waitcnt lgkmcnt(0)
    s_barrier
    v_lshrrev_b32 v18, 3, v20
    v_lshrrev_b32 v19, 18, v20
    v_and_b32 v20, 0x3fff, v20
    v_and_or_b32 v18, v18, s65, v19
    v_mad_u32_u24 v20, v18, s63, v20
    buffer_load_dwordx4 v[18:21], v20, s[68:71], 0 offen
    v_mov_b32 v122, s19
    s_xor_b32 s19, s19, 4
    ds_read_b32 v125, v122 offset:53760
    s_cmp_lg_u32 s21, 0
    s_cbranch_scc1 p2_nostat2
    v_bfe_u32 v62, v112, 1, 7
    ds_read_b64 v[60:61], v62 offset:53824
    s_waitcnt lgkmcnt(0)
    s_nop 1
    v_max_u32_dpp v60, v60, v60 row_shr:1 row_mask:0xf bank_mask:0xf bound_ctrl:0
    v_add_f32_dpp v61, v61, v61 row_shr:1 row_mask:0xf bank_mask:0xf bound_ctrl:0
    s_nop 0
    v_max_u32_dpp v60, v60, v60 row_shr:2 row_mask:0xf bank_mask:0xf bound_ctrl:0
    v_add_f32_dpp v61, v61, v61 row_shr:2 row_mask:0xf bank_mask:0xf bound_ctrl:0
    s_nop 0
    v_max_u32_dpp v60, v60, v60 row_shr:4 row_mask:0xf bank_mask:0xf bound_ctrl:0
    v_add_f32_dpp v61, v61, v61 row_shr:4 row_mask:0xf bank_mask:0xf bound_ctrl:0
    s_nop 0
    v_max_u32_dpp v60, v60, v60 row_shr:8 row_mask:0xf bank_mask:0xf bound_ctrl:0
    v_add_f32_dpp v61, v61, v61 row_shr:8 row_mask:0xf bank_mask:0xf bound_ctrl:0
    s_nop 0
    v_max_u32_dpp v60, v60, v60 row_bcast:15 row_mask:0xa bank_mask:0xf
    v_add_f32_dpp v61, v61, v61 row_bcast:15 row_mask:0xa bank_mask:0xf
    s_nop 0
    v_max_u32_dpp v60, v60, v60 row_bcast:31 row_mask:0xc bank_mask:0xf
    v_add_f32_dpp v61, v61, v61 row_bcast:31 row_mask:0xc bank_mask:0xf
    s_nop 0
    s_nop 0
    v_readlane_b32 s44, v60, 15
    v_readlane_b32 s45, v61, 15
    s_nop 1
    s_lshl_b32 s44, s44, 16
    s_lshr_b32 s46, s44, 23
    s_sub_u32 s47, s46, 80
    s_cmp_lt_u32 s47, 100
    s_cselect_b32 s21, 0, 1
    v_mov_b32 v60, s45
    v_mul_f32 v60, 0x34a7c5ac, v60
    v_sqrt_f32 v60, v60
    v_mov_b32 v61, s44
    v_mul_f32 v62, 0x41800000, v60
    v_cmp_nle_f32 vcc, v61, v62
    v_mul_f32 v60, 0x3ac00000, v60
    v_mul_f32 v61, 0x3901742e, v61
    v_max_f32 v60, v60, v61
    s_cmp_lg_u64 vcc, 0
    s_cselect_b32 s21, 1, s21
    v_readfirstlane_b32 s44, v60
    s_nop 0
    s_and_b32 s47, s44, 0x7fffff
    s_or_b32 s47, s47, 0x3f000000
    s_and_b32 s48, s44, 0x7f800000
    s_add_u32 s48, s48, 0x800000
    v_rcp_f32 v60, s47
    s_nop 0
    v_rcp_f32 v61, v60
    v_mul_f32 v60, 0x7b800000, v60
    v_mul_f32 v61, s48, v61
    s_nop 0
    v_readfirstlane_b32 s26, v60
    v_readfirstlane_b32 s30, v61
    s_add_u32 s34, s48, 197132288
    s_mov_b32 s35, s34
    s_sub_u32 s36, 0, s34
    s_subb_u32 s37, 0, s34
    s_cmp_eq_u32 s21, 0
    s_cbranch_scc1 p2_nostat2
    s_waitcnt vmcnt(0) lgkmcnt(0)
    s_branch p2_restart
p2_nostat2:
    s_cmp_eq_u32 s21, 0
    s_cselect_b32 s26, s26, 0x7b800000
    v_mov_b32 v114, s26
    s_waitcnt lgkmcnt(0)
    v_readfirstlane_b32 s44, v125
    s_nop 0
    s_cmp_lg_u32 s44, 0
    s_cbranch_scc1 p2_adva
    s_mov_b32 s61, 1
    v_mov_b32 v110, v68
    v_mov_b32 v111, v69
p2_adva:
    v_lshrrev_b32 v86, 3, v88
    v_lshrrev_b32 v87, 18, v88
    v_and_b32 v88, 0x3fff, v88
    v_and_or_b32 v86, v86, s65, v87
    v_mad_u32_u24 v88, v86, s63, v88
    buffer_load_dwordx4 v[86:89], v88, s[68:71], 0 offen
    s_mov_b32 m0, s23
    v_mov_b32 v53, 0x3c000
    s_movk_i32 s44, 512
    v_sub_u32_sdwa v4, v111, v110 dst_sel:DWORD dst_unused:UNUSED_PAD src0_sel:WORD_0 src1_sel:WORD_0
    v_sub_u32_sdwa v5, v111, v110 dst_sel:DWORD dst_unused:UNUSED_PAD src0_sel:WORD_1 src1_sel:WORD_1
    v_med3_i32 v4, v4, 0, s44
    v_med3_i32 v5, v5, 0, s44
    v_add_u32 v48, v4, v5
    ds_write_addtid_b32 v53 offset:0
    ds_write_addtid_b32 v53 offset:256
    ds_write_addtid_b32 v53 offset:512
    ds_write_addtid_b32 v53 offset:768
    ds_write_addtid_b32 v53 offset:1024
    ds_write_addtid_b32 v53 offset:1280
    ds_write_addtid_b32 v53 offset:1536
    ds_write_addtid_b32 v53 offset:1792
    v_lshl_add_u32 v53, v112, 15, s41
    s_nop 1
    v_add_u32_dpp v48, v48, v48 row_shr:1 row_mask:0xf bank_mask:0xf bound_ctrl:0
    s_nop 1
    v_add_u32_dpp v48, v48, v48 row_shr:2 row_mask:0xf bank_mask:0xf bound_ctrl:0
    s_nop 1
    v_add_u32_dpp v48, v48, v48 row_shr:4 row_mask:0xf bank_mask:0xf bound_ctrl:0
    s_nop 1
    v_add_u32_dpp v48, v48, v48 row_shr:8 row_mask:0xf bank_mask:0xf bound_ctrl:0
    s_nop 1
    v_add_u32_dpp v48, v48, v48 row_bcast:15 row_mask:0xa bank_mask:0xf
    s_nop 1
    v_add_u32_dpp v48, v48, v48 row_bcast:31 row_mask:0xc bank_mask:0xf
    s_nop 1
    s_nop 0
    v_readlane_b32 s38, v48, 63
    v_sub_u32 v50, v48, v5
    v_sub_u32 v49, v50, v4
    v_sub_u32 v10, 512, v49
    v_mad_u32_u16 v51, v110, 16, v53
    v_med3_i32 v10, v10, 0, v4
    v_lshl_add_u32 v49, v49, 2, s23
    v_sub_u32 v11, 512, v50
    v_mad_u32_u16 v52, v110, 16, v53 op_sel:[1,0,0,0]
    v_med3_i32 v11, v11, 0, v5
    v_lshl_add_u32 v50, v50, 2, s23
    v_lshl_add_u32 v48, v11, 16, v10
    v_add_u32 v52, 262144, v52
    v_add_u32 v110, v110, v48
    s_min_u32 s17, s38, 512
    s_add_u32 s17, s17, 63
    s_lshr_b32 s17, s17, 6
p2_xb_0:
    v_cmpx_lt_i32 vcc, 0, v10
    s_cbranch_execz p2_yb_0
    ds_write_b32 v49, v51 offset:0
    v_add_u32 v51, 16, v51
    v_cmpx_lt_i32 vcc, 1, v10
    s_cbranch_execz p2_yb_0
    ds_write_b32 v49, v51 offset:4
    v_add_u32 v51, 16, v51
    v_cmpx_lt_i32 vcc, 2, v10
    s_cbranch_execz p2_yb_0
    ds_write_b32 v49, v51 offset:8
    v_add_u32 v51, 16, v51
    v_cmpx_lt_i32 vcc, 3, v10
    s_cbranch_execz p2_yb_0
    ds_write_b32 v49, v51 offset:12
    v_add_u32 v51, 16, v51
    v_cmpx_lt_i32 vcc, 4, v10
    s_cbranch_execz p2_yb_0
    ds_write_b32 v49, v51 offset:16
    v_add_u32 v51, 16, v51
    v_cmpx_lt_i32 vcc, 5, v10
    s_cbranch_execz p2_yb_0
    ds_write_b32 v49, v51 offset:20
    v_add_u32 v51, 16, v51
    v_cmpx_lt_i32 vcc, 6, v10
    s_cbranch_execz p2_yb_0
    ds_write_b32 v49, v51 offset:24
    v_add_u32 v51, 16, v51
    v_cmpx_lt_i32 vcc, 7, v10
    s_cbranch_execz p2_yb_0
    ds_write_b32 v49, v51 offset:28
    v_add_u32 v51, 16, v51
    v_subrev_u32 v10, 8, v10
    v_add_u32 v49, 32, v49
    s_branch p2_xb_0
p2_yb_0:
    s_mov_b64 exec, -1
p2_xb_1:
    v_cmpx_lt_i32 vcc, 0, v11
    s_cbranch_execz p2_yb_1
    ds_write_b32 v50, v52 offset:0
    v_add_u32 v52, 16, v52
    v_cmpx_lt_i32 vcc, 1, v11
    s_cbranch_execz p2_yb_1
    ds_write_b32 v50, v52 offset:4
    v_add_u32 v52, 16, v52
    v_cmpx_lt_i32 vcc, 2, v11
    s_cbranch_execz p2_yb_1
    ds_write_b32 v50, v52 offset:8
    v_add_u32 v52, 16, v52
    v_cmpx_lt_i32 vcc, 3, v11
    s_cbranch_execz p2_yb_1
    ds_write_b32 v50, v52 offset:12
    v_add_u32 v52, 16, v52
    v_cmpx_lt_i32 vcc, 4, v11
    s_cbranch_execz p2_yb_1
    ds_write_b32 v50, v52 offset:16
    v_add_u32 v52, 16, v52
    v_cmpx_lt_i32 vcc, 5, v11
    s_cbranch_execz p2_yb_1
    ds_write_b32 v50, v52 offset:20
    v_add_u32 v52, 16, v52
    v_cmpx_lt_i32 vcc, 6, v11
    s_cbranch_execz p2_yb_1
    ds_write_b32 v50, v52 offset:24
    v_add_u32 v52, 16, v52
    v_cmpx_lt_i32 vcc, 7, v11
    s_cbranch_execz p2_yb_1
    ds_write_b32 v50, v52 offset:28
    v_add_u32 v52, 16, v52
    v_subrev_u32 v11, 8, v11
    v_add_u32 v50, 32, v50
    s_branch p2_xb_1
p2_yb_1:
    s_mov_b64 exec, -1
    s_cmp_lt_u32 s38, 512
    s_cbranch_scc1 p2_nomoreb
    v_cmp_lt_u32_sdwa s[44:45], v110, v111 src0_sel:WORD_0 src1_sel:WORD_0
    v_cmp_lt_u32_sdwa s[46:47], v110, v111 src0_sel:WORD_1 src1_sel:WORD_1
    s_nop 0
    s_or_b64 s[44:45], s[44:45], s[46:47]
    s_cbranch_scc0 p2_nomoreb
    v_mov_b32 v49, s19
    v_mov_b32 v50, 1
    ds_write_b32 v49, v50 offset:53760
p2_nomoreb:
    s_mov_b32 m0, s23
    s_nop 0
    ds_read_addtid_b32 v102 offset:0
    ds_read_addtid_b32 v103 offset:256
    ds_read_addtid_b32 v104 offset:512
    ds_read_addtid_b32 v105 offset:768
    ds_read_addtid_b32 v106 offset:1024
    ds_read_addtid_b32 v107 offset:1280
    ds_read_addtid_b32 v108 offset:1536
    ds_read_addtid_b32 v109 offset:1792
    v_lshrrev_b32 v90, 3, v92
    v_lshrrev_b32 v91, 18, v92
    v_and_b32 v92, 0x3fff, v92
    v_and_or_b32 v90, v90, s65, v91
    v_mad_u32_u24 v92, v90, s63, v92
    buffer_load_dwordx4 v[90:93], v92, s[68:71], 0 offen
    s_waitcnt vmcnt(6)
    s_mov_b32 m0, s24
    s_cmp_ge_u32 s10, 9
    s_cbranch_scc1 p2_stp
    ds_write_addtid_b32 v84 offset:49152
    ds_write_addtid_b32 v85 offset:49408
p2_stp:
    s_mov_b32 m0, s23
    s_add_u32 s20, s20, 53760
    ds_write_addtid_b32 v72 offset:0
    ds_write_addtid_b32 v73 offset:256
    ds_write_addtid_b32 v74 offset:512
    ds_write_addtid_b32 v75 offset:768
    ds_write_addtid_b32 v76 offset:1024
    ds_write_addtid_b32 v77 offset:1280
    ds_write_addtid_b32 v78 offset:1536
    ds_write_addtid_b32 v79 offset:1792
    ds_write_addtid_b32 v80 offset:2048
    ds_write_addtid_b32 v81 offset:2304
    ds_write_addtid_b32 v82 offset:2560
    ds_write_addtid_b32 v83 offset:2816
    s_waitcnt lgkmcnt(0)
    s_barrier
    v_lshrrev_b32 v94, 3, v96
    v_lshrrev_b32 v95, 18, v96
    v_and_b32 v96, 0x3fff, v96
    v_and_or_b32 v94, v94, s65, v95
    v_mad_u32_u24 v96, v94, s63, v96
    buffer_load_dwordx4 v[94:97], v96, s[68:71], 0 offen
    v_lshrrev_b32 v98, 3, v100
    v_lshrrev_b32 v99, 18, v100
    v_and_b32 v100, 0x3fff, v100
    v_and_or_b32 v98, v98, s65, v99
    v_mad_u32_u24 v100, v98, s63, v100
    buffer_load_dwordx4 v[98:101], v100, s[68:71], 0 offen
    s_cmp_ge_u32 s10, 9
    s_cbranch_scc1 p2_nmq
    v_lshrrev_b32 v84, 1, v112
    s_add_u32 s44, s20, s42
    buffer_load_dwordx2 v[84:85], v84, s[4:7], s44 offen
p2_nmq:
    buffer_load_dwordx4 v[72:75], v112, s[4:7], s20 offen offset:0
    buffer_load_dwordx4 v[76:79], v112, s[4:7], s20 offen offset:1024
    buffer_load_dwordx4 v[80:83], v112, s[4:7], s20 offen offset:2048
    s_waitcnt vmcnt(10)
    v_perm_b32 v48, v3, v0, s31
    v_perm_b32 v49, v3, v1, s32
    v_perm_b32 v50, v3, v2, s33
    v_lshlrev_b16 v4, 3, v2
    v_lshlrev_b16 v2, 3, v1
    v_lshlrev_b16 v0, 3, v0
    v_cmpx_ge_u16 vcc, 0x3fff, v48
    ds_read_b64 v[0:1], v0
    s_mov_b64 exec, -1
    v_cmpx_ge_u16 vcc, 0x3fff, v49
    ds_read_b64 v[2:3], v2
    s_mov_b64 exec, -1
    v_cmpx_ge_u16 vcc, 0x3fff, v50
    ds_read_b64 v[4:5], v4
    s_mov_b64 exec, -1
    s_waitcnt vmcnt(9)
    v_perm_b32 v51, v9, v6, s31
    v_perm_b32 v52, v9, v7, s32
    v_perm_b32 v53, v9, v8, s33
    v_lshlrev_b16 v10, 3, v8
    v_lshlrev_b16 v8, 3, v7
    v_lshlrev_b16 v6, 3, v6
    v_cmpx_ge_u16 vcc, 0x3fff, v51
    ds_read_b64 v[6:7], v6
    s_mov_b64 exec, -1
    v_cmpx_ge_u16 vcc, 0x3fff, v52
    ds_read_b64 v[8:9], v8
    s_mov_b64 exec, -1
    v_cmpx_ge_u16 vcc, 0x3fff, v53
    ds_read_b64 v[10:11], v10
    s_mov_b64 exec, -1
    s_waitcnt vmcnt(8)
    v_perm_b32 v54, v15, v12, s31
    v_perm_b32 v55, v15, v13, s32
    v_perm_b32 v56, v15, v14, s33
    v_lshlrev_b16 v16, 3, v14
    v_lshlrev_b16 v14, 3, v13
    v_lshlrev_b16 v12, 3, v12
    v_cmpx_ge_u16 vcc, 0x3fff, v54
    ds_read_b64 v[12:13], v12
    s_mov_b64 exec, -1
    v_cmpx_ge_u16 vcc, 0x3fff, v55
    ds_read_b64 v[14:15], v14
    s_mov_b64 exec, -1
    v_cmpx_ge_u16 vcc, 0x3fff, v56
    ds_read_b64 v[16:17], v16
    s_mov_b64 exec, -1
    s_waitcnt vmcnt(7)
    v_perm_b32 v57, v21, v18, s31
    v_perm_b32 v58, v21, v19, s32
    v_perm_b32 v59, v21, v20, s33
    v_lshlrev_b16 v22, 3, v20
    v_lshlrev_b16 v20, 3, v19
    v_lshlrev_b16 v18, 3, v18
    v_cmpx_ge_u16 vcc, 0x3fff, v57
    ds_read_b64 v[18:19], v18
    s_mov_b64 exec, -1
    v_cmpx_ge_u16 vcc, 0x3fff, v58
    ds_read_b64 v[20:21], v20
    s_mov_b64 exec, -1
    v_cmpx_ge_u16 vcc, 0x3fff, v59
    ds_read_b64 v[22:23], v22
    s_mov_b64 exec, -1
    s_waitcnt vmcnt(6)
    v_perm_b32 v60, v89, v86, s31
    v_perm_b32 v61, v89, v87, s32
    v_perm_b32 v62, v89, v88, s33
    v_lshlrev_b16 v28, 3, v88
    v_lshlrev_b16 v26, 3, v87
    v_lshlrev_b16 v24, 3, v86
    v_cmpx_ge_u16 vcc, 0x3fff, v60
    ds_read_b64 v[24:25], v24
    s_mov_b64 exec, -1
    v_cmpx_ge_u16 vcc, 0x3fff, v61
    ds_read_b64 v[26:27], v26
    s_mov_b64 exec, -1
    v_cmpx_ge_u16 vcc, 0x3fff, v62
    ds_read_b64 v[28:29], v28
    s_mov_b64 exec, -1
    v_lshrrev_b32 v86, 3, v106
    v_lshrrev_b32 v87, 18, v106
    v_and_b32 v106, 0x3fff, v106
    v_and_or_b32 v86, v86, s65, v87
    v_mad_u32_u24 v106, v86, s63, v106
    buffer_load_dwordx4 v[86:89], v106, s[68:71], 0 offen
    s_waitcnt vmcnt(6)
    v_perm_b32 v63, v93, v90, s31
    v_perm_b32 v64, v93, v91, s32
    v_perm_b32 v65, v93, v92, s33
    v_lshlrev_b16 v34, 3, v92
    v_lshlrev_b16 v32, 3, v91
    v_lshlrev_b16 v30, 3, v90
    v_cmpx_ge_u16 vcc, 0x3fff, v63
    ds_read_b64 v[30:31], v30
    s_mov_b64 exec, -1
    v_cmpx_ge_u16 vcc, 0x3fff, v64
    ds_read_b64 v[32:33], v32
    s_mov_b64 exec, -1
    v_cmpx_ge_u16 vcc, 0x3fff, v65
    ds_read_b64 v[34:35], v34
    s_mov_b64 exec, -1
    v_lshrrev_b32 v90, 3, v107
    v_lshrrev_b32 v91, 18, v107
    v_and_b32 v107, 0x3fff, v107
    v_and_or_b32 v90, v90, s65, v91
    v_mad_u32_u24 v107, v90, s63, v107
    buffer_load_dwordx4 v[90:93], v107, s[68:71], 0 offen
    s_waitcnt vmcnt(6)
    v_perm_b32 v66, v97, v94, s31
    v_perm_b32 v67, v97, v95, s32
    v_perm_b32 v68, v97, v96, s33
    v_lshlrev_b16 v40, 3, v96
    v_lshlrev_b16 v38, 3, v95
    v_lshlrev_b16 v36, 3, v94
    v_cmpx_ge_u16 vcc, 0x3fff, v66
    ds_read_b64 v[36:37], v36
    s_mov_b64 exec, -1
    v_cmpx_ge_u16 vcc, 0x3fff, v67
    ds_read_b64 v[38:39], v38
    s_mov_b64 exec, -1
    v_cmpx_ge_u16 vcc, 0x3fff, v68
    ds_read_b64 v[40:41], v40
    s_mov_b64 exec, -1
    s_waitcnt vmcnt(5)
    v_perm_b32 v69, v101, v98, s31
    v_perm_b32 v70, v101, v99, s32
    v_perm_b32 v71, v101, v100, s33
    v_lshlrev_b16 v46, 3, v100
    v_lshlrev_b16 v44, 3, v99
    v_lshlrev_b16 v42, 3, v98
    s_cmp_le_u32 s16, 7
    s_cbranch_scc1 p2_gp
    v_cmpx_ge_u16 vcc, 0x3fff, v69
    ds_read_b64 v[42:43], v42
    s_mov_b64 exec, -1
    v_cmpx_ge_u16 vcc, 0x3fff, v70
    ds_read_b64 v[44:45], v44
    s_mov_b64 exec, -1
    v_cmpx_ge_u16 vcc, 0x3fff, v71
    ds_read_b64 v[46:47], v46
    s_mov_b64 exec, -1
p2_gp:
    s_waitcnt lgkmcnt(0)
    s_barrier
    s_branch p2_tail
p2_top:
    s_cmp_lg_u32 s21, 0
    s_cbranch_scc1 p2_topf
    s_cmp_eq_u32 s60, 10
    s_cbranch_scc1 p2_drain0
    v_cmpx_gt_i16 vcc, 0, v48
    ds_read_b64 v[0:1], v0
    s_mov_b64 exec, -1
    v_cmpx_gt_i16 vcc, 0, v49
    ds_read_b64 v[2:3], v2
    s_mov_b64 exec, -1
    v_cmpx_gt_i16 vcc, 0, v50
    ds_read_b64 v[4:5], v4
    s_mov_b64 exec, -1
    v_cmpx_gt_i16 vcc, 0, v51
    ds_read_b64 v[6:7], v6
    s_mov_b64 exec, -1
    v_cmpx_gt_i16 vcc, 0, v52
    ds_read_b64 v[8:9], v8
    s_mov_b64 exec, -1
    v_cmpx_gt_i16 vcc, 0, v53
    ds_read_b64 v[10:11], v10
    s_mov_b64 exec, -1
    v_cmpx_gt_i16 vcc, 0, v54
    ds_read_b64 v[12:13], v12
    s_mov_b64 exec, -1
    v_cmpx_gt_i16 vcc, 0, v55
    ds_read_b64 v[14:15], v14
    s_mov_b64 exec, -1
    v_cmpx_gt_i16 vcc, 0, v56
    ds_read_b64 v[16:17], v16
    s_mov_b64 exec, -1
    v_cmpx_gt_i16 vcc, 0, v57
    ds_read_b64 v[18:19], v18
    s_mov_b64 exec, -1
    v_cmpx_gt_i16 vcc, 0, v58
    ds_read_b64 v[20:21], v20
    s_mov_b64 exec, -1
    v_cmpx_gt_i16 vcc, 0, v59
    ds_read_b64 v[22:23], v22
    s_mov_b64 exec, -1
    s_cmp_ge_u32 s10, 9
    s_cbranch_scc1 p2_nm0m0a
    v_lshrrev_b32 v84, 1, v112
    s_add_u32 s44, s20, s42
    buffer_load_dwordx2 v[84:85], v84, s[4:7], s44 offen
p2_nm0m0a:
    buffer_load_dwordx4 v[72:75], v112, s[4:7], s20 offen offset:0
    buffer_load_dwordx4 v[76:79], v112, s[4:7], s20 offen offset:1024
    buffer_load_dwordx4 v[80:83], v112, s[4:7], s20 offen offset:2048
    v_cmpx_gt_i16 vcc, 0, v60
    ds_read_b64 v[24:25], v24
    s_mov_b64 exec, -1
    v_cmpx_gt_i16 vcc, 0, v61
    ds_read_b64 v[26:27], v26
    s_mov_b64 exec, -1
    v_cmpx_gt_i16 vcc, 0, v62
    ds_read_b64 v[28:29], v28
    s_mov_b64 exec, -1
    v_cmpx_gt_i16 vcc, 0, v63
    ds_read_b64 v[30:31], v30
    s_mov_b64 exec, -1
    v_cmpx_gt_i16 vcc, 0, v64
    ds_read_b64 v[32:33], v32
    s_mov_b64 exec, -1
    v_cmpx_gt_i16 vcc, 0, v65
    ds_read_b64 v[34:35], v34
    s_mov_b64 exec, -1
    v_cmpx_gt_i16 vcc, 0, v66
    ds_read_b64 v[36:37], v36
    s_mov_b64 exec, -1
    v_cmpx_gt_i16 vcc, 0, v67
    ds_read_b64 v[38:39], v38
    s_mov_b64 exec, -1
    v_cmpx_gt_i16 vcc, 0, v68
    ds_read_b64 v[40:41], v40
    s_mov_b64 exec, -1
    s_cmp_le_u32 s15, 7
    s_cbranch_scc1 p2_g0r27
    v_cmpx_gt_i16 vcc, 0, v69
    ds_read_b64 v[42:43], v42
    s_mov_b64 exec, -1
    v_cmpx_gt_i16 vcc, 0, v70
    ds_read_b64 v[44:45], v44
    s_mov_b64 exec, -1
    v_cmpx_gt_i16 vcc, 0, v71
    ds_read_b64 v[46:47], v46
    s_mov_b64 exec, -1
p2_g0r27:
    s_waitcnt lgkmcnt(15)
    v_ashrrev_i32 v122, 5, v48
    v_lshlrev_b16 v123, 2, v48
    v_lshlrev_b32 v124, 16, v0
    v_bitop3_b32 v122, v122, v113, v113 bitop3:0x0c
    v_and_b32 v125, 0xffff0000, v0
    v_lshlrev_b32 v126, 16, v1
    v_mul_f32 v122, v114, v122
    v_and_b32 v127, 0xffff0000, v1
    v_add_u32 v123, v123, v123
    v_pk_fma_f32 v[124:125], v[124:125], v[122:123], s[34:35] op_sel_hi:[1,0,1]
    v_pk_fma_f32 v[126:127], v[126:127], v[122:123], s[34:35] op_sel_hi:[1,0,1]
    v_lshl_add_u32 v124, v125, 16, v124
    v_lshl_add_u32 v125, v127, 16, v126
    s_waitcnt lgkmcnt(15)
    v_bitop3_b32 v115, v115, v116, v117 bitop3:0xfe
    v_lshl_add_u64 v[124:125], v[124:125], 0, s[36:37]
    v_cmpx_le_u32 vcc, 0x1000000, v48
    ds_add_rtn_u64 v[116:117], v123, v[124:125] offset:54272
    s_mov_b64 exec, -1
    v_ashrrev_i32 v122, 5, v49
    v_lshlrev_b16 v123, 2, v49
    v_lshlrev_b32 v124, 16, v2
    v_bitop3_b32 v122, v122, v113, v113 bitop3:0x0c
    v_and_b32 v125, 0xffff0000, v2
    v_lshlrev_b32 v126, 16, v3
    v_mul_f32 v122, v114, v122
    v_and_b32 v127, 0xffff0000, v3
    v_add_u32 v123, v123, v123
    v_pk_fma_f32 v[124:125], v[124:125], v[122:123], s[34:35] op_sel_hi:[1,0,1]
    v_pk_fma_f32 v[126:127], v[126:127], v[122:123], s[34:35] op_sel_hi:[1,0,1]
    v_lshl_add_u32 v124, v125, 16, v124
    v_lshl_add_u32 v125, v127, 16, v126
    s_waitcnt lgkmcnt(15)
    v_bitop3_b32 v115, v115, v118, v119 bitop3:0xfe
    v_lshl_add_u64 v[124:125], v[124:125], 0, s[36:37]
    v_cmpx_le_u32 vcc, 0x1000000, v49
    ds_add_rtn_u64 v[118:119], v123, v[124:125] offset:54272
    s_mov_b64 exec, -1
    v_ashrrev_i32 v122, 5, v50
    v_lshlrev_b16 v123, 2, v50
    v_lshlrev_b32 v124, 16, v4
    v_bitop3_b32 v122, v122, v113, v113 bitop3:0x0c
    v_and_b32 v125, 0xffff0000, v4
    v_lshlrev_b32 v126, 16, v5
    v_mul_f32 v122, v114, v122
    v_and_b32 v127, 0xffff0000, v5
    v_add_u32 v123, v123, v123
    v_pk_fma_f32 v[124:125], v[124:125], v[122:123], s[34:35] op_sel_hi:[1,0,1]
    v_pk_fma_f32 v[126:127], v[126:127], v[122:123], s[34:35] op_sel_hi:[1,0,1]
    v_lshl_add_u32 v124, v125, 16, v124
    v_lshl_add_u32 v125, v127, 16, v126
    s_waitcnt lgkmcnt(15)
    v_bitop3_b32 v115, v115, v120, v121 bitop3:0xfe
    v_lshl_add_u64 v[124:125], v[124:125], 0, s[36:37]
    v_cmpx_le_u32 vcc, 0x1000000, v50
    ds_add_rtn_u64 v[120:121], v123, v[124:125] offset:54272
    s_mov_b64 exec, -1
    v_lshrrev_b32 v0, 3, v102
    v_lshrrev_b32 v1, 18, v102
    v_and_b32 v102, 0x3fff, v102
    v_and_or_b32 v0, v0, s65, v1
    v_mad_u32_u24 v102, v0, s63, v102
    buffer_load_dwordx4 v[0:3], v102, s[68:71], 0 offen
    s_waitcnt lgkmcnt(15)
    v_ashrrev_i32 v122, 5, v51
    v_lshlrev_b16 v123, 2, v51
    v_lshlrev_b32 v124, 16, v6
    v_bitop3_b32 v122, v122, v113, v113 bitop3:0x0c
    v_and_b32 v125, 0xffff0000, v6
    v_lshlrev_b32 v126, 16, v7
    v_mul_f32 v122, v114, v122
    v_and_b32 v127, 0xffff0000, v7
    v_add_u32 v123, v123, v123
    v_pk_fma_f32 v[124:125], v[124:125], v[122:123], s[34:35] op_sel_hi:[1,0,1]
    v_pk_fma_f32 v[126:127], v[126:127], v[122:123], s[34:35] op_sel_hi:[1,0,1]
    v_lshl_add_u32 v124, v125, 16, v124
    v_lshl_add_u32 v125, v127, 16, v126
    s_waitcnt lgkmcnt(2)
    v_bitop3_b32 v115, v115, v116, v117 bitop3:0xfe
    v_lshl_add_u64 v[124:125], v[124:125], 0, s[36:37]
    v_cmpx_le_u32 vcc, 0x1000000, v51
    ds_add_rtn_u64 v[116:117], v123, v[124:125] offset:54272
    s_mov_b64 exec, -1
    v_ashrrev_i32 v122, 5, v52
    v_lshlrev_b16 v123, 2, v52
    v_lshlrev_b32 v124, 16, v8
    v_bitop3_b32 v122, v122, v113, v113 bitop3:0x0c
    v_and_b32 v125, 0xffff0000, v8
    v_lshlrev_b32 v126, 16, v9
    v_mul_f32 v122, v114, v122
    v_and_b32 v127, 0xffff0000, v9
    v_add_u32 v123, v123, v123
    v_pk_fma_f32 v[124:125], v[124:125], v[122:123], s[34:35] op_sel_hi:[1,0,1]
    v_pk_fma_f32 v[126:127], v[126:127], v[122:123], s[34:35] op_sel_hi:[1,0,1]
    v_lshl_add_u32 v124, v125, 16, v124
    v_lshl_add_u32 v125, v127, 16, v126
    s_waitcnt lgkmcnt(2)
    v_bitop3_b32 v115, v115, v118, v119 bitop3:0xfe
    v_lshl_add_u64 v[124:125], v[124:125], 0, s[36:37]
    v_cmpx_le_u32 vcc, 0x1000000, v52
    ds_add_rtn_u64 v[118:119], v123, v[124:125] offset:54272
    s_mov_b64 exec, -1
    v_ashrrev_i32 v122, 5, v53
    v_lshlrev_b16 v123, 2, v53
    v_lshlrev_b32 v124, 16, v10
    v_bitop3_b32 v122, v122, v113, v113 bitop3:0x0c
    v_and_b32 v125, 0xffff0000, v10
    v_lshlrev_b32 v126, 16, v11
    v_mul_f32 v122, v114, v122
    v_and_b32 v127, 0xffff0000, v11
    v_add_u32 v123, v123, v123
    v_pk_fma_f32 v[124:125], v[124:125], v[122:123], s[34:35] op_sel_hi:[1,0,1]
    v_pk_fma_f32 v[126:127], v[126:127], v[122:123], s[34:35] op_sel_hi:[1,0,1]
    v_lshl_add_u32 v124, v125, 16, v124
    v_lshl_add_u32 v125, v127, 16, v126
    s_waitcnt lgkmcnt(2)
    v_bitop3_b32 v115, v115, v120, v121 bitop3:0xfe
    v_lshl_add_u64 v[124:125], v[124:125], 0, s[36:37]
    v_cmpx_le_u32 vcc, 0x1000000, v53
    ds_add_rtn_u64 v[120:121], v123, v[124:125] offset:54272
    s_mov_b64 exec, -1
    v_lshrrev_b32 v6, 3, v103
    v_lshrrev_b32 v7, 18, v103
    v_and_b32 v103, 0x3fff, v103
    v_and_or_b32 v6, v6, s65, v7
    v_mad_u32_u24 v103, v6, s63, v103
    buffer_load_dwordx4 v[6:9], v103, s[68:71], 0 offen
    s_waitcnt lgkmcnt(6)
    s_barrier
    s_waitcnt lgkmcnt(15)
    v_ashrrev_i32 v122, 5, v54
    v_lshlrev_b16 v123, 2, v54
    v_lshlrev_b32 v124, 16, v12
    v_bitop3_b32 v122, v122, v113, v113 bitop3:0x0c
    v_and_b32 v125, 0xffff0000, v12
    v_lshlrev_b32 v126, 16, v13
    v_mul_f32 v122, v114, v122
    v_and_b32 v127, 0xffff0000, v13
    v_add_u32 v123, v123, v123
    v_pk_fma_f32 v[124:125], v[124:125], v[122:123], s[34:35] op_sel_hi:[1,0,1]
    v_pk_fma_f32 v[126:127], v[126:127], v[122:123], s[34:35] op_sel_hi:[1,0,1]
    v_lshl_add_u32 v124, v125, 16, v124
    v_lshl_add_u32 v125, v127, 16, v126
    s_waitcnt lgkmcnt(2)
    v_bitop3_b32 v115, v115, v116, v117 bitop3:0xfe
    v_lshl_add_u64 v[124:125], v[124:125], 0, s[36:37]
    v_cmpx_le_u32 vcc, 0x1000000, v54
    ds_add_rtn_u64 v[116:117], v123, v[124:125] offset:54272
    s_mov_b64 exec, -1
    v_ashrrev_i32 v122, 5, v55
    v_lshlrev_b16 v123, 2, v55
    v_lshlrev_b32 v124, 16, v14
    v_bitop3_b32 v122, v122, v113, v113 bitop3:0x0c
    v_and_b32 v125, 0xffff0000, v14
    v_lshlrev_b32 v126, 16, v15
    v_mul_f32 v122, v114, v122
    v_and_b32 v127, 0xffff0000, v15
    v_add_u32 v123, v123, v123
    v_pk_fma_f32 v[124:125], v[124:125], v[122:123], s[34:35] op_sel_hi:[1,0,1]
    v_pk_fma_f32 v[126:127], v[126:127], v[122:123], s[34:35] op_sel_hi:[1,0,1]
    v_lshl_add_u32 v124, v125, 16, v124
    v_lshl_add_u32 v125, v127, 16, v126
    s_waitcnt lgkmcnt(2)
    v_bitop3_b32 v115, v115, v118, v119 bitop3:0xfe
    v_lshl_add_u64 v[124:125], v[124:125], 0, s[36:37]
    v_cmpx_le_u32 vcc, 0x1000000, v55
    ds_add_rtn_u64 v[118:119], v123, v[124:125] offset:54272
    s_mov_b64 exec, -1
    v_ashrrev_i32 v122, 5, v56
    v_lshlrev_b16 v123, 2, v56
    v_lshlrev_b32 v124, 16, v16
    v_bitop3_b32 v122, v122, v113, v113 bitop3:0x0c
    v_and_b32 v125, 0xffff0000, v16
    v_lshlrev_b32 v126, 16, v17
    v_mul_f32 v122, v114, v122
    v_and_b32 v127, 0xffff0000, v17
    v_add_u32 v123, v123, v123
    v_pk_fma_f32 v[124:125], v[124:125], v[122:123], s[34:35] op_sel_hi:[1,0,1]
    v_pk_fma_f32 v[126:127], v[126:127], v[122:123], s[34:35] op_sel_hi:[1,0,1]
    v_lshl_add_u32 v124, v125, 16, v124
    v_lshl_add_u32 v125, v127, 16, v126
    s_waitcnt lgkmcnt(2)
    v_bitop3_b32 v115, v115, v120, v121 bitop3:0xfe
    v_lshl_add_u64 v[124:125], v[124:125], 0, s[36:37]
    v_cmpx_le_u32 vcc, 0x1000000, v56
    ds_add_rtn_u64 v[120:121], v123, v[124:125] offset:54272
    s_mov_b64 exec, -1
    v_lshrrev_b32 v12, 3, v104
    v_lshrrev_b32 v13, 18, v104
    v_and_b32 v104, 0x3fff, v104
    v_and_or_b32 v12, v12, s65, v13
    v_mad_u32_u24 v104, v12, s63, v104
    buffer_load_dwordx4 v[12:15], v104, s[68:71], 0 offen
    s_waitcnt lgkmcnt(15)
    v_ashrrev_i32 v122, 5, v57
    v_lshlrev_b16 v123, 2, v57
    v_lshlrev_b32 v124, 16, v18
    v_bitop3_b32 v122, v122, v113, v113 bitop3:0x0c
    v_and_b32 v125, 0xffff0000, v18
    v_lshlrev_b32 v126, 16, v19
    v_mul_f32 v122, v114, v122
    v_and_b32 v127, 0xffff0000, v19
    v_add_u32 v123, v123, v123
    v_pk_fma_f32 v[124:125], v[124:125], v[122:123], s[34:35] op_sel_hi:[1,0,1]
    v_pk_fma_f32 v[126:127], v[126:127], v[122:123], s[34:35] op_sel_hi:[1,0,1]
    v_lshl_add_u32 v124, v125, 16, v124
    v_lshl_add_u32 v125, v127, 16, v126
    s_waitcnt lgkmcnt(2)
    v_bitop3_b32 v115, v115, v116, v117 bitop3:0xfe
    v_lshl_add_u64 v[124:125], v[124:125], 0, s[36:37]
    v_cmpx_le_u32 vcc, 0x1000000, v57
    ds_add_rtn_u64 v[116:117], v123, v[124:125] offset:54272
    s_mov_b64 exec, -1
    v_ashrrev_i32 v122, 5, v58
    v_lshlrev_b16 v123, 2, v58
    v_lshlrev_b32 v124, 16, v20
    v_bitop3_b32 v122, v122, v113, v113 bitop3:0x0c
    v_and_b32 v125, 0xffff0000, v20
    v_lshlrev_b32 v126, 16, v21
    v_mul_f32 v122, v114, v122
    v_and_b32 v127, 0xffff0000, v21
    v_add_u32 v123, v123, v123
    v_pk_fma_f32 v[124:125], v[124:125], v[122:123], s[34:35] op_sel_hi:[1,0,1]
    v_pk_fma_f32 v[126:127], v[126:127], v[122:123], s[34:35] op_sel_hi:[1,0,1]
    v_lshl_add_u32 v124, v125, 16, v124
    v_lshl_add_u32 v125, v127, 16, v126
    s_waitcnt lgkmcnt(2)
    v_bitop3_b32 v115, v115, v118, v119 bitop3:0xfe
    v_lshl_add_u64 v[124:125], v[124:125], 0, s[36:37]
    v_cmpx_le_u32 vcc, 0x1000000, v58
    ds_add_rtn_u64 v[118:119], v123, v[124:125] offset:54272
    s_mov_b64 exec, -1
    v_ashrrev_i32 v122, 5, v59
    v_lshlrev_b16 v123, 2, v59
    v_lshlrev_b32 v124, 16, v22
    v_bitop3_b32 v122, v122, v113, v113 bitop3:0x0c
    v_and_b32 v125, 0xffff0000, v22
    v_lshlrev_b32 v126, 16, v23
    v_mul_f32 v122, v114, v122
    v_and_b32 v127, 0xffff0000, v23
    v_add_u32 v123, v123, v123
    v_pk_fma_f32 v[124:125], v[124:125], v[122:123], s[34:35] op_sel_hi:[1,0,1]
    v_pk_fma_f32 v[126:127], v[126:127], v[122:123], s[34:35] op_sel_hi:[1,0,1]
    v_lshl_add_u32 v124, v125, 16, v124
    v_lshl_add_u32 v125, v127, 16, v126
    s_waitcnt lgkmcnt(2)
    v_bitop3_b32 v115, v115, v120, v121 bitop3:0xfe
    v_lshl_add_u64 v[124:125], v[124:125], 0, s[36:37]
    v_cmpx_le_u32 vcc, 0x1000000, v59
    ds_add_rtn_u64 v[120:121], v123, v[124:125] offset:54272
    s_mov_b64 exec, -1
    v_lshrrev_b32 v18, 3, v105
    v_lshrrev_b32 v19, 18, v105
    v_and_b32 v105, 0x3fff, v105
    v_and_or_b32 v18, v18, s65, v19
    v_mad_u32_u24 v105, v18, s63, v105
    buffer_load_dwordx4 v[18:21], v105, s[68:71], 0 offen
    s_mov_b32 m0, s23
    v_mov_b32 v53, 0x3c000
    s_movk_i32 s44, 512
    v_sub_u32_sdwa v4, v111, v110 dst_sel:DWORD dst_unused:UNUSED_PAD src0_sel:WORD_0 src1_sel:WORD_0
    v_sub_u32_sdwa v5, v111, v110 dst_sel:DWORD dst_unused:UNUSED_PAD src0_sel:WORD_1 src1_sel:WORD_1
    v_med3_i32 v4, v4, 0, s44
    v_med3_i32 v5, v5, 0, s44
    v_add_u32 v48, v4, v5
    ds_write_addtid_b32 v53 offset:0
    ds_write_addtid_b32 v53 offset:256
    ds_write_addtid_b32 v53 offset:512
    ds_write_addtid_b32 v53 offset:768
    ds_write_addtid_b32 v53 offset:1024
    ds_write_addtid_b32 v53 offset:1280
    ds_write_addtid_b32 v53 offset:1536
    ds_write_addtid_b32 v53 offset:1792
    v_lshl_add_u32 v53, v112, 15, s41
    s_nop 1
    v_add_u32_dpp v48, v48, v48 row_shr:1 row_mask:0xf bank_mask:0xf bound_ctrl:0
    s_nop 1
    v_add_u32_dpp v48, v48, v48 row_shr:2 row_mask:0xf bank_mask:0xf bound_ctrl:0
    s_nop 1
    v_add_u32_dpp v48, v48, v48 row_shr:4 row_mask:0xf bank_mask:0xf bound_ctrl:0
    s_nop 1
    v_add_u32_dpp v48, v48, v48 row_shr:8 row_mask:0xf bank_mask:0xf bound_ctrl:0
    s_nop 1
    v_add_u32_dpp v48, v48, v48 row_bcast:15 row_mask:0xa bank_mask:0xf
    s_nop 1
    v_add_u32_dpp v48, v48, v48 row_bcast:31 row_mask:0xc bank_mask:0xf
    s_nop 1
    s_nop 0
    v_readlane_b32 s38, v48, 63
    v_sub_u32 v50, v48, v5
    v_sub_u32 v49, v50, v4
    v_sub_u32 v10, 512, v49
    v_mad_u32_u16 v51, v110, 16, v53
    v_med3_i32 v10, v10, 0, v4
    v_lshl_add_u32 v49, v49, 2, s23
    v_sub_u32 v11, 512, v50
    v_mad_u32_u16 v52, v110, 16, v53 op_sel:[1,0,0,0]
    v_med3_i32 v11, v11, 0, v5
    v_lshl_add_u32 v50, v50, 2, s23
    v_lshl_add_u32 v48, v11, 16, v10
    v_add_u32 v52, 262144, v52
    v_add_u32 v110, v110, v48
    s_min_u32 s17, s38, 512
    s_add_u32 s17, s17, 63
    s_lshr_b32 s17, s17, 6
p2_x0x_0:
    v_cmpx_lt_i32 vcc, 0, v10
    s_cbranch_execz p2_y0x_0
    ds_write_b32 v49, v51 offset:0
    v_add_u32 v51, 16, v51
    v_cmpx_lt_i32 vcc, 1, v10
    s_cbranch_execz p2_y0x_0
    ds_write_b32 v49, v51 offset:4
    v_add_u32 v51, 16, v51
    v_cmpx_lt_i32 vcc, 2, v10
    s_cbranch_execz p2_y0x_0
    ds_write_b32 v49, v51 offset:8
    v_add_u32 v51, 16, v51
    v_cmpx_lt_i32 vcc, 3, v10
    s_cbranch_execz p2_y0x_0
    ds_write_b32 v49, v51 offset:12
    v_add_u32 v51, 16, v51
    v_cmpx_lt_i32 vcc, 4, v10
    s_cbranch_execz p2_y0x_0
    ds_write_b32 v49, v51 offset:16
    v_add_u32 v51, 16, v51
    v_cmpx_lt_i32 vcc, 5, v10
    s_cbranch_execz p2_y0x_0
    ds_write_b32 v49, v51 offset:20
    v_add_u32 v51, 16, v51
    v_cmpx_lt_i32 vcc, 6, v10
    s_cbranch_execz p2_y0x_0
    ds_write_b32 v49, v51 offset:24
    v_add_u32 v51, 16, v51
    v_cmpx_lt_i32 vcc, 7, v10
    s_cbranch_execz p2_y0x_0
    ds_write_b32 v49, v51 offset:28
    v_add_u32 v51, 16, v51
    v_subrev_u32 v10, 8, v10
    v_add_u32 v49, 32, v49
    s_branch p2_x0x_0
p2_y0x_0:
    s_mov_b64 exec, -1
p2_x0x_1:
    v_cmpx_lt_i32 vcc, 0, v11
    s_cbranch_execz p2_y0x_1
    ds_write_b32 v50, v52 offset:0
    v_add_u32 v52, 16, v52
    v_cmpx_lt_i32 vcc, 1, v11
    s_cbranch_execz p2_y0x_1
    ds_write_b32 v50, v52 offset:4
    v_add_u32 v52, 16, v52
    v_cmpx_lt_i32 vcc, 2, v11
    s_cbranch_execz p2_y0x_1
    ds_write_b32 v50, v52 offset:8
    v_add_u32 v52, 16, v52
    v_cmpx_lt_i32 vcc, 3, v11
    s_cbranch_execz p2_y0x_1
    ds_write_b32 v50, v52 offset:12
    v_add_u32 v52, 16, v52
    v_cmpx_lt_i32 vcc, 4, v11
    s_cbranch_execz p2_y0x_1
    ds_write_b32 v50, v52 offset:16
    v_add_u32 v52, 16, v52
    v_cmpx_lt_i32 vcc, 5, v11
    s_cbranch_execz p2_y0x_1
    ds_write_b32 v50, v52 offset:20
    v_add_u32 v52, 16, v52
    v_cmpx_lt_i32 vcc, 6, v11
    s_cbranch_execz p2_y0x_1
    ds_write_b32 v50, v52 offset:24
    v_add_u32 v52, 16, v52
    v_cmpx_lt_i32 vcc, 7, v11
    s_cbranch_execz p2_y0x_1
    ds_write_b32 v50, v52 offset:28
    v_add_u32 v52, 16, v52
    v_subrev_u32 v11, 8, v11
    v_add_u32 v50, 32, v50
    s_branch p2_x0x_1
p2_y0x_1:
    s_mov_b64 exec, -1
    s_cmp_lt_u32 s38, 512
    s_cbranch_scc1 p2_nomore0x
    v_cmp_lt_u32_sdwa s[44:45], v110, v111 src0_sel:WORD_0 src1_sel:WORD_0
    v_cmp_lt_u32_sdwa s[46:47], v110, v111 src0_sel:WORD_1 src1_sel:WORD_1
    s_nop 0
    s_or_b64 s[44:45], s[44:45], s[46:47]
    s_cbranch_scc0 p2_nomore0x
    v_mov_b32 v49, s19
    v_mov_b32 v50, 1
    ds_write_b32 v49, v50 offset:53760
p2_nomore0x:
    s_mov_b32 m0, s23
    s_nop 0
    ds_read_addtid_b32 v102 offset:0
    ds_read_addtid_b32 v103 offset:256
    ds_read_addtid_b32 v104 offset:512
    ds_read_addtid_b32 v105 offset:768
    ds_read_addtid_b32 v106 offset:1024
    ds_read_addtid_b32 v107 offset:1280
    ds_read_addtid_b32 v108 offset:1536
    ds_read_addtid_b32 v109 offset:1792
    s_waitcnt vmcnt(4)
    s_mov_b32 m0, s24
    s_cmp_ge_u32 s10, 9
    s_cbranch_scc1 p2_st0s0
    ds_write_addtid_b32 v84 offset:49152
    ds_write_addtid_b32 v85 offset:49408
p2_st0s0:
    s_mov_b32 m0, s23
    s_add_u32 s20, s20, 53760
    ds_write_addtid_b32 v72 offset:0
    ds_write_addtid_b32 v73 offset:256
    ds_write_addtid_b32 v74 offset:512
    ds_write_addtid_b32 v75 offset:768
    ds_write_addtid_b32 v76 offset:1024
    ds_write_addtid_b32 v77 offset:1280
    ds_write_addtid_b32 v78 offset:1536
    ds_write_addtid_b32 v79 offset:1792
    ds_write_addtid_b32 v80 offset:2048
    ds_write_addtid_b32 v81 offset:2304
    ds_write_addtid_b32 v82 offset:2560
    ds_write_addtid_b32 v83 offset:2816
    s_waitcnt lgkmcnt(15)
    v_ashrrev_i32 v122, 5, v60
    v_lshlrev_b16 v123, 2, v60
    v_lshlrev_b32 v124, 16, v24
    v_bitop3_b32 v122, v122, v113, v113 bitop3:0x0c
    v_and_b32 v125, 0xffff0000, v24
    v_lshlrev_b32 v126, 16, v25
    v_mul_f32 v122, v114, v122
    v_and_b32 v127, 0xffff0000, v25
    v_add_u32 v123, v123, v123
    v_pk_fma_f32 v[124:125], v[124:125], v[122:123], s[34:35] op_sel_hi:[1,0,1]
    v_pk_fma_f32 v[126:127], v[126:127], v[122:123], s[34:35] op_sel_hi:[1,0,1]
    v_lshl_add_u32 v124, v125, 16, v124
    v_lshl_add_u32 v125, v127, 16, v126
    s_waitcnt lgkmcnt(15)
    v_bitop3_b32 v115, v115, v116, v117 bitop3:0xfe
    v_lshl_add_u64 v[124:125], v[124:125], 0, s[36:37]
    v_cmpx_le_u32 vcc, 0x1000000, v60
    ds_add_rtn_u64 v[116:117], v123, v[124:125] offset:54272
    s_mov_b64 exec, -1
    v_ashrrev_i32 v122, 5, v61
    v_lshlrev_b16 v123, 2, v61
    v_lshlrev_b32 v124, 16, v26
    v_bitop3_b32 v122, v122, v113, v113 bitop3:0x0c
    v_and_b32 v125, 0xffff0000, v26
    v_lshlrev_b32 v126, 16, v27
    v_mul_f32 v122, v114, v122
    v_and_b32 v127, 0xffff0000, v27
    v_add_u32 v123, v123, v123
    v_pk_fma_f32 v[124:125], v[124:125], v[122:123], s[34:35] op_sel_hi:[1,0,1]
    v_pk_fma_f32 v[126:127], v[126:127], v[122:123], s[34:35] op_sel_hi:[1,0,1]
    v_lshl_add_u32 v124, v125, 16, v124
    v_lshl_add_u32 v125, v127, 16, v126
    s_waitcnt lgkmcnt(15)
    v_bitop3_b32 v115, v115, v118, v119 bitop3:0xfe
    v_lshl_add_u64 v[124:125], v[124:125], 0, s[36:37]
    v_cmpx_le_u32 vcc, 0x1000000, v61
    ds_add_rtn_u64 v[118:119], v123, v[124:125] offset:54272
    s_mov_b64 exec, -1
    v_ashrrev_i32 v122, 5, v62
    v_lshlrev_b16 v123, 2, v62
    v_lshlrev_b32 v124, 16, v28
    v_bitop3_b32 v122, v122, v113, v113 bitop3:0x0c
    v_and_b32 v125, 0xffff0000, v28
    v_lshlrev_b32 v126, 16, v29
    v_mul_f32 v122, v114, v122
    v_and_b32 v127, 0xffff0000, v29
    v_add_u32 v123, v123, v123
    v_pk_fma_f32 v[124:125], v[124:125], v[122:123], s[34:35] op_sel_hi:[1,0,1]
    v_pk_fma_f32 v[126:127], v[126:127], v[122:123], s[34:35] op_sel_hi:[1,0,1]
    v_lshl_add_u32 v124, v125, 16, v124
    v_lshl_add_u32 v125, v127, 16, v126
    s_waitcnt lgkmcnt(15)
    v_bitop3_b32 v115, v115, v120, v121 bitop3:0xfe
    v_lshl_add_u64 v[124:125], v[124:125], 0, s[36:37]
    v_cmpx_le_u32 vcc, 0x1000000, v62
    ds_add_rtn_u64 v[120:121], v123, v[124:125] offset:54272
    s_mov_b64 exec, -1
    s_waitcnt vmcnt(13)
    v_perm_b32 v60, v89, v86, s31
    v_perm_b32 v61, v89, v87, s32
    v_perm_b32 v62, v89, v88, s33
    v_lshlrev_b16 v28, 3, v88
    v_lshlrev_b16 v26, 3, v87
    v_lshlrev_b16 v24, 3, v86
    s_waitcnt lgkmcnt(3)
    s_barrier
    s_cmp_ge_u32 s10, 9
    s_cbranch_scc1 p2_nm0m1a
    v_lshrrev_b32 v84, 1, v112
    s_add_u32 s44, s20, s42
    buffer_load_dwordx2 v[84:85], v84, s[4:7], s44 offen
p2_nm0m1a:
    buffer_load_dwordx4 v[72:75], v112, s[4:7], s20 offen offset:0
    buffer_load_dwordx4 v[76:79], v112, s[4:7], s20 offen offset:1024
    buffer_load_dwordx4 v[80:83], v112, s[4:7], s20 offen offset:2048
    v_cmpx_ge_u16 vcc, 0x3fff, v60
    ds_read_b64 v[24:25], v24
    s_mov_b64 exec, -1
    v_cmpx_ge_u16 vcc, 0x3fff, v61
    ds_read_b64 v[26:27], v26
    s_mov_b64 exec, -1
    v_cmpx_ge_u16 vcc, 0x3fff, v62
    ds_read_b64 v[28:29], v28
    s_mov_b64 exec, -1
    s_waitcnt lgkmcnt(15)
    v_ashrrev_i32 v122, 5, v63
    v_lshlrev_b16 v123, 2, v63
    v_lshlrev_b32 v124, 16, v30
    v_bitop3_b32 v122, v122, v113, v113 bitop3:0x0c
    v_and_b32 v125, 0xffff0000, v30
    v_lshlrev_b32 v126, 16, v31
    v_mul_f32 v122, v114, v122
    v_and_b32 v127, 0xffff0000, v31
    v_add_u32 v123, v123, v123
    v_pk_fma_f32 v[124:125], v[124:125], v[122:123], s[34:35] op_sel_hi:[1,0,1]
    v_pk_fma_f32 v[126:127], v[126:127], v[122:123], s[34:35] op_sel_hi:[1,0,1]
    v_lshl_add_u32 v124, v125, 16, v124
    v_lshl_add_u32 v125, v127, 16, v126
    s_waitcnt lgkmcnt(5)
    v_bitop3_b32 v115, v115, v116, v117 bitop3:0xfe
    v_lshl_add_u64 v[124:125], v[124:125], 0, s[36:37]
    v_cmpx_le_u32 vcc, 0x1000000, v63
    ds_add_rtn_u64 v[116:117], v123, v[124:125] offset:54272
    s_mov_b64 exec, -1
    v_ashrrev_i32 v122, 5, v64
    v_lshlrev_b16 v123, 2, v64
    v_lshlrev_b32 v124, 16, v32
    v_bitop3_b32 v122, v122, v113, v113 bitop3:0x0c
    v_and_b32 v125, 0xffff0000, v32
    v_lshlrev_b32 v126, 16, v33
    v_mul_f32 v122, v114, v122
    v_and_b32 v127, 0xffff0000, v33
    v_add_u32 v123, v123, v123
    v_pk_fma_f32 v[124:125], v[124:125], v[122:123], s[34:35] op_sel_hi:[1,0,1]
    v_pk_fma_f32 v[126:127], v[126:127], v[122:123], s[34:35] op_sel_hi:[1,0,1]
    v_lshl_add_u32 v124, v125, 16, v124
    v_lshl_add_u32 v125, v127, 16, v126
    s_waitcnt lgkmcnt(5)
    v_bitop3_b32 v115, v115, v118, v119 bitop3:0xfe
    v_lshl_add_u64 v[124:125], v[124:125], 0, s[36:37]
    v_cmpx_le_u32 vcc, 0x1000000, v64
    ds_add_rtn_u64 v[118:119], v123, v[124:125] offset:54272
    s_mov_b64 exec, -1
    v_ashrrev_i32 v122, 5, v65
    v_lshlrev_b16 v123, 2, v65
    v_lshlrev_b32 v124, 16, v34
    v_bitop3_b32 v122, v122, v113, v113 bitop3:0x0c
    v_and_b32 v125, 0xffff0000, v34
    v_lshlrev_b32 v126, 16, v35
    v_mul_f32 v122, v114, v122
    v_and_b32 v127, 0xffff0000, v35
    v_add_u32 v123, v123, v123
    v_pk_fma_f32 v[124:125], v[124:125], v[122:123], s[34:35] op_sel_hi:[1,0,1]
    v_pk_fma_f32 v[126:127], v[126:127], v[122:123], s[34:35] op_sel_hi:[1,0,1]
    v_lshl_add_u32 v124, v125, 16, v124
    v_lshl_add_u32 v125, v127, 16, v126
    s_waitcnt lgkmcnt(5)
    v_bitop3_b32 v115, v115, v120, v121 bitop3:0xfe
    v_lshl_add_u64 v[124:125], v[124:125], 0, s[36:37]
    v_cmpx_le_u32 vcc, 0x1000000, v65
    ds_add_rtn_u64 v[120:121], v123, v[124:125] offset:54272
    s_mov_b64 exec, -1
    s_waitcnt vmcnt(15)
    v_perm_b32 v63, v93, v90, s31
    v_perm_b32 v64, v93, v91, s32
    v_perm_b32 v65, v93, v92, s33
    v_lshlrev_b16 v34, 3, v92
    v_lshlrev_b16 v32, 3, v91
    v_lshlrev_b16 v30, 3, v90
    v_cmpx_ge_u16 vcc, 0x3fff, v63
    ds_read_b64 v[30:31], v30
    s_mov_b64 exec, -1
    v_cmpx_ge_u16 vcc, 0x3fff, v64
    ds_read_b64 v[32:33], v32
    s_mov_b64 exec, -1
    v_cmpx_ge_u16 vcc, 0x3fff, v65
    ds_read_b64 v[34:35], v34
    s_mov_b64 exec, -1
    s_waitcnt lgkmcnt(15)
    v_lshrrev_b32 v86, 3, v106
    v_lshrrev_b32 v87, 18, v106
    v_and_b32 v106, 0x3fff, v106
    v_and_or_b32 v86, v86, s65, v87
    v_mad_u32_u24 v106, v86, s63, v106
    buffer_load_dwordx4 v[86:89], v106, s[68:71], 0 offen
    s_waitcnt lgkmcnt(15)
    v_ashrrev_i32 v122, 5, v66
    v_lshlrev_b16 v123, 2, v66
    v_lshlrev_b32 v124, 16, v36
    v_bitop3_b32 v122, v122, v113, v113 bitop3:0x0c
    v_and_b32 v125, 0xffff0000, v36
    v_lshlrev_b32 v126, 16, v37
    v_mul_f32 v122, v114, v122
    v_and_b32 v127, 0xffff0000, v37
    v_add_u32 v123, v123, v123
    v_pk_fma_f32 v[124:125], v[124:125], v[122:123], s[34:35] op_sel_hi:[1,0,1]
    v_pk_fma_f32 v[126:127], v[126:127], v[122:123], s[34:35] op_sel_hi:[1,0,1]
    v_lshl_add_u32 v124, v125, 16, v124
    v_lshl_add_u32 v125, v127, 16, v126
    s_waitcnt lgkmcnt(5)
    v_bitop3_b32 v115, v115, v116, v117 bitop3:0xfe
    v_lshl_add_u64 v[124:125], v[124:125], 0, s[36:37]
    v_cmpx_le_u32 vcc, 0x1000000, v66
    ds_add_rtn_u64 v[116:117], v123, v[124:125] offset:54272
    s_mov_b64 exec, -1
    v_ashrrev_i32 v122, 5, v67
    v_lshlrev_b16 v123, 2, v67
    v_lshlrev_b32 v124, 16, v38
    v_bitop3_b32 v122, v122, v113, v113 bitop3:0x0c
    v_and_b32 v125, 0xffff0000, v38
    v_lshlrev_b32 v126, 16, v39
    v_mul_f32 v122, v114, v122
    v_and_b32 v127, 0xffff0000, v39
    v_add_u32 v123, v123, v123
    v_pk_fma_f32 v[124:125], v[124:125], v[122:123], s[34:35] op_sel_hi:[1,0,1]
    v_pk_fma_f32 v[126:127], v[126:127], v[122:123], s[34:35] op_sel_hi:[1,0,1]
    v_lshl_add_u32 v124, v125, 16, v124
    v_lshl_add_u32 v125, v127, 16, v126
    s_waitcnt lgkmcnt(5)
    v_bitop3_b32 v115, v115, v118, v119 bitop3:0xfe
    v_lshl_add_u64 v[124:125], v[124:125], 0, s[36:37]
    v_cmpx_le_u32 vcc, 0x1000000, v67
    ds_add_rtn_u64 v[118:119], v123, v[124:125] offset:54272
    s_mov_b64 exec, -1
    v_ashrrev_i32 v122, 5, v68
    v_lshlrev_b16 v123, 2, v68
    v_lshlrev_b32 v124, 16, v40
    v_bitop3_b32 v122, v122, v113, v113 bitop3:0x0c
    v_and_b32 v125, 0xffff0000, v40
    v_lshlrev_b32 v126, 16, v41
    v_mul_f32 v122, v114, v122
    v_and_b32 v127, 0xffff0000, v41
    v_add_u32 v123, v123, v123
    v_pk_fma_f32 v[124:125], v[124:125], v[122:123], s[34:35] op_sel_hi:[1,0,1]
    v_pk_fma_f32 v[126:127], v[126:127], v[122:123], s[34:35] op_sel_hi:[1,0,1]
    v_lshl_add_u32 v124, v125, 16, v124
    v_lshl_add_u32 v125, v127, 16, v126
    s_waitcnt lgkmcnt(5)
    v_bitop3_b32 v115, v115, v120, v121 bitop3:0xfe
    v_lshl_add_u64 v[124:125], v[124:125], 0, s[36:37]
    v_cmpx_le_u32 vcc, 0x1000000, v68
    ds_add_rtn_u64 v[120:121], v123, v[124:125] offset:54272
    s_mov_b64 exec, -1
    s_waitcnt vmcnt(12)
    v_perm_b32 v66, v97, v94, s31
    v_perm_b32 v67, v97, v95, s32
    v_perm_b32 v68, v97, v96, s33
    v_lshlrev_b16 v40, 3, v96
    v_lshlrev_b16 v38, 3, v95
    v_lshlrev_b16 v36, 3, v94
    v_cmpx_ge_u16 vcc, 0x3fff, v66
    ds_read_b64 v[36:37], v36
    s_mov_b64 exec, -1
    v_cmpx_ge_u16 vcc, 0x3fff, v67
    ds_read_b64 v[38:39], v38
    s_mov_b64 exec, -1
    v_cmpx_ge_u16 vcc, 0x3fff, v68
    ds_read_b64 v[40:41], v40
    s_mov_b64 exec, -1
    s_cmp_le_u32 s15, 7
    s_cbranch_scc1 p2_na0a7
    s_waitcnt lgkmcnt(15)
    v_ashrrev_i32 v122, 5, v69
    v_lshlrev_b16 v123, 2, v69
    v_lshlrev_b32 v124, 16, v42
    v_bitop3_b32 v122, v122, v113, v113 bitop3:0x0c
    v_and_b32 v125, 0xffff0000, v42
    v_lshlrev_b32 v126, 16, v43
    v_mul_f32 v122, v114, v122
    v_and_b32 v127, 0xffff0000, v43
    v_add_u32 v123, v123, v123
    v_pk_fma_f32 v[124:125], v[124:125], v[122:123], s[34:35] op_sel_hi:[1,0,1]
    v_pk_fma_f32 v[126:127], v[126:127], v[122:123], s[34:35] op_sel_hi:[1,0,1]
    v_lshl_add_u32 v124, v125, 16, v124
    v_lshl_add_u32 v125, v127, 16, v126
    s_waitcnt lgkmcnt(5)
    v_bitop3_b32 v115, v115, v116, v117 bitop3:0xfe
    v_lshl_add_u64 v[124:125], v[124:125], 0, s[36:37]
    v_cmpx_le_u32 vcc, 0x1000000, v69
    ds_add_rtn_u64 v[116:117], v123, v[124:125] offset:54272
    s_mov_b64 exec, -1
    v_ashrrev_i32 v122, 5, v70
    v_lshlrev_b16 v123, 2, v70
    v_lshlrev_b32 v124, 16, v44
    v_bitop3_b32 v122, v122, v113, v113 bitop3:0x0c
    v_and_b32 v125, 0xffff0000, v44
    v_lshlrev_b32 v126, 16, v45
    v_mul_f32 v122, v114, v122
    v_and_b32 v127, 0xffff0000, v45
    v_add_u32 v123, v123, v123
    v_pk_fma_f32 v[124:125], v[124:125], v[122:123], s[34:35] op_sel_hi:[1,0,1]
    v_pk_fma_f32 v[126:127], v[126:127], v[122:123], s[34:35] op_sel_hi:[1,0,1]
    v_lshl_add_u32 v124, v125, 16, v124
    v_lshl_add_u32 v125, v127, 16, v126
    s_waitcnt lgkmcnt(5)
    v_bitop3_b32 v115, v115, v118, v119 bitop3:0xfe
    v_lshl_add_u64 v[124:125], v[124:125], 0, s[36:37]
    v_cmpx_le_u32 vcc, 0x1000000, v70
    ds_add_rtn_u64 v[118:119], v123, v[124:125] offset:54272
    s_mov_b64 exec, -1
    v_ashrrev_i32 v122, 5, v71
    v_lshlrev_b16 v123, 2, v71
    v_lshlrev_b32 v124, 16, v46
    v_bitop3_b32 v122, v122, v113, v113 bitop3:0x0c
    v_and_b32 v125, 0xffff0000, v46
    v_lshlrev_b32 v126, 16, v47
    v_mul_f32 v122, v114, v122
    v_and_b32 v127, 0xffff0000, v47
    v_add_u32 v123, v123, v123
    v_pk_fma_f32 v[124:125], v[124:125], v[122:123], s[34:35] op_sel_hi:[1,0,1]
    v_pk_fma_f32 v[126:127], v[126:127], v[122:123], s[34:35] op_sel_hi:[1,0,1]
    v_lshl_add_u32 v124, v125, 16, v124
    v_lshl_add_u32 v125, v127, 16, v126
    s_waitcnt lgkmcnt(5)
    v_bitop3_b32 v115, v115, v120, v121 bitop3:0xfe
    v_lshl_add_u64 v[124:125], v[124:125], 0, s[36:37]
    v_cmpx_le_u32 vcc, 0x1000000, v71
    ds_add_rtn_u64 v[120:121], v123, v[124:125] offset:54272
    s_mov_b64 exec, -1
p2_na0a7:
    s_waitcnt vmcnt(11)
    v_perm_b32 v69, v101, v98, s31
    v_perm_b32 v70, v101, v99, s32
    v_perm_b32 v71, v101, v100, s33
    v_lshlrev_b16 v46, 3, v100
    v_lshlrev_b16 v44, 3, v99
    v_lshlrev_b16 v42, 3, v98
    s_cmp_le_u32 s16, 7
    s_cbranch_scc1 p2_g0r07
    v_cmpx_ge_u16 vcc, 0x3fff, v69
    ds_read_b64 v[42:43], v42
    s_mov_b64 exec, -1
    v_cmpx_ge_u16 vcc, 0x3fff, v70
    ds_read_b64 v[44:45], v44
    s_mov_b64 exec, -1
    v_cmpx_ge_u16 vcc, 0x3fff, v71
    ds_read_b64 v[46:47], v46
    s_mov_b64 exec, -1
p2_g0r07:
    s_waitcnt lgkmcnt(15)
    v_lshrrev_b32 v90, 3, v107
    v_lshrrev_b32 v91, 18, v107
    v_and_b32 v107, 0x3fff, v107
    v_and_or_b32 v90, v90, s65, v91
    v_mad_u32_u24 v107, v90, s63, v107
    buffer_load_dwordx4 v[90:93], v107, s[68:71], 0 offen
    s_waitcnt vmcnt(8)
    v_perm_b32 v48, v3, v0, s31
    v_perm_b32 v49, v3, v1, s32
    v_perm_b32 v50, v3, v2, s33
    v_lshlrev_b16 v4, 3, v2
    v_lshlrev_b16 v2, 3, v1
    v_lshlrev_b16 v0, 3, v0
    v_cmpx_ge_u16 vcc, 0x3fff, v48
    ds_read_b64 v[0:1], v0
    s_mov_b64 exec, -1
    v_cmpx_ge_u16 vcc, 0x3fff, v49
    ds_read_b64 v[2:3], v2
    s_mov_b64 exec, -1
    v_cmpx_ge_u16 vcc, 0x3fff, v50
    ds_read_b64 v[4:5], v4
    s_mov_b64 exec, -1
    s_waitcnt vmcnt(7)
    v_perm_b32 v51, v9, v6, s31
    v_perm_b32 v52, v9, v7, s32
    v_perm_b32 v53, v9, v8, s33
    v_lshlrev_b16 v10, 3, v8
    v_lshlrev_b16 v8, 3, v7
    v_lshlrev_b16 v6, 3, v6
    v_cmpx_ge_u16 vcc, 0x3fff, v51
    ds_read_b64 v[6:7], v6
    s_mov_b64 exec, -1
    v_cmpx_ge_u16 vcc, 0x3fff, v52
    ds_read_b64 v[8:9], v8
    s_mov_b64 exec, -1
    v_cmpx_ge_u16 vcc, 0x3fff, v53
    ds_read_b64 v[10:11], v10
    s_mov_b64 exec, -1
    s_waitcnt vmcnt(6)
    v_perm_b32 v54, v15, v12, s31
    v_perm_b32 v55, v15, v13, s32
    v_perm_b32 v56, v15, v14, s33
    v_lshlrev_b16 v16, 3, v14
    v_lshlrev_b16 v14, 3, v13
    v_lshlrev_b16 v12, 3, v12
    v_cmpx_ge_u16 vcc, 0x3fff, v54
    ds_read_b64 v[12:13], v12
    s_mov_b64 exec, -1
    v_cmpx_ge_u16 vcc, 0x3fff, v55
    ds_read_b64 v[14:15], v14
    s_mov_b64 exec, -1
    v_cmpx_ge_u16 vcc, 0x3fff, v56
    ds_read_b64 v[16:17], v16
    s_mov_b64 exec, -1
    s_waitcnt vmcnt(5)
    v_perm_b32 v57, v21, v18, s31
    v_perm_b32 v58, v21, v19, s32
    v_perm_b32 v59, v21, v20, s33
    v_lshlrev_b16 v22, 3, v20
    v_lshlrev_b16 v20, 3, v19
    v_lshlrev_b16 v18, 3, v18
    v_cmpx_ge_u16 vcc, 0x3fff, v57
    ds_read_b64 v[18:19], v18
    s_mov_b64 exec, -1
    v_cmpx_ge_u16 vcc, 0x3fff, v58
    ds_read_b64 v[20:21], v20
    s_mov_b64 exec, -1
    v_cmpx_ge_u16 vcc, 0x3fff, v59
    ds_read_b64 v[22:23], v22
    s_mov_b64 exec, -1
    s_waitcnt lgkmcnt(0)
    s_barrier
    s_waitcnt lgkmcnt(15)
    s_branch p2_tail
p2_drain0:
    v_cmpx_gt_i16 vcc, 0, v48
    ds_read_b64 v[0:1], v0
    s_mov_b64 exec, -1
    v_cmpx_gt_i16 vcc, 0, v49
    ds_read_b64 v[2:3], v2
    s_mov_b64 exec, -1
    v_cmpx_gt_i16 vcc, 0, v50
    ds_read_b64 v[4:5], v4
    s_mov_b64 exec, -1
    v_cmpx_gt_i16 vcc, 0, v51
    ds_read_b64 v[6:7], v6
    s_mov_b64 exec, -1
    v_cmpx_gt_i16 vcc, 0, v52
    ds_read_b64 v[8:9], v8
    s_mov_b64 exec, -1
    v_cmpx_gt_i16 vcc, 0, v53
    ds_read_b64 v[10:11], v10
    s_mov_b64 exec, -1
    v_cmpx_gt_i16 vcc, 0, v54
    ds_read_b64 v[12:13], v12
    s_mov_b64 exec, -1
    v_cmpx_gt_i16 vcc, 0, v55
    ds_read_b64 v[14:15], v14
    s_mov_b64 exec, -1
    v_cmpx_gt_i16 vcc, 0, v56
    ds_read_b64 v[16:17], v16
    s_mov_b64 exec, -1
    v_cmpx_gt_i16 vcc, 0, v57
    ds_read_b64 v[18:19], v18
    s_mov_b64 exec, -1
    v_cmpx_gt_i16 vcc, 0, v58
    ds_read_b64 v[20:21], v20
    s_mov_b64 exec, -1
    v_cmpx_gt_i16 vcc, 0, v59
    ds_read_b64 v[22:23], v22
    s_mov_b64 exec, -1
    v_cmpx_gt_i16 vcc, 0, v60
    ds_read_b64 v[24:25], v24
    s_mov_b64 exec, -1
    v_cmpx_gt_i16 vcc, 0, v61
    ds_read_b64 v[26:27], v26
    s_mov_b64 exec, -1
    v_cmpx_gt_i16 vcc, 0, v62
    ds_read_b64 v[28:29], v28
    s_mov_b64 exec, -1
    v_cmpx_gt_i16 vcc, 0, v63
    ds_read_b64 v[30:31], v30
    s_mov_b64 exec, -1
    v_cmpx_gt_i16 vcc, 0, v64
    ds_read_b64 v[32:33], v32
    s_mov_b64 exec, -1
    v_cmpx_gt_i16 vcc, 0, v65
    ds_read_b64 v[34:35], v34
    s_mov_b64 exec, -1
    v_cmpx_gt_i16 vcc, 0, v66
    ds_read_b64 v[36:37], v36
    s_mov_b64 exec, -1
    v_cmpx_gt_i16 vcc, 0, v67
    ds_read_b64 v[38:39], v38
    s_mov_b64 exec, -1
    v_cmpx_gt_i16 vcc, 0, v68
    ds_read_b64 v[40:41], v40
    s_mov_b64 exec, -1
    s_cmp_le_u32 s15, 7
    s_cbranch_scc1 p2_gd0
    v_cmpx_gt_i16 vcc, 0, v69
    ds_read_b64 v[42:43], v42
    s_mov_b64 exec, -1
    v_cmpx_gt_i16 vcc, 0, v70
    ds_read_b64 v[44:45], v44
    s_mov_b64 exec, -1
    v_cmpx_gt_i16 vcc, 0, v71
    ds_read_b64 v[46:47], v46
    s_mov_b64 exec, -1
p2_gd0:
    s_waitcnt lgkmcnt(15)
    v_ashrrev_i32 v122, 5, v48
    v_lshlrev_b16 v123, 2, v48
    v_lshlrev_b32 v124, 16, v0
    v_bitop3_b32 v122, v122, v113, v113 bitop3:0x0c
    v_and_b32 v125, 0xffff0000, v0
    v_lshlrev_b32 v126, 16, v1
    v_mul_f32 v122, v114, v122
    v_and_b32 v127, 0xffff0000, v1
    v_add_u32 v123, v123, v123
    v_pk_fma_f32 v[124:125], v[124:125], v[122:123], s[34:35] op_sel_hi:[1,0,1]
    v_pk_fma_f32 v[126:127], v[126:127], v[122:123], s[34:35] op_sel_hi:[1,0,1]
    v_lshl_add_u32 v124, v125, 16, v124
    v_lshl_add_u32 v125, v127, 16, v126
    s_waitcnt lgkmcnt(15)
    v_bitop3_b32 v115, v115, v116, v117 bitop3:0xfe
    v_lshl_add_u64 v[124:125], v[124:125], 0, s[36:37]
    v_cmpx_le_u32 vcc, 0x1000000, v48
    ds_add_rtn_u64 v[116:117], v123, v[124:125] offset:54272
    s_mov_b64 exec, -1
    v_ashrrev_i32 v122, 5, v49
    v_lshlrev_b16 v123, 2, v49
    v_lshlrev_b32 v124, 16, v2
    v_bitop3_b32 v122, v122, v113, v113 bitop3:0x0c
    v_and_b32 v125, 0xffff0000, v2
    v_lshlrev_b32 v126, 16, v3
    v_mul_f32 v122, v114, v122
    v_and_b32 v127, 0xffff0000, v3
    v_add_u32 v123, v123, v123
    v_pk_fma_f32 v[124:125], v[124:125], v[122:123], s[34:35] op_sel_hi:[1,0,1]
    v_pk_fma_f32 v[126:127], v[126:127], v[122:123], s[34:35] op_sel_hi:[1,0,1]
    v_lshl_add_u32 v124, v125, 16, v124
    v_lshl_add_u32 v125, v127, 16, v126
    s_waitcnt lgkmcnt(15)
    v_bitop3_b32 v115, v115, v118, v119 bitop3:0xfe
    v_lshl_add_u64 v[124:125], v[124:125], 0, s[36:37]
    v_cmpx_le_u32 vcc, 0x1000000, v49
    ds_add_rtn_u64 v[118:119], v123, v[124:125] offset:54272
    s_mov_b64 exec, -1
    v_ashrrev_i32 v122, 5, v50
    v_lshlrev_b16 v123, 2, v50
    v_lshlrev_b32 v124, 16, v4
    v_bitop3_b32 v122, v122, v113, v113 bitop3:0x0c
    v_and_b32 v125, 0xffff0000, v4
    v_lshlrev_b32 v126, 16, v5
    v_mul_f32 v122, v114, v122
    v_and_b32 v127, 0xffff0000, v5
    v_add_u32 v123, v123, v123
    v_pk_fma_f32 v[124:125], v[124:125], v[122:123], s[34:35] op_sel_hi:[1,0,1]
    v_pk_fma_f32 v[126:127], v[126:127], v[122:123], s[34:35] op_sel_hi:[1,0,1]
    v_lshl_add_u32 v124, v125, 16, v124
    v_lshl_add_u32 v125, v127, 16, v126
    s_waitcnt lgkmcnt(15)
    v_bitop3_b32 v115, v115, v120, v121 bitop3:0xfe
    v_lshl_add_u64 v[124:125], v[124:125], 0, s[36:37]
    v_cmpx_le_u32 vcc, 0x1000000, v50
    ds_add_rtn_u64 v[120:121], v123, v[124:125] offset:54272
    s_mov_b64 exec, -1
    s_waitcnt lgkmcnt(15)
    v_ashrrev_i32 v122, 5, v51
    v_lshlrev_b16 v123, 2, v51
    v_lshlrev_b32 v124, 16, v6
    v_bitop3_b32 v122, v122, v113, v113 bitop3:0x0c
    v_and_b32 v125, 0xffff0000, v6
    v_lshlrev_b32 v126, 16, v7
    v_mul_f32 v122, v114, v122
    v_and_b32 v127, 0xffff0000, v7
    v_add_u32 v123, v123, v123
    v_pk_fma_f32 v[124:125], v[124:125], v[122:123], s[34:35] op_sel_hi:[1,0,1]
    v_pk_fma_f32 v[126:127], v[126:127], v[122:123], s[34:35] op_sel_hi:[1,0,1]
    v_lshl_add_u32 v124, v125, 16, v124
    v_lshl_add_u32 v125, v127, 16, v126
    s_waitcnt lgkmcnt(2)
    v_bitop3_b32 v115, v115, v116, v117 bitop3:0xfe
    v_lshl_add_u64 v[124:125], v[124:125], 0, s[36:37]
    v_cmpx_le_u32 vcc, 0x1000000, v51
    ds_add_rtn_u64 v[116:117], v123, v[124:125] offset:54272
    s_mov_b64 exec, -1
    v_ashrrev_i32 v122, 5, v52
    v_lshlrev_b16 v123, 2, v52
    v_lshlrev_b32 v124, 16, v8
    v_bitop3_b32 v122, v122, v113, v113 bitop3:0x0c
    v_and_b32 v125, 0xffff0000, v8
    v_lshlrev_b32 v126, 16, v9
    v_mul_f32 v122, v114, v122
    v_and_b32 v127, 0xffff0000, v9
    v_add_u32 v123, v123, v123
    v_pk_fma_f32 v[124:125], v[124:125], v[122:123], s[34:35] op_sel_hi:[1,0,1]
    v_pk_fma_f32 v[126:127], v[126:127], v[122:123], s[34:35] op_sel_hi:[1,0,1]
    v_lshl_add_u32 v124, v125, 16, v124
    v_lshl_add_u32 v125, v127, 16, v126
    s_waitcnt lgkmcnt(2)
    v_bitop3_b32 v115, v115, v118, v119 bitop3:0xfe
    v_lshl_add_u64 v[124:125], v[124:125], 0, s[36:37]
    v_cmpx_le_u32 vcc, 0x1000000, v52
    ds_add_rtn_u64 v[118:119], v123, v[124:125] offset:54272
    s_mov_b64 exec, -1
    v_ashrrev_i32 v122, 5, v53
    v_lshlrev_b16 v123, 2, v53
    v_lshlrev_b32 v124, 16, v10
    v_bitop3_b32 v122, v122, v113, v113 bitop3:0x0c
    v_and_b32 v125, 0xffff0000, v10
    v_lshlrev_b32 v126, 16, v11
    v_mul_f32 v122, v114, v122
    v_and_b32 v127, 0xffff0000, v11
    v_add_u32 v123, v123, v123
    v_pk_fma_f32 v[124:125], v[124:125], v[122:123], s[34:35] op_sel_hi:[1,0,1]
    v_pk_fma_f32 v[126:127], v[126:127], v[122:123], s[34:35] op_sel_hi:[1,0,1]
    v_lshl_add_u32 v124, v125, 16, v124
    v_lshl_add_u32 v125, v127, 16, v126
    s_waitcnt lgkmcnt(2)
    v_bitop3_b32 v115, v115, v120, v121 bitop3:0xfe
    v_lshl_add_u64 v[124:125], v[124:125], 0, s[36:37]
    v_cmpx_le_u32 vcc, 0x1000000, v53
    ds_add_rtn_u64 v[120:121], v123, v[124:125] offset:54272
    s_mov_b64 exec, -1
    s_waitcnt lgkmcnt(15)
    v_ashrrev_i32 v122, 5, v54
    v_lshlrev_b16 v123, 2, v54
    v_lshlrev_b32 v124, 16, v12
    v_bitop3_b32 v122, v122, v113, v113 bitop3:0x0c
    v_and_b32 v125, 0xffff0000, v12
    v_lshlrev_b32 v126, 16, v13
    v_mul_f32 v122, v114, v122
    v_and_b32 v127, 0xffff0000, v13
    v_add_u32 v123, v123, v123
    v_pk_fma_f32 v[124:125], v[124:125], v[122:123], s[34:35] op_sel_hi:[1,0,1]
    v_pk_fma_f32 v[126:127], v[126:127], v[122:123], s[34:35] op_sel_hi:[1,0,1]
    v_lshl_add_u32 v124, v125, 16, v124
    v_lshl_add_u32 v125, v127, 16, v126
    s_waitcnt lgkmcnt(2)
    v_bitop3_b32 v115, v115, v116, v117 bitop3:0xfe
    v_lshl_add_u64 v[124:125], v[124:125], 0, s[36:37]
    v_cmpx_le_u32 vcc, 0x1000000, v54
    ds_add_rtn_u64 v[116:117], v123, v[124:125] offset:54272
    s_mov_b64 exec, -1
    v_ashrrev_i32 v122, 5, v55
    v_lshlrev_b16 v123, 2, v55
    v_lshlrev_b32 v124, 16, v14
    v_bitop3_b32 v122, v122, v113, v113 bitop3:0x0c
    v_and_b32 v125, 0xffff0000, v14
    v_lshlrev_b32 v126, 16, v15
    v_mul_f32 v122, v114, v122
    v_and_b32 v127, 0xffff0000, v15
    v_add_u32 v123, v123, v123
    v_pk_fma_f32 v[124:125], v[124:125], v[122:123], s[34:35] op_sel_hi:[1,0,1]
    v_pk_fma_f32 v[126:127], v[126:127], v[122:123], s[34:35] op_sel_hi:[1,0,1]
    v_lshl_add_u32 v124, v125, 16, v124
    v_lshl_add_u32 v125, v127, 16, v126
    s_waitcnt lgkmcnt(2)
    v_bitop3_b32 v115, v115, v118, v119 bitop3:0xfe
    v_lshl_add_u64 v[124:125], v[124:125], 0, s[36:37]
    v_cmpx_le_u32 vcc, 0x1000000, v55
    ds_add_rtn_u64 v[118:119], v123, v[124:125] offset:54272
    s_mov_b64 exec, -1
    v_ashrrev_i32 v122, 5, v56
    v_lshlrev_b16 v123, 2, v56
    v_lshlrev_b32 v124, 16, v16
    v_bitop3_b32 v122, v122, v113, v113 bitop3:0x0c
    v_and_b32 v125, 0xffff0000, v16
    v_lshlrev_b32 v126, 16, v17
    v_mul_f32 v122, v114, v122
    v_and_b32 v127, 0xffff0000, v17
    v_add_u32 v123, v123, v123
    v_pk_fma_f32 v[124:125], v[124:125], v[122:123], s[34:35] op_sel_hi:[1,0,1]
    v_pk_fma_f32 v[126:127], v[126:127], v[122:123], s[34:35] op_sel_hi:[1,0,1]
    v_lshl_add_u32 v124, v125, 16, v124
    v_lshl_add_u32 v125, v127, 16, v126
    s_waitcnt lgkmcnt(2)
    v_bitop3_b32 v115, v115, v120, v121 bitop3:0xfe
    v_lshl_add_u64 v[124:125], v[124:125], 0, s[36:37]
    v_cmpx_le_u32 vcc, 0x1000000, v56
    ds_add_rtn_u64 v[120:121], v123, v[124:125] offset:54272
    s_mov_b64 exec, -1
    s_waitcnt lgkmcnt(15)
    v_ashrrev_i32 v122, 5, v57
    v_lshlrev_b16 v123, 2, v57
    v_lshlrev_b32 v124, 16, v18
    v_bitop3_b32 v122, v122, v113, v113 bitop3:0x0c
    v_and_b32 v125, 0xffff0000, v18
    v_lshlrev_b32 v126, 16, v19
    v_mul_f32 v122, v114, v122
    v_and_b32 v127, 0xffff0000, v19
    v_add_u32 v123, v123, v123
    v_pk_fma_f32 v[124:125], v[124:125], v[122:123], s[34:35] op_sel_hi:[1,0,1]
    v_pk_fma_f32 v[126:127], v[126:127], v[122:123], s[34:35] op_sel_hi:[1,0,1]
    v_lshl_add_u32 v124, v125, 16, v124
    v_lshl_add_u32 v125, v127, 16, v126
    s_waitcnt lgkmcnt(2)
    v_bitop3_b32 v115, v115, v116, v117 bitop3:0xfe
    v_lshl_add_u64 v[124:125], v[124:125], 0, s[36:37]
    v_cmpx_le_u32 vcc, 0x1000000, v57
    ds_add_rtn_u64 v[116:117], v123, v[124:125] offset:54272
    s_mov_b64 exec, -1
    v_ashrrev_i32 v122, 5, v58
    v_lshlrev_b16 v123, 2, v58
    v_lshlrev_b32 v124, 16, v20
    v_bitop3_b32 v122, v122, v113, v113 bitop3:0x0c
    v_and_b32 v125, 0xffff0000, v20
    v_lshlrev_b32 v126, 16, v21
    v_mul_f32 v122, v114, v122
    v_and_b32 v127, 0xffff0000, v21
    v_add_u32 v123, v123, v123
    v_pk_fma_f32 v[124:125], v[124:125], v[122:123], s[34:35] op_sel_hi:[1,0,1]
    v_pk_fma_f32 v[126:127], v[126:127], v[122:123], s[34:35] op_sel_hi:[1,0,1]
    v_lshl_add_u32 v124, v125, 16, v124
    v_lshl_add_u32 v125, v127, 16, v126
    s_waitcnt lgkmcnt(2)
    v_bitop3_b32 v115, v115, v118, v119 bitop3:0xfe
    v_lshl_add_u64 v[124:125], v[124:125], 0, s[36:37]
    v_cmpx_le_u32 vcc, 0x1000000, v58
    ds_add_rtn_u64 v[118:119], v123, v[124:125] offset:54272
    s_mov_b64 exec, -1
    v_ashrrev_i32 v122, 5, v59
    v_lshlrev_b16 v123, 2, v59
    v_lshlrev_b32 v124, 16, v22
    v_bitop3_b32 v122, v122, v113, v113 bitop3:0x0c
    v_and_b32 v125, 0xffff0000, v22
    v_lshlrev_b32 v126, 16, v23
    v_mul_f32 v122, v114, v122
    v_and_b32 v127, 0xffff0000, v23
    v_add_u32 v123, v123, v123
    v_pk_fma_f32 v[124:125], v[124:125], v[122:123], s[34:35] op_sel_hi:[1,0,1]
    v_pk_fma_f32 v[126:127], v[126:127], v[122:123], s[34:35] op_sel_hi:[1,0,1]
    v_lshl_add_u32 v124, v125, 16, v124
    v_lshl_add_u32 v125, v127, 16, v126
    s_waitcnt lgkmcnt(2)
    v_bitop3_b32 v115, v115, v120, v121 bitop3:0xfe
    v_lshl_add_u64 v[124:125], v[124:125], 0, s[36:37]
    v_cmpx_le_u32 vcc, 0x1000000, v59
    ds_add_rtn_u64 v[120:121], v123, v[124:125] offset:54272
    s_mov_b64 exec, -1
    s_waitcnt lgkmcnt(15)
    v_ashrrev_i32 v122, 5, v60
    v_lshlrev_b16 v123, 2, v60
    v_lshlrev_b32 v124, 16, v24
    v_bitop3_b32 v122, v122, v113, v113 bitop3:0x0c
    v_and_b32 v125, 0xffff0000, v24
    v_lshlrev_b32 v126, 16, v25
    v_mul_f32 v122, v114, v122
    v_and_b32 v127, 0xffff0000, v25
    v_add_u32 v123, v123, v123
    v_pk_fma_f32 v[124:125], v[124:125], v[122:123], s[34:35] op_sel_hi:[1,0,1]
    v_pk_fma_f32 v[126:127], v[126:127], v[122:123], s[34:35] op_sel_hi:[1,0,1]
    v_lshl_add_u32 v124, v125, 16, v124
    v_lshl_add_u32 v125, v127, 16, v126
    s_waitcnt lgkmcnt(2)
    v_bitop3_b32 v115, v115, v116, v117 bitop3:0xfe
    v_lshl_add_u64 v[124:125], v[124:125], 0, s[36:37]
    v_cmpx_le_u32 vcc, 0x1000000, v60
    ds_add_rtn_u64 v[116:117], v123, v[124:125] offset:54272
    s_mov_b64 exec, -1
    v_ashrrev_i32 v122, 5, v61
    v_lshlrev_b16 v123, 2, v61
    v_lshlrev_b32 v124, 16, v26
    v_bitop3_b32 v122, v122, v113, v113 bitop3:0x0c
    v_and_b32 v125, 0xffff0000, v26
    v_lshlrev_b32 v126, 16, v27
    v_mul_f32 v122, v114, v122
    v_and_b32 v127, 0xffff0000, v27
    v_add_u32 v123, v123, v123
    v_pk_fma_f32 v[124:125], v[124:125], v[122:123], s[34:35] op_sel_hi:[1,0,1]
    v_pk_fma_f32 v[126:127], v[126:127], v[122:123], s[34:35] op_sel_hi:[1,0,1]
    v_lshl_add_u32 v124, v125, 16, v124
    v_lshl_add_u32 v125, v127, 16, v126
    s_waitcnt lgkmcnt(2)
    v_bitop3_b32 v115, v115, v118, v119 bitop3:0xfe
    v_lshl_add_u64 v[124:125], v[124:125], 0, s[36:37]
    v_cmpx_le_u32 vcc, 0x1000000, v61
    ds_add_rtn_u64 v[118:119], v123, v[124:125] offset:54272
    s_mov_b64 exec, -1
    v_ashrrev_i32 v122, 5, v62
    v_lshlrev_b16 v123, 2, v62
    v_lshlrev_b32 v124, 16, v28
    v_bitop3_b32 v122, v122, v113, v113 bitop3:0x0c
    v_and_b32 v125, 0xffff0000, v28
    v_lshlrev_b32 v126, 16, v29
    v_mul_f32 v122, v114, v122
    v_and_b32 v127, 0xffff0000, v29
    v_add_u32 v123, v123, v123
    v_pk_fma_f32 v[124:125], v[124:125], v[122:123], s[34:35] op_sel_hi:[1,0,1]
    v_pk_fma_f32 v[126:127], v[126:127], v[122:123], s[34:35] op_sel_hi:[1,0,1]
    v_lshl_add_u32 v124, v125, 16, v124
    v_lshl_add_u32 v125, v127, 16, v126
    s_waitcnt lgkmcnt(2)
    v_bitop3_b32 v115, v115, v120, v121 bitop3:0xfe
    v_lshl_add_u64 v[124:125], v[124:125], 0, s[36:37]
    v_cmpx_le_u32 vcc, 0x1000000, v62
    ds_add_rtn_u64 v[120:121], v123, v[124:125] offset:54272
    s_mov_b64 exec, -1
    s_waitcnt lgkmcnt(15)
    v_ashrrev_i32 v122, 5, v63
    v_lshlrev_b16 v123, 2, v63
    v_lshlrev_b32 v124, 16, v30
    v_bitop3_b32 v122, v122, v113, v113 bitop3:0x0c
    v_and_b32 v125, 0xffff0000, v30
    v_lshlrev_b32 v126, 16, v31
    v_mul_f32 v122, v114, v122
    v_and_b32 v127, 0xffff0000, v31
    v_add_u32 v123, v123, v123
    v_pk_fma_f32 v[124:125], v[124:125], v[122:123], s[34:35] op_sel_hi:[1,0,1]
    v_pk_fma_f32 v[126:127], v[126:127], v[122:123], s[34:35] op_sel_hi:[1,0,1]
    v_lshl_add_u32 v124, v125, 16, v124
    v_lshl_add_u32 v125, v127, 16, v126
    s_waitcnt lgkmcnt(2)
    v_bitop3_b32 v115, v115, v116, v117 bitop3:0xfe
    v_lshl_add_u64 v[124:125], v[124:125], 0, s[36:37]
    v_cmpx_le_u32 vcc, 0x1000000, v63
    ds_add_rtn_u64 v[116:117], v123, v[124:125] offset:54272
    s_mov_b64 exec, -1
    v_ashrrev_i32 v122, 5, v64
    v_lshlrev_b16 v123, 2, v64
    v_lshlrev_b32 v124, 16, v32
    v_bitop3_b32 v122, v122, v113, v113 bitop3:0x0c
    v_and_b32 v125, 0xffff0000, v32
    v_lshlrev_b32 v126, 16, v33
    v_mul_f32 v122, v114, v122
    v_and_b32 v127, 0xffff0000, v33
    v_add_u32 v123, v123, v123
    v_pk_fma_f32 v[124:125], v[124:125], v[122:123], s[34:35] op_sel_hi:[1,0,1]
    v_pk_fma_f32 v[126:127], v[126:127], v[122:123], s[34:35] op_sel_hi:[1,0,1]
    v_lshl_add_u32 v124, v125, 16, v124
    v_lshl_add_u32 v125, v127, 16, v126
    s_waitcnt lgkmcnt(2)
    v_bitop3_b32 v115, v115, v118, v119 bitop3:0xfe
    v_lshl_add_u64 v[124:125], v[124:125], 0, s[36:37]
    v_cmpx_le_u32 vcc, 0x1000000, v64
    ds_add_rtn_u64 v[118:119], v123, v[124:125] offset:54272
    s_mov_b64 exec, -1
    v_ashrrev_i32 v122, 5, v65
    v_lshlrev_b16 v123, 2, v65
    v_lshlrev_b32 v124, 16, v34
    v_bitop3_b32 v122, v122, v113, v113 bitop3:0x0c
    v_and_b32 v125, 0xffff0000, v34
    v_lshlrev_b32 v126, 16, v35
    v_mul_f32 v122, v114, v122
    v_and_b32 v127, 0xffff0000, v35
    v_add_u32 v123, v123, v123
    v_pk_fma_f32 v[124:125], v[124:125], v[122:123], s[34:35] op_sel_hi:[1,0,1]
    v_pk_fma_f32 v[126:127], v[126:127], v[122:123], s[34:35] op_sel_hi:[1,0,1]
    v_lshl_add_u32 v124, v125, 16, v124
    v_lshl_add_u32 v125, v127, 16, v126
    s_waitcnt lgkmcnt(2)
    v_bitop3_b32 v115, v115, v120, v121 bitop3:0xfe
    v_lshl_add_u64 v[124:125], v[124:125], 0, s[36:37]
    v_cmpx_le_u32 vcc, 0x1000000, v65
    ds_add_rtn_u64 v[120:121], v123, v[124:125] offset:54272
    s_mov_b64 exec, -1
    s_waitcnt lgkmcnt(15)
    v_ashrrev_i32 v122, 5, v66
    v_lshlrev_b16 v123, 2, v66
    v_lshlrev_b32 v124, 16, v36
    v_bitop3_b32 v122, v122, v113, v113 bitop3:0x0c
    v_and_b32 v125, 0xffff0000, v36
    v_lshlrev_b32 v126, 16, v37
    v_mul_f32 v122, v114, v122
    v_and_b32 v127, 0xffff0000, v37
    v_add_u32 v123, v123, v123
    v_pk_fma_f32 v[124:125], v[124:125], v[122:123], s[34:35] op_sel_hi:[1,0,1]
    v_pk_fma_f32 v[126:127], v[126:127], v[122:123], s[34:35] op_sel_hi:[1,0,1]
    v_lshl_add_u32 v124, v125, 16, v124
    v_lshl_add_u32 v125, v127, 16, v126
    s_waitcnt lgkmcnt(2)
    v_bitop3_b32 v115, v115, v116, v117 bitop3:0xfe
    v_lshl_add_u64 v[124:125], v[124:125], 0, s[36:37]
    v_cmpx_le_u32 vcc, 0x1000000, v66
    ds_add_rtn_u64 v[116:117], v123, v[124:125] offset:54272
    s_mov_b64 exec, -1
    v_ashrrev_i32 v122, 5, v67
    v_lshlrev_b16 v123, 2, v67
    v_lshlrev_b32 v124, 16, v38
    v_bitop3_b32 v122, v122, v113, v113 bitop3:0x0c
    v_and_b32 v125, 0xffff0000, v38
    v_lshlrev_b32 v126, 16, v39
    v_mul_f32 v122, v114, v122
    v_and_b32 v127, 0xffff0000, v39
    v_add_u32 v123, v123, v123
    v_pk_fma_f32 v[124:125], v[124:125], v[122:123], s[34:35] op_sel_hi:[1,0,1]
    v_pk_fma_f32 v[126:127], v[126:127], v[122:123], s[34:35] op_sel_hi:[1,0,1]
    v_lshl_add_u32 v124, v125, 16, v124
    v_lshl_add_u32 v125, v127, 16, v126
    s_waitcnt lgkmcnt(2)
    v_bitop3_b32 v115, v115, v118, v119 bitop3:0xfe
    v_lshl_add_u64 v[124:125], v[124:125], 0, s[36:37]
    v_cmpx_le_u32 vcc, 0x1000000, v67
    ds_add_rtn_u64 v[118:119], v123, v[124:125] offset:54272
    s_mov_b64 exec, -1
    v_ashrrev_i32 v122, 5, v68
    v_lshlrev_b16 v123, 2, v68
    v_lshlrev_b32 v124, 16, v40
    v_bitop3_b32 v122, v122, v113, v113 bitop3:0x0c
    v_and_b32 v125, 0xffff0000, v40
    v_lshlrev_b32 v126, 16, v41
    v_mul_f32 v122, v114, v122
    v_and_b32 v127, 0xffff0000, v41
    v_add_u32 v123, v123, v123
    v_pk_fma_f32 v[124:125], v[124:125], v[122:123], s[34:35] op_sel_hi:[1,0,1]
    v_pk_fma_f32 v[126:127], v[126:127], v[122:123], s[34:35] op_sel_hi:[1,0,1]
    v_lshl_add_u32 v124, v125, 16, v124
    v_lshl_add_u32 v125, v127, 16, v126
    s_waitcnt lgkmcnt(2)
    v_bitop3_b32 v115, v115, v120, v121 bitop3:0xfe
    v_lshl_add_u64 v[124:125], v[124:125], 0, s[36:37]
    v_cmpx_le_u32 vcc, 0x1000000, v68
    ds_add_rtn_u64 v[120:121], v123, v[124:125] offset:54272
    s_mov_b64 exec, -1
    s_cmp_le_u32 s15, 7
    s_cbranch_scc1 p2_nad0
    s_waitcnt lgkmcnt(15)
    v_ashrrev_i32 v122, 5, v69
    v_lshlrev_b16 v123, 2, v69
    v_lshlrev_b32 v124, 16, v42
    v_bitop3_b32 v122, v122, v113, v113 bitop3:0x0c
    v_and_b32 v125, 0xffff0000, v42
    v_lshlrev_b32 v126, 16, v43
    v_mul_f32 v122, v114, v122
    v_and_b32 v127, 0xffff0000, v43
    v_add_u32 v123, v123, v123
    v_pk_fma_f32 v[124:125], v[124:125], v[122:123], s[34:35] op_sel_hi:[1,0,1]
    v_pk_fma_f32 v[126:127], v[126:127], v[122:123], s[34:35] op_sel_hi:[1,0,1]
    v_lshl_add_u32 v124, v125, 16, v124
    v_lshl_add_u32 v125, v127, 16, v126
    s_waitcnt lgkmcnt(2)
    v_bitop3_b32 v115, v115, v116, v117 bitop3:0xfe
    v_lshl_add_u64 v[124:125], v[124:125], 0, s[36:37]
    v_cmpx_le_u32 vcc, 0x1000000, v69
    ds_add_rtn_u64 v[116:117], v123, v[124:125] offset:54272
    s_mov_b64 exec, -1
    v_ashrrev_i32 v122, 5, v70
    v_lshlrev_b16 v123, 2, v70
    v_lshlrev_b32 v124, 16, v44
    v_bitop3_b32 v122, v122, v113, v113 bitop3:0x0c
    v_and_b32 v125, 0xffff0000, v44
    v_lshlrev_b32 v126, 16, v45
    v_mul_f32 v122, v114, v122
    v_and_b32 v127, 0xffff0000, v45
    v_add_u32 v123, v123, v123
    v_pk_fma_f32 v[124:125], v[124:125], v[122:123], s[34:35] op_sel_hi:[1,0,1]
    v_pk_fma_f32 v[126:127], v[126:127], v[122:123], s[34:35] op_sel_hi:[1,0,1]
    v_lshl_add_u32 v124, v125, 16, v124
    v_lshl_add_u32 v125, v127, 16, v126
    s_waitcnt lgkmcnt(2)
    v_bitop3_b32 v115, v115, v118, v119 bitop3:0xfe
    v_lshl_add_u64 v[124:125], v[124:125], 0, s[36:37]
    v_cmpx_le_u32 vcc, 0x1000000, v70
    ds_add_rtn_u64 v[118:119], v123, v[124:125] offset:54272
    s_mov_b64 exec, -1
    v_ashrrev_i32 v122, 5, v71
    v_lshlrev_b16 v123, 2, v71
    v_lshlrev_b32 v124, 16, v46
    v_bitop3_b32 v122, v122, v113, v113 bitop3:0x0c
    v_and_b32 v125, 0xffff0000, v46
    v_lshlrev_b32 v126, 16, v47
    v_mul_f32 v122, v114, v122
    v_and_b32 v127, 0xffff0000, v47
    v_add_u32 v123, v123, v123
    v_pk_fma_f32 v[124:125], v[124:125], v[122:123], s[34:35] op_sel_hi:[1,0,1]
    v_pk_fma_f32 v[126:127], v[126:127], v[122:123], s[34:35] op_sel_hi:[1,0,1]
    v_lshl_add_u32 v124, v125, 16, v124
    v_lshl_add_u32 v125, v127, 16, v126
    s_waitcnt lgkmcnt(2)
    v_bitop3_b32 v115, v115, v120, v121 bitop3:0xfe
    v_lshl_add_u64 v[124:125], v[124:125], 0, s[36:37]
    v_cmpx_le_u32 vcc, 0x1000000, v71
    ds_add_rtn_u64 v[120:121], v123, v[124:125] offset:54272
    s_mov_b64 exec, -1
p2_nad0:
    s_branch p2_fin
p2_topf:
    s_cmp_eq_u32 s60, 10
    s_cbranch_scc1 p2_drain1
    v_cmpx_gt_i16 vcc, 0, v48
    ds_read_b64 v[0:1], v0
    s_mov_b64 exec, -1
    v_cmpx_gt_i16 vcc, 0, v49
    ds_read_b64 v[2:3], v2
    s_mov_b64 exec, -1
    v_cmpx_gt_i16 vcc, 0, v50
    ds_read_b64 v[4:5], v4
    s_mov_b64 exec, -1
    v_cmpx_gt_i16 vcc, 0, v51
    ds_read_b64 v[6:7], v6
    s_mov_b64 exec, -1
    v_cmpx_gt_i16 vcc, 0, v52
    ds_read_b64 v[8:9], v8
    s_mov_b64 exec, -1
    v_cmpx_gt_i16 vcc, 0, v53
    ds_read_b64 v[10:11], v10
    s_mov_b64 exec, -1
    v_cmpx_gt_i16 vcc, 0, v54
    ds_read_b64 v[12:13], v12
    s_mov_b64 exec, -1
    v_cmpx_gt_i16 vcc, 0, v55
    ds_read_b64 v[14:15], v14
    s_mov_b64 exec, -1
    v_cmpx_gt_i16 vcc, 0, v56
    ds_read_b64 v[16:17], v16
    s_mov_b64 exec, -1
    v_cmpx_gt_i16 vcc, 0, v57
    ds_read_b64 v[18:19], v18
    s_mov_b64 exec, -1
    v_cmpx_gt_i16 vcc, 0, v58
    ds_read_b64 v[20:21], v20
    s_mov_b64 exec, -1
    v_cmpx_gt_i16 vcc, 0, v59
    ds_read_b64 v[22:23], v22
    s_mov_b64 exec, -1
    s_cmp_ge_u32 s10, 9
    s_cbranch_scc1 p2_nm1m0a
    v_lshrrev_b32 v84, 1, v112
    s_add_u32 s44, s20, s42
    buffer_load_dwordx2 v[84:85], v84, s[4:7], s44 offen
p2_nm1m0a:
    buffer_load_dwordx4 v[72:75], v112, s[4:7], s20 offen offset:0
    buffer_load_dwordx4 v[76:79], v112, s[4:7], s20 offen offset:1024
    buffer_load_dwordx4 v[80:83], v112, s[4:7], s20 offen offset:2048
    v_cmpx_gt_i16 vcc, 0, v60
    ds_read_b64 v[24:25], v24
    s_mov_b64 exec, -1
    v_cmpx_gt_i16 vcc, 0, v61
    ds_read_b64 v[26:27], v26
    s_mov_b64 exec, -1
    v_cmpx_gt_i16 vcc, 0, v62
    ds_read_b64 v[28:29], v28
    s_mov_b64 exec, -1
    v_cmpx_gt_i16 vcc, 0, v63
    ds_read_b64 v[30:31], v30
    s_mov_b64 exec, -1
    v_cmpx_gt_i16 vcc, 0, v64
    ds_read_b64 v[32:33], v32
    s_mov_b64 exec, -1
    v_cmpx_gt_i16 vcc, 0, v65
    ds_read_b64 v[34:35], v34
    s_mov_b64 exec, -1
    v_cmpx_gt_i16 vcc, 0, v66
    ds_read_b64 v[36:37], v36
    s_mov_b64 exec, -1
    v_cmpx_gt_i16 vcc, 0, v67
    ds_read_b64 v[38:39], v38
    s_mov_b64 exec, -1
    v_cmpx_gt_i16 vcc, 0, v68
    ds_read_b64 v[40:41], v40
    s_mov_b64 exec, -1
    s_cmp_le_u32 s15, 7
    s_cbranch_scc1 p2_g1r27
    v_cmpx_gt_i16 vcc, 0, v69
    ds_read_b64 v[42:43], v42
    s_mov_b64 exec, -1
    v_cmpx_gt_i16 vcc, 0, v70
    ds_read_b64 v[44:45], v44
    s_mov_b64 exec, -1
    v_cmpx_gt_i16 vcc, 0, v71
    ds_read_b64 v[46:47], v46
    s_mov_b64 exec, -1
p2_g1r27:
    s_waitcnt lgkmcnt(15)
    v_ashrrev_i32 v122, 5, v48
    v_lshlrev_b16 v123, 2, v48
    v_cndmask_b32 v126, v0, v1, s[66:67]
    v_bitop3_b32 v122, v122, v113, v113 bitop3:0x0c
    v_lshlrev_b32 v124, 16, v126
    v_mul_f32 v122, v114, v122
    v_and_b32 v125, 0xffff0000, v126
    v_add_u32 v123, v123, v123
    v_mul_f32 v124, v122, v124
    v_mul_f32 v125, v122, v125
    v_cmpx_le_u32 vcc, 0x1000000, v48
    ds_add_f32 v123, v124 offset:54272
    ds_add_f32 v123, v125 offset:54276
    s_mov_b64 exec, -1
    v_ashrrev_i32 v122, 5, v49
    v_lshlrev_b16 v123, 2, v49
    v_cndmask_b32 v126, v2, v3, s[66:67]
    v_bitop3_b32 v122, v122, v113, v113 bitop3:0x0c
    v_lshlrev_b32 v124, 16, v126
    v_mul_f32 v122, v114, v122
    v_and_b32 v125, 0xffff0000, v126
    v_add_u32 v123, v123, v123
    v_mul_f32 v124, v122, v124
    v_mul_f32 v125, v122, v125
    v_cmpx_le_u32 vcc, 0x1000000, v49
    ds_add_f32 v123, v124 offset:54272
    ds_add_f32 v123, v125 offset:54276
    s_mov_b64 exec, -1
    v_ashrrev_i32 v122, 5, v50
    v_lshlrev_b16 v123, 2, v50
    v_cndmask_b32 v126, v4, v5, s[66:67]
    v_bitop3_b32 v122, v122, v113, v113 bitop3:0x0c
    v_lshlrev_b32 v124, 16, v126
    v_mul_f32 v122, v114, v122
    v_and_b32 v125, 0xffff0000, v126
    v_add_u32 v123, v123, v123
    v_mul_f32 v124, v122, v124
    v_mul_f32 v125, v122, v125
    v_cmpx_le_u32 vcc, 0x1000000, v50
    ds_add_f32 v123, v124 offset:54272
    ds_add_f32 v123, v125 offset:54276
    s_mov_b64 exec, -1
    v_lshrrev_b32 v0, 3, v102
    v_lshrrev_b32 v1, 18, v102
    v_and_b32 v102, 0x3fff, v102
    v_and_or_b32 v0, v0, s65, v1
    v_mad_u32_u24 v102, v0, s63, v102
    buffer_load_dwordx4 v[0:3], v102, s[68:71], 0 offen
    s_waitcnt lgkmcnt(15)
    v_ashrrev_i32 v122, 5, v51
    v_lshlrev_b16 v123, 2, v51
    v_cndmask_b32 v126, v6, v7, s[66:67]
    v_bitop3_b32 v122, v122, v113, v113 bitop3:0x0c
    v_lshlrev_b32 v124, 16, v126
    v_mul_f32 v122, v114, v122
    v_and_b32 v125, 0xffff0000, v126
    v_add_u32 v123, v123, v123
    v_mul_f32 v124, v122, v124
    v_mul_f32 v125, v122, v125
    v_cmpx_le_u32 vcc, 0x1000000, v51
    ds_add_f32 v123, v124 offset:54272
    ds_add_f32 v123, v125 offset:54276
    s_mov_b64 exec, -1
    v_ashrrev_i32 v122, 5, v52
    v_lshlrev_b16 v123, 2, v52
    v_cndmask_b32 v126, v8, v9, s[66:67]
    v_bitop3_b32 v122, v122, v113, v113 bitop3:0x0c
    v_lshlrev_b32 v124, 16, v126
    v_mul_f32 v122, v114, v122
    v_and_b32 v125, 0xffff0000, v126
    v_add_u32 v123, v123, v123
    v_mul_f32 v124, v122, v124
    v_mul_f32 v125, v122, v125
    v_cmpx_le_u32 vcc, 0x1000000, v52
    ds_add_f32 v123, v124 offset:54272
    ds_add_f32 v123, v125 offset:54276
    s_mov_b64 exec, -1
    v_ashrrev_i32 v122, 5, v53
    v_lshlrev_b16 v123, 2, v53
    v_cndmask_b32 v126, v10, v11, s[66:67]
    v_bitop3_b32 v122, v122, v113, v113 bitop3:0x0c
    v_lshlrev_b32 v124, 16, v126
    v_mul_f32 v122, v114, v122
    v_and_b32 v125, 0xffff0000, v126
    v_add_u32 v123, v123, v123
    v_mul_f32 v124, v122, v124
    v_mul_f32 v125, v122, v125
    v_cmpx_le_u32 vcc, 0x1000000, v53
    ds_add_f32 v123, v124 offset:54272
    ds_add_f32 v123, v125 offset:54276
    s_mov_b64 exec, -1
    v_lshrrev_b32 v6, 3, v103
    v_lshrrev_b32 v7, 18, v103
    v_and_b32 v103, 0x3fff, v103
    v_and_or_b32 v6, v6, s65, v7
    v_mad_u32_u24 v103, v6, s63, v103
    buffer_load_dwordx4 v[6:9], v103, s[68:71], 0 offen
    s_waitcnt lgkmcnt(12)
    s_barrier
    s_waitcnt lgkmcnt(15)
    v_ashrrev_i32 v122, 5, v54
    v_lshlrev_b16 v123, 2, v54
    v_cndmask_b32 v126, v12, v13, s[66:67]
    v_bitop3_b32 v122, v122, v113, v113 bitop3:0x0c
    v_lshlrev_b32 v124, 16, v126
    v_mul_f32 v122, v114, v122
    v_and_b32 v125, 0xffff0000, v126
    v_add_u32 v123, v123, v123
    v_mul_f32 v124, v122, v124
    v_mul_f32 v125, v122, v125
    v_cmpx_le_u32 vcc, 0x1000000, v54
    ds_add_f32 v123, v124 offset:54272
    ds_add_f32 v123, v125 offset:54276
    s_mov_b64 exec, -1
    v_ashrrev_i32 v122, 5, v55
    v_lshlrev_b16 v123, 2, v55
    v_cndmask_b32 v126, v14, v15, s[66:67]
    v_bitop3_b32 v122, v122, v113, v113 bitop3:0x0c
    v_lshlrev_b32 v124, 16, v126
    v_mul_f32 v122, v114, v122
    v_and_b32 v125, 0xffff0000, v126
    v_add_u32 v123, v123, v123
    v_mul_f32 v124, v122, v124
    v_mul_f32 v125, v122, v125
    v_cmpx_le_u32 vcc, 0x1000000, v55
    ds_add_f32 v123, v124 offset:54272
    ds_add_f32 v123, v125 offset:54276
    s_mov_b64 exec, -1
    v_ashrrev_i32 v122, 5, v56
    v_lshlrev_b16 v123, 2, v56
    v_cndmask_b32 v126, v16, v17, s[66:67]
    v_bitop3_b32 v122, v122, v113, v113 bitop3:0x0c
    v_lshlrev_b32 v124, 16, v126
    v_mul_f32 v122, v114, v122
    v_and_b32 v125, 0xffff0000, v126
    v_add_u32 v123, v123, v123
    v_mul_f32 v124, v122, v124
    v_mul_f32 v125, v122, v125
    v_cmpx_le_u32 vcc, 0x1000000, v56
    ds_add_f32 v123, v124 offset:54272
    ds_add_f32 v123, v125 offset:54276
    s_mov_b64 exec, -1
    v_lshrrev_b32 v12, 3, v104
    v_lshrrev_b32 v13, 18, v104
    v_and_b32 v104, 0x3fff, v104
    v_and_or_b32 v12, v12, s65, v13
    v_mad_u32_u24 v104, v12, s63, v104
    buffer_load_dwordx4 v[12:15], v104, s[68:71], 0 offen
    s_waitcnt lgkmcnt(15)
    v_ashrrev_i32 v122, 5, v57
    v_lshlrev_b16 v123, 2, v57
    v_cndmask_b32 v126, v18, v19, s[66:67]
    v_bitop3_b32 v122, v122, v113, v113 bitop3:0x0c
    v_lshlrev_b32 v124, 16, v126
    v_mul_f32 v122, v114, v122
    v_and_b32 v125, 0xffff0000, v126
    v_add_u32 v123, v123, v123
    v_mul_f32 v124, v122, v124
    v_mul_f32 v125, v122, v125
    v_cmpx_le_u32 vcc, 0x1000000, v57
    ds_add_f32 v123, v124 offset:54272
    ds_add_f32 v123, v125 offset:54276
    s_mov_b64 exec, -1
    v_ashrrev_i32 v122, 5, v58
    v_lshlrev_b16 v123, 2, v58
    v_cndmask_b32 v126, v20, v21, s[66:67]
    v_bitop3_b32 v122, v122, v113, v113 bitop3:0x0c
    v_lshlrev_b32 v124, 16, v126
    v_mul_f32 v122, v114, v122
    v_and_b32 v125, 0xffff0000, v126
    v_add_u32 v123, v123, v123
    v_mul_f32 v124, v122, v124
    v_mul_f32 v125, v122, v125
    v_cmpx_le_u32 vcc, 0x1000000, v58
    ds_add_f32 v123, v124 offset:54272
    ds_add_f32 v123, v125 offset:54276
    s_mov_b64 exec, -1
    v_ashrrev_i32 v122, 5, v59
    v_lshlrev_b16 v123, 2, v59
    v_cndmask_b32 v126, v22, v23, s[66:67]
    v_bitop3_b32 v122, v122, v113, v113 bitop3:0x0c
    v_lshlrev_b32 v124, 16, v126
    v_mul_f32 v122, v114, v122
    v_and_b32 v125, 0xffff0000, v126
    v_add_u32 v123, v123, v123
    v_mul_f32 v124, v122, v124
    v_mul_f32 v125, v122, v125
    v_cmpx_le_u32 vcc, 0x1000000, v59
    ds_add_f32 v123, v124 offset:54272
    ds_add_f32 v123, v125 offset:54276
    s_mov_b64 exec, -1
    v_lshrrev_b32 v18, 3, v105
    v_lshrrev_b32 v19, 18, v105
    v_and_b32 v105, 0x3fff, v105
    v_and_or_b32 v18, v18, s65, v19
    v_mad_u32_u24 v105, v18, s63, v105
    buffer_load_dwordx4 v[18:21], v105, s[68:71], 0 offen
    s_mov_b32 m0, s23
    v_mov_b32 v53, 0x3c000
    s_movk_i32 s44, 512
    v_sub_u32_sdwa v4, v111, v110 dst_sel:DWORD dst_unused:UNUSED_PAD src0_sel:WORD_0 src1_sel:WORD_0
    v_sub_u32_sdwa v5, v111, v110 dst_sel:DWORD dst_unused:UNUSED_PAD src0_sel:WORD_1 src1_sel:WORD_1
    v_med3_i32 v4, v4, 0, s44
    v_med3_i32 v5, v5, 0, s44
    v_add_u32 v48, v4, v5
    ds_write_addtid_b32 v53 offset:0
    ds_write_addtid_b32 v53 offset:256
    ds_write_addtid_b32 v53 offset:512
    ds_write_addtid_b32 v53 offset:768
    ds_write_addtid_b32 v53 offset:1024
    ds_write_addtid_b32 v53 offset:1280
    ds_write_addtid_b32 v53 offset:1536
    ds_write_addtid_b32 v53 offset:1792
    v_lshl_add_u32 v53, v112, 15, s41
    s_nop 1
    v_add_u32_dpp v48, v48, v48 row_shr:1 row_mask:0xf bank_mask:0xf bound_ctrl:0
    s_nop 1
    v_add_u32_dpp v48, v48, v48 row_shr:2 row_mask:0xf bank_mask:0xf bound_ctrl:0
    s_nop 1
    v_add_u32_dpp v48, v48, v48 row_shr:4 row_mask:0xf bank_mask:0xf bound_ctrl:0
    s_nop 1
    v_add_u32_dpp v48, v48, v48 row_shr:8 row_mask:0xf bank_mask:0xf bound_ctrl:0
    s_nop 1
    v_add_u32_dpp v48, v48, v48 row_bcast:15 row_mask:0xa bank_mask:0xf
    s_nop 1
    v_add_u32_dpp v48, v48, v48 row_bcast:31 row_mask:0xc bank_mask:0xf
    s_nop 1
    s_nop 0
    v_readlane_b32 s38, v48, 63
    v_sub_u32 v50, v48, v5
    v_sub_u32 v49, v50, v4
    v_sub_u32 v10, 512, v49
    v_mad_u32_u16 v51, v110, 16, v53
    v_med3_i32 v10, v10, 0, v4
    v_lshl_add_u32 v49, v49, 2, s23
    v_sub_u32 v11, 512, v50
    v_mad_u32_u16 v52, v110, 16, v53 op_sel:[1,0,0,0]
    v_med3_i32 v11, v11, 0, v5
    v_lshl_add_u32 v50, v50, 2, s23
    v_lshl_add_u32 v48, v11, 16, v10
    v_add_u32 v52, 262144, v52
    v_add_u32 v110, v110, v48
    s_min_u32 s17, s38, 512
    s_add_u32 s17, s17, 63
    s_lshr_b32 s17, s17, 6
p2_x1x_0:
    v_cmpx_lt_i32 vcc, 0, v10
    s_cbranch_execz p2_y1x_0
    ds_write_b32 v49, v51 offset:0
    v_add_u32 v51, 16, v51
    v_cmpx_lt_i32 vcc, 1, v10
    s_cbranch_execz p2_y1x_0
    ds_write_b32 v49, v51 offset:4
    v_add_u32 v51, 16, v51
    v_cmpx_lt_i32 vcc, 2, v10
    s_cbranch_execz p2_y1x_0
    ds_write_b32 v49, v51 offset:8
    v_add_u32 v51, 16, v51
    v_cmpx_lt_i32 vcc, 3, v10
    s_cbranch_execz p2_y1x_0
    ds_write_b32 v49, v51 offset:12
    v_add_u32 v51, 16, v51
    v_cmpx_lt_i32 vcc, 4, v10
    s_cbranch_execz p2_y1x_0
    ds_write_b32 v49, v51 offset:16
    v_add_u32 v51, 16, v51
    v_cmpx_lt_i32 vcc, 5, v10
    s_cbranch_execz p2_y1x_0
    ds_write_b32 v49, v51 offset:20
    v_add_u32 v51, 16, v51
    v_cmpx_lt_i32 vcc, 6, v10
    s_cbranch_execz p2_y1x_0
    ds_write_b32 v49, v51 offset:24
    v_add_u32 v51, 16, v51
    v_cmpx_lt_i32 vcc, 7, v10
    s_cbranch_execz p2_y1x_0
    ds_write_b32 v49, v51 offset:28
    v_add_u32 v51, 16, v51
    v_subrev_u32 v10, 8, v10
    v_add_u32 v49, 32, v49
    s_branch p2_x1x_0
p2_y1x_0:
    s_mov_b64 exec, -1
p2_x1x_1:
    v_cmpx_lt_i32 vcc, 0, v11
    s_cbranch_execz p2_y1x_1
    ds_write_b32 v50, v52 offset:0
    v_add_u32 v52, 16, v52
    v_cmpx_lt_i32 vcc, 1, v11
    s_cbranch_execz p2_y1x_1
    ds_write_b32 v50, v52 offset:4
    v_add_u32 v52, 16, v52
    v_cmpx_lt_i32 vcc, 2, v11
    s_cbranch_execz p2_y1x_1
    ds_write_b32 v50, v52 offset:8
    v_add_u32 v52, 16, v52
    v_cmpx_lt_i32 vcc, 3, v11
    s_cbranch_execz p2_y1x_1
    ds_write_b32 v50, v52 offset:12
    v_add_u32 v52, 16, v52
    v_cmpx_lt_i32 vcc, 4, v11
    s_cbranch_execz p2_y1x_1
    ds_write_b32 v50, v52 offset:16
    v_add_u32 v52, 16, v52
    v_cmpx_lt_i32 vcc, 5, v11
    s_cbranch_execz p2_y1x_1
    ds_write_b32 v50, v52 offset:20
    v_add_u32 v52, 16, v52
    v_cmpx_lt_i32 vcc, 6, v11
    s_cbranch_execz p2_y1x_1
    ds_write_b32 v50, v52 offset:24
    v_add_u32 v52, 16, v52
    v_cmpx_lt_i32 vcc, 7, v11
    s_cbranch_execz p2_y1x_1
    ds_write_b32 v50, v52 offset:28
    v_add_u32 v52, 16, v52
    v_subrev_u32 v11, 8, v11
    v_add_u32 v50, 32, v50
    s_branch p2_x1x_1
p2_y1x_1:
    s_mov_b64 exec, -1
    s_cmp_lt_u32 s38, 512
    s_cbranch_scc1 p2_nomore1x
    v_cmp_lt_u32_sdwa s[44:45], v110, v111 src0_sel:WORD_0 src1_sel:WORD_0
    v_cmp_lt_u32_sdwa s[46:47], v110, v111 src0_sel:WORD_1 src1_sel:WORD_1
    s_nop 0
    s_or_b64 s[44:45], s[44:45], s[46:47]
    s_cbranch_scc0 p2_nomore1x
    v_mov_b32 v49, s19
    v_mov_b32 v50, 1
    ds_write_b32 v49, v50 offset:53760
p2_nomore1x:
    s_mov_b32 m0, s23
    s_nop 0
    ds_read_addtid_b32 v102 offset:0
    ds_read_addtid_b32 v103 offset:256
    ds_read_addtid_b32 v104 offset:512
    ds_read_addtid_b32 v105 offset:768
    ds_read_addtid_b32 v106 offset:1024
    ds_read_addtid_b32 v107 offset:1280
    ds_read_addtid_b32 v108 offset:1536
    ds_read_addtid_b32 v109 offset:1792
    s_waitcnt vmcnt(4)
    s_mov_b32 m0, s24
    s_cmp_ge_u32 s10, 9
    s_cbranch_scc1 p2_st1s0
    ds_write_addtid_b32 v84 offset:49152
    ds_write_addtid_b32 v85 offset:49408
p2_st1s0:
    s_mov_b32 m0, s23
    s_add_u32 s20, s20, 53760
    ds_write_addtid_b32 v72 offset:0
    ds_write_addtid_b32 v73 offset:256
    ds_write_addtid_b32 v74 offset:512
    ds_write_addtid_b32 v75 offset:768
    ds_write_addtid_b32 v76 offset:1024
    ds_write_addtid_b32 v77 offset:1280
    ds_write_addtid_b32 v78 offset:1536
    ds_write_addtid_b32 v79 offset:1792
    ds_write_addtid_b32 v80 offset:2048
    ds_write_addtid_b32 v81 offset:2304
    ds_write_addtid_b32 v82 offset:2560
    ds_write_addtid_b32 v83 offset:2816
    s_waitcnt lgkmcnt(15)
    v_ashrrev_i32 v122, 5, v60
    v_lshlrev_b16 v123, 2, v60
    v_cndmask_b32 v126, v24, v25, s[66:67]
    v_bitop3_b32 v122, v122, v113, v113 bitop3:0x0c
    v_lshlrev_b32 v124, 16, v126
    v_mul_f32 v122, v114, v122
    v_and_b32 v125, 0xffff0000, v126
    v_add_u32 v123, v123, v123
    v_mul_f32 v124, v122, v124
    v_mul_f32 v125, v122, v125
    v_cmpx_le_u32 vcc, 0x1000000, v60
    ds_add_f32 v123, v124 offset:54272
    ds_add_f32 v123, v125 offset:54276
    s_mov_b64 exec, -1
    v_ashrrev_i32 v122, 5, v61
    v_lshlrev_b16 v123, 2, v61
    v_cndmask_b32 v126, v26, v27, s[66:67]
    v_bitop3_b32 v122, v122, v113, v113 bitop3:0x0c
    v_lshlrev_b32 v124, 16, v126
    v_mul_f32 v122, v114, v122
    v_and_b32 v125, 0xffff0000, v126
    v_add_u32 v123, v123, v123
    v_mul_f32 v124, v122, v124
    v_mul_f32 v125, v122, v125
    v_cmpx_le_u32 vcc, 0x1000000, v61
    ds_add_f32 v123, v124 offset:54272
    ds_add_f32 v123, v125 offset:54276
    s_mov_b64 exec, -1
    v_ashrrev_i32 v122, 5, v62
    v_lshlrev_b16 v123, 2, v62
    v_cndmask_b32 v126, v28, v29, s[66:67]
    v_bitop3_b32 v122, v122, v113, v113 bitop3:0x0c
    v_lshlrev_b32 v124, 16, v126
    v_mul_f32 v122, v114, v122
    v_and_b32 v125, 0xffff0000, v126
    v_add_u32 v123, v123, v123
    v_mul_f32 v124, v122, v124
    v_mul_f32 v125, v122, v125
    v_cmpx_le_u32 vcc, 0x1000000, v62
    ds_add_f32 v123, v124 offset:54272
    ds_add_f32 v123, v125 offset:54276
    s_mov_b64 exec, -1
    s_waitcnt vmcnt(13)
    v_perm_b32 v60, v89, v86, s31
    v_perm_b32 v61, v89, v87, s32
    v_perm_b32 v62, v89, v88, s33
    v_lshlrev_b16 v28, 3, v88
    v_lshlrev_b16 v26, 3, v87
    v_lshlrev_b16 v24, 3, v86
    s_waitcnt lgkmcnt(6)
    s_barrier
    s_cmp_ge_u32 s10, 9
    s_cbranch_scc1 p2_nm1m1a
    v_lshrrev_b32 v84, 1, v112
    s_add_u32 s44, s20, s42
    buffer_load_dwordx2 v[84:85], v84, s[4:7], s44 offen
p2_nm1m1a:
    buffer_load_dwordx4 v[72:75], v112, s[4:7], s20 offen offset:0
    buffer_load_dwordx4 v[76:79], v112, s[4:7], s20 offen offset:1024
    buffer_load_dwordx4 v[80:83], v112, s[4:7], s20 offen offset:2048
    v_cmpx_ge_u16 vcc, 0x3fff, v60
    ds_read_b64 v[24:25], v24
    s_mov_b64 exec, -1
    v_cmpx_ge_u16 vcc, 0x3fff, v61
    ds_read_b64 v[26:27], v26
    s_mov_b64 exec, -1
    v_cmpx_ge_u16 vcc, 0x3fff, v62
    ds_read_b64 v[28:29], v28
    s_mov_b64 exec, -1
    s_waitcnt lgkmcnt(15)
    v_ashrrev_i32 v122, 5, v63
    v_lshlrev_b16 v123, 2, v63
    v_cndmask_b32 v126, v30, v31, s[66:67]
    v_bitop3_b32 v122, v122, v113, v113 bitop3:0x0c
    v_lshlrev_b32 v124, 16, v126
    v_mul_f32 v122, v114, v122
    v_and_b32 v125, 0xffff0000, v126
    v_add_u32 v123, v123, v123
    v_mul_f32 v124, v122, v124
    v_mul_f32 v125, v122, v125
    v_cmpx_le_u32 vcc, 0x1000000, v63
    ds_add_f32 v123, v124 offset:54272
    ds_add_f32 v123, v125 offset:54276
    s_mov_b64 exec, -1
    v_ashrrev_i32 v122, 5, v64
    v_lshlrev_b16 v123, 2, v64
    v_cndmask_b32 v126, v32, v33, s[66:67]
    v_bitop3_b32 v122, v122, v113, v113 bitop3:0x0c
    v_lshlrev_b32 v124, 16, v126
    v_mul_f32 v122, v114, v122
    v_and_b32 v125, 0xffff0000, v126
    v_add_u32 v123, v123, v123
    v_mul_f32 v124, v122, v124
    v_mul_f32 v125, v122, v125
    v_cmpx_le_u32 vcc, 0x1000000, v64
    ds_add_f32 v123, v124 offset:54272
    ds_add_f32 v123, v125 offset:54276
    s_mov_b64 exec, -1
    v_ashrrev_i32 v122, 5, v65
    v_lshlrev_b16 v123, 2, v65
    v_cndmask_b32 v126, v34, v35, s[66:67]
    v_bitop3_b32 v122, v122, v113, v113 bitop3:0x0c
    v_lshlrev_b32 v124, 16, v126
    v_mul_f32 v122, v114, v122
    v_and_b32 v125, 0xffff0000, v126
    v_add_u32 v123, v123, v123
    v_mul_f32 v124, v122, v124
    v_mul_f32 v125, v122, v125
    v_cmpx_le_u32 vcc, 0x1000000, v65
    ds_add_f32 v123, v124 offset:54272
    ds_add_f32 v123, v125 offset:54276
    s_mov_b64 exec, -1
    s_waitcnt vmcnt(15)
    v_perm_b32 v63, v93, v90, s31
    v_perm_b32 v64, v93, v91, s32
    v_perm_b32 v65, v93, v92, s33
    v_lshlrev_b16 v34, 3, v92
    v_lshlrev_b16 v32, 3, v91
    v_lshlrev_b16 v30, 3, v90
    v_cmpx_ge_u16 vcc, 0x3fff, v63
    ds_read_b64 v[30:31], v30
    s_mov_b64 exec, -1
    v_cmpx_ge_u16 vcc, 0x3fff, v64
    ds_read_b64 v[32:33], v32
    s_mov_b64 exec, -1
    v_cmpx_ge_u16 vcc, 0x3fff, v65
    ds_read_b64 v[34:35], v34
    s_mov_b64 exec, -1
    s_waitcnt lgkmcnt(15)
    v_lshrrev_b32 v86, 3, v106
    v_lshrrev_b32 v87, 18, v106
    v_and_b32 v106, 0x3fff, v106
    v_and_or_b32 v86, v86, s65, v87
    v_mad_u32_u24 v106, v86, s63, v106
    buffer_load_dwordx4 v[86:89], v106, s[68:71], 0 offen
    s_waitcnt lgkmcnt(15)
    v_ashrrev_i32 v122, 5, v66
    v_lshlrev_b16 v123, 2, v66
    v_cndmask_b32 v126, v36, v37, s[66:67]
    v_bitop3_b32 v122, v122, v113, v113 bitop3:0x0c
    v_lshlrev_b32 v124, 16, v126
    v_mul_f32 v122, v114, v122
    v_and_b32 v125, 0xffff0000, v126
    v_add_u32 v123, v123, v123
    v_mul_f32 v124, v122, v124
    v_mul_f32 v125, v122, v125
    v_cmpx_le_u32 vcc, 0x1000000, v66
    ds_add_f32 v123, v124 offset:54272
    ds_add_f32 v123, v125 offset:54276
    s_mov_b64 exec, -1
    v_ashrrev_i32 v122, 5, v67
    v_lshlrev_b16 v123, 2, v67
    v_cndmask_b32 v126, v38, v39, s[66:67]
    v_bitop3_b32 v122, v122, v113, v113 bitop3:0x0c
    v_lshlrev_b32 v124, 16, v126
    v_mul_f32 v122, v114, v122
    v_and_b32 v125, 0xffff0000, v126
    v_add_u32 v123, v123, v123
    v_mul_f32 v124, v122, v124
    v_mul_f32 v125, v122, v125
    v_cmpx_le_u32 vcc, 0x1000000, v67
    ds_add_f32 v123, v124 offset:54272
    ds_add_f32 v123, v125 offset:54276
    s_mov_b64 exec, -1
    v_ashrrev_i32 v122, 5, v68
    v_lshlrev_b16 v123, 2, v68
    v_cndmask_b32 v126, v40, v41, s[66:67]
    v_bitop3_b32 v122, v122, v113, v113 bitop3:0x0c
    v_lshlrev_b32 v124, 16, v126
    v_mul_f32 v122, v114, v122
    v_and_b32 v125, 0xffff0000, v126
    v_add_u32 v123, v123, v123
    v_mul_f32 v124, v122, v124
    v_mul_f32 v125, v122, v125
    v_cmpx_le_u32 vcc, 0x1000000, v68
    ds_add_f32 v123, v124 offset:54272
    ds_add_f32 v123, v125 offset:54276
    s_mov_b64 exec, -1
    s_waitcnt vmcnt(12)
    v_perm_b32 v66, v97, v94, s31
    v_perm_b32 v67, v97, v95, s32
    v_perm_b32 v68, v97, v96, s33
    v_lshlrev_b16 v40, 3, v96
    v_lshlrev_b16 v38, 3, v95
    v_lshlrev_b16 v36, 3, v94
    v_cmpx_ge_u16 vcc, 0x3fff, v66
    ds_read_b64 v[36:37], v36
    s_mov_b64 exec, -1
    v_cmpx_ge_u16 vcc, 0x3fff, v67
    ds_read_b64 v[38:39], v38
    s_mov_b64 exec, -1
    v_cmpx_ge_u16 vcc, 0x3fff, v68
    ds_read_b64 v[40:41], v40
    s_mov_b64 exec, -1
    s_cmp_le_u32 s15, 7
    s_cbranch_scc1 p2_na1a7
    s_waitcnt lgkmcnt(15)
    v_ashrrev_i32 v122, 5, v69
    v_lshlrev_b16 v123, 2, v69
    v_cndmask_b32 v126, v42, v43, s[66:67]
    v_bitop3_b32 v122, v122, v113, v113 bitop3:0x0c
    v_lshlrev_b32 v124, 16, v126
    v_mul_f32 v122, v114, v122
    v_and_b32 v125, 0xffff0000, v126
    v_add_u32 v123, v123, v123
    v_mul_f32 v124, v122, v124
    v_mul_f32 v125, v122, v125
    v_cmpx_le_u32 vcc, 0x1000000, v69
    ds_add_f32 v123, v124 offset:54272
    ds_add_f32 v123, v125 offset:54276
    s_mov_b64 exec, -1
    v_ashrrev_i32 v122, 5, v70
    v_lshlrev_b16 v123, 2, v70
    v_cndmask_b32 v126, v44, v45, s[66:67]
    v_bitop3_b32 v122, v122, v113, v113 bitop3:0x0c
    v_lshlrev_b32 v124, 16, v126
    v_mul_f32 v122, v114, v122
    v_and_b32 v125, 0xffff0000, v126
    v_add_u32 v123, v123, v123
    v_mul_f32 v124, v122, v124
    v_mul_f32 v125, v122, v125
    v_cmpx_le_u32 vcc, 0x1000000, v70
    ds_add_f32 v123, v124 offset:54272
    ds_add_f32 v123, v125 offset:54276
    s_mov_b64 exec, -1
    v_ashrrev_i32 v122, 5, v71
    v_lshlrev_b16 v123, 2, v71
    v_cndmask_b32 v126, v46, v47, s[66:67]
    v_bitop3_b32 v122, v122, v113, v113 bitop3:0x0c
    v_lshlrev_b32 v124, 16, v126
    v_mul_f32 v122, v114, v122
    v_and_b32 v125, 0xffff0000, v126
    v_add_u32 v123, v123, v123
    v_mul_f32 v124, v122, v124
    v_mul_f32 v125, v122, v125
    v_cmpx_le_u32 vcc, 0x1000000, v71
    ds_add_f32 v123, v124 offset:54272
    ds_add_f32 v123, v125 offset:54276
    s_mov_b64 exec, -1
p2_na1a7:
    s_waitcnt vmcnt(11)
    v_perm_b32 v69, v101, v98, s31
    v_perm_b32 v70, v101, v99, s32
    v_perm_b32 v71, v101, v100, s33
    v_lshlrev_b16 v46, 3, v100
    v_lshlrev_b16 v44, 3, v99
    v_lshlrev_b16 v42, 3, v98
    s_cmp_le_u32 s16, 7
    s_cbranch_scc1 p2_g1r07
    v_cmpx_ge_u16 vcc, 0x3fff, v69
    ds_read_b64 v[42:43], v42
    s_mov_b64 exec, -1
    v_cmpx_ge_u16 vcc, 0x3fff, v70
    ds_read_b64 v[44:45], v44
    s_mov_b64 exec, -1
    v_cmpx_ge_u16 vcc, 0x3fff, v71
    ds_read_b64 v[46:47], v46
    s_mov_b64 exec, -1
p2_g1r07:
    s_waitcnt lgkmcnt(15)
    v_lshrrev_b32 v90, 3, v107
    v_lshrrev_b32 v91, 18, v107
    v_and_b32 v107, 0x3fff, v107
    v_and_or_b32 v90, v90, s65, v91
    v_mad_u32_u24 v107, v90, s63, v107
    buffer_load_dwordx4 v[90:93], v107, s[68:71], 0 offen
    s_waitcnt vmcnt(8)
    v_perm_b32 v48, v3, v0, s31
    v_perm_b32 v49, v3, v1, s32
    v_perm_b32 v50, v3, v2, s33
    v_lshlrev_b16 v4, 3, v2
    v_lshlrev_b16 v2, 3, v1
    v_lshlrev_b16 v0, 3, v0
    v_cmpx_ge_u16 vcc, 0x3fff, v48
    ds_read_b64 v[0:1], v0
    s_mov_b64 exec, -1
    v_cmpx_ge_u16 vcc, 0x3fff, v49
    ds_read_b64 v[2:3], v2
    s_mov_b64 exec, -1
    v_cmpx_ge_u16 vcc, 0x3fff, v50
    ds_read_b64 v[4:5], v4
    s_mov_b64 exec, -1
    s_waitcnt vmcnt(7)
    v_perm_b32 v51, v9, v6, s31
    v_perm_b32 v52, v9, v7, s32
    v_perm_b32 v53, v9, v8, s33
    v_lshlrev_b16 v10, 3, v8
    v_lshlrev_b16 v8, 3, v7
    v_lshlrev_b16 v6, 3, v6
    v_cmpx_ge_u16 vcc, 0x3fff, v51
    ds_read_b64 v[6:7], v6
    s_mov_b64 exec, -1
    v_cmpx_ge_u16 vcc, 0x3fff, v52
    ds_read_b64 v[8:9], v8
    s_mov_b64 exec, -1
    v_cmpx_ge_u16 vcc, 0x3fff, v53
    ds_read_b64 v[10:11], v10
    s_mov_b64 exec, -1
    s_waitcnt vmcnt(6)
    v_perm_b32 v54, v15, v12, s31
    v_perm_b32 v55, v15, v13, s32
    v_perm_b32 v56, v15, v14, s33
    v_lshlrev_b16 v16, 3, v14
    v_lshlrev_b16 v14, 3, v13
    v_lshlrev_b16 v12, 3, v12
    v_cmpx_ge_u16 vcc, 0x3fff, v54
    ds_read_b64 v[12:13], v12
    s_mov_b64 exec, -1
    v_cmpx_ge_u16 vcc, 0x3fff, v55
    ds_read_b64 v[14:15], v14
    s_mov_b64 exec, -1
    v_cmpx_ge_u16 vcc, 0x3fff, v56
    ds_read_b64 v[16:17], v16
    s_mov_b64 exec, -1
    s_waitcnt vmcnt(5)
    v_perm_b32 v57, v21, v18, s31
    v_perm_b32 v58, v21, v19, s32
    v_perm_b32 v59, v21, v20, s33
    v_lshlrev_b16 v22, 3, v20
    v_lshlrev_b16 v20, 3, v19
    v_lshlrev_b16 v18, 3, v18
    v_cmpx_ge_u16 vcc, 0x3fff, v57
    ds_read_b64 v[18:19], v18
    s_mov_b64 exec, -1
    v_cmpx_ge_u16 vcc, 0x3fff, v58
    ds_read_b64 v[20:21], v20
    s_mov_b64 exec, -1
    v_cmpx_ge_u16 vcc, 0x3fff, v59
    ds_read_b64 v[22:23], v22
    s_mov_b64 exec, -1
    s_waitcnt lgkmcnt(0)
    s_barrier
    s_waitcnt lgkmcnt(15)
    s_branch p2_tail
p2_drain1:
    v_cmpx_gt_i16 vcc, 0, v48
    ds_read_b64 v[0:1], v0
    s_mov_b64 exec, -1
    v_cmpx_gt_i16 vcc, 0, v49
    ds_read_b64 v[2:3], v2
    s_mov_b64 exec, -1
    v_cmpx_gt_i16 vcc, 0, v50
    ds_read_b64 v[4:5], v4
    s_mov_b64 exec, -1
    v_cmpx_gt_i16 vcc, 0, v51
    ds_read_b64 v[6:7], v6
    s_mov_b64 exec, -1
    v_cmpx_gt_i16 vcc, 0, v52
    ds_read_b64 v[8:9], v8
    s_mov_b64 exec, -1
    v_cmpx_gt_i16 vcc, 0, v53
    ds_read_b64 v[10:11], v10
    s_mov_b64 exec, -1
    v_cmpx_gt_i16 vcc, 0, v54
    ds_read_b64 v[12:13], v12
    s_mov_b64 exec, -1
    v_cmpx_gt_i16 vcc, 0, v55
    ds_read_b64 v[14:15], v14
    s_mov_b64 exec, -1
    v_cmpx_gt_i16 vcc, 0, v56
    ds_read_b64 v[16:17], v16
    s_mov_b64 exec, -1
    v_cmpx_gt_i16 vcc, 0, v57
    ds_read_b64 v[18:19], v18
    s_mov_b64 exec, -1
    v_cmpx_gt_i16 vcc, 0, v58
    ds_read_b64 v[20:21], v20
    s_mov_b64 exec, -1
    v_cmpx_gt_i16 vcc, 0, v59
    ds_read_b64 v[22:23], v22
    s_mov_b64 exec, -1
    v_cmpx_gt_i16 vcc, 0, v60
    ds_read_b64 v[24:25], v24
    s_mov_b64 exec, -1
    v_cmpx_gt_i16 vcc, 0, v61
    ds_read_b64 v[26:27], v26
    s_mov_b64 exec, -1
    v_cmpx_gt_i16 vcc, 0, v62
    ds_read_b64 v[28:29], v28
    s_mov_b64 exec, -1
    v_cmpx_gt_i16 vcc, 0, v63
    ds_read_b64 v[30:31], v30
    s_mov_b64 exec, -1
    v_cmpx_gt_i16 vcc, 0, v64
    ds_read_b64 v[32:33], v32
    s_mov_b64 exec, -1
    v_cmpx_gt_i16 vcc, 0, v65
    ds_read_b64 v[34:35], v34
    s_mov_b64 exec, -1
    v_cmpx_gt_i16 vcc, 0, v66
    ds_read_b64 v[36:37], v36
    s_mov_b64 exec, -1
    v_cmpx_gt_i16 vcc, 0, v67
    ds_read_b64 v[38:39], v38
    s_mov_b64 exec, -1
    v_cmpx_gt_i16 vcc, 0, v68
    ds_read_b64 v[40:41], v40
    s_mov_b64 exec, -1
    s_cmp_le_u32 s15, 7
    s_cbranch_scc1 p2_gd1
    v_cmpx_gt_i16 vcc, 0, v69
    ds_read_b64 v[42:43], v42
    s_mov_b64 exec, -1
    v_cmpx_gt_i16 vcc, 0, v70
    ds_read_b64 v[44:45], v44
    s_mov_b64 exec, -1
    v_cmpx_gt_i16 vcc, 0, v71
    ds_read_b64 v[46:47], v46
    s_mov_b64 exec, -1
p2_gd1:
    s_waitcnt lgkmcnt(15)
    v_ashrrev_i32 v122, 5, v48
    v_lshlrev_b16 v123, 2, v48
    v_cndmask_b32 v126, v0, v1, s[66:67]
    v_bitop3_b32 v122, v122, v113, v113 bitop3:0x0c
    v_lshlrev_b32 v124, 16, v126
    v_mul_f32 v122, v114, v122
    v_and_b32 v125, 0xffff0000, v126
    v_add_u32 v123, v123, v123
    v_mul_f32 v124, v122, v124
    v_mul_f32 v125, v122, v125
    v_cmpx_le_u32 vcc, 0x1000000, v48
    ds_add_f32 v123, v124 offset:54272
    ds_add_f32 v123, v125 offset:54276
    s_mov_b64 exec, -1
    v_ashrrev_i32 v122, 5, v49
    v_lshlrev_b16 v123, 2, v49
    v_cndmask_b32 v126, v2, v3, s[66:67]
    v_bitop3_b32 v122, v122, v113, v113 bitop3:0x0c
    v_lshlrev_b32 v124, 16, v126
    v_mul_f32 v122, v114, v122
    v_and_b32 v125, 0xffff0000, v126
    v_add_u32 v123, v123, v123
    v_mul_f32 v124, v122, v124
    v_mul_f32 v125, v122, v125
    v_cmpx_le_u32 vcc, 0x1000000, v49
    ds_add_f32 v123, v124 offset:54272
    ds_add_f32 v123, v125 offset:54276
    s_mov_b64 exec, -1
    v_ashrrev_i32 v122, 5, v50
    v_lshlrev_b16 v123, 2, v50
    v_cndmask_b32 v126, v4, v5, s[66:67]
    v_bitop3_b32 v122, v122, v113, v113 bitop3:0x0c
    v_lshlrev_b32 v124, 16, v126
    v_mul_f32 v122, v114, v122
    v_and_b32 v125, 0xffff0000, v126
    v_add_u32 v123, v123, v123
    v_mul_f32 v124, v122, v124
    v_mul_f32 v125, v122, v125
    v_cmpx_le_u32 vcc, 0x1000000, v50
    ds_add_f32 v123, v124 offset:54272
    ds_add_f32 v123, v125 offset:54276
    s_mov_b64 exec, -1
    s_waitcnt lgkmcnt(15)
    v_ashrrev_i32 v122, 5, v51
    v_lshlrev_b16 v123, 2, v51
    v_cndmask_b32 v126, v6, v7, s[66:67]
    v_bitop3_b32 v122, v122, v113, v113 bitop3:0x0c
    v_lshlrev_b32 v124, 16, v126
    v_mul_f32 v122, v114, v122
    v_and_b32 v125, 0xffff0000, v126
    v_add_u32 v123, v123, v123
    v_mul_f32 v124, v122, v124
    v_mul_f32 v125, v122, v125
    v_cmpx_le_u32 vcc, 0x1000000, v51
    ds_add_f32 v123, v124 offset:54272
    ds_add_f32 v123, v125 offset:54276
    s_mov_b64 exec, -1
    v_ashrrev_i32 v122, 5, v52
    v_lshlrev_b16 v123, 2, v52
    v_cndmask_b32 v126, v8, v9, s[66:67]
    v_bitop3_b32 v122, v122, v113, v113 bitop3:0x0c
    v_lshlrev_b32 v124, 16, v126
    v_mul_f32 v122, v114, v122
    v_and_b32 v125, 0xffff0000, v126
    v_add_u32 v123, v123, v123
    v_mul_f32 v124, v122, v124
    v_mul_f32 v125, v122, v125
    v_cmpx_le_u32 vcc, 0x1000000, v52
    ds_add_f32 v123, v124 offset:54272
    ds_add_f32 v123, v125 offset:54276
    s_mov_b64 exec, -1
    v_ashrrev_i32 v122, 5, v53
    v_lshlrev_b16 v123, 2, v53
    v_cndmask_b32 v126, v10, v11, s[66:67]
    v_bitop3_b32 v122, v122, v113, v113 bitop3:0x0c
    v_lshlrev_b32 v124, 16, v126
    v_mul_f32 v122, v114, v122
    v_and_b32 v125, 0xffff0000, v126
    v_add_u32 v123, v123, v123
    v_mul_f32 v124, v122, v124
    v_mul_f32 v125, v122, v125
    v_cmpx_le_u32 vcc, 0x1000000, v53
    ds_add_f32 v123, v124 offset:54272
    ds_add_f32 v123, v125 offset:54276
    s_mov_b64 exec, -1
    s_waitcnt lgkmcnt(15)
    v_ashrrev_i32 v122, 5, v54
    v_lshlrev_b16 v123, 2, v54
    v_cndmask_b32 v126, v12, v13, s[66:67]
    v_bitop3_b32 v122, v122, v113, v113 bitop3:0x0c
    v_lshlrev_b32 v124, 16, v126
    v_mul_f32 v122, v114, v122
    v_and_b32 v125, 0xffff0000, v126
    v_add_u32 v123, v123, v123
    v_mul_f32 v124, v122, v124
    v_mul_f32 v125, v122, v125
    v_cmpx_le_u32 vcc, 0x1000000, v54
    ds_add_f32 v123, v124 offset:54272
    ds_add_f32 v123, v125 offset:54276
    s_mov_b64 exec, -1
    v_ashrrev_i32 v122, 5, v55
    v_lshlrev_b16 v123, 2, v55
    v_cndmask_b32 v126, v14, v15, s[66:67]
    v_bitop3_b32 v122, v122, v113, v113 bitop3:0x0c
    v_lshlrev_b32 v124, 16, v126
    v_mul_f32 v122, v114, v122
    v_and_b32 v125, 0xffff0000, v126
    v_add_u32 v123, v123, v123
    v_mul_f32 v124, v122, v124
    v_mul_f32 v125, v122, v125
    v_cmpx_le_u32 vcc, 0x1000000, v55
    ds_add_f32 v123, v124 offset:54272
    ds_add_f32 v123, v125 offset:54276
    s_mov_b64 exec, -1
    v_ashrrev_i32 v122, 5, v56
    v_lshlrev_b16 v123, 2, v56
    v_cndmask_b32 v126, v16, v17, s[66:67]
    v_bitop3_b32 v122, v122, v113, v113 bitop3:0x0c
    v_lshlrev_b32 v124, 16, v126
    v_mul_f32 v122, v114, v122
    v_and_b32 v125, 0xffff0000, v126
    v_add_u32 v123, v123, v123
    v_mul_f32 v124, v122, v124
    v_mul_f32 v125, v122, v125
    v_cmpx_le_u32 vcc, 0x1000000, v56
    ds_add_f32 v123, v124 offset:54272
    ds_add_f32 v123, v125 offset:54276
    s_mov_b64 exec, -1
    s_waitcnt lgkmcnt(15)
    v_ashrrev_i32 v122, 5, v57
    v_lshlrev_b16 v123, 2, v57
    v_cndmask_b32 v126, v18, v19, s[66:67]
    v_bitop3_b32 v122, v122, v113, v113 bitop3:0x0c
    v_lshlrev_b32 v124, 16, v126
    v_mul_f32 v122, v114, v122
    v_and_b32 v125, 0xffff0000, v126
    v_add_u32 v123, v123, v123
    v_mul_f32 v124, v122, v124
    v_mul_f32 v125, v122, v125
    v_cmpx_le_u32 vcc, 0x1000000, v57
    ds_add_f32 v123, v124 offset:54272
    ds_add_f32 v123, v125 offset:54276
    s_mov_b64 exec, -1
    v_ashrrev_i32 v122, 5, v58
    v_lshlrev_b16 v123, 2, v58
    v_cndmask_b32 v126, v20, v21, s[66:67]
    v_bitop3_b32 v122, v122, v113, v113 bitop3:0x0c
    v_lshlrev_b32 v124, 16, v126
    v_mul_f32 v122, v114, v122
    v_and_b32 v125, 0xffff0000, v126
    v_add_u32 v123, v123, v123
    v_mul_f32 v124, v122, v124
    v_mul_f32 v125, v122, v125
    v_cmpx_le_u32 vcc, 0x1000000, v58
    ds_add_f32 v123, v124 offset:54272
    ds_add_f32 v123, v125 offset:54276
    s_mov_b64 exec, -1
    v_ashrrev_i32 v122, 5, v59
    v_lshlrev_b16 v123, 2, v59
    v_cndmask_b32 v126, v22, v23, s[66:67]
    v_bitop3_b32 v122, v122, v113, v113 bitop3:0x0c
    v_lshlrev_b32 v124, 16, v126
    v_mul_f32 v122, v114, v122
    v_and_b32 v125, 0xffff0000, v126
    v_add_u32 v123, v123, v123
    v_mul_f32 v124, v122, v124
    v_mul_f32 v125, v122, v125
    v_cmpx_le_u32 vcc, 0x1000000, v59
    ds_add_f32 v123, v124 offset:54272
    ds_add_f32 v123, v125 offset:54276
    s_mov_b64 exec, -1
    s_waitcnt lgkmcnt(15)
    v_ashrrev_i32 v122, 5, v60
    v_lshlrev_b16 v123, 2, v60
    v_cndmask_b32 v126, v24, v25, s[66:67]
    v_bitop3_b32 v122, v122, v113, v113 bitop3:0x0c
    v_lshlrev_b32 v124, 16, v126
    v_mul_f32 v122, v114, v122
    v_and_b32 v125, 0xffff0000, v126
    v_add_u32 v123, v123, v123
    v_mul_f32 v124, v122, v124
    v_mul_f32 v125, v122, v125
    v_cmpx_le_u32 vcc, 0x1000000, v60
    ds_add_f32 v123, v124 offset:54272
    ds_add_f32 v123, v125 offset:54276
    s_mov_b64 exec, -1
    v_ashrrev_i32 v122, 5, v61
    v_lshlrev_b16 v123, 2, v61
    v_cndmask_b32 v126, v26, v27, s[66:67]
    v_bitop3_b32 v122, v122, v113, v113 bitop3:0x0c
    v_lshlrev_b32 v124, 16, v126
    v_mul_f32 v122, v114, v122
    v_and_b32 v125, 0xffff0000, v126
    v_add_u32 v123, v123, v123
    v_mul_f32 v124, v122, v124
    v_mul_f32 v125, v122, v125
    v_cmpx_le_u32 vcc, 0x1000000, v61
    ds_add_f32 v123, v124 offset:54272
    ds_add_f32 v123, v125 offset:54276
    s_mov_b64 exec, -1
    v_ashrrev_i32 v122, 5, v62
    v_lshlrev_b16 v123, 2, v62
    v_cndmask_b32 v126, v28, v29, s[66:67]
    v_bitop3_b32 v122, v122, v113, v113 bitop3:0x0c
    v_lshlrev_b32 v124, 16, v126
    v_mul_f32 v122, v114, v122
    v_and_b32 v125, 0xffff0000, v126
    v_add_u32 v123, v123, v123
    v_mul_f32 v124, v122, v124
    v_mul_f32 v125, v122, v125
    v_cmpx_le_u32 vcc, 0x1000000, v62
    ds_add_f32 v123, v124 offset:54272
    ds_add_f32 v123, v125 offset:54276
    s_mov_b64 exec, -1
    s_waitcnt lgkmcnt(15)
    v_ashrrev_i32 v122, 5, v63
    v_lshlrev_b16 v123, 2, v63
    v_cndmask_b32 v126, v30, v31, s[66:67]
    v_bitop3_b32 v122, v122, v113, v113 bitop3:0x0c
    v_lshlrev_b32 v124, 16, v126
    v_mul_f32 v122, v114, v122
    v_and_b32 v125, 0xffff0000, v126
    v_add_u32 v123, v123, v123
    v_mul_f32 v124, v122, v124
    v_mul_f32 v125, v122, v125
    v_cmpx_le_u32 vcc, 0x1000000, v63
    ds_add_f32 v123, v124 offset:54272
    ds_add_f32 v123, v125 offset:54276
    s_mov_b64 exec, -1
    v_ashrrev_i32 v122, 5, v64
    v_lshlrev_b16 v123, 2, v64
    v_cndmask_b32 v126, v32, v33, s[66:67]
    v_bitop3_b32 v122, v122, v113, v113 bitop3:0x0c
    v_lshlrev_b32 v124, 16, v126
    v_mul_f32 v122, v114, v122
    v_and_b32 v125, 0xffff0000, v126
    v_add_u32 v123, v123, v123
    v_mul_f32 v124, v122, v124
    v_mul_f32 v125, v122, v125
    v_cmpx_le_u32 vcc, 0x1000000, v64
    ds_add_f32 v123, v124 offset:54272
    ds_add_f32 v123, v125 offset:54276
    s_mov_b64 exec, -1
    v_ashrrev_i32 v122, 5, v65
    v_lshlrev_b16 v123, 2, v65
    v_cndmask_b32 v126, v34, v35, s[66:67]
    v_bitop3_b32 v122, v122, v113, v113 bitop3:0x0c
    v_lshlrev_b32 v124, 16, v126
    v_mul_f32 v122, v114, v122
    v_and_b32 v125, 0xffff0000, v126
    v_add_u32 v123, v123, v123
    v_mul_f32 v124, v122, v124
    v_mul_f32 v125, v122, v125
    v_cmpx_le_u32 vcc, 0x1000000, v65
    ds_add_f32 v123, v124 offset:54272
    ds_add_f32 v123, v125 offset:54276
    s_mov_b64 exec, -1
    s_waitcnt lgkmcnt(15)
    v_ashrrev_i32 v122, 5, v66
    v_lshlrev_b16 v123, 2, v66
    v_cndmask_b32 v126, v36, v37, s[66:67]
    v_bitop3_b32 v122, v122, v113, v113 bitop3:0x0c
    v_lshlrev_b32 v124, 16, v126
    v_mul_f32 v122, v114, v122
    v_and_b32 v125, 0xffff0000, v126
    v_add_u32 v123, v123, v123
    v_mul_f32 v124, v122, v124
    v_mul_f32 v125, v122, v125
    v_cmpx_le_u32 vcc, 0x1000000, v66
    ds_add_f32 v123, v124 offset:54272
    ds_add_f32 v123, v125 offset:54276
    s_mov_b64 exec, -1
    v_ashrrev_i32 v122, 5, v67
    v_lshlrev_b16 v123, 2, v67
    v_cndmask_b32 v126, v38, v39, s[66:67]
    v_bitop3_b32 v122, v122, v113, v113 bitop3:0x0c
    v_lshlrev_b32 v124, 16, v126
    v_mul_f32 v122, v114, v122
    v_and_b32 v125, 0xffff0000, v126
    v_add_u32 v123, v123, v123
    v_mul_f32 v124, v122, v124
    v_mul_f32 v125, v122, v125
    v_cmpx_le_u32 vcc, 0x1000000, v67
    ds_add_f32 v123, v124 offset:54272
    ds_add_f32 v123, v125 offset:54276
    s_mov_b64 exec, -1
    v_ashrrev_i32 v122, 5, v68
    v_lshlrev_b16 v123, 2, v68
    v_cndmask_b32 v126, v40, v41, s[66:67]
    v_bitop3_b32 v122, v122, v113, v113 bitop3:0x0c
    v_lshlrev_b32 v124, 16, v126
    v_mul_f32 v122, v114, v122
    v_and_b32 v125, 0xffff0000, v126
    v_add_u32 v123, v123, v123
    v_mul_f32 v124, v122, v124
    v_mul_f32 v125, v122, v125
    v_cmpx_le_u32 vcc, 0x1000000, v68
    ds_add_f32 v123, v124 offset:54272
    ds_add_f32 v123, v125 offset:54276
    s_mov_b64 exec, -1
    s_cmp_le_u32 s15, 7
    s_cbranch_scc1 p2_nad1
    s_waitcnt lgkmcnt(15)
    v_ashrrev_i32 v122, 5, v69
    v_lshlrev_b16 v123, 2, v69
    v_cndmask_b32 v126, v42, v43, s[66:67]
    v_bitop3_b32 v122, v122, v113, v113 bitop3:0x0c
    v_lshlrev_b32 v124, 16, v126
    v_mul_f32 v122, v114, v122
    v_and_b32 v125, 0xffff0000, v126
    v_add_u32 v123, v123, v123
    v_mul_f32 v124, v122, v124
    v_mul_f32 v125, v122, v125
    v_cmpx_le_u32 vcc, 0x1000000, v69
    ds_add_f32 v123, v124 offset:54272
    ds_add_f32 v123, v125 offset:54276
    s_mov_b64 exec, -1
    v_ashrrev_i32 v122, 5, v70
    v_lshlrev_b16 v123, 2, v70
    v_cndmask_b32 v126, v44, v45, s[66:67]
    v_bitop3_b32 v122, v122, v113, v113 bitop3:0x0c
    v_lshlrev_b32 v124, 16, v126
    v_mul_f32 v122, v114, v122
    v_and_b32 v125, 0xffff0000, v126
    v_add_u32 v123, v123, v123
    v_mul_f32 v124, v122, v124
    v_mul_f32 v125, v122, v125
    v_cmpx_le_u32 vcc, 0x1000000, v70
    ds_add_f32 v123, v124 offset:54272
    ds_add_f32 v123, v125 offset:54276
    s_mov_b64 exec, -1
    v_ashrrev_i32 v122, 5, v71
    v_lshlrev_b16 v123, 2, v71
    v_cndmask_b32 v126, v46, v47, s[66:67]
    v_bitop3_b32 v122, v122, v113, v113 bitop3:0x0c
    v_lshlrev_b32 v124, 16, v126
    v_mul_f32 v122, v114, v122
    v_and_b32 v125, 0xffff0000, v126
    v_add_u32 v123, v123, v123
    v_mul_f32 v124, v122, v124
    v_mul_f32 v125, v122, v125
    v_cmpx_le_u32 vcc, 0x1000000, v71
    ds_add_f32 v123, v124 offset:54272
    ds_add_f32 v123, v125 offset:54276
    s_mov_b64 exec, -1
p2_nad1:
    s_branch p2_fin
p2_tail:
    s_mov_b32 s60, s61
    s_mov_b32 s15, s16
    s_mov_b32 s16, s17
    v_mov_b32 v122, s19
    s_xor_b32 s19, s19, 4
    ds_read_b32 v125, v122 offset:53760
    v_mov_b32 v123, s19
    v_mov_b32 v124, 0
    ds_write_b32 v123, v124 offset:53760
    s_waitcnt vmcnt(2)
    s_mov_b32 m0, s24
    s_cmp_ge_u32 s10, 9
    s_cbranch_scc1 p2_st2s1
    ds_write_addtid_b32 v84 offset:49152
    ds_write_addtid_b32 v85 offset:49408
p2_st2s1:
    s_mov_b32 m0, s23
    s_add_u32 s20, s20, 53760
    ds_write_addtid_b32 v72 offset:0
    ds_write_addtid_b32 v73 offset:256
    ds_write_addtid_b32 v74 offset:512
    ds_write_addtid_b32 v75 offset:768
    ds_write_addtid_b32 v76 offset:1024
    ds_write_addtid_b32 v77 offset:1280
    ds_write_addtid_b32 v78 offset:1536
    ds_write_addtid_b32 v79 offset:1792
    ds_write_addtid_b32 v80 offset:2048
    ds_write_addtid_b32 v81 offset:2304
    ds_write_addtid_b32 v82 offset:2560
    ds_write_addtid_b32 v83 offset:2816
    s_waitcnt lgkmcnt(0)
    s_barrier
    s_waitcnt lgkmcnt(13)
    v_readfirstlane_b32 s44, v125
    s_nop 0
    s_cmp_lg_u32 s44, 0
    s_cbranch_scc1 p2_advb
    s_add_u32 s61, s61, 1
    s_min_u32 s61, s61, 10
    v_mov_b32 v110, 0
    v_mov_b32 v111, 0
    s_cmp_eq_u32 s61, 10
    s_cbranch_scc1 p2_advb
    s_mul_i32 s44, s61, 4160
    s_add_u32 s44, s44, s40
    v_lshrrev_b32 v110, 6, v112
    v_bfe_u32 v111, v112, 2, 4
    v_mul_u32_u24 v110, 41600, v110
    v_add_u32 v111, v110, v111
    buffer_load_dword v110, v111, s[4:7], s44 offen
    buffer_load_dword v111, v111, s[4:7], s44 offen offset:16
p2_advb:
    s_cmp_lg_u32 s10, 0
    s_cbranch_scc1 p2_ntg
    s_lshr_b32 s44, s2, 3
    s_mul_i32 s44, s44, 5120
    s_mul_i32 s45, s60, 645120
    s_add_u32 s44, s44, s45
    s_add_u32 s44, s44, s62
    v_lshlrev_b32 v127, 3, v112
    s_mov_b32 exec_hi, 0xff
    buffer_load_dword v127, v127, s[4:7], s44 offen
    s_mov_b64 exec, -1
p2_ntg:
    s_cmp_ge_u32 s10, 9
    s_cbranch_scc1 p2_nm2m2a
    v_lshrrev_b32 v84, 1, v112
    s_add_u32 s44, s20, s42
    buffer_load_dwordx2 v[84:85], v84, s[4:7], s44 offen
p2_nm2m2a:
    buffer_load_dwordx4 v[72:75], v112, s[4:7], s20 offen offset:0
    buffer_load_dwordx4 v[76:79], v112, s[4:7], s20 offen offset:1024
    buffer_load_dwordx4 v[80:83], v112, s[4:7], s20 offen offset:2048
    v_cmpx_lt_i16 vcc, 0x3fff, v48
    ds_read_b64 v[0:1], v0
    s_mov_b64 exec, -1
    v_cmpx_lt_i16 vcc, 0x3fff, v49
    ds_read_b64 v[2:3], v2
    s_mov_b64 exec, -1
    v_cmpx_lt_i16 vcc, 0x3fff, v50
    ds_read_b64 v[4:5], v4
    s_mov_b64 exec, -1
    v_cmpx_lt_i16 vcc, 0x3fff, v51
    ds_read_b64 v[6:7], v6
    s_mov_b64 exec, -1
    v_cmpx_lt_i16 vcc, 0x3fff, v52
    ds_read_b64 v[8:9], v8
    s_mov_b64 exec, -1
    v_cmpx_lt_i16 vcc, 0x3fff, v53
    ds_read_b64 v[10:11], v10
    s_mov_b64 exec, -1
    v_cmpx_lt_i16 vcc, 0x3fff, v54
    ds_read_b64 v[12:13], v12
    s_mov_b64 exec, -1
    v_cmpx_lt_i16 vcc, 0x3fff, v55
    ds_read_b64 v[14:15], v14
    s_mov_b64 exec, -1
    v_cmpx_lt_i16 vcc, 0x3fff, v56
    ds_read_b64 v[16:17], v16
    s_mov_b64 exec, -1
    v_cmpx_lt_i16 vcc, 0x3fff, v57
    ds_read_b64 v[18:19], v18
    s_mov_b64 exec, -1
    v_cmpx_lt_i16 vcc, 0x3fff, v58
    ds_read_b64 v[20:21], v20
    s_mov_b64 exec, -1
    v_cmpx_lt_i16 vcc, 0x3fff, v59
    ds_read_b64 v[22:23], v22
    s_mov_b64 exec, -1
    v_lshrrev_b32 v94, 3, v108
    v_lshrrev_b32 v95, 18, v108
    v_and_b32 v108, 0x3fff, v108
    v_and_or_b32 v94, v94, s65, v95
    v_mad_u32_u24 v108, v94, s63, v108
    buffer_load_dwordx4 v[94:97], v108, s[68:71], 0 offen
    v_cmpx_lt_i16 vcc, 0x3fff, v60
    ds_read_b64 v[24:25], v24
    s_mov_b64 exec, -1
    v_cmpx_lt_i16 vcc, 0x3fff, v61
    ds_read_b64 v[26:27], v26
    s_mov_b64 exec, -1
    v_cmpx_lt_i16 vcc, 0x3fff, v62
    ds_read_b64 v[28:29], v28
    s_mov_b64 exec, -1
    v_cmpx_lt_i16 vcc, 0x3fff, v63
    ds_read_b64 v[30:31], v30
    s_mov_b64 exec, -1
    v_cmpx_lt_i16 vcc, 0x3fff, v64
    ds_read_b64 v[32:33], v32
    s_mov_b64 exec, -1
    v_cmpx_lt_i16 vcc, 0x3fff, v65
    ds_read_b64 v[34:35], v34
    s_mov_b64 exec, -1
    v_cmpx_lt_i16 vcc, 0x3fff, v66
    ds_read_b64 v[36:37], v36
    s_mov_b64 exec, -1
    v_cmpx_lt_i16 vcc, 0x3fff, v67
    ds_read_b64 v[38:39], v38
    s_mov_b64 exec, -1
    v_cmpx_lt_i16 vcc, 0x3fff, v68
    ds_read_b64 v[40:41], v40
    s_mov_b64 exec, -1
    s_cmp_le_u32 s15, 7
    s_cbranch_scc1 p2_g2r17
    v_cmpx_lt_i16 vcc, 0x3fff, v69
    ds_read_b64 v[42:43], v42
    s_mov_b64 exec, -1
    v_cmpx_lt_i16 vcc, 0x3fff, v70
    ds_read_b64 v[44:45], v44
    s_mov_b64 exec, -1
    v_cmpx_lt_i16 vcc, 0x3fff, v71
    ds_read_b64 v[46:47], v46
    s_mov_b64 exec, -1
p2_g2r17:
    v_lshrrev_b32 v98, 3, v109
    v_lshrrev_b32 v99, 18, v109
    v_and_b32 v109, 0x3fff, v109
    v_and_or_b32 v98, v98, s65, v99
    v_mad_u32_u24 v109, v98, s63, v109
    buffer_load_dwordx4 v[98:101], v109, s[68:71], 0 offen
    s_waitcnt lgkmcnt(0)
    s_barrier
    s_waitcnt vmcnt(2)
    s_mov_b32 m0, s24
    s_cmp_ge_u32 s10, 9
    s_cbranch_scc1 p2_st2s2
    ds_write_addtid_b32 v84 offset:49152
    ds_write_addtid_b32 v85 offset:49408
p2_st2s2:
    s_mov_b32 m0, s23
    s_mul_i32 s20, s60, 645120
    s_add_u32 s20, s20, s62
    ds_write_addtid_b32 v72 offset:0
    ds_write_addtid_b32 v73 offset:256
    ds_write_addtid_b32 v74 offset:512
    ds_write_addtid_b32 v75 offset:768
    ds_write_addtid_b32 v76 offset:1024
    ds_write_addtid_b32 v77 offset:1280
    ds_write_addtid_b32 v78 offset:1536
    ds_write_addtid_b32 v79 offset:1792
    ds_write_addtid_b32 v80 offset:2048
    ds_write_addtid_b32 v81 offset:2304
    ds_write_addtid_b32 v82 offset:2560
    ds_write_addtid_b32 v83 offset:2816
    s_waitcnt lgkmcnt(0)
    s_barrier
    s_branch p2_top
p2_fin:
    s_waitcnt vmcnt(0) lgkmcnt(0)
    s_barrier
    s_mov_b32 s48, s11
    s_mul_i32 s44, s48, 800768
    s_mul_i32 s45, s12, 12512
    s_add_u32 s49, s44, s45
    s_lshl_b32 s44, s49, 3
    s_add_u32 s44, s44, 363410432
    s_lshl_b32 s48, s48, 2
    s_lshl_b32 s45, s12, 4
    s_add_u32 s48, s48, s45
    s_add_u32 s48, s48, 363409408
    v_add_u32 v123, s64, v112
    v_add_u32 v122, s25, v123
    v_mov_b32 v24, 0
    v_mov_b32 v25, 0
    v_mov_b32 v26, 0
    v_mov_b32 v27, 0
    v_cmp_gt_u32 vcc, 1792, v123
    v_mov_b32 v124, 0x38000000
    v_mov_b32 v126, 0
    v_cndmask_b32 v124, v124, v123, vcc
    ds_read_b128 v[0:3], v122 offset:0
    ds_read_b128 v[4:7], v122 offset:16384
    ds_read_b128 v[8:11], v122 offset:32768
    v_add_u32 v122, 49152, v122
    ds_read_b128 v[12:15], v122 offset:0
    ds_read_b128 v[16:19], v122 offset:16384
    ds_read_b128 v[20:23], v122 offset:32768
    s_mov_b64 exec, vcc
    ds_read_b128 v[24:27], v122 offset:49152
    s_mov_b64 exec, -1
    s_cmp_lg_u32 s21, 0
    s_cbranch_scc1 p2_finf
    s_waitcnt lgkmcnt(6)
    buffer_store_dwordx4 v[0:3], v123, s[4:7], s44 offen
    s_add_u32 s44, s44, 16384
    s_waitcnt lgkmcnt(5)
    buffer_store_dwordx4 v[4:7], v123, s[4:7], s44 offen
    s_add_u32 s44, s44, 16384
    s_waitcnt lgkmcnt(4)
    buffer_store_dwordx4 v[8:11], v123, s[4:7], s44 offen
    s_add_u32 s44, s44, 16384
    s_waitcnt lgkmcnt(3)
    buffer_store_dwordx4 v[12:15], v123, s[4:7], s44 offen
    s_add_u32 s44, s44, 16384
    s_waitcnt lgkmcnt(2)
    buffer_store_dwordx4 v[16:19], v123, s[4:7], s44 offen
    s_add_u32 s44, s44, 16384
    s_waitcnt lgkmcnt(1)
    buffer_store_dwordx4 v[20:23], v123, s[4:7], s44 offen
    s_add_u32 s44, s44, 16384
    s_waitcnt lgkmcnt(0)
    buffer_store_dwordx4 v[24:27], v124, s[4:7], s44 offen
    s_add_u32 s44, s44, 16384
    v_bitop3_b32 v115, v115, v0, v1 bitop3:0xfe
    v_bitop3_b32 v115, v115, v2, v3 bitop3:0xfe
    v_bitop3_b32 v115, v115, v4, v5 bitop3:0xfe
    v_bitop3_b32 v115, v115, v6, v7 bitop3:0xfe
    v_bitop3_b32 v115, v115, v8, v9 bitop3:0xfe
    v_bitop3_b32 v115, v115, v10, v11 bitop3:0xfe
    v_bitop3_b32 v115, v115, v12, v13 bitop3:0xfe
    v_bitop3_b32 v115, v115, v14, v15 bitop3:0xfe
    v_bitop3_b32 v115, v115, v16, v17 bitop3:0xfe
    v_bitop3_b32 v115, v115, v18, v19 bitop3:0xfe
    v_bitop3_b32 v115, v115, v20, v21 bitop3:0xfe
    v_bitop3_b32 v115, v115, v22, v23 bitop3:0xfe
    v_bitop3_b32 v115, v115, v24, v25 bitop3:0xfe
    v_bitop3_b32 v115, v115, v26, v27 bitop3:0xfe
    v_bitop3_b32 v115, v115, v116, v117 bitop3:0xfe
    v_bitop3_b32 v115, v115, v118, v119 bitop3:0xfe
    v_bitop3_b32 v115, v115, v120, v121 bitop3:0xfe
    v_and_b32 v115, 0x80008000, v115
    v_cmpx_ne_u32 vcc, 0, v115
    ds_write_b32 v126, v115 offset:53768
    s_mov_b64 exec, -1
    s_waitcnt lgkmcnt(0)
    s_barrier
    ds_read_b32 v125, v126 offset:53768
    s_waitcnt lgkmcnt(0)
    v_readfirstlane_b32 s45, v125
    s_nop 0
    s_cmp_eq_u32 s45, 0
    s_cbranch_scc1 p2_done
    s_mov_b32 s21, 1
    s_waitcnt vmcnt(0)
    s_branch p2_restart
p2_finf:
    s_lshl_b32 s49, s49, 4
    s_lshl_b32 s45, s21, 3
    s_add_u32 s49, s49, s45
    s_add_u32 s49, s49, 389035000
    v_mov_b32 v28, 1073758208
    v_mov_b32 v29, 1073758208
    v_mov_b32 v30, 1073758208
    v_mov_b32 v31, 1073758208
    v_lshlrev_b32 v122, 1, v123
    v_lshlrev_b32 v125, 1, v124
    s_waitcnt lgkmcnt(0)
    buffer_store_dwordx4 v[28:31], v123, s[4:7], s44 offen
    s_add_u32 s44, s44, 16384
    buffer_store_dwordx2 v[0:1], v122, s[4:7], s49 offen offset:0
    buffer_store_dwordx2 v[2:3], v122, s[4:7], s49 offen offset:16
    s_add_u32 s49, s49, 32768
    buffer_store_dwordx4 v[28:31], v123, s[4:7], s44 offen
    s_add_u32 s44, s44, 16384
    buffer_store_dwordx2 v[4:5], v122, s[4:7], s49 offen offset:0
    buffer_store_dwordx2 v[6:7], v122, s[4:7], s49 offen offset:16
    s_add_u32 s49, s49, 32768
    buffer_store_dwordx4 v[28:31], v123, s[4:7], s44 offen
    s_add_u32 s44, s44, 16384
    buffer_store_dwordx2 v[8:9], v122, s[4:7], s49 offen offset:0
    buffer_store_dwordx2 v[10:11], v122, s[4:7], s49 offen offset:16
    s_add_u32 s49, s49, 32768
    buffer_store_dwordx4 v[28:31], v123, s[4:7], s44 offen
    s_add_u32 s44, s44, 16384
    buffer_store_dwordx2 v[12:13], v122, s[4:7], s49 offen offset:0
    buffer_store_dwordx2 v[14:15], v122, s[4:7], s49 offen offset:16
    s_add_u32 s49, s49, 32768
    buffer_store_dwordx4 v[28:31], v123, s[4:7], s44 offen
    s_add_u32 s44, s44, 16384
    buffer_store_dwordx2 v[16:17], v122, s[4:7], s49 offen offset:0
    buffer_store_dwordx2 v[18:19], v122, s[4:7], s49 offen offset:16
    s_add_u32 s49, s49, 32768
    buffer_store_dwordx4 v[28:31], v123, s[4:7], s44 offen
    s_add_u32 s44, s44, 16384
    buffer_store_dwordx2 v[20:21], v122, s[4:7], s49 offen offset:0
    buffer_store_dwordx2 v[22:23], v122, s[4:7], s49 offen offset:16
    s_add_u32 s49, s49, 32768
    buffer_store_dwordx4 v[28:31], v124, s[4:7], s44 offen
    s_add_u32 s44, s44, 16384
    buffer_store_dwordx2 v[24:25], v125, s[4:7], s49 offen offset:0
    buffer_store_dwordx2 v[26:27], v125, s[4:7], s49 offen offset:16
    s_add_u32 s49, s49, 32768
    s_add_u32 s21, s21, 1
    s_mov_b32 s30, 0
    s_waitcnt vmcnt(0)
    s_cmp_eq_u32 s21, 2
    s_cbranch_scc1 p2_restart
p2_done:
    v_mov_b32 v125, s30
    buffer_store_dword v125, v126, s[4:7], s48 offen
p2_end:
    s_endpgm
.globl p3_kernel
.p2align 8
.type p3_kernel,@function
p3_kernel:
    s_cmp_ge_u32 s2, 1563
    s_cbranch_scc1 p3_end
    s_load_dwordx2 s[4:5], s[0:1], 0
    s_load_dwordx2 s[6:7], s[0:1], 24
    s_load_dwordx2 s[8:9], s[0:1], 40
    s_load_dwordx8 s[12:19], s[0:1], 56
    s_load_dwordx2 s[10:11], s[0:1], 88
    s_load_dwordx2 s[20:21], s[0:1], 104
    s_lshl_b32 s3, s2, 8
    v_add_u32 v0, s3, v0
    v_lshlrev_b32 v2, 4, v0
    v_lshlrev_b32 v3, 2, v0
    v_add_u32 v0, v0, v0
    v_mul_hi_u32_u24 v1, 343268, v0
    v_lshlrev_b16 v1, 4, v1
    s_waitcnt lgkmcnt(0)
    s_load_dwordx4 s[32:35], s[8:9], 0
    s_load_dwordx16 s[36:51], s[12:13], 0
    s_load_dwordx16 s[52:67], s[14:15], 0
    s_load_dwordx8 s[68:75], s[16:17], 0
    s_load_dwordx8 s[76:83], s[18:19], 0
    s_mov_b32 s24, s6
    s_and_b32 s25, s7, 0xffff
    s_mov_b32 s26, 1600000
    s_mov_b32 s27, 0x20000
    buffer_load_dword v4, v3, s[24:27], 0 offen
    s_mov_b32 s28, s20
    s_and_b32 s29, s21, 0xffff
    s_mov_b32 s30, 819200000
    s_mov_b32 s31, 0x20000
    s_mov_b32 s22, 363410432
    buffer_load_dwordx4 v[40:43], v2, s[28:31], s22 offen
    s_mov_b32 s22, 369816576
    buffer_load_dwordx4 v[44:47], v2, s[28:31], s22 offen
    s_mov_b32 s22, 376222720
    buffer_load_dwordx4 v[48:51], v2, s[28:31], s22 offen
    s_mov_b32 s22, 382628864
    buffer_load_dwordx4 v[52:55], v2, s[28:31], s22 offen
    s_mov_b32 s22, 363409408
    buffer_load_dwordx4 v[56:59], v1, s[28:31], s22 offen
    s_mov_b32 s24, s4
    s_and_b32 s25, s5, 0xffff
    s_mov_b32 s26, 6400000
    s_mov_b32 s27, 0x20000
    buffer_load_dwordx4 v[60:63], v2, s[24:27], 0 offen
    s_mov_b32 s24, s10
    s_and_b32 s25, s11, 0xffff
    s_mov_b32 s26, 6400000
    s_mov_b32 s27, 0x20000
    s_waitcnt vmcnt(6) lgkmcnt(0)
    v_and_b32 v5, 0xffff0000, v4
    v_lshlrev_b32 v4, 16, v4
    s_lshl_b32 s14, s32, 16
    s_and_b32 s15, s32, 0xffff0000
    v_pk_add_f32 v[8:9], v[4:5], s[14:15] op_sel:[0,0] op_sel_hi:[0,1] neg_lo:[0,1] neg_hi:[0,1]
    v_pk_add_f32 v[16:17], v[4:5], s[14:15] op_sel:[1,0] op_sel_hi:[1,1] neg_lo:[0,1] neg_hi:[0,1]
    s_lshl_b32 s16, s33, 16
    s_and_b32 s17, s33, 0xffff0000
    v_pk_add_f32 v[10:11], v[4:5], s[16:17] op_sel:[0,0] op_sel_hi:[0,1] neg_lo:[0,1] neg_hi:[0,1]
    v_pk_add_f32 v[18:19], v[4:5], s[16:17] op_sel:[1,0] op_sel_hi:[1,1] neg_lo:[0,1] neg_hi:[0,1]
    s_lshl_b32 s18, s34, 16
    s_and_b32 s19, s34, 0xffff0000
    v_pk_add_f32 v[12:13], v[4:5], s[18:19] op_sel:[0,0] op_sel_hi:[0,1] neg_lo:[0,1] neg_hi:[0,1]
    v_pk_add_f32 v[20:21], v[4:5], s[18:19] op_sel:[1,0] op_sel_hi:[1,1] neg_lo:[0,1] neg_hi:[0,1]
    s_lshl_b32 s12, s35, 16
    s_and_b32 s13, s35, 0xffff0000
    v_pk_add_f32 v[14:15], v[4:5], s[12:13] op_sel:[0,0] op_sel_hi:[0,1] neg_lo:[0,1] neg_hi:[0,1]
    v_pk_add_f32 v[22:23], v[4:5], s[12:13] op_sel:[1,0] op_sel_hi:[1,1] neg_lo:[0,1] neg_hi:[0,1]
    v_cvt_pk_bf16_f32 v8, v8, v9
    v_cvt_pk_bf16_f32 v10, v10, v11
    v_cvt_pk_bf16_f32 v12, v12, v13
    v_cvt_pk_bf16_f32 v14, v14, v15
    v_cvt_pk_bf16_f32 v16, v16, v17
    v_cvt_pk_bf16_f32 v18, v18, v19
    v_cvt_pk_bf16_f32 v20, v20, v21
    v_cvt_pk_bf16_f32 v22, v22, v23
    v_and_b32 v9, 0xffff0000, v8
    v_lshlrev_b32 v8, 16, v8
    v_and_b32 v11, 0xffff0000, v10
    v_lshlrev_b32 v10, 16, v10
    v_and_b32 v13, 0xffff0000, v12
    v_lshlrev_b32 v12, 16, v12
    v_and_b32 v15, 0xffff0000, v14
    v_lshlrev_b32 v14, 16, v14
    v_and_b32 v17, 0xffff0000, v16
    v_lshlrev_b32 v16, 16, v16
    v_and_b32 v19, 0xffff0000, v18
    v_lshlrev_b32 v18, 16, v18
    v_and_b32 v21, 0xffff0000, v20
    v_lshlrev_b32 v20, 16, v20
    v_and_b32 v23, 0xffff0000, v22
    v_lshlrev_b32 v22, 16, v22
    v_mul_f32 v8, v8, v8
    v_mul_f32 v9, v9, v9
    v_mul_f32 v10, v10, v10
    v_mul_f32 v11, v11, v11
    v_mul_f32 v12, v12, v12
    v_mul_f32 v13, v13, v13
    v_mul_f32 v14, v14, v14
    v_mul_f32 v15, v15, v15
    v_mul_f32 v16, v16, v16
    v_mul_f32 v17, v17, v17
    v_mul_f32 v18, v18, v18
    v_mul_f32 v19, v19, v19
    v_mul_f32 v20, v20, v20
    v_mul_f32 v21, v21, v21
    v_mul_f32 v22, v22, v22
    v_mul_f32 v23, v23, v23
    v_cvt_pk_bf16_f32 v8, v8, v9
    v_cvt_pk_bf16_f32 v10, v10, v11
    v_cvt_pk_bf16_f32 v12, v12, v13
    v_cvt_pk_bf16_f32 v14, v14, v15
    v_cvt_pk_bf16_f32 v16, v16, v17
    v_cvt_pk_bf16_f32 v18, v18, v19
    v_cvt_pk_bf16_f32 v20, v20, v21
    v_cvt_pk_bf16_f32 v22, v22, v23
    v_and_b32 v9, 0xffff0000, v8
    v_lshlrev_b32 v8, 16, v8
    v_and_b32 v11, 0xffff0000, v10
    v_lshlrev_b32 v10, 16, v10
    v_and_b32 v13, 0xffff0000, v12
    v_lshlrev_b32 v12, 16, v12
    v_and_b32 v15, 0xffff0000, v14
    v_lshlrev_b32 v14, 16, v14
    v_and_b32 v17, 0xffff0000, v16
    v_lshlrev_b32 v16, 16, v16
    v_and_b32 v19, 0xffff0000, v18
    v_lshlrev_b32 v18, 16, v18
    v_and_b32 v21, 0xffff0000, v20
    v_lshlrev_b32 v20, 16, v20
    v_and_b32 v23, 0xffff0000, v22
    v_lshlrev_b32 v22, 16, v22
    v_mul_f32 v8, 0xc1200000, v8
    v_mul_f32 v9, 0xc1200000, v9
    v_mul_f32 v10, 0xc1200000, v10
    v_mul_f32 v11, 0xc1200000, v11
    v_mul_f32 v12, 0xc1200000, v12
    v_mul_f32 v13, 0xc1200000, v13
    v_mul_f32 v14, 0xc1200000, v14
    v_mul_f32 v15, 0xc1200000, v15
    v_mul_f32 v16, 0xc1200000, v16
    v_mul_f32 v17, 0xc1200000, v17
    v_mul_f32 v18, 0xc1200000, v18
    v_mul_f32 v19, 0xc1200000, v19
    v_mul_f32 v20, 0xc1200000, v20
    v_mul_f32 v21, 0xc1200000, v21
    v_mul_f32 v22, 0xc1200000, v22
    v_mul_f32 v23, 0xc1200000, v23
    v_cvt_pk_bf16_f32 v8, v8, v9
    v_cvt_pk_bf16_f32 v10, v10, v11
    v_cvt_pk_bf16_f32 v12, v12, v13
    v_cvt_pk_bf16_f32 v14, v14, v15
    v_cvt_pk_bf16_f32 v16, v16, v17
    v_cvt_pk_bf16_f32 v18, v18, v19
    v_cvt_pk_bf16_f32 v20, v20, v21
    v_cvt_pk_bf16_f32 v22, v22, v23
    v_and_b32 v9, 0xffff0000, v8
    v_lshlrev_b32 v8, 16, v8
    v_and_b32 v11, 0xffff0000, v10
    v_lshlrev_b32 v10, 16, v10
    v_and_b32 v13, 0xffff0000, v12
    v_lshlrev_b32 v12, 16, v12
    v_and_b32 v15, 0xffff0000, v14
    v_lshlrev_b32 v14, 16, v14
    v_and_b32 v17, 0xffff0000, v16
    v_lshlrev_b32 v16, 16, v16
    v_and_b32 v19, 0xffff0000, v18
    v_lshlrev_b32 v18, 16, v18
    v_and_b32 v21, 0xffff0000, v20
    v_lshlrev_b32 v20, 16, v20
    v_and_b32 v23, 0xffff0000, v22
    v_lshlrev_b32 v22, 16, v22
    v_mul_f32 v8, 0x3fb8aa3b, v8
    v_mul_f32 v9, 0x3fb8aa3b, v9
    v_mul_f32 v10, 0x3fb8aa3b, v10
    v_mul_f32 v11, 0x3fb8aa3b, v11
    v_mul_f32 v12, 0x3fb8aa3b, v12
    v_mul_f32 v13, 0x3fb8aa3b, v13
    v_mul_f32 v14, 0x3fb8aa3b, v14
    v_mul_f32 v15, 0x3fb8aa3b, v15
    v_mul_f32 v16, 0x3fb8aa3b, v16
    v_mul_f32 v17, 0x3fb8aa3b, v17
    v_mul_f32 v18, 0x3fb8aa3b, v18
    v_mul_f32 v19, 0x3fb8aa3b, v19
    v_mul_f32 v20, 0x3fb8aa3b, v20
    v_mul_f32 v21, 0x3fb8aa3b, v21
    v_mul_f32 v22, 0x3fb8aa3b, v22
    v_mul_f32 v23, 0x3fb8aa3b, v23
    v_exp_f32 v8, v8
    v_exp_f32 v9, v9
    v_exp_f32 v10, v10
    v_exp_f32 v11, v11
    v_exp_f32 v12, v12
    v_exp_f32 v13, v13
    v_exp_f32 v14, v14
    v_exp_f32 v15, v15
    v_exp_f32 v16, v16
    v_exp_f32 v17, v17
    v_exp_f32 v18, v18
    v_exp_f32 v19, v19
    v_exp_f32 v20, v20
    v_exp_f32 v21, v21
    v_exp_f32 v22, v22
    v_exp_f32 v23, v23
    s_nop 0
    v_cvt_pk_bf16_f32 v8, v8, v9
    v_cvt_pk_bf16_f32 v10, v10, v11
    v_cvt_pk_bf16_f32 v12, v12, v13
    v_cvt_pk_bf16_f32 v14, v14, v15
    v_cvt_pk_bf16_f32 v16, v16, v17
    v_cvt_pk_bf16_f32 v18, v18, v19
    v_cvt_pk_bf16_f32 v20, v20, v21
    v_cvt_pk_bf16_f32 v22, v22, v23
    v_and_b32 v9, 0xffff0000, v8
    v_lshlrev_b32 v8, 16, v8
    v_and_b32 v11, 0xffff0000, v10
    v_lshlrev_b32 v10, 16, v10
    v_and_b32 v13, 0xffff0000, v12
    v_lshlrev_b32 v12, 16, v12
    v_and_b32 v15, 0xffff0000, v14
    v_lshlrev_b32 v14, 16, v14
    v_and_b32 v17, 0xffff0000, v16
    v_lshlrev_b32 v16, 16, v16
    v_and_b32 v19, 0xffff0000, v18
    v_lshlrev_b32 v18, 16, v18
    v_and_b32 v21, 0xffff0000, v20
    v_lshlrev_b32 v20, 16, v20
    v_and_b32 v23, 0xffff0000, v22
    v_lshlrev_b32 v22, 16, v22
    s_lshl_b32 s14, s52, 16
    s_and_b32 s15, s52, 0xffff0000
    v_pk_mul_f32 v[24:25], v[8:9], s[14:15] op_sel:[0,0] op_sel_hi:[0,1]
    v_pk_mul_f32 v[28:29], v[16:17], s[14:15] op_sel:[0,0] op_sel_hi:[0,1]
    s_lshl_b32 s16, s53, 16
    s_and_b32 s17, s53, 0xffff0000
    v_pk_mul_f32 v[26:27], v[8:9], s[16:17] op_sel:[0,0] op_sel_hi:[0,1]
    v_pk_mul_f32 v[30:31], v[16:17], s[16:17] op_sel:[0,0] op_sel_hi:[0,1]
    s_lshl_b32 s18, s54, 16
    s_and_b32 s19, s54, 0xffff0000
    v_pk_fma_f32 v[24:25], v[8:9], s[18:19], v[24:25] op_sel:[1,0,0] op_sel_hi:[1,1,1]
    v_pk_fma_f32 v[28:29], v[16:17], s[18:19], v[28:29] op_sel:[1,0,0] op_sel_hi:[1,1,1]
    s_lshl_b32 s12, s55, 16
    s_and_b32 s13, s55, 0xffff0000
    v_pk_fma_f32 v[26:27], v[8:9], s[12:13], v[26:27] op_sel:[1,0,0] op_sel_hi:[1,1,1]
    v_pk_fma_f32 v[30:31], v[16:17], s[12:13], v[30:31] op_sel:[1,0,0] op_sel_hi:[1,1,1]
    s_lshl_b32 s14, s56, 16
    s_and_b32 s15, s56, 0xffff0000
    v_pk_fma_f32 v[24:25], v[10:11], s[14:15], v[24:25] op_sel:[0,0,0] op_sel_hi:[0,1,1]
    v_pk_fma_f32 v[28:29], v[18:19], s[14:15], v[28:29] op_sel:[0,0,0] op_sel_hi:[0,1,1]
    s_lshl_b32 s16, s57, 16
    s_and_b32 s17, s57, 0xffff0000
    v_pk_fma_f32 v[26:27], v[10:11], s[16:17], v[26:27] op_sel:[0,0,0] op_sel_hi:[0,1,1]
    v_pk_fma_f32 v[30:31], v[18:19], s[16:17], v[30:31] op_sel:[0,0,0] op_sel_hi:[0,1,1]
    s_lshl_b32 s18, s58, 16
    s_and_b32 s19, s58, 0xffff0000
    v_pk_fma_f32 v[24:25], v[10:11], s[18:19], v[24:25] op_sel:[1,0,0] op_sel_hi:[1,1,1]
    v_pk_fma_f32 v[28:29], v[18:19], s[18:19], v[28:29] op_sel:[1,0,0] op_sel_hi:[1,1,1]
    s_lshl_b32 s12, s59, 16
    s_and_b32 s13, s59, 0xffff0000
    v_pk_fma_f32 v[26:27], v[10:11], s[12:13], v[26:27] op_sel:[1,0,0] op_sel_hi:[1,1,1]
    v_pk_fma_f32 v[30:31], v[18:19], s[12:13], v[30:31] op_sel:[1,0,0] op_sel_hi:[1,1,1]
    s_lshl_b32 s14, s60, 16
    s_and_b32 s15, s60, 0xffff0000
    v_pk_fma_f32 v[24:25], v[12:13], s[14:15], v[24:25] op_sel:[0,0,0] op_sel_hi:[0,1,1]
    v_pk_fma_f32 v[28:29], v[20:21], s[14:15], v[28:29] op_sel:[0,0,0] op_sel_hi:[0,1,1]
    s_lshl_b32 s16, s61, 16
    s_and_b32 s17, s61, 0xffff0000
    v_pk_fma_f32 v[26:27], v[12:13], s[16:17], v[26:27] op_sel:[0,0,0] op_sel_hi:[0,1,1]
    v_pk_fma_f32 v[30:31], v[20:21], s[16:17], v[30:31] op_sel:[0,0,0] op_sel_hi:[0,1,1]
    s_lshl_b32 s18, s62, 16
    s_and_b32 s19, s62, 0xffff0000
    v_pk_fma_f32 v[24:25], v[12:13], s[18:19], v[24:25] op_sel:[1,0,0] op_sel_hi:[1,1,1]
    v_pk_fma_f32 v[28:29], v[20:21], s[18:19], v[28:29] op_sel:[1,0,0] op_sel_hi:[1,1,1]
    s_lshl_b32 s12, s63, 16
    s_and_b32 s13, s63, 0xffff0000
    v_pk_fma_f32 v[26:27], v[12:13], s[12:13], v[26:27] op_sel:[1,0,0] op_sel_hi:[1,1,1]
    v_pk_fma_f32 v[30:31], v[20:21], s[12:13], v[30:31] op_sel:[1,0,0] op_sel_hi:[1,1,1]
    s_lshl_b32 s14, s64, 16
    s_and_b32 s15, s64, 0xffff0000
    v_pk_fma_f32 v[24:25], v[14:15], s[14:15], v[24:25] op_sel:[0,0,0] op_sel_hi:[0,1,1]
    v_pk_fma_f32 v[28:29], v[22:23], s[14:15], v[28:29] op_sel:[0,0,0] op_sel_hi:[0,1,1]
    s_lshl_b32 s16, s65, 16
    s_and_b32 s17, s65, 0xffff0000
    v_pk_fma_f32 v[26:27], v[14:15], s[16:17], v[26:27] op_sel:[0,0,0] op_sel_hi:[0,1,1]
    v_pk_fma_f32 v[30:31], v[22:23], s[16:17], v[30:31] op_sel:[0,0,0] op_sel_hi:[0,1,1]
    s_lshl_b32 s18, s66, 16
    s_and_b32 s19, s66, 0xffff0000
    v_pk_fma_f32 v[24:25], v[14:15], s[18:19], v[24:25] op_sel:[1,0,0] op_sel_hi:[1,1,1]
    v_pk_fma_f32 v[28:29], v[22:23], s[18:19], v[28:29] op_sel:[1,0,0] op_sel_hi:[1,1,1]
    s_lshl_b32 s12, s67, 16
    s_and_b32 s13, s67, 0xffff0000
    v_pk_fma_f32 v[26:27], v[14:15], s[12:13], v[26:27] op_sel:[1,0,0] op_sel_hi:[1,1,1]
    v_pk_fma_f32 v[30:31], v[22:23], s[12:13], v[30:31] op_sel:[1,0,0] op_sel_hi:[1,1,1]
    s_lshl_b32 s14, s36, 16
    s_and_b32 s15, s36, 0xffff0000
    v_pk_mul_f32 v[32:33], v[8:9], s[14:15] op_sel:[0,0] op_sel_hi:[0,1]
    v_pk_mul_f32 v[36:37], v[16:17], s[14:15] op_sel:[0,0] op_sel_hi:[0,1]
    s_lshl_b32 s16, s37, 16
    s_and_b32 s17, s37, 0xffff0000
    v_pk_mul_f32 v[34:35], v[8:9], s[16:17] op_sel:[0,0] op_sel_hi:[0,1]
    v_pk_mul_f32 v[38:39], v[16:17], s[16:17] op_sel:[0,0] op_sel_hi:[0,1]
    s_lshl_b32 s18, s38, 16
    s_and_b32 s19, s38, 0xffff0000
    v_pk_fma_f32 v[32:33], v[8:9], s[18:19], v[32:33] op_sel:[1,0,0] op_sel_hi:[1,1,1]
    v_pk_fma_f32 v[36:37], v[16:17], s[18:19], v[36:37] op_sel:[1,0,0] op_sel_hi:[1,1,1]
    s_lshl_b32 s12, s39, 16
    s_and_b32 s13, s39, 0xffff0000
    v_pk_fma_f32 v[34:35], v[8:9], s[12:13], v[34:35] op_sel:[1,0,0] op_sel_hi:[1,1,1]
    v_pk_fma_f32 v[38:39], v[16:17], s[12:13], v[38:39] op_sel:[1,0,0] op_sel_hi:[1,1,1]
    s_lshl_b32 s14, s40, 16
    s_and_b32 s15, s40, 0xffff0000
    v_pk_fma_f32 v[32:33], v[10:11], s[14:15], v[32:33] op_sel:[0,0,0] op_sel_hi:[0,1,1]
    v_pk_fma_f32 v[36:37], v[18:19], s[14:15], v[36:37] op_sel:[0,0,0] op_sel_hi:[0,1,1]
    s_lshl_b32 s16, s41, 16
    s_and_b32 s17, s41, 0xffff0000
    v_pk_fma_f32 v[34:35], v[10:11], s[16:17], v[34:35] op_sel:[0,0,0] op_sel_hi:[0,1,1]
    v_pk_fma_f32 v[38:39], v[18:19], s[16:17], v[38:39] op_sel:[0,0,0] op_sel_hi:[0,1,1]
    s_lshl_b32 s18, s42, 16
    s_and_b32 s19, s42, 0xffff0000
    v_pk_fma_f32 v[32:33], v[10:11], s[18:19], v[32:33] op_sel:[1,0,0] op_sel_hi:[1,1,1]
    v_pk_fma_f32 v[36:37], v[18:19], s[18:19], v[36:37] op_sel:[1,0,0] op_sel_hi:[1,1,1]
    s_lshl_b32 s12, s43, 16
    s_and_b32 s13, s43, 0xffff0000
    v_pk_fma_f32 v[34:35], v[10:11], s[12:13], v[34:35] op_sel:[1,0,0] op_sel_hi:[1,1,1]
    v_pk_fma_f32 v[38:39], v[18:19], s[12:13], v[38:39] op_sel:[1,0,0] op_sel_hi:[1,1,1]
    s_lshl_b32 s14, s44, 16
    s_and_b32 s15, s44, 0xffff0000
    v_pk_fma_f32 v[32:33], v[12:13], s[14:15], v[32:33] op_sel:[0,0,0] op_sel_hi:[0,1,1]
    v_pk_fma_f32 v[36:37], v[20:21], s[14:15], v[36:37] op_sel:[0,0,0] op_sel_hi:[0,1,1]
    s_lshl_b32 s16, s45, 16
    s_and_b32 s17, s45, 0xffff0000
    v_pk_fma_f32 v[34:35], v[12:13], s[16:17], v[34:35] op_sel:[0,0,0] op_sel_hi:[0,1,1]
    v_pk_fma_f32 v[38:39], v[20:21], s[16:17], v[38:39] op_sel:[0,0,0] op_sel_hi:[0,1,1]
    s_lshl_b32 s18, s46, 16
    s_and_b32 s19, s46, 0xffff0000
    v_pk_fma_f32 v[32:33], v[12:13], s[18:19], v[32:33] op_sel:[1,0,0] op_sel_hi:[1,1,1]
    v_pk_fma_f32 v[36:37], v[20:21], s[18:19], v[36:37] op_sel:[1,0,0] op_sel_hi:[1,1,1]
    s_lshl_b32 s12, s47, 16
    s_and_b32 s13, s47, 0xffff0000
    v_pk_fma_f32 v[34:35], v[12:13], s[12:13], v[34:35] op_sel:[1,0,0] op_sel_hi:[1,1,1]
    v_pk_fma_f32 v[38:39], v[20:21], s[12:13], v[38:39] op_sel:[1,0,0] op_sel_hi:[1,1,1]
    s_lshl_b32 s14, s48, 16
    s_and_b32 s15, s48, 0xffff0000
    v_pk_fma_f32 v[32:33], v[14:15], s[14:15], v[32:33] op_sel:[0,0,0] op_sel_hi:[0,1,1]
    v_pk_fma_f32 v[36:37], v[22:23], s[14:15], v[36:37] op_sel:[0,0,0] op_sel_hi:[0,1,1]
    s_lshl_b32 s16, s49, 16
    s_and_b32 s17, s49, 0xffff0000
    v_pk_fma_f32 v[34:35], v[14:15], s[16:17], v[34:35] op_sel:[0,0,0] op_sel_hi:[0,1,1]
    v_pk_fma_f32 v[38:39], v[22:23], s[16:17], v[38:39] op_sel:[0,0,0] op_sel_hi:[0,1,1]
    s_lshl_b32 s18, s50, 16
    s_and_b32 s19, s50, 0xffff0000
    v_pk_fma_f32 v[32:33], v[14:15], s[18:19], v[32:33] op_sel:[1,0,0] op_sel_hi:[1,1,1]
    v_pk_fma_f32 v[36:37], v[22:23], s[18:19], v[36:37] op_sel:[1,0,0] op_sel_hi:[1,1,1]
    s_lshl_b32 s12, s51, 16
    s_and_b32 s13, s51, 0xffff0000
    v_pk_fma_f32 v[34:35], v[14:15], s[12:13], v[34:35] op_sel:[1,0,0] op_sel_hi:[1,1,1]
    v_pk_fma_f32 v[38:39], v[22:23], s[12:13], v[38:39] op_sel:[1,0,0] op_sel_hi:[1,1,1]
    v_cvt_pk_bf16_f32 v32, v32, v33
    v_cvt_pk_bf16_f32 v34, v34, v35
    v_cvt_pk_bf16_f32 v36, v36, v37
    v_cvt_pk_bf16_f32 v38, v38, v39
    v_and_b32 v33, 0xffff0000, v32
    v_lshlrev_b32 v32, 16, v32
    v_and_b32 v35, 0xffff0000, v34
    v_lshlrev_b32 v34, 16, v34
    v_and_b32 v37, 0xffff0000, v36
    v_lshlrev_b32 v36, 16, v36
    v_and_b32 v39, 0xffff0000, v38
    v_lshlrev_b32 v38, 16, v38
    s_waitcnt vmcnt(1)
    v_add_u32 v40, v40, v44
    v_add_u32 v48, v48, v52
    v_add_u32 v41, v41, v45
    v_add_u32 v49, v49, v53
    v_add_u32 v42, v42, v46
    v_add_u32 v50, v50, v54
    v_add_u32 v43, v43, v47
    v_add_u32 v51, v51, v55
    v_add_u32_sdwa v8, v40, v48 dst_sel:DWORD dst_unused:UNUSED_PAD src0_sel:WORD_0 src1_sel:WORD_0
    v_add_u32_sdwa v9, v40, v48 dst_sel:DWORD dst_unused:UNUSED_PAD src0_sel:WORD_1 src1_sel:WORD_1
    v_add_u32_sdwa v10, v41, v49 dst_sel:DWORD dst_unused:UNUSED_PAD src0_sel:WORD_0 src1_sel:WORD_0
    v_add_u32_sdwa v11, v41, v49 dst_sel:DWORD dst_unused:UNUSED_PAD src0_sel:WORD_1 src1_sel:WORD_1
    v_add_u32_sdwa v12, v42, v50 dst_sel:DWORD dst_unused:UNUSED_PAD src0_sel:WORD_0 src1_sel:WORD_0
    v_add_u32_sdwa v13, v42, v50 dst_sel:DWORD dst_unused:UNUSED_PAD src0_sel:WORD_1 src1_sel:WORD_1
    v_add_u32_sdwa v14, v43, v51 dst_sel:DWORD dst_unused:UNUSED_PAD src0_sel:WORD_0 src1_sel:WORD_0
    v_add_u32_sdwa v15, v43, v51 dst_sel:DWORD dst_unused:UNUSED_PAD src0_sel:WORD_1 src1_sel:WORD_1
    v_min3_u32 v5, v56, v57, v58
    v_bitop3_b32 v4, v56, v57, v58 bitop3:0xfe
    v_min_u32 v5, v5, v59
    v_or_b32 v4, v4, v59
    v_or_b32 v8, 0x4b000000, v8
    v_or_b32 v9, 0x4b000000, v9
    v_or_b32 v10, 0x4b000000, v10
    v_or_b32 v11, 0x4b000000, v11
    v_or_b32 v12, 0x4b000000, v12
    v_or_b32 v13, 0x4b000000, v13
    v_or_b32 v14, 0x4b000000, v14
    v_or_b32 v15, 0x4b000000, v15
    v_cmp_eq_u32 vcc, 0, v5
    v_add_f32 v8, 0xcb010000, v8
    v_add_f32 v9, 0xcb010000, v9
    v_add_f32 v10, 0xcb010000, v10
    v_add_f32 v11, 0xcb010000, v11
    v_add_f32 v12, 0xcb010000, v12
    v_add_f32 v13, 0xcb010000, v13
    v_add_f32 v14, 0xcb010000, v14
    v_add_f32 v15, 0xcb010000, v15
    v_mul_f32 v8, v4, v8
    v_mul_f32 v9, v4, v9
    v_mul_f32 v10, v4, v10
    v_mul_f32 v11, v4, v11
    v_mul_f32 v12, v4, v12
    v_mul_f32 v13, v4, v13
    v_mul_f32 v14, v4, v14
    v_mul_f32 v15, v4, v15
    s_cbranch_vccz p3_nof
    v_lshlrev_b32 v1, 4, v0
    v_mov_b32 v3, 0x70000000
    v_cmp_eq_u32 vcc, 0, v56
    s_mov_b32 s22, 389035008
    s_nop 0
    v_cndmask_b32 v5, v3, v1, vcc
    buffer_load_dwordx4 v[16:19], v5, s[28:31], s22 offen
    buffer_load_dwordx4 v[20:23], v5, s[28:31], s22 offen offset:16
    s_waitcnt vmcnt(0)
    v_add_f32 v8, v8, v16
    v_add_f32 v9, v9, v17
    v_add_f32 v10, v10, v18
    v_add_f32 v11, v11, v19
    v_add_f32 v12, v12, v20
    v_add_f32 v13, v13, v21
    v_add_f32 v14, v14, v22
    v_add_f32 v15, v15, v23
    v_cmp_eq_u32 vcc, 0, v57
    s_mov_b32 s22, 401847296
    s_nop 0
    v_cndmask_b32 v5, v3, v1, vcc
    buffer_load_dwordx4 v[16:19], v5, s[28:31], s22 offen
    buffer_load_dwordx4 v[20:23], v5, s[28:31], s22 offen offset:16
    s_waitcnt vmcnt(0)
    v_add_f32 v8, v8, v16
    v_add_f32 v9, v9, v17
    v_add_f32 v10, v10, v18
    v_add_f32 v11, v11, v19
    v_add_f32 v12, v12, v20
    v_add_f32 v13, v13, v21
    v_add_f32 v14, v14, v22
    v_add_f32 v15, v15, v23
    v_cmp_eq_u32 vcc, 0, v58
    s_mov_b32 s22, 414659584
    s_nop 0
    v_cndmask_b32 v5, v3, v1, vcc
    buffer_load_dwordx4 v[16:19], v5, s[28:31], s22 offen
    buffer_load_dwordx4 v[20:23], v5, s[28:31], s22 offen offset:16
    s_waitcnt vmcnt(0)
    v_add_f32 v8, v8, v16
    v_add_f32 v9, v9, v17
    v_add_f32 v10, v10, v18
    v_add_f32 v11, v11, v19
    v_add_f32 v12, v12, v20
    v_add_f32 v13, v13, v21
    v_add_f32 v14, v14, v22
    v_add_f32 v15, v15, v23
    v_cmp_eq_u32 vcc, 0, v59
    s_mov_b32 s22, 427471872
    s_nop 0
    v_cndmask_b32 v5, v3, v1, vcc
    buffer_load_dwordx4 v[16:19], v5, s[28:31], s22 offen
    buffer_load_dwordx4 v[20:23], v5, s[28:31], s22 offen offset:16
    s_waitcnt vmcnt(0)
    v_add_f32 v8, v8, v16
    v_add_f32 v9, v9, v17
    v_add_f32 v10, v10, v18
    v_add_f32 v11, v11, v19
    v_add_f32 v12, v12, v20
    v_add_f32 v13, v13, v21
    v_add_f32 v14, v14, v22
    v_add_f32 v15, v15, v23
p3_nof:
    s_lshl_b32 s14, s68, 16
    s_and_b32 s15, s68, 0xffff0000
    v_pk_mul_f32 v[16:17], v[8:9], s[14:15] op_sel:[0,0] op_sel_hi:[0,1]
    v_pk_mul_f32 v[20:21], v[12:13], s[14:15] op_sel:[0,0] op_sel_hi:[0,1]
    s_lshl_b32 s16, s69, 16
    s_and_b32 s17, s69, 0xffff0000
    v_pk_mul_f32 v[18:19], v[8:9], s[16:17] op_sel:[0,0] op_sel_hi:[0,1]
    v_pk_mul_f32 v[22:23], v[12:13], s[16:17] op_sel:[0,0] op_sel_hi:[0,1]
    s_lshl_b32 s18, s70, 16
    s_and_b32 s19, s70, 0xffff0000
    v_pk_fma_f32 v[16:17], v[8:9], s[18:19], v[16:17] op_sel:[1,0,0] op_sel_hi:[1,1,1]
    v_pk_fma_f32 v[20:21], v[12:13], s[18:19], v[20:21] op_sel:[1,0,0] op_sel_hi:[1,1,1]
    s_lshl_b32 s12, s71, 16
    s_and_b32 s13, s71, 0xffff0000
    v_pk_fma_f32 v[18:19], v[8:9], s[12:13], v[18:19] op_sel:[1,0,0] op_sel_hi:[1,1,1]
    v_pk_fma_f32 v[22:23], v[12:13], s[12:13], v[22:23] op_sel:[1,0,0] op_sel_hi:[1,1,1]
    s_lshl_b32 s14, s72, 16
    s_and_b32 s15, s72, 0xffff0000
    v_pk_fma_f32 v[16:17], v[10:11], s[14:15], v[16:17] op_sel:[0,0,0] op_sel_hi:[0,1,1]
    v_pk_fma_f32 v[20:21], v[14:15], s[14:15], v[20:21] op_sel:[0,0,0] op_sel_hi:[0,1,1]
    s_lshl_b32 s16, s73, 16
    s_and_b32 s17, s73, 0xffff0000
    v_pk_fma_f32 v[18:19], v[10:11], s[16:17], v[18:19] op_sel:[0,0,0] op_sel_hi:[0,1,1]
    v_pk_fma_f32 v[22:23], v[14:15], s[16:17], v[22:23] op_sel:[0,0,0] op_sel_hi:[0,1,1]
    s_lshl_b32 s18, s74, 16
    s_and_b32 s19, s74, 0xffff0000
    v_pk_fma_f32 v[16:17], v[10:11], s[18:19], v[16:17] op_sel:[1,0,0] op_sel_hi:[1,1,1]
    v_pk_fma_f32 v[20:21], v[14:15], s[18:19], v[20:21] op_sel:[1,0,0] op_sel_hi:[1,1,1]
    s_lshl_b32 s12, s75, 16
    s_and_b32 s13, s75, 0xffff0000
    v_pk_fma_f32 v[18:19], v[10:11], s[12:13], v[18:19] op_sel:[1,0,0] op_sel_hi:[1,1,1]
    v_pk_fma_f32 v[22:23], v[14:15], s[12:13], v[22:23] op_sel:[1,0,0] op_sel_hi:[1,1,1]
    v_mul_f32 v24, v24, v16
    v_mul_f32 v25, v25, v17
    v_mul_f32 v26, v26, v18
    v_mul_f32 v27, v27, v19
    v_mul_f32 v28, v28, v20
    v_mul_f32 v29, v29, v21
    v_mul_f32 v30, v30, v22
    v_mul_f32 v31, v31, v23
    v_cvt_pk_bf16_f32 v24, v24, v25
    v_cvt_pk_bf16_f32 v26, v26, v27
    v_cvt_pk_bf16_f32 v28, v28, v29
    v_cvt_pk_bf16_f32 v30, v30, v31
    v_and_b32 v25, 0xffff0000, v24
    v_lshlrev_b32 v24, 16, v24
    v_and_b32 v27, 0xffff0000, v26
    v_lshlrev_b32 v26, 16, v26
    v_and_b32 v29, 0xffff0000, v28
    v_lshlrev_b32 v28, 16, v28
    v_and_b32 v31, 0xffff0000, v30
    v_lshlrev_b32 v30, 16, v30
    s_lshl_b32 s14, s76, 16
    s_and_b32 s15, s76, 0xffff0000
    v_pk_mul_f32 v[16:17], v[24:25], s[14:15] op_sel:[0,0] op_sel_hi:[0,1]
    v_pk_mul_f32 v[20:21], v[28:29], s[14:15] op_sel:[0,0] op_sel_hi:[0,1]
    s_lshl_b32 s16, s77, 16
    s_and_b32 s17, s77, 0xffff0000
    v_pk_mul_f32 v[18:19], v[24:25], s[16:17] op_sel:[0,0] op_sel_hi:[0,1]
    v_pk_mul_f32 v[22:23], v[28:29], s[16:17] op_sel:[0,0] op_sel_hi:[0,1]
    s_lshl_b32 s18, s78, 16
    s_and_b32 s19, s78, 0xffff0000
    v_pk_fma_f32 v[16:17], v[24:25], s[18:19], v[16:17] op_sel:[1,0,0] op_sel_hi:[1,1,1]
    v_pk_fma_f32 v[20:21], v[28:29], s[18:19], v[20:21] op_sel:[1,0,0] op_sel_hi:[1,1,1]
    s_lshl_b32 s12, s79, 16
    s_and_b32 s13, s79, 0xffff0000
    v_pk_fma_f32 v[18:19], v[24:25], s[12:13], v[18:19] op_sel:[1,0,0] op_sel_hi:[1,1,1]
    v_pk_fma_f32 v[22:23], v[28:29], s[12:13], v[22:23] op_sel:[1,0,0] op_sel_hi:[1,1,1]
    s_lshl_b32 s14, s80, 16
    s_and_b32 s15, s80, 0xffff0000
    v_pk_fma_f32 v[16:17], v[26:27], s[14:15], v[16:17] op_sel:[0,0,0] op_sel_hi:[0,1,1]
    v_pk_fma_f32 v[20:21], v[30:31], s[14:15], v[20:21] op_sel:[0,0,0] op_sel_hi:[0,1,1]
    s_lshl_b32 s16, s81, 16
    s_and_b32 s17, s81, 0xffff0000
    v_pk_fma_f32 v[18:19], v[26:27], s[16:17], v[18:19] op_sel:[0,0,0] op_sel_hi:[0,1,1]
    v_pk_fma_f32 v[22:23], v[30:31], s[16:17], v[22:23] op_sel:[0,0,0] op_sel_hi:[0,1,1]
    s_lshl_b32 s18, s82, 16
    s_and_b32 s19, s82, 0xffff0000
    v_pk_fma_f32 v[16:17], v[26:27], s[18:19], v[16:17] op_sel:[1,0,0] op_sel_hi:[1,1,1]
    v_pk_fma_f32 v[20:21], v[30:31], s[18:19], v[20:21] op_sel:[1,0,0] op_sel_hi:[1,1,1]
    s_lshl_b32 s12, s83, 16
    s_and_b32 s13, s83, 0xffff0000
    v_pk_fma_f32 v[18:19], v[26:27], s[12:13], v[18:19] op_sel:[1,0,0] op_sel_hi:[1,1,1]
    v_pk_fma_f32 v[22:23], v[30:31], s[12:13], v[22:23] op_sel:[1,0,0] op_sel_hi:[1,1,1]
    v_cvt_pk_bf16_f32 v16, v16, v17
    v_cvt_pk_bf16_f32 v18, v18, v19
    v_cvt_pk_bf16_f32 v20, v20, v21
    v_cvt_pk_bf16_f32 v22, v22, v23
    v_and_b32 v17, 0xffff0000, v16
    v_lshlrev_b32 v16, 16, v16
    v_and_b32 v19, 0xffff0000, v18
    v_lshlrev_b32 v18, 16, v18
    v_and_b32 v21, 0xffff0000, v20
    v_lshlrev_b32 v20, 16, v20
    v_and_b32 v23, 0xffff0000, v22
    v_lshlrev_b32 v22, 16, v22
    v_mul_f32 v16, v16, v32
    v_mul_f32 v17, v17, v33
    v_mul_f32 v18, v18, v34
    v_mul_f32 v19, v19, v35
    v_mul_f32 v20, v20, v36
    v_mul_f32 v21, v21, v37
    v_mul_f32 v22, v22, v38
    v_mul_f32 v23, v23, v39
    v_cvt_pk_bf16_f32 v16, v16, v17
    v_cvt_pk_bf16_f32 v18, v18, v19
    v_cvt_pk_bf16_f32 v20, v20, v21
    v_cvt_pk_bf16_f32 v22, v22, v23
    v_and_b32 v17, 0xffff0000, v16
    v_lshlrev_b32 v16, 16, v16
    v_and_b32 v19, 0xffff0000, v18
    v_lshlrev_b32 v18, 16, v18
    v_and_b32 v21, 0xffff0000, v20
    v_lshlrev_b32 v20, 16, v20
    v_and_b32 v23, 0xffff0000, v22
    v_lshlrev_b32 v22, 16, v22
    s_waitcnt vmcnt(0)
    v_lshlrev_b32 v8, 16, v60
    v_and_b32 v9, 0xffff0000, v60
    v_lshlrev_b32 v10, 16, v61
    v_and_b32 v11, 0xffff0000, v61
    v_lshlrev_b32 v12, 16, v62
    v_and_b32 v13, 0xffff0000, v62
    v_lshlrev_b32 v14, 16, v63
    v_and_b32 v15, 0xffff0000, v63
    v_add_f32 v8, v8, v16
    v_add_f32 v9, v9, v17
    v_add_f32 v10, v10, v18
    v_add_f32 v11, v11, v19
    v_add_f32 v12, v12, v20
    v_add_f32 v13, v13, v21
    v_add_f32 v14, v14, v22
    v_add_f32 v15, v15, v23
    v_cvt_pk_bf16_f32 v4, v8, v9
    v_cvt_pk_bf16_f32 v5, v10, v11
    v_cvt_pk_bf16_f32 v6, v12, v13
    v_cvt_pk_bf16_f32 v7, v14, v15
    buffer_store_dwordx4 v[4:7], v2, s[24:27], 0 offen
p3_end:
    s_endpgm
.section .rodata,"a"
.p2align 6
.amdhsa_kernel p1_kernel
  .amdhsa_next_free_vgpr 128
  .amdhsa_next_free_sgpr 72
  .amdhsa_accum_offset 128
  .amdhsa_group_segment_fixed_size 0
  .amdhsa_kernarg_size 112
  .amdhsa_user_sgpr_count 2
  .amdhsa_user_sgpr_kernarg_segment_ptr 1
  .amdhsa_system_sgpr_workgroup_id_x 1
  .amdhsa_float_denorm_mode_32 3
.end_amdhsa_kernel
.p2align 6
.amdhsa_kernel p2_kernel
  .amdhsa_next_free_vgpr 128
  .amdhsa_next_free_sgpr 72
  .amdhsa_accum_offset 128
  .amdhsa_group_segment_fixed_size 0
  .amdhsa_kernarg_size 112
  .amdhsa_user_sgpr_count 2
  .amdhsa_user_sgpr_kernarg_segment_ptr 1
  .amdhsa_system_sgpr_workgroup_id_x 1
  .amdhsa_float_denorm_mode_32 3
.end_amdhsa_kernel
.p2align 6
.amdhsa_kernel p3_kernel
  .amdhsa_next_free_vgpr 64
  .amdhsa_next_free_sgpr 84
  .amdhsa_accum_offset 64
  .amdhsa_group_segment_fixed_size 0
  .amdhsa_kernarg_size 112
  .amdhsa_user_sgpr_count 2
  .amdhsa_user_sgpr_kernarg_segment_ptr 1
  .amdhsa_system_sgpr_workgroup_id_x 1
  .amdhsa_float_denorm_mode_32 3
.end_amdhsa_kernel
```

```asm
; @launch kernel=p1_kernel grid=(256,1,1) block=(1024,1,1) lds=161600
; @launch kernel=p2_kernel grid=(256,1,1) block=(1024,1,1) lds=154368
; @launch kernel=p3_kernel grid=(1563,1,1) block=(256,1,1) lds=0
.amdgcn_target "amdgcn-amd-amdhsa--gfx950"
.text
.globl p1_kernel
.p2align 8
.type p1_kernel,@function
p1_kernel:
    s_cmp_ge_u32 s2, 256
    s_cbranch_scc1 p1_end
    s_load_dwordx2 s[52:53], s[0:1], 0
    s_load_dwordx4 s[56:59], s[0:1], 8
    s_load_dwordx2 s[54:55], s[0:1], 32
    s_load_dwordx2 s[60:61], s[0:1], 48
    s_load_dwordx2 s[48:49], s[0:1], 104
    s_load_dwordx2 s[62:63], s[0:1], 96
    v_lshlrev_b32 v1, 4, v0
    v_lshlrev_b32 v2, 3, v0
    v_mov_b32 v3, 1
    v_lshrrev_b32 v117, 6, v0
    s_nop 0
    v_readfirstlane_b32 s28, v117
    s_waitcnt lgkmcnt(0)
    s_load_dword s45, s[60:61], 0
    s_mov_b32 s24, s52
    s_and_b32 s25, s53, 0xffff
    s_mov_b32 s26, 6400000
    s_mov_b32 s27, 0x20000
    s_mov_b32 s4, s56
    s_and_b32 s5, s57, 0xffff
    s_mov_b32 s6, 204800000
    s_mov_b32 s7, 0x20000
    s_mov_b32 s8, s58
    s_and_b32 s9, s59, 0xffff
    s_mov_b32 s10, 204800000
    s_mov_b32 s11, 0x20000
    s_mov_b32 s12, s54
    s_and_b32 s13, s55, 0xffff
    s_mov_b32 s14, 102400000
    s_mov_b32 s15, 0x20000
    s_mov_b32 s16, s48
    s_and_b32 s17, s49, 0xffff
    s_mov_b32 s18, 819200000
    s_mov_b32 s19, 0x20000
    s_mov_b32 s20, s48
    s_and_b32 s21, s49, 0xffff
    s_mov_b32 s22, 0
    s_mov_b32 s23, 0x20000
    s_mov_b32 s40, s62
    s_and_b32 s41, s63, 0xffff
    s_mov_b32 s42, 256
    s_mov_b32 s43, 0x20000
    s_mov_b32 s36, 643827
    s_mov_b32 s37, 214609
    s_mov_b32 s38, 343268
    s_mov_b32 s39, -6671
    s_mov_b32 s44, -12512
    s_waitcnt lgkmcnt(0)
    s_lshl_b32 s45, s45, 16
    s_mov_b32 s29, s2
    s_add_u32 s68, s2, 256
    s_cmp_lt_u32 s29, 1696
    s_cselect_b32 s34, 8, 0
    s_mul_i32 s47, s29, 392
    s_sub_i32 s50, s29, 1696
    s_max_i32 s50, s50, 0
    s_lshl_b32 s50, s50, 3
    s_sub_u32 s47, s47, s50
    s_lshl_b32 s30, s47, 8
    s_lshl_b32 s31, s47, 7
    s_add_u32 s32, s30, 0
    buffer_load_dwordx4 v[4:7], v1, s[4:7], s32 offen nt
    buffer_load_dwordx4 v[28:31], v1, s[8:11], s32 offen nt
    s_add_u32 s32, s31, 0
    buffer_load_dwordx2 v[52:53], v2, s[12:15], s32 offen nt
    s_add_u32 s32, s30, 16384
    buffer_load_dwordx4 v[8:11], v1, s[4:7], s32 offen nt
    buffer_load_dwordx4 v[32:35], v1, s[8:11], s32 offen nt
    s_add_u32 s32, s31, 8192
    buffer_load_dwordx2 v[54:55], v2, s[12:15], s32 offen nt
    s_add_u32 s32, s30, 32768
    buffer_load_dwordx4 v[12:15], v1, s[4:7], s32 offen nt
    buffer_load_dwordx4 v[36:39], v1, s[8:11], s32 offen nt
    s_add_u32 s32, s31, 16384
    buffer_load_dwordx2 v[56:57], v2, s[12:15], s32 offen nt
    s_add_u32 s32, s30, 49152
    buffer_load_dwordx4 v[16:19], v1, s[4:7], s32 offen nt
    buffer_load_dwordx4 v[40:43], v1, s[8:11], s32 offen nt
    s_add_u32 s32, s31, 24576
    buffer_load_dwordx2 v[58:59], v2, s[12:15], s32 offen nt
    s_add_u32 s32, s30, 65536
    buffer_load_dwordx4 v[20:23], v1, s[4:7], s32 offen nt
    buffer_load_dwordx4 v[44:47], v1, s[8:11], s32 offen nt
    s_add_u32 s32, s31, 32768
    buffer_load_dwordx2 v[60:61], v2, s[12:15], s32 offen nt
    s_add_u32 s32, s30, 81920
    buffer_load_dwordx4 v[24:27], v1, s[4:7], s32 offen nt
    buffer_load_dwordx4 v[48:51], v1, s[8:11], s32 offen nt
    s_add_u32 s32, s31, 40960
    buffer_load_dwordx2 v[62:63], v2, s[12:15], s32 offen nt
    s_cmp_lt_u32 s28, s34
    s_cselect_b32 s46, 0, 0x40000000
    v_lshl_add_u32 v117, v0, 2, s46
    s_add_u32 s32, s30, 98304
    buffer_load_dword v64, v117, s[4:7], s32 offen nt
    buffer_load_dword v65, v117, s[8:11], s32 offen nt
    v_lshrrev_b32 v117, 1, v117
    s_add_u32 s32, s31, 49152
    buffer_load_ushort v66, v117, s[12:15], s32 offen nt
    v_mov_b32 v68, 0
    v_mov_b32 v69, 0
    v_mov_b32 v70, 0
    v_mov_b32 v71, 0
    ds_write_b128 v1, v[68:71] offset:0
    s_waitcnt vmcnt(0) lgkmcnt(0)
    s_barrier
p1_tile:
    s_mov_b32 s33, s34
    s_cmp_lt_u32 s68, 1696
    s_cselect_b32 s34, 8, 0
    s_mul_i32 s47, s68, 392
    s_sub_i32 s50, s68, 1696
    s_max_i32 s50, s50, 0
    s_lshl_b32 s50, s50, 3
    s_sub_u32 s47, s47, s50
    s_lshl_b32 s30, s47, 8
    s_lshl_b32 s31, s47, 7
    v_mov_b32 v68, 0
    v_mov_b32 v69, 0
    v_mov_b32 v70, 0
    v_mov_b32 v71, 0
    ds_write_b128 v1, v[68:71] offset:10496
    ds_write_b128 v1, v[68:71] offset:26880
    s_waitcnt vmcnt(10)
    v_mov_b32 v123, s45
    v_mov_b32 v124, 0x007f007f
    v_mov_b32 v125, 0xe000
    v_mov_b32 v126, 0xffff0000
    v_lshlrev_b32 v117, 16, v52
    v_and_b32 v118, v126, v52
    v_mul_f32 v117, v123, v117
    v_mul_f32 v118, v123, v118
    v_cvt_pk_bf16_f32 v117, v117, v118
    v_and_b32 v118, v126, v117
    v_lshlrev_b32 v117, 16, v117
    v_mul_f32 v117, 0.15915494, v117
    v_mul_f32 v118, 0.15915494, v118
    v_fract_f32 v117, v117
    v_fract_f32 v118, v118
    v_cos_f32 v117, v117
    v_cos_f32 v118, v118
    v_mul_hi_u32_u24 v120, s36, v4
    v_mul_hi_u32_u24 v121, s37, v4
    v_mul_hi_u32_u24 v122, s38, v28
    v_mad_i32_i24 v67, v120, s39, v4
    v_mad_u32_u24 v92, v122, 40, v121
    v_mad_i32_i24 v120, v121, -3, v120
    v_lshlrev_b16 v92, 2, v92
    v_mad_i32_i24 v122, v122, s44, v28
    ds_add_u32 v92, v3 offset:0
    v_lshl_or_b32 v67, v120, 30, v67
    v_lshl_or_b32 v67, v122, 16, v67
    v_mul_f32 v117, 0x03800000, v117
    v_mul_f32 v118, 0x03800000, v118
    v_cvt_pk_bf16_f32 v117, v117, v118
    v_mul_hi_u32_u24 v120, s36, v5
    v_mul_hi_u32_u24 v121, s37, v5
    v_mul_hi_u32_u24 v122, s38, v29
    v_mad_i32_i24 v68, v120, s39, v5
    v_mad_u32_u24 v93, v122, 40, v121
    v_mad_i32_i24 v120, v121, -3, v120
    v_lshlrev_b16 v93, 2, v93
    v_mad_i32_i24 v122, v122, s44, v29
    ds_add_u32 v93, v3 offset:0
    v_lshl_or_b32 v68, v120, 30, v68
    v_lshl_or_b32 v68, v122, 16, v68
    v_lshrrev_b32 v118, 3, v117
    v_lshrrev_b32 v119, 8, v117
    v_lshlrev_b16 v117, 13, v117
    v_bitop3_b32 v119, v118, v119, v124 bitop3:0x1b
    v_bitop3_b32 v67, v117, v125, v67 bitop3:0xae
    v_lshl_or_b32 v92, v119, 16, v92
    v_bitop3_b32 v68, v118, v125, v68 bitop3:0xae
    v_bitop3_b32 v93, v119, v126, v93 bitop3:0xea
    v_lshlrev_b32 v117, 16, v53
    v_and_b32 v118, v126, v53
    v_mul_f32 v117, v123, v117
    v_mul_f32 v118, v123, v118
    v_cvt_pk_bf16_f32 v117, v117, v118
    v_and_b32 v118, v126, v117
    v_lshlrev_b32 v117, 16, v117
    v_mul_f32 v117, 0.15915494, v117
    v_mul_f32 v118, 0.15915494, v118
    v_fract_f32 v117, v117
    v_fract_f32 v118, v118
    v_cos_f32 v117, v117
    v_cos_f32 v118, v118
    v_mul_hi_u32_u24 v120, s36, v6
    v_mul_hi_u32_u24 v121, s37, v6
    v_mul_hi_u32_u24 v122, s38, v30
    v_mad_i32_i24 v69, v120, s39, v6
    v_mad_u32_u24 v94, v122, 40, v121
    v_mad_i32_i24 v120, v121, -3, v120
    v_lshlrev_b16 v94, 2, v94
    v_mad_i32_i24 v122, v122, s44, v30
    ds_add_u32 v94, v3 offset:0
    v_lshl_or_b32 v69, v120, 30, v69
    v_lshl_or_b32 v69, v122, 16, v69
    v_mul_f32 v117, 0x03800000, v117
    v_mul_f32 v118, 0x03800000, v118
    v_cvt_pk_bf16_f32 v117, v117, v118
    v_mul_hi_u32_u24 v120, s36, v7
    v_mul_hi_u32_u24 v121, s37, v7
    v_mul_hi_u32_u24 v122, s38, v31
    v_mad_i32_i24 v70, v120, s39, v7
    v_mad_u32_u24 v95, v122, 40, v121
    v_mad_i32_i24 v120, v121, -3, v120
    v_lshlrev_b16 v95, 2, v95
    v_mad_i32_i24 v122, v122, s44, v31
    ds_add_u32 v95, v3 offset:0
    v_lshl_or_b32 v70, v120, 30, v70
    v_lshl_or_b32 v70, v122, 16, v70
    v_lshrrev_b32 v118, 3, v117
    v_lshrrev_b32 v119, 8, v117
    v_lshlrev_b16 v117, 13, v117
    v_bitop3_b32 v119, v118, v119, v124 bitop3:0x1b
    v_bitop3_b32 v69, v117, v125, v69 bitop3:0xae
    v_lshl_or_b32 v94, v119, 16, v94
    v_bitop3_b32 v70, v118, v125, v70 bitop3:0xae
    v_bitop3_b32 v95, v119, v126, v95 bitop3:0xea
    v_lshlrev_b32 v117, 16, v54
    v_and_b32 v118, v126, v54
    v_mul_f32 v117, v123, v117
    v_mul_f32 v118, v123, v118
    v_cvt_pk_bf16_f32 v117, v117, v118
    v_and_b32 v118, v126, v117
    v_lshlrev_b32 v117, 16, v117
    v_mul_f32 v117, 0.15915494, v117
    v_mul_f32 v118, 0.15915494, v118
    v_fract_f32 v117, v117
    v_fract_f32 v118, v118
    v_cos_f32 v117, v117
    v_cos_f32 v118, v118
    v_mul_hi_u32_u24 v120, s36, v8
    v_mul_hi_u32_u24 v121, s37, v8
    v_mul_hi_u32_u24 v122, s38, v32
    v_mad_i32_i24 v71, v120, s39, v8
    v_mad_u32_u24 v96, v122, 40, v121
    v_mad_i32_i24 v120, v121, -3, v120
    v_lshlrev_b16 v96, 2, v96
    v_mad_i32_i24 v122, v122, s44, v32
    ds_add_u32 v96, v3 offset:0
    v_lshl_or_b32 v71, v120, 30, v71
    v_lshl_or_b32 v71, v122, 16, v71
    v_mul_f32 v117, 0x03800000, v117
    v_mul_f32 v118, 0x03800000, v118
    v_cvt_pk_bf16_f32 v117, v117, v118
    v_mul_hi_u32_u24 v120, s36, v9
    v_mul_hi_u32_u24 v121, s37, v9
    v_mul_hi_u32_u24 v122, s38, v33
    v_mad_i32_i24 v72, v120, s39, v9
    v_mad_u32_u24 v97, v122, 40, v121
    v_mad_i32_i24 v120, v121, -3, v120
    v_lshlrev_b16 v97, 2, v97
    v_mad_i32_i24 v122, v122, s44, v33
    ds_add_u32 v97, v3 offset:0
    v_lshl_or_b32 v72, v120, 30, v72
    v_lshl_or_b32 v72, v122, 16, v72
    v_lshrrev_b32 v118, 3, v117
    v_lshrrev_b32 v119, 8, v117
    v_lshlrev_b16 v117, 13, v117
    v_bitop3_b32 v119, v118, v119, v124 bitop3:0x1b
    v_bitop3_b32 v71, v117, v125, v71 bitop3:0xae
    v_lshl_or_b32 v96, v119, 16, v96
    v_bitop3_b32 v72, v118, v125, v72 bitop3:0xae
    v_bitop3_b32 v97, v119, v126, v97 bitop3:0xea
    v_lshlrev_b32 v117, 16, v55
    v_and_b32 v118, v126, v55
    v_mul_f32 v117, v123, v117
    v_mul_f32 v118, v123, v118
    v_cvt_pk_bf16_f32 v117, v117, v118
    v_and_b32 v118, v126, v117
    v_lshlrev_b32 v117, 16, v117
    v_mul_f32 v117, 0.15915494, v117
    v_mul_f32 v118, 0.15915494, v118
    v_fract_f32 v117, v117
    v_fract_f32 v118, v118
    v_cos_f32 v117, v117
    v_cos_f32 v118, v118
    v_mul_hi_u32_u24 v120, s36, v10
    v_mul_hi_u32_u24 v121, s37, v10
    v_mul_hi_u32_u24 v122, s38, v34
    v_mad_i32_i24 v73, v120, s39, v10
    v_mad_u32_u24 v98, v122, 40, v121
    v_mad_i32_i24 v120, v121, -3, v120
    v_lshlrev_b16 v98, 2, v98
    v_mad_i32_i24 v122, v122, s44, v34
    ds_add_u32 v98, v3 offset:0
    v_lshl_or_b32 v73, v120, 30, v73
    v_lshl_or_b32 v73, v122, 16, v73
    v_mul_f32 v117, 0x03800000, v117
    v_mul_f32 v118, 0x03800000, v118
    v_cvt_pk_bf16_f32 v117, v117, v118
    v_mul_hi_u32_u24 v120, s36, v11
    v_mul_hi_u32_u24 v121, s37, v11
    v_mul_hi_u32_u24 v122, s38, v35
    v_mad_i32_i24 v74, v120, s39, v11
    v_mad_u32_u24 v99, v122, 40, v121
    v_mad_i32_i24 v120, v121, -3, v120
    v_lshlrev_b16 v99, 2, v99
    v_mad_i32_i24 v122, v122, s44, v35
    ds_add_u32 v99, v3 offset:0
    v_lshl_or_b32 v74, v120, 30, v74
    v_lshl_or_b32 v74, v122, 16, v74
    v_lshrrev_b32 v118, 3, v117
    v_lshrrev_b32 v119, 8, v117
    v_lshlrev_b16 v117, 13, v117
    v_bitop3_b32 v119, v118, v119, v124 bitop3:0x1b
    v_bitop3_b32 v73, v117, v125, v73 bitop3:0xae
    v_lshl_or_b32 v98, v119, 16, v98
    v_bitop3_b32 v74, v118, v125, v74 bitop3:0xae
    v_bitop3_b32 v99, v119, v126, v99 bitop3:0xea
    s_waitcnt lgkmcnt(4)
    s_cmp_ge_u32 s68, 2048
    s_cbranch_scc1 p1_nl0
    s_add_u32 s32, s30, 0
    buffer_load_dwordx4 v[4:7], v1, s[4:7], s32 offen nt
    buffer_load_dwordx4 v[28:31], v1, s[8:11], s32 offen nt
    s_add_u32 s32, s31, 0
    buffer_load_dwordx2 v[52:53], v2, s[12:15], s32 offen nt
p1_nl0:
    v_lshlrev_b32 v117, 16, v56
    v_and_b32 v118, v126, v56
    v_mul_f32 v117, v123, v117
    v_mul_f32 v118, v123, v118
    v_cvt_pk_bf16_f32 v117, v117, v118
    v_and_b32 v118, v126, v117
    v_lshlrev_b32 v117, 16, v117
    v_mul_f32 v117, 0.15915494, v117
    v_mul_f32 v118, 0.15915494, v118
    v_fract_f32 v117, v117
    v_fract_f32 v118, v118
    v_cos_f32 v117, v117
    v_cos_f32 v118, v118
    v_mul_hi_u32_u24 v120, s36, v12
    v_mul_hi_u32_u24 v121, s37, v12
    v_mul_hi_u32_u24 v122, s38, v36
    v_mad_i32_i24 v75, v120, s39, v12
    v_mad_u32_u24 v100, v122, 40, v121
    v_mad_i32_i24 v120, v121, -3, v120
    v_lshlrev_b16 v100, 2, v100
    v_mad_i32_i24 v122, v122, s44, v36
    ds_add_u32 v100, v3 offset:0
    v_lshl_or_b32 v75, v120, 30, v75
    v_lshl_or_b32 v75, v122, 16, v75
    v_mul_f32 v117, 0x03800000, v117
    v_mul_f32 v118, 0x03800000, v118
    v_cvt_pk_bf16_f32 v117, v117, v118
    v_mul_hi_u32_u24 v120, s36, v13
    v_mul_hi_u32_u24 v121, s37, v13
    v_mul_hi_u32_u24 v122, s38, v37
    v_mad_i32_i24 v76, v120, s39, v13
    v_mad_u32_u24 v101, v122, 40, v121
    v_mad_i32_i24 v120, v121, -3, v120
    v_lshlrev_b16 v101, 2, v101
    v_mad_i32_i24 v122, v122, s44, v37
    ds_add_u32 v101, v3 offset:0
    v_lshl_or_b32 v76, v120, 30, v76
    v_lshl_or_b32 v76, v122, 16, v76
    v_lshrrev_b32 v118, 3, v117
    v_lshrrev_b32 v119, 8, v117
    v_lshlrev_b16 v117, 13, v117
    v_bitop3_b32 v119, v118, v119, v124 bitop3:0x1b
    v_bitop3_b32 v75, v117, v125, v75 bitop3:0xae
    v_lshl_or_b32 v100, v119, 16, v100
    v_bitop3_b32 v76, v118, v125, v76 bitop3:0xae
    v_bitop3_b32 v101, v119, v126, v101 bitop3:0xea
    v_lshlrev_b32 v117, 16, v57
    v_and_b32 v118, v126, v57
    v_mul_f32 v117, v123, v117
    v_mul_f32 v118, v123, v118
    v_cvt_pk_bf16_f32 v117, v117, v118
    v_and_b32 v118, v126, v117
    v_lshlrev_b32 v117, 16, v117
    v_mul_f32 v117, 0.15915494, v117
    v_mul_f32 v118, 0.15915494, v118
    v_fract_f32 v117, v117
    v_fract_f32 v118, v118
    v_cos_f32 v117, v117
    v_cos_f32 v118, v118
    v_mul_hi_u32_u24 v120, s36, v14
    v_mul_hi_u32_u24 v121, s37, v14
    v_mul_hi_u32_u24 v122, s38, v38
    v_mad_i32_i24 v77, v120, s39, v14
    v_mad_u32_u24 v102, v122, 40, v121
    v_mad_i32_i24 v120, v121, -3, v120
    v_lshlrev_b16 v102, 2, v102
    v_mad_i32_i24 v122, v122, s44, v38
    ds_add_u32 v102, v3 offset:0
    v_lshl_or_b32 v77, v120, 30, v77
    v_lshl_or_b32 v77, v122, 16, v77
    v_mul_f32 v117, 0x03800000, v117
    v_mul_f32 v118, 0x03800000, v118
    v_cvt_pk_bf16_f32 v117, v117, v118
    v_mul_hi_u32_u24 v120, s36, v15
    v_mul_hi_u32_u24 v121, s37, v15
    v_mul_hi_u32_u24 v122, s38, v39
    v_mad_i32_i24 v78, v120, s39, v15
    v_mad_u32_u24 v103, v122, 40, v121
    v_mad_i32_i24 v120, v121, -3, v120
    v_lshlrev_b16 v103, 2, v103
    v_mad_i32_i24 v122, v122, s44, v39
    ds_add_u32 v103, v3 offset:0
    v_lshl_or_b32 v78, v120, 30, v78
    v_lshl_or_b32 v78, v122, 16, v78
    v_lshrrev_b32 v118, 3, v117
    v_lshrrev_b32 v119, 8, v117
    v_lshlrev_b16 v117, 13, v117
    v_bitop3_b32 v119, v118, v119, v124 bitop3:0x1b
    v_bitop3_b32 v77, v117, v125, v77 bitop3:0xae
    v_lshl_or_b32 v102, v119, 16, v102
    v_bitop3_b32 v78, v118, v125, v78 bitop3:0xae
    v_bitop3_b32 v103, v119, v126, v103 bitop3:0xea
    v_lshlrev_b32 v117, 16, v58
    v_and_b32 v118, v126, v58
    v_mul_f32 v117, v123, v117
    v_mul_f32 v118, v123, v118
    v_cvt_pk_bf16_f32 v117, v117, v118
    v_and_b32 v118, v126, v117
    v_lshlrev_b32 v117, 16, v117
    v_mul_f32 v117, 0.15915494, v117
    v_mul_f32 v118, 0.15915494, v118
    v_fract_f32 v117, v117
    v_fract_f32 v118, v118
    v_cos_f32 v117, v117
    v_cos_f32 v118, v118
    v_mul_hi_u32_u24 v120, s36, v16
    v_mul_hi_u32_u24 v121, s37, v16
    v_mul_hi_u32_u24 v122, s38, v40
    v_mad_i32_i24 v79, v120, s39, v16
    v_mad_u32_u24 v104, v122, 40, v121
    v_mad_i32_i24 v120, v121, -3, v120
    v_lshlrev_b16 v104, 2, v104
    v_mad_i32_i24 v122, v122, s44, v40
    ds_add_u32 v104, v3 offset:0
    v_lshl_or_b32 v79, v120, 30, v79
    v_lshl_or_b32 v79, v122, 16, v79
    v_mul_f32 v117, 0x03800000, v117
    v_mul_f32 v118, 0x03800000, v118
    v_cvt_pk_bf16_f32 v117, v117, v118
    v_mul_hi_u32_u24 v120, s36, v17
    v_mul_hi_u32_u24 v121, s37, v17
    v_mul_hi_u32_u24 v122, s38, v41
    v_mad_i32_i24 v80, v120, s39, v17
    v_mad_u32_u24 v105, v122, 40, v121
    v_mad_i32_i24 v120, v121, -3, v120
    v_lshlrev_b16 v105, 2, v105
    v_mad_i32_i24 v122, v122, s44, v41
    ds_add_u32 v105, v3 offset:0
    v_lshl_or_b32 v80, v120, 30, v80
    v_lshl_or_b32 v80, v122, 16, v80
    v_lshrrev_b32 v118, 3, v117
    v_lshrrev_b32 v119, 8, v117
    v_lshlrev_b16 v117, 13, v117
    v_bitop3_b32 v119, v118, v119, v124 bitop3:0x1b
    v_bitop3_b32 v79, v117, v125, v79 bitop3:0xae
    v_lshl_or_b32 v104, v119, 16, v104
    v_bitop3_b32 v80, v118, v125, v80 bitop3:0xae
    v_bitop3_b32 v105, v119, v126, v105 bitop3:0xea
    v_lshlrev_b32 v117, 16, v59
    v_and_b32 v118, v126, v59
    v_mul_f32 v117, v123, v117
    v_mul_f32 v118, v123, v118
    v_cvt_pk_bf16_f32 v117, v117, v118
    v_and_b32 v118, v126, v117
    v_lshlrev_b32 v117, 16, v117
    v_mul_f32 v117, 0.15915494, v117
    v_mul_f32 v118, 0.15915494, v118
    v_fract_f32 v117, v117
    v_fract_f32 v118, v118
    v_cos_f32 v117, v117
    v_cos_f32 v118, v118
    v_mul_hi_u32_u24 v120, s36, v18
    v_mul_hi_u32_u24 v121, s37, v18
    v_mul_hi_u32_u24 v122, s38, v42
    v_mad_i32_i24 v81, v120, s39, v18
    v_mad_u32_u24 v106, v122, 40, v121
    v_mad_i32_i24 v120, v121, -3, v120
    v_lshlrev_b16 v106, 2, v106
    v_mad_i32_i24 v122, v122, s44, v42
    ds_add_u32 v106, v3 offset:0
    v_lshl_or_b32 v81, v120, 30, v81
    v_lshl_or_b32 v81, v122, 16, v81
    v_mul_f32 v117, 0x03800000, v117
    v_mul_f32 v118, 0x03800000, v118
    v_cvt_pk_bf16_f32 v117, v117, v118
    v_mul_hi_u32_u24 v120, s36, v19
    v_mul_hi_u32_u24 v121, s37, v19
    v_mul_hi_u32_u24 v122, s38, v43
    v_mad_i32_i24 v82, v120, s39, v19
    v_mad_u32_u24 v107, v122, 40, v121
    v_mad_i32_i24 v120, v121, -3, v120
    v_lshlrev_b16 v107, 2, v107
    v_mad_i32_i24 v122, v122, s44, v43
    ds_add_u32 v107, v3 offset:0
    v_lshl_or_b32 v82, v120, 30, v82
    v_lshl_or_b32 v82, v122, 16, v82
    v_lshrrev_b32 v118, 3, v117
    v_lshrrev_b32 v119, 8, v117
    v_lshlrev_b16 v117, 13, v117
    v_bitop3_b32 v119, v118, v119, v124 bitop3:0x1b
    v_bitop3_b32 v81, v117, v125, v81 bitop3:0xae
    v_lshl_or_b32 v106, v119, 16, v106
    v_bitop3_b32 v82, v118, v125, v82 bitop3:0xae
    v_bitop3_b32 v107, v119, v126, v107 bitop3:0xea
    s_waitcnt lgkmcnt(4)
    s_cmp_ge_u32 s68, 2048
    s_cbranch_scc1 p1_nl1
    s_add_u32 s32, s30, 16384
    buffer_load_dwordx4 v[8:11], v1, s[4:7], s32 offen nt
    buffer_load_dwordx4 v[32:35], v1, s[8:11], s32 offen nt
    s_add_u32 s32, s31, 8192
    buffer_load_dwordx2 v[54:55], v2, s[12:15], s32 offen nt
p1_nl1:
    v_lshlrev_b32 v117, 16, v60
    v_and_b32 v118, v126, v60
    v_mul_f32 v117, v123, v117
    v_mul_f32 v118, v123, v118
    v_cvt_pk_bf16_f32 v117, v117, v118
    v_and_b32 v118, v126, v117
    v_lshlrev_b32 v117, 16, v117
    v_mul_f32 v117, 0.15915494, v117
    v_mul_f32 v118, 0.15915494, v118
    v_fract_f32 v117, v117
    v_fract_f32 v118, v118
    v_cos_f32 v117, v117
    v_cos_f32 v118, v118
    v_mul_hi_u32_u24 v120, s36, v20
    v_mul_hi_u32_u24 v121, s37, v20
    v_mul_hi_u32_u24 v122, s38, v44
    v_mad_i32_i24 v83, v120, s39, v20
    v_mad_u32_u24 v108, v122, 40, v121
    v_mad_i32_i24 v120, v121, -3, v120
    v_lshlrev_b16 v108, 2, v108
    v_mad_i32_i24 v122, v122, s44, v44
    ds_add_u32 v108, v3 offset:0
    v_lshl_or_b32 v83, v120, 30, v83
    v_lshl_or_b32 v83, v122, 16, v83
    v_mul_f32 v117, 0x03800000, v117
    v_mul_f32 v118, 0x03800000, v118
    v_cvt_pk_bf16_f32 v117, v117, v118
    v_mul_hi_u32_u24 v120, s36, v21
    v_mul_hi_u32_u24 v121, s37, v21
    v_mul_hi_u32_u24 v122, s38, v45
    v_mad_i32_i24 v84, v120, s39, v21
    v_mad_u32_u24 v109, v122, 40, v121
    v_mad_i32_i24 v120, v121, -3, v120
    v_lshlrev_b16 v109, 2, v109
    v_mad_i32_i24 v122, v122, s44, v45
    ds_add_u32 v109, v3 offset:0
    v_lshl_or_b32 v84, v120, 30, v84
    v_lshl_or_b32 v84, v122, 16, v84
    v_lshrrev_b32 v118, 3, v117
    v_lshrrev_b32 v119, 8, v117
    v_lshlrev_b16 v117, 13, v117
    v_bitop3_b32 v119, v118, v119, v124 bitop3:0x1b
    v_bitop3_b32 v83, v117, v125, v83 bitop3:0xae
    v_lshl_or_b32 v108, v119, 16, v108
    v_bitop3_b32 v84, v118, v125, v84 bitop3:0xae
    v_bitop3_b32 v109, v119, v126, v109 bitop3:0xea
    v_lshlrev_b32 v117, 16, v61
    v_and_b32 v118, v126, v61
    v_mul_f32 v117, v123, v117
    v_mul_f32 v118, v123, v118
    v_cvt_pk_bf16_f32 v117, v117, v118
    v_and_b32 v118, v126, v117
    v_lshlrev_b32 v117, 16, v117
    v_mul_f32 v117, 0.15915494, v117
    v_mul_f32 v118, 0.15915494, v118
    v_fract_f32 v117, v117
    v_fract_f32 v118, v118
    v_cos_f32 v117, v117
    v_cos_f32 v118, v118
    v_mul_hi_u32_u24 v120, s36, v22
    v_mul_hi_u32_u24 v121, s37, v22
    v_mul_hi_u32_u24 v122, s38, v46
    v_mad_i32_i24 v85, v120, s39, v22
    v_mad_u32_u24 v110, v122, 40, v121
    v_mad_i32_i24 v120, v121, -3, v120
    v_lshlrev_b16 v110, 2, v110
    v_mad_i32_i24 v122, v122, s44, v46
    ds_add_u32 v110, v3 offset:0
    v_lshl_or_b32 v85, v120, 30, v85
    v_lshl_or_b32 v85, v122, 16, v85
    v_mul_f32 v117, 0x03800000, v117
    v_mul_f32 v118, 0x03800000, v118
    v_cvt_pk_bf16_f32 v117, v117, v118
    v_mul_hi_u32_u24 v120, s36, v23
    v_mul_hi_u32_u24 v121, s37, v23
    v_mul_hi_u32_u24 v122, s38, v47
    v_mad_i32_i24 v86, v120, s39, v23
    v_mad_u32_u24 v111, v122, 40, v121
    v_mad_i32_i24 v120, v121, -3, v120
    v_lshlrev_b16 v111, 2, v111
    v_mad_i32_i24 v122, v122, s44, v47
    ds_add_u32 v111, v3 offset:0
    v_lshl_or_b32 v86, v120, 30, v86
    v_lshl_or_b32 v86, v122, 16, v86
    v_lshrrev_b32 v118, 3, v117
    v_lshrrev_b32 v119, 8, v117
    v_lshlrev_b16 v117, 13, v117
    v_bitop3_b32 v119, v118, v119, v124 bitop3:0x1b
    v_bitop3_b32 v85, v117, v125, v85 bitop3:0xae
    v_lshl_or_b32 v110, v119, 16, v110
    v_bitop3_b32 v86, v118, v125, v86 bitop3:0xae
    v_bitop3_b32 v111, v119, v126, v111 bitop3:0xea
    v_lshlrev_b32 v117, 16, v62
    v_and_b32 v118, v126, v62
    v_mul_f32 v117, v123, v117
    v_mul_f32 v118, v123, v118
    v_cvt_pk_bf16_f32 v117, v117, v118
    v_and_b32 v118, v126, v117
    v_lshlrev_b32 v117, 16, v117
    v_mul_f32 v117, 0.15915494, v117
    v_mul_f32 v118, 0.15915494, v118
    v_fract_f32 v117, v117
    v_fract_f32 v118, v118
    v_cos_f32 v117, v117
    v_cos_f32 v118, v118
    v_mul_hi_u32_u24 v120, s36, v24
    v_mul_hi_u32_u24 v121, s37, v24
    v_mul_hi_u32_u24 v122, s38, v48
    v_mad_i32_i24 v87, v120, s39, v24
    v_mad_u32_u24 v112, v122, 40, v121
    v_mad_i32_i24 v120, v121, -3, v120
    v_lshlrev_b16 v112, 2, v112
    v_mad_i32_i24 v122, v122, s44, v48
    ds_add_u32 v112, v3 offset:0
    v_lshl_or_b32 v87, v120, 30, v87
    v_lshl_or_b32 v87, v122, 16, v87
    v_mul_f32 v117, 0x03800000, v117
    v_mul_f32 v118, 0x03800000, v118
    v_cvt_pk_bf16_f32 v117, v117, v118
    v_mul_hi_u32_u24 v120, s36, v25
    v_mul_hi_u32_u24 v121, s37, v25
    v_mul_hi_u32_u24 v122, s38, v49
    v_mad_i32_i24 v88, v120, s39, v25
    v_mad_u32_u24 v113, v122, 40, v121
    v_mad_i32_i24 v120, v121, -3, v120
    v_lshlrev_b16 v113, 2, v113
    v_mad_i32_i24 v122, v122, s44, v49
    ds_add_u32 v113, v3 offset:0
    v_lshl_or_b32 v88, v120, 30, v88
    v_lshl_or_b32 v88, v122, 16, v88
    v_lshrrev_b32 v118, 3, v117
    v_lshrrev_b32 v119, 8, v117
    v_lshlrev_b16 v117, 13, v117
    v_bitop3_b32 v119, v118, v119, v124 bitop3:0x1b
    v_bitop3_b32 v87, v117, v125, v87 bitop3:0xae
    v_lshl_or_b32 v112, v119, 16, v112
    v_bitop3_b32 v88, v118, v125, v88 bitop3:0xae
    v_bitop3_b32 v113, v119, v126, v113 bitop3:0xea
    v_lshlrev_b32 v117, 16, v63
    v_and_b32 v118, v126, v63
    v_mul_f32 v117, v123, v117
    v_mul_f32 v118, v123, v118
    v_cvt_pk_bf16_f32 v117, v117, v118
    v_and_b32 v118, v126, v117
    v_lshlrev_b32 v117, 16, v117
    v_mul_f32 v117, 0.15915494, v117
    v_mul_f32 v118, 0.15915494, v118
    v_fract_f32 v117, v117
    v_fract_f32 v118, v118
    v_cos_f32 v117, v117
    v_cos_f32 v118, v118
    v_mul_hi_u32_u24 v120, s36, v26
    v_mul_hi_u32_u24 v121, s37, v26
    v_mul_hi_u32_u24 v122, s38, v50
    v_mad_i32_i24 v89, v120, s39, v26
    v_mad_u32_u24 v114, v122, 40, v121
    v_mad_i32_i24 v120, v121, -3, v120
    v_lshlrev_b16 v114, 2, v114
    v_mad_i32_i24 v122, v122, s44, v50
    ds_add_u32 v114, v3 offset:0
    v_lshl_or_b32 v89, v120, 30, v89
    v_lshl_or_b32 v89, v122, 16, v89
    v_mul_f32 v117, 0x03800000, v117
    v_mul_f32 v118, 0x03800000, v118
    v_cvt_pk_bf16_f32 v117, v117, v118
    v_mul_hi_u32_u24 v120, s36, v27
    v_mul_hi_u32_u24 v121, s37, v27
    v_mul_hi_u32_u24 v122, s38, v51
    v_mad_i32_i24 v90, v120, s39, v27
    v_mad_u32_u24 v115, v122, 40, v121
    v_mad_i32_i24 v120, v121, -3, v120
    v_lshlrev_b16 v115, 2, v115
    v_mad_i32_i24 v122, v122, s44, v51
    ds_add_u32 v115, v3 offset:0
    v_lshl_or_b32 v90, v120, 30, v90
    v_lshl_or_b32 v90, v122, 16, v90
    v_lshrrev_b32 v118, 3, v117
    v_lshrrev_b32 v119, 8, v117
    v_lshlrev_b16 v117, 13, v117
    v_bitop3_b32 v119, v118, v119, v124 bitop3:0x1b
    v_bitop3_b32 v89, v117, v125, v89 bitop3:0xae
    v_lshl_or_b32 v114, v119, 16, v114
    v_bitop3_b32 v90, v118, v125, v90 bitop3:0xae
    v_bitop3_b32 v115, v119, v126, v115 bitop3:0xea
    s_waitcnt lgkmcnt(4)
    s_cmp_ge_u32 s68, 2048
    s_cbranch_scc1 p1_nl2
    s_add_u32 s32, s30, 32768
    buffer_load_dwordx4 v[12:15], v1, s[4:7], s32 offen nt
    buffer_load_dwordx4 v[36:39], v1, s[8:11], s32 offen nt
    s_add_u32 s32, s31, 16384
    buffer_load_dwordx2 v[56:57], v2, s[12:15], s32 offen nt
p1_nl2:
    s_cmp_ge_u32 s28, s33
    s_cbranch_scc1 p1_r_done
    v_lshlrev_b32 v117, 16, v66
    v_and_b32 v118, v126, v66
    v_mul_f32 v117, v123, v117
    v_mul_f32 v118, v123, v118
    v_cvt_pk_bf16_f32 v117, v117, v118
    v_and_b32 v118, v126, v117
    v_lshlrev_b32 v117, 16, v117
    v_mul_f32 v117, 0.15915494, v117
    v_mul_f32 v118, 0.15915494, v118
    v_fract_f32 v117, v117
    v_fract_f32 v118, v118
    v_cos_f32 v117, v117
    v_cos_f32 v118, v118
    v_mul_hi_u32_u24 v120, s36, v64
    v_mul_hi_u32_u24 v121, s37, v64
    v_mul_hi_u32_u24 v122, s38, v65
    v_mad_i32_i24 v91, v120, s39, v64
    v_mad_u32_u24 v116, v122, 40, v121
    v_mad_i32_i24 v120, v121, -3, v120
    v_lshlrev_b16 v116, 2, v116
    v_mad_i32_i24 v122, v122, s44, v65
    ds_add_u32 v116, v3 offset:0
    v_lshl_or_b32 v91, v120, 30, v91
    v_lshl_or_b32 v91, v122, 16, v91
    v_mul_f32 v117, 0x03800000, v117
    v_mul_f32 v118, 0x03800000, v118
    v_cvt_pk_bf16_f32 v117, v117, v118
    v_lshrrev_b32 v118, 3, v117
    v_lshrrev_b32 v119, 8, v117
    v_lshlrev_b16 v117, 13, v117
    v_bitop3_b32 v119, v118, v119, v124 bitop3:0x1b
    v_bitop3_b32 v91, v117, v125, v91 bitop3:0xae
    v_lshl_or_b32 v116, v119, 16, v116
p1_r_done:
    s_waitcnt lgkmcnt(0)
    s_barrier
    s_cmp_ge_u32 s28, 10
    s_cbranch_scc1 p1_s1_skip
    v_and_b32 v126, 63, v0
    s_lshl_b32 s54, s28, 4
    v_mul_u32_u24 v117, 160, v126
    v_add_u32 v117, s54, v117
    ds_read_b128 v[118:121], v117 offset:0
    s_mov_b32 s55, 43691
    s_waitcnt lgkmcnt(0)
    v_add_u32 v118, 2, v118
    v_add_u32 v119, 2, v119
    v_add_u32 v120, 2, v120
    v_add_u32 v121, 2, v121
    v_mul_u32_u24 v118, s55, v118
    v_mul_u32_u24 v119, s55, v119
    v_mul_u32_u24 v120, s55, v120
    v_mul_u32_u24 v121, s55, v121
    v_lshrrev_b32 v118, 17, v118
    v_lshrrev_b32 v119, 17, v119
    v_lshrrev_b32 v120, 17, v120
    v_lshrrev_b32 v121, 17, v121
    v_lshl_or_b32 v122, v119, 16, v118
    v_lshl_or_b32 v123, v121, 16, v120
    v_mov_b32 v124, v122
    v_mov_b32 v125, v123
    s_nop 1
    v_add_u32_dpp v124, v124, v124 row_shr:1 row_mask:0xf bank_mask:0xf bound_ctrl:0
    v_add_u32_dpp v125, v125, v125 row_shr:1 row_mask:0xf bank_mask:0xf bound_ctrl:0
    s_nop 0
    v_add_u32_dpp v124, v124, v124 row_shr:2 row_mask:0xf bank_mask:0xf bound_ctrl:0
    v_add_u32_dpp v125, v125, v125 row_shr:2 row_mask:0xf bank_mask:0xf bound_ctrl:0
    s_nop 0
    v_add_u32_dpp v124, v124, v124 row_shr:4 row_mask:0xf bank_mask:0xf bound_ctrl:0
    v_add_u32_dpp v125, v125, v125 row_shr:4 row_mask:0xf bank_mask:0xf bound_ctrl:0
    s_nop 0
    v_add_u32_dpp v124, v124, v124 row_shr:8 row_mask:0xf bank_mask:0xf bound_ctrl:0
    v_add_u32_dpp v125, v125, v125 row_shr:8 row_mask:0xf bank_mask:0xf bound_ctrl:0
    s_nop 0
    v_add_u32_dpp v124, v124, v124 row_bcast:15 row_mask:0xa bank_mask:0xf
    v_add_u32_dpp v125, v125, v125 row_bcast:15 row_mask:0xa bank_mask:0xf
    s_nop 0
    v_add_u32_dpp v124, v124, v124 row_bcast:31 row_mask:0xc bank_mask:0xf
    v_add_u32_dpp v125, v125, v125 row_bcast:31 row_mask:0xc bank_mask:0xf
    s_nop 0
    s_nop 0
    v_mov_b32 v127, s54
    v_and_b32 v118, 0xffff, v124
    v_lshrrev_b32 v119, 16, v124
    v_and_b32 v120, 0xffff, v125
    v_lshrrev_b32 v121, 16, v125
    s_mov_b64 exec, 1
    s_lshl_b64 exec, exec, 63
    ds_write_b128 v127, v[118:121] offset:10240
    s_mov_b64 exec, -1
p1_s1_skip:
    s_waitcnt lgkmcnt(0)
    s_barrier
    v_and_b32 v127, 63, v0
    v_lshlrev_b32 v118, 2, v127
    v_cmp_gt_u32 vcc, 40, v127
    ds_read_b32 v119, v118 offset:10240
    s_waitcnt lgkmcnt(0)
    v_cndmask_b32 v119, 0, v119, vcc
    v_mov_b32 v120, v119
    s_nop 1
    v_add_u32_dpp v120, v120, v120 row_shr:1 row_mask:0xf bank_mask:0xf bound_ctrl:0
    s_nop 1
    v_add_u32_dpp v120, v120, v120 row_shr:2 row_mask:0xf bank_mask:0xf bound_ctrl:0
    s_nop 1
    v_add_u32_dpp v120, v120, v120 row_shr:4 row_mask:0xf bank_mask:0xf bound_ctrl:0
    s_nop 1
    v_add_u32_dpp v120, v120, v120 row_shr:8 row_mask:0xf bank_mask:0xf bound_ctrl:0
    s_nop 1
    v_add_u32_dpp v120, v120, v120 row_bcast:15 row_mask:0xa bank_mask:0xf
    s_nop 1
    v_add_u32_dpp v120, v120, v120 row_bcast:31 row_mask:0xc bank_mask:0xf
    s_nop 1
    s_nop 0
    v_sub_u32 v119, v120, v119
    v_readlane_b32 s35, v120, 63
    s_cmp_ge_u32 s28, 10
    s_cbranch_scc1 p1_s2_skip
    s_lshl_b32 s54, s28, 2
    s_add_u32 s55, s54, 0
    v_readlane_b32 s56, v119, s55
    s_add_u32 s55, s54, 1
    v_readlane_b32 s57, v119, s55
    s_add_u32 s55, s54, 2
    v_readlane_b32 s58, v119, s55
    s_add_u32 s55, s54, 3
    v_readlane_b32 s59, v119, s55
    s_nop 0
    s_lshl_b32 s57, s57, 16
    s_or_b32 s56, s56, s57
    s_lshl_b32 s59, s59, 16
    s_or_b32 s58, s58, s59
    v_add_u32 v124, s56, v124
    v_add_u32 v125, s58, v125
    v_sub_u32 v122, v124, v122
    v_sub_u32 v123, v125, v123
    v_and_b32 v118, 0xffff, v122
    v_lshrrev_b32 v119, 16, v122
    v_and_b32 v120, 0xffff, v123
    v_lshrrev_b32 v121, 16, v123
    v_mul_u32_u24 v118, 3, v118
    v_mul_u32_u24 v119, 3, v119
    v_mul_u32_u24 v120, 3, v120
    v_mul_u32_u24 v121, 3, v121
    ds_write_b128 v117, v[118:121] offset:0
    s_mul_i32 s55, s29, 5248
    s_mul_i32 s56, s28, 520
    s_add_u32 s55, s55, s56
    s_add_u32 s55, s55, 335544320
    v_lshlrev_b32 v127, 3, v126
    buffer_store_dwordx2 v[122:123], v127, s[16:19], s55 offen sc1
    s_mov_b64 exec, 1
    s_lshl_b64 exec, exec, 63
    buffer_store_dwordx2 v[124:125], v127, s[16:19], s55 offen offset:8 sc1
    s_mov_b64 exec, -1
p1_s2_skip:
    s_mul_i32 s51, s29, 16384
    s_lshr_b32 s52, s35, 10
    s_mul_i32 s52, s52, 33554432
    s_and_b32 s53, s35, 1023
    s_lshl_b32 s53, s53, 4
    s_add_u32 s52, s52, s53
    s_add_u32 s52, s52, s51
    s_min_u32 s22, s52, 335544320
    s_mov_b32 s70, 0
    s_waitcnt lgkmcnt(0)
    s_barrier
    s_cmp_ge_u32 s68, 2048
    s_cbranch_scc1 p1_prep0
    s_branch p1_tk0
p1_prep0:
    s_cmp_lg_u32 s28, 15
    s_cbranch_scc1 p1_hv0
    s_lshl_b32 s58, s68, 2
    s_and_b32 s58, s58, 28
    s_lshl_b32 s52, 1, s58
    v_mov_b32 v127, s52
    s_sub_u32 s52, s68, 2048
    s_lshr_b32 s52, s52, 3
    s_lshl_b32 s52, s52, 2
    s_mov_b64 exec, 1
    buffer_atomic_add v127, off, s[40:43], s52 sc0 sc1
    s_mov_b64 exec, -1
p1_hv0:
    s_cmp_ge_u32 s68, 2168
    s_cbranch_scc1 p1_tk0
    s_sub_u32 s52, s68, 2048
    s_mul_i32 s52, s52, 53368
    s_mul_i32 s53, s28, 3072
    s_add_u32 s53, s53, s52
    v_and_b32 v20, 63, v0
    v_lshl_add_u32 v21, v20, 2, s53
    s_lshl_b32 s53, s28, 9
    s_add_u32 s53, s53, s52
    s_add_u32 s53, s53, 49152
    s_cmp_lt_u32 s28, 9
    s_cselect_b32 s53, s53, 0x40000000
    v_lshl_add_u32 v22, v20, 2, s53
    buffer_load_dword v4, v21, s[24:27], 0 offen offset:0
    buffer_load_dword v5, v21, s[24:27], 0 offen offset:256
    buffer_load_dword v6, v21, s[24:27], 0 offen offset:512
    buffer_load_dword v7, v21, s[24:27], 0 offen offset:768
    buffer_load_dword v8, v21, s[24:27], 0 offen offset:1024
    buffer_load_dword v9, v21, s[24:27], 0 offen offset:1280
    buffer_load_dword v10, v21, s[24:27], 0 offen offset:1536
    buffer_load_dword v11, v21, s[24:27], 0 offen offset:1792
    buffer_load_dword v12, v21, s[24:27], 0 offen offset:2048
    buffer_load_dword v13, v21, s[24:27], 0 offen offset:2304
    buffer_load_dword v14, v21, s[24:27], 0 offen offset:2560
    buffer_load_dword v15, v21, s[24:27], 0 offen offset:2816
    buffer_load_dword v16, v22, s[24:27], 0 offen offset:0
    buffer_load_dword v17, v22, s[24:27], 0 offen offset:256
p1_tk0:
    v_and_b32 v117, 0xffff, v92
    ds_add_rtn_u32 v117, v117, v3 offset:0
    v_and_b32 v118, 0xffff, v93
    ds_add_rtn_u32 v118, v118, v3 offset:0
    v_and_b32 v119, 0xffff, v94
    ds_add_rtn_u32 v119, v119, v3 offset:0
    v_and_b32 v120, 0xffff, v95
    ds_add_rtn_u32 v120, v120, v3 offset:0
    s_cmp_ge_u32 s68, 2048
    s_cbranch_scc1 p1_nl3
    s_add_u32 s32, s30, 49152
    buffer_load_dwordx4 v[16:19], v1, s[4:7], s32 offen nt
    buffer_load_dwordx4 v[40:43], v1, s[8:11], s32 offen nt
    s_add_u32 s32, s31, 24576
    buffer_load_dwordx2 v[58:59], v2, s[12:15], s32 offen nt
p1_nl3:
    v_and_b32 v121, 0xffff, v96
    ds_add_rtn_u32 v121, v121, v3 offset:0
    v_and_b32 v122, 0xffff, v97
    ds_add_rtn_u32 v122, v122, v3 offset:0
    v_and_b32 v123, 0xffff, v98
    ds_add_rtn_u32 v123, v123, v3 offset:0
    v_and_b32 v124, 0xffff, v99
    ds_add_rtn_u32 v124, v124, v3 offset:0
    s_waitcnt lgkmcnt(4)
    ds_write_b8_d16_hi v117, v92 offset:10496
    v_lshlrev_b32 v117, 2, v117
    ds_write_b32 v117, v67 offset:40736
    ds_write_b8_d16_hi v118, v93 offset:10496
    v_lshlrev_b32 v118, 2, v118
    ds_write_b32 v118, v68 offset:40736
    ds_write_b8_d16_hi v119, v94 offset:10496
    v_lshlrev_b32 v119, 2, v119
    ds_write_b32 v119, v69 offset:40736
    ds_write_b8_d16_hi v120, v95 offset:10496
    v_lshlrev_b32 v120, 2, v120
    ds_write_b32 v120, v70 offset:40736
    s_cmp_ge_u32 s68, 2048
    s_cbranch_scc1 p1_nl4
    s_add_u32 s32, s30, 65536
    buffer_load_dwordx4 v[20:23], v1, s[4:7], s32 offen nt
    buffer_load_dwordx4 v[44:47], v1, s[8:11], s32 offen nt
    s_add_u32 s32, s31, 32768
    buffer_load_dwordx2 v[60:61], v2, s[12:15], s32 offen nt
p1_nl4:
    v_and_b32 v117, 0xffff, v100
    ds_add_rtn_u32 v117, v117, v3 offset:0
    v_and_b32 v118, 0xffff, v101
    ds_add_rtn_u32 v118, v118, v3 offset:0
    v_and_b32 v119, 0xffff, v102
    ds_add_rtn_u32 v119, v119, v3 offset:0
    v_and_b32 v120, 0xffff, v103
    ds_add_rtn_u32 v120, v120, v3 offset:0
    s_waitcnt lgkmcnt(4)
    ds_write_b8_d16_hi v121, v96 offset:10496
    v_lshlrev_b32 v121, 2, v121
    ds_write_b32 v121, v71 offset:40736
    ds_write_b8_d16_hi v122, v97 offset:10496
    v_lshlrev_b32 v122, 2, v122
    ds_write_b32 v122, v72 offset:40736
    ds_write_b8_d16_hi v123, v98 offset:10496
    v_lshlrev_b32 v123, 2, v123
    ds_write_b32 v123, v73 offset:40736
    ds_write_b8_d16_hi v124, v99 offset:10496
    v_lshlrev_b32 v124, 2, v124
    ds_write_b32 v124, v74 offset:40736
    v_and_b32 v121, 0xffff, v104
    ds_add_rtn_u32 v121, v121, v3 offset:0
    v_and_b32 v122, 0xffff, v105
    ds_add_rtn_u32 v122, v122, v3 offset:0
    v_and_b32 v123, 0xffff, v106
    ds_add_rtn_u32 v123, v123, v3 offset:0
    v_and_b32 v124, 0xffff, v107
    ds_add_rtn_u32 v124, v124, v3 offset:0
    s_waitcnt lgkmcnt(4)
    ds_write_b8_d16_hi v117, v100 offset:10496
    v_lshlrev_b32 v117, 2, v117
    ds_write_b32 v117, v75 offset:40736
    ds_write_b8_d16_hi v118, v101 offset:10496
    v_lshlrev_b32 v118, 2, v118
    ds_write_b32 v118, v76 offset:40736
    ds_write_b8_d16_hi v119, v102 offset:10496
    v_lshlrev_b32 v119, 2, v119
    ds_write_b32 v119, v77 offset:40736
    ds_write_b8_d16_hi v120, v103 offset:10496
    v_lshlrev_b32 v120, 2, v120
    ds_write_b32 v120, v78 offset:40736
    s_cmp_ge_u32 s68, 2048
    s_cbranch_scc1 p1_nl5
    s_add_u32 s32, s30, 81920
    buffer_load_dwordx4 v[24:27], v1, s[4:7], s32 offen nt
    buffer_load_dwordx4 v[48:51], v1, s[8:11], s32 offen nt
    s_add_u32 s32, s31, 40960
    buffer_load_dwordx2 v[62:63], v2, s[12:15], s32 offen nt
p1_nl5:
    v_and_b32 v117, 0xffff, v108
    ds_add_rtn_u32 v117, v117, v3 offset:0
    v_and_b32 v118, 0xffff, v109
    ds_add_rtn_u32 v118, v118, v3 offset:0
    v_and_b32 v119, 0xffff, v110
    ds_add_rtn_u32 v119, v119, v3 offset:0
    v_and_b32 v120, 0xffff, v111
    ds_add_rtn_u32 v120, v120, v3 offset:0
    s_waitcnt lgkmcnt(4)
    ds_write_b8_d16_hi v121, v104 offset:10496
    v_lshlrev_b32 v121, 2, v121
    ds_write_b32 v121, v79 offset:40736
    ds_write_b8_d16_hi v122, v105 offset:10496
    v_lshlrev_b32 v122, 2, v122
    ds_write_b32 v122, v80 offset:40736
    ds_write_b8_d16_hi v123, v106 offset:10496
    v_lshlrev_b32 v123, 2, v123
    ds_write_b32 v123, v81 offset:40736
    ds_write_b8_d16_hi v124, v107 offset:10496
    v_lshlrev_b32 v124, 2, v124
    ds_write_b32 v124, v82 offset:40736
    s_cmp_ge_u32 s28, 10
    s_cbranch_scc1 p1_jn
    s_cmp_lt_u32 s68, 2048
    s_cbranch_scc1 p1_vwj
    s_waitcnt vmcnt(0)
p1_vwj:
    s_waitcnt vmcnt(9)
    v_mov_b32 v125, 0
    s_mov_b64 exec, 1
    ds_add_rtn_u32 v125, v125, v3 offset:10432
    s_waitcnt lgkmcnt(0)
    v_readfirstlane_b32 s52, v125
    s_lshr_b32 s53, s29, 1
    s_and_b32 s53, s53, 28
    s_cmp_lg_u32 s52, 9
    s_cbranch_scc1 p1_jn1
    s_lshl_b32 s54, 1, s53
    v_mov_b32 v127, s54
    s_lshr_b32 s54, s29, 6
    s_lshl_b32 s54, s54, 2
    s_mov_b32 s70, 1
    buffer_atomic_add v127, off, s[40:43], s54 sc0 sc1
p1_jn1:
    s_mov_b64 exec, -1
p1_jn:
    s_cmp_ge_u32 s68, 2048
    s_cbranch_scc1 p1_nl6
    s_cmp_lt_u32 s28, s34
    s_cselect_b32 s46, 0, 0x40000000
    v_lshl_add_u32 v126, v0, 2, s46
    s_add_u32 s32, s30, 98304
    buffer_load_dword v64, v126, s[4:7], s32 offen nt
    buffer_load_dword v65, v126, s[8:11], s32 offen nt
    v_lshrrev_b32 v126, 1, v126
    s_add_u32 s32, s31, 49152
    buffer_load_ushort v66, v126, s[12:15], s32 offen nt
p1_nl6:
    v_and_b32 v121, 0xffff, v112
    ds_add_rtn_u32 v121, v121, v3 offset:0
    v_and_b32 v122, 0xffff, v113
    ds_add_rtn_u32 v122, v122, v3 offset:0
    v_and_b32 v123, 0xffff, v114
    ds_add_rtn_u32 v123, v123, v3 offset:0
    v_and_b32 v124, 0xffff, v115
    ds_add_rtn_u32 v124, v124, v3 offset:0
    s_waitcnt lgkmcnt(4)
    ds_write_b8_d16_hi v117, v108 offset:10496
    v_lshlrev_b32 v117, 2, v117
    ds_write_b32 v117, v83 offset:40736
    ds_write_b8_d16_hi v118, v109 offset:10496
    v_lshlrev_b32 v118, 2, v118
    ds_write_b32 v118, v84 offset:40736
    ds_write_b8_d16_hi v119, v110 offset:10496
    v_lshlrev_b32 v119, 2, v119
    ds_write_b32 v119, v85 offset:40736
    ds_write_b8_d16_hi v120, v111 offset:10496
    v_lshlrev_b32 v120, 2, v120
    ds_write_b32 v120, v86 offset:40736
    s_waitcnt lgkmcnt(0)
    ds_write_b8_d16_hi v121, v112 offset:10496
    v_lshlrev_b32 v121, 2, v121
    ds_write_b32 v121, v87 offset:40736
    ds_write_b8_d16_hi v122, v113 offset:10496
    v_lshlrev_b32 v122, 2, v122
    ds_write_b32 v122, v88 offset:40736
    ds_write_b8_d16_hi v123, v114 offset:10496
    v_lshlrev_b32 v123, 2, v123
    ds_write_b32 v123, v89 offset:40736
    ds_write_b8_d16_hi v124, v115 offset:10496
    v_lshlrev_b32 v124, 2, v124
    ds_write_b32 v124, v90 offset:40736
    s_cmp_ge_u32 s28, s33
    s_cbranch_scc1 p1_p_done
    v_and_b32 v125, 0xffff, v116
    ds_add_rtn_u32 v125, v125, v3 offset:0
    s_waitcnt lgkmcnt(0)
    ds_write_b8_d16_hi v125, v116 offset:10496
    v_lshlrev_b32 v125, 2, v125
    ds_write_b32 v125, v91 offset:40736
p1_p_done:
    s_cmp_eq_u32 s70, 0
    s_cbranch_scc1 p1_sg
    s_cmp_lt_u32 s68, 2048
    s_cbranch_scc1 p1_vws
    s_waitcnt vmcnt(0)
p1_vws:
    s_waitcnt vmcnt(3)
    v_bfe_u32 v127, v127, s53, 4
    v_mov_b32 v125, 0
    s_mov_b64 exec, 1
    ds_write_b32 v125, v127 offset:10452
    s_mov_b64 exec, -1
p1_sg:
    s_cmp_ge_u32 s68, 2048
    s_cbranch_scc1 p1_prep1
    s_branch p1_tk1
p1_prep1:
    s_cmp_lg_u32 s28, 15
    s_cbranch_scc1 p1_hv1
    s_waitcnt vmcnt(0)
    v_bfe_u32 v127, v127, s58, 4
    v_mov_b32 v125, 0
    s_mov_b64 exec, 1
    ds_write_b32 v125, v127 offset:10448
    s_mov_b64 exec, -1
p1_hv1:
    s_cmp_ge_u32 s68, 2168
    s_cbranch_scc1 p1_tk1
    s_sub_u32 s52, s68, 2048
    s_mul_i32 s53, s52, 53760
    s_add_u32 s53, s53, 356941824
    s_mul_i32 s54, s28, 3072
    v_lshl_add_u32 v21, v20, 4, s54
    s_lshl_b32 s54, s28, 9
    s_add_u32 s54, s54, 49152
    s_cmp_lt_u32 s28, 9
    s_cselect_b32 s54, s54, 0x40000000
    v_lshl_add_u32 v22, v20, 3, s54
    v_mov_b32 v24, 0
    v_mov_b32 v25, 0
    s_waitcnt vmcnt(0)
    buffer_store_dwordx4 v[4:7], v21, s[16:19], s53 offen offset:0
    buffer_store_dwordx4 v[8:11], v21, s[16:19], s53 offen offset:1024
    buffer_store_dwordx4 v[12:15], v21, s[16:19], s53 offen offset:2048
    buffer_store_dwordx2 v[16:17], v22, s[16:19], s53 offen
    v_and_b32 v26, 0x7fff7fff, v4
    v_pk_max_u16 v24, v24, v26
    v_lshlrev_b32 v27, 16, v26
    v_and_b32 v26, 0xffff0000, v26
    v_fmac_f32 v25, v27, v27
    v_fmac_f32 v25, v26, v26
    v_and_b32 v26, 0x7fff7fff, v5
    v_pk_max_u16 v24, v24, v26
    v_lshlrev_b32 v27, 16, v26
    v_and_b32 v26, 0xffff0000, v26
    v_fmac_f32 v25, v27, v27
    v_fmac_f32 v25, v26, v26
    v_and_b32 v26, 0x7fff7fff, v6
    v_pk_max_u16 v24, v24, v26
    v_lshlrev_b32 v27, 16, v26
    v_and_b32 v26, 0xffff0000, v26
    v_fmac_f32 v25, v27, v27
    v_fmac_f32 v25, v26, v26
    v_and_b32 v26, 0x7fff7fff, v7
    v_pk_max_u16 v24, v24, v26
    v_lshlrev_b32 v27, 16, v26
    v_and_b32 v26, 0xffff0000, v26
    v_fmac_f32 v25, v27, v27
    v_fmac_f32 v25, v26, v26
    v_and_b32 v26, 0x7fff7fff, v8
    v_pk_max_u16 v24, v24, v26
    v_lshlrev_b32 v27, 16, v26
    v_and_b32 v26, 0xffff0000, v26
    v_fmac_f32 v25, v27, v27
    v_fmac_f32 v25, v26, v26
    v_and_b32 v26, 0x7fff7fff, v9
    v_pk_max_u16 v24, v24, v26
    v_lshlrev_b32 v27, 16, v26
    v_and_b32 v26, 0xffff0000, v26
    v_fmac_f32 v25, v27, v27
    v_fmac_f32 v25, v26, v26
    v_and_b32 v26, 0x7fff7fff, v10
    v_pk_max_u16 v24, v24, v26
    v_lshlrev_b32 v27, 16, v26
    v_and_b32 v26, 0xffff0000, v26
    v_fmac_f32 v25, v27, v27
    v_fmac_f32 v25, v26, v26
    v_and_b32 v26, 0x7fff7fff, v11
    v_pk_max_u16 v24, v24, v26
    v_lshlrev_b32 v27, 16, v26
    v_and_b32 v26, 0xffff0000, v26
    v_fmac_f32 v25, v27, v27
    v_fmac_f32 v25, v26, v26
    v_and_b32 v26, 0x7fff7fff, v12
    v_pk_max_u16 v24, v24, v26
    v_lshlrev_b32 v27, 16, v26
    v_and_b32 v26, 0xffff0000, v26
    v_fmac_f32 v25, v27, v27
    v_fmac_f32 v25, v26, v26
    v_and_b32 v26, 0x7fff7fff, v13
    v_pk_max_u16 v24, v24, v26
    v_lshlrev_b32 v27, 16, v26
    v_and_b32 v26, 0xffff0000, v26
    v_fmac_f32 v25, v27, v27
    v_fmac_f32 v25, v26, v26
    v_and_b32 v26, 0x7fff7fff, v14
    v_pk_max_u16 v24, v24, v26
    v_lshlrev_b32 v27, 16, v26
    v_and_b32 v26, 0xffff0000, v26
    v_fmac_f32 v25, v27, v27
    v_fmac_f32 v25, v26, v26
    v_and_b32 v26, 0x7fff7fff, v15
    v_pk_max_u16 v24, v24, v26
    v_lshlrev_b32 v27, 16, v26
    v_and_b32 v26, 0xffff0000, v26
    v_fmac_f32 v25, v27, v27
    v_fmac_f32 v25, v26, v26
    v_and_b32 v26, 0x7fff7fff, v16
    v_pk_max_u16 v24, v24, v26
    v_lshlrev_b32 v27, 16, v26
    v_and_b32 v26, 0xffff0000, v26
    v_fmac_f32 v25, v27, v27
    v_fmac_f32 v25, v26, v26
    v_and_b32 v26, 0x7fff7fff, v17
    v_pk_max_u16 v24, v24, v26
    v_lshlrev_b32 v27, 16, v26
    v_and_b32 v26, 0xffff0000, v26
    v_fmac_f32 v25, v27, v27
    v_fmac_f32 v25, v26, v26
    v_lshrrev_b32 v26, 16, v24
    v_and_b32 v24, 0xffff, v24
    v_max_u32 v24, v24, v26
    s_nop 1
    v_max_u32_dpp v24, v24, v24 row_shr:1 row_mask:0xf bank_mask:0xf bound_ctrl:0
    v_add_f32_dpp v25, v25, v25 row_shr:1 row_mask:0xf bank_mask:0xf bound_ctrl:0
    s_nop 0
    v_max_u32_dpp v24, v24, v24 row_shr:2 row_mask:0xf bank_mask:0xf bound_ctrl:0
    v_add_f32_dpp v25, v25, v25 row_shr:2 row_mask:0xf bank_mask:0xf bound_ctrl:0
    s_nop 0
    v_max_u32_dpp v24, v24, v24 row_shr:4 row_mask:0xf bank_mask:0xf bound_ctrl:0
    v_add_f32_dpp v25, v25, v25 row_shr:4 row_mask:0xf bank_mask:0xf bound_ctrl:0
    s_nop 0
    v_max_u32_dpp v24, v24, v24 row_shr:8 row_mask:0xf bank_mask:0xf bound_ctrl:0
    v_add_f32_dpp v25, v25, v25 row_shr:8 row_mask:0xf bank_mask:0xf bound_ctrl:0
    s_nop 0
    v_max_u32_dpp v24, v24, v24 row_bcast:15 row_mask:0xa bank_mask:0xf
    v_add_f32_dpp v25, v25, v25 row_bcast:15 row_mask:0xa bank_mask:0xf
    s_nop 0
    v_max_u32_dpp v24, v24, v24 row_bcast:31 row_mask:0xc bank_mask:0xf
    v_add_f32_dpp v25, v25, v25 row_bcast:31 row_mask:0xc bank_mask:0xf
    s_nop 0
    s_nop 0
    s_lshl_b32 s52, s52, 4
    s_add_u32 s52, s52, s28
    s_lshl_b32 s52, s52, 3
    s_add_u32 s52, s52, 363393024
    s_mov_b64 exec, 1
    s_lshl_b64 exec, exec, 63
    buffer_store_dwordx2 v[24:25], off, s[16:19], s52
    s_mov_b64 exec, -1
p1_tk1:
    s_waitcnt lgkmcnt(0)
    s_barrier
    v_mul_u32_u24 v119, 3, v0
    v_lshlrev_b32 v117, 2, v119
    v_add_u32 v117, 40736, v117
    v_and_b32 v118, -4, v119
    v_add_u32 v120, s51, v1
    v_mov_b32 v122, 0
    v_mov_b32 v123, 0
    v_mov_b32 v124, 0
    v_mov_b32 v125, 0
    ds_read_b64 v[126:127], v122 offset:10448
    ds_write_b32 v122, v122 offset:10432
    v_cmp_gt_u32 vcc, 640, v0
    s_and_saveexec_b64 s[52:53], vcc
    ds_write_b128 v1, v[122:125] offset:0
    s_mov_b64 exec, -1
    s_waitcnt lgkmcnt(2)
    v_readfirstlane_b32 s69, v126
    v_readfirstlane_b32 s71, v127
    s_cmp_ge_u32 s68, 2048
    s_cselect_b32 s3, s69, 0
    s_cmp_gt_u32 s28, 10
    s_cselect_b32 s71, 0, s71
    s_cselect_b32 s3, 0, s3
    s_add_u32 s69, s69, 512
    s_or_b32 s52, s71, s3
    s_bitcmp0_b32 s52, 3
    s_cbranch_scc1 p1_tr0
    v_and_b32 v116, 63, v0
    s_cmp_eq_u32 s28, 10
    s_cbranch_scc1 p1_tr1
    s_mul_i32 s52, s28, 520
    v_lshl_add_u32 v114, v116, 3, s52
    s_mul_i32 s52, s28, 4160
    v_lshl_add_u32 v115, v116, 4, s52
    s_branch p1_tr2
p1_tr1:
    v_mul_u32_u24 v114, 520, v116
    v_add_u32 v114, 512, v114
    v_mul_u32_u24 v115, 4160, v116
    v_add_u32 v115, 1024, v115
    v_cmp_gt_u32 vcc, 10, v116
    v_mov_b32 v116, 0x40000000
    s_nop 0
    v_cndmask_b32 v114, v116, v114, vcc
    v_cndmask_b32 v115, v116, v115, vcc
p1_tr2:
    s_cmp_lg_u32 s71, 8
    s_cbranch_scc1 p1_tl0
    s_lshr_b32 s52, s29, 3
    s_mul_i32 s52, s52, 41984
    s_add_u32 s52, s52, 335544320
    buffer_load_dwordx2 v[86:87], v114, s[16:19], s52 offen sc1
    s_add_u32 s52, s52, 5248
    buffer_load_dwordx2 v[88:89], v114, s[16:19], s52 offen sc1
    s_add_u32 s52, s52, 5248
    buffer_load_dwordx2 v[90:91], v114, s[16:19], s52 offen sc1
    s_add_u32 s52, s52, 5248
    buffer_load_dwordx2 v[92:93], v114, s[16:19], s52 offen sc1
    s_add_u32 s52, s52, 5248
    buffer_load_dwordx2 v[94:95], v114, s[16:19], s52 offen sc1
    s_add_u32 s52, s52, 5248
    buffer_load_dwordx2 v[96:97], v114, s[16:19], s52 offen sc1
    s_add_u32 s52, s52, 5248
    buffer_load_dwordx2 v[98:99], v114, s[16:19], s52 offen sc1
    s_add_u32 s52, s52, 5248
    buffer_load_dwordx2 v[100:101], v114, s[16:19], s52 offen sc1
    s_add_u32 s52, s52, 5248
p1_tl0:
    s_cmp_lg_u32 s3, 8
    s_cbranch_scc1 p1_tl1
    s_sub_u32 s52, s68, 2048
    s_mul_i32 s52, s52, 41984
    s_add_u32 s52, s52, 335544320
    buffer_load_dwordx2 v[28:29], v114, s[16:19], s52 offen sc1
    s_add_u32 s52, s52, 5248
    buffer_load_dwordx2 v[30:31], v114, s[16:19], s52 offen sc1
    s_add_u32 s52, s52, 5248
    buffer_load_dwordx2 v[32:33], v114, s[16:19], s52 offen sc1
    s_add_u32 s52, s52, 5248
    buffer_load_dwordx2 v[34:35], v114, s[16:19], s52 offen sc1
    s_add_u32 s52, s52, 5248
    buffer_load_dwordx2 v[36:37], v114, s[16:19], s52 offen sc1
    s_add_u32 s52, s52, 5248
    buffer_load_dwordx2 v[38:39], v114, s[16:19], s52 offen sc1
    s_add_u32 s52, s52, 5248
    buffer_load_dwordx2 v[40:41], v114, s[16:19], s52 offen sc1
    s_add_u32 s52, s52, 5248
    buffer_load_dwordx2 v[42:43], v114, s[16:19], s52 offen sc1
    s_add_u32 s52, s52, 5248
p1_tl1:
p1_tr0:
    s_cmp_ge_u32 s68, 2048
    s_cbranch_scc1 p1_lt0
    s_cmp_lg_u32 s28, 15
    s_cbranch_scc1 p1_lt0
    v_mov_b32 v127, 1
    s_mov_b64 exec, 1
    buffer_atomic_add v127, off, s[40:43], 0 offset:128 sc0 sc1
    s_mov_b64 exec, -1
p1_lt0:
    ds_read_b32 v68, v117 offset:0
    ds_read_b32 v69, v117 offset:4
    ds_read_b32 v70, v117 offset:8
    ds_read_b32 v71, v118 offset:10496
    ds_read_b32 v72, v118 offset:10500
    ds_read_b32 v74, v117 offset:12288
    ds_read_b32 v75, v117 offset:12292
    ds_read_b32 v76, v117 offset:12296
    ds_read_b32 v77, v118 offset:13568
    ds_read_b32 v78, v118 offset:13572
    s_waitcnt lgkmcnt(5)
    ds_read_b32 v80, v117 offset:24576
    ds_read_b32 v81, v117 offset:24580
    ds_read_b32 v82, v117 offset:24584
    ds_read_b32 v83, v118 offset:16640
    ds_read_b32 v84, v118 offset:16644
    v_alignbyte_b32 v71, v72, v71, v119
    buffer_store_dwordx4 v[68:71], v120, s[20:23], 0 offen
    v_add_u32 v120, 33554432, v120
    s_waitcnt lgkmcnt(5)
    ds_read_b32 v68, v117 offset:36864
    ds_read_b32 v69, v117 offset:36868
    ds_read_b32 v70, v117 offset:36872
    ds_read_b32 v71, v118 offset:19712
    ds_read_b32 v72, v118 offset:19716
    v_alignbyte_b32 v77, v78, v77, v119
    buffer_store_dwordx4 v[74:77], v120, s[20:23], 0 offen
    v_add_u32 v120, 33554432, v120
    s_waitcnt lgkmcnt(5)
    ds_read_b32 v74, v117 offset:49152
    ds_read_b32 v75, v117 offset:49156
    ds_read_b32 v76, v117 offset:49160
    ds_read_b32 v77, v118 offset:22784
    ds_read_b32 v78, v118 offset:22788
    v_alignbyte_b32 v83, v84, v83, v119
    buffer_store_dwordx4 v[80:83], v120, s[20:23], 0 offen
    v_add_u32 v120, 33554432, v120
    s_waitcnt lgkmcnt(5)
    v_add_u32 v117, 61440, v117
    ds_read_b32 v80, v117 offset:0
    ds_read_b32 v81, v117 offset:4
    ds_read_b32 v82, v117 offset:8
    ds_read_b32 v83, v118 offset:25856
    ds_read_b32 v84, v118 offset:25860
    v_alignbyte_b32 v71, v72, v71, v119
    buffer_store_dwordx4 v[68:71], v120, s[20:23], 0 offen
    v_add_u32 v120, 33554432, v120
    s_waitcnt lgkmcnt(5)
    ds_read_b32 v68, v117 offset:12288
    ds_read_b32 v69, v117 offset:12292
    ds_read_b32 v70, v117 offset:12296
    ds_read_b32 v71, v118 offset:28928
    ds_read_b32 v72, v118 offset:28932
    v_alignbyte_b32 v77, v78, v77, v119
    buffer_store_dwordx4 v[74:77], v120, s[20:23], 0 offen
    v_add_u32 v120, 33554432, v120
    s_waitcnt lgkmcnt(5)
    ds_read_b32 v74, v117 offset:24576
    ds_read_b32 v75, v117 offset:24580
    ds_read_b32 v76, v117 offset:24584
    ds_read_b32 v77, v118 offset:32000
    ds_read_b32 v78, v118 offset:32004
    v_alignbyte_b32 v83, v84, v83, v119
    buffer_store_dwordx4 v[80:83], v120, s[20:23], 0 offen nt
    v_add_u32 v120, 33554432, v120
    s_waitcnt lgkmcnt(5)
    ds_read_b32 v80, v117 offset:36864
    ds_read_b32 v81, v117 offset:36868
    ds_read_b32 v82, v117 offset:36872
    ds_read_b32 v83, v118 offset:35072
    ds_read_b32 v84, v118 offset:35076
    v_alignbyte_b32 v71, v72, v71, v119
    buffer_store_dwordx4 v[68:71], v120, s[20:23], 0 offen nt
    v_add_u32 v120, 33554432, v120
    s_waitcnt lgkmcnt(5)
    ds_read_b32 v68, v117 offset:49152
    ds_read_b32 v69, v117 offset:49156
    ds_read_b32 v70, v117 offset:49160
    ds_read_b32 v71, v118 offset:38144
    ds_read_b32 v72, v118 offset:38148
    v_alignbyte_b32 v77, v78, v77, v119
    buffer_store_dwordx4 v[74:77], v120, s[20:23], 0 offen nt
    v_add_u32 v120, 33554432, v120
    s_waitcnt lgkmcnt(5)
    v_alignbyte_b32 v83, v84, v83, v119
    buffer_store_dwordx4 v[80:83], v120, s[20:23], 0 offen nt
    v_add_u32 v120, 33554432, v120
    s_waitcnt lgkmcnt(0)
    v_alignbyte_b32 v71, v72, v71, v119
    buffer_store_dwordx4 v[68:71], v120, s[20:23], 0 offen nt
    s_mov_b32 s54, 0x05040100
    s_mov_b32 s55, 0x07060302
    s_cmp_lg_u32 s71, 8
    s_cbranch_scc1 p1_ts0
    s_lshr_b32 s52, s29, 3
    s_mul_i32 s52, s52, 41600
    s_add_u32 s52, s52, 346292224
    s_waitcnt vmcnt(10)
    v_perm_b32 v102, v88, v86, s54
    v_perm_b32 v103, v92, v90, s54
    v_perm_b32 v104, v96, v94, s54
    v_perm_b32 v105, v100, v98, s54
    buffer_store_dwordx4 v[102:105], v115, s[16:19], s52 offen offset:0
    v_perm_b32 v106, v88, v86, s55
    v_perm_b32 v107, v92, v90, s55
    v_perm_b32 v108, v96, v94, s55
    v_perm_b32 v109, v100, v98, s55
    buffer_store_dwordx4 v[106:109], v115, s[16:19], s52 offen offset:1040
    v_perm_b32 v110, v89, v87, s54
    v_perm_b32 v111, v93, v91, s54
    v_perm_b32 v112, v97, v95, s54
    v_perm_b32 v113, v101, v99, s54
    buffer_store_dwordx4 v[110:113], v115, s[16:19], s52 offen offset:2080
    v_perm_b32 v102, v89, v87, s55
    v_perm_b32 v103, v93, v91, s55
    v_perm_b32 v104, v97, v95, s55
    v_perm_b32 v105, v101, v99, s55
    buffer_store_dwordx4 v[102:105], v115, s[16:19], s52 offen offset:3120
p1_ts0:
    s_cmp_lg_u32 s3, 8
    s_cbranch_scc1 p1_ts1
    s_sub_u32 s52, s68, 2048
    s_mul_i32 s52, s52, 41600
    s_add_u32 s52, s52, 346292224
    s_waitcnt vmcnt(10)
    v_perm_b32 v44, v30, v28, s54
    v_perm_b32 v45, v34, v32, s54
    v_perm_b32 v46, v38, v36, s54
    v_perm_b32 v47, v42, v40, s54
    buffer_store_dwordx4 v[44:47], v115, s[16:19], s52 offen offset:0
    v_perm_b32 v48, v30, v28, s55
    v_perm_b32 v49, v34, v32, s55
    v_perm_b32 v50, v38, v36, s55
    v_perm_b32 v51, v42, v40, s55
    buffer_store_dwordx4 v[48:51], v115, s[16:19], s52 offen offset:1040
    v_perm_b32 v52, v31, v29, s54
    v_perm_b32 v53, v35, v33, s54
    v_perm_b32 v54, v39, v37, s54
    v_perm_b32 v55, v43, v41, s54
    buffer_store_dwordx4 v[52:55], v115, s[16:19], s52 offen offset:2080
    v_perm_b32 v56, v31, v29, s55
    v_perm_b32 v57, v35, v33, s55
    v_perm_b32 v58, v39, v37, s55
    v_perm_b32 v59, v43, v41, s55
    buffer_store_dwordx4 v[56:59], v115, s[16:19], s52 offen offset:3120
p1_ts1:
    s_cmp_ge_u32 s68, 2048
    s_cbranch_scc1 p1_lt1
    s_cmp_lg_u32 s28, 15
    s_cbranch_scc1 p1_lt1
    s_waitcnt vmcnt(10)
    s_mov_b64 exec, 1
    ds_write_b32 v122, v127 offset:10456
    s_mov_b64 exec, -1
    s_waitcnt lgkmcnt(0)
p1_lt1:
    s_barrier
    ds_read_b32 v126, v122 offset:10456
    s_waitcnt lgkmcnt(0)
    v_readfirstlane_b32 s69, v126
    s_nop 0
    s_add_u32 s69, s69, 512
    s_mov_b32 s29, s68
    s_mov_b32 s68, s69
    s_cmp_lt_u32 s29, 2048
    s_cbranch_scc1 p1_tile
p1_end:
    s_endpgm
.globl p2_kernel
.p2align 8
.type p2_kernel,@function
p2_kernel:
    s_cmp_ge_u32 s2, 256
    s_cbranch_scc1 p2_end
    s_load_dwordx2 s[8:9], s[0:1], 104
    v_and_b32 v112, 63, v0
    v_lshrrev_b32 v122, 6, v0
    v_lshlrev_b32 v112, 4, v112
    v_readfirstlane_b32 s10, v122
    v_mov_b32 v113, 0x83ff0000
    s_and_b32 s44, s2, 7
    s_lshr_b32 s11, s44, 1
    s_and_b32 s44, s44, 1
    s_lshl_b32 s12, s44, 5
    s_lshr_b32 s44, s2, 3
    s_add_u32 s12, s12, s44
    s_mov_b32 s25, 54272
    s_mov_b32 s31, 67175170
    s_mov_b32 s32, 83952386
    s_mov_b32 s33, 100729602
    s_mov_b32 s21, 0
    s_mul_i32 s23, s10, 3072
    s_lshl_b32 s24, s10, 9
    s_lshl_b32 s64, s10, 10
    s_sub_u32 s42, s24, s23
    s_add_u32 s42, s42, 49152
    s_lshl_b32 s41, s10, 21
    s_mov_b32 s63, 16384
    s_movk_i32 s65, 0x7800
    s_mul_i32 s62, s11, 161280
    s_add_u32 s62, s62, 356941824
    s_add_u32 s62, s62, s23
    s_mul_i32 s40, s10, 41600
    s_add_u32 s40, s40, 346292224
    s_mul_i32 s44, s11, 1040
    s_add_u32 s40, s40, s44
    s_lshl_b32 s44, s12, 4
    s_add_u32 s40, s40, s44
    s_waitcnt lgkmcnt(0)
    s_mov_b32 s4, s8
    s_and_b32 s5, s9, 0xffff
    s_mov_b32 s6, 819200000
    s_mov_b32 s7, 0x20000
    s_mov_b32 s68, s8
    s_and_b32 s69, s9, 0xffff
    s_mov_b32 s70, 335544320
    s_mov_b32 s71, 0x20000
    s_and_b32 s44, s2, 7
    s_lshl_b32 s44, s44, 2
    s_lshr_b32 s18, 0x00000000, s44
    s_and_b32 s18, s18, 15
p2_restart:
    s_mov_b32 s61, 0
    s_add_u32 s44, s61, s18
    s_cmp_ge_u32 s44, 10
    s_cselect_b32 s53, 10, 0
    s_sub_u32 s44, s44, s53
    s_mul_i32 s44, s44, 4160
    s_add_u32 s44, s44, s40
    v_lshrrev_b32 v110, 6, v112
    v_bfe_u32 v111, v112, 2, 4
    v_mul_u32_u24 v110, 665600, v110
    v_add_u32 v111, v110, v111
    buffer_load_dword v110, v111, s[4:7], s44 offen
    buffer_load_dword v111, v111, s[4:7], s44 offen offset:16
    s_mov_b32 s61, 1
    s_add_u32 s44, s61, s18
    s_cmp_ge_u32 s44, 10
    s_cselect_b32 s53, 10, 0
    s_sub_u32 s44, s44, s53
    s_mul_i32 s44, s44, 4160
    s_add_u32 s44, s44, s40
    v_lshrrev_b32 v68, 6, v112
    v_bfe_u32 v69, v112, 2, 4
    v_mul_u32_u24 v68, 665600, v68
    v_add_u32 v69, v68, v69
    buffer_load_dword v68, v69, s[4:7], s44 offen
    buffer_load_dword v69, v69, s[4:7], s44 offen offset:16
    s_mov_b32 s61, 0
    s_cmp_lt_u32 s10, 15
    s_cselect_b32 s44, s64, 0x40000000
    v_add_u32 v60, s44, v112
    s_mov_b32 s44, 363393024
    buffer_load_dwordx4 v[60:63], v60, s[4:7], s44 offen
    s_mul_i32 s20, s18, 645120
    s_add_u32 s20, s20, s62
    s_cmp_ge_u32 s10, 9
    s_cbranch_scc1 p2_nmp
    v_lshrrev_b32 v84, 1, v112
    s_add_u32 s44, s20, s42
    buffer_load_dwordx2 v[84:85], v84, s[4:7], s44 offen
p2_nmp:
    buffer_load_dwordx4 v[72:75], v112, s[4:7], s20 offen offset:0
    buffer_load_dwordx4 v[76:79], v112, s[4:7], s20 offen offset:1024
    buffer_load_dwordx4 v[80:83], v112, s[4:7], s20 offen offset:2048
    s_barrier
    v_mov_b32 v115, 0
    v_mov_b32 v116, 0
    v_mov_b32 v117, 0
    v_mov_b32 v118, 0
    v_mov_b32 v119, 0
    v_mov_b32 v120, 0
    v_mov_b32 v121, 0
    ds_write_b128 v115, v[116:119] offset:53760
    s_mov_b32 s19, 0
    s_cmp_eq_u32 s21, 2
    s_cselect_b64 s[66:67], -1, 0
    s_waitcnt lgkmcnt(0)
    s_barrier
    s_waitcnt vmcnt(6)
    s_mov_b32 m0, s23
    v_mov_b32 v53, 0x3c000
    s_movk_i32 s44, 512
    v_sub_u32_sdwa v4, v111, v110 dst_sel:DWORD dst_unused:UNUSED_PAD src0_sel:WORD_0 src1_sel:WORD_0
    v_sub_u32_sdwa v5, v111, v110 dst_sel:DWORD dst_unused:UNUSED_PAD src0_sel:WORD_1 src1_sel:WORD_1
    v_med3_i32 v4, v4, 0, s44
    v_med3_i32 v5, v5, 0, s44
    v_add_u32 v48, v4, v5
    ds_write_addtid_b32 v53 offset:0
    ds_write_addtid_b32 v53 offset:256
    ds_write_addtid_b32 v53 offset:512
    ds_write_addtid_b32 v53 offset:768
    ds_write_addtid_b32 v53 offset:1024
    ds_write_addtid_b32 v53 offset:1280
    ds_write_addtid_b32 v53 offset:1536
    ds_write_addtid_b32 v53 offset:1792
    v_and_b32 v49, 0x3c0, v112
    v_and_b32 v53, 0x30, v112
    v_lshl_or_b32 v53, v49, 4, v53
    v_lshl_add_u32 v53, v53, 15, s41
    s_nop 1
    v_add_u32_dpp v48, v48, v48 row_shr:1 row_mask:0xf bank_mask:0xf bound_ctrl:0
    s_nop 1
    v_add_u32_dpp v48, v48, v48 row_shr:2 row_mask:0xf bank_mask:0xf bound_ctrl:0
    s_nop 1
    v_add_u32_dpp v48, v48, v48 row_shr:4 row_mask:0xf bank_mask:0xf bound_ctrl:0
    s_nop 1
    v_add_u32_dpp v48, v48, v48 row_shr:8 row_mask:0xf bank_mask:0xf bound_ctrl:0
    s_nop 1
    v_add_u32_dpp v48, v48, v48 row_bcast:15 row_mask:0xa bank_mask:0xf
    s_nop 1
    v_add_u32_dpp v48, v48, v48 row_bcast:31 row_mask:0xc bank_mask:0xf
    s_nop 1
    s_nop 0
    v_readlane_b32 s38, v48, 63
    v_sub_u32 v50, v48, v5
    v_sub_u32 v49, v50, v4
    v_sub_u32 v10, 512, v49
    v_mad_u32_u16 v51, v110, 16, v53
    v_med3_i32 v10, v10, 0, v4
    v_lshl_add_u32 v49, v49, 2, s23
    v_sub_u32 v11, 512, v50
    v_mad_u32_u16 v52, v110, 16, v53 op_sel:[1,0,0,0]
    v_med3_i32 v11, v11, 0, v5
    v_lshl_add_u32 v50, v50, 2, s23
    v_lshl_add_u32 v48, v11, 16, v10
    v_add_u32 v52, 262144, v52
    v_add_u32 v110, v110, v48
    s_min_u32 s17, s38, 512
    s_add_u32 s17, s17, 63
    s_lshr_b32 s17, s17, 6
p2_xa_0:
    v_cmpx_lt_i32 vcc, 0, v10
    s_cbranch_execz p2_ya_0
    ds_write_b32 v49, v51 offset:0
    v_add_u32 v51, 16, v51
    v_cmpx_lt_i32 vcc, 1, v10
    s_cbranch_execz p2_ya_0
    ds_write_b32 v49, v51 offset:4
    v_add_u32 v51, 16, v51
    v_cmpx_lt_i32 vcc, 2, v10
    s_cbranch_execz p2_ya_0
    ds_write_b32 v49, v51 offset:8
    v_add_u32 v51, 16, v51
    v_cmpx_lt_i32 vcc, 3, v10
    s_cbranch_execz p2_ya_0
    ds_write_b32 v49, v51 offset:12
    v_add_u32 v51, 16, v51
    v_cmpx_lt_i32 vcc, 4, v10
    s_cbranch_execz p2_ya_0
    ds_write_b32 v49, v51 offset:16
    v_add_u32 v51, 16, v51
    v_cmpx_lt_i32 vcc, 5, v10
    s_cbranch_execz p2_ya_0
    ds_write_b32 v49, v51 offset:20
    v_add_u32 v51, 16, v51
    v_cmpx_lt_i32 vcc, 6, v10
    s_cbranch_execz p2_ya_0
    ds_write_b32 v49, v51 offset:24
    v_add_u32 v51, 16, v51
    v_cmpx_lt_i32 vcc, 7, v10
    s_cbranch_execz p2_ya_0
    ds_write_b32 v49, v51 offset:28
    v_add_u32 v51, 16, v51
    v_subrev_u32 v10, 8, v10
    v_add_u32 v49, 32, v49
    s_branch p2_xa_0
p2_ya_0:
    s_mov_b64 exec, -1
p2_xa_1:
    v_cmpx_lt_i32 vcc, 0, v11
    s_cbranch_execz p2_ya_1
    ds_write_b32 v50, v52 offset:0
    v_add_u32 v52, 16, v52
    v_cmpx_lt_i32 vcc, 1, v11
    s_cbranch_execz p2_ya_1
    ds_write_b32 v50, v52 offset:4
    v_add_u32 v52, 16, v52
    v_cmpx_lt_i32 vcc, 2, v11
    s_cbranch_execz p2_ya_1
    ds_write_b32 v50, v52 offset:8
    v_add_u32 v52, 16, v52
    v_cmpx_lt_i32 vcc, 3, v11
    s_cbranch_execz p2_ya_1
    ds_write_b32 v50, v52 offset:12
    v_add_u32 v52, 16, v52
    v_cmpx_lt_i32 vcc, 4, v11
    s_cbranch_execz p2_ya_1
    ds_write_b32 v50, v52 offset:16
    v_add_u32 v52, 16, v52
    v_cmpx_lt_i32 vcc, 5, v11
    s_cbranch_execz p2_ya_1
    ds_write_b32 v50, v52 offset:20
    v_add_u32 v52, 16, v52
    v_cmpx_lt_i32 vcc, 6, v11
    s_cbranch_execz p2_ya_1
    ds_write_b32 v50, v52 offset:24
    v_add_u32 v52, 16, v52
    v_cmpx_lt_i32 vcc, 7, v11
    s_cbranch_execz p2_ya_1
    ds_write_b32 v50, v52 offset:28
    v_add_u32 v52, 16, v52
    v_subrev_u32 v11, 8, v11
    v_add_u32 v50, 32, v50
    s_branch p2_xa_1
p2_ya_1:
    s_mov_b64 exec, -1
    s_cmp_lt_u32 s38, 512
    s_cbranch_scc1 p2_nomorea
    v_cmp_lt_u32_sdwa s[44:45], v110, v111 src0_sel:WORD_0 src1_sel:WORD_0
    v_cmp_lt_u32_sdwa s[46:47], v110, v111 src0_sel:WORD_1 src1_sel:WORD_1
    s_nop 0
    s_or_b64 s[44:45], s[44:45], s[46:47]
    s_cbranch_scc0 p2_nomorea
    v_mov_b32 v49, s19
    v_mov_b32 v50, 1
    ds_write_b32 v49, v50 offset:53760
p2_nomorea:
    s_mov_b32 m0, s23
    s_nop 0
    ds_read_addtid_b32 v2 offset:0
    ds_read_addtid_b32 v8 offset:256
    ds_read_addtid_b32 v14 offset:512
    ds_read_addtid_b32 v20 offset:768
    ds_read_addtid_b32 v88 offset:1024
    ds_read_addtid_b32 v92 offset:1280
    ds_read_addtid_b32 v96 offset:1536
    ds_read_addtid_b32 v100 offset:1792
    s_waitcnt lgkmcnt(0)
    v_lshrrev_b32 v0, 3, v2
    v_lshrrev_b32 v1, 18, v2
    v_and_b32 v2, 0x3fff, v2
    v_and_or_b32 v0, v0, s65, v1
    v_mad_u32_u24 v2, v0, s63, v2
    buffer_load_dwordx4 v[0:3], v2, s[68:71], 0 offen
    v_lshrrev_b32 v6, 3, v8
    v_lshrrev_b32 v7, 18, v8
    v_and_b32 v8, 0x3fff, v8
    v_and_or_b32 v6, v6, s65, v7
    v_mad_u32_u24 v8, v6, s63, v8
    buffer_load_dwordx4 v[6:9], v8, s[68:71], 0 offen
    s_cmp_eq_u32 s21, 0
    s_cselect_b32 s44, 1073758208, 0
    v_mov_b32 v124, s44
    v_mov_b32 v125, s44
    v_mov_b32 v126, s44
    v_mov_b32 v127, s44
    v_add_u32 v123, s64, v112
    v_add_u32 v122, s25, v123
    ds_write_b128 v122, v[124:127] offset:0
    ds_write_b128 v122, v[124:127] offset:16384
    ds_write_b128 v122, v[124:127] offset:32768
    v_add_u32 v122, 49152, v122
    ds_write_b128 v122, v[124:127] offset:0
    ds_write_b128 v122, v[124:127] offset:16384
    ds_write_b128 v122, v[124:127] offset:32768
    v_cmpx_gt_u32 vcc, 1792, v123
    ds_write_b128 v122, v[124:127] offset:49152
    s_mov_b64 exec, -1
    v_lshrrev_b32 v12, 3, v14
    v_lshrrev_b32 v13, 18, v14
    v_and_b32 v14, 0x3fff, v14
    v_and_or_b32 v12, v12, s65, v13
    v_mad_u32_u24 v14, v12, s63, v14
    buffer_load_dwordx4 v[12:15], v14, s[68:71], 0 offen
    s_mov_b32 s16, s17
    s_waitcnt vmcnt(6)
    s_cmp_lg_u32 s21, 0
    s_cbranch_scc1 p2_nostat1
    v_max_u32 v60, v60, v62
    v_add_f32 v61, v61, v63
    s_nop 1
    v_max_u32_dpp v60, v60, v60 row_shr:1 row_mask:0xf bank_mask:0xf bound_ctrl:0
    v_add_f32_dpp v61, v61, v61 row_shr:1 row_mask:0xf bank_mask:0xf bound_ctrl:0
    s_nop 0
    v_max_u32_dpp v60, v60, v60 row_shr:2 row_mask:0xf bank_mask:0xf bound_ctrl:0
    v_add_f32_dpp v61, v61, v61 row_shr:2 row_mask:0xf bank_mask:0xf bound_ctrl:0
    s_nop 0
    v_max_u32_dpp v60, v60, v60 row_shr:4 row_mask:0xf bank_mask:0xf bound_ctrl:0
    v_add_f32_dpp v61, v61, v61 row_shr:4 row_mask:0xf bank_mask:0xf bound_ctrl:0
    s_nop 0
    v_max_u32_dpp v60, v60, v60 row_shr:8 row_mask:0xf bank_mask:0xf bound_ctrl:0
    v_add_f32_dpp v61, v61, v61 row_shr:8 row_mask:0xf bank_mask:0xf bound_ctrl:0
    s_nop 0
    v_max_u32_dpp v60, v60, v60 row_bcast:15 row_mask:0xa bank_mask:0xf
    v_add_f32_dpp v61, v61, v61 row_bcast:15 row_mask:0xa bank_mask:0xf
    s_nop 0
    v_max_u32_dpp v60, v60, v60 row_bcast:31 row_mask:0xc bank_mask:0xf
    v_add_f32_dpp v61, v61, v61 row_bcast:31 row_mask:0xc bank_mask:0xf
    s_nop 0
    s_nop 0
    s_lshl_b32 s44, s10, 3
    v_mov_b32 v62, s44
    s_mov_b64 exec, 1
    s_lshl_b64 exec, exec, 63
    ds_write_b64 v62, v[60:61] offset:53824
    s_mov_b64 exec, -1
p2_nostat1:
    s_waitcnt lgkmcnt(0)
    s_barrier
    v_lshrrev_b32 v18, 3, v20
    v_lshrrev_b32 v19, 18, v20
    v_and_b32 v20, 0x3fff, v20
    v_and_or_b32 v18, v18, s65, v19
    v_mad_u32_u24 v20, v18, s63, v20
    buffer_load_dwordx4 v[18:21], v20, s[68:71], 0 offen
    v_mov_b32 v122, s19
    s_xor_b32 s19, s19, 4
    ds_read_b32 v125, v122 offset:53760
    s_cmp_lg_u32 s21, 0
    s_cbranch_scc1 p2_nostat2
    v_bfe_u32 v62, v112, 1, 7
    ds_read_b64 v[60:61], v62 offset:53824
    s_waitcnt lgkmcnt(0)
    s_nop 1
    v_max_u32_dpp v60, v60, v60 row_shr:1 row_mask:0xf bank_mask:0xf bound_ctrl:0
    v_add_f32_dpp v61, v61, v61 row_shr:1 row_mask:0xf bank_mask:0xf bound_ctrl:0
    s_nop 0
    v_max_u32_dpp v60, v60, v60 row_shr:2 row_mask:0xf bank_mask:0xf bound_ctrl:0
    v_add_f32_dpp v61, v61, v61 row_shr:2 row_mask:0xf bank_mask:0xf bound_ctrl:0
    s_nop 0
    v_max_u32_dpp v60, v60, v60 row_shr:4 row_mask:0xf bank_mask:0xf bound_ctrl:0
    v_add_f32_dpp v61, v61, v61 row_shr:4 row_mask:0xf bank_mask:0xf bound_ctrl:0
    s_nop 0
    v_max_u32_dpp v60, v60, v60 row_shr:8 row_mask:0xf bank_mask:0xf bound_ctrl:0
    v_add_f32_dpp v61, v61, v61 row_shr:8 row_mask:0xf bank_mask:0xf bound_ctrl:0
    s_nop 0
    v_max_u32_dpp v60, v60, v60 row_bcast:15 row_mask:0xa bank_mask:0xf
    v_add_f32_dpp v61, v61, v61 row_bcast:15 row_mask:0xa bank_mask:0xf
    s_nop 0
    v_max_u32_dpp v60, v60, v60 row_bcast:31 row_mask:0xc bank_mask:0xf
    v_add_f32_dpp v61, v61, v61 row_bcast:31 row_mask:0xc bank_mask:0xf
    s_nop 0
    s_nop 0
    v_readlane_b32 s44, v60, 15
    v_readlane_b32 s45, v61, 15
    s_nop 1
    s_lshl_b32 s44, s44, 16
    s_lshr_b32 s46, s44, 23
    s_sub_u32 s47, s46, 80
    s_cmp_lt_u32 s47, 100
    s_cselect_b32 s21, 0, 1
    v_mov_b32 v60, s45
    v_mul_f32 v60, 0x34a7c5ac, v60
    v_sqrt_f32 v60, v60
    v_mov_b32 v61, s44
    v_mul_f32 v62, 0x41800000, v60
    v_cmp_nle_f32 vcc, v61, v62
    v_mul_f32 v60, 0x3ac00000, v60
    v_mul_f32 v61, 0x3901742e, v61
    v_max_f32 v60, v60, v61
    s_cmp_lg_u64 vcc, 0
    s_cselect_b32 s21, 1, s21
    v_readfirstlane_b32 s44, v60
    s_nop 0
    s_and_b32 s47, s44, 0x7fffff
    s_or_b32 s47, s47, 0x3f000000
    s_and_b32 s48, s44, 0x7f800000
    s_add_u32 s48, s48, 0x800000
    v_rcp_f32 v60, s47
    s_nop 0
    v_rcp_f32 v61, v60
    v_mul_f32 v60, 0x7b800000, v60
    v_mul_f32 v61, s48, v61
    s_nop 0
    v_readfirstlane_b32 s26, v60
    v_readfirstlane_b32 s30, v61
    s_add_u32 s34, s48, 197132288
    s_mov_b32 s35, s34
    s_sub_u32 s36, 0, s34
    s_subb_u32 s37, 0, s34
    s_cmp_eq_u32 s21, 0
    s_cbranch_scc1 p2_nostat2
    s_waitcnt vmcnt(0) lgkmcnt(0)
    s_branch p2_restart
p2_nostat2:
    s_cmp_eq_u32 s21, 0
    s_cselect_b32 s26, s26, 0x7b800000
    v_mov_b32 v114, s26
    s_waitcnt lgkmcnt(0)
    v_readfirstlane_b32 s44, v125
    s_nop 0
    s_cmp_lg_u32 s44, 0
    s_cbranch_scc1 p2_adva
    s_mov_b32 s61, 1
    v_mov_b32 v110, v68
    v_mov_b32 v111, v69
p2_adva:
    v_lshrrev_b32 v86, 3, v88
    v_lshrrev_b32 v87, 18, v88
    v_and_b32 v88, 0x3fff, v88
    v_and_or_b32 v86, v86, s65, v87
    v_mad_u32_u24 v88, v86, s63, v88
    buffer_load_dwordx4 v[86:89], v88, s[68:71], 0 offen
    s_mov_b32 m0, s23
    v_mov_b32 v53, 0x3c000
    s_movk_i32 s44, 512
    v_sub_u32_sdwa v4, v111, v110 dst_sel:DWORD dst_unused:UNUSED_PAD src0_sel:WORD_0 src1_sel:WORD_0
    v_sub_u32_sdwa v5, v111, v110 dst_sel:DWORD dst_unused:UNUSED_PAD src0_sel:WORD_1 src1_sel:WORD_1
    v_med3_i32 v4, v4, 0, s44
    v_med3_i32 v5, v5, 0, s44
    v_add_u32 v48, v4, v5
    ds_write_addtid_b32 v53 offset:0
    ds_write_addtid_b32 v53 offset:256
    ds_write_addtid_b32 v53 offset:512
    ds_write_addtid_b32 v53 offset:768
    ds_write_addtid_b32 v53 offset:1024
    ds_write_addtid_b32 v53 offset:1280
    ds_write_addtid_b32 v53 offset:1536
    ds_write_addtid_b32 v53 offset:1792
    v_and_b32 v49, 0x3c0, v112
    v_and_b32 v53, 0x30, v112
    v_lshl_or_b32 v53, v49, 4, v53
    v_lshl_add_u32 v53, v53, 15, s41
    s_nop 1
    v_add_u32_dpp v48, v48, v48 row_shr:1 row_mask:0xf bank_mask:0xf bound_ctrl:0
    s_nop 1
    v_add_u32_dpp v48, v48, v48 row_shr:2 row_mask:0xf bank_mask:0xf bound_ctrl:0
    s_nop 1
    v_add_u32_dpp v48, v48, v48 row_shr:4 row_mask:0xf bank_mask:0xf bound_ctrl:0
    s_nop 1
    v_add_u32_dpp v48, v48, v48 row_shr:8 row_mask:0xf bank_mask:0xf bound_ctrl:0
    s_nop 1
    v_add_u32_dpp v48, v48, v48 row_bcast:15 row_mask:0xa bank_mask:0xf
    s_nop 1
    v_add_u32_dpp v48, v48, v48 row_bcast:31 row_mask:0xc bank_mask:0xf
    s_nop 1
    s_nop 0
    v_readlane_b32 s38, v48, 63
    v_sub_u32 v50, v48, v5
    v_sub_u32 v49, v50, v4
    v_sub_u32 v10, 512, v49
    v_mad_u32_u16 v51, v110, 16, v53
    v_med3_i32 v10, v10, 0, v4
    v_lshl_add_u32 v49, v49, 2, s23
    v_sub_u32 v11, 512, v50
    v_mad_u32_u16 v52, v110, 16, v53 op_sel:[1,0,0,0]
    v_med3_i32 v11, v11, 0, v5
    v_lshl_add_u32 v50, v50, 2, s23
    v_lshl_add_u32 v48, v11, 16, v10
    v_add_u32 v52, 262144, v52
    v_add_u32 v110, v110, v48
    s_min_u32 s17, s38, 512
    s_add_u32 s17, s17, 63
    s_lshr_b32 s17, s17, 6
p2_xb_0:
    v_cmpx_lt_i32 vcc, 0, v10
    s_cbranch_execz p2_yb_0
    ds_write_b32 v49, v51 offset:0
    v_add_u32 v51, 16, v51
    v_cmpx_lt_i32 vcc, 1, v10
    s_cbranch_execz p2_yb_0
    ds_write_b32 v49, v51 offset:4
    v_add_u32 v51, 16, v51
    v_cmpx_lt_i32 vcc, 2, v10
    s_cbranch_execz p2_yb_0
    ds_write_b32 v49, v51 offset:8
    v_add_u32 v51, 16, v51
    v_cmpx_lt_i32 vcc, 3, v10
    s_cbranch_execz p2_yb_0
    ds_write_b32 v49, v51 offset:12
    v_add_u32 v51, 16, v51
    v_cmpx_lt_i32 vcc, 4, v10
    s_cbranch_execz p2_yb_0
    ds_write_b32 v49, v51 offset:16
    v_add_u32 v51, 16, v51
    v_cmpx_lt_i32 vcc, 5, v10
    s_cbranch_execz p2_yb_0
    ds_write_b32 v49, v51 offset:20
    v_add_u32 v51, 16, v51
    v_cmpx_lt_i32 vcc, 6, v10
    s_cbranch_execz p2_yb_0
    ds_write_b32 v49, v51 offset:24
    v_add_u32 v51, 16, v51
    v_cmpx_lt_i32 vcc, 7, v10
    s_cbranch_execz p2_yb_0
    ds_write_b32 v49, v51 offset:28
    v_add_u32 v51, 16, v51
    v_subrev_u32 v10, 8, v10
    v_add_u32 v49, 32, v49
    s_branch p2_xb_0
p2_yb_0:
    s_mov_b64 exec, -1
p2_xb_1:
    v_cmpx_lt_i32 vcc, 0, v11
    s_cbranch_execz p2_yb_1
    ds_write_b32 v50, v52 offset:0
    v_add_u32 v52, 16, v52
    v_cmpx_lt_i32 vcc, 1, v11
    s_cbranch_execz p2_yb_1
    ds_write_b32 v50, v52 offset:4
    v_add_u32 v52, 16, v52
    v_cmpx_lt_i32 vcc, 2, v11
    s_cbranch_execz p2_yb_1
    ds_write_b32 v50, v52 offset:8
    v_add_u32 v52, 16, v52
    v_cmpx_lt_i32 vcc, 3, v11
    s_cbranch_execz p2_yb_1
    ds_write_b32 v50, v52 offset:12
    v_add_u32 v52, 16, v52
    v_cmpx_lt_i32 vcc, 4, v11
    s_cbranch_execz p2_yb_1
    ds_write_b32 v50, v52 offset:16
    v_add_u32 v52, 16, v52
    v_cmpx_lt_i32 vcc, 5, v11
    s_cbranch_execz p2_yb_1
    ds_write_b32 v50, v52 offset:20
    v_add_u32 v52, 16, v52
    v_cmpx_lt_i32 vcc, 6, v11
    s_cbranch_execz p2_yb_1
    ds_write_b32 v50, v52 offset:24
    v_add_u32 v52, 16, v52
    v_cmpx_lt_i32 vcc, 7, v11
    s_cbranch_execz p2_yb_1
    ds_write_b32 v50, v52 offset:28
    v_add_u32 v52, 16, v52
    v_subrev_u32 v11, 8, v11
    v_add_u32 v50, 32, v50
    s_branch p2_xb_1
p2_yb_1:
    s_mov_b64 exec, -1
    s_cmp_lt_u32 s38, 512
    s_cbranch_scc1 p2_nomoreb
    v_cmp_lt_u32_sdwa s[44:45], v110, v111 src0_sel:WORD_0 src1_sel:WORD_0
    v_cmp_lt_u32_sdwa s[46:47], v110, v111 src0_sel:WORD_1 src1_sel:WORD_1
    s_nop 0
    s_or_b64 s[44:45], s[44:45], s[46:47]
    s_cbranch_scc0 p2_nomoreb
    v_mov_b32 v49, s19
    v_mov_b32 v50, 1
    ds_write_b32 v49, v50 offset:53760
p2_nomoreb:
    s_mov_b32 m0, s23
    s_nop 0
    ds_read_addtid_b32 v102 offset:0
    ds_read_addtid_b32 v103 offset:256
    ds_read_addtid_b32 v104 offset:512
    ds_read_addtid_b32 v105 offset:768
    ds_read_addtid_b32 v106 offset:1024
    ds_read_addtid_b32 v107 offset:1280
    ds_read_addtid_b32 v108 offset:1536
    ds_read_addtid_b32 v109 offset:1792
    v_lshrrev_b32 v90, 3, v92
    v_lshrrev_b32 v91, 18, v92
    v_and_b32 v92, 0x3fff, v92
    v_and_or_b32 v90, v90, s65, v91
    v_mad_u32_u24 v92, v90, s63, v92
    buffer_load_dwordx4 v[90:93], v92, s[68:71], 0 offen
    s_waitcnt vmcnt(6)
    s_mov_b32 m0, s24
    s_cmp_ge_u32 s10, 9
    s_cbranch_scc1 p2_stp
    ds_write_addtid_b32 v84 offset:49152
    ds_write_addtid_b32 v85 offset:49408
p2_stp:
    s_mov_b32 m0, s23
    s_add_u32 s20, s20, 53760
    ds_write_addtid_b32 v72 offset:0
    ds_write_addtid_b32 v73 offset:256
    ds_write_addtid_b32 v74 offset:512
    ds_write_addtid_b32 v75 offset:768
    ds_write_addtid_b32 v76 offset:1024
    ds_write_addtid_b32 v77 offset:1280
    ds_write_addtid_b32 v78 offset:1536
    ds_write_addtid_b32 v79 offset:1792
    ds_write_addtid_b32 v80 offset:2048
    ds_write_addtid_b32 v81 offset:2304
    ds_write_addtid_b32 v82 offset:2560
    ds_write_addtid_b32 v83 offset:2816
    s_waitcnt lgkmcnt(0)
    s_barrier
    v_lshrrev_b32 v94, 3, v96
    v_lshrrev_b32 v95, 18, v96
    v_and_b32 v96, 0x3fff, v96
    v_and_or_b32 v94, v94, s65, v95
    v_mad_u32_u24 v96, v94, s63, v96
    buffer_load_dwordx4 v[94:97], v96, s[68:71], 0 offen
    v_lshrrev_b32 v98, 3, v100
    v_lshrrev_b32 v99, 18, v100
    v_and_b32 v100, 0x3fff, v100
    v_and_or_b32 v98, v98, s65, v99
    v_mad_u32_u24 v100, v98, s63, v100
    buffer_load_dwordx4 v[98:101], v100, s[68:71], 0 offen
    s_cmp_ge_u32 s10, 9
    s_cbranch_scc1 p2_nmq
    v_lshrrev_b32 v84, 1, v112
    s_add_u32 s44, s20, s42
    buffer_load_dwordx2 v[84:85], v84, s[4:7], s44 offen
p2_nmq:
    buffer_load_dwordx4 v[72:75], v112, s[4:7], s20 offen offset:0
    buffer_load_dwordx4 v[76:79], v112, s[4:7], s20 offen offset:1024
    buffer_load_dwordx4 v[80:83], v112, s[4:7], s20 offen offset:2048
    s_waitcnt vmcnt(10)
    v_perm_b32 v48, v3, v0, s31
    v_perm_b32 v49, v3, v1, s32
    v_perm_b32 v50, v3, v2, s33
    v_lshlrev_b16 v4, 3, v2
    v_lshlrev_b16 v2, 3, v1
    v_lshlrev_b16 v0, 3, v0
    v_cmpx_ge_u16 vcc, 0x3fff, v48
    ds_read_b64 v[0:1], v0
    s_mov_b64 exec, -1
    v_cmpx_ge_u16 vcc, 0x3fff, v49
    ds_read_b64 v[2:3], v2
    s_mov_b64 exec, -1
    v_cmpx_ge_u16 vcc, 0x3fff, v50
    ds_read_b64 v[4:5], v4
    s_mov_b64 exec, -1
    s_waitcnt vmcnt(9)
    v_perm_b32 v51, v9, v6, s31
    v_perm_b32 v52, v9, v7, s32
    v_perm_b32 v53, v9, v8, s33
    v_lshlrev_b16 v10, 3, v8
    v_lshlrev_b16 v8, 3, v7
    v_lshlrev_b16 v6, 3, v6
    v_cmpx_ge_u16 vcc, 0x3fff, v51
    ds_read_b64 v[6:7], v6
    s_mov_b64 exec, -1
    v_cmpx_ge_u16 vcc, 0x3fff, v52
    ds_read_b64 v[8:9], v8
    s_mov_b64 exec, -1
    v_cmpx_ge_u16 vcc, 0x3fff, v53
    ds_read_b64 v[10:11], v10
    s_mov_b64 exec, -1
    s_waitcnt vmcnt(8)
    v_perm_b32 v54, v15, v12, s31
    v_perm_b32 v55, v15, v13, s32
    v_perm_b32 v56, v15, v14, s33
    v_lshlrev_b16 v16, 3, v14
    v_lshlrev_b16 v14, 3, v13
    v_lshlrev_b16 v12, 3, v12
    v_cmpx_ge_u16 vcc, 0x3fff, v54
    ds_read_b64 v[12:13], v12
    s_mov_b64 exec, -1
    v_cmpx_ge_u16 vcc, 0x3fff, v55
    ds_read_b64 v[14:15], v14
    s_mov_b64 exec, -1
    v_cmpx_ge_u16 vcc, 0x3fff, v56
    ds_read_b64 v[16:17], v16
    s_mov_b64 exec, -1
    s_waitcnt vmcnt(7)
    v_perm_b32 v57, v21, v18, s31
    v_perm_b32 v58, v21, v19, s32
    v_perm_b32 v59, v21, v20, s33
    v_lshlrev_b16 v22, 3, v20
    v_lshlrev_b16 v20, 3, v19
    v_lshlrev_b16 v18, 3, v18
    v_cmpx_ge_u16 vcc, 0x3fff, v57
    ds_read_b64 v[18:19], v18
    s_mov_b64 exec, -1
    v_cmpx_ge_u16 vcc, 0x3fff, v58
    ds_read_b64 v[20:21], v20
    s_mov_b64 exec, -1
    v_cmpx_ge_u16 vcc, 0x3fff, v59
    ds_read_b64 v[22:23], v22
    s_mov_b64 exec, -1
    s_waitcnt vmcnt(6)
    v_perm_b32 v60, v89, v86, s31
    v_perm_b32 v61, v89, v87, s32
    v_perm_b32 v62, v89, v88, s33
    v_lshlrev_b16 v28, 3, v88
    v_lshlrev_b16 v26, 3, v87
    v_lshlrev_b16 v24, 3, v86
    v_cmpx_ge_u16 vcc, 0x3fff, v60
    ds_read_b64 v[24:25], v24
    s_mov_b64 exec, -1
    v_cmpx_ge_u16 vcc, 0x3fff, v61
    ds_read_b64 v[26:27], v26
    s_mov_b64 exec, -1
    v_cmpx_ge_u16 vcc, 0x3fff, v62
    ds_read_b64 v[28:29], v28
    s_mov_b64 exec, -1
    v_lshrrev_b32 v86, 3, v106
    v_lshrrev_b32 v87, 18, v106
    v_and_b32 v106, 0x3fff, v106
    v_and_or_b32 v86, v86, s65, v87
    v_mad_u32_u24 v106, v86, s63, v106
    buffer_load_dwordx4 v[86:89], v106, s[68:71], 0 offen
    s_waitcnt vmcnt(6)
    v_perm_b32 v63, v93, v90, s31
    v_perm_b32 v64, v93, v91, s32
    v_perm_b32 v65, v93, v92, s33
    v_lshlrev_b16 v34, 3, v92
    v_lshlrev_b16 v32, 3, v91
    v_lshlrev_b16 v30, 3, v90
    v_cmpx_ge_u16 vcc, 0x3fff, v63
    ds_read_b64 v[30:31], v30
    s_mov_b64 exec, -1
    v_cmpx_ge_u16 vcc, 0x3fff, v64
    ds_read_b64 v[32:33], v32
    s_mov_b64 exec, -1
    v_cmpx_ge_u16 vcc, 0x3fff, v65
    ds_read_b64 v[34:35], v34
    s_mov_b64 exec, -1
    v_lshrrev_b32 v90, 3, v107
    v_lshrrev_b32 v91, 18, v107
    v_and_b32 v107, 0x3fff, v107
    v_and_or_b32 v90, v90, s65, v91
    v_mad_u32_u24 v107, v90, s63, v107
    buffer_load_dwordx4 v[90:93], v107, s[68:71], 0 offen
    s_waitcnt vmcnt(6)
    v_perm_b32 v66, v97, v94, s31
    v_perm_b32 v67, v97, v95, s32
    v_perm_b32 v68, v97, v96, s33
    v_lshlrev_b16 v40, 3, v96
    v_lshlrev_b16 v38, 3, v95
    v_lshlrev_b16 v36, 3, v94
    v_cmpx_ge_u16 vcc, 0x3fff, v66
    ds_read_b64 v[36:37], v36
    s_mov_b64 exec, -1
    v_cmpx_ge_u16 vcc, 0x3fff, v67
    ds_read_b64 v[38:39], v38
    s_mov_b64 exec, -1
    v_cmpx_ge_u16 vcc, 0x3fff, v68
    ds_read_b64 v[40:41], v40
    s_mov_b64 exec, -1
    s_waitcnt vmcnt(5)
    v_perm_b32 v69, v101, v98, s31
    v_perm_b32 v70, v101, v99, s32
    v_perm_b32 v71, v101, v100, s33
    v_lshlrev_b16 v46, 3, v100
    v_lshlrev_b16 v44, 3, v99
    v_lshlrev_b16 v42, 3, v98
    s_cmp_le_u32 s16, 7
    s_cbranch_scc1 p2_gp
    v_cmpx_ge_u16 vcc, 0x3fff, v69
    ds_read_b64 v[42:43], v42
    s_mov_b64 exec, -1
    v_cmpx_ge_u16 vcc, 0x3fff, v70
    ds_read_b64 v[44:45], v44
    s_mov_b64 exec, -1
    v_cmpx_ge_u16 vcc, 0x3fff, v71
    ds_read_b64 v[46:47], v46
    s_mov_b64 exec, -1
p2_gp:
    s_waitcnt lgkmcnt(0)
    s_barrier
    s_branch p2_tail
p2_top:
    s_cmp_lg_u32 s21, 0
    s_cbranch_scc1 p2_topf
    s_cmp_eq_u32 s60, 10
    s_cbranch_scc1 p2_drain0
    v_cmpx_gt_i16 vcc, 0, v48
    ds_read_b64 v[0:1], v0
    s_mov_b64 exec, -1
    v_cmpx_gt_i16 vcc, 0, v49
    ds_read_b64 v[2:3], v2
    s_mov_b64 exec, -1
    v_cmpx_gt_i16 vcc, 0, v50
    ds_read_b64 v[4:5], v4
    s_mov_b64 exec, -1
    v_cmpx_gt_i16 vcc, 0, v51
    ds_read_b64 v[6:7], v6
    s_mov_b64 exec, -1
    v_cmpx_gt_i16 vcc, 0, v52
    ds_read_b64 v[8:9], v8
    s_mov_b64 exec, -1
    v_cmpx_gt_i16 vcc, 0, v53
    ds_read_b64 v[10:11], v10
    s_mov_b64 exec, -1
    v_cmpx_gt_i16 vcc, 0, v54
    ds_read_b64 v[12:13], v12
    s_mov_b64 exec, -1
    v_cmpx_gt_i16 vcc, 0, v55
    ds_read_b64 v[14:15], v14
    s_mov_b64 exec, -1
    v_cmpx_gt_i16 vcc, 0, v56
    ds_read_b64 v[16:17], v16
    s_mov_b64 exec, -1
    v_cmpx_gt_i16 vcc, 0, v57
    ds_read_b64 v[18:19], v18
    s_mov_b64 exec, -1
    v_cmpx_gt_i16 vcc, 0, v58
    ds_read_b64 v[20:21], v20
    s_mov_b64 exec, -1
    v_cmpx_gt_i16 vcc, 0, v59
    ds_read_b64 v[22:23], v22
    s_mov_b64 exec, -1
    s_cmp_ge_u32 s10, 9
    s_cbranch_scc1 p2_nm0m0a
    v_lshrrev_b32 v84, 1, v112
    s_add_u32 s44, s20, s42
    buffer_load_dwordx2 v[84:85], v84, s[4:7], s44 offen
p2_nm0m0a:
    buffer_load_dwordx4 v[72:75], v112, s[4:7], s20 offen offset:0
    buffer_load_dwordx4 v[76:79], v112, s[4:7], s20 offen offset:1024
    buffer_load_dwordx4 v[80:83], v112, s[4:7], s20 offen offset:2048
    v_cmpx_gt_i16 vcc, 0, v60
    ds_read_b64 v[24:25], v24
    s_mov_b64 exec, -1
    v_cmpx_gt_i16 vcc, 0, v61
    ds_read_b64 v[26:27], v26
    s_mov_b64 exec, -1
    v_cmpx_gt_i16 vcc, 0, v62
    ds_read_b64 v[28:29], v28
    s_mov_b64 exec, -1
    v_cmpx_gt_i16 vcc, 0, v63
    ds_read_b64 v[30:31], v30
    s_mov_b64 exec, -1
    v_cmpx_gt_i16 vcc, 0, v64
    ds_read_b64 v[32:33], v32
    s_mov_b64 exec, -1
    v_cmpx_gt_i16 vcc, 0, v65
    ds_read_b64 v[34:35], v34
    s_mov_b64 exec, -1
    v_cmpx_gt_i16 vcc, 0, v66
    ds_read_b64 v[36:37], v36
    s_mov_b64 exec, -1
    v_cmpx_gt_i16 vcc, 0, v67
    ds_read_b64 v[38:39], v38
    s_mov_b64 exec, -1
    v_cmpx_gt_i16 vcc, 0, v68
    ds_read_b64 v[40:41], v40
    s_mov_b64 exec, -1
    s_cmp_le_u32 s15, 7
    s_cbranch_scc1 p2_g0r27
    v_cmpx_gt_i16 vcc, 0, v69
    ds_read_b64 v[42:43], v42
    s_mov_b64 exec, -1
    v_cmpx_gt_i16 vcc, 0, v70
    ds_read_b64 v[44:45], v44
    s_mov_b64 exec, -1
    v_cmpx_gt_i16 vcc, 0, v71
    ds_read_b64 v[46:47], v46
    s_mov_b64 exec, -1
p2_g0r27:
    s_waitcnt lgkmcnt(15)
    v_ashrrev_i32 v122, 5, v48
    v_lshlrev_b16 v123, 2, v48
    v_lshlrev_b32 v124, 16, v0
    v_bitop3_b32 v122, v122, v113, v113 bitop3:0x0c
    v_and_b32 v125, 0xffff0000, v0
    v_lshlrev_b32 v126, 16, v1
    v_mul_f32 v122, v114, v122
    v_and_b32 v127, 0xffff0000, v1
    v_add_u32 v123, v123, v123
    v_pk_fma_f32 v[124:125], v[124:125], v[122:123], s[34:35] op_sel_hi:[1,0,1]
    v_pk_fma_f32 v[126:127], v[126:127], v[122:123], s[34:35] op_sel_hi:[1,0,1]
    v_lshl_add_u32 v124, v125, 16, v124
    v_lshl_add_u32 v125, v127, 16, v126
    s_waitcnt lgkmcnt(15)
    v_bitop3_b32 v115, v115, v116, v117 bitop3:0xfe
    v_lshl_add_u64 v[124:125], v[124:125], 0, s[36:37]
    v_cmpx_le_u32 vcc, 0x1000000, v48
    ds_add_rtn_u64 v[116:117], v123, v[124:125] offset:54272
    s_mov_b64 exec, -1
    v_ashrrev_i32 v122, 5, v49
    v_lshlrev_b16 v123, 2, v49
    v_lshlrev_b32 v124, 16, v2
    v_bitop3_b32 v122, v122, v113, v113 bitop3:0x0c
    v_and_b32 v125, 0xffff0000, v2
    v_lshlrev_b32 v126, 16, v3
    v_mul_f32 v122, v114, v122
    v_and_b32 v127, 0xffff0000, v3
    v_add_u32 v123, v123, v123
    v_pk_fma_f32 v[124:125], v[124:125], v[122:123], s[34:35] op_sel_hi:[1,0,1]
    v_pk_fma_f32 v[126:127], v[126:127], v[122:123], s[34:35] op_sel_hi:[1,0,1]
    v_lshl_add_u32 v124, v125, 16, v124
    v_lshl_add_u32 v125, v127, 16, v126
    s_waitcnt lgkmcnt(15)
    v_bitop3_b32 v115, v115, v118, v119 bitop3:0xfe
    v_lshl_add_u64 v[124:125], v[124:125], 0, s[36:37]
    v_cmpx_le_u32 vcc, 0x1000000, v49
    ds_add_rtn_u64 v[118:119], v123, v[124:125] offset:54272
    s_mov_b64 exec, -1
    v_ashrrev_i32 v122, 5, v50
    v_lshlrev_b16 v123, 2, v50
    v_lshlrev_b32 v124, 16, v4
    v_bitop3_b32 v122, v122, v113, v113 bitop3:0x0c
    v_and_b32 v125, 0xffff0000, v4
    v_lshlrev_b32 v126, 16, v5
    v_mul_f32 v122, v114, v122
    v_and_b32 v127, 0xffff0000, v5
    v_add_u32 v123, v123, v123
    v_pk_fma_f32 v[124:125], v[124:125], v[122:123], s[34:35] op_sel_hi:[1,0,1]
    v_pk_fma_f32 v[126:127], v[126:127], v[122:123], s[34:35] op_sel_hi:[1,0,1]
    v_lshl_add_u32 v124, v125, 16, v124
    v_lshl_add_u32 v125, v127, 16, v126
    s_waitcnt lgkmcnt(15)
    v_bitop3_b32 v115, v115, v120, v121 bitop3:0xfe
    v_lshl_add_u64 v[124:125], v[124:125], 0, s[36:37]
    v_cmpx_le_u32 vcc, 0x1000000, v50
    ds_add_rtn_u64 v[120:121], v123, v[124:125] offset:54272
    s_mov_b64 exec, -1
    v_lshrrev_b32 v0, 3, v102
    v_lshrrev_b32 v1, 18, v102
    v_and_b32 v102, 0x3fff, v102
    v_and_or_b32 v0, v0, s65, v1
    v_mad_u32_u24 v102, v0, s63, v102
    buffer_load_dwordx4 v[0:3], v102, s[68:71], 0 offen
    s_waitcnt lgkmcnt(15)
    v_ashrrev_i32 v122, 5, v51
    v_lshlrev_b16 v123, 2, v51
    v_lshlrev_b32 v124, 16, v6
    v_bitop3_b32 v122, v122, v113, v113 bitop3:0x0c
    v_and_b32 v125, 0xffff0000, v6
    v_lshlrev_b32 v126, 16, v7
    v_mul_f32 v122, v114, v122
    v_and_b32 v127, 0xffff0000, v7
    v_add_u32 v123, v123, v123
    v_pk_fma_f32 v[124:125], v[124:125], v[122:123], s[34:35] op_sel_hi:[1,0,1]
    v_pk_fma_f32 v[126:127], v[126:127], v[122:123], s[34:35] op_sel_hi:[1,0,1]
    v_lshl_add_u32 v124, v125, 16, v124
    v_lshl_add_u32 v125, v127, 16, v126
    s_waitcnt lgkmcnt(2)
    v_bitop3_b32 v115, v115, v116, v117 bitop3:0xfe
    v_lshl_add_u64 v[124:125], v[124:125], 0, s[36:37]
    v_cmpx_le_u32 vcc, 0x1000000, v51
    ds_add_rtn_u64 v[116:117], v123, v[124:125] offset:54272
    s_mov_b64 exec, -1
    v_ashrrev_i32 v122, 5, v52
    v_lshlrev_b16 v123, 2, v52
    v_lshlrev_b32 v124, 16, v8
    v_bitop3_b32 v122, v122, v113, v113 bitop3:0x0c
    v_and_b32 v125, 0xffff0000, v8
    v_lshlrev_b32 v126, 16, v9
    v_mul_f32 v122, v114, v122
    v_and_b32 v127, 0xffff0000, v9
    v_add_u32 v123, v123, v123
    v_pk_fma_f32 v[124:125], v[124:125], v[122:123], s[34:35] op_sel_hi:[1,0,1]
    v_pk_fma_f32 v[126:127], v[126:127], v[122:123], s[34:35] op_sel_hi:[1,0,1]
    v_lshl_add_u32 v124, v125, 16, v124
    v_lshl_add_u32 v125, v127, 16, v126
    s_waitcnt lgkmcnt(2)
    v_bitop3_b32 v115, v115, v118, v119 bitop3:0xfe
    v_lshl_add_u64 v[124:125], v[124:125], 0, s[36:37]
    v_cmpx_le_u32 vcc, 0x1000000, v52
    ds_add_rtn_u64 v[118:119], v123, v[124:125] offset:54272
    s_mov_b64 exec, -1
    v_ashrrev_i32 v122, 5, v53
    v_lshlrev_b16 v123, 2, v53
    v_lshlrev_b32 v124, 16, v10
    v_bitop3_b32 v122, v122, v113, v113 bitop3:0x0c
    v_and_b32 v125, 0xffff0000, v10
    v_lshlrev_b32 v126, 16, v11
    v_mul_f32 v122, v114, v122
    v_and_b32 v127, 0xffff0000, v11
    v_add_u32 v123, v123, v123
    v_pk_fma_f32 v[124:125], v[124:125], v[122:123], s[34:35] op_sel_hi:[1,0,1]
    v_pk_fma_f32 v[126:127], v[126:127], v[122:123], s[34:35] op_sel_hi:[1,0,1]
    v_lshl_add_u32 v124, v125, 16, v124
    v_lshl_add_u32 v125, v127, 16, v126
    s_waitcnt lgkmcnt(2)
    v_bitop3_b32 v115, v115, v120, v121 bitop3:0xfe
    v_lshl_add_u64 v[124:125], v[124:125], 0, s[36:37]
    v_cmpx_le_u32 vcc, 0x1000000, v53
    ds_add_rtn_u64 v[120:121], v123, v[124:125] offset:54272
    s_mov_b64 exec, -1
    v_lshrrev_b32 v6, 3, v103
    v_lshrrev_b32 v7, 18, v103
    v_and_b32 v103, 0x3fff, v103
    v_and_or_b32 v6, v6, s65, v7
    v_mad_u32_u24 v103, v6, s63, v103
    buffer_load_dwordx4 v[6:9], v103, s[68:71], 0 offen
    s_waitcnt lgkmcnt(6)
    s_barrier
    s_waitcnt lgkmcnt(15)
    v_ashrrev_i32 v122, 5, v54
    v_lshlrev_b16 v123, 2, v54
    v_lshlrev_b32 v124, 16, v12
    v_bitop3_b32 v122, v122, v113, v113 bitop3:0x0c
    v_and_b32 v125, 0xffff0000, v12
    v_lshlrev_b32 v126, 16, v13
    v_mul_f32 v122, v114, v122
    v_and_b32 v127, 0xffff0000, v13
    v_add_u32 v123, v123, v123
    v_pk_fma_f32 v[124:125], v[124:125], v[122:123], s[34:35] op_sel_hi:[1,0,1]
    v_pk_fma_f32 v[126:127], v[126:127], v[122:123], s[34:35] op_sel_hi:[1,0,1]
    v_lshl_add_u32 v124, v125, 16, v124
    v_lshl_add_u32 v125, v127, 16, v126
    s_waitcnt lgkmcnt(2)
    v_bitop3_b32 v115, v115, v116, v117 bitop3:0xfe
    v_lshl_add_u64 v[124:125], v[124:125], 0, s[36:37]
    v_cmpx_le_u32 vcc, 0x1000000, v54
    ds_add_rtn_u64 v[116:117], v123, v[124:125] offset:54272
    s_mov_b64 exec, -1
    v_ashrrev_i32 v122, 5, v55
    v_lshlrev_b16 v123, 2, v55
    v_lshlrev_b32 v124, 16, v14
    v_bitop3_b32 v122, v122, v113, v113 bitop3:0x0c
    v_and_b32 v125, 0xffff0000, v14
    v_lshlrev_b32 v126, 16, v15
    v_mul_f32 v122, v114, v122
    v_and_b32 v127, 0xffff0000, v15
    v_add_u32 v123, v123, v123
    v_pk_fma_f32 v[124:125], v[124:125], v[122:123], s[34:35] op_sel_hi:[1,0,1]
    v_pk_fma_f32 v[126:127], v[126:127], v[122:123], s[34:35] op_sel_hi:[1,0,1]
    v_lshl_add_u32 v124, v125, 16, v124
    v_lshl_add_u32 v125, v127, 16, v126
    s_waitcnt lgkmcnt(2)
    v_bitop3_b32 v115, v115, v118, v119 bitop3:0xfe
    v_lshl_add_u64 v[124:125], v[124:125], 0, s[36:37]
    v_cmpx_le_u32 vcc, 0x1000000, v55
    ds_add_rtn_u64 v[118:119], v123, v[124:125] offset:54272
    s_mov_b64 exec, -1
    v_ashrrev_i32 v122, 5, v56
    v_lshlrev_b16 v123, 2, v56
    v_lshlrev_b32 v124, 16, v16
    v_bitop3_b32 v122, v122, v113, v113 bitop3:0x0c
    v_and_b32 v125, 0xffff0000, v16
    v_lshlrev_b32 v126, 16, v17
    v_mul_f32 v122, v114, v122
    v_and_b32 v127, 0xffff0000, v17
    v_add_u32 v123, v123, v123
    v_pk_fma_f32 v[124:125], v[124:125], v[122:123], s[34:35] op_sel_hi:[1,0,1]
    v_pk_fma_f32 v[126:127], v[126:127], v[122:123], s[34:35] op_sel_hi:[1,0,1]
    v_lshl_add_u32 v124, v125, 16, v124
    v_lshl_add_u32 v125, v127, 16, v126
    s_waitcnt lgkmcnt(2)
    v_bitop3_b32 v115, v115, v120, v121 bitop3:0xfe
    v_lshl_add_u64 v[124:125], v[124:125], 0, s[36:37]
    v_cmpx_le_u32 vcc, 0x1000000, v56
    ds_add_rtn_u64 v[120:121], v123, v[124:125] offset:54272
    s_mov_b64 exec, -1
    v_lshrrev_b32 v12, 3, v104
    v_lshrrev_b32 v13, 18, v104
    v_and_b32 v104, 0x3fff, v104
    v_and_or_b32 v12, v12, s65, v13
    v_mad_u32_u24 v104, v12, s63, v104
    buffer_load_dwordx4 v[12:15], v104, s[68:71], 0 offen
    s_waitcnt lgkmcnt(15)
    v_ashrrev_i32 v122, 5, v57
    v_lshlrev_b16 v123, 2, v57
    v_lshlrev_b32 v124, 16, v18
    v_bitop3_b32 v122, v122, v113, v113 bitop3:0x0c
    v_and_b32 v125, 0xffff0000, v18
    v_lshlrev_b32 v126, 16, v19
    v_mul_f32 v122, v114, v122
    v_and_b32 v127, 0xffff0000, v19
    v_add_u32 v123, v123, v123
    v_pk_fma_f32 v[124:125], v[124:125], v[122:123], s[34:35] op_sel_hi:[1,0,1]
    v_pk_fma_f32 v[126:127], v[126:127], v[122:123], s[34:35] op_sel_hi:[1,0,1]
    v_lshl_add_u32 v124, v125, 16, v124
    v_lshl_add_u32 v125, v127, 16, v126
    s_waitcnt lgkmcnt(2)
    v_bitop3_b32 v115, v115, v116, v117 bitop3:0xfe
    v_lshl_add_u64 v[124:125], v[124:125], 0, s[36:37]
    v_cmpx_le_u32 vcc, 0x1000000, v57
    ds_add_rtn_u64 v[116:117], v123, v[124:125] offset:54272
    s_mov_b64 exec, -1
    v_ashrrev_i32 v122, 5, v58
    v_lshlrev_b16 v123, 2, v58
    v_lshlrev_b32 v124, 16, v20
    v_bitop3_b32 v122, v122, v113, v113 bitop3:0x0c
    v_and_b32 v125, 0xffff0000, v20
    v_lshlrev_b32 v126, 16, v21
    v_mul_f32 v122, v114, v122
    v_and_b32 v127, 0xffff0000, v21
    v_add_u32 v123, v123, v123
    v_pk_fma_f32 v[124:125], v[124:125], v[122:123], s[34:35] op_sel_hi:[1,0,1]
    v_pk_fma_f32 v[126:127], v[126:127], v[122:123], s[34:35] op_sel_hi:[1,0,1]
    v_lshl_add_u32 v124, v125, 16, v124
    v_lshl_add_u32 v125, v127, 16, v126
    s_waitcnt lgkmcnt(2)
    v_bitop3_b32 v115, v115, v118, v119 bitop3:0xfe
    v_lshl_add_u64 v[124:125], v[124:125], 0, s[36:37]
    v_cmpx_le_u32 vcc, 0x1000000, v58
    ds_add_rtn_u64 v[118:119], v123, v[124:125] offset:54272
    s_mov_b64 exec, -1
    v_ashrrev_i32 v122, 5, v59
    v_lshlrev_b16 v123, 2, v59
    v_lshlrev_b32 v124, 16, v22
    v_bitop3_b32 v122, v122, v113, v113 bitop3:0x0c
    v_and_b32 v125, 0xffff0000, v22
    v_lshlrev_b32 v126, 16, v23
    v_mul_f32 v122, v114, v122
    v_and_b32 v127, 0xffff0000, v23
    v_add_u32 v123, v123, v123
    v_pk_fma_f32 v[124:125], v[124:125], v[122:123], s[34:35] op_sel_hi:[1,0,1]
    v_pk_fma_f32 v[126:127], v[126:127], v[122:123], s[34:35] op_sel_hi:[1,0,1]
    v_lshl_add_u32 v124, v125, 16, v124
    v_lshl_add_u32 v125, v127, 16, v126
    s_waitcnt lgkmcnt(2)
    v_bitop3_b32 v115, v115, v120, v121 bitop3:0xfe
    v_lshl_add_u64 v[124:125], v[124:125], 0, s[36:37]
    v_cmpx_le_u32 vcc, 0x1000000, v59
    ds_add_rtn_u64 v[120:121], v123, v[124:125] offset:54272
    s_mov_b64 exec, -1
    v_lshrrev_b32 v18, 3, v105
    v_lshrrev_b32 v19, 18, v105
    v_and_b32 v105, 0x3fff, v105
    v_and_or_b32 v18, v18, s65, v19
    v_mad_u32_u24 v105, v18, s63, v105
    buffer_load_dwordx4 v[18:21], v105, s[68:71], 0 offen
    s_mov_b32 m0, s23
    v_mov_b32 v53, 0x3c000
    s_movk_i32 s44, 512
    v_sub_u32_sdwa v4, v111, v110 dst_sel:DWORD dst_unused:UNUSED_PAD src0_sel:WORD_0 src1_sel:WORD_0
    v_sub_u32_sdwa v5, v111, v110 dst_sel:DWORD dst_unused:UNUSED_PAD src0_sel:WORD_1 src1_sel:WORD_1
    v_med3_i32 v4, v4, 0, s44
    v_med3_i32 v5, v5, 0, s44
    v_add_u32 v48, v4, v5
    ds_write_addtid_b32 v53 offset:0
    ds_write_addtid_b32 v53 offset:256
    ds_write_addtid_b32 v53 offset:512
    ds_write_addtid_b32 v53 offset:768
    ds_write_addtid_b32 v53 offset:1024
    ds_write_addtid_b32 v53 offset:1280
    ds_write_addtid_b32 v53 offset:1536
    ds_write_addtid_b32 v53 offset:1792
    v_and_b32 v49, 0x3c0, v112
    v_and_b32 v53, 0x30, v112
    v_lshl_or_b32 v53, v49, 4, v53
    v_lshl_add_u32 v53, v53, 15, s41
    s_nop 1
    v_add_u32_dpp v48, v48, v48 row_shr:1 row_mask:0xf bank_mask:0xf bound_ctrl:0
    s_nop 1
    v_add_u32_dpp v48, v48, v48 row_shr:2 row_mask:0xf bank_mask:0xf bound_ctrl:0
    s_nop 1
    v_add_u32_dpp v48, v48, v48 row_shr:4 row_mask:0xf bank_mask:0xf bound_ctrl:0
    s_nop 1
    v_add_u32_dpp v48, v48, v48 row_shr:8 row_mask:0xf bank_mask:0xf bound_ctrl:0
    s_nop 1
    v_add_u32_dpp v48, v48, v48 row_bcast:15 row_mask:0xa bank_mask:0xf
    s_nop 1
    v_add_u32_dpp v48, v48, v48 row_bcast:31 row_mask:0xc bank_mask:0xf
    s_nop 1
    s_nop 0
    v_readlane_b32 s38, v48, 63
    v_sub_u32 v50, v48, v5
    v_sub_u32 v49, v50, v4
    v_sub_u32 v10, 512, v49
    v_mad_u32_u16 v51, v110, 16, v53
    v_med3_i32 v10, v10, 0, v4
    v_lshl_add_u32 v49, v49, 2, s23
    v_sub_u32 v11, 512, v50
    v_mad_u32_u16 v52, v110, 16, v53 op_sel:[1,0,0,0]
    v_med3_i32 v11, v11, 0, v5
    v_lshl_add_u32 v50, v50, 2, s23
    v_lshl_add_u32 v48, v11, 16, v10
    v_add_u32 v52, 262144, v52
    v_add_u32 v110, v110, v48
    s_min_u32 s17, s38, 512
    s_add_u32 s17, s17, 63
    s_lshr_b32 s17, s17, 6
p2_x0x_0:
    v_cmpx_lt_i32 vcc, 0, v10
    s_cbranch_execz p2_y0x_0
    ds_write_b32 v49, v51 offset:0
    v_add_u32 v51, 16, v51
    v_cmpx_lt_i32 vcc, 1, v10
    s_cbranch_execz p2_y0x_0
    ds_write_b32 v49, v51 offset:4
    v_add_u32 v51, 16, v51
    v_cmpx_lt_i32 vcc, 2, v10
    s_cbranch_execz p2_y0x_0
    ds_write_b32 v49, v51 offset:8
    v_add_u32 v51, 16, v51
    v_cmpx_lt_i32 vcc, 3, v10
    s_cbranch_execz p2_y0x_0
    ds_write_b32 v49, v51 offset:12
    v_add_u32 v51, 16, v51
    v_cmpx_lt_i32 vcc, 4, v10
    s_cbranch_execz p2_y0x_0
    ds_write_b32 v49, v51 offset:16
    v_add_u32 v51, 16, v51
    v_cmpx_lt_i32 vcc, 5, v10
    s_cbranch_execz p2_y0x_0
    ds_write_b32 v49, v51 offset:20
    v_add_u32 v51, 16, v51
    v_cmpx_lt_i32 vcc, 6, v10
    s_cbranch_execz p2_y0x_0
    ds_write_b32 v49, v51 offset:24
    v_add_u32 v51, 16, v51
    v_cmpx_lt_i32 vcc, 7, v10
    s_cbranch_execz p2_y0x_0
    ds_write_b32 v49, v51 offset:28
    v_add_u32 v51, 16, v51
    v_subrev_u32 v10, 8, v10
    v_add_u32 v49, 32, v49
    s_branch p2_x0x_0
p2_y0x_0:
    s_mov_b64 exec, -1
p2_x0x_1:
    v_cmpx_lt_i32 vcc, 0, v11
    s_cbranch_execz p2_y0x_1
    ds_write_b32 v50, v52 offset:0
    v_add_u32 v52, 16, v52
    v_cmpx_lt_i32 vcc, 1, v11
    s_cbranch_execz p2_y0x_1
    ds_write_b32 v50, v52 offset:4
    v_add_u32 v52, 16, v52
    v_cmpx_lt_i32 vcc, 2, v11
    s_cbranch_execz p2_y0x_1
    ds_write_b32 v50, v52 offset:8
    v_add_u32 v52, 16, v52
    v_cmpx_lt_i32 vcc, 3, v11
    s_cbranch_execz p2_y0x_1
    ds_write_b32 v50, v52 offset:12
    v_add_u32 v52, 16, v52
    v_cmpx_lt_i32 vcc, 4, v11
    s_cbranch_execz p2_y0x_1
    ds_write_b32 v50, v52 offset:16
    v_add_u32 v52, 16, v52
    v_cmpx_lt_i32 vcc, 5, v11
    s_cbranch_execz p2_y0x_1
    ds_write_b32 v50, v52 offset:20
    v_add_u32 v52, 16, v52
    v_cmpx_lt_i32 vcc, 6, v11
    s_cbranch_execz p2_y0x_1
    ds_write_b32 v50, v52 offset:24
    v_add_u32 v52, 16, v52
    v_cmpx_lt_i32 vcc, 7, v11
    s_cbranch_execz p2_y0x_1
    ds_write_b32 v50, v52 offset:28
    v_add_u32 v52, 16, v52
    v_subrev_u32 v11, 8, v11
    v_add_u32 v50, 32, v50
    s_branch p2_x0x_1
p2_y0x_1:
    s_mov_b64 exec, -1
    s_cmp_lt_u32 s38, 512
    s_cbranch_scc1 p2_nomore0x
    v_cmp_lt_u32_sdwa s[44:45], v110, v111 src0_sel:WORD_0 src1_sel:WORD_0
    v_cmp_lt_u32_sdwa s[46:47], v110, v111 src0_sel:WORD_1 src1_sel:WORD_1
    s_nop 0
    s_or_b64 s[44:45], s[44:45], s[46:47]
    s_cbranch_scc0 p2_nomore0x
    v_mov_b32 v49, s19
    v_mov_b32 v50, 1
    ds_write_b32 v49, v50 offset:53760
p2_nomore0x:
    s_mov_b32 m0, s23
    s_nop 0
    ds_read_addtid_b32 v102 offset:0
    ds_read_addtid_b32 v103 offset:256
    ds_read_addtid_b32 v104 offset:512
    ds_read_addtid_b32 v105 offset:768
    ds_read_addtid_b32 v106 offset:1024
    ds_read_addtid_b32 v107 offset:1280
    ds_read_addtid_b32 v108 offset:1536
    ds_read_addtid_b32 v109 offset:1792
    s_waitcnt vmcnt(4)
    s_mov_b32 m0, s24
    s_cmp_ge_u32 s10, 9
    s_cbranch_scc1 p2_st0s0
    ds_write_addtid_b32 v84 offset:49152
    ds_write_addtid_b32 v85 offset:49408
p2_st0s0:
    s_mov_b32 m0, s23
    s_add_u32 s20, s20, 53760
    ds_write_addtid_b32 v72 offset:0
    ds_write_addtid_b32 v73 offset:256
    ds_write_addtid_b32 v74 offset:512
    ds_write_addtid_b32 v75 offset:768
    ds_write_addtid_b32 v76 offset:1024
    ds_write_addtid_b32 v77 offset:1280
    ds_write_addtid_b32 v78 offset:1536
    ds_write_addtid_b32 v79 offset:1792
    ds_write_addtid_b32 v80 offset:2048
    ds_write_addtid_b32 v81 offset:2304
    ds_write_addtid_b32 v82 offset:2560
    ds_write_addtid_b32 v83 offset:2816
    s_waitcnt lgkmcnt(15)
    v_ashrrev_i32 v122, 5, v60
    v_lshlrev_b16 v123, 2, v60
    v_lshlrev_b32 v124, 16, v24
    v_bitop3_b32 v122, v122, v113, v113 bitop3:0x0c
    v_and_b32 v125, 0xffff0000, v24
    v_lshlrev_b32 v126, 16, v25
    v_mul_f32 v122, v114, v122
    v_and_b32 v127, 0xffff0000, v25
    v_add_u32 v123, v123, v123
    v_pk_fma_f32 v[124:125], v[124:125], v[122:123], s[34:35] op_sel_hi:[1,0,1]
    v_pk_fma_f32 v[126:127], v[126:127], v[122:123], s[34:35] op_sel_hi:[1,0,1]
    v_lshl_add_u32 v124, v125, 16, v124
    v_lshl_add_u32 v125, v127, 16, v126
    s_waitcnt lgkmcnt(15)
    v_bitop3_b32 v115, v115, v116, v117 bitop3:0xfe
    v_lshl_add_u64 v[124:125], v[124:125], 0, s[36:37]
    v_cmpx_le_u32 vcc, 0x1000000, v60
    ds_add_rtn_u64 v[116:117], v123, v[124:125] offset:54272
    s_mov_b64 exec, -1
    v_ashrrev_i32 v122, 5, v61
    v_lshlrev_b16 v123, 2, v61
    v_lshlrev_b32 v124, 16, v26
    v_bitop3_b32 v122, v122, v113, v113 bitop3:0x0c
    v_and_b32 v125, 0xffff0000, v26
    v_lshlrev_b32 v126, 16, v27
    v_mul_f32 v122, v114, v122
    v_and_b32 v127, 0xffff0000, v27
    v_add_u32 v123, v123, v123
    v_pk_fma_f32 v[124:125], v[124:125], v[122:123], s[34:35] op_sel_hi:[1,0,1]
    v_pk_fma_f32 v[126:127], v[126:127], v[122:123], s[34:35] op_sel_hi:[1,0,1]
    v_lshl_add_u32 v124, v125, 16, v124
    v_lshl_add_u32 v125, v127, 16, v126
    s_waitcnt lgkmcnt(15)
    v_bitop3_b32 v115, v115, v118, v119 bitop3:0xfe
    v_lshl_add_u64 v[124:125], v[124:125], 0, s[36:37]
    v_cmpx_le_u32 vcc, 0x1000000, v61
    ds_add_rtn_u64 v[118:119], v123, v[124:125] offset:54272
    s_mov_b64 exec, -1
    v_ashrrev_i32 v122, 5, v62
    v_lshlrev_b16 v123, 2, v62
    v_lshlrev_b32 v124, 16, v28
    v_bitop3_b32 v122, v122, v113, v113 bitop3:0x0c
    v_and_b32 v125, 0xffff0000, v28
    v_lshlrev_b32 v126, 16, v29
    v_mul_f32 v122, v114, v122
    v_and_b32 v127, 0xffff0000, v29
    v_add_u32 v123, v123, v123
    v_pk_fma_f32 v[124:125], v[124:125], v[122:123], s[34:35] op_sel_hi:[1,0,1]
    v_pk_fma_f32 v[126:127], v[126:127], v[122:123], s[34:35] op_sel_hi:[1,0,1]
    v_lshl_add_u32 v124, v125, 16, v124
    v_lshl_add_u32 v125, v127, 16, v126
    s_waitcnt lgkmcnt(15)
    v_bitop3_b32 v115, v115, v120, v121 bitop3:0xfe
    v_lshl_add_u64 v[124:125], v[124:125], 0, s[36:37]
    v_cmpx_le_u32 vcc, 0x1000000, v62
    ds_add_rtn_u64 v[120:121], v123, v[124:125] offset:54272
    s_mov_b64 exec, -1
    s_waitcnt vmcnt(13)
    v_perm_b32 v60, v89, v86, s31
    v_perm_b32 v61, v89, v87, s32
    v_perm_b32 v62, v89, v88, s33
    v_lshlrev_b16 v28, 3, v88
    v_lshlrev_b16 v26, 3, v87
    v_lshlrev_b16 v24, 3, v86
    s_waitcnt lgkmcnt(3)
    s_barrier
    s_cmp_ge_u32 s10, 9
    s_cbranch_scc1 p2_nm0m1a
    v_lshrrev_b32 v84, 1, v112
    s_add_u32 s44, s20, s42
    buffer_load_dwordx2 v[84:85], v84, s[4:7], s44 offen
p2_nm0m1a:
    buffer_load_dwordx4 v[72:75], v112, s[4:7], s20 offen offset:0
    buffer_load_dwordx4 v[76:79], v112, s[4:7], s20 offen offset:1024
    buffer_load_dwordx4 v[80:83], v112, s[4:7], s20 offen offset:2048
    v_cmpx_ge_u16 vcc, 0x3fff, v60
    ds_read_b64 v[24:25], v24
    s_mov_b64 exec, -1
    v_cmpx_ge_u16 vcc, 0x3fff, v61
    ds_read_b64 v[26:27], v26
    s_mov_b64 exec, -1
    v_cmpx_ge_u16 vcc, 0x3fff, v62
    ds_read_b64 v[28:29], v28
    s_mov_b64 exec, -1
    s_waitcnt lgkmcnt(15)
    v_ashrrev_i32 v122, 5, v63
    v_lshlrev_b16 v123, 2, v63
    v_lshlrev_b32 v124, 16, v30
    v_bitop3_b32 v122, v122, v113, v113 bitop3:0x0c
    v_and_b32 v125, 0xffff0000, v30
    v_lshlrev_b32 v126, 16, v31
    v_mul_f32 v122, v114, v122
    v_and_b32 v127, 0xffff0000, v31
    v_add_u32 v123, v123, v123
    v_pk_fma_f32 v[124:125], v[124:125], v[122:123], s[34:35] op_sel_hi:[1,0,1]
    v_pk_fma_f32 v[126:127], v[126:127], v[122:123], s[34:35] op_sel_hi:[1,0,1]
    v_lshl_add_u32 v124, v125, 16, v124
    v_lshl_add_u32 v125, v127, 16, v126
    s_waitcnt lgkmcnt(5)
    v_bitop3_b32 v115, v115, v116, v117 bitop3:0xfe
    v_lshl_add_u64 v[124:125], v[124:125], 0, s[36:37]
    v_cmpx_le_u32 vcc, 0x1000000, v63
    ds_add_rtn_u64 v[116:117], v123, v[124:125] offset:54272
    s_mov_b64 exec, -1
    v_ashrrev_i32 v122, 5, v64
    v_lshlrev_b16 v123, 2, v64
    v_lshlrev_b32 v124, 16, v32
    v_bitop3_b32 v122, v122, v113, v113 bitop3:0x0c
    v_and_b32 v125, 0xffff0000, v32
    v_lshlrev_b32 v126, 16, v33
    v_mul_f32 v122, v114, v122
    v_and_b32 v127, 0xffff0000, v33
    v_add_u32 v123, v123, v123
    v_pk_fma_f32 v[124:125], v[124:125], v[122:123], s[34:35] op_sel_hi:[1,0,1]
    v_pk_fma_f32 v[126:127], v[126:127], v[122:123], s[34:35] op_sel_hi:[1,0,1]
    v_lshl_add_u32 v124, v125, 16, v124
    v_lshl_add_u32 v125, v127, 16, v126
    s_waitcnt lgkmcnt(5)
    v_bitop3_b32 v115, v115, v118, v119 bitop3:0xfe
    v_lshl_add_u64 v[124:125], v[124:125], 0, s[36:37]
    v_cmpx_le_u32 vcc, 0x1000000, v64
    ds_add_rtn_u64 v[118:119], v123, v[124:125] offset:54272
    s_mov_b64 exec, -1
    v_ashrrev_i32 v122, 5, v65
    v_lshlrev_b16 v123, 2, v65
    v_lshlrev_b32 v124, 16, v34
    v_bitop3_b32 v122, v122, v113, v113 bitop3:0x0c
    v_and_b32 v125, 0xffff0000, v34
    v_lshlrev_b32 v126, 16, v35
    v_mul_f32 v122, v114, v122
    v_and_b32 v127, 0xffff0000, v35
    v_add_u32 v123, v123, v123
    v_pk_fma_f32 v[124:125], v[124:125], v[122:123], s[34:35] op_sel_hi:[1,0,1]
    v_pk_fma_f32 v[126:127], v[126:127], v[122:123], s[34:35] op_sel_hi:[1,0,1]
    v_lshl_add_u32 v124, v125, 16, v124
    v_lshl_add_u32 v125, v127, 16, v126
    s_waitcnt lgkmcnt(5)
    v_bitop3_b32 v115, v115, v120, v121 bitop3:0xfe
    v_lshl_add_u64 v[124:125], v[124:125], 0, s[36:37]
    v_cmpx_le_u32 vcc, 0x1000000, v65
    ds_add_rtn_u64 v[120:121], v123, v[124:125] offset:54272
    s_mov_b64 exec, -1
    s_waitcnt vmcnt(15)
    v_perm_b32 v63, v93, v90, s31
    v_perm_b32 v64, v93, v91, s32
    v_perm_b32 v65, v93, v92, s33
    v_lshlrev_b16 v34, 3, v92
    v_lshlrev_b16 v32, 3, v91
    v_lshlrev_b16 v30, 3, v90
    v_cmpx_ge_u16 vcc, 0x3fff, v63
    ds_read_b64 v[30:31], v30
    s_mov_b64 exec, -1
    v_cmpx_ge_u16 vcc, 0x3fff, v64
    ds_read_b64 v[32:33], v32
    s_mov_b64 exec, -1
    v_cmpx_ge_u16 vcc, 0x3fff, v65
    ds_read_b64 v[34:35], v34
    s_mov_b64 exec, -1
    s_waitcnt lgkmcnt(15)
    v_lshrrev_b32 v86, 3, v106
    v_lshrrev_b32 v87, 18, v106
    v_and_b32 v106, 0x3fff, v106
    v_and_or_b32 v86, v86, s65, v87
    v_mad_u32_u24 v106, v86, s63, v106
    buffer_load_dwordx4 v[86:89], v106, s[68:71], 0 offen
    s_waitcnt lgkmcnt(15)
    v_ashrrev_i32 v122, 5, v66
    v_lshlrev_b16 v123, 2, v66
    v_lshlrev_b32 v124, 16, v36
    v_bitop3_b32 v122, v122, v113, v113 bitop3:0x0c
    v_and_b32 v125, 0xffff0000, v36
    v_lshlrev_b32 v126, 16, v37
    v_mul_f32 v122, v114, v122
    v_and_b32 v127, 0xffff0000, v37
    v_add_u32 v123, v123, v123
    v_pk_fma_f32 v[124:125], v[124:125], v[122:123], s[34:35] op_sel_hi:[1,0,1]
    v_pk_fma_f32 v[126:127], v[126:127], v[122:123], s[34:35] op_sel_hi:[1,0,1]
    v_lshl_add_u32 v124, v125, 16, v124
    v_lshl_add_u32 v125, v127, 16, v126
    s_waitcnt lgkmcnt(5)
    v_bitop3_b32 v115, v115, v116, v117 bitop3:0xfe
    v_lshl_add_u64 v[124:125], v[124:125], 0, s[36:37]
    v_cmpx_le_u32 vcc, 0x1000000, v66
    ds_add_rtn_u64 v[116:117], v123, v[124:125] offset:54272
    s_mov_b64 exec, -1
    v_ashrrev_i32 v122, 5, v67
    v_lshlrev_b16 v123, 2, v67
    v_lshlrev_b32 v124, 16, v38
    v_bitop3_b32 v122, v122, v113, v113 bitop3:0x0c
    v_and_b32 v125, 0xffff0000, v38
    v_lshlrev_b32 v126, 16, v39
    v_mul_f32 v122, v114, v122
    v_and_b32 v127, 0xffff0000, v39
    v_add_u32 v123, v123, v123
    v_pk_fma_f32 v[124:125], v[124:125], v[122:123], s[34:35] op_sel_hi:[1,0,1]
    v_pk_fma_f32 v[126:127], v[126:127], v[122:123], s[34:35] op_sel_hi:[1,0,1]
    v_lshl_add_u32 v124, v125, 16, v124
    v_lshl_add_u32 v125, v127, 16, v126
    s_waitcnt lgkmcnt(5)
    v_bitop3_b32 v115, v115, v118, v119 bitop3:0xfe
    v_lshl_add_u64 v[124:125], v[124:125], 0, s[36:37]
    v_cmpx_le_u32 vcc, 0x1000000, v67
    ds_add_rtn_u64 v[118:119], v123, v[124:125] offset:54272
    s_mov_b64 exec, -1
    v_ashrrev_i32 v122, 5, v68
    v_lshlrev_b16 v123, 2, v68
    v_lshlrev_b32 v124, 16, v40
    v_bitop3_b32 v122, v122, v113, v113 bitop3:0x0c
    v_and_b32 v125, 0xffff0000, v40
    v_lshlrev_b32 v126, 16, v41
    v_mul_f32 v122, v114, v122
    v_and_b32 v127, 0xffff0000, v41
    v_add_u32 v123, v123, v123
    v_pk_fma_f32 v[124:125], v[124:125], v[122:123], s[34:35] op_sel_hi:[1,0,1]
    v_pk_fma_f32 v[126:127], v[126:127], v[122:123], s[34:35] op_sel_hi:[1,0,1]
    v_lshl_add_u32 v124, v125, 16, v124
    v_lshl_add_u32 v125, v127, 16, v126
    s_waitcnt lgkmcnt(5)
    v_bitop3_b32 v115, v115, v120, v121 bitop3:0xfe
    v_lshl_add_u64 v[124:125], v[124:125], 0, s[36:37]
    v_cmpx_le_u32 vcc, 0x1000000, v68
    ds_add_rtn_u64 v[120:121], v123, v[124:125] offset:54272
    s_mov_b64 exec, -1
    s_waitcnt vmcnt(12)
    v_perm_b32 v66, v97, v94, s31
    v_perm_b32 v67, v97, v95, s32
    v_perm_b32 v68, v97, v96, s33
    v_lshlrev_b16 v40, 3, v96
    v_lshlrev_b16 v38, 3, v95
    v_lshlrev_b16 v36, 3, v94
    v_cmpx_ge_u16 vcc, 0x3fff, v66
    ds_read_b64 v[36:37], v36
    s_mov_b64 exec, -1
    v_cmpx_ge_u16 vcc, 0x3fff, v67
    ds_read_b64 v[38:39], v38
    s_mov_b64 exec, -1
    v_cmpx_ge_u16 vcc, 0x3fff, v68
    ds_read_b64 v[40:41], v40
    s_mov_b64 exec, -1
    s_cmp_le_u32 s15, 7
    s_cbranch_scc1 p2_na0a7
    s_waitcnt lgkmcnt(15)
    v_ashrrev_i32 v122, 5, v69
    v_lshlrev_b16 v123, 2, v69
    v_lshlrev_b32 v124, 16, v42
    v_bitop3_b32 v122, v122, v113, v113 bitop3:0x0c
    v_and_b32 v125, 0xffff0000, v42
    v_lshlrev_b32 v126, 16, v43
    v_mul_f32 v122, v114, v122
    v_and_b32 v127, 0xffff0000, v43
    v_add_u32 v123, v123, v123
    v_pk_fma_f32 v[124:125], v[124:125], v[122:123], s[34:35] op_sel_hi:[1,0,1]
    v_pk_fma_f32 v[126:127], v[126:127], v[122:123], s[34:35] op_sel_hi:[1,0,1]
    v_lshl_add_u32 v124, v125, 16, v124
    v_lshl_add_u32 v125, v127, 16, v126
    s_waitcnt lgkmcnt(5)
    v_bitop3_b32 v115, v115, v116, v117 bitop3:0xfe
    v_lshl_add_u64 v[124:125], v[124:125], 0, s[36:37]
    v_cmpx_le_u32 vcc, 0x1000000, v69
    ds_add_rtn_u64 v[116:117], v123, v[124:125] offset:54272
    s_mov_b64 exec, -1
    v_ashrrev_i32 v122, 5, v70
    v_lshlrev_b16 v123, 2, v70
    v_lshlrev_b32 v124, 16, v44
    v_bitop3_b32 v122, v122, v113, v113 bitop3:0x0c
    v_and_b32 v125, 0xffff0000, v44
    v_lshlrev_b32 v126, 16, v45
    v_mul_f32 v122, v114, v122
    v_and_b32 v127, 0xffff0000, v45
    v_add_u32 v123, v123, v123
    v_pk_fma_f32 v[124:125], v[124:125], v[122:123], s[34:35] op_sel_hi:[1,0,1]
    v_pk_fma_f32 v[126:127], v[126:127], v[122:123], s[34:35] op_sel_hi:[1,0,1]
    v_lshl_add_u32 v124, v125, 16, v124
    v_lshl_add_u32 v125, v127, 16, v126
    s_waitcnt lgkmcnt(5)
    v_bitop3_b32 v115, v115, v118, v119 bitop3:0xfe
    v_lshl_add_u64 v[124:125], v[124:125], 0, s[36:37]
    v_cmpx_le_u32 vcc, 0x1000000, v70
    ds_add_rtn_u64 v[118:119], v123, v[124:125] offset:54272
    s_mov_b64 exec, -1
    v_ashrrev_i32 v122, 5, v71
    v_lshlrev_b16 v123, 2, v71
    v_lshlrev_b32 v124, 16, v46
    v_bitop3_b32 v122, v122, v113, v113 bitop3:0x0c
    v_and_b32 v125, 0xffff0000, v46
    v_lshlrev_b32 v126, 16, v47
    v_mul_f32 v122, v114, v122
    v_and_b32 v127, 0xffff0000, v47
    v_add_u32 v123, v123, v123
    v_pk_fma_f32 v[124:125], v[124:125], v[122:123], s[34:35] op_sel_hi:[1,0,1]
    v_pk_fma_f32 v[126:127], v[126:127], v[122:123], s[34:35] op_sel_hi:[1,0,1]
    v_lshl_add_u32 v124, v125, 16, v124
    v_lshl_add_u32 v125, v127, 16, v126
    s_waitcnt lgkmcnt(5)
    v_bitop3_b32 v115, v115, v120, v121 bitop3:0xfe
    v_lshl_add_u64 v[124:125], v[124:125], 0, s[36:37]
    v_cmpx_le_u32 vcc, 0x1000000, v71
    ds_add_rtn_u64 v[120:121], v123, v[124:125] offset:54272
    s_mov_b64 exec, -1
p2_na0a7:
    s_waitcnt vmcnt(11)
    v_perm_b32 v69, v101, v98, s31
    v_perm_b32 v70, v101, v99, s32
    v_perm_b32 v71, v101, v100, s33
    v_lshlrev_b16 v46, 3, v100
    v_lshlrev_b16 v44, 3, v99
    v_lshlrev_b16 v42, 3, v98
    s_cmp_le_u32 s16, 7
    s_cbranch_scc1 p2_g0r07
    v_cmpx_ge_u16 vcc, 0x3fff, v69
    ds_read_b64 v[42:43], v42
    s_mov_b64 exec, -1
    v_cmpx_ge_u16 vcc, 0x3fff, v70
    ds_read_b64 v[44:45], v44
    s_mov_b64 exec, -1
    v_cmpx_ge_u16 vcc, 0x3fff, v71
    ds_read_b64 v[46:47], v46
    s_mov_b64 exec, -1
p2_g0r07:
    s_waitcnt lgkmcnt(15)
    v_lshrrev_b32 v90, 3, v107
    v_lshrrev_b32 v91, 18, v107
    v_and_b32 v107, 0x3fff, v107
    v_and_or_b32 v90, v90, s65, v91
    v_mad_u32_u24 v107, v90, s63, v107
    buffer_load_dwordx4 v[90:93], v107, s[68:71], 0 offen
    s_waitcnt vmcnt(8)
    v_perm_b32 v48, v3, v0, s31
    v_perm_b32 v49, v3, v1, s32
    v_perm_b32 v50, v3, v2, s33
    v_lshlrev_b16 v4, 3, v2
    v_lshlrev_b16 v2, 3, v1
    v_lshlrev_b16 v0, 3, v0
    v_cmpx_ge_u16 vcc, 0x3fff, v48
    ds_read_b64 v[0:1], v0
    s_mov_b64 exec, -1
    v_cmpx_ge_u16 vcc, 0x3fff, v49
    ds_read_b64 v[2:3], v2
    s_mov_b64 exec, -1
    v_cmpx_ge_u16 vcc, 0x3fff, v50
    ds_read_b64 v[4:5], v4
    s_mov_b64 exec, -1
    s_waitcnt vmcnt(7)
    v_perm_b32 v51, v9, v6, s31
    v_perm_b32 v52, v9, v7, s32
    v_perm_b32 v53, v9, v8, s33
    v_lshlrev_b16 v10, 3, v8
    v_lshlrev_b16 v8, 3, v7
    v_lshlrev_b16 v6, 3, v6
    v_cmpx_ge_u16 vcc, 0x3fff, v51
    ds_read_b64 v[6:7], v6
    s_mov_b64 exec, -1
    v_cmpx_ge_u16 vcc, 0x3fff, v52
    ds_read_b64 v[8:9], v8
    s_mov_b64 exec, -1
    v_cmpx_ge_u16 vcc, 0x3fff, v53
    ds_read_b64 v[10:11], v10
    s_mov_b64 exec, -1
    s_waitcnt vmcnt(6)
    v_perm_b32 v54, v15, v12, s31
    v_perm_b32 v55, v15, v13, s32
    v_perm_b32 v56, v15, v14, s33
    v_lshlrev_b16 v16, 3, v14
    v_lshlrev_b16 v14, 3, v13
    v_lshlrev_b16 v12, 3, v12
    v_cmpx_ge_u16 vcc, 0x3fff, v54
    ds_read_b64 v[12:13], v12
    s_mov_b64 exec, -1
    v_cmpx_ge_u16 vcc, 0x3fff, v55
    ds_read_b64 v[14:15], v14
    s_mov_b64 exec, -1
    v_cmpx_ge_u16 vcc, 0x3fff, v56
    ds_read_b64 v[16:17], v16
    s_mov_b64 exec, -1
    s_waitcnt vmcnt(5)
    v_perm_b32 v57, v21, v18, s31
    v_perm_b32 v58, v21, v19, s32
    v_perm_b32 v59, v21, v20, s33
    v_lshlrev_b16 v22, 3, v20
    v_lshlrev_b16 v20, 3, v19
    v_lshlrev_b16 v18, 3, v18
    v_cmpx_ge_u16 vcc, 0x3fff, v57
    ds_read_b64 v[18:19], v18
    s_mov_b64 exec, -1
    v_cmpx_ge_u16 vcc, 0x3fff, v58
    ds_read_b64 v[20:21], v20
    s_mov_b64 exec, -1
    v_cmpx_ge_u16 vcc, 0x3fff, v59
    ds_read_b64 v[22:23], v22
    s_mov_b64 exec, -1
    s_waitcnt lgkmcnt(0)
    s_barrier
    s_waitcnt lgkmcnt(15)
    s_branch p2_tail
p2_drain0:
    v_cmpx_gt_i16 vcc, 0, v48
    ds_read_b64 v[0:1], v0
    s_mov_b64 exec, -1
    v_cmpx_gt_i16 vcc, 0, v49
    ds_read_b64 v[2:3], v2
    s_mov_b64 exec, -1
    v_cmpx_gt_i16 vcc, 0, v50
    ds_read_b64 v[4:5], v4
    s_mov_b64 exec, -1
    v_cmpx_gt_i16 vcc, 0, v51
    ds_read_b64 v[6:7], v6
    s_mov_b64 exec, -1
    v_cmpx_gt_i16 vcc, 0, v52
    ds_read_b64 v[8:9], v8
    s_mov_b64 exec, -1
    v_cmpx_gt_i16 vcc, 0, v53
    ds_read_b64 v[10:11], v10
    s_mov_b64 exec, -1
    v_cmpx_gt_i16 vcc, 0, v54
    ds_read_b64 v[12:13], v12
    s_mov_b64 exec, -1
    v_cmpx_gt_i16 vcc, 0, v55
    ds_read_b64 v[14:15], v14
    s_mov_b64 exec, -1
    v_cmpx_gt_i16 vcc, 0, v56
    ds_read_b64 v[16:17], v16
    s_mov_b64 exec, -1
    v_cmpx_gt_i16 vcc, 0, v57
    ds_read_b64 v[18:19], v18
    s_mov_b64 exec, -1
    v_cmpx_gt_i16 vcc, 0, v58
    ds_read_b64 v[20:21], v20
    s_mov_b64 exec, -1
    v_cmpx_gt_i16 vcc, 0, v59
    ds_read_b64 v[22:23], v22
    s_mov_b64 exec, -1
    v_cmpx_gt_i16 vcc, 0, v60
    ds_read_b64 v[24:25], v24
    s_mov_b64 exec, -1
    v_cmpx_gt_i16 vcc, 0, v61
    ds_read_b64 v[26:27], v26
    s_mov_b64 exec, -1
    v_cmpx_gt_i16 vcc, 0, v62
    ds_read_b64 v[28:29], v28
    s_mov_b64 exec, -1
    v_cmpx_gt_i16 vcc, 0, v63
    ds_read_b64 v[30:31], v30
    s_mov_b64 exec, -1
    v_cmpx_gt_i16 vcc, 0, v64
    ds_read_b64 v[32:33], v32
    s_mov_b64 exec, -1
    v_cmpx_gt_i16 vcc, 0, v65
    ds_read_b64 v[34:35], v34
    s_mov_b64 exec, -1
    v_cmpx_gt_i16 vcc, 0, v66
    ds_read_b64 v[36:37], v36
    s_mov_b64 exec, -1
    v_cmpx_gt_i16 vcc, 0, v67
    ds_read_b64 v[38:39], v38
    s_mov_b64 exec, -1
    v_cmpx_gt_i16 vcc, 0, v68
    ds_read_b64 v[40:41], v40
    s_mov_b64 exec, -1
    s_cmp_le_u32 s15, 7
    s_cbranch_scc1 p2_gd0
    v_cmpx_gt_i16 vcc, 0, v69
    ds_read_b64 v[42:43], v42
    s_mov_b64 exec, -1
    v_cmpx_gt_i16 vcc, 0, v70
    ds_read_b64 v[44:45], v44
    s_mov_b64 exec, -1
    v_cmpx_gt_i16 vcc, 0, v71
    ds_read_b64 v[46:47], v46
    s_mov_b64 exec, -1
p2_gd0:
    s_waitcnt lgkmcnt(15)
    v_ashrrev_i32 v122, 5, v48
    v_lshlrev_b16 v123, 2, v48
    v_lshlrev_b32 v124, 16, v0
    v_bitop3_b32 v122, v122, v113, v113 bitop3:0x0c
    v_and_b32 v125, 0xffff0000, v0
    v_lshlrev_b32 v126, 16, v1
    v_mul_f32 v122, v114, v122
    v_and_b32 v127, 0xffff0000, v1
    v_add_u32 v123, v123, v123
    v_pk_fma_f32 v[124:125], v[124:125], v[122:123], s[34:35] op_sel_hi:[1,0,1]
    v_pk_fma_f32 v[126:127], v[126:127], v[122:123], s[34:35] op_sel_hi:[1,0,1]
    v_lshl_add_u32 v124, v125, 16, v124
    v_lshl_add_u32 v125, v127, 16, v126
    s_waitcnt lgkmcnt(15)
    v_bitop3_b32 v115, v115, v116, v117 bitop3:0xfe
    v_lshl_add_u64 v[124:125], v[124:125], 0, s[36:37]
    v_cmpx_le_u32 vcc, 0x1000000, v48
    ds_add_rtn_u64 v[116:117], v123, v[124:125] offset:54272
    s_mov_b64 exec, -1
    v_ashrrev_i32 v122, 5, v49
    v_lshlrev_b16 v123, 2, v49
    v_lshlrev_b32 v124, 16, v2
    v_bitop3_b32 v122, v122, v113, v113 bitop3:0x0c
    v_and_b32 v125, 0xffff0000, v2
    v_lshlrev_b32 v126, 16, v3
    v_mul_f32 v122, v114, v122
    v_and_b32 v127, 0xffff0000, v3
    v_add_u32 v123, v123, v123
    v_pk_fma_f32 v[124:125], v[124:125], v[122:123], s[34:35] op_sel_hi:[1,0,1]
    v_pk_fma_f32 v[126:127], v[126:127], v[122:123], s[34:35] op_sel_hi:[1,0,1]
    v_lshl_add_u32 v124, v125, 16, v124
    v_lshl_add_u32 v125, v127, 16, v126
    s_waitcnt lgkmcnt(15)
    v_bitop3_b32 v115, v115, v118, v119 bitop3:0xfe
    v_lshl_add_u64 v[124:125], v[124:125], 0, s[36:37]
    v_cmpx_le_u32 vcc, 0x1000000, v49
    ds_add_rtn_u64 v[118:119], v123, v[124:125] offset:54272
    s_mov_b64 exec, -1
    v_ashrrev_i32 v122, 5, v50
    v_lshlrev_b16 v123, 2, v50
    v_lshlrev_b32 v124, 16, v4
    v_bitop3_b32 v122, v122, v113, v113 bitop3:0x0c
    v_and_b32 v125, 0xffff0000, v4
    v_lshlrev_b32 v126, 16, v5
    v_mul_f32 v122, v114, v122
    v_and_b32 v127, 0xffff0000, v5
    v_add_u32 v123, v123, v123
    v_pk_fma_f32 v[124:125], v[124:125], v[122:123], s[34:35] op_sel_hi:[1,0,1]
    v_pk_fma_f32 v[126:127], v[126:127], v[122:123], s[34:35] op_sel_hi:[1,0,1]
    v_lshl_add_u32 v124, v125, 16, v124
    v_lshl_add_u32 v125, v127, 16, v126
    s_waitcnt lgkmcnt(15)
    v_bitop3_b32 v115, v115, v120, v121 bitop3:0xfe
    v_lshl_add_u64 v[124:125], v[124:125], 0, s[36:37]
    v_cmpx_le_u32 vcc, 0x1000000, v50
    ds_add_rtn_u64 v[120:121], v123, v[124:125] offset:54272
    s_mov_b64 exec, -1
    s_waitcnt lgkmcnt(15)
    v_ashrrev_i32 v122, 5, v51
    v_lshlrev_b16 v123, 2, v51
    v_lshlrev_b32 v124, 16, v6
    v_bitop3_b32 v122, v122, v113, v113 bitop3:0x0c
    v_and_b32 v125, 0xffff0000, v6
    v_lshlrev_b32 v126, 16, v7
    v_mul_f32 v122, v114, v122
    v_and_b32 v127, 0xffff0000, v7
    v_add_u32 v123, v123, v123
    v_pk_fma_f32 v[124:125], v[124:125], v[122:123], s[34:35] op_sel_hi:[1,0,1]
    v_pk_fma_f32 v[126:127], v[126:127], v[122:123], s[34:35] op_sel_hi:[1,0,1]
    v_lshl_add_u32 v124, v125, 16, v124
    v_lshl_add_u32 v125, v127, 16, v126
    s_waitcnt lgkmcnt(2)
    v_bitop3_b32 v115, v115, v116, v117 bitop3:0xfe
    v_lshl_add_u64 v[124:125], v[124:125], 0, s[36:37]
    v_cmpx_le_u32 vcc, 0x1000000, v51
    ds_add_rtn_u64 v[116:117], v123, v[124:125] offset:54272
    s_mov_b64 exec, -1
    v_ashrrev_i32 v122, 5, v52
    v_lshlrev_b16 v123, 2, v52
    v_lshlrev_b32 v124, 16, v8
    v_bitop3_b32 v122, v122, v113, v113 bitop3:0x0c
    v_and_b32 v125, 0xffff0000, v8
    v_lshlrev_b32 v126, 16, v9
    v_mul_f32 v122, v114, v122
    v_and_b32 v127, 0xffff0000, v9
    v_add_u32 v123, v123, v123
    v_pk_fma_f32 v[124:125], v[124:125], v[122:123], s[34:35] op_sel_hi:[1,0,1]
    v_pk_fma_f32 v[126:127], v[126:127], v[122:123], s[34:35] op_sel_hi:[1,0,1]
    v_lshl_add_u32 v124, v125, 16, v124
    v_lshl_add_u32 v125, v127, 16, v126
    s_waitcnt lgkmcnt(2)
    v_bitop3_b32 v115, v115, v118, v119 bitop3:0xfe
    v_lshl_add_u64 v[124:125], v[124:125], 0, s[36:37]
    v_cmpx_le_u32 vcc, 0x1000000, v52
    ds_add_rtn_u64 v[118:119], v123, v[124:125] offset:54272
    s_mov_b64 exec, -1
    v_ashrrev_i32 v122, 5, v53
    v_lshlrev_b16 v123, 2, v53
    v_lshlrev_b32 v124, 16, v10
    v_bitop3_b32 v122, v122, v113, v113 bitop3:0x0c
    v_and_b32 v125, 0xffff0000, v10
    v_lshlrev_b32 v126, 16, v11
    v_mul_f32 v122, v114, v122
    v_and_b32 v127, 0xffff0000, v11
    v_add_u32 v123, v123, v123
    v_pk_fma_f32 v[124:125], v[124:125], v[122:123], s[34:35] op_sel_hi:[1,0,1]
    v_pk_fma_f32 v[126:127], v[126:127], v[122:123], s[34:35] op_sel_hi:[1,0,1]
    v_lshl_add_u32 v124, v125, 16, v124
    v_lshl_add_u32 v125, v127, 16, v126
    s_waitcnt lgkmcnt(2)
    v_bitop3_b32 v115, v115, v120, v121 bitop3:0xfe
    v_lshl_add_u64 v[124:125], v[124:125], 0, s[36:37]
    v_cmpx_le_u32 vcc, 0x1000000, v53
    ds_add_rtn_u64 v[120:121], v123, v[124:125] offset:54272
    s_mov_b64 exec, -1
    s_waitcnt lgkmcnt(15)
    v_ashrrev_i32 v122, 5, v54
    v_lshlrev_b16 v123, 2, v54
    v_lshlrev_b32 v124, 16, v12
    v_bitop3_b32 v122, v122, v113, v113 bitop3:0x0c
    v_and_b32 v125, 0xffff0000, v12
    v_lshlrev_b32 v126, 16, v13
    v_mul_f32 v122, v114, v122
    v_and_b32 v127, 0xffff0000, v13
    v_add_u32 v123, v123, v123
    v_pk_fma_f32 v[124:125], v[124:125], v[122:123], s[34:35] op_sel_hi:[1,0,1]
    v_pk_fma_f32 v[126:127], v[126:127], v[122:123], s[34:35] op_sel_hi:[1,0,1]
    v_lshl_add_u32 v124, v125, 16, v124
    v_lshl_add_u32 v125, v127, 16, v126
    s_waitcnt lgkmcnt(2)
    v_bitop3_b32 v115, v115, v116, v117 bitop3:0xfe
    v_lshl_add_u64 v[124:125], v[124:125], 0, s[36:37]
    v_cmpx_le_u32 vcc, 0x1000000, v54
    ds_add_rtn_u64 v[116:117], v123, v[124:125] offset:54272
    s_mov_b64 exec, -1
    v_ashrrev_i32 v122, 5, v55
    v_lshlrev_b16 v123, 2, v55
    v_lshlrev_b32 v124, 16, v14
    v_bitop3_b32 v122, v122, v113, v113 bitop3:0x0c
    v_and_b32 v125, 0xffff0000, v14
    v_lshlrev_b32 v126, 16, v15
    v_mul_f32 v122, v114, v122
    v_and_b32 v127, 0xffff0000, v15
    v_add_u32 v123, v123, v123
    v_pk_fma_f32 v[124:125], v[124:125], v[122:123], s[34:35] op_sel_hi:[1,0,1]
    v_pk_fma_f32 v[126:127], v[126:127], v[122:123], s[34:35] op_sel_hi:[1,0,1]
    v_lshl_add_u32 v124, v125, 16, v124
    v_lshl_add_u32 v125, v127, 16, v126
    s_waitcnt lgkmcnt(2)
    v_bitop3_b32 v115, v115, v118, v119 bitop3:0xfe
    v_lshl_add_u64 v[124:125], v[124:125], 0, s[36:37]
    v_cmpx_le_u32 vcc, 0x1000000, v55
    ds_add_rtn_u64 v[118:119], v123, v[124:125] offset:54272
    s_mov_b64 exec, -1
    v_ashrrev_i32 v122, 5, v56
    v_lshlrev_b16 v123, 2, v56
    v_lshlrev_b32 v124, 16, v16
    v_bitop3_b32 v122, v122, v113, v113 bitop3:0x0c
    v_and_b32 v125, 0xffff0000, v16
    v_lshlrev_b32 v126, 16, v17
    v_mul_f32 v122, v114, v122
    v_and_b32 v127, 0xffff0000, v17
    v_add_u32 v123, v123, v123
    v_pk_fma_f32 v[124:125], v[124:125], v[122:123], s[34:35] op_sel_hi:[1,0,1]
    v_pk_fma_f32 v[126:127], v[126:127], v[122:123], s[34:35] op_sel_hi:[1,0,1]
    v_lshl_add_u32 v124, v125, 16, v124
    v_lshl_add_u32 v125, v127, 16, v126
    s_waitcnt lgkmcnt(2)
    v_bitop3_b32 v115, v115, v120, v121 bitop3:0xfe
    v_lshl_add_u64 v[124:125], v[124:125], 0, s[36:37]
    v_cmpx_le_u32 vcc, 0x1000000, v56
    ds_add_rtn_u64 v[120:121], v123, v[124:125] offset:54272
    s_mov_b64 exec, -1
    s_waitcnt lgkmcnt(15)
    v_ashrrev_i32 v122, 5, v57
    v_lshlrev_b16 v123, 2, v57
    v_lshlrev_b32 v124, 16, v18
    v_bitop3_b32 v122, v122, v113, v113 bitop3:0x0c
    v_and_b32 v125, 0xffff0000, v18
    v_lshlrev_b32 v126, 16, v19
    v_mul_f32 v122, v114, v122
    v_and_b32 v127, 0xffff0000, v19
    v_add_u32 v123, v123, v123
    v_pk_fma_f32 v[124:125], v[124:125], v[122:123], s[34:35] op_sel_hi:[1,0,1]
    v_pk_fma_f32 v[126:127], v[126:127], v[122:123], s[34:35] op_sel_hi:[1,0,1]
    v_lshl_add_u32 v124, v125, 16, v124
    v_lshl_add_u32 v125, v127, 16, v126
    s_waitcnt lgkmcnt(2)
    v_bitop3_b32 v115, v115, v116, v117 bitop3:0xfe
    v_lshl_add_u64 v[124:125], v[124:125], 0, s[36:37]
    v_cmpx_le_u32 vcc, 0x1000000, v57
    ds_add_rtn_u64 v[116:117], v123, v[124:125] offset:54272
    s_mov_b64 exec, -1
    v_ashrrev_i32 v122, 5, v58
    v_lshlrev_b16 v123, 2, v58
    v_lshlrev_b32 v124, 16, v20
    v_bitop3_b32 v122, v122, v113, v113 bitop3:0x0c
    v_and_b32 v125, 0xffff0000, v20
    v_lshlrev_b32 v126, 16, v21
    v_mul_f32 v122, v114, v122
    v_and_b32 v127, 0xffff0000, v21
    v_add_u32 v123, v123, v123
    v_pk_fma_f32 v[124:125], v[124:125], v[122:123], s[34:35] op_sel_hi:[1,0,1]
    v_pk_fma_f32 v[126:127], v[126:127], v[122:123], s[34:35] op_sel_hi:[1,0,1]
    v_lshl_add_u32 v124, v125, 16, v124
    v_lshl_add_u32 v125, v127, 16, v126
    s_waitcnt lgkmcnt(2)
    v_bitop3_b32 v115, v115, v118, v119 bitop3:0xfe
    v_lshl_add_u64 v[124:125], v[124:125], 0, s[36:37]
    v_cmpx_le_u32 vcc, 0x1000000, v58
    ds_add_rtn_u64 v[118:119], v123, v[124:125] offset:54272
    s_mov_b64 exec, -1
    v_ashrrev_i32 v122, 5, v59
    v_lshlrev_b16 v123, 2, v59
    v_lshlrev_b32 v124, 16, v22
    v_bitop3_b32 v122, v122, v113, v113 bitop3:0x0c
    v_and_b32 v125, 0xffff0000, v22
    v_lshlrev_b32 v126, 16, v23
    v_mul_f32 v122, v114, v122
    v_and_b32 v127, 0xffff0000, v23
    v_add_u32 v123, v123, v123
    v_pk_fma_f32 v[124:125], v[124:125], v[122:123], s[34:35] op_sel_hi:[1,0,1]
    v_pk_fma_f32 v[126:127], v[126:127], v[122:123], s[34:35] op_sel_hi:[1,0,1]
    v_lshl_add_u32 v124, v125, 16, v124
    v_lshl_add_u32 v125, v127, 16, v126
    s_waitcnt lgkmcnt(2)
    v_bitop3_b32 v115, v115, v120, v121 bitop3:0xfe
    v_lshl_add_u64 v[124:125], v[124:125], 0, s[36:37]
    v_cmpx_le_u32 vcc, 0x1000000, v59
    ds_add_rtn_u64 v[120:121], v123, v[124:125] offset:54272
    s_mov_b64 exec, -1
    s_waitcnt lgkmcnt(15)
    v_ashrrev_i32 v122, 5, v60
    v_lshlrev_b16 v123, 2, v60
    v_lshlrev_b32 v124, 16, v24
    v_bitop3_b32 v122, v122, v113, v113 bitop3:0x0c
    v_and_b32 v125, 0xffff0000, v24
    v_lshlrev_b32 v126, 16, v25
    v_mul_f32 v122, v114, v122
    v_and_b32 v127, 0xffff0000, v25
    v_add_u32 v123, v123, v123
    v_pk_fma_f32 v[124:125], v[124:125], v[122:123], s[34:35] op_sel_hi:[1,0,1]
    v_pk_fma_f32 v[126:127], v[126:127], v[122:123], s[34:35] op_sel_hi:[1,0,1]
    v_lshl_add_u32 v124, v125, 16, v124
    v_lshl_add_u32 v125, v127, 16, v126
    s_waitcnt lgkmcnt(2)
    v_bitop3_b32 v115, v115, v116, v117 bitop3:0xfe
    v_lshl_add_u64 v[124:125], v[124:125], 0, s[36:37]
    v_cmpx_le_u32 vcc, 0x1000000, v60
    ds_add_rtn_u64 v[116:117], v123, v[124:125] offset:54272
    s_mov_b64 exec, -1
    v_ashrrev_i32 v122, 5, v61
    v_lshlrev_b16 v123, 2, v61
    v_lshlrev_b32 v124, 16, v26
    v_bitop3_b32 v122, v122, v113, v113 bitop3:0x0c
    v_and_b32 v125, 0xffff0000, v26
    v_lshlrev_b32 v126, 16, v27
    v_mul_f32 v122, v114, v122
    v_and_b32 v127, 0xffff0000, v27
    v_add_u32 v123, v123, v123
    v_pk_fma_f32 v[124:125], v[124:125], v[122:123], s[34:35] op_sel_hi:[1,0,1]
    v_pk_fma_f32 v[126:127], v[126:127], v[122:123], s[34:35] op_sel_hi:[1,0,1]
    v_lshl_add_u32 v124, v125, 16, v124
    v_lshl_add_u32 v125, v127, 16, v126
    s_waitcnt lgkmcnt(2)
    v_bitop3_b32 v115, v115, v118, v119 bitop3:0xfe
    v_lshl_add_u64 v[124:125], v[124:125], 0, s[36:37]
    v_cmpx_le_u32 vcc, 0x1000000, v61
    ds_add_rtn_u64 v[118:119], v123, v[124:125] offset:54272
    s_mov_b64 exec, -1
    v_ashrrev_i32 v122, 5, v62
    v_lshlrev_b16 v123, 2, v62
    v_lshlrev_b32 v124, 16, v28
    v_bitop3_b32 v122, v122, v113, v113 bitop3:0x0c
    v_and_b32 v125, 0xffff0000, v28
    v_lshlrev_b32 v126, 16, v29
    v_mul_f32 v122, v114, v122
    v_and_b32 v127, 0xffff0000, v29
    v_add_u32 v123, v123, v123
    v_pk_fma_f32 v[124:125], v[124:125], v[122:123], s[34:35] op_sel_hi:[1,0,1]
    v_pk_fma_f32 v[126:127], v[126:127], v[122:123], s[34:35] op_sel_hi:[1,0,1]
    v_lshl_add_u32 v124, v125, 16, v124
    v_lshl_add_u32 v125, v127, 16, v126
    s_waitcnt lgkmcnt(2)
    v_bitop3_b32 v115, v115, v120, v121 bitop3:0xfe
    v_lshl_add_u64 v[124:125], v[124:125], 0, s[36:37]
    v_cmpx_le_u32 vcc, 0x1000000, v62
    ds_add_rtn_u64 v[120:121], v123, v[124:125] offset:54272
    s_mov_b64 exec, -1
    s_waitcnt lgkmcnt(15)
    v_ashrrev_i32 v122, 5, v63
    v_lshlrev_b16 v123, 2, v63
    v_lshlrev_b32 v124, 16, v30
    v_bitop3_b32 v122, v122, v113, v113 bitop3:0x0c
    v_and_b32 v125, 0xffff0000, v30
    v_lshlrev_b32 v126, 16, v31
    v_mul_f32 v122, v114, v122
    v_and_b32 v127, 0xffff0000, v31
    v_add_u32 v123, v123, v123
    v_pk_fma_f32 v[124:125], v[124:125], v[122:123], s[34:35] op_sel_hi:[1,0,1]
    v_pk_fma_f32 v[126:127], v[126:127], v[122:123], s[34:35] op_sel_hi:[1,0,1]
    v_lshl_add_u32 v124, v125, 16, v124
    v_lshl_add_u32 v125, v127, 16, v126
    s_waitcnt lgkmcnt(2)
    v_bitop3_b32 v115, v115, v116, v117 bitop3:0xfe
    v_lshl_add_u64 v[124:125], v[124:125], 0, s[36:37]
    v_cmpx_le_u32 vcc, 0x1000000, v63
    ds_add_rtn_u64 v[116:117], v123, v[124:125] offset:54272
    s_mov_b64 exec, -1
    v_ashrrev_i32 v122, 5, v64
    v_lshlrev_b16 v123, 2, v64
    v_lshlrev_b32 v124, 16, v32
    v_bitop3_b32 v122, v122, v113, v113 bitop3:0x0c
    v_and_b32 v125, 0xffff0000, v32
    v_lshlrev_b32 v126, 16, v33
    v_mul_f32 v122, v114, v122
    v_and_b32 v127, 0xffff0000, v33
    v_add_u32 v123, v123, v123
    v_pk_fma_f32 v[124:125], v[124:125], v[122:123], s[34:35] op_sel_hi:[1,0,1]
    v_pk_fma_f32 v[126:127], v[126:127], v[122:123], s[34:35] op_sel_hi:[1,0,1]
    v_lshl_add_u32 v124, v125, 16, v124
    v_lshl_add_u32 v125, v127, 16, v126
    s_waitcnt lgkmcnt(2)
    v_bitop3_b32 v115, v115, v118, v119 bitop3:0xfe
    v_lshl_add_u64 v[124:125], v[124:125], 0, s[36:37]
    v_cmpx_le_u32 vcc, 0x1000000, v64
    ds_add_rtn_u64 v[118:119], v123, v[124:125] offset:54272
    s_mov_b64 exec, -1
    v_ashrrev_i32 v122, 5, v65
    v_lshlrev_b16 v123, 2, v65
    v_lshlrev_b32 v124, 16, v34
    v_bitop3_b32 v122, v122, v113, v113 bitop3:0x0c
    v_and_b32 v125, 0xffff0000, v34
    v_lshlrev_b32 v126, 16, v35
    v_mul_f32 v122, v114, v122
    v_and_b32 v127, 0xffff0000, v35
    v_add_u32 v123, v123, v123
    v_pk_fma_f32 v[124:125], v[124:125], v[122:123], s[34:35] op_sel_hi:[1,0,1]
    v_pk_fma_f32 v[126:127], v[126:127], v[122:123], s[34:35] op_sel_hi:[1,0,1]
    v_lshl_add_u32 v124, v125, 16, v124
    v_lshl_add_u32 v125, v127, 16, v126
    s_waitcnt lgkmcnt(2)
    v_bitop3_b32 v115, v115, v120, v121 bitop3:0xfe
    v_lshl_add_u64 v[124:125], v[124:125], 0, s[36:37]
    v_cmpx_le_u32 vcc, 0x1000000, v65
    ds_add_rtn_u64 v[120:121], v123, v[124:125] offset:54272
    s_mov_b64 exec, -1
    s_waitcnt lgkmcnt(15)
    v_ashrrev_i32 v122, 5, v66
    v_lshlrev_b16 v123, 2, v66
    v_lshlrev_b32 v124, 16, v36
    v_bitop3_b32 v122, v122, v113, v113 bitop3:0x0c
    v_and_b32 v125, 0xffff0000, v36
    v_lshlrev_b32 v126, 16, v37
    v_mul_f32 v122, v114, v122
    v_and_b32 v127, 0xffff0000, v37
    v_add_u32 v123, v123, v123
    v_pk_fma_f32 v[124:125], v[124:125], v[122:123], s[34:35] op_sel_hi:[1,0,1]
    v_pk_fma_f32 v[126:127], v[126:127], v[122:123], s[34:35] op_sel_hi:[1,0,1]
    v_lshl_add_u32 v124, v125, 16, v124
    v_lshl_add_u32 v125, v127, 16, v126
    s_waitcnt lgkmcnt(2)
    v_bitop3_b32 v115, v115, v116, v117 bitop3:0xfe
    v_lshl_add_u64 v[124:125], v[124:125], 0, s[36:37]
    v_cmpx_le_u32 vcc, 0x1000000, v66
    ds_add_rtn_u64 v[116:117], v123, v[124:125] offset:54272
    s_mov_b64 exec, -1
    v_ashrrev_i32 v122, 5, v67
    v_lshlrev_b16 v123, 2, v67
    v_lshlrev_b32 v124, 16, v38
    v_bitop3_b32 v122, v122, v113, v113 bitop3:0x0c
    v_and_b32 v125, 0xffff0000, v38
    v_lshlrev_b32 v126, 16, v39
    v_mul_f32 v122, v114, v122
    v_and_b32 v127, 0xffff0000, v39
    v_add_u32 v123, v123, v123
    v_pk_fma_f32 v[124:125], v[124:125], v[122:123], s[34:35] op_sel_hi:[1,0,1]
    v_pk_fma_f32 v[126:127], v[126:127], v[122:123], s[34:35] op_sel_hi:[1,0,1]
    v_lshl_add_u32 v124, v125, 16, v124
    v_lshl_add_u32 v125, v127, 16, v126
    s_waitcnt lgkmcnt(2)
    v_bitop3_b32 v115, v115, v118, v119 bitop3:0xfe
    v_lshl_add_u64 v[124:125], v[124:125], 0, s[36:37]
    v_cmpx_le_u32 vcc, 0x1000000, v67
    ds_add_rtn_u64 v[118:119], v123, v[124:125] offset:54272
    s_mov_b64 exec, -1
    v_ashrrev_i32 v122, 5, v68
    v_lshlrev_b16 v123, 2, v68
    v_lshlrev_b32 v124, 16, v40
    v_bitop3_b32 v122, v122, v113, v113 bitop3:0x0c
    v_and_b32 v125, 0xffff0000, v40
    v_lshlrev_b32 v126, 16, v41
    v_mul_f32 v122, v114, v122
    v_and_b32 v127, 0xffff0000, v41
    v_add_u32 v123, v123, v123
    v_pk_fma_f32 v[124:125], v[124:125], v[122:123], s[34:35] op_sel_hi:[1,0,1]
    v_pk_fma_f32 v[126:127], v[126:127], v[122:123], s[34:35] op_sel_hi:[1,0,1]
    v_lshl_add_u32 v124, v125, 16, v124
    v_lshl_add_u32 v125, v127, 16, v126
    s_waitcnt lgkmcnt(2)
    v_bitop3_b32 v115, v115, v120, v121 bitop3:0xfe
    v_lshl_add_u64 v[124:125], v[124:125], 0, s[36:37]
    v_cmpx_le_u32 vcc, 0x1000000, v68
    ds_add_rtn_u64 v[120:121], v123, v[124:125] offset:54272
    s_mov_b64 exec, -1
    s_cmp_le_u32 s15, 7
    s_cbranch_scc1 p2_nad0
    s_waitcnt lgkmcnt(15)
    v_ashrrev_i32 v122, 5, v69
    v_lshlrev_b16 v123, 2, v69
    v_lshlrev_b32 v124, 16, v42
    v_bitop3_b32 v122, v122, v113, v113 bitop3:0x0c
    v_and_b32 v125, 0xffff0000, v42
    v_lshlrev_b32 v126, 16, v43
    v_mul_f32 v122, v114, v122
    v_and_b32 v127, 0xffff0000, v43
    v_add_u32 v123, v123, v123
    v_pk_fma_f32 v[124:125], v[124:125], v[122:123], s[34:35] op_sel_hi:[1,0,1]
    v_pk_fma_f32 v[126:127], v[126:127], v[122:123], s[34:35] op_sel_hi:[1,0,1]
    v_lshl_add_u32 v124, v125, 16, v124
    v_lshl_add_u32 v125, v127, 16, v126
    s_waitcnt lgkmcnt(2)
    v_bitop3_b32 v115, v115, v116, v117 bitop3:0xfe
    v_lshl_add_u64 v[124:125], v[124:125], 0, s[36:37]
    v_cmpx_le_u32 vcc, 0x1000000, v69
    ds_add_rtn_u64 v[116:117], v123, v[124:125] offset:54272
    s_mov_b64 exec, -1
    v_ashrrev_i32 v122, 5, v70
    v_lshlrev_b16 v123, 2, v70
    v_lshlrev_b32 v124, 16, v44
    v_bitop3_b32 v122, v122, v113, v113 bitop3:0x0c
    v_and_b32 v125, 0xffff0000, v44
    v_lshlrev_b32 v126, 16, v45
    v_mul_f32 v122, v114, v122
    v_and_b32 v127, 0xffff0000, v45
    v_add_u32 v123, v123, v123
    v_pk_fma_f32 v[124:125], v[124:125], v[122:123], s[34:35] op_sel_hi:[1,0,1]
    v_pk_fma_f32 v[126:127], v[126:127], v[122:123], s[34:35] op_sel_hi:[1,0,1]
    v_lshl_add_u32 v124, v125, 16, v124
    v_lshl_add_u32 v125, v127, 16, v126
    s_waitcnt lgkmcnt(2)
    v_bitop3_b32 v115, v115, v118, v119 bitop3:0xfe
    v_lshl_add_u64 v[124:125], v[124:125], 0, s[36:37]
    v_cmpx_le_u32 vcc, 0x1000000, v70
    ds_add_rtn_u64 v[118:119], v123, v[124:125] offset:54272
    s_mov_b64 exec, -1
    v_ashrrev_i32 v122, 5, v71
    v_lshlrev_b16 v123, 2, v71
    v_lshlrev_b32 v124, 16, v46
    v_bitop3_b32 v122, v122, v113, v113 bitop3:0x0c
    v_and_b32 v125, 0xffff0000, v46
    v_lshlrev_b32 v126, 16, v47
    v_mul_f32 v122, v114, v122
    v_and_b32 v127, 0xffff0000, v47
    v_add_u32 v123, v123, v123
    v_pk_fma_f32 v[124:125], v[124:125], v[122:123], s[34:35] op_sel_hi:[1,0,1]
    v_pk_fma_f32 v[126:127], v[126:127], v[122:123], s[34:35] op_sel_hi:[1,0,1]
    v_lshl_add_u32 v124, v125, 16, v124
    v_lshl_add_u32 v125, v127, 16, v126
    s_waitcnt lgkmcnt(2)
    v_bitop3_b32 v115, v115, v120, v121 bitop3:0xfe
    v_lshl_add_u64 v[124:125], v[124:125], 0, s[36:37]
    v_cmpx_le_u32 vcc, 0x1000000, v71
    ds_add_rtn_u64 v[120:121], v123, v[124:125] offset:54272
    s_mov_b64 exec, -1
p2_nad0:
    s_branch p2_fin
p2_topf:
    s_cmp_eq_u32 s60, 10
    s_cbranch_scc1 p2_drain1
    v_cmpx_gt_i16 vcc, 0, v48
    ds_read_b64 v[0:1], v0
    s_mov_b64 exec, -1
    v_cmpx_gt_i16 vcc, 0, v49
    ds_read_b64 v[2:3], v2
    s_mov_b64 exec, -1
    v_cmpx_gt_i16 vcc, 0, v50
    ds_read_b64 v[4:5], v4
    s_mov_b64 exec, -1
    v_cmpx_gt_i16 vcc, 0, v51
    ds_read_b64 v[6:7], v6
    s_mov_b64 exec, -1
    v_cmpx_gt_i16 vcc, 0, v52
    ds_read_b64 v[8:9], v8
    s_mov_b64 exec, -1
    v_cmpx_gt_i16 vcc, 0, v53
    ds_read_b64 v[10:11], v10
    s_mov_b64 exec, -1
    v_cmpx_gt_i16 vcc, 0, v54
    ds_read_b64 v[12:13], v12
    s_mov_b64 exec, -1
    v_cmpx_gt_i16 vcc, 0, v55
    ds_read_b64 v[14:15], v14
    s_mov_b64 exec, -1
    v_cmpx_gt_i16 vcc, 0, v56
    ds_read_b64 v[16:17], v16
    s_mov_b64 exec, -1
    v_cmpx_gt_i16 vcc, 0, v57
    ds_read_b64 v[18:19], v18
    s_mov_b64 exec, -1
    v_cmpx_gt_i16 vcc, 0, v58
    ds_read_b64 v[20:21], v20
    s_mov_b64 exec, -1
    v_cmpx_gt_i16 vcc, 0, v59
    ds_read_b64 v[22:23], v22
    s_mov_b64 exec, -1
    s_cmp_ge_u32 s10, 9
    s_cbranch_scc1 p2_nm1m0a
    v_lshrrev_b32 v84, 1, v112
    s_add_u32 s44, s20, s42
    buffer_load_dwordx2 v[84:85], v84, s[4:7], s44 offen
p2_nm1m0a:
    buffer_load_dwordx4 v[72:75], v112, s[4:7], s20 offen offset:0
    buffer_load_dwordx4 v[76:79], v112, s[4:7], s20 offen offset:1024
    buffer_load_dwordx4 v[80:83], v112, s[4:7], s20 offen offset:2048
    v_cmpx_gt_i16 vcc, 0, v60
    ds_read_b64 v[24:25], v24
    s_mov_b64 exec, -1
    v_cmpx_gt_i16 vcc, 0, v61
    ds_read_b64 v[26:27], v26
    s_mov_b64 exec, -1
    v_cmpx_gt_i16 vcc, 0, v62
    ds_read_b64 v[28:29], v28
    s_mov_b64 exec, -1
    v_cmpx_gt_i16 vcc, 0, v63
    ds_read_b64 v[30:31], v30
    s_mov_b64 exec, -1
    v_cmpx_gt_i16 vcc, 0, v64
    ds_read_b64 v[32:33], v32
    s_mov_b64 exec, -1
    v_cmpx_gt_i16 vcc, 0, v65
    ds_read_b64 v[34:35], v34
    s_mov_b64 exec, -1
    v_cmpx_gt_i16 vcc, 0, v66
    ds_read_b64 v[36:37], v36
    s_mov_b64 exec, -1
    v_cmpx_gt_i16 vcc, 0, v67
    ds_read_b64 v[38:39], v38
    s_mov_b64 exec, -1
    v_cmpx_gt_i16 vcc, 0, v68
    ds_read_b64 v[40:41], v40
    s_mov_b64 exec, -1
    s_cmp_le_u32 s15, 7
    s_cbranch_scc1 p2_g1r27
    v_cmpx_gt_i16 vcc, 0, v69
    ds_read_b64 v[42:43], v42
    s_mov_b64 exec, -1
    v_cmpx_gt_i16 vcc, 0, v70
    ds_read_b64 v[44:45], v44
    s_mov_b64 exec, -1
    v_cmpx_gt_i16 vcc, 0, v71
    ds_read_b64 v[46:47], v46
    s_mov_b64 exec, -1
p2_g1r27:
    s_waitcnt lgkmcnt(15)
    v_ashrrev_i32 v122, 5, v48
    v_lshlrev_b16 v123, 2, v48
    v_cndmask_b32 v126, v0, v1, s[66:67]
    v_bitop3_b32 v122, v122, v113, v113 bitop3:0x0c
    v_lshlrev_b32 v124, 16, v126
    v_mul_f32 v122, v114, v122
    v_and_b32 v125, 0xffff0000, v126
    v_add_u32 v123, v123, v123
    v_mul_f32 v124, v122, v124
    v_mul_f32 v125, v122, v125
    v_cmpx_le_u32 vcc, 0x1000000, v48
    ds_add_f32 v123, v124 offset:54272
    ds_add_f32 v123, v125 offset:54276
    s_mov_b64 exec, -1
    v_ashrrev_i32 v122, 5, v49
    v_lshlrev_b16 v123, 2, v49
    v_cndmask_b32 v126, v2, v3, s[66:67]
    v_bitop3_b32 v122, v122, v113, v113 bitop3:0x0c
    v_lshlrev_b32 v124, 16, v126
    v_mul_f32 v122, v114, v122
    v_and_b32 v125, 0xffff0000, v126
    v_add_u32 v123, v123, v123
    v_mul_f32 v124, v122, v124
    v_mul_f32 v125, v122, v125
    v_cmpx_le_u32 vcc, 0x1000000, v49
    ds_add_f32 v123, v124 offset:54272
    ds_add_f32 v123, v125 offset:54276
    s_mov_b64 exec, -1
    v_ashrrev_i32 v122, 5, v50
    v_lshlrev_b16 v123, 2, v50
    v_cndmask_b32 v126, v4, v5, s[66:67]
    v_bitop3_b32 v122, v122, v113, v113 bitop3:0x0c
    v_lshlrev_b32 v124, 16, v126
    v_mul_f32 v122, v114, v122
    v_and_b32 v125, 0xffff0000, v126
    v_add_u32 v123, v123, v123
    v_mul_f32 v124, v122, v124
    v_mul_f32 v125, v122, v125
    v_cmpx_le_u32 vcc, 0x1000000, v50
    ds_add_f32 v123, v124 offset:54272
    ds_add_f32 v123, v125 offset:54276
    s_mov_b64 exec, -1
    v_lshrrev_b32 v0, 3, v102
    v_lshrrev_b32 v1, 18, v102
    v_and_b32 v102, 0x3fff, v102
    v_and_or_b32 v0, v0, s65, v1
    v_mad_u32_u24 v102, v0, s63, v102
    buffer_load_dwordx4 v[0:3], v102, s[68:71], 0 offen
    s_waitcnt lgkmcnt(15)
    v_ashrrev_i32 v122, 5, v51
    v_lshlrev_b16 v123, 2, v51
    v_cndmask_b32 v126, v6, v7, s[66:67]
    v_bitop3_b32 v122, v122, v113, v113 bitop3:0x0c
    v_lshlrev_b32 v124, 16, v126
    v_mul_f32 v122, v114, v122
    v_and_b32 v125, 0xffff0000, v126
    v_add_u32 v123, v123, v123
    v_mul_f32 v124, v122, v124
    v_mul_f32 v125, v122, v125
    v_cmpx_le_u32 vcc, 0x1000000, v51
    ds_add_f32 v123, v124 offset:54272
    ds_add_f32 v123, v125 offset:54276
    s_mov_b64 exec, -1
    v_ashrrev_i32 v122, 5, v52
    v_lshlrev_b16 v123, 2, v52
    v_cndmask_b32 v126, v8, v9, s[66:67]
    v_bitop3_b32 v122, v122, v113, v113 bitop3:0x0c
    v_lshlrev_b32 v124, 16, v126
    v_mul_f32 v122, v114, v122
    v_and_b32 v125, 0xffff0000, v126
    v_add_u32 v123, v123, v123
    v_mul_f32 v124, v122, v124
    v_mul_f32 v125, v122, v125
    v_cmpx_le_u32 vcc, 0x1000000, v52
    ds_add_f32 v123, v124 offset:54272
    ds_add_f32 v123, v125 offset:54276
    s_mov_b64 exec, -1
    v_ashrrev_i32 v122, 5, v53
    v_lshlrev_b16 v123, 2, v53
    v_cndmask_b32 v126, v10, v11, s[66:67]
    v_bitop3_b32 v122, v122, v113, v113 bitop3:0x0c
    v_lshlrev_b32 v124, 16, v126
    v_mul_f32 v122, v114, v122
    v_and_b32 v125, 0xffff0000, v126
    v_add_u32 v123, v123, v123
    v_mul_f32 v124, v122, v124
    v_mul_f32 v125, v122, v125
    v_cmpx_le_u32 vcc, 0x1000000, v53
    ds_add_f32 v123, v124 offset:54272
    ds_add_f32 v123, v125 offset:54276
    s_mov_b64 exec, -1
    v_lshrrev_b32 v6, 3, v103
    v_lshrrev_b32 v7, 18, v103
    v_and_b32 v103, 0x3fff, v103
    v_and_or_b32 v6, v6, s65, v7
    v_mad_u32_u24 v103, v6, s63, v103
    buffer_load_dwordx4 v[6:9], v103, s[68:71], 0 offen
    s_waitcnt lgkmcnt(12)
    s_barrier
    s_waitcnt lgkmcnt(15)
    v_ashrrev_i32 v122, 5, v54
    v_lshlrev_b16 v123, 2, v54
    v_cndmask_b32 v126, v12, v13, s[66:67]
    v_bitop3_b32 v122, v122, v113, v113 bitop3:0x0c
    v_lshlrev_b32 v124, 16, v126
    v_mul_f32 v122, v114, v122
    v_and_b32 v125, 0xffff0000, v126
    v_add_u32 v123, v123, v123
    v_mul_f32 v124, v122, v124
    v_mul_f32 v125, v122, v125
    v_cmpx_le_u32 vcc, 0x1000000, v54
    ds_add_f32 v123, v124 offset:54272
    ds_add_f32 v123, v125 offset:54276
    s_mov_b64 exec, -1
    v_ashrrev_i32 v122, 5, v55
    v_lshlrev_b16 v123, 2, v55
    v_cndmask_b32 v126, v14, v15, s[66:67]
    v_bitop3_b32 v122, v122, v113, v113 bitop3:0x0c
    v_lshlrev_b32 v124, 16, v126
    v_mul_f32 v122, v114, v122
    v_and_b32 v125, 0xffff0000, v126
    v_add_u32 v123, v123, v123
    v_mul_f32 v124, v122, v124
    v_mul_f32 v125, v122, v125
    v_cmpx_le_u32 vcc, 0x1000000, v55
    ds_add_f32 v123, v124 offset:54272
    ds_add_f32 v123, v125 offset:54276
    s_mov_b64 exec, -1
    v_ashrrev_i32 v122, 5, v56
    v_lshlrev_b16 v123, 2, v56
    v_cndmask_b32 v126, v16, v17, s[66:67]
    v_bitop3_b32 v122, v122, v113, v113 bitop3:0x0c
    v_lshlrev_b32 v124, 16, v126
    v_mul_f32 v122, v114, v122
    v_and_b32 v125, 0xffff0000, v126
    v_add_u32 v123, v123, v123
    v_mul_f32 v124, v122, v124
    v_mul_f32 v125, v122, v125
    v_cmpx_le_u32 vcc, 0x1000000, v56
    ds_add_f32 v123, v124 offset:54272
    ds_add_f32 v123, v125 offset:54276
    s_mov_b64 exec, -1
    v_lshrrev_b32 v12, 3, v104
    v_lshrrev_b32 v13, 18, v104
    v_and_b32 v104, 0x3fff, v104
    v_and_or_b32 v12, v12, s65, v13
    v_mad_u32_u24 v104, v12, s63, v104
    buffer_load_dwordx4 v[12:15], v104, s[68:71], 0 offen
    s_waitcnt lgkmcnt(15)
    v_ashrrev_i32 v122, 5, v57
    v_lshlrev_b16 v123, 2, v57
    v_cndmask_b32 v126, v18, v19, s[66:67]
    v_bitop3_b32 v122, v122, v113, v113 bitop3:0x0c
    v_lshlrev_b32 v124, 16, v126
    v_mul_f32 v122, v114, v122
    v_and_b32 v125, 0xffff0000, v126
    v_add_u32 v123, v123, v123
    v_mul_f32 v124, v122, v124
    v_mul_f32 v125, v122, v125
    v_cmpx_le_u32 vcc, 0x1000000, v57
    ds_add_f32 v123, v124 offset:54272
    ds_add_f32 v123, v125 offset:54276
    s_mov_b64 exec, -1
    v_ashrrev_i32 v122, 5, v58
    v_lshlrev_b16 v123, 2, v58
    v_cndmask_b32 v126, v20, v21, s[66:67]
    v_bitop3_b32 v122, v122, v113, v113 bitop3:0x0c
    v_lshlrev_b32 v124, 16, v126
    v_mul_f32 v122, v114, v122
    v_and_b32 v125, 0xffff0000, v126
    v_add_u32 v123, v123, v123
    v_mul_f32 v124, v122, v124
    v_mul_f32 v125, v122, v125
    v_cmpx_le_u32 vcc, 0x1000000, v58
    ds_add_f32 v123, v124 offset:54272
    ds_add_f32 v123, v125 offset:54276
    s_mov_b64 exec, -1
    v_ashrrev_i32 v122, 5, v59
    v_lshlrev_b16 v123, 2, v59
    v_cndmask_b32 v126, v22, v23, s[66:67]
    v_bitop3_b32 v122, v122, v113, v113 bitop3:0x0c
    v_lshlrev_b32 v124, 16, v126
    v_mul_f32 v122, v114, v122
    v_and_b32 v125, 0xffff0000, v126
    v_add_u32 v123, v123, v123
    v_mul_f32 v124, v122, v124
    v_mul_f32 v125, v122, v125
    v_cmpx_le_u32 vcc, 0x1000000, v59
    ds_add_f32 v123, v124 offset:54272
    ds_add_f32 v123, v125 offset:54276
    s_mov_b64 exec, -1
    v_lshrrev_b32 v18, 3, v105
    v_lshrrev_b32 v19, 18, v105
    v_and_b32 v105, 0x3fff, v105
    v_and_or_b32 v18, v18, s65, v19
    v_mad_u32_u24 v105, v18, s63, v105
    buffer_load_dwordx4 v[18:21], v105, s[68:71], 0 offen
    s_mov_b32 m0, s23
    v_mov_b32 v53, 0x3c000
    s_movk_i32 s44, 512
    v_sub_u32_sdwa v4, v111, v110 dst_sel:DWORD dst_unused:UNUSED_PAD src0_sel:WORD_0 src1_sel:WORD_0
    v_sub_u32_sdwa v5, v111, v110 dst_sel:DWORD dst_unused:UNUSED_PAD src0_sel:WORD_1 src1_sel:WORD_1
    v_med3_i32 v4, v4, 0, s44
    v_med3_i32 v5, v5, 0, s44
    v_add_u32 v48, v4, v5
    ds_write_addtid_b32 v53 offset:0
    ds_write_addtid_b32 v53 offset:256
    ds_write_addtid_b32 v53 offset:512
    ds_write_addtid_b32 v53 offset:768
    ds_write_addtid_b32 v53 offset:1024
    ds_write_addtid_b32 v53 offset:1280
    ds_write_addtid_b32 v53 offset:1536
    ds_write_addtid_b32 v53 offset:1792
    v_and_b32 v49, 0x3c0, v112
    v_and_b32 v53, 0x30, v112
    v_lshl_or_b32 v53, v49, 4, v53
    v_lshl_add_u32 v53, v53, 15, s41
    s_nop 1
    v_add_u32_dpp v48, v48, v48 row_shr:1 row_mask:0xf bank_mask:0xf bound_ctrl:0
    s_nop 1
    v_add_u32_dpp v48, v48, v48 row_shr:2 row_mask:0xf bank_mask:0xf bound_ctrl:0
    s_nop 1
    v_add_u32_dpp v48, v48, v48 row_shr:4 row_mask:0xf bank_mask:0xf bound_ctrl:0
    s_nop 1
    v_add_u32_dpp v48, v48, v48 row_shr:8 row_mask:0xf bank_mask:0xf bound_ctrl:0
    s_nop 1
    v_add_u32_dpp v48, v48, v48 row_bcast:15 row_mask:0xa bank_mask:0xf
    s_nop 1
    v_add_u32_dpp v48, v48, v48 row_bcast:31 row_mask:0xc bank_mask:0xf
    s_nop 1
    s_nop 0
    v_readlane_b32 s38, v48, 63
    v_sub_u32 v50, v48, v5
    v_sub_u32 v49, v50, v4
    v_sub_u32 v10, 512, v49
    v_mad_u32_u16 v51, v110, 16, v53
    v_med3_i32 v10, v10, 0, v4
    v_lshl_add_u32 v49, v49, 2, s23
    v_sub_u32 v11, 512, v50
    v_mad_u32_u16 v52, v110, 16, v53 op_sel:[1,0,0,0]
    v_med3_i32 v11, v11, 0, v5
    v_lshl_add_u32 v50, v50, 2, s23
    v_lshl_add_u32 v48, v11, 16, v10
    v_add_u32 v52, 262144, v52
    v_add_u32 v110, v110, v48
    s_min_u32 s17, s38, 512
    s_add_u32 s17, s17, 63
    s_lshr_b32 s17, s17, 6
p2_x1x_0:
    v_cmpx_lt_i32 vcc, 0, v10
    s_cbranch_execz p2_y1x_0
    ds_write_b32 v49, v51 offset:0
    v_add_u32 v51, 16, v51
    v_cmpx_lt_i32 vcc, 1, v10
    s_cbranch_execz p2_y1x_0
    ds_write_b32 v49, v51 offset:4
    v_add_u32 v51, 16, v51
    v_cmpx_lt_i32 vcc, 2, v10
    s_cbranch_execz p2_y1x_0
    ds_write_b32 v49, v51 offset:8
    v_add_u32 v51, 16, v51
    v_cmpx_lt_i32 vcc, 3, v10
    s_cbranch_execz p2_y1x_0
    ds_write_b32 v49, v51 offset:12
    v_add_u32 v51, 16, v51
    v_cmpx_lt_i32 vcc, 4, v10
    s_cbranch_execz p2_y1x_0
    ds_write_b32 v49, v51 offset:16
    v_add_u32 v51, 16, v51
    v_cmpx_lt_i32 vcc, 5, v10
    s_cbranch_execz p2_y1x_0
    ds_write_b32 v49, v51 offset:20
    v_add_u32 v51, 16, v51
    v_cmpx_lt_i32 vcc, 6, v10
    s_cbranch_execz p2_y1x_0
    ds_write_b32 v49, v51 offset:24
    v_add_u32 v51, 16, v51
    v_cmpx_lt_i32 vcc, 7, v10
    s_cbranch_execz p2_y1x_0
    ds_write_b32 v49, v51 offset:28
    v_add_u32 v51, 16, v51
    v_subrev_u32 v10, 8, v10
    v_add_u32 v49, 32, v49
    s_branch p2_x1x_0
p2_y1x_0:
    s_mov_b64 exec, -1
p2_x1x_1:
    v_cmpx_lt_i32 vcc, 0, v11
    s_cbranch_execz p2_y1x_1
    ds_write_b32 v50, v52 offset:0
    v_add_u32 v52, 16, v52
    v_cmpx_lt_i32 vcc, 1, v11
    s_cbranch_execz p2_y1x_1
    ds_write_b32 v50, v52 offset:4
    v_add_u32 v52, 16, v52
    v_cmpx_lt_i32 vcc, 2, v11
    s_cbranch_execz p2_y1x_1
    ds_write_b32 v50, v52 offset:8
    v_add_u32 v52, 16, v52
    v_cmpx_lt_i32 vcc, 3, v11
    s_cbranch_execz p2_y1x_1
    ds_write_b32 v50, v52 offset:12
    v_add_u32 v52, 16, v52
    v_cmpx_lt_i32 vcc, 4, v11
    s_cbranch_execz p2_y1x_1
    ds_write_b32 v50, v52 offset:16
    v_add_u32 v52, 16, v52
    v_cmpx_lt_i32 vcc, 5, v11
    s_cbranch_execz p2_y1x_1
    ds_write_b32 v50, v52 offset:20
    v_add_u32 v52, 16, v52
    v_cmpx_lt_i32 vcc, 6, v11
    s_cbranch_execz p2_y1x_1
    ds_write_b32 v50, v52 offset:24
    v_add_u32 v52, 16, v52
    v_cmpx_lt_i32 vcc, 7, v11
    s_cbranch_execz p2_y1x_1
    ds_write_b32 v50, v52 offset:28
    v_add_u32 v52, 16, v52
    v_subrev_u32 v11, 8, v11
    v_add_u32 v50, 32, v50
    s_branch p2_x1x_1
p2_y1x_1:
    s_mov_b64 exec, -1
    s_cmp_lt_u32 s38, 512
    s_cbranch_scc1 p2_nomore1x
    v_cmp_lt_u32_sdwa s[44:45], v110, v111 src0_sel:WORD_0 src1_sel:WORD_0
    v_cmp_lt_u32_sdwa s[46:47], v110, v111 src0_sel:WORD_1 src1_sel:WORD_1
    s_nop 0
    s_or_b64 s[44:45], s[44:45], s[46:47]
    s_cbranch_scc0 p2_nomore1x
    v_mov_b32 v49, s19
    v_mov_b32 v50, 1
    ds_write_b32 v49, v50 offset:53760
p2_nomore1x:
    s_mov_b32 m0, s23
    s_nop 0
    ds_read_addtid_b32 v102 offset:0
    ds_read_addtid_b32 v103 offset:256
    ds_read_addtid_b32 v104 offset:512
    ds_read_addtid_b32 v105 offset:768
    ds_read_addtid_b32 v106 offset:1024
    ds_read_addtid_b32 v107 offset:1280
    ds_read_addtid_b32 v108 offset:1536
    ds_read_addtid_b32 v109 offset:1792
    s_waitcnt vmcnt(4)
    s_mov_b32 m0, s24
    s_cmp_ge_u32 s10, 9
    s_cbranch_scc1 p2_st1s0
    ds_write_addtid_b32 v84 offset:49152
    ds_write_addtid_b32 v85 offset:49408
p2_st1s0:
    s_mov_b32 m0, s23
    s_add_u32 s20, s20, 53760
    ds_write_addtid_b32 v72 offset:0
    ds_write_addtid_b32 v73 offset:256
    ds_write_addtid_b32 v74 offset:512
    ds_write_addtid_b32 v75 offset:768
    ds_write_addtid_b32 v76 offset:1024
    ds_write_addtid_b32 v77 offset:1280
    ds_write_addtid_b32 v78 offset:1536
    ds_write_addtid_b32 v79 offset:1792
    ds_write_addtid_b32 v80 offset:2048
    ds_write_addtid_b32 v81 offset:2304
    ds_write_addtid_b32 v82 offset:2560
    ds_write_addtid_b32 v83 offset:2816
    s_waitcnt lgkmcnt(15)
    v_ashrrev_i32 v122, 5, v60
    v_lshlrev_b16 v123, 2, v60
    v_cndmask_b32 v126, v24, v25, s[66:67]
    v_bitop3_b32 v122, v122, v113, v113 bitop3:0x0c
    v_lshlrev_b32 v124, 16, v126
    v_mul_f32 v122, v114, v122
    v_and_b32 v125, 0xffff0000, v126
    v_add_u32 v123, v123, v123
    v_mul_f32 v124, v122, v124
    v_mul_f32 v125, v122, v125
    v_cmpx_le_u32 vcc, 0x1000000, v60
    ds_add_f32 v123, v124 offset:54272
    ds_add_f32 v123, v125 offset:54276
    s_mov_b64 exec, -1
    v_ashrrev_i32 v122, 5, v61
    v_lshlrev_b16 v123, 2, v61
    v_cndmask_b32 v126, v26, v27, s[66:67]
    v_bitop3_b32 v122, v122, v113, v113 bitop3:0x0c
    v_lshlrev_b32 v124, 16, v126
    v_mul_f32 v122, v114, v122
    v_and_b32 v125, 0xffff0000, v126
    v_add_u32 v123, v123, v123
    v_mul_f32 v124, v122, v124
    v_mul_f32 v125, v122, v125
    v_cmpx_le_u32 vcc, 0x1000000, v61
    ds_add_f32 v123, v124 offset:54272
    ds_add_f32 v123, v125 offset:54276
    s_mov_b64 exec, -1
    v_ashrrev_i32 v122, 5, v62
    v_lshlrev_b16 v123, 2, v62
    v_cndmask_b32 v126, v28, v29, s[66:67]
    v_bitop3_b32 v122, v122, v113, v113 bitop3:0x0c
    v_lshlrev_b32 v124, 16, v126
    v_mul_f32 v122, v114, v122
    v_and_b32 v125, 0xffff0000, v126
    v_add_u32 v123, v123, v123
    v_mul_f32 v124, v122, v124
    v_mul_f32 v125, v122, v125
    v_cmpx_le_u32 vcc, 0x1000000, v62
    ds_add_f32 v123, v124 offset:54272
    ds_add_f32 v123, v125 offset:54276
    s_mov_b64 exec, -1
    s_waitcnt vmcnt(13)
    v_perm_b32 v60, v89, v86, s31
    v_perm_b32 v61, v89, v87, s32
    v_perm_b32 v62, v89, v88, s33
    v_lshlrev_b16 v28, 3, v88
    v_lshlrev_b16 v26, 3, v87
    v_lshlrev_b16 v24, 3, v86
    s_waitcnt lgkmcnt(6)
    s_barrier
    s_cmp_ge_u32 s10, 9
    s_cbranch_scc1 p2_nm1m1a
    v_lshrrev_b32 v84, 1, v112
    s_add_u32 s44, s20, s42
    buffer_load_dwordx2 v[84:85], v84, s[4:7], s44 offen
p2_nm1m1a:
    buffer_load_dwordx4 v[72:75], v112, s[4:7], s20 offen offset:0
    buffer_load_dwordx4 v[76:79], v112, s[4:7], s20 offen offset:1024
    buffer_load_dwordx4 v[80:83], v112, s[4:7], s20 offen offset:2048
    v_cmpx_ge_u16 vcc, 0x3fff, v60
    ds_read_b64 v[24:25], v24
    s_mov_b64 exec, -1
    v_cmpx_ge_u16 vcc, 0x3fff, v61
    ds_read_b64 v[26:27], v26
    s_mov_b64 exec, -1
    v_cmpx_ge_u16 vcc, 0x3fff, v62
    ds_read_b64 v[28:29], v28
    s_mov_b64 exec, -1
    s_waitcnt lgkmcnt(15)
    v_ashrrev_i32 v122, 5, v63
    v_lshlrev_b16 v123, 2, v63
    v_cndmask_b32 v126, v30, v31, s[66:67]
    v_bitop3_b32 v122, v122, v113, v113 bitop3:0x0c
    v_lshlrev_b32 v124, 16, v126
    v_mul_f32 v122, v114, v122
    v_and_b32 v125, 0xffff0000, v126
    v_add_u32 v123, v123, v123
    v_mul_f32 v124, v122, v124
    v_mul_f32 v125, v122, v125
    v_cmpx_le_u32 vcc, 0x1000000, v63
    ds_add_f32 v123, v124 offset:54272
    ds_add_f32 v123, v125 offset:54276
    s_mov_b64 exec, -1
    v_ashrrev_i32 v122, 5, v64
    v_lshlrev_b16 v123, 2, v64
    v_cndmask_b32 v126, v32, v33, s[66:67]
    v_bitop3_b32 v122, v122, v113, v113 bitop3:0x0c
    v_lshlrev_b32 v124, 16, v126
    v_mul_f32 v122, v114, v122
    v_and_b32 v125, 0xffff0000, v126
    v_add_u32 v123, v123, v123
    v_mul_f32 v124, v122, v124
    v_mul_f32 v125, v122, v125
    v_cmpx_le_u32 vcc, 0x1000000, v64
    ds_add_f32 v123, v124 offset:54272
    ds_add_f32 v123, v125 offset:54276
    s_mov_b64 exec, -1
    v_ashrrev_i32 v122, 5, v65
    v_lshlrev_b16 v123, 2, v65
    v_cndmask_b32 v126, v34, v35, s[66:67]
    v_bitop3_b32 v122, v122, v113, v113 bitop3:0x0c
    v_lshlrev_b32 v124, 16, v126
    v_mul_f32 v122, v114, v122
    v_and_b32 v125, 0xffff0000, v126
    v_add_u32 v123, v123, v123
    v_mul_f32 v124, v122, v124
    v_mul_f32 v125, v122, v125
    v_cmpx_le_u32 vcc, 0x1000000, v65
    ds_add_f32 v123, v124 offset:54272
    ds_add_f32 v123, v125 offset:54276
    s_mov_b64 exec, -1
    s_waitcnt vmcnt(15)
    v_perm_b32 v63, v93, v90, s31
    v_perm_b32 v64, v93, v91, s32
    v_perm_b32 v65, v93, v92, s33
    v_lshlrev_b16 v34, 3, v92
    v_lshlrev_b16 v32, 3, v91
    v_lshlrev_b16 v30, 3, v90
    v_cmpx_ge_u16 vcc, 0x3fff, v63
    ds_read_b64 v[30:31], v30
    s_mov_b64 exec, -1
    v_cmpx_ge_u16 vcc, 0x3fff, v64
    ds_read_b64 v[32:33], v32
    s_mov_b64 exec, -1
    v_cmpx_ge_u16 vcc, 0x3fff, v65
    ds_read_b64 v[34:35], v34
    s_mov_b64 exec, -1
    s_waitcnt lgkmcnt(15)
    v_lshrrev_b32 v86, 3, v106
    v_lshrrev_b32 v87, 18, v106
    v_and_b32 v106, 0x3fff, v106
    v_and_or_b32 v86, v86, s65, v87
    v_mad_u32_u24 v106, v86, s63, v106
    buffer_load_dwordx4 v[86:89], v106, s[68:71], 0 offen
    s_waitcnt lgkmcnt(15)
    v_ashrrev_i32 v122, 5, v66
    v_lshlrev_b16 v123, 2, v66
    v_cndmask_b32 v126, v36, v37, s[66:67]
    v_bitop3_b32 v122, v122, v113, v113 bitop3:0x0c
    v_lshlrev_b32 v124, 16, v126
    v_mul_f32 v122, v114, v122
    v_and_b32 v125, 0xffff0000, v126
    v_add_u32 v123, v123, v123
    v_mul_f32 v124, v122, v124
    v_mul_f32 v125, v122, v125
    v_cmpx_le_u32 vcc, 0x1000000, v66
    ds_add_f32 v123, v124 offset:54272
    ds_add_f32 v123, v125 offset:54276
    s_mov_b64 exec, -1
    v_ashrrev_i32 v122, 5, v67
    v_lshlrev_b16 v123, 2, v67
    v_cndmask_b32 v126, v38, v39, s[66:67]
    v_bitop3_b32 v122, v122, v113, v113 bitop3:0x0c
    v_lshlrev_b32 v124, 16, v126
    v_mul_f32 v122, v114, v122
    v_and_b32 v125, 0xffff0000, v126
    v_add_u32 v123, v123, v123
    v_mul_f32 v124, v122, v124
    v_mul_f32 v125, v122, v125
    v_cmpx_le_u32 vcc, 0x1000000, v67
    ds_add_f32 v123, v124 offset:54272
    ds_add_f32 v123, v125 offset:54276
    s_mov_b64 exec, -1
    v_ashrrev_i32 v122, 5, v68
    v_lshlrev_b16 v123, 2, v68
    v_cndmask_b32 v126, v40, v41, s[66:67]
    v_bitop3_b32 v122, v122, v113, v113 bitop3:0x0c
    v_lshlrev_b32 v124, 16, v126
    v_mul_f32 v122, v114, v122
    v_and_b32 v125, 0xffff0000, v126
    v_add_u32 v123, v123, v123
    v_mul_f32 v124, v122, v124
    v_mul_f32 v125, v122, v125
    v_cmpx_le_u32 vcc, 0x1000000, v68
    ds_add_f32 v123, v124 offset:54272
    ds_add_f32 v123, v125 offset:54276
    s_mov_b64 exec, -1
    s_waitcnt vmcnt(12)
    v_perm_b32 v66, v97, v94, s31
    v_perm_b32 v67, v97, v95, s32
    v_perm_b32 v68, v97, v96, s33
    v_lshlrev_b16 v40, 3, v96
    v_lshlrev_b16 v38, 3, v95
    v_lshlrev_b16 v36, 3, v94
    v_cmpx_ge_u16 vcc, 0x3fff, v66
    ds_read_b64 v[36:37], v36
    s_mov_b64 exec, -1
    v_cmpx_ge_u16 vcc, 0x3fff, v67
    ds_read_b64 v[38:39], v38
    s_mov_b64 exec, -1
    v_cmpx_ge_u16 vcc, 0x3fff, v68
    ds_read_b64 v[40:41], v40
    s_mov_b64 exec, -1
    s_cmp_le_u32 s15, 7
    s_cbranch_scc1 p2_na1a7
    s_waitcnt lgkmcnt(15)
    v_ashrrev_i32 v122, 5, v69
    v_lshlrev_b16 v123, 2, v69
    v_cndmask_b32 v126, v42, v43, s[66:67]
    v_bitop3_b32 v122, v122, v113, v113 bitop3:0x0c
    v_lshlrev_b32 v124, 16, v126
    v_mul_f32 v122, v114, v122
    v_and_b32 v125, 0xffff0000, v126
    v_add_u32 v123, v123, v123
    v_mul_f32 v124, v122, v124
    v_mul_f32 v125, v122, v125
    v_cmpx_le_u32 vcc, 0x1000000, v69
    ds_add_f32 v123, v124 offset:54272
    ds_add_f32 v123, v125 offset:54276
    s_mov_b64 exec, -1
    v_ashrrev_i32 v122, 5, v70
    v_lshlrev_b16 v123, 2, v70
    v_cndmask_b32 v126, v44, v45, s[66:67]
    v_bitop3_b32 v122, v122, v113, v113 bitop3:0x0c
    v_lshlrev_b32 v124, 16, v126
    v_mul_f32 v122, v114, v122
    v_and_b32 v125, 0xffff0000, v126
    v_add_u32 v123, v123, v123
    v_mul_f32 v124, v122, v124
    v_mul_f32 v125, v122, v125
    v_cmpx_le_u32 vcc, 0x1000000, v70
    ds_add_f32 v123, v124 offset:54272
    ds_add_f32 v123, v125 offset:54276
    s_mov_b64 exec, -1
    v_ashrrev_i32 v122, 5, v71
    v_lshlrev_b16 v123, 2, v71
    v_cndmask_b32 v126, v46, v47, s[66:67]
    v_bitop3_b32 v122, v122, v113, v113 bitop3:0x0c
    v_lshlrev_b32 v124, 16, v126
    v_mul_f32 v122, v114, v122
    v_and_b32 v125, 0xffff0000, v126
    v_add_u32 v123, v123, v123
    v_mul_f32 v124, v122, v124
    v_mul_f32 v125, v122, v125
    v_cmpx_le_u32 vcc, 0x1000000, v71
    ds_add_f32 v123, v124 offset:54272
    ds_add_f32 v123, v125 offset:54276
    s_mov_b64 exec, -1
p2_na1a7:
    s_waitcnt vmcnt(11)
    v_perm_b32 v69, v101, v98, s31
    v_perm_b32 v70, v101, v99, s32
    v_perm_b32 v71, v101, v100, s33
    v_lshlrev_b16 v46, 3, v100
    v_lshlrev_b16 v44, 3, v99
    v_lshlrev_b16 v42, 3, v98
    s_cmp_le_u32 s16, 7
    s_cbranch_scc1 p2_g1r07
    v_cmpx_ge_u16 vcc, 0x3fff, v69
    ds_read_b64 v[42:43], v42
    s_mov_b64 exec, -1
    v_cmpx_ge_u16 vcc, 0x3fff, v70
    ds_read_b64 v[44:45], v44
    s_mov_b64 exec, -1
    v_cmpx_ge_u16 vcc, 0x3fff, v71
    ds_read_b64 v[46:47], v46
    s_mov_b64 exec, -1
p2_g1r07:
    s_waitcnt lgkmcnt(15)
    v_lshrrev_b32 v90, 3, v107
    v_lshrrev_b32 v91, 18, v107
    v_and_b32 v107, 0x3fff, v107
    v_and_or_b32 v90, v90, s65, v91
    v_mad_u32_u24 v107, v90, s63, v107
    buffer_load_dwordx4 v[90:93], v107, s[68:71], 0 offen
    s_waitcnt vmcnt(8)
    v_perm_b32 v48, v3, v0, s31
    v_perm_b32 v49, v3, v1, s32
    v_perm_b32 v50, v3, v2, s33
    v_lshlrev_b16 v4, 3, v2
    v_lshlrev_b16 v2, 3, v1
    v_lshlrev_b16 v0, 3, v0
    v_cmpx_ge_u16 vcc, 0x3fff, v48
    ds_read_b64 v[0:1], v0
    s_mov_b64 exec, -1
    v_cmpx_ge_u16 vcc, 0x3fff, v49
    ds_read_b64 v[2:3], v2
    s_mov_b64 exec, -1
    v_cmpx_ge_u16 vcc, 0x3fff, v50
    ds_read_b64 v[4:5], v4
    s_mov_b64 exec, -1
    s_waitcnt vmcnt(7)
    v_perm_b32 v51, v9, v6, s31
    v_perm_b32 v52, v9, v7, s32
    v_perm_b32 v53, v9, v8, s33
    v_lshlrev_b16 v10, 3, v8
    v_lshlrev_b16 v8, 3, v7
    v_lshlrev_b16 v6, 3, v6
    v_cmpx_ge_u16 vcc, 0x3fff, v51
    ds_read_b64 v[6:7], v6
    s_mov_b64 exec, -1
    v_cmpx_ge_u16 vcc, 0x3fff, v52
    ds_read_b64 v[8:9], v8
    s_mov_b64 exec, -1
    v_cmpx_ge_u16 vcc, 0x3fff, v53
    ds_read_b64 v[10:11], v10
    s_mov_b64 exec, -1
    s_waitcnt vmcnt(6)
    v_perm_b32 v54, v15, v12, s31
    v_perm_b32 v55, v15, v13, s32
    v_perm_b32 v56, v15, v14, s33
    v_lshlrev_b16 v16, 3, v14
    v_lshlrev_b16 v14, 3, v13
    v_lshlrev_b16 v12, 3, v12
    v_cmpx_ge_u16 vcc, 0x3fff, v54
    ds_read_b64 v[12:13], v12
    s_mov_b64 exec, -1
    v_cmpx_ge_u16 vcc, 0x3fff, v55
    ds_read_b64 v[14:15], v14
    s_mov_b64 exec, -1
    v_cmpx_ge_u16 vcc, 0x3fff, v56
    ds_read_b64 v[16:17], v16
    s_mov_b64 exec, -1
    s_waitcnt vmcnt(5)
    v_perm_b32 v57, v21, v18, s31
    v_perm_b32 v58, v21, v19, s32
    v_perm_b32 v59, v21, v20, s33
    v_lshlrev_b16 v22, 3, v20
    v_lshlrev_b16 v20, 3, v19
    v_lshlrev_b16 v18, 3, v18
    v_cmpx_ge_u16 vcc, 0x3fff, v57
    ds_read_b64 v[18:19], v18
    s_mov_b64 exec, -1
    v_cmpx_ge_u16 vcc, 0x3fff, v58
    ds_read_b64 v[20:21], v20
    s_mov_b64 exec, -1
    v_cmpx_ge_u16 vcc, 0x3fff, v59
    ds_read_b64 v[22:23], v22
    s_mov_b64 exec, -1
    s_waitcnt lgkmcnt(0)
    s_barrier
    s_waitcnt lgkmcnt(15)
    s_branch p2_tail
p2_drain1:
    v_cmpx_gt_i16 vcc, 0, v48
    ds_read_b64 v[0:1], v0
    s_mov_b64 exec, -1
    v_cmpx_gt_i16 vcc, 0, v49
    ds_read_b64 v[2:3], v2
    s_mov_b64 exec, -1
    v_cmpx_gt_i16 vcc, 0, v50
    ds_read_b64 v[4:5], v4
    s_mov_b64 exec, -1
    v_cmpx_gt_i16 vcc, 0, v51
    ds_read_b64 v[6:7], v6
    s_mov_b64 exec, -1
    v_cmpx_gt_i16 vcc, 0, v52
    ds_read_b64 v[8:9], v8
    s_mov_b64 exec, -1
    v_cmpx_gt_i16 vcc, 0, v53
    ds_read_b64 v[10:11], v10
    s_mov_b64 exec, -1
    v_cmpx_gt_i16 vcc, 0, v54
    ds_read_b64 v[12:13], v12
    s_mov_b64 exec, -1
    v_cmpx_gt_i16 vcc, 0, v55
    ds_read_b64 v[14:15], v14
    s_mov_b64 exec, -1
    v_cmpx_gt_i16 vcc, 0, v56
    ds_read_b64 v[16:17], v16
    s_mov_b64 exec, -1
    v_cmpx_gt_i16 vcc, 0, v57
    ds_read_b64 v[18:19], v18
    s_mov_b64 exec, -1
    v_cmpx_gt_i16 vcc, 0, v58
    ds_read_b64 v[20:21], v20
    s_mov_b64 exec, -1
    v_cmpx_gt_i16 vcc, 0, v59
    ds_read_b64 v[22:23], v22
    s_mov_b64 exec, -1
    v_cmpx_gt_i16 vcc, 0, v60
    ds_read_b64 v[24:25], v24
    s_mov_b64 exec, -1
    v_cmpx_gt_i16 vcc, 0, v61
    ds_read_b64 v[26:27], v26
    s_mov_b64 exec, -1
    v_cmpx_gt_i16 vcc, 0, v62
    ds_read_b64 v[28:29], v28
    s_mov_b64 exec, -1
    v_cmpx_gt_i16 vcc, 0, v63
    ds_read_b64 v[30:31], v30
    s_mov_b64 exec, -1
    v_cmpx_gt_i16 vcc, 0, v64
    ds_read_b64 v[32:33], v32
    s_mov_b64 exec, -1
    v_cmpx_gt_i16 vcc, 0, v65
    ds_read_b64 v[34:35], v34
    s_mov_b64 exec, -1
    v_cmpx_gt_i16 vcc, 0, v66
    ds_read_b64 v[36:37], v36
    s_mov_b64 exec, -1
    v_cmpx_gt_i16 vcc, 0, v67
    ds_read_b64 v[38:39], v38
    s_mov_b64 exec, -1
    v_cmpx_gt_i16 vcc, 0, v68
    ds_read_b64 v[40:41], v40
    s_mov_b64 exec, -1
    s_cmp_le_u32 s15, 7
    s_cbranch_scc1 p2_gd1
    v_cmpx_gt_i16 vcc, 0, v69
    ds_read_b64 v[42:43], v42
    s_mov_b64 exec, -1
    v_cmpx_gt_i16 vcc, 0, v70
    ds_read_b64 v[44:45], v44
    s_mov_b64 exec, -1
    v_cmpx_gt_i16 vcc, 0, v71
    ds_read_b64 v[46:47], v46
    s_mov_b64 exec, -1
p2_gd1:
    s_waitcnt lgkmcnt(15)
    v_ashrrev_i32 v122, 5, v48
    v_lshlrev_b16 v123, 2, v48
    v_cndmask_b32 v126, v0, v1, s[66:67]
    v_bitop3_b32 v122, v122, v113, v113 bitop3:0x0c
    v_lshlrev_b32 v124, 16, v126
    v_mul_f32 v122, v114, v122
    v_and_b32 v125, 0xffff0000, v126
    v_add_u32 v123, v123, v123
    v_mul_f32 v124, v122, v124
    v_mul_f32 v125, v122, v125
    v_cmpx_le_u32 vcc, 0x1000000, v48
    ds_add_f32 v123, v124 offset:54272
    ds_add_f32 v123, v125 offset:54276
    s_mov_b64 exec, -1
    v_ashrrev_i32 v122, 5, v49
    v_lshlrev_b16 v123, 2, v49
    v_cndmask_b32 v126, v2, v3, s[66:67]
    v_bitop3_b32 v122, v122, v113, v113 bitop3:0x0c
    v_lshlrev_b32 v124, 16, v126
    v_mul_f32 v122, v114, v122
    v_and_b32 v125, 0xffff0000, v126
    v_add_u32 v123, v123, v123
    v_mul_f32 v124, v122, v124
    v_mul_f32 v125, v122, v125
    v_cmpx_le_u32 vcc, 0x1000000, v49
    ds_add_f32 v123, v124 offset:54272
    ds_add_f32 v123, v125 offset:54276
    s_mov_b64 exec, -1
    v_ashrrev_i32 v122, 5, v50
    v_lshlrev_b16 v123, 2, v50
    v_cndmask_b32 v126, v4, v5, s[66:67]
    v_bitop3_b32 v122, v122, v113, v113 bitop3:0x0c
    v_lshlrev_b32 v124, 16, v126
    v_mul_f32 v122, v114, v122
    v_and_b32 v125, 0xffff0000, v126
    v_add_u32 v123, v123, v123
    v_mul_f32 v124, v122, v124
    v_mul_f32 v125, v122, v125
    v_cmpx_le_u32 vcc, 0x1000000, v50
    ds_add_f32 v123, v124 offset:54272
    ds_add_f32 v123, v125 offset:54276
    s_mov_b64 exec, -1
    s_waitcnt lgkmcnt(15)
    v_ashrrev_i32 v122, 5, v51
    v_lshlrev_b16 v123, 2, v51
    v_cndmask_b32 v126, v6, v7, s[66:67]
    v_bitop3_b32 v122, v122, v113, v113 bitop3:0x0c
    v_lshlrev_b32 v124, 16, v126
    v_mul_f32 v122, v114, v122
    v_and_b32 v125, 0xffff0000, v126
    v_add_u32 v123, v123, v123
    v_mul_f32 v124, v122, v124
    v_mul_f32 v125, v122, v125
    v_cmpx_le_u32 vcc, 0x1000000, v51
    ds_add_f32 v123, v124 offset:54272
    ds_add_f32 v123, v125 offset:54276
    s_mov_b64 exec, -1
    v_ashrrev_i32 v122, 5, v52
    v_lshlrev_b16 v123, 2, v52
    v_cndmask_b32 v126, v8, v9, s[66:67]
    v_bitop3_b32 v122, v122, v113, v113 bitop3:0x0c
    v_lshlrev_b32 v124, 16, v126
    v_mul_f32 v122, v114, v122
    v_and_b32 v125, 0xffff0000, v126
    v_add_u32 v123, v123, v123
    v_mul_f32 v124, v122, v124
    v_mul_f32 v125, v122, v125
    v_cmpx_le_u32 vcc, 0x1000000, v52
    ds_add_f32 v123, v124 offset:54272
    ds_add_f32 v123, v125 offset:54276
    s_mov_b64 exec, -1
    v_ashrrev_i32 v122, 5, v53
    v_lshlrev_b16 v123, 2, v53
    v_cndmask_b32 v126, v10, v11, s[66:67]
    v_bitop3_b32 v122, v122, v113, v113 bitop3:0x0c
    v_lshlrev_b32 v124, 16, v126
    v_mul_f32 v122, v114, v122
    v_and_b32 v125, 0xffff0000, v126
    v_add_u32 v123, v123, v123
    v_mul_f32 v124, v122, v124
    v_mul_f32 v125, v122, v125
    v_cmpx_le_u32 vcc, 0x1000000, v53
    ds_add_f32 v123, v124 offset:54272
    ds_add_f32 v123, v125 offset:54276
    s_mov_b64 exec, -1
    s_waitcnt lgkmcnt(15)
    v_ashrrev_i32 v122, 5, v54
    v_lshlrev_b16 v123, 2, v54
    v_cndmask_b32 v126, v12, v13, s[66:67]
    v_bitop3_b32 v122, v122, v113, v113 bitop3:0x0c
    v_lshlrev_b32 v124, 16, v126
    v_mul_f32 v122, v114, v122
    v_and_b32 v125, 0xffff0000, v126
    v_add_u32 v123, v123, v123
    v_mul_f32 v124, v122, v124
    v_mul_f32 v125, v122, v125
    v_cmpx_le_u32 vcc, 0x1000000, v54
    ds_add_f32 v123, v124 offset:54272
    ds_add_f32 v123, v125 offset:54276
    s_mov_b64 exec, -1
    v_ashrrev_i32 v122, 5, v55
    v_lshlrev_b16 v123, 2, v55
    v_cndmask_b32 v126, v14, v15, s[66:67]
    v_bitop3_b32 v122, v122, v113, v113 bitop3:0x0c
    v_lshlrev_b32 v124, 16, v126
    v_mul_f32 v122, v114, v122
    v_and_b32 v125, 0xffff0000, v126
    v_add_u32 v123, v123, v123
    v_mul_f32 v124, v122, v124
    v_mul_f32 v125, v122, v125
    v_cmpx_le_u32 vcc, 0x1000000, v55
    ds_add_f32 v123, v124 offset:54272
    ds_add_f32 v123, v125 offset:54276
    s_mov_b64 exec, -1
    v_ashrrev_i32 v122, 5, v56
    v_lshlrev_b16 v123, 2, v56
    v_cndmask_b32 v126, v16, v17, s[66:67]
    v_bitop3_b32 v122, v122, v113, v113 bitop3:0x0c
    v_lshlrev_b32 v124, 16, v126
    v_mul_f32 v122, v114, v122
    v_and_b32 v125, 0xffff0000, v126
    v_add_u32 v123, v123, v123
    v_mul_f32 v124, v122, v124
    v_mul_f32 v125, v122, v125
    v_cmpx_le_u32 vcc, 0x1000000, v56
    ds_add_f32 v123, v124 offset:54272
    ds_add_f32 v123, v125 offset:54276
    s_mov_b64 exec, -1
    s_waitcnt lgkmcnt(15)
    v_ashrrev_i32 v122, 5, v57
    v_lshlrev_b16 v123, 2, v57
    v_cndmask_b32 v126, v18, v19, s[66:67]
    v_bitop3_b32 v122, v122, v113, v113 bitop3:0x0c
    v_lshlrev_b32 v124, 16, v126
    v_mul_f32 v122, v114, v122
    v_and_b32 v125, 0xffff0000, v126
    v_add_u32 v123, v123, v123
    v_mul_f32 v124, v122, v124
    v_mul_f32 v125, v122, v125
    v_cmpx_le_u32 vcc, 0x1000000, v57
    ds_add_f32 v123, v124 offset:54272
    ds_add_f32 v123, v125 offset:54276
    s_mov_b64 exec, -1
    v_ashrrev_i32 v122, 5, v58
    v_lshlrev_b16 v123, 2, v58
    v_cndmask_b32 v126, v20, v21, s[66:67]
    v_bitop3_b32 v122, v122, v113, v113 bitop3:0x0c
    v_lshlrev_b32 v124, 16, v126
    v_mul_f32 v122, v114, v122
    v_and_b32 v125, 0xffff0000, v126
    v_add_u32 v123, v123, v123
    v_mul_f32 v124, v122, v124
    v_mul_f32 v125, v122, v125
    v_cmpx_le_u32 vcc, 0x1000000, v58
    ds_add_f32 v123, v124 offset:54272
    ds_add_f32 v123, v125 offset:54276
    s_mov_b64 exec, -1
    v_ashrrev_i32 v122, 5, v59
    v_lshlrev_b16 v123, 2, v59
    v_cndmask_b32 v126, v22, v23, s[66:67]
    v_bitop3_b32 v122, v122, v113, v113 bitop3:0x0c
    v_lshlrev_b32 v124, 16, v126
    v_mul_f32 v122, v114, v122
    v_and_b32 v125, 0xffff0000, v126
    v_add_u32 v123, v123, v123
    v_mul_f32 v124, v122, v124
    v_mul_f32 v125, v122, v125
    v_cmpx_le_u32 vcc, 0x1000000, v59
    ds_add_f32 v123, v124 offset:54272
    ds_add_f32 v123, v125 offset:54276
    s_mov_b64 exec, -1
    s_waitcnt lgkmcnt(15)
    v_ashrrev_i32 v122, 5, v60
    v_lshlrev_b16 v123, 2, v60
    v_cndmask_b32 v126, v24, v25, s[66:67]
    v_bitop3_b32 v122, v122, v113, v113 bitop3:0x0c
    v_lshlrev_b32 v124, 16, v126
    v_mul_f32 v122, v114, v122
    v_and_b32 v125, 0xffff0000, v126
    v_add_u32 v123, v123, v123
    v_mul_f32 v124, v122, v124
    v_mul_f32 v125, v122, v125
    v_cmpx_le_u32 vcc, 0x1000000, v60
    ds_add_f32 v123, v124 offset:54272
    ds_add_f32 v123, v125 offset:54276
    s_mov_b64 exec, -1
    v_ashrrev_i32 v122, 5, v61
    v_lshlrev_b16 v123, 2, v61
    v_cndmask_b32 v126, v26, v27, s[66:67]
    v_bitop3_b32 v122, v122, v113, v113 bitop3:0x0c
    v_lshlrev_b32 v124, 16, v126
    v_mul_f32 v122, v114, v122
    v_and_b32 v125, 0xffff0000, v126
    v_add_u32 v123, v123, v123
    v_mul_f32 v124, v122, v124
    v_mul_f32 v125, v122, v125
    v_cmpx_le_u32 vcc, 0x1000000, v61
    ds_add_f32 v123, v124 offset:54272
    ds_add_f32 v123, v125 offset:54276
    s_mov_b64 exec, -1
    v_ashrrev_i32 v122, 5, v62
    v_lshlrev_b16 v123, 2, v62
    v_cndmask_b32 v126, v28, v29, s[66:67]
    v_bitop3_b32 v122, v122, v113, v113 bitop3:0x0c
    v_lshlrev_b32 v124, 16, v126
    v_mul_f32 v122, v114, v122
    v_and_b32 v125, 0xffff0000, v126
    v_add_u32 v123, v123, v123
    v_mul_f32 v124, v122, v124
    v_mul_f32 v125, v122, v125
    v_cmpx_le_u32 vcc, 0x1000000, v62
    ds_add_f32 v123, v124 offset:54272
    ds_add_f32 v123, v125 offset:54276
    s_mov_b64 exec, -1
    s_waitcnt lgkmcnt(15)
    v_ashrrev_i32 v122, 5, v63
    v_lshlrev_b16 v123, 2, v63
    v_cndmask_b32 v126, v30, v31, s[66:67]
    v_bitop3_b32 v122, v122, v113, v113 bitop3:0x0c
    v_lshlrev_b32 v124, 16, v126
    v_mul_f32 v122, v114, v122
    v_and_b32 v125, 0xffff0000, v126
    v_add_u32 v123, v123, v123
    v_mul_f32 v124, v122, v124
    v_mul_f32 v125, v122, v125
    v_cmpx_le_u32 vcc, 0x1000000, v63
    ds_add_f32 v123, v124 offset:54272
    ds_add_f32 v123, v125 offset:54276
    s_mov_b64 exec, -1
    v_ashrrev_i32 v122, 5, v64
    v_lshlrev_b16 v123, 2, v64
    v_cndmask_b32 v126, v32, v33, s[66:67]
    v_bitop3_b32 v122, v122, v113, v113 bitop3:0x0c
    v_lshlrev_b32 v124, 16, v126
    v_mul_f32 v122, v114, v122
    v_and_b32 v125, 0xffff0000, v126
    v_add_u32 v123, v123, v123
    v_mul_f32 v124, v122, v124
    v_mul_f32 v125, v122, v125
    v_cmpx_le_u32 vcc, 0x1000000, v64
    ds_add_f32 v123, v124 offset:54272
    ds_add_f32 v123, v125 offset:54276
    s_mov_b64 exec, -1
    v_ashrrev_i32 v122, 5, v65
    v_lshlrev_b16 v123, 2, v65
    v_cndmask_b32 v126, v34, v35, s[66:67]
    v_bitop3_b32 v122, v122, v113, v113 bitop3:0x0c
    v_lshlrev_b32 v124, 16, v126
    v_mul_f32 v122, v114, v122
    v_and_b32 v125, 0xffff0000, v126
    v_add_u32 v123, v123, v123
    v_mul_f32 v124, v122, v124
    v_mul_f32 v125, v122, v125
    v_cmpx_le_u32 vcc, 0x1000000, v65
    ds_add_f32 v123, v124 offset:54272
    ds_add_f32 v123, v125 offset:54276
    s_mov_b64 exec, -1
    s_waitcnt lgkmcnt(15)
    v_ashrrev_i32 v122, 5, v66
    v_lshlrev_b16 v123, 2, v66
    v_cndmask_b32 v126, v36, v37, s[66:67]
    v_bitop3_b32 v122, v122, v113, v113 bitop3:0x0c
    v_lshlrev_b32 v124, 16, v126
    v_mul_f32 v122, v114, v122
    v_and_b32 v125, 0xffff0000, v126
    v_add_u32 v123, v123, v123
    v_mul_f32 v124, v122, v124
    v_mul_f32 v125, v122, v125
    v_cmpx_le_u32 vcc, 0x1000000, v66
    ds_add_f32 v123, v124 offset:54272
    ds_add_f32 v123, v125 offset:54276
    s_mov_b64 exec, -1
    v_ashrrev_i32 v122, 5, v67
    v_lshlrev_b16 v123, 2, v67
    v_cndmask_b32 v126, v38, v39, s[66:67]
    v_bitop3_b32 v122, v122, v113, v113 bitop3:0x0c
    v_lshlrev_b32 v124, 16, v126
    v_mul_f32 v122, v114, v122
    v_and_b32 v125, 0xffff0000, v126
    v_add_u32 v123, v123, v123
    v_mul_f32 v124, v122, v124
    v_mul_f32 v125, v122, v125
    v_cmpx_le_u32 vcc, 0x1000000, v67
    ds_add_f32 v123, v124 offset:54272
    ds_add_f32 v123, v125 offset:54276
    s_mov_b64 exec, -1
    v_ashrrev_i32 v122, 5, v68
    v_lshlrev_b16 v123, 2, v68
    v_cndmask_b32 v126, v40, v41, s[66:67]
    v_bitop3_b32 v122, v122, v113, v113 bitop3:0x0c
    v_lshlrev_b32 v124, 16, v126
    v_mul_f32 v122, v114, v122
    v_and_b32 v125, 0xffff0000, v126
    v_add_u32 v123, v123, v123
    v_mul_f32 v124, v122, v124
    v_mul_f32 v125, v122, v125
    v_cmpx_le_u32 vcc, 0x1000000, v68
    ds_add_f32 v123, v124 offset:54272
    ds_add_f32 v123, v125 offset:54276
    s_mov_b64 exec, -1
    s_cmp_le_u32 s15, 7
    s_cbranch_scc1 p2_nad1
    s_waitcnt lgkmcnt(15)
    v_ashrrev_i32 v122, 5, v69
    v_lshlrev_b16 v123, 2, v69
    v_cndmask_b32 v126, v42, v43, s[66:67]
    v_bitop3_b32 v122, v122, v113, v113 bitop3:0x0c
    v_lshlrev_b32 v124, 16, v126
    v_mul_f32 v122, v114, v122
    v_and_b32 v125, 0xffff0000, v126
    v_add_u32 v123, v123, v123
    v_mul_f32 v124, v122, v124
    v_mul_f32 v125, v122, v125
    v_cmpx_le_u32 vcc, 0x1000000, v69
    ds_add_f32 v123, v124 offset:54272
    ds_add_f32 v123, v125 offset:54276
    s_mov_b64 exec, -1
    v_ashrrev_i32 v122, 5, v70
    v_lshlrev_b16 v123, 2, v70
    v_cndmask_b32 v126, v44, v45, s[66:67]
    v_bitop3_b32 v122, v122, v113, v113 bitop3:0x0c
    v_lshlrev_b32 v124, 16, v126
    v_mul_f32 v122, v114, v122
    v_and_b32 v125, 0xffff0000, v126
    v_add_u32 v123, v123, v123
    v_mul_f32 v124, v122, v124
    v_mul_f32 v125, v122, v125
    v_cmpx_le_u32 vcc, 0x1000000, v70
    ds_add_f32 v123, v124 offset:54272
    ds_add_f32 v123, v125 offset:54276
    s_mov_b64 exec, -1
    v_ashrrev_i32 v122, 5, v71
    v_lshlrev_b16 v123, 2, v71
    v_cndmask_b32 v126, v46, v47, s[66:67]
    v_bitop3_b32 v122, v122, v113, v113 bitop3:0x0c
    v_lshlrev_b32 v124, 16, v126
    v_mul_f32 v122, v114, v122
    v_and_b32 v125, 0xffff0000, v126
    v_add_u32 v123, v123, v123
    v_mul_f32 v124, v122, v124
    v_mul_f32 v125, v122, v125
    v_cmpx_le_u32 vcc, 0x1000000, v71
    ds_add_f32 v123, v124 offset:54272
    ds_add_f32 v123, v125 offset:54276
    s_mov_b64 exec, -1
p2_nad1:
    s_branch p2_fin
p2_tail:
    s_mov_b32 s60, s61
    s_mov_b32 s15, s16
    s_mov_b32 s16, s17
    v_mov_b32 v122, s19
    s_xor_b32 s19, s19, 4
    ds_read_b32 v125, v122 offset:53760
    v_mov_b32 v123, s19
    v_mov_b32 v124, 0
    ds_write_b32 v123, v124 offset:53760
    s_waitcnt vmcnt(2)
    s_mov_b32 m0, s24
    s_cmp_ge_u32 s10, 9
    s_cbranch_scc1 p2_st2s1
    ds_write_addtid_b32 v84 offset:49152
    ds_write_addtid_b32 v85 offset:49408
p2_st2s1:
    s_mov_b32 m0, s23
    s_add_u32 s20, s20, 53760
    ds_write_addtid_b32 v72 offset:0
    ds_write_addtid_b32 v73 offset:256
    ds_write_addtid_b32 v74 offset:512
    ds_write_addtid_b32 v75 offset:768
    ds_write_addtid_b32 v76 offset:1024
    ds_write_addtid_b32 v77 offset:1280
    ds_write_addtid_b32 v78 offset:1536
    ds_write_addtid_b32 v79 offset:1792
    ds_write_addtid_b32 v80 offset:2048
    ds_write_addtid_b32 v81 offset:2304
    ds_write_addtid_b32 v82 offset:2560
    ds_write_addtid_b32 v83 offset:2816
    s_waitcnt lgkmcnt(0)
    s_barrier
    s_waitcnt lgkmcnt(13)
    v_readfirstlane_b32 s44, v125
    s_nop 0
    s_cmp_lg_u32 s44, 0
    s_cbranch_scc1 p2_advb
    s_add_u32 s61, s61, 1
    s_min_u32 s61, s61, 10
    v_mov_b32 v110, 0
    v_mov_b32 v111, 0
    s_cmp_eq_u32 s61, 10
    s_cbranch_scc1 p2_advb
    s_add_u32 s44, s61, s18
    s_cmp_ge_u32 s44, 10
    s_cselect_b32 s53, 10, 0
    s_sub_u32 s44, s44, s53
    s_mul_i32 s44, s44, 4160
    s_add_u32 s44, s44, s40
    v_lshrrev_b32 v110, 6, v112
    v_bfe_u32 v111, v112, 2, 4
    v_mul_u32_u24 v110, 665600, v110
    v_add_u32 v111, v110, v111
    buffer_load_dword v110, v111, s[4:7], s44 offen
    buffer_load_dword v111, v111, s[4:7], s44 offen offset:16
p2_advb:
    s_cmp_lg_u32 s10, 0
    s_cbranch_scc1 p2_ntg
    s_lshr_b32 s44, s2, 3
    s_mul_i32 s44, s44, 5120
    s_add_u32 s45, s60, s18
    s_cmp_ge_u32 s45, 10
    s_cselect_b32 s53, 10, 0
    s_sub_u32 s45, s45, s53
    s_mul_i32 s45, s45, 645120
    s_add_u32 s44, s44, s45
    s_add_u32 s44, s44, s62
    v_lshlrev_b32 v127, 3, v112
    s_mov_b32 exec_hi, 0xff
    buffer_load_dword v127, v127, s[4:7], s44 offen
    s_mov_b64 exec, -1
p2_ntg:
    s_cmp_ge_u32 s10, 9
    s_cbranch_scc1 p2_nm2m2a
    v_lshrrev_b32 v84, 1, v112
    s_add_u32 s44, s20, s42
    buffer_load_dwordx2 v[84:85], v84, s[4:7], s44 offen
p2_nm2m2a:
    buffer_load_dwordx4 v[72:75], v112, s[4:7], s20 offen offset:0
    buffer_load_dwordx4 v[76:79], v112, s[4:7], s20 offen offset:1024
    buffer_load_dwordx4 v[80:83], v112, s[4:7], s20 offen offset:2048
    v_cmpx_lt_i16 vcc, 0x3fff, v48
    ds_read_b64 v[0:1], v0
    s_mov_b64 exec, -1
    v_cmpx_lt_i16 vcc, 0x3fff, v49
    ds_read_b64 v[2:3], v2
    s_mov_b64 exec, -1
    v_cmpx_lt_i16 vcc, 0x3fff, v50
    ds_read_b64 v[4:5], v4
    s_mov_b64 exec, -1
    v_cmpx_lt_i16 vcc, 0x3fff, v51
    ds_read_b64 v[6:7], v6
    s_mov_b64 exec, -1
    v_cmpx_lt_i16 vcc, 0x3fff, v52
    ds_read_b64 v[8:9], v8
    s_mov_b64 exec, -1
    v_cmpx_lt_i16 vcc, 0x3fff, v53
    ds_read_b64 v[10:11], v10
    s_mov_b64 exec, -1
    v_cmpx_lt_i16 vcc, 0x3fff, v54
    ds_read_b64 v[12:13], v12
    s_mov_b64 exec, -1
    v_cmpx_lt_i16 vcc, 0x3fff, v55
    ds_read_b64 v[14:15], v14
    s_mov_b64 exec, -1
    v_cmpx_lt_i16 vcc, 0x3fff, v56
    ds_read_b64 v[16:17], v16
    s_mov_b64 exec, -1
    v_cmpx_lt_i16 vcc, 0x3fff, v57
    ds_read_b64 v[18:19], v18
    s_mov_b64 exec, -1
    v_cmpx_lt_i16 vcc, 0x3fff, v58
    ds_read_b64 v[20:21], v20
    s_mov_b64 exec, -1
    v_cmpx_lt_i16 vcc, 0x3fff, v59
    ds_read_b64 v[22:23], v22
    s_mov_b64 exec, -1
    v_lshrrev_b32 v94, 3, v108
    v_lshrrev_b32 v95, 18, v108
    v_and_b32 v108, 0x3fff, v108
    v_and_or_b32 v94, v94, s65, v95
    v_mad_u32_u24 v108, v94, s63, v108
    buffer_load_dwordx4 v[94:97], v108, s[68:71], 0 offen
    v_cmpx_lt_i16 vcc, 0x3fff, v60
    ds_read_b64 v[24:25], v24
    s_mov_b64 exec, -1
    v_cmpx_lt_i16 vcc, 0x3fff, v61
    ds_read_b64 v[26:27], v26
    s_mov_b64 exec, -1
    v_cmpx_lt_i16 vcc, 0x3fff, v62
    ds_read_b64 v[28:29], v28
    s_mov_b64 exec, -1
    v_cmpx_lt_i16 vcc, 0x3fff, v63
    ds_read_b64 v[30:31], v30
    s_mov_b64 exec, -1
    v_cmpx_lt_i16 vcc, 0x3fff, v64
    ds_read_b64 v[32:33], v32
    s_mov_b64 exec, -1
    v_cmpx_lt_i16 vcc, 0x3fff, v65
    ds_read_b64 v[34:35], v34
    s_mov_b64 exec, -1
    v_cmpx_lt_i16 vcc, 0x3fff, v66
    ds_read_b64 v[36:37], v36
    s_mov_b64 exec, -1
    v_cmpx_lt_i16 vcc, 0x3fff, v67
    ds_read_b64 v[38:39], v38
    s_mov_b64 exec, -1
    v_cmpx_lt_i16 vcc, 0x3fff, v68
    ds_read_b64 v[40:41], v40
    s_mov_b64 exec, -1
    s_cmp_le_u32 s15, 7
    s_cbranch_scc1 p2_g2r17
    v_cmpx_lt_i16 vcc, 0x3fff, v69
    ds_read_b64 v[42:43], v42
    s_mov_b64 exec, -1
    v_cmpx_lt_i16 vcc, 0x3fff, v70
    ds_read_b64 v[44:45], v44
    s_mov_b64 exec, -1
    v_cmpx_lt_i16 vcc, 0x3fff, v71
    ds_read_b64 v[46:47], v46
    s_mov_b64 exec, -1
p2_g2r17:
    v_lshrrev_b32 v98, 3, v109
    v_lshrrev_b32 v99, 18, v109
    v_and_b32 v109, 0x3fff, v109
    v_and_or_b32 v98, v98, s65, v99
    v_mad_u32_u24 v109, v98, s63, v109
    buffer_load_dwordx4 v[98:101], v109, s[68:71], 0 offen
    s_waitcnt lgkmcnt(0)
    s_barrier
    s_waitcnt vmcnt(2)
    s_mov_b32 m0, s24
    s_cmp_ge_u32 s10, 9
    s_cbranch_scc1 p2_st2s2
    ds_write_addtid_b32 v84 offset:49152
    ds_write_addtid_b32 v85 offset:49408
p2_st2s2:
    s_mov_b32 m0, s23
    s_add_u32 s20, s60, s18
    s_cmp_ge_u32 s20, 10
    s_cselect_b32 s53, 10, 0
    s_sub_u32 s20, s20, s53
    s_mul_i32 s20, s20, 645120
    s_add_u32 s20, s20, s62
    ds_write_addtid_b32 v72 offset:0
    ds_write_addtid_b32 v73 offset:256
    ds_write_addtid_b32 v74 offset:512
    ds_write_addtid_b32 v75 offset:768
    ds_write_addtid_b32 v76 offset:1024
    ds_write_addtid_b32 v77 offset:1280
    ds_write_addtid_b32 v78 offset:1536
    ds_write_addtid_b32 v79 offset:1792
    ds_write_addtid_b32 v80 offset:2048
    ds_write_addtid_b32 v81 offset:2304
    ds_write_addtid_b32 v82 offset:2560
    ds_write_addtid_b32 v83 offset:2816
    s_waitcnt lgkmcnt(0)
    s_barrier
    s_branch p2_top
p2_fin:
    s_waitcnt vmcnt(0) lgkmcnt(0)
    s_barrier
    s_mov_b32 s48, s11
    s_mul_i32 s44, s48, 800768
    s_mul_i32 s45, s12, 12512
    s_add_u32 s49, s44, s45
    s_lshl_b32 s44, s49, 3
    s_add_u32 s44, s44, 363410432
    s_lshl_b32 s48, s48, 2
    s_lshl_b32 s45, s12, 4
    s_add_u32 s48, s48, s45
    s_add_u32 s48, s48, 363409408
    v_add_u32 v123, s64, v112
    v_add_u32 v122, s25, v123
    v_mov_b32 v24, 0
    v_mov_b32 v25, 0
    v_mov_b32 v26, 0
    v_mov_b32 v27, 0
    v_cmp_gt_u32 vcc, 1792, v123
    v_mov_b32 v124, 0x38000000
    v_mov_b32 v126, 0
    v_cndmask_b32 v124, v124, v123, vcc
    ds_read_b128 v[0:3], v122 offset:0
    ds_read_b128 v[4:7], v122 offset:16384
    ds_read_b128 v[8:11], v122 offset:32768
    v_add_u32 v122, 49152, v122
    ds_read_b128 v[12:15], v122 offset:0
    ds_read_b128 v[16:19], v122 offset:16384
    ds_read_b128 v[20:23], v122 offset:32768
    s_mov_b64 exec, vcc
    ds_read_b128 v[24:27], v122 offset:49152
    s_mov_b64 exec, -1
    s_cmp_lg_u32 s21, 0
    s_cbranch_scc1 p2_finf
    s_waitcnt lgkmcnt(6)
    buffer_store_dwordx4 v[0:3], v123, s[4:7], s44 offen
    s_add_u32 s44, s44, 16384
    s_waitcnt lgkmcnt(5)
    buffer_store_dwordx4 v[4:7], v123, s[4:7], s44 offen
    s_add_u32 s44, s44, 16384
    s_waitcnt lgkmcnt(4)
    buffer_store_dwordx4 v[8:11], v123, s[4:7], s44 offen
    s_add_u32 s44, s44, 16384
    s_waitcnt lgkmcnt(3)
    buffer_store_dwordx4 v[12:15], v123, s[4:7], s44 offen
    s_add_u32 s44, s44, 16384
    s_waitcnt lgkmcnt(2)
    buffer_store_dwordx4 v[16:19], v123, s[4:7], s44 offen
    s_add_u32 s44, s44, 16384
    s_waitcnt lgkmcnt(1)
    buffer_store_dwordx4 v[20:23], v123, s[4:7], s44 offen
    s_add_u32 s44, s44, 16384
    s_waitcnt lgkmcnt(0)
    buffer_store_dwordx4 v[24:27], v124, s[4:7], s44 offen
    s_add_u32 s44, s44, 16384
    v_bitop3_b32 v115, v115, v0, v1 bitop3:0xfe
    v_bitop3_b32 v115, v115, v2, v3 bitop3:0xfe
    v_bitop3_b32 v115, v115, v4, v5 bitop3:0xfe
    v_bitop3_b32 v115, v115, v6, v7 bitop3:0xfe
    v_bitop3_b32 v115, v115, v8, v9 bitop3:0xfe
    v_bitop3_b32 v115, v115, v10, v11 bitop3:0xfe
    v_bitop3_b32 v115, v115, v12, v13 bitop3:0xfe
    v_bitop3_b32 v115, v115, v14, v15 bitop3:0xfe
    v_bitop3_b32 v115, v115, v16, v17 bitop3:0xfe
    v_bitop3_b32 v115, v115, v18, v19 bitop3:0xfe
    v_bitop3_b32 v115, v115, v20, v21 bitop3:0xfe
    v_bitop3_b32 v115, v115, v22, v23 bitop3:0xfe
    v_bitop3_b32 v115, v115, v24, v25 bitop3:0xfe
    v_bitop3_b32 v115, v115, v26, v27 bitop3:0xfe
    v_bitop3_b32 v115, v115, v116, v117 bitop3:0xfe
    v_bitop3_b32 v115, v115, v118, v119 bitop3:0xfe
    v_bitop3_b32 v115, v115, v120, v121 bitop3:0xfe
    v_and_b32 v115, 0x80008000, v115
    v_cmpx_ne_u32 vcc, 0, v115
    ds_write_b32 v126, v115 offset:53768
    s_mov_b64 exec, -1
    s_waitcnt lgkmcnt(0)
    s_barrier
    ds_read_b32 v125, v126 offset:53768
    s_waitcnt lgkmcnt(0)
    v_readfirstlane_b32 s45, v125
    s_nop 0
    s_cmp_eq_u32 s45, 0
    s_cbranch_scc1 p2_done
    s_mov_b32 s21, 1
    s_waitcnt vmcnt(0)
    s_branch p2_restart
p2_finf:
    s_lshl_b32 s49, s49, 4
    s_lshl_b32 s45, s21, 3
    s_add_u32 s49, s49, s45
    s_add_u32 s49, s49, 389035000
    v_mov_b32 v28, 1073758208
    v_mov_b32 v29, 1073758208
    v_mov_b32 v30, 1073758208
    v_mov_b32 v31, 1073758208
    v_lshlrev_b32 v122, 1, v123
    v_lshlrev_b32 v125, 1, v124
    s_waitcnt lgkmcnt(0)
    buffer_store_dwordx4 v[28:31], v123, s[4:7], s44 offen
    s_add_u32 s44, s44, 16384
    buffer_store_dwordx2 v[0:1], v122, s[4:7], s49 offen offset:0
    buffer_store_dwordx2 v[2:3], v122, s[4:7], s49 offen offset:16
    s_add_u32 s49, s49, 32768
    buffer_store_dwordx4 v[28:31], v123, s[4:7], s44 offen
    s_add_u32 s44, s44, 16384
    buffer_store_dwordx2 v[4:5], v122, s[4:7], s49 offen offset:0
    buffer_store_dwordx2 v[6:7], v122, s[4:7], s49 offen offset:16
    s_add_u32 s49, s49, 32768
    buffer_store_dwordx4 v[28:31], v123, s[4:7], s44 offen
    s_add_u32 s44, s44, 16384
    buffer_store_dwordx2 v[8:9], v122, s[4:7], s49 offen offset:0
    buffer_store_dwordx2 v[10:11], v122, s[4:7], s49 offen offset:16
    s_add_u32 s49, s49, 32768
    buffer_store_dwordx4 v[28:31], v123, s[4:7], s44 offen
    s_add_u32 s44, s44, 16384
    buffer_store_dwordx2 v[12:13], v122, s[4:7], s49 offen offset:0
    buffer_store_dwordx2 v[14:15], v122, s[4:7], s49 offen offset:16
    s_add_u32 s49, s49, 32768
    buffer_store_dwordx4 v[28:31], v123, s[4:7], s44 offen
    s_add_u32 s44, s44, 16384
    buffer_store_dwordx2 v[16:17], v122, s[4:7], s49 offen offset:0
    buffer_store_dwordx2 v[18:19], v122, s[4:7], s49 offen offset:16
    s_add_u32 s49, s49, 32768
    buffer_store_dwordx4 v[28:31], v123, s[4:7], s44 offen
    s_add_u32 s44, s44, 16384
    buffer_store_dwordx2 v[20:21], v122, s[4:7], s49 offen offset:0
    buffer_store_dwordx2 v[22:23], v122, s[4:7], s49 offen offset:16
    s_add_u32 s49, s49, 32768
    buffer_store_dwordx4 v[28:31], v124, s[4:7], s44 offen
    s_add_u32 s44, s44, 16384
    buffer_store_dwordx2 v[24:25], v125, s[4:7], s49 offen offset:0
    buffer_store_dwordx2 v[26:27], v125, s[4:7], s49 offen offset:16
    s_add_u32 s49, s49, 32768
    s_add_u32 s21, s21, 1
    s_mov_b32 s30, 0
    s_waitcnt vmcnt(0)
    s_cmp_eq_u32 s21, 2
    s_cbranch_scc1 p2_restart
p2_done:
    v_mov_b32 v125, s30
    buffer_store_dword v125, v126, s[4:7], s48 offen
p2_end:
    s_endpgm
.globl p3_kernel
.p2align 8
.type p3_kernel,@function
p3_kernel:
    s_cmp_ge_u32 s2, 1563
    s_cbranch_scc1 p3_end
    s_load_dwordx2 s[4:5], s[0:1], 0
    s_load_dwordx2 s[6:7], s[0:1], 24
    s_load_dwordx2 s[8:9], s[0:1], 40
    s_load_dwordx8 s[12:19], s[0:1], 56
    s_load_dwordx2 s[10:11], s[0:1], 88
    s_load_dwordx2 s[20:21], s[0:1], 104
    s_lshl_b32 s3, s2, 8
    v_add_u32 v0, s3, v0
    v_lshlrev_b32 v2, 4, v0
    v_lshlrev_b32 v3, 2, v0
    v_add_u32 v0, v0, v0
    v_mul_hi_u32_u24 v1, 343268, v0
    v_lshlrev_b16 v1, 4, v1
    s_waitcnt lgkmcnt(0)
    s_load_dwordx4 s[32:35], s[8:9], 0
    s_load_dwordx16 s[36:51], s[12:13], 0
    s_load_dwordx16 s[52:67], s[14:15], 0
    s_load_dwordx8 s[68:75], s[16:17], 0
    s_load_dwordx8 s[76:83], s[18:19], 0
    s_mov_b32 s24, s6
    s_and_b32 s25, s7, 0xffff
    s_mov_b32 s26, 1600000
    s_mov_b32 s27, 0x20000
    buffer_load_dword v4, v3, s[24:27], 0 offen
    s_mov_b32 s28, s20
    s_and_b32 s29, s21, 0xffff
    s_mov_b32 s30, 819200000
    s_mov_b32 s31, 0x20000
    s_mov_b32 s22, 363410432
    buffer_load_dwordx4 v[40:43], v2, s[28:31], s22 offen
    s_mov_b32 s22, 369816576
    buffer_load_dwordx4 v[44:47], v2, s[28:31], s22 offen
    s_mov_b32 s22, 376222720
    buffer_load_dwordx4 v[48:51], v2, s[28:31], s22 offen
    s_mov_b32 s22, 382628864
    buffer_load_dwordx4 v[52:55], v2, s[28:31], s22 offen
    s_mov_b32 s22, 363409408
    buffer_load_dwordx4 v[56:59], v1, s[28:31], s22 offen
    s_mov_b32 s24, s4
    s_and_b32 s25, s5, 0xffff
    s_mov_b32 s26, 6400000
    s_mov_b32 s27, 0x20000
    buffer_load_dwordx4 v[60:63], v2, s[24:27], 0 offen
    s_mov_b32 s24, s10
    s_and_b32 s25, s11, 0xffff
    s_mov_b32 s26, 6400000
    s_mov_b32 s27, 0x20000
    s_waitcnt vmcnt(6) lgkmcnt(0)
    v_and_b32 v5, 0xffff0000, v4
    v_lshlrev_b32 v4, 16, v4
    s_lshl_b32 s14, s32, 16
    s_and_b32 s15, s32, 0xffff0000
    v_pk_add_f32 v[8:9], v[4:5], s[14:15] op_sel:[0,0] op_sel_hi:[0,1] neg_lo:[0,1] neg_hi:[0,1]
    v_pk_add_f32 v[16:17], v[4:5], s[14:15] op_sel:[1,0] op_sel_hi:[1,1] neg_lo:[0,1] neg_hi:[0,1]
    s_lshl_b32 s16, s33, 16
    s_and_b32 s17, s33, 0xffff0000
    v_pk_add_f32 v[10:11], v[4:5], s[16:17] op_sel:[0,0] op_sel_hi:[0,1] neg_lo:[0,1] neg_hi:[0,1]
    v_pk_add_f32 v[18:19], v[4:5], s[16:17] op_sel:[1,0] op_sel_hi:[1,1] neg_lo:[0,1] neg_hi:[0,1]
    s_lshl_b32 s18, s34, 16
    s_and_b32 s19, s34, 0xffff0000
    v_pk_add_f32 v[12:13], v[4:5], s[18:19] op_sel:[0,0] op_sel_hi:[0,1] neg_lo:[0,1] neg_hi:[0,1]
    v_pk_add_f32 v[20:21], v[4:5], s[18:19] op_sel:[1,0] op_sel_hi:[1,1] neg_lo:[0,1] neg_hi:[0,1]
    s_lshl_b32 s12, s35, 16
    s_and_b32 s13, s35, 0xffff0000
    v_pk_add_f32 v[14:15], v[4:5], s[12:13] op_sel:[0,0] op_sel_hi:[0,1] neg_lo:[0,1] neg_hi:[0,1]
    v_pk_add_f32 v[22:23], v[4:5], s[12:13] op_sel:[1,0] op_sel_hi:[1,1] neg_lo:[0,1] neg_hi:[0,1]
    v_cvt_pk_bf16_f32 v8, v8, v9
    v_cvt_pk_bf16_f32 v10, v10, v11
    v_cvt_pk_bf16_f32 v12, v12, v13
    v_cvt_pk_bf16_f32 v14, v14, v15
    v_cvt_pk_bf16_f32 v16, v16, v17
    v_cvt_pk_bf16_f32 v18, v18, v19
    v_cvt_pk_bf16_f32 v20, v20, v21
    v_cvt_pk_bf16_f32 v22, v22, v23
    v_and_b32 v9, 0xffff0000, v8
    v_lshlrev_b32 v8, 16, v8
    v_and_b32 v11, 0xffff0000, v10
    v_lshlrev_b32 v10, 16, v10
    v_and_b32 v13, 0xffff0000, v12
    v_lshlrev_b32 v12, 16, v12
    v_and_b32 v15, 0xffff0000, v14
    v_lshlrev_b32 v14, 16, v14
    v_and_b32 v17, 0xffff0000, v16
    v_lshlrev_b32 v16, 16, v16
    v_and_b32 v19, 0xffff0000, v18
    v_lshlrev_b32 v18, 16, v18
    v_and_b32 v21, 0xffff0000, v20
    v_lshlrev_b32 v20, 16, v20
    v_and_b32 v23, 0xffff0000, v22
    v_lshlrev_b32 v22, 16, v22
    v_mul_f32 v8, v8, v8
    v_mul_f32 v9, v9, v9
    v_mul_f32 v10, v10, v10
    v_mul_f32 v11, v11, v11
    v_mul_f32 v12, v12, v12
    v_mul_f32 v13, v13, v13
    v_mul_f32 v14, v14, v14
    v_mul_f32 v15, v15, v15
    v_mul_f32 v16, v16, v16
    v_mul_f32 v17, v17, v17
    v_mul_f32 v18, v18, v18
    v_mul_f32 v19, v19, v19
    v_mul_f32 v20, v20, v20
    v_mul_f32 v21, v21, v21
    v_mul_f32 v22, v22, v22
    v_mul_f32 v23, v23, v23
    v_cvt_pk_bf16_f32 v8, v8, v9
    v_cvt_pk_bf16_f32 v10, v10, v11
    v_cvt_pk_bf16_f32 v12, v12, v13
    v_cvt_pk_bf16_f32 v14, v14, v15
    v_cvt_pk_bf16_f32 v16, v16, v17
    v_cvt_pk_bf16_f32 v18, v18, v19
    v_cvt_pk_bf16_f32 v20, v20, v21
    v_cvt_pk_bf16_f32 v22, v22, v23
    v_and_b32 v9, 0xffff0000, v8
    v_lshlrev_b32 v8, 16, v8
    v_and_b32 v11, 0xffff0000, v10
    v_lshlrev_b32 v10, 16, v10
    v_and_b32 v13, 0xffff0000, v12
    v_lshlrev_b32 v12, 16, v12
    v_and_b32 v15, 0xffff0000, v14
    v_lshlrev_b32 v14, 16, v14
    v_and_b32 v17, 0xffff0000, v16
    v_lshlrev_b32 v16, 16, v16
    v_and_b32 v19, 0xffff0000, v18
    v_lshlrev_b32 v18, 16, v18
    v_and_b32 v21, 0xffff0000, v20
    v_lshlrev_b32 v20, 16, v20
    v_and_b32 v23, 0xffff0000, v22
    v_lshlrev_b32 v22, 16, v22
    v_mul_f32 v8, 0xc1200000, v8
    v_mul_f32 v9, 0xc1200000, v9
    v_mul_f32 v10, 0xc1200000, v10
    v_mul_f32 v11, 0xc1200000, v11
    v_mul_f32 v12, 0xc1200000, v12
    v_mul_f32 v13, 0xc1200000, v13
    v_mul_f32 v14, 0xc1200000, v14
    v_mul_f32 v15, 0xc1200000, v15
    v_mul_f32 v16, 0xc1200000, v16
    v_mul_f32 v17, 0xc1200000, v17
    v_mul_f32 v18, 0xc1200000, v18
    v_mul_f32 v19, 0xc1200000, v19
    v_mul_f32 v20, 0xc1200000, v20
    v_mul_f32 v21, 0xc1200000, v21
    v_mul_f32 v22, 0xc1200000, v22
    v_mul_f32 v23, 0xc1200000, v23
    v_cvt_pk_bf16_f32 v8, v8, v9
    v_cvt_pk_bf16_f32 v10, v10, v11
    v_cvt_pk_bf16_f32 v12, v12, v13
    v_cvt_pk_bf16_f32 v14, v14, v15
    v_cvt_pk_bf16_f32 v16, v16, v17
    v_cvt_pk_bf16_f32 v18, v18, v19
    v_cvt_pk_bf16_f32 v20, v20, v21
    v_cvt_pk_bf16_f32 v22, v22, v23
    v_and_b32 v9, 0xffff0000, v8
    v_lshlrev_b32 v8, 16, v8
    v_and_b32 v11, 0xffff0000, v10
    v_lshlrev_b32 v10, 16, v10
    v_and_b32 v13, 0xffff0000, v12
    v_lshlrev_b32 v12, 16, v12
    v_and_b32 v15, 0xffff0000, v14
    v_lshlrev_b32 v14, 16, v14
    v_and_b32 v17, 0xffff0000, v16
    v_lshlrev_b32 v16, 16, v16
    v_and_b32 v19, 0xffff0000, v18
    v_lshlrev_b32 v18, 16, v18
    v_and_b32 v21, 0xffff0000, v20
    v_lshlrev_b32 v20, 16, v20
    v_and_b32 v23, 0xffff0000, v22
    v_lshlrev_b32 v22, 16, v22
    v_mul_f32 v8, 0x3fb8aa3b, v8
    v_mul_f32 v9, 0x3fb8aa3b, v9
    v_mul_f32 v10, 0x3fb8aa3b, v10
    v_mul_f32 v11, 0x3fb8aa3b, v11
    v_mul_f32 v12, 0x3fb8aa3b, v12
    v_mul_f32 v13, 0x3fb8aa3b, v13
    v_mul_f32 v14, 0x3fb8aa3b, v14
    v_mul_f32 v15, 0x3fb8aa3b, v15
    v_mul_f32 v16, 0x3fb8aa3b, v16
    v_mul_f32 v17, 0x3fb8aa3b, v17
    v_mul_f32 v18, 0x3fb8aa3b, v18
    v_mul_f32 v19, 0x3fb8aa3b, v19
    v_mul_f32 v20, 0x3fb8aa3b, v20
    v_mul_f32 v21, 0x3fb8aa3b, v21
    v_mul_f32 v22, 0x3fb8aa3b, v22
    v_mul_f32 v23, 0x3fb8aa3b, v23
    v_exp_f32 v8, v8
    v_exp_f32 v9, v9
    v_exp_f32 v10, v10
    v_exp_f32 v11, v11
    v_exp_f32 v12, v12
    v_exp_f32 v13, v13
    v_exp_f32 v14, v14
    v_exp_f32 v15, v15
    v_exp_f32 v16, v16
    v_exp_f32 v17, v17
    v_exp_f32 v18, v18
    v_exp_f32 v19, v19
    v_exp_f32 v20, v20
    v_exp_f32 v21, v21
    v_exp_f32 v22, v22
    v_exp_f32 v23, v23
    s_nop 0
    v_cvt_pk_bf16_f32 v8, v8, v9
    v_cvt_pk_bf16_f32 v10, v10, v11
    v_cvt_pk_bf16_f32 v12, v12, v13
    v_cvt_pk_bf16_f32 v14, v14, v15
    v_cvt_pk_bf16_f32 v16, v16, v17
    v_cvt_pk_bf16_f32 v18, v18, v19
    v_cvt_pk_bf16_f32 v20, v20, v21
    v_cvt_pk_bf16_f32 v22, v22, v23
    v_and_b32 v9, 0xffff0000, v8
    v_lshlrev_b32 v8, 16, v8
    v_and_b32 v11, 0xffff0000, v10
    v_lshlrev_b32 v10, 16, v10
    v_and_b32 v13, 0xffff0000, v12
    v_lshlrev_b32 v12, 16, v12
    v_and_b32 v15, 0xffff0000, v14
    v_lshlrev_b32 v14, 16, v14
    v_and_b32 v17, 0xffff0000, v16
    v_lshlrev_b32 v16, 16, v16
    v_and_b32 v19, 0xffff0000, v18
    v_lshlrev_b32 v18, 16, v18
    v_and_b32 v21, 0xffff0000, v20
    v_lshlrev_b32 v20, 16, v20
    v_and_b32 v23, 0xffff0000, v22
    v_lshlrev_b32 v22, 16, v22
    s_lshl_b32 s14, s52, 16
    s_and_b32 s15, s52, 0xffff0000
    v_pk_mul_f32 v[24:25], v[8:9], s[14:15] op_sel:[0,0] op_sel_hi:[0,1]
    v_pk_mul_f32 v[28:29], v[16:17], s[14:15] op_sel:[0,0] op_sel_hi:[0,1]
    s_lshl_b32 s16, s53, 16
    s_and_b32 s17, s53, 0xffff0000
    v_pk_mul_f32 v[26:27], v[8:9], s[16:17] op_sel:[0,0] op_sel_hi:[0,1]
    v_pk_mul_f32 v[30:31], v[16:17], s[16:17] op_sel:[0,0] op_sel_hi:[0,1]
    s_lshl_b32 s18, s54, 16
    s_and_b32 s19, s54, 0xffff0000
    v_pk_fma_f32 v[24:25], v[8:9], s[18:19], v[24:25] op_sel:[1,0,0] op_sel_hi:[1,1,1]
    v_pk_fma_f32 v[28:29], v[16:17], s[18:19], v[28:29] op_sel:[1,0,0] op_sel_hi:[1,1,1]
    s_lshl_b32 s12, s55, 16
    s_and_b32 s13, s55, 0xffff0000
    v_pk_fma_f32 v[26:27], v[8:9], s[12:13], v[26:27] op_sel:[1,0,0] op_sel_hi:[1,1,1]
    v_pk_fma_f32 v[30:31], v[16:17], s[12:13], v[30:31] op_sel:[1,0,0] op_sel_hi:[1,1,1]
    s_lshl_b32 s14, s56, 16
    s_and_b32 s15, s56, 0xffff0000
    v_pk_fma_f32 v[24:25], v[10:11], s[14:15], v[24:25] op_sel:[0,0,0] op_sel_hi:[0,1,1]
    v_pk_fma_f32 v[28:29], v[18:19], s[14:15], v[28:29] op_sel:[0,0,0] op_sel_hi:[0,1,1]
    s_lshl_b32 s16, s57, 16
    s_and_b32 s17, s57, 0xffff0000
    v_pk_fma_f32 v[26:27], v[10:11], s[16:17], v[26:27] op_sel:[0,0,0] op_sel_hi:[0,1,1]
    v_pk_fma_f32 v[30:31], v[18:19], s[16:17], v[30:31] op_sel:[0,0,0] op_sel_hi:[0,1,1]
    s_lshl_b32 s18, s58, 16
    s_and_b32 s19, s58, 0xffff0000
    v_pk_fma_f32 v[24:25], v[10:11], s[18:19], v[24:25] op_sel:[1,0,0] op_sel_hi:[1,1,1]
    v_pk_fma_f32 v[28:29], v[18:19], s[18:19], v[28:29] op_sel:[1,0,0] op_sel_hi:[1,1,1]
    s_lshl_b32 s12, s59, 16
    s_and_b32 s13, s59, 0xffff0000
    v_pk_fma_f32 v[26:27], v[10:11], s[12:13], v[26:27] op_sel:[1,0,0] op_sel_hi:[1,1,1]
    v_pk_fma_f32 v[30:31], v[18:19], s[12:13], v[30:31] op_sel:[1,0,0] op_sel_hi:[1,1,1]
    s_lshl_b32 s14, s60, 16
    s_and_b32 s15, s60, 0xffff0000
    v_pk_fma_f32 v[24:25], v[12:13], s[14:15], v[24:25] op_sel:[0,0,0] op_sel_hi:[0,1,1]
    v_pk_fma_f32 v[28:29], v[20:21], s[14:15], v[28:29] op_sel:[0,0,0] op_sel_hi:[0,1,1]
    s_lshl_b32 s16, s61, 16
    s_and_b32 s17, s61, 0xffff0000
    v_pk_fma_f32 v[26:27], v[12:13], s[16:17], v[26:27] op_sel:[0,0,0] op_sel_hi:[0,1,1]
    v_pk_fma_f32 v[30:31], v[20:21], s[16:17], v[30:31] op_sel:[0,0,0] op_sel_hi:[0,1,1]
    s_lshl_b32 s18, s62, 16
    s_and_b32 s19, s62, 0xffff0000
    v_pk_fma_f32 v[24:25], v[12:13], s[18:19], v[24:25] op_sel:[1,0,0] op_sel_hi:[1,1,1]
    v_pk_fma_f32 v[28:29], v[20:21], s[18:19], v[28:29] op_sel:[1,0,0] op_sel_hi:[1,1,1]
    s_lshl_b32 s12, s63, 16
    s_and_b32 s13, s63, 0xffff0000
    v_pk_fma_f32 v[26:27], v[12:13], s[12:13], v[26:27] op_sel:[1,0,0] op_sel_hi:[1,1,1]
    v_pk_fma_f32 v[30:31], v[20:21], s[12:13], v[30:31] op_sel:[1,0,0] op_sel_hi:[1,1,1]
    s_lshl_b32 s14, s64, 16
    s_and_b32 s15, s64, 0xffff0000
    v_pk_fma_f32 v[24:25], v[14:15], s[14:15], v[24:25] op_sel:[0,0,0] op_sel_hi:[0,1,1]
    v_pk_fma_f32 v[28:29], v[22:23], s[14:15], v[28:29] op_sel:[0,0,0] op_sel_hi:[0,1,1]
    s_lshl_b32 s16, s65, 16
    s_and_b32 s17, s65, 0xffff0000
    v_pk_fma_f32 v[26:27], v[14:15], s[16:17], v[26:27] op_sel:[0,0,0] op_sel_hi:[0,1,1]
    v_pk_fma_f32 v[30:31], v[22:23], s[16:17], v[30:31] op_sel:[0,0,0] op_sel_hi:[0,1,1]
    s_lshl_b32 s18, s66, 16
    s_and_b32 s19, s66, 0xffff0000
    v_pk_fma_f32 v[24:25], v[14:15], s[18:19], v[24:25] op_sel:[1,0,0] op_sel_hi:[1,1,1]
    v_pk_fma_f32 v[28:29], v[22:23], s[18:19], v[28:29] op_sel:[1,0,0] op_sel_hi:[1,1,1]
    s_lshl_b32 s12, s67, 16
    s_and_b32 s13, s67, 0xffff0000
    v_pk_fma_f32 v[26:27], v[14:15], s[12:13], v[26:27] op_sel:[1,0,0] op_sel_hi:[1,1,1]
    v_pk_fma_f32 v[30:31], v[22:23], s[12:13], v[30:31] op_sel:[1,0,0] op_sel_hi:[1,1,1]
    s_lshl_b32 s14, s36, 16
    s_and_b32 s15, s36, 0xffff0000
    v_pk_mul_f32 v[32:33], v[8:9], s[14:15] op_sel:[0,0] op_sel_hi:[0,1]
    v_pk_mul_f32 v[36:37], v[16:17], s[14:15] op_sel:[0,0] op_sel_hi:[0,1]
    s_lshl_b32 s16, s37, 16
    s_and_b32 s17, s37, 0xffff0000
    v_pk_mul_f32 v[34:35], v[8:9], s[16:17] op_sel:[0,0] op_sel_hi:[0,1]
    v_pk_mul_f32 v[38:39], v[16:17], s[16:17] op_sel:[0,0] op_sel_hi:[0,1]
    s_lshl_b32 s18, s38, 16
    s_and_b32 s19, s38, 0xffff0000
    v_pk_fma_f32 v[32:33], v[8:9], s[18:19], v[32:33] op_sel:[1,0,0] op_sel_hi:[1,1,1]
    v_pk_fma_f32 v[36:37], v[16:17], s[18:19], v[36:37] op_sel:[1,0,0] op_sel_hi:[1,1,1]
    s_lshl_b32 s12, s39, 16
    s_and_b32 s13, s39, 0xffff0000
    v_pk_fma_f32 v[34:35], v[8:9], s[12:13], v[34:35] op_sel:[1,0,0] op_sel_hi:[1,1,1]
    v_pk_fma_f32 v[38:39], v[16:17], s[12:13], v[38:39] op_sel:[1,0,0] op_sel_hi:[1,1,1]
    s_lshl_b32 s14, s40, 16
    s_and_b32 s15, s40, 0xffff0000
    v_pk_fma_f32 v[32:33], v[10:11], s[14:15], v[32:33] op_sel:[0,0,0] op_sel_hi:[0,1,1]
    v_pk_fma_f32 v[36:37], v[18:19], s[14:15], v[36:37] op_sel:[0,0,0] op_sel_hi:[0,1,1]
    s_lshl_b32 s16, s41, 16
    s_and_b32 s17, s41, 0xffff0000
    v_pk_fma_f32 v[34:35], v[10:11], s[16:17], v[34:35] op_sel:[0,0,0] op_sel_hi:[0,1,1]
    v_pk_fma_f32 v[38:39], v[18:19], s[16:17], v[38:39] op_sel:[0,0,0] op_sel_hi:[0,1,1]
    s_lshl_b32 s18, s42, 16
    s_and_b32 s19, s42, 0xffff0000
    v_pk_fma_f32 v[32:33], v[10:11], s[18:19], v[32:33] op_sel:[1,0,0] op_sel_hi:[1,1,1]
    v_pk_fma_f32 v[36:37], v[18:19], s[18:19], v[36:37] op_sel:[1,0,0] op_sel_hi:[1,1,1]
    s_lshl_b32 s12, s43, 16
    s_and_b32 s13, s43, 0xffff0000
    v_pk_fma_f32 v[34:35], v[10:11], s[12:13], v[34:35] op_sel:[1,0,0] op_sel_hi:[1,1,1]
    v_pk_fma_f32 v[38:39], v[18:19], s[12:13], v[38:39] op_sel:[1,0,0] op_sel_hi:[1,1,1]
    s_lshl_b32 s14, s44, 16
    s_and_b32 s15, s44, 0xffff0000
    v_pk_fma_f32 v[32:33], v[12:13], s[14:15], v[32:33] op_sel:[0,0,0] op_sel_hi:[0,1,1]
    v_pk_fma_f32 v[36:37], v[20:21], s[14:15], v[36:37] op_sel:[0,0,0] op_sel_hi:[0,1,1]
    s_lshl_b32 s16, s45, 16
    s_and_b32 s17, s45, 0xffff0000
    v_pk_fma_f32 v[34:35], v[12:13], s[16:17], v[34:35] op_sel:[0,0,0] op_sel_hi:[0,1,1]
    v_pk_fma_f32 v[38:39], v[20:21], s[16:17], v[38:39] op_sel:[0,0,0] op_sel_hi:[0,1,1]
    s_lshl_b32 s18, s46, 16
    s_and_b32 s19, s46, 0xffff0000
    v_pk_fma_f32 v[32:33], v[12:13], s[18:19], v[32:33] op_sel:[1,0,0] op_sel_hi:[1,1,1]
    v_pk_fma_f32 v[36:37], v[20:21], s[18:19], v[36:37] op_sel:[1,0,0] op_sel_hi:[1,1,1]
    s_lshl_b32 s12, s47, 16
    s_and_b32 s13, s47, 0xffff0000
    v_pk_fma_f32 v[34:35], v[12:13], s[12:13], v[34:35] op_sel:[1,0,0] op_sel_hi:[1,1,1]
    v_pk_fma_f32 v[38:39], v[20:21], s[12:13], v[38:39] op_sel:[1,0,0] op_sel_hi:[1,1,1]
    s_lshl_b32 s14, s48, 16
    s_and_b32 s15, s48, 0xffff0000
    v_pk_fma_f32 v[32:33], v[14:15], s[14:15], v[32:33] op_sel:[0,0,0] op_sel_hi:[0,1,1]
    v_pk_fma_f32 v[36:37], v[22:23], s[14:15], v[36:37] op_sel:[0,0,0] op_sel_hi:[0,1,1]
    s_lshl_b32 s16, s49, 16
    s_and_b32 s17, s49, 0xffff0000
    v_pk_fma_f32 v[34:35], v[14:15], s[16:17], v[34:35] op_sel:[0,0,0] op_sel_hi:[0,1,1]
    v_pk_fma_f32 v[38:39], v[22:23], s[16:17], v[38:39] op_sel:[0,0,0] op_sel_hi:[0,1,1]
    s_lshl_b32 s18, s50, 16
    s_and_b32 s19, s50, 0xffff0000
    v_pk_fma_f32 v[32:33], v[14:15], s[18:19], v[32:33] op_sel:[1,0,0] op_sel_hi:[1,1,1]
    v_pk_fma_f32 v[36:37], v[22:23], s[18:19], v[36:37] op_sel:[1,0,0] op_sel_hi:[1,1,1]
    s_lshl_b32 s12, s51, 16
    s_and_b32 s13, s51, 0xffff0000
    v_pk_fma_f32 v[34:35], v[14:15], s[12:13], v[34:35] op_sel:[1,0,0] op_sel_hi:[1,1,1]
    v_pk_fma_f32 v[38:39], v[22:23], s[12:13], v[38:39] op_sel:[1,0,0] op_sel_hi:[1,1,1]
    v_cvt_pk_bf16_f32 v32, v32, v33
    v_cvt_pk_bf16_f32 v34, v34, v35
    v_cvt_pk_bf16_f32 v36, v36, v37
    v_cvt_pk_bf16_f32 v38, v38, v39
    v_and_b32 v33, 0xffff0000, v32
    v_lshlrev_b32 v32, 16, v32
    v_and_b32 v35, 0xffff0000, v34
    v_lshlrev_b32 v34, 16, v34
    v_and_b32 v37, 0xffff0000, v36
    v_lshlrev_b32 v36, 16, v36
    v_and_b32 v39, 0xffff0000, v38
    v_lshlrev_b32 v38, 16, v38
    s_waitcnt vmcnt(1)
    v_add_u32 v40, v40, v44
    v_add_u32 v48, v48, v52
    v_add_u32 v41, v41, v45
    v_add_u32 v49, v49, v53
    v_add_u32 v42, v42, v46
    v_add_u32 v50, v50, v54
    v_add_u32 v43, v43, v47
    v_add_u32 v51, v51, v55
    v_add_u32_sdwa v8, v40, v48 dst_sel:DWORD dst_unused:UNUSED_PAD src0_sel:WORD_0 src1_sel:WORD_0
    v_add_u32_sdwa v9, v40, v48 dst_sel:DWORD dst_unused:UNUSED_PAD src0_sel:WORD_1 src1_sel:WORD_1
    v_add_u32_sdwa v10, v41, v49 dst_sel:DWORD dst_unused:UNUSED_PAD src0_sel:WORD_0 src1_sel:WORD_0
    v_add_u32_sdwa v11, v41, v49 dst_sel:DWORD dst_unused:UNUSED_PAD src0_sel:WORD_1 src1_sel:WORD_1
    v_add_u32_sdwa v12, v42, v50 dst_sel:DWORD dst_unused:UNUSED_PAD src0_sel:WORD_0 src1_sel:WORD_0
    v_add_u32_sdwa v13, v42, v50 dst_sel:DWORD dst_unused:UNUSED_PAD src0_sel:WORD_1 src1_sel:WORD_1
    v_add_u32_sdwa v14, v43, v51 dst_sel:DWORD dst_unused:UNUSED_PAD src0_sel:WORD_0 src1_sel:WORD_0
    v_add_u32_sdwa v15, v43, v51 dst_sel:DWORD dst_unused:UNUSED_PAD src0_sel:WORD_1 src1_sel:WORD_1
    v_min3_u32 v5, v56, v57, v58
    v_bitop3_b32 v4, v56, v57, v58 bitop3:0xfe
    v_min_u32 v5, v5, v59
    v_or_b32 v4, v4, v59
    v_or_b32 v8, 0x4b000000, v8
    v_or_b32 v9, 0x4b000000, v9
    v_or_b32 v10, 0x4b000000, v10
    v_or_b32 v11, 0x4b000000, v11
    v_or_b32 v12, 0x4b000000, v12
    v_or_b32 v13, 0x4b000000, v13
    v_or_b32 v14, 0x4b000000, v14
    v_or_b32 v15, 0x4b000000, v15
    v_cmp_eq_u32 vcc, 0, v5
    v_add_f32 v8, 0xcb010000, v8
    v_add_f32 v9, 0xcb010000, v9
    v_add_f32 v10, 0xcb010000, v10
    v_add_f32 v11, 0xcb010000, v11
    v_add_f32 v12, 0xcb010000, v12
    v_add_f32 v13, 0xcb010000, v13
    v_add_f32 v14, 0xcb010000, v14
    v_add_f32 v15, 0xcb010000, v15
    v_mul_f32 v8, v4, v8
    v_mul_f32 v9, v4, v9
    v_mul_f32 v10, v4, v10
    v_mul_f32 v11, v4, v11
    v_mul_f32 v12, v4, v12
    v_mul_f32 v13, v4, v13
    v_mul_f32 v14, v4, v14
    v_mul_f32 v15, v4, v15
    s_cbranch_vccz p3_nof
    v_lshlrev_b32 v1, 4, v0
    v_mov_b32 v3, 0x70000000
    v_cmp_eq_u32 vcc, 0, v56
    s_mov_b32 s22, 389035008
    s_nop 0
    v_cndmask_b32 v5, v3, v1, vcc
    buffer_load_dwordx4 v[16:19], v5, s[28:31], s22 offen
    buffer_load_dwordx4 v[20:23], v5, s[28:31], s22 offen offset:16
    s_waitcnt vmcnt(0)
    v_add_f32 v8, v8, v16
    v_add_f32 v9, v9, v17
    v_add_f32 v10, v10, v18
    v_add_f32 v11, v11, v19
    v_add_f32 v12, v12, v20
    v_add_f32 v13, v13, v21
    v_add_f32 v14, v14, v22
    v_add_f32 v15, v15, v23
    v_cmp_eq_u32 vcc, 0, v57
    s_mov_b32 s22, 401847296
    s_nop 0
    v_cndmask_b32 v5, v3, v1, vcc
    buffer_load_dwordx4 v[16:19], v5, s[28:31], s22 offen
    buffer_load_dwordx4 v[20:23], v5, s[28:31], s22 offen offset:16
    s_waitcnt vmcnt(0)
    v_add_f32 v8, v8, v16
    v_add_f32 v9, v9, v17
    v_add_f32 v10, v10, v18
    v_add_f32 v11, v11, v19
    v_add_f32 v12, v12, v20
    v_add_f32 v13, v13, v21
    v_add_f32 v14, v14, v22
    v_add_f32 v15, v15, v23
    v_cmp_eq_u32 vcc, 0, v58
    s_mov_b32 s22, 414659584
    s_nop 0
    v_cndmask_b32 v5, v3, v1, vcc
    buffer_load_dwordx4 v[16:19], v5, s[28:31], s22 offen
    buffer_load_dwordx4 v[20:23], v5, s[28:31], s22 offen offset:16
    s_waitcnt vmcnt(0)
    v_add_f32 v8, v8, v16
    v_add_f32 v9, v9, v17
    v_add_f32 v10, v10, v18
    v_add_f32 v11, v11, v19
    v_add_f32 v12, v12, v20
    v_add_f32 v13, v13, v21
    v_add_f32 v14, v14, v22
    v_add_f32 v15, v15, v23
    v_cmp_eq_u32 vcc, 0, v59
    s_mov_b32 s22, 427471872
    s_nop 0
    v_cndmask_b32 v5, v3, v1, vcc
    buffer_load_dwordx4 v[16:19], v5, s[28:31], s22 offen
    buffer_load_dwordx4 v[20:23], v5, s[28:31], s22 offen offset:16
    s_waitcnt vmcnt(0)
    v_add_f32 v8, v8, v16
    v_add_f32 v9, v9, v17
    v_add_f32 v10, v10, v18
    v_add_f32 v11, v11, v19
    v_add_f32 v12, v12, v20
    v_add_f32 v13, v13, v21
    v_add_f32 v14, v14, v22
    v_add_f32 v15, v15, v23
p3_nof:
    s_lshl_b32 s14, s68, 16
    s_and_b32 s15, s68, 0xffff0000
    v_pk_mul_f32 v[16:17], v[8:9], s[14:15] op_sel:[0,0] op_sel_hi:[0,1]
    v_pk_mul_f32 v[20:21], v[12:13], s[14:15] op_sel:[0,0] op_sel_hi:[0,1]
    s_lshl_b32 s16, s69, 16
    s_and_b32 s17, s69, 0xffff0000
    v_pk_mul_f32 v[18:19], v[8:9], s[16:17] op_sel:[0,0] op_sel_hi:[0,1]
    v_pk_mul_f32 v[22:23], v[12:13], s[16:17] op_sel:[0,0] op_sel_hi:[0,1]
    s_lshl_b32 s18, s70, 16
    s_and_b32 s19, s70, 0xffff0000
    v_pk_fma_f32 v[16:17], v[8:9], s[18:19], v[16:17] op_sel:[1,0,0] op_sel_hi:[1,1,1]
    v_pk_fma_f32 v[20:21], v[12:13], s[18:19], v[20:21] op_sel:[1,0,0] op_sel_hi:[1,1,1]
    s_lshl_b32 s12, s71, 16
    s_and_b32 s13, s71, 0xffff0000
    v_pk_fma_f32 v[18:19], v[8:9], s[12:13], v[18:19] op_sel:[1,0,0] op_sel_hi:[1,1,1]
    v_pk_fma_f32 v[22:23], v[12:13], s[12:13], v[22:23] op_sel:[1,0,0] op_sel_hi:[1,1,1]
    s_lshl_b32 s14, s72, 16
    s_and_b32 s15, s72, 0xffff0000
    v_pk_fma_f32 v[16:17], v[10:11], s[14:15], v[16:17] op_sel:[0,0,0] op_sel_hi:[0,1,1]
    v_pk_fma_f32 v[20:21], v[14:15], s[14:15], v[20:21] op_sel:[0,0,0] op_sel_hi:[0,1,1]
    s_lshl_b32 s16, s73, 16
    s_and_b32 s17, s73, 0xffff0000
    v_pk_fma_f32 v[18:19], v[10:11], s[16:17], v[18:19] op_sel:[0,0,0] op_sel_hi:[0,1,1]
    v_pk_fma_f32 v[22:23], v[14:15], s[16:17], v[22:23] op_sel:[0,0,0] op_sel_hi:[0,1,1]
    s_lshl_b32 s18, s74, 16
    s_and_b32 s19, s74, 0xffff0000
    v_pk_fma_f32 v[16:17], v[10:11], s[18:19], v[16:17] op_sel:[1,0,0] op_sel_hi:[1,1,1]
    v_pk_fma_f32 v[20:21], v[14:15], s[18:19], v[20:21] op_sel:[1,0,0] op_sel_hi:[1,1,1]
    s_lshl_b32 s12, s75, 16
    s_and_b32 s13, s75, 0xffff0000
    v_pk_fma_f32 v[18:19], v[10:11], s[12:13], v[18:19] op_sel:[1,0,0] op_sel_hi:[1,1,1]
    v_pk_fma_f32 v[22:23], v[14:15], s[12:13], v[22:23] op_sel:[1,0,0] op_sel_hi:[1,1,1]
    v_mul_f32 v24, v24, v16
    v_mul_f32 v25, v25, v17
    v_mul_f32 v26, v26, v18
    v_mul_f32 v27, v27, v19
    v_mul_f32 v28, v28, v20
    v_mul_f32 v29, v29, v21
    v_mul_f32 v30, v30, v22
    v_mul_f32 v31, v31, v23
    v_cvt_pk_bf16_f32 v24, v24, v25
    v_cvt_pk_bf16_f32 v26, v26, v27
    v_cvt_pk_bf16_f32 v28, v28, v29
    v_cvt_pk_bf16_f32 v30, v30, v31
    v_and_b32 v25, 0xffff0000, v24
    v_lshlrev_b32 v24, 16, v24
    v_and_b32 v27, 0xffff0000, v26
    v_lshlrev_b32 v26, 16, v26
    v_and_b32 v29, 0xffff0000, v28
    v_lshlrev_b32 v28, 16, v28
    v_and_b32 v31, 0xffff0000, v30
    v_lshlrev_b32 v30, 16, v30
    s_lshl_b32 s14, s76, 16
    s_and_b32 s15, s76, 0xffff0000
    v_pk_mul_f32 v[16:17], v[24:25], s[14:15] op_sel:[0,0] op_sel_hi:[0,1]
    v_pk_mul_f32 v[20:21], v[28:29], s[14:15] op_sel:[0,0] op_sel_hi:[0,1]
    s_lshl_b32 s16, s77, 16
    s_and_b32 s17, s77, 0xffff0000
    v_pk_mul_f32 v[18:19], v[24:25], s[16:17] op_sel:[0,0] op_sel_hi:[0,1]
    v_pk_mul_f32 v[22:23], v[28:29], s[16:17] op_sel:[0,0] op_sel_hi:[0,1]
    s_lshl_b32 s18, s78, 16
    s_and_b32 s19, s78, 0xffff0000
    v_pk_fma_f32 v[16:17], v[24:25], s[18:19], v[16:17] op_sel:[1,0,0] op_sel_hi:[1,1,1]
    v_pk_fma_f32 v[20:21], v[28:29], s[18:19], v[20:21] op_sel:[1,0,0] op_sel_hi:[1,1,1]
    s_lshl_b32 s12, s79, 16
    s_and_b32 s13, s79, 0xffff0000
    v_pk_fma_f32 v[18:19], v[24:25], s[12:13], v[18:19] op_sel:[1,0,0] op_sel_hi:[1,1,1]
    v_pk_fma_f32 v[22:23], v[28:29], s[12:13], v[22:23] op_sel:[1,0,0] op_sel_hi:[1,1,1]
    s_lshl_b32 s14, s80, 16
    s_and_b32 s15, s80, 0xffff0000
    v_pk_fma_f32 v[16:17], v[26:27], s[14:15], v[16:17] op_sel:[0,0,0] op_sel_hi:[0,1,1]
    v_pk_fma_f32 v[20:21], v[30:31], s[14:15], v[20:21] op_sel:[0,0,0] op_sel_hi:[0,1,1]
    s_lshl_b32 s16, s81, 16
    s_and_b32 s17, s81, 0xffff0000
    v_pk_fma_f32 v[18:19], v[26:27], s[16:17], v[18:19] op_sel:[0,0,0] op_sel_hi:[0,1,1]
    v_pk_fma_f32 v[22:23], v[30:31], s[16:17], v[22:23] op_sel:[0,0,0] op_sel_hi:[0,1,1]
    s_lshl_b32 s18, s82, 16
    s_and_b32 s19, s82, 0xffff0000
    v_pk_fma_f32 v[16:17], v[26:27], s[18:19], v[16:17] op_sel:[1,0,0] op_sel_hi:[1,1,1]
    v_pk_fma_f32 v[20:21], v[30:31], s[18:19], v[20:21] op_sel:[1,0,0] op_sel_hi:[1,1,1]
    s_lshl_b32 s12, s83, 16
    s_and_b32 s13, s83, 0xffff0000
    v_pk_fma_f32 v[18:19], v[26:27], s[12:13], v[18:19] op_sel:[1,0,0] op_sel_hi:[1,1,1]
    v_pk_fma_f32 v[22:23], v[30:31], s[12:13], v[22:23] op_sel:[1,0,0] op_sel_hi:[1,1,1]
    v_cvt_pk_bf16_f32 v16, v16, v17
    v_cvt_pk_bf16_f32 v18, v18, v19
    v_cvt_pk_bf16_f32 v20, v20, v21
    v_cvt_pk_bf16_f32 v22, v22, v23
    v_and_b32 v17, 0xffff0000, v16
    v_lshlrev_b32 v16, 16, v16
    v_and_b32 v19, 0xffff0000, v18
    v_lshlrev_b32 v18, 16, v18
    v_and_b32 v21, 0xffff0000, v20
    v_lshlrev_b32 v20, 16, v20
    v_and_b32 v23, 0xffff0000, v22
    v_lshlrev_b32 v22, 16, v22
    v_mul_f32 v16, v16, v32
    v_mul_f32 v17, v17, v33
    v_mul_f32 v18, v18, v34
    v_mul_f32 v19, v19, v35
    v_mul_f32 v20, v20, v36
    v_mul_f32 v21, v21, v37
    v_mul_f32 v22, v22, v38
    v_mul_f32 v23, v23, v39
    v_cvt_pk_bf16_f32 v16, v16, v17
    v_cvt_pk_bf16_f32 v18, v18, v19
    v_cvt_pk_bf16_f32 v20, v20, v21
    v_cvt_pk_bf16_f32 v22, v22, v23
    v_and_b32 v17, 0xffff0000, v16
    v_lshlrev_b32 v16, 16, v16
    v_and_b32 v19, 0xffff0000, v18
    v_lshlrev_b32 v18, 16, v18
    v_and_b32 v21, 0xffff0000, v20
    v_lshlrev_b32 v20, 16, v20
    v_and_b32 v23, 0xffff0000, v22
    v_lshlrev_b32 v22, 16, v22
    s_waitcnt vmcnt(0)
    v_lshlrev_b32 v8, 16, v60
    v_and_b32 v9, 0xffff0000, v60
    v_lshlrev_b32 v10, 16, v61
    v_and_b32 v11, 0xffff0000, v61
    v_lshlrev_b32 v12, 16, v62
    v_and_b32 v13, 0xffff0000, v62
    v_lshlrev_b32 v14, 16, v63
    v_and_b32 v15, 0xffff0000, v63
    v_add_f32 v8, v8, v16
    v_add_f32 v9, v9, v17
    v_add_f32 v10, v10, v18
    v_add_f32 v11, v11, v19
    v_add_f32 v12, v12, v20
    v_add_f32 v13, v13, v21
    v_add_f32 v14, v14, v22
    v_add_f32 v15, v15, v23
    v_cvt_pk_bf16_f32 v4, v8, v9
    v_cvt_pk_bf16_f32 v5, v10, v11
    v_cvt_pk_bf16_f32 v6, v12, v13
    v_cvt_pk_bf16_f32 v7, v14, v15
    buffer_store_dwordx4 v[4:7], v2, s[24:27], 0 offen
p3_end:
    s_endpgm
.section .rodata,"a"
.p2align 6
.amdhsa_kernel p1_kernel
  .amdhsa_next_free_vgpr 128
  .amdhsa_next_free_sgpr 72
  .amdhsa_accum_offset 128
  .amdhsa_group_segment_fixed_size 0
  .amdhsa_kernarg_size 112
  .amdhsa_user_sgpr_count 2
  .amdhsa_user_sgpr_kernarg_segment_ptr 1
  .amdhsa_system_sgpr_workgroup_id_x 1
  .amdhsa_float_denorm_mode_32 3
.end_amdhsa_kernel
.p2align 6
.amdhsa_kernel p2_kernel
  .amdhsa_next_free_vgpr 128
  .amdhsa_next_free_sgpr 72
  .amdhsa_accum_offset 128
  .amdhsa_group_segment_fixed_size 0
  .amdhsa_kernarg_size 112
  .amdhsa_user_sgpr_count 2
  .amdhsa_user_sgpr_kernarg_segment_ptr 1
  .amdhsa_system_sgpr_workgroup_id_x 1
  .amdhsa_float_denorm_mode_32 3
.end_amdhsa_kernel
.p2align 6
.amdhsa_kernel p3_kernel
  .amdhsa_next_free_vgpr 64
  .amdhsa_next_free_sgpr 84
  .amdhsa_accum_offset 64
  .amdhsa_group_segment_fixed_size 0
  .amdhsa_kernarg_size 112
  .amdhsa_user_sgpr_count 2
  .amdhsa_user_sgpr_kernarg_segment_ptr 1
  .amdhsa_system_sgpr_workgroup_id_x 1
  .amdhsa_float_denorm_mode_32 3
.end_amdhsa_kernel
```

```asm
; @launch kernel=p1_kernel grid=(256,1,1) block=(1024,1,1) lds=163072
; @launch kernel=p2_kernel grid=(256,1,1) block=(1024,1,1) lds=154368
; @launch kernel=p3_kernel grid=(1563,1,1) block=(256,1,1) lds=0
.amdgcn_target "amdgcn-amd-amdhsa--gfx950"
.text
.globl p1_kernel
.p2align 8
.type p1_kernel,@function
p1_kernel:
    s_cmp_ge_u32 s2, 256
    s_cbranch_scc1 p1_end
    s_load_dwordx2 s[52:53], s[0:1], 0
    s_load_dwordx4 s[56:59], s[0:1], 8
    s_load_dwordx2 s[54:55], s[0:1], 32
    s_load_dwordx2 s[60:61], s[0:1], 48
    s_load_dwordx2 s[48:49], s[0:1], 104
    s_load_dwordx2 s[62:63], s[0:1], 96
    v_lshlrev_b32 v1, 4, v0
    v_lshlrev_b32 v2, 3, v0
    v_mov_b32 v3, 1
    v_lshrrev_b32 v117, 6, v0
    s_nop 0
    v_readfirstlane_b32 s28, v117
    s_waitcnt lgkmcnt(0)
    s_load_dword s45, s[60:61], 0
    s_mov_b32 s24, s52
    s_and_b32 s25, s53, 0xffff
    s_mov_b32 s26, 6400000
    s_mov_b32 s27, 0x20000
    s_mov_b32 s4, s56
    s_and_b32 s5, s57, 0xffff
    s_mov_b32 s6, 204800000
    s_mov_b32 s7, 0x20000
    s_mov_b32 s8, s58
    s_and_b32 s9, s59, 0xffff
    s_mov_b32 s10, 204800000
    s_mov_b32 s11, 0x20000
    s_mov_b32 s12, s54
    s_and_b32 s13, s55, 0xffff
    s_mov_b32 s14, 102400000
    s_mov_b32 s15, 0x20000
    s_mov_b32 s16, s48
    s_and_b32 s17, s49, 0xffff
    s_mov_b32 s18, 819200000
    s_mov_b32 s19, 0x20000
    s_mov_b32 s20, s48
    s_and_b32 s21, s49, 0xffff
    s_mov_b32 s22, 0
    s_mov_b32 s23, 0x20000
    s_mov_b32 s40, s62
    s_and_b32 s41, s63, 0xffff
    s_mov_b32 s42, 256
    s_mov_b32 s43, 0x20000
    s_mov_b32 s36, 643827
    s_mov_b32 s37, 214609
    s_mov_b32 s38, 343268
    s_mov_b32 s39, -6671
    s_mov_b32 s44, -12512
    s_mov_b32 s34, 1
    s_waitcnt lgkmcnt(0)
    s_lshl_b32 s45, s45, 16
    s_mov_b32 s29, s2
    s_mul_i32 s46, s29, 1
    s_min_u32 s47, s29, 1499
    s_add_u32 s46, s46, s47
    s_min_u32 s47, s29, 1462
    s_add_u32 s46, s46, s47
    s_min_u32 s47, s29, 1426
    s_add_u32 s46, s46, s47
    s_min_u32 s47, s29, 1389
    s_add_u32 s46, s46, s47
    s_min_u32 s47, s29, 1352
    s_add_u32 s46, s46, s47
    s_min_u32 s47, s29, 1315
    s_add_u32 s46, s46, s47
    s_min_u32 s47, s29, 1279
    s_add_u32 s46, s46, s47
    s_min_u32 s47, s29, 1242
    s_add_u32 s46, s46, s47
    s_lshl_b32 s30, s46, 14
    s_lshl_b32 s31, s46, 13
    s_add_u32 s32, s30, 0
    buffer_load_dwordx4 v[94:97], v1, s[4:7], s32 offen nt
    buffer_load_dwordx4 v[102:105], v1, s[8:11], s32 offen nt
    s_add_u32 s32, s31, 0
    buffer_load_dwordx2 v[76:77], v2, s[12:15], s32 offen nt
    s_add_u32 s32, s30, 16384
    buffer_load_dwordx4 v[98:101], v1, s[4:7], s32 offen nt
    buffer_load_dwordx4 v[106:109], v1, s[8:11], s32 offen nt
    s_add_u32 s32, s31, 8192
    buffer_load_dwordx2 v[78:79], v2, s[12:15], s32 offen nt
    s_add_u32 s32, s30, 32768
    buffer_load_dwordx4 v[12:15], v1, s[4:7], s32 offen nt
    buffer_load_dwordx4 v[48:51], v1, s[8:11], s32 offen nt
    s_add_u32 s32, s31, 16384
    buffer_load_dwordx2 v[80:81], v2, s[12:15], s32 offen nt
    s_add_u32 s32, s31, 24576
    buffer_load_dwordx2 v[82:83], v2, s[12:15], s32 offen nt
    s_add_u32 s32, s31, 32768
    buffer_load_dwordx2 v[84:85], v2, s[12:15], s32 offen nt
    s_add_u32 s32, s31, 40960
    buffer_load_dwordx2 v[86:87], v2, s[12:15], s32 offen nt
    s_add_u32 s32, s31, 49152
    buffer_load_dwordx2 v[88:89], v2, s[12:15], s32 offen nt
    s_add_u32 s32, s31, 57344
    buffer_load_dwordx2 v[90:91], v2, s[12:15], s32 offen nt
    s_add_u32 s32, s31, 65536
    buffer_load_dwordx2 v[92:93], v2, s[12:15], s32 offen nt
    v_mov_b32 v73, 0x40000000
    v_mov_b32 v122, 0
    v_mov_b32 v123, 0
    v_mov_b32 v124, 0
    v_mov_b32 v125, 0
    ds_write_b128 v1, v[122:125] offset:0
    s_waitcnt lgkmcnt(0)
    s_barrier
p1_tile:
    v_mov_b32 v122, 0
    v_mov_b32 v123, 0
    v_mov_b32 v124, 0
    v_mov_b32 v125, 0
    ds_write_b128 v1, v[122:125] offset:10496
    ds_write_b128 v1, v[122:125] offset:26880
    ds_write_b128 v1, v[122:125] offset:43264
    s_cmp_lg_u32 s28, 15
    s_cbranch_scc1 p1_tk0
    v_mov_b32 v127, 1
    s_mov_b64 exec, 1
    buffer_atomic_add v127, off, s[40:43], 0 offset:128 sc0 sc1
    s_mov_b64 exec, -1
p1_tk0:
    v_mov_b32 v123, s45
    v_mov_b32 v124, 0x007f007f
    v_mov_b32 v125, 0xe000
    v_mov_b32 v126, 0xffff0000
    s_cmp_lt_u32 s29, 1426
    s_cselect_b32 s6, 204800000, 0
    s_cselect_b32 s10, 204800000, 0
    s_add_u32 s32, s30, 49152
    buffer_load_dwordx4 v[16:19], v1, s[4:7], s32 offen nt
    buffer_load_dwordx4 v[52:55], v1, s[8:11], s32 offen nt
    s_waitcnt vmcnt(14)
    v_lshlrev_b32 v117, 16, v76
    v_and_b32 v118, v126, v76
    v_mul_f32 v117, v123, v117
    v_mul_f32 v118, v123, v118
    v_cvt_pk_bf16_f32 v117, v117, v118
    v_and_b32 v118, v126, v117
    v_lshlrev_b32 v117, 16, v117
    v_mul_f32 v117, 0.15915494, v117
    v_mul_f32 v118, 0.15915494, v118
    v_fract_f32 v117, v117
    v_fract_f32 v118, v118
    v_cos_f32 v117, v117
    v_cos_f32 v118, v118
    v_mul_hi_u32_u24 v122, s38, v102
    v_mul_hi_u32_u24 v121, s37, v94
    v_mul_hi_u32_u24 v120, s36, v94
    v_mad_i32_i24 v110, v122, s44, v102
    v_mad_u32_u24 v40, v122, 40, v121
    v_mad_i32_i24 v4, v120, s39, v94
    v_lshlrev_b16 v40, 2, v40
    v_mad_i32_i24 v120, v121, -3, v120
    ds_add_u32 v40, v3 offset:0
    v_lshl_or_b32 v4, v110, 16, v4
    v_lshl_or_b32 v4, v120, 30, v4
    v_mul_f32 v117, 0x03800000, v117
    v_mul_f32 v118, 0x03800000, v118
    v_cvt_pk_bf16_f32 v117, v117, v118
    v_mul_hi_u32_u24 v122, s38, v103
    v_mul_hi_u32_u24 v121, s37, v95
    v_mul_hi_u32_u24 v120, s36, v95
    v_mad_i32_i24 v110, v122, s44, v103
    v_mad_u32_u24 v41, v122, 40, v121
    v_mad_i32_i24 v5, v120, s39, v95
    v_lshlrev_b16 v41, 2, v41
    v_mad_i32_i24 v120, v121, -3, v120
    ds_add_u32 v41, v3 offset:0
    v_lshl_or_b32 v5, v110, 16, v5
    v_lshl_or_b32 v5, v120, 30, v5
    v_lshrrev_b32 v118, 3, v117
    v_lshrrev_b32 v119, 8, v117
    v_lshlrev_b16 v117, 13, v117
    v_bitop3_b32 v119, v118, v119, v124 bitop3:0x1b
    v_bitop3_b32 v4, v117, v125, v4 bitop3:0xae
    v_lshl_or_b32 v40, v119, 16, v40
    v_bitop3_b32 v5, v118, v125, v5 bitop3:0xae
    v_bitop3_b32 v41, v119, v126, v41 bitop3:0xea
    v_lshlrev_b32 v117, 16, v77
    v_and_b32 v118, v126, v77
    v_mul_f32 v117, v123, v117
    v_mul_f32 v118, v123, v118
    v_cvt_pk_bf16_f32 v117, v117, v118
    v_and_b32 v118, v126, v117
    v_lshlrev_b32 v117, 16, v117
    v_mul_f32 v117, 0.15915494, v117
    v_mul_f32 v118, 0.15915494, v118
    v_fract_f32 v117, v117
    v_fract_f32 v118, v118
    v_cos_f32 v117, v117
    v_cos_f32 v118, v118
    v_mul_hi_u32_u24 v122, s38, v104
    v_mul_hi_u32_u24 v121, s37, v96
    v_mul_hi_u32_u24 v120, s36, v96
    v_mad_i32_i24 v110, v122, s44, v104
    v_mad_u32_u24 v42, v122, 40, v121
    v_mad_i32_i24 v6, v120, s39, v96
    v_lshlrev_b16 v42, 2, v42
    v_mad_i32_i24 v120, v121, -3, v120
    ds_add_u32 v42, v3 offset:0
    v_lshl_or_b32 v6, v110, 16, v6
    v_lshl_or_b32 v6, v120, 30, v6
    v_mul_f32 v117, 0x03800000, v117
    v_mul_f32 v118, 0x03800000, v118
    v_cvt_pk_bf16_f32 v117, v117, v118
    v_mul_hi_u32_u24 v122, s38, v105
    v_mul_hi_u32_u24 v121, s37, v97
    v_mul_hi_u32_u24 v120, s36, v97
    v_mad_i32_i24 v110, v122, s44, v105
    v_mad_u32_u24 v43, v122, 40, v121
    v_mad_i32_i24 v7, v120, s39, v97
    v_lshlrev_b16 v43, 2, v43
    v_mad_i32_i24 v120, v121, -3, v120
    ds_add_u32 v43, v3 offset:0
    v_lshl_or_b32 v7, v110, 16, v7
    v_lshl_or_b32 v7, v120, 30, v7
    v_lshrrev_b32 v118, 3, v117
    v_lshrrev_b32 v119, 8, v117
    v_lshlrev_b16 v117, 13, v117
    v_bitop3_b32 v119, v118, v119, v124 bitop3:0x1b
    v_bitop3_b32 v6, v117, v125, v6 bitop3:0xae
    v_lshl_or_b32 v42, v119, 16, v42
    v_bitop3_b32 v7, v118, v125, v7 bitop3:0xae
    v_bitop3_b32 v43, v119, v126, v43 bitop3:0xea
    s_cmp_lt_u32 s29, 1389
    s_cselect_b32 s6, 204800000, 0
    s_cselect_b32 s10, 204800000, 0
    s_add_u32 s32, s30, 65536
    buffer_load_dwordx4 v[20:23], v1, s[4:7], s32 offen nt
    buffer_load_dwordx4 v[56:59], v1, s[8:11], s32 offen nt
    s_cmp_ge_u32 s29, 1499
    s_cbranch_scc1 p1_k2
    s_cmp_lg_u32 s34, 0
    s_cbranch_scc1 p1_w3
    s_waitcnt vmcnt(10)
p1_w3:
    s_waitcnt vmcnt(13)
    v_lshlrev_b32 v117, 16, v78
    v_and_b32 v118, v126, v78
    v_mul_f32 v117, v123, v117
    v_mul_f32 v118, v123, v118
    v_cvt_pk_bf16_f32 v117, v117, v118
    v_and_b32 v118, v126, v117
    v_lshlrev_b32 v117, 16, v117
    v_mul_f32 v117, 0.15915494, v117
    v_mul_f32 v118, 0.15915494, v118
    v_fract_f32 v117, v117
    v_fract_f32 v118, v118
    v_cos_f32 v117, v117
    v_cos_f32 v118, v118
    v_mul_hi_u32_u24 v122, s38, v106
    v_mul_hi_u32_u24 v121, s37, v98
    v_mul_hi_u32_u24 v120, s36, v98
    v_mad_i32_i24 v110, v122, s44, v106
    v_mad_u32_u24 v44, v122, 40, v121
    v_mad_i32_i24 v8, v120, s39, v98
    v_lshlrev_b16 v44, 2, v44
    v_mad_i32_i24 v120, v121, -3, v120
    ds_add_u32 v44, v3 offset:0
    v_lshl_or_b32 v8, v110, 16, v8
    v_lshl_or_b32 v8, v120, 30, v8
    v_mul_f32 v117, 0x03800000, v117
    v_mul_f32 v118, 0x03800000, v118
    v_cvt_pk_bf16_f32 v117, v117, v118
    v_mul_hi_u32_u24 v122, s38, v107
    v_mul_hi_u32_u24 v121, s37, v99
    v_mul_hi_u32_u24 v120, s36, v99
    v_mad_i32_i24 v110, v122, s44, v107
    v_mad_u32_u24 v45, v122, 40, v121
    v_mad_i32_i24 v9, v120, s39, v99
    v_lshlrev_b16 v45, 2, v45
    v_mad_i32_i24 v120, v121, -3, v120
    ds_add_u32 v45, v3 offset:0
    v_lshl_or_b32 v9, v110, 16, v9
    v_lshl_or_b32 v9, v120, 30, v9
    v_lshrrev_b32 v118, 3, v117
    v_lshrrev_b32 v119, 8, v117
    v_lshlrev_b16 v117, 13, v117
    v_bitop3_b32 v119, v118, v119, v124 bitop3:0x1b
    v_bitop3_b32 v8, v117, v125, v8 bitop3:0xae
    v_lshl_or_b32 v44, v119, 16, v44
    v_bitop3_b32 v9, v118, v125, v9 bitop3:0xae
    v_bitop3_b32 v45, v119, v126, v45 bitop3:0xea
    v_lshlrev_b32 v117, 16, v79
    v_and_b32 v118, v126, v79
    v_mul_f32 v117, v123, v117
    v_mul_f32 v118, v123, v118
    v_cvt_pk_bf16_f32 v117, v117, v118
    v_and_b32 v118, v126, v117
    v_lshlrev_b32 v117, 16, v117
    v_mul_f32 v117, 0.15915494, v117
    v_mul_f32 v118, 0.15915494, v118
    v_fract_f32 v117, v117
    v_fract_f32 v118, v118
    v_cos_f32 v117, v117
    v_cos_f32 v118, v118
    v_mul_hi_u32_u24 v122, s38, v108
    v_mul_hi_u32_u24 v121, s37, v100
    v_mul_hi_u32_u24 v120, s36, v100
    v_mad_i32_i24 v110, v122, s44, v108
    v_mad_u32_u24 v46, v122, 40, v121
    v_mad_i32_i24 v10, v120, s39, v100
    v_lshlrev_b16 v46, 2, v46
    v_mad_i32_i24 v120, v121, -3, v120
    ds_add_u32 v46, v3 offset:0
    v_lshl_or_b32 v10, v110, 16, v10
    v_lshl_or_b32 v10, v120, 30, v10
    v_mul_f32 v117, 0x03800000, v117
    v_mul_f32 v118, 0x03800000, v118
    v_cvt_pk_bf16_f32 v117, v117, v118
    v_mul_hi_u32_u24 v122, s38, v109
    v_mul_hi_u32_u24 v121, s37, v101
    v_mul_hi_u32_u24 v120, s36, v101
    v_mad_i32_i24 v110, v122, s44, v109
    v_mad_u32_u24 v47, v122, 40, v121
    v_mad_i32_i24 v11, v120, s39, v101
    v_lshlrev_b16 v47, 2, v47
    v_mad_i32_i24 v120, v121, -3, v120
    ds_add_u32 v47, v3 offset:0
    v_lshl_or_b32 v11, v110, 16, v11
    v_lshl_or_b32 v11, v120, 30, v11
    v_lshrrev_b32 v118, 3, v117
    v_lshrrev_b32 v119, 8, v117
    v_lshlrev_b16 v117, 13, v117
    v_bitop3_b32 v119, v118, v119, v124 bitop3:0x1b
    v_bitop3_b32 v10, v117, v125, v10 bitop3:0xae
    v_lshl_or_b32 v46, v119, 16, v46
    v_bitop3_b32 v11, v118, v125, v11 bitop3:0xae
    v_bitop3_b32 v47, v119, v126, v47 bitop3:0xea
p1_k2:
    s_cmp_lt_u32 s29, 1352
    s_cselect_b32 s6, 204800000, 0
    s_cselect_b32 s10, 204800000, 0
    s_add_u32 s32, s30, 81920
    buffer_load_dwordx4 v[24:27], v1, s[4:7], s32 offen nt
    buffer_load_dwordx4 v[60:63], v1, s[8:11], s32 offen nt
    s_cmp_ge_u32 s29, 1462
    s_cbranch_scc1 p1_k4
    s_cmp_lg_u32 s34, 0
    s_cbranch_scc1 p1_w5
    s_waitcnt vmcnt(6)
p1_w5:
    s_waitcnt vmcnt(11)
    v_lshlrev_b32 v117, 16, v80
    v_and_b32 v118, v126, v80
    v_mul_f32 v117, v123, v117
    v_mul_f32 v118, v123, v118
    v_cvt_pk_bf16_f32 v117, v117, v118
    v_and_b32 v118, v126, v117
    v_lshlrev_b32 v117, 16, v117
    v_mul_f32 v117, 0.15915494, v117
    v_mul_f32 v118, 0.15915494, v118
    v_fract_f32 v117, v117
    v_fract_f32 v118, v118
    v_cos_f32 v117, v117
    v_cos_f32 v118, v118
    v_mul_hi_u32_u24 v122, s38, v48
    v_mul_hi_u32_u24 v121, s37, v12
    v_mul_hi_u32_u24 v120, s36, v12
    v_mad_i32_i24 v110, v122, s44, v48
    v_mad_u32_u24 v48, v122, 40, v121
    v_mad_i32_i24 v12, v120, s39, v12
    v_lshlrev_b16 v48, 2, v48
    v_mad_i32_i24 v120, v121, -3, v120
    ds_add_u32 v48, v3 offset:0
    v_lshl_or_b32 v12, v110, 16, v12
    v_lshl_or_b32 v12, v120, 30, v12
    v_mul_f32 v117, 0x03800000, v117
    v_mul_f32 v118, 0x03800000, v118
    v_cvt_pk_bf16_f32 v117, v117, v118
    v_mul_hi_u32_u24 v122, s38, v49
    v_mul_hi_u32_u24 v121, s37, v13
    v_mul_hi_u32_u24 v120, s36, v13
    v_mad_i32_i24 v110, v122, s44, v49
    v_mad_u32_u24 v49, v122, 40, v121
    v_mad_i32_i24 v13, v120, s39, v13
    v_lshlrev_b16 v49, 2, v49
    v_mad_i32_i24 v120, v121, -3, v120
    ds_add_u32 v49, v3 offset:0
    v_lshl_or_b32 v13, v110, 16, v13
    v_lshl_or_b32 v13, v120, 30, v13
    v_lshrrev_b32 v118, 3, v117
    v_lshrrev_b32 v119, 8, v117
    v_lshlrev_b16 v117, 13, v117
    v_bitop3_b32 v119, v118, v119, v124 bitop3:0x1b
    v_bitop3_b32 v12, v117, v125, v12 bitop3:0xae
    v_lshl_or_b32 v48, v119, 16, v48
    v_bitop3_b32 v13, v118, v125, v13 bitop3:0xae
    v_bitop3_b32 v49, v119, v126, v49 bitop3:0xea
    v_lshlrev_b32 v117, 16, v81
    v_and_b32 v118, v126, v81
    v_mul_f32 v117, v123, v117
    v_mul_f32 v118, v123, v118
    v_cvt_pk_bf16_f32 v117, v117, v118
    v_and_b32 v118, v126, v117
    v_lshlrev_b32 v117, 16, v117
    v_mul_f32 v117, 0.15915494, v117
    v_mul_f32 v118, 0.15915494, v118
    v_fract_f32 v117, v117
    v_fract_f32 v118, v118
    v_cos_f32 v117, v117
    v_cos_f32 v118, v118
    v_mul_hi_u32_u24 v122, s38, v50
    v_mul_hi_u32_u24 v121, s37, v14
    v_mul_hi_u32_u24 v120, s36, v14
    v_mad_i32_i24 v110, v122, s44, v50
    v_mad_u32_u24 v50, v122, 40, v121
    v_mad_i32_i24 v14, v120, s39, v14
    v_lshlrev_b16 v50, 2, v50
    v_mad_i32_i24 v120, v121, -3, v120
    ds_add_u32 v50, v3 offset:0
    v_lshl_or_b32 v14, v110, 16, v14
    v_lshl_or_b32 v14, v120, 30, v14
    v_mul_f32 v117, 0x03800000, v117
    v_mul_f32 v118, 0x03800000, v118
    v_cvt_pk_bf16_f32 v117, v117, v118
    v_mul_hi_u32_u24 v122, s38, v51
    v_mul_hi_u32_u24 v121, s37, v15
    v_mul_hi_u32_u24 v120, s36, v15
    v_mad_i32_i24 v110, v122, s44, v51
    v_mad_u32_u24 v51, v122, 40, v121
    v_mad_i32_i24 v15, v120, s39, v15
    v_lshlrev_b16 v51, 2, v51
    v_mad_i32_i24 v120, v121, -3, v120
    ds_add_u32 v51, v3 offset:0
    v_lshl_or_b32 v15, v110, 16, v15
    v_lshl_or_b32 v15, v120, 30, v15
    v_lshrrev_b32 v118, 3, v117
    v_lshrrev_b32 v119, 8, v117
    v_lshlrev_b16 v117, 13, v117
    v_bitop3_b32 v119, v118, v119, v124 bitop3:0x1b
    v_bitop3_b32 v14, v117, v125, v14 bitop3:0xae
    v_lshl_or_b32 v50, v119, 16, v50
    v_bitop3_b32 v15, v118, v125, v15 bitop3:0xae
    v_bitop3_b32 v51, v119, v126, v51 bitop3:0xea
p1_k4:
    s_cmp_lt_u32 s29, 1315
    s_cselect_b32 s6, 204800000, 0
    s_cselect_b32 s10, 204800000, 0
    s_add_u32 s32, s30, 98304
    buffer_load_dwordx4 v[28:31], v1, s[4:7], s32 offen nt
    buffer_load_dwordx4 v[64:67], v1, s[8:11], s32 offen nt
    s_cmp_ge_u32 s29, 1426
    s_cbranch_scc1 p1_k6
    s_waitcnt vmcnt(6)
    v_lshlrev_b32 v117, 16, v82
    v_and_b32 v118, v126, v82
    v_mul_f32 v117, v123, v117
    v_mul_f32 v118, v123, v118
    v_cvt_pk_bf16_f32 v117, v117, v118
    v_and_b32 v118, v126, v117
    v_lshlrev_b32 v117, 16, v117
    v_mul_f32 v117, 0.15915494, v117
    v_mul_f32 v118, 0.15915494, v118
    v_fract_f32 v117, v117
    v_fract_f32 v118, v118
    v_cos_f32 v117, v117
    v_cos_f32 v118, v118
    v_mul_hi_u32_u24 v122, s38, v52
    v_mul_hi_u32_u24 v121, s37, v16
    v_mul_hi_u32_u24 v120, s36, v16
    v_mad_i32_i24 v110, v122, s44, v52
    v_mad_u32_u24 v52, v122, 40, v121
    v_mad_i32_i24 v16, v120, s39, v16
    v_lshlrev_b16 v52, 2, v52
    v_mad_i32_i24 v120, v121, -3, v120
    ds_add_u32 v52, v3 offset:0
    v_lshl_or_b32 v16, v110, 16, v16
    v_lshl_or_b32 v16, v120, 30, v16
    v_mul_f32 v117, 0x03800000, v117
    v_mul_f32 v118, 0x03800000, v118
    v_cvt_pk_bf16_f32 v117, v117, v118
    v_mul_hi_u32_u24 v122, s38, v53
    v_mul_hi_u32_u24 v121, s37, v17
    v_mul_hi_u32_u24 v120, s36, v17
    v_mad_i32_i24 v110, v122, s44, v53
    v_mad_u32_u24 v53, v122, 40, v121
    v_mad_i32_i24 v17, v120, s39, v17
    v_lshlrev_b16 v53, 2, v53
    v_mad_i32_i24 v120, v121, -3, v120
    ds_add_u32 v53, v3 offset:0
    v_lshl_or_b32 v17, v110, 16, v17
    v_lshl_or_b32 v17, v120, 30, v17
    v_lshrrev_b32 v118, 3, v117
    v_lshrrev_b32 v119, 8, v117
    v_lshlrev_b16 v117, 13, v117
    v_bitop3_b32 v119, v118, v119, v124 bitop3:0x1b
    v_bitop3_b32 v16, v117, v125, v16 bitop3:0xae
    v_lshl_or_b32 v52, v119, 16, v52
    v_bitop3_b32 v17, v118, v125, v17 bitop3:0xae
    v_bitop3_b32 v53, v119, v126, v53 bitop3:0xea
    v_lshlrev_b32 v117, 16, v83
    v_and_b32 v118, v126, v83
    v_mul_f32 v117, v123, v117
    v_mul_f32 v118, v123, v118
    v_cvt_pk_bf16_f32 v117, v117, v118
    v_and_b32 v118, v126, v117
    v_lshlrev_b32 v117, 16, v117
    v_mul_f32 v117, 0.15915494, v117
    v_mul_f32 v118, 0.15915494, v118
    v_fract_f32 v117, v117
    v_fract_f32 v118, v118
    v_cos_f32 v117, v117
    v_cos_f32 v118, v118
    v_mul_hi_u32_u24 v122, s38, v54
    v_mul_hi_u32_u24 v121, s37, v18
    v_mul_hi_u32_u24 v120, s36, v18
    v_mad_i32_i24 v110, v122, s44, v54
    v_mad_u32_u24 v54, v122, 40, v121
    v_mad_i32_i24 v18, v120, s39, v18
    v_lshlrev_b16 v54, 2, v54
    v_mad_i32_i24 v120, v121, -3, v120
    ds_add_u32 v54, v3 offset:0
    v_lshl_or_b32 v18, v110, 16, v18
    v_lshl_or_b32 v18, v120, 30, v18
    v_mul_f32 v117, 0x03800000, v117
    v_mul_f32 v118, 0x03800000, v118
    v_cvt_pk_bf16_f32 v117, v117, v118
    v_mul_hi_u32_u24 v122, s38, v55
    v_mul_hi_u32_u24 v121, s37, v19
    v_mul_hi_u32_u24 v120, s36, v19
    v_mad_i32_i24 v110, v122, s44, v55
    v_mad_u32_u24 v55, v122, 40, v121
    v_mad_i32_i24 v19, v120, s39, v19
    v_lshlrev_b16 v55, 2, v55
    v_mad_i32_i24 v120, v121, -3, v120
    ds_add_u32 v55, v3 offset:0
    v_lshl_or_b32 v19, v110, 16, v19
    v_lshl_or_b32 v19, v120, 30, v19
    v_lshrrev_b32 v118, 3, v117
    v_lshrrev_b32 v119, 8, v117
    v_lshlrev_b16 v117, 13, v117
    v_bitop3_b32 v119, v118, v119, v124 bitop3:0x1b
    v_bitop3_b32 v18, v117, v125, v18 bitop3:0xae
    v_lshl_or_b32 v54, v119, 16, v54
    v_bitop3_b32 v19, v118, v125, v19 bitop3:0xae
    v_bitop3_b32 v55, v119, v126, v55 bitop3:0xea
p1_k6:
    s_cmp_lt_u32 s29, 1279
    s_cselect_b32 s6, 204800000, 0
    s_cselect_b32 s10, 204800000, 0
    s_add_u32 s32, s30, 114688
    buffer_load_dwordx4 v[32:35], v1, s[4:7], s32 offen nt
    buffer_load_dwordx4 v[68:71], v1, s[8:11], s32 offen nt
    s_cmp_ge_u32 s29, 1389
    s_cbranch_scc1 p1_k8
    s_waitcnt vmcnt(6)
    v_lshlrev_b32 v117, 16, v84
    v_and_b32 v118, v126, v84
    v_mul_f32 v117, v123, v117
    v_mul_f32 v118, v123, v118
    v_cvt_pk_bf16_f32 v117, v117, v118
    v_and_b32 v118, v126, v117
    v_lshlrev_b32 v117, 16, v117
    v_mul_f32 v117, 0.15915494, v117
    v_mul_f32 v118, 0.15915494, v118
    v_fract_f32 v117, v117
    v_fract_f32 v118, v118
    v_cos_f32 v117, v117
    v_cos_f32 v118, v118
    v_mul_hi_u32_u24 v122, s38, v56
    v_mul_hi_u32_u24 v121, s37, v20
    v_mul_hi_u32_u24 v120, s36, v20
    v_mad_i32_i24 v110, v122, s44, v56
    v_mad_u32_u24 v56, v122, 40, v121
    v_mad_i32_i24 v20, v120, s39, v20
    v_lshlrev_b16 v56, 2, v56
    v_mad_i32_i24 v120, v121, -3, v120
    ds_add_u32 v56, v3 offset:0
    v_lshl_or_b32 v20, v110, 16, v20
    v_lshl_or_b32 v20, v120, 30, v20
    v_mul_f32 v117, 0x03800000, v117
    v_mul_f32 v118, 0x03800000, v118
    v_cvt_pk_bf16_f32 v117, v117, v118
    v_mul_hi_u32_u24 v122, s38, v57
    v_mul_hi_u32_u24 v121, s37, v21
    v_mul_hi_u32_u24 v120, s36, v21
    v_mad_i32_i24 v110, v122, s44, v57
    v_mad_u32_u24 v57, v122, 40, v121
    v_mad_i32_i24 v21, v120, s39, v21
    v_lshlrev_b16 v57, 2, v57
    v_mad_i32_i24 v120, v121, -3, v120
    ds_add_u32 v57, v3 offset:0
    v_lshl_or_b32 v21, v110, 16, v21
    v_lshl_or_b32 v21, v120, 30, v21
    v_lshrrev_b32 v118, 3, v117
    v_lshrrev_b32 v119, 8, v117
    v_lshlrev_b16 v117, 13, v117
    v_bitop3_b32 v119, v118, v119, v124 bitop3:0x1b
    v_bitop3_b32 v20, v117, v125, v20 bitop3:0xae
    v_lshl_or_b32 v56, v119, 16, v56
    v_bitop3_b32 v21, v118, v125, v21 bitop3:0xae
    v_bitop3_b32 v57, v119, v126, v57 bitop3:0xea
    v_lshlrev_b32 v117, 16, v85
    v_and_b32 v118, v126, v85
    v_mul_f32 v117, v123, v117
    v_mul_f32 v118, v123, v118
    v_cvt_pk_bf16_f32 v117, v117, v118
    v_and_b32 v118, v126, v117
    v_lshlrev_b32 v117, 16, v117
    v_mul_f32 v117, 0.15915494, v117
    v_mul_f32 v118, 0.15915494, v118
    v_fract_f32 v117, v117
    v_fract_f32 v118, v118
    v_cos_f32 v117, v117
    v_cos_f32 v118, v118
    v_mul_hi_u32_u24 v122, s38, v58
    v_mul_hi_u32_u24 v121, s37, v22
    v_mul_hi_u32_u24 v120, s36, v22
    v_mad_i32_i24 v110, v122, s44, v58
    v_mad_u32_u24 v58, v122, 40, v121
    v_mad_i32_i24 v22, v120, s39, v22
    v_lshlrev_b16 v58, 2, v58
    v_mad_i32_i24 v120, v121, -3, v120
    ds_add_u32 v58, v3 offset:0
    v_lshl_or_b32 v22, v110, 16, v22
    v_lshl_or_b32 v22, v120, 30, v22
    v_mul_f32 v117, 0x03800000, v117
    v_mul_f32 v118, 0x03800000, v118
    v_cvt_pk_bf16_f32 v117, v117, v118
    v_mul_hi_u32_u24 v122, s38, v59
    v_mul_hi_u32_u24 v121, s37, v23
    v_mul_hi_u32_u24 v120, s36, v23
    v_mad_i32_i24 v110, v122, s44, v59
    v_mad_u32_u24 v59, v122, 40, v121
    v_mad_i32_i24 v23, v120, s39, v23
    v_lshlrev_b16 v59, 2, v59
    v_mad_i32_i24 v120, v121, -3, v120
    ds_add_u32 v59, v3 offset:0
    v_lshl_or_b32 v23, v110, 16, v23
    v_lshl_or_b32 v23, v120, 30, v23
    v_lshrrev_b32 v118, 3, v117
    v_lshrrev_b32 v119, 8, v117
    v_lshlrev_b16 v117, 13, v117
    v_bitop3_b32 v119, v118, v119, v124 bitop3:0x1b
    v_bitop3_b32 v22, v117, v125, v22 bitop3:0xae
    v_lshl_or_b32 v58, v119, 16, v58
    v_bitop3_b32 v23, v118, v125, v23 bitop3:0xae
    v_bitop3_b32 v59, v119, v126, v59 bitop3:0xea
p1_k8:
    s_cmp_lt_u32 s29, 1242
    s_cselect_b32 s6, 204800000, 0
    s_cselect_b32 s10, 204800000, 0
    s_add_u32 s32, s30, 131072
    buffer_load_dwordx4 v[36:39], v1, s[4:7], s32 offen nt
    buffer_load_dwordx4 v[72:75], v1, s[8:11], s32 offen nt
    s_cmp_ge_u32 s29, 1352
    s_cbranch_scc1 p1_k10
    s_waitcnt vmcnt(6)
    v_lshlrev_b32 v117, 16, v86
    v_and_b32 v118, v126, v86
    v_mul_f32 v117, v123, v117
    v_mul_f32 v118, v123, v118
    v_cvt_pk_bf16_f32 v117, v117, v118
    v_and_b32 v118, v126, v117
    v_lshlrev_b32 v117, 16, v117
    v_mul_f32 v117, 0.15915494, v117
    v_mul_f32 v118, 0.15915494, v118
    v_fract_f32 v117, v117
    v_fract_f32 v118, v118
    v_cos_f32 v117, v117
    v_cos_f32 v118, v118
    v_mul_hi_u32_u24 v122, s38, v60
    v_mul_hi_u32_u24 v121, s37, v24
    v_mul_hi_u32_u24 v120, s36, v24
    v_mad_i32_i24 v110, v122, s44, v60
    v_mad_u32_u24 v60, v122, 40, v121
    v_mad_i32_i24 v24, v120, s39, v24
    v_lshlrev_b16 v60, 2, v60
    v_mad_i32_i24 v120, v121, -3, v120
    ds_add_u32 v60, v3 offset:0
    v_lshl_or_b32 v24, v110, 16, v24
    v_lshl_or_b32 v24, v120, 30, v24
    v_mul_f32 v117, 0x03800000, v117
    v_mul_f32 v118, 0x03800000, v118
    v_cvt_pk_bf16_f32 v117, v117, v118
    v_mul_hi_u32_u24 v122, s38, v61
    v_mul_hi_u32_u24 v121, s37, v25
    v_mul_hi_u32_u24 v120, s36, v25
    v_mad_i32_i24 v110, v122, s44, v61
    v_mad_u32_u24 v61, v122, 40, v121
    v_mad_i32_i24 v25, v120, s39, v25
    v_lshlrev_b16 v61, 2, v61
    v_mad_i32_i24 v120, v121, -3, v120
    ds_add_u32 v61, v3 offset:0
    v_lshl_or_b32 v25, v110, 16, v25
    v_lshl_or_b32 v25, v120, 30, v25
    v_lshrrev_b32 v118, 3, v117
    v_lshrrev_b32 v119, 8, v117
    v_lshlrev_b16 v117, 13, v117
    v_bitop3_b32 v119, v118, v119, v124 bitop3:0x1b
    v_bitop3_b32 v24, v117, v125, v24 bitop3:0xae
    v_lshl_or_b32 v60, v119, 16, v60
    v_bitop3_b32 v25, v118, v125, v25 bitop3:0xae
    v_bitop3_b32 v61, v119, v126, v61 bitop3:0xea
    v_lshlrev_b32 v117, 16, v87
    v_and_b32 v118, v126, v87
    v_mul_f32 v117, v123, v117
    v_mul_f32 v118, v123, v118
    v_cvt_pk_bf16_f32 v117, v117, v118
    v_and_b32 v118, v126, v117
    v_lshlrev_b32 v117, 16, v117
    v_mul_f32 v117, 0.15915494, v117
    v_mul_f32 v118, 0.15915494, v118
    v_fract_f32 v117, v117
    v_fract_f32 v118, v118
    v_cos_f32 v117, v117
    v_cos_f32 v118, v118
    v_mul_hi_u32_u24 v122, s38, v62
    v_mul_hi_u32_u24 v121, s37, v26
    v_mul_hi_u32_u24 v120, s36, v26
    v_mad_i32_i24 v110, v122, s44, v62
    v_mad_u32_u24 v62, v122, 40, v121
    v_mad_i32_i24 v26, v120, s39, v26
    v_lshlrev_b16 v62, 2, v62
    v_mad_i32_i24 v120, v121, -3, v120
    ds_add_u32 v62, v3 offset:0
    v_lshl_or_b32 v26, v110, 16, v26
    v_lshl_or_b32 v26, v120, 30, v26
    v_mul_f32 v117, 0x03800000, v117
    v_mul_f32 v118, 0x03800000, v118
    v_cvt_pk_bf16_f32 v117, v117, v118
    v_mul_hi_u32_u24 v122, s38, v63
    v_mul_hi_u32_u24 v121, s37, v27
    v_mul_hi_u32_u24 v120, s36, v27
    v_mad_i32_i24 v110, v122, s44, v63
    v_mad_u32_u24 v63, v122, 40, v121
    v_mad_i32_i24 v27, v120, s39, v27
    v_lshlrev_b16 v63, 2, v63
    v_mad_i32_i24 v120, v121, -3, v120
    ds_add_u32 v63, v3 offset:0
    v_lshl_or_b32 v27, v110, 16, v27
    v_lshl_or_b32 v27, v120, 30, v27
    v_lshrrev_b32 v118, 3, v117
    v_lshrrev_b32 v119, 8, v117
    v_lshlrev_b16 v117, 13, v117
    v_bitop3_b32 v119, v118, v119, v124 bitop3:0x1b
    v_bitop3_b32 v26, v117, v125, v26 bitop3:0xae
    v_lshl_or_b32 v62, v119, 16, v62
    v_bitop3_b32 v27, v118, v125, v27 bitop3:0xae
    v_bitop3_b32 v63, v119, v126, v63 bitop3:0xea
p1_k10:
    s_cmp_ge_u32 s29, 1315
    s_cbranch_scc1 p1_k12
    s_waitcnt vmcnt(4)
    v_lshlrev_b32 v117, 16, v88
    v_and_b32 v118, v126, v88
    v_mul_f32 v117, v123, v117
    v_mul_f32 v118, v123, v118
    v_cvt_pk_bf16_f32 v117, v117, v118
    v_and_b32 v118, v126, v117
    v_lshlrev_b32 v117, 16, v117
    v_mul_f32 v117, 0.15915494, v117
    v_mul_f32 v118, 0.15915494, v118
    v_fract_f32 v117, v117
    v_fract_f32 v118, v118
    v_cos_f32 v117, v117
    v_cos_f32 v118, v118
    v_mul_hi_u32_u24 v122, s38, v64
    v_mul_hi_u32_u24 v121, s37, v28
    v_mul_hi_u32_u24 v120, s36, v28
    v_mad_i32_i24 v110, v122, s44, v64
    v_mad_u32_u24 v64, v122, 40, v121
    v_mad_i32_i24 v28, v120, s39, v28
    v_lshlrev_b16 v64, 2, v64
    v_mad_i32_i24 v120, v121, -3, v120
    ds_add_u32 v64, v3 offset:0
    v_lshl_or_b32 v28, v110, 16, v28
    v_lshl_or_b32 v28, v120, 30, v28
    v_mul_f32 v117, 0x03800000, v117
    v_mul_f32 v118, 0x03800000, v118
    v_cvt_pk_bf16_f32 v117, v117, v118
    v_mul_hi_u32_u24 v122, s38, v65
    v_mul_hi_u32_u24 v121, s37, v29
    v_mul_hi_u32_u24 v120, s36, v29
    v_mad_i32_i24 v110, v122, s44, v65
    v_mad_u32_u24 v65, v122, 40, v121
    v_mad_i32_i24 v29, v120, s39, v29
    v_lshlrev_b16 v65, 2, v65
    v_mad_i32_i24 v120, v121, -3, v120
    ds_add_u32 v65, v3 offset:0
    v_lshl_or_b32 v29, v110, 16, v29
    v_lshl_or_b32 v29, v120, 30, v29
    v_lshrrev_b32 v118, 3, v117
    v_lshrrev_b32 v119, 8, v117
    v_lshlrev_b16 v117, 13, v117
    v_bitop3_b32 v119, v118, v119, v124 bitop3:0x1b
    v_bitop3_b32 v28, v117, v125, v28 bitop3:0xae
    v_lshl_or_b32 v64, v119, 16, v64
    v_bitop3_b32 v29, v118, v125, v29 bitop3:0xae
    v_bitop3_b32 v65, v119, v126, v65 bitop3:0xea
    v_lshlrev_b32 v117, 16, v89
    v_and_b32 v118, v126, v89
    v_mul_f32 v117, v123, v117
    v_mul_f32 v118, v123, v118
    v_cvt_pk_bf16_f32 v117, v117, v118
    v_and_b32 v118, v126, v117
    v_lshlrev_b32 v117, 16, v117
    v_mul_f32 v117, 0.15915494, v117
    v_mul_f32 v118, 0.15915494, v118
    v_fract_f32 v117, v117
    v_fract_f32 v118, v118
    v_cos_f32 v117, v117
    v_cos_f32 v118, v118
    v_mul_hi_u32_u24 v122, s38, v66
    v_mul_hi_u32_u24 v121, s37, v30
    v_mul_hi_u32_u24 v120, s36, v30
    v_mad_i32_i24 v110, v122, s44, v66
    v_mad_u32_u24 v66, v122, 40, v121
    v_mad_i32_i24 v30, v120, s39, v30
    v_lshlrev_b16 v66, 2, v66
    v_mad_i32_i24 v120, v121, -3, v120
    ds_add_u32 v66, v3 offset:0
    v_lshl_or_b32 v30, v110, 16, v30
    v_lshl_or_b32 v30, v120, 30, v30
    v_mul_f32 v117, 0x03800000, v117
    v_mul_f32 v118, 0x03800000, v118
    v_cvt_pk_bf16_f32 v117, v117, v118
    v_mul_hi_u32_u24 v122, s38, v67
    v_mul_hi_u32_u24 v121, s37, v31
    v_mul_hi_u32_u24 v120, s36, v31
    v_mad_i32_i24 v110, v122, s44, v67
    v_mad_u32_u24 v67, v122, 40, v121
    v_mad_i32_i24 v31, v120, s39, v31
    v_lshlrev_b16 v67, 2, v67
    v_mad_i32_i24 v120, v121, -3, v120
    ds_add_u32 v67, v3 offset:0
    v_lshl_or_b32 v31, v110, 16, v31
    v_lshl_or_b32 v31, v120, 30, v31
    v_lshrrev_b32 v118, 3, v117
    v_lshrrev_b32 v119, 8, v117
    v_lshlrev_b16 v117, 13, v117
    v_bitop3_b32 v119, v118, v119, v124 bitop3:0x1b
    v_bitop3_b32 v30, v117, v125, v30 bitop3:0xae
    v_lshl_or_b32 v66, v119, 16, v66
    v_bitop3_b32 v31, v118, v125, v31 bitop3:0xae
    v_bitop3_b32 v67, v119, v126, v67 bitop3:0xea
p1_k12:
    s_cmp_ge_u32 s29, 1279
    s_cbranch_scc1 p1_k14
    s_waitcnt vmcnt(2)
    v_lshlrev_b32 v117, 16, v90
    v_and_b32 v118, v126, v90
    v_mul_f32 v117, v123, v117
    v_mul_f32 v118, v123, v118
    v_cvt_pk_bf16_f32 v117, v117, v118
    v_and_b32 v118, v126, v117
    v_lshlrev_b32 v117, 16, v117
    v_mul_f32 v117, 0.15915494, v117
    v_mul_f32 v118, 0.15915494, v118
    v_fract_f32 v117, v117
    v_fract_f32 v118, v118
    v_cos_f32 v117, v117
    v_cos_f32 v118, v118
    v_mul_hi_u32_u24 v122, s38, v68
    v_mul_hi_u32_u24 v121, s37, v32
    v_mul_hi_u32_u24 v120, s36, v32
    v_mad_i32_i24 v110, v122, s44, v68
    v_mad_u32_u24 v68, v122, 40, v121
    v_mad_i32_i24 v32, v120, s39, v32
    v_lshlrev_b16 v68, 2, v68
    v_mad_i32_i24 v120, v121, -3, v120
    ds_add_u32 v68, v3 offset:0
    v_lshl_or_b32 v32, v110, 16, v32
    v_lshl_or_b32 v32, v120, 30, v32
    v_mul_f32 v117, 0x03800000, v117
    v_mul_f32 v118, 0x03800000, v118
    v_cvt_pk_bf16_f32 v117, v117, v118
    v_mul_hi_u32_u24 v122, s38, v69
    v_mul_hi_u32_u24 v121, s37, v33
    v_mul_hi_u32_u24 v120, s36, v33
    v_mad_i32_i24 v110, v122, s44, v69
    v_mad_u32_u24 v69, v122, 40, v121
    v_mad_i32_i24 v33, v120, s39, v33
    v_lshlrev_b16 v69, 2, v69
    v_mad_i32_i24 v120, v121, -3, v120
    ds_add_u32 v69, v3 offset:0
    v_lshl_or_b32 v33, v110, 16, v33
    v_lshl_or_b32 v33, v120, 30, v33
    v_lshrrev_b32 v118, 3, v117
    v_lshrrev_b32 v119, 8, v117
    v_lshlrev_b16 v117, 13, v117
    v_bitop3_b32 v119, v118, v119, v124 bitop3:0x1b
    v_bitop3_b32 v32, v117, v125, v32 bitop3:0xae
    v_lshl_or_b32 v68, v119, 16, v68
    v_bitop3_b32 v33, v118, v125, v33 bitop3:0xae
    v_bitop3_b32 v69, v119, v126, v69 bitop3:0xea
    v_lshlrev_b32 v117, 16, v91
    v_and_b32 v118, v126, v91
    v_mul_f32 v117, v123, v117
    v_mul_f32 v118, v123, v118
    v_cvt_pk_bf16_f32 v117, v117, v118
    v_and_b32 v118, v126, v117
    v_lshlrev_b32 v117, 16, v117
    v_mul_f32 v117, 0.15915494, v117
    v_mul_f32 v118, 0.15915494, v118
    v_fract_f32 v117, v117
    v_fract_f32 v118, v118
    v_cos_f32 v117, v117
    v_cos_f32 v118, v118
    v_mul_hi_u32_u24 v122, s38, v70
    v_mul_hi_u32_u24 v121, s37, v34
    v_mul_hi_u32_u24 v120, s36, v34
    v_mad_i32_i24 v110, v122, s44, v70
    v_mad_u32_u24 v70, v122, 40, v121
    v_mad_i32_i24 v34, v120, s39, v34
    v_lshlrev_b16 v70, 2, v70
    v_mad_i32_i24 v120, v121, -3, v120
    ds_add_u32 v70, v3 offset:0
    v_lshl_or_b32 v34, v110, 16, v34
    v_lshl_or_b32 v34, v120, 30, v34
    v_mul_f32 v117, 0x03800000, v117
    v_mul_f32 v118, 0x03800000, v118
    v_cvt_pk_bf16_f32 v117, v117, v118
    v_mul_hi_u32_u24 v122, s38, v71
    v_mul_hi_u32_u24 v121, s37, v35
    v_mul_hi_u32_u24 v120, s36, v35
    v_mad_i32_i24 v110, v122, s44, v71
    v_mad_u32_u24 v71, v122, 40, v121
    v_mad_i32_i24 v35, v120, s39, v35
    v_lshlrev_b16 v71, 2, v71
    v_mad_i32_i24 v120, v121, -3, v120
    ds_add_u32 v71, v3 offset:0
    v_lshl_or_b32 v35, v110, 16, v35
    v_lshl_or_b32 v35, v120, 30, v35
    v_lshrrev_b32 v118, 3, v117
    v_lshrrev_b32 v119, 8, v117
    v_lshlrev_b16 v117, 13, v117
    v_bitop3_b32 v119, v118, v119, v124 bitop3:0x1b
    v_bitop3_b32 v34, v117, v125, v34 bitop3:0xae
    v_lshl_or_b32 v70, v119, 16, v70
    v_bitop3_b32 v35, v118, v125, v35 bitop3:0xae
    v_bitop3_b32 v71, v119, v126, v71 bitop3:0xea
p1_k14:
    s_cmp_ge_u32 s29, 1242
    s_cbranch_scc1 p1_k16
    s_waitcnt vmcnt(0)
    v_lshlrev_b32 v117, 16, v92
    v_and_b32 v118, v126, v92
    v_mul_f32 v117, v123, v117
    v_mul_f32 v118, v123, v118
    v_cvt_pk_bf16_f32 v117, v117, v118
    v_and_b32 v118, v126, v117
    v_lshlrev_b32 v117, 16, v117
    v_mul_f32 v117, 0.15915494, v117
    v_mul_f32 v118, 0.15915494, v118
    v_fract_f32 v117, v117
    v_fract_f32 v118, v118
    v_cos_f32 v117, v117
    v_cos_f32 v118, v118
    v_mul_hi_u32_u24 v122, s38, v72
    v_mul_hi_u32_u24 v121, s37, v36
    v_mul_hi_u32_u24 v120, s36, v36
    v_mad_i32_i24 v110, v122, s44, v72
    v_mad_u32_u24 v72, v122, 40, v121
    v_mad_i32_i24 v36, v120, s39, v36
    v_lshlrev_b16 v72, 2, v72
    v_mad_i32_i24 v120, v121, -3, v120
    ds_add_u32 v72, v3 offset:0
    v_lshl_or_b32 v36, v110, 16, v36
    v_lshl_or_b32 v36, v120, 30, v36
    v_mul_f32 v117, 0x03800000, v117
    v_mul_f32 v118, 0x03800000, v118
    v_cvt_pk_bf16_f32 v117, v117, v118
    v_mul_hi_u32_u24 v122, s38, v73
    v_mul_hi_u32_u24 v121, s37, v37
    v_mul_hi_u32_u24 v120, s36, v37
    v_mad_i32_i24 v110, v122, s44, v73
    v_mad_u32_u24 v73, v122, 40, v121
    v_mad_i32_i24 v37, v120, s39, v37
    v_lshlrev_b16 v73, 2, v73
    v_mad_i32_i24 v120, v121, -3, v120
    ds_add_u32 v73, v3 offset:0
    v_lshl_or_b32 v37, v110, 16, v37
    v_lshl_or_b32 v37, v120, 30, v37
    v_lshrrev_b32 v118, 3, v117
    v_lshrrev_b32 v119, 8, v117
    v_lshlrev_b16 v117, 13, v117
    v_bitop3_b32 v119, v118, v119, v124 bitop3:0x1b
    v_bitop3_b32 v36, v117, v125, v36 bitop3:0xae
    v_lshl_or_b32 v72, v119, 16, v72
    v_bitop3_b32 v37, v118, v125, v37 bitop3:0xae
    v_bitop3_b32 v73, v119, v126, v73 bitop3:0xea
    v_lshlrev_b32 v117, 16, v93
    v_and_b32 v118, v126, v93
    v_mul_f32 v117, v123, v117
    v_mul_f32 v118, v123, v118
    v_cvt_pk_bf16_f32 v117, v117, v118
    v_and_b32 v118, v126, v117
    v_lshlrev_b32 v117, 16, v117
    v_mul_f32 v117, 0.15915494, v117
    v_mul_f32 v118, 0.15915494, v118
    v_fract_f32 v117, v117
    v_fract_f32 v118, v118
    v_cos_f32 v117, v117
    v_cos_f32 v118, v118
    v_mul_hi_u32_u24 v122, s38, v74
    v_mul_hi_u32_u24 v121, s37, v38
    v_mul_hi_u32_u24 v120, s36, v38
    v_mad_i32_i24 v110, v122, s44, v74
    v_mad_u32_u24 v74, v122, 40, v121
    v_mad_i32_i24 v38, v120, s39, v38
    v_lshlrev_b16 v74, 2, v74
    v_mad_i32_i24 v120, v121, -3, v120
    ds_add_u32 v74, v3 offset:0
    v_lshl_or_b32 v38, v110, 16, v38
    v_lshl_or_b32 v38, v120, 30, v38
    v_mul_f32 v117, 0x03800000, v117
    v_mul_f32 v118, 0x03800000, v118
    v_cvt_pk_bf16_f32 v117, v117, v118
    v_mul_hi_u32_u24 v122, s38, v75
    v_mul_hi_u32_u24 v121, s37, v39
    v_mul_hi_u32_u24 v120, s36, v39
    v_mad_i32_i24 v110, v122, s44, v75
    v_mad_u32_u24 v75, v122, 40, v121
    v_mad_i32_i24 v39, v120, s39, v39
    v_lshlrev_b16 v75, 2, v75
    v_mad_i32_i24 v120, v121, -3, v120
    ds_add_u32 v75, v3 offset:0
    v_lshl_or_b32 v39, v110, 16, v39
    v_lshl_or_b32 v39, v120, 30, v39
    v_lshrrev_b32 v118, 3, v117
    v_lshrrev_b32 v119, 8, v117
    v_lshlrev_b16 v117, 13, v117
    v_bitop3_b32 v119, v118, v119, v124 bitop3:0x1b
    v_bitop3_b32 v38, v117, v125, v38 bitop3:0xae
    v_lshl_or_b32 v74, v119, 16, v74
    v_bitop3_b32 v39, v118, v125, v39 bitop3:0xae
    v_bitop3_b32 v75, v119, v126, v75 bitop3:0xea
p1_k16:
    s_waitcnt vmcnt(0)
    s_cmp_lg_u32 s28, 15
    s_cbranch_scc1 p1_tk1
    v_mov_b32 v126, 0
    s_mov_b64 exec, 1
    ds_write_b32 v126, v127 offset:10456
    s_mov_b64 exec, -1
p1_tk1:
    s_waitcnt lgkmcnt(0)
    s_barrier
    s_cmp_ge_u32 s28, 10
    s_cbranch_scc1 p1_s1_skip
    v_and_b32 v126, 63, v0
    s_lshl_b32 s54, s28, 4
    v_mul_u32_u24 v117, 160, v126
    v_add_u32 v117, s54, v117
    ds_read_b128 v[118:121], v117 offset:0
    s_waitcnt lgkmcnt(0)
    v_add_u32 v118, 2, v118
    v_add_u32 v119, 2, v119
    v_add_u32 v120, 2, v120
    v_add_u32 v121, 2, v121
    v_mul_u32_u24 v118, 43691, v118
    v_mul_u32_u24 v119, 43691, v119
    v_mul_u32_u24 v120, 43691, v120
    v_mul_u32_u24 v121, 43691, v121
    v_lshrrev_b32 v118, 17, v118
    v_lshrrev_b32 v119, 17, v119
    v_lshrrev_b32 v120, 17, v120
    v_lshrrev_b32 v121, 17, v121
    v_lshl_or_b32 v122, v119, 16, v118
    v_lshl_or_b32 v123, v121, 16, v120
    v_mov_b32 v124, v122
    v_mov_b32 v125, v123
    s_nop 1
    v_add_u32_dpp v124, v124, v124 row_shr:1 row_mask:0xf bank_mask:0xf bound_ctrl:0
    v_add_u32_dpp v125, v125, v125 row_shr:1 row_mask:0xf bank_mask:0xf bound_ctrl:0
    s_nop 0
    v_add_u32_dpp v124, v124, v124 row_shr:2 row_mask:0xf bank_mask:0xf bound_ctrl:0
    v_add_u32_dpp v125, v125, v125 row_shr:2 row_mask:0xf bank_mask:0xf bound_ctrl:0
    s_nop 0
    v_add_u32_dpp v124, v124, v124 row_shr:4 row_mask:0xf bank_mask:0xf bound_ctrl:0
    v_add_u32_dpp v125, v125, v125 row_shr:4 row_mask:0xf bank_mask:0xf bound_ctrl:0
    s_nop 0
    v_add_u32_dpp v124, v124, v124 row_shr:8 row_mask:0xf bank_mask:0xf bound_ctrl:0
    v_add_u32_dpp v125, v125, v125 row_shr:8 row_mask:0xf bank_mask:0xf bound_ctrl:0
    s_nop 0
    v_add_u32_dpp v124, v124, v124 row_bcast:15 row_mask:0xa bank_mask:0xf
    v_add_u32_dpp v125, v125, v125 row_bcast:15 row_mask:0xa bank_mask:0xf
    s_nop 0
    v_add_u32_dpp v124, v124, v124 row_bcast:31 row_mask:0xc bank_mask:0xf
    v_add_u32_dpp v125, v125, v125 row_bcast:31 row_mask:0xc bank_mask:0xf
    s_nop 0
    s_nop 0
    v_mov_b32 v127, s54
    v_and_b32 v118, 0xffff, v124
    v_lshrrev_b32 v119, 16, v124
    v_and_b32 v120, 0xffff, v125
    v_lshrrev_b32 v121, 16, v125
    s_mov_b64 exec, 1
    s_lshl_b64 exec, exec, 63
    ds_write_b128 v127, v[118:121] offset:10240
    s_mov_b64 exec, -1
p1_s1_skip:
    s_waitcnt lgkmcnt(0)
    s_barrier
    v_and_b32 v127, 63, v0
    v_lshlrev_b32 v118, 2, v127
    v_cmp_gt_u32 vcc, 40, v127
    ds_read_b32 v119, v118 offset:10240
    s_waitcnt lgkmcnt(0)
    v_readlane_b32 s33, v119, 54
    v_cndmask_b32 v119, 0, v119, vcc
    v_mov_b32 v120, v119
    s_nop 1
    v_add_u32_dpp v120, v120, v120 row_shr:1 row_mask:0xf bank_mask:0xf bound_ctrl:0
    s_nop 1
    v_add_u32_dpp v120, v120, v120 row_shr:2 row_mask:0xf bank_mask:0xf bound_ctrl:0
    s_nop 1
    v_add_u32_dpp v120, v120, v120 row_shr:4 row_mask:0xf bank_mask:0xf bound_ctrl:0
    s_nop 1
    v_add_u32_dpp v120, v120, v120 row_shr:8 row_mask:0xf bank_mask:0xf bound_ctrl:0
    s_nop 1
    v_add_u32_dpp v120, v120, v120 row_bcast:15 row_mask:0xa bank_mask:0xf
    s_nop 1
    v_add_u32_dpp v120, v120, v120 row_bcast:31 row_mask:0xc bank_mask:0xf
    s_nop 1
    s_nop 0
    v_sub_u32 v119, v120, v119
    v_readlane_b32 s35, v120, 63
    s_add_u32 s33, s33, 256
    s_mul_i32 s46, s33, 1
    s_min_u32 s47, s33, 1499
    s_add_u32 s46, s46, s47
    s_min_u32 s47, s33, 1462
    s_add_u32 s46, s46, s47
    s_min_u32 s47, s33, 1426
    s_add_u32 s46, s46, s47
    s_min_u32 s47, s33, 1389
    s_add_u32 s46, s46, s47
    s_min_u32 s47, s33, 1352
    s_add_u32 s46, s46, s47
    s_min_u32 s47, s33, 1315
    s_add_u32 s46, s46, s47
    s_min_u32 s47, s33, 1279
    s_add_u32 s46, s46, s47
    s_min_u32 s47, s33, 1242
    s_add_u32 s46, s46, s47
    s_lshl_b32 s30, s46, 14
    s_lshl_b32 s31, s46, 13
    s_cmp_ge_u32 s28, 10
    s_cbranch_scc1 p1_s2_skip
    s_lshl_b32 s54, s28, 2
    s_add_u32 s55, s54, 0
    v_readlane_b32 s56, v119, s55
    s_add_u32 s55, s54, 1
    v_readlane_b32 s57, v119, s55
    s_add_u32 s55, s54, 2
    v_readlane_b32 s58, v119, s55
    s_add_u32 s55, s54, 3
    v_readlane_b32 s59, v119, s55
    s_nop 0
    s_lshl_b32 s57, s57, 16
    s_or_b32 s56, s56, s57
    s_lshl_b32 s59, s59, 16
    s_or_b32 s58, s58, s59
    v_add_u32 v124, s56, v124
    v_add_u32 v125, s58, v125
    v_sub_u32 v122, v124, v122
    v_sub_u32 v123, v125, v123
    v_and_b32 v118, 0xffff, v122
    v_lshrrev_b32 v119, 16, v122
    v_and_b32 v120, 0xffff, v123
    v_lshrrev_b32 v121, 16, v123
    v_mul_u32_u24 v118, 3, v118
    v_mul_u32_u24 v119, 3, v119
    v_mul_u32_u24 v120, 3, v120
    v_mul_u32_u24 v121, 3, v121
    ds_write_b128 v117, v[118:121] offset:0
    s_mul_i32 s55, s29, 5248
    s_mul_i32 s56, s28, 520
    s_add_u32 s55, s55, s56
    s_add_u32 s55, s55, 469762048
    v_lshlrev_b32 v127, 3, v126
    buffer_store_dwordx2 v[122:123], v127, s[16:19], s55 offen sc1
    s_mov_b64 exec, 1
    s_lshl_b64 exec, exec, 63
    buffer_store_dwordx2 v[124:125], v127, s[16:19], s55 offen offset:8 sc1
    s_mov_b64 exec, -1
p1_s2_skip:
    s_mul_i32 s50, s29, 16384
    s_lshr_b32 s52, s35, 10
    s_mul_i32 s52, s52, 33554432
    s_and_b32 s53, s35, 1023
    s_lshl_b32 s53, s53, 4
    s_add_u32 s52, s52, s53
    s_add_u32 s52, s52, s50
    s_min_u32 s22, s52, 469762048
    s_mov_b32 s68, 0
    s_cmp_lt_u32 s29, 1242
    s_cselect_b32 s35, 13994, s35
    s_waitcnt lgkmcnt(0)
    s_barrier
    s_cmp_lt_u32 s33, 1536
    s_cbranch_scc1 p1_f0
    s_cmp_lg_u32 s28, 15
    s_cbranch_scc1 p1_hv0
    s_sub_u32 s52, s33, 1536
    s_and_b32 s52, s52, 255
    s_lshl_b32 s58, s52, 2
    s_and_b32 s58, s58, 28
    s_lshl_b32 s53, 1, s58
    v_mov_b32 v127, s53
    s_lshr_b32 s52, s52, 3
    s_lshl_b32 s52, s52, 2
    s_mov_b64 exec, 1
    buffer_atomic_add v127, off, s[40:43], s52 sc0 sc1
    s_mov_b64 exec, -1
p1_hv0:
    s_cmp_ge_u32 s33, 1656
    s_cbranch_scc1 p1_f0
    s_sub_u32 s52, s33, 1536
    s_mul_i32 s52, s52, 53368
    s_mul_i32 s53, s28, 3072
    s_add_u32 s53, s53, s52
    v_and_b32 v92, 63, v0
    v_lshl_add_u32 v93, v92, 2, s53
    s_lshl_b32 s53, s28, 9
    s_add_u32 s53, s53, s52
    s_add_u32 s53, s53, 49152
    s_cmp_lt_u32 s28, 9
    s_cselect_b32 s53, s53, 0x40000000
    v_lshl_add_u32 v94, v92, 2, s53
    buffer_load_dword v76, v93, s[24:27], 0 offen offset:0
    buffer_load_dword v77, v93, s[24:27], 0 offen offset:256
    buffer_load_dword v78, v93, s[24:27], 0 offen offset:512
    buffer_load_dword v79, v93, s[24:27], 0 offen offset:768
    buffer_load_dword v80, v93, s[24:27], 0 offen offset:1024
    buffer_load_dword v81, v93, s[24:27], 0 offen offset:1280
    buffer_load_dword v82, v93, s[24:27], 0 offen offset:1536
    buffer_load_dword v83, v93, s[24:27], 0 offen offset:1792
    buffer_load_dword v84, v93, s[24:27], 0 offen offset:2048
    buffer_load_dword v85, v93, s[24:27], 0 offen offset:2304
    buffer_load_dword v86, v93, s[24:27], 0 offen offset:2560
    buffer_load_dword v87, v93, s[24:27], 0 offen offset:2816
    buffer_load_dword v88, v94, s[24:27], 0 offen offset:0
    buffer_load_dword v89, v94, s[24:27], 0 offen offset:256
p1_f0:
    v_and_b32 v117, 0xffff, v40
    ds_add_rtn_u32 v117, v117, v3 offset:0
    v_and_b32 v118, 0xffff, v41
    ds_add_rtn_u32 v118, v118, v3 offset:0
    v_and_b32 v119, 0xffff, v42
    ds_add_rtn_u32 v119, v119, v3 offset:0
    v_and_b32 v120, 0xffff, v43
    ds_add_rtn_u32 v120, v120, v3 offset:0
    s_cmp_ge_u32 s33, 1536
    s_cbranch_scc1 p1_k18
    s_cmp_lt_u32 s33, 1536
    s_cselect_b32 s14, 102400000, 0
    s_add_u32 s32, s31, 0
    buffer_load_dwordx2 v[76:77], v2, s[12:15], s32 offen nt
p1_k18:
    s_cmp_ge_u32 s33, 1536
    s_cbranch_scc1 p1_k19
    s_cmp_lt_u32 s33, 1536
    s_cselect_b32 s6, 204800000, 0
    s_cselect_b32 s10, 204800000, 0
    s_add_u32 s32, s30, 0
    buffer_load_dwordx4 v[94:97], v1, s[4:7], s32 offen nt
    buffer_load_dwordx4 v[102:105], v1, s[8:11], s32 offen nt
p1_k19:
    s_cmp_lt_u32 s29, 1499
    s_cbranch_scc1 p1_pa0
    s_waitcnt lgkmcnt(0)
    s_branch p1_pb0
p1_pa0:
    v_and_b32 v121, 0xffff, v44
    ds_add_rtn_u32 v121, v121, v3 offset:0
    v_and_b32 v122, 0xffff, v45
    ds_add_rtn_u32 v122, v122, v3 offset:0
    v_and_b32 v123, 0xffff, v46
    ds_add_rtn_u32 v123, v123, v3 offset:0
    v_and_b32 v124, 0xffff, v47
    ds_add_rtn_u32 v124, v124, v3 offset:0
    s_waitcnt lgkmcnt(4)
p1_pb0:
    ds_write_b8_d16_hi v117, v40 offset:10496
    v_lshlrev_b32 v40, 2, v117
    ds_write_b32 v40, v4 offset:52480
    ds_write_b8_d16_hi v118, v41 offset:10496
    v_lshlrev_b32 v41, 2, v118
    ds_write_b32 v41, v5 offset:52480
    ds_write_b8_d16_hi v119, v42 offset:10496
    v_lshlrev_b32 v42, 2, v119
    ds_write_b32 v42, v6 offset:52480
    ds_write_b8_d16_hi v120, v43 offset:10496
    v_lshlrev_b32 v43, 2, v120
    ds_write_b32 v43, v7 offset:52480
    s_cmp_ge_u32 s33, 1536
    s_cbranch_scc1 p1_k20
    s_cmp_lt_u32 s33, 1499
    s_cselect_b32 s14, 102400000, 0
    s_add_u32 s32, s31, 8192
    buffer_load_dwordx2 v[78:79], v2, s[12:15], s32 offen nt
p1_k20:
    s_cmp_lt_u32 s29, 1462
    s_cbranch_scc1 p1_pa1
    s_waitcnt lgkmcnt(0)
    s_branch p1_pb1
p1_pa1:
    v_and_b32 v117, 0xffff, v48
    ds_add_rtn_u32 v117, v117, v3 offset:0
    v_and_b32 v118, 0xffff, v49
    ds_add_rtn_u32 v118, v118, v3 offset:0
    v_and_b32 v119, 0xffff, v50
    ds_add_rtn_u32 v119, v119, v3 offset:0
    v_and_b32 v120, 0xffff, v51
    ds_add_rtn_u32 v120, v120, v3 offset:0
    s_waitcnt lgkmcnt(4)
p1_pb1:
    s_cmp_ge_u32 s29, 1499
    s_cbranch_scc1 p1_k21
    ds_write_b8_d16_hi v121, v44 offset:10496
    v_lshlrev_b32 v44, 2, v121
    ds_write_b32 v44, v8 offset:52480
    ds_write_b8_d16_hi v122, v45 offset:10496
    v_lshlrev_b32 v45, 2, v122
    ds_write_b32 v45, v9 offset:52480
    ds_write_b8_d16_hi v123, v46 offset:10496
    v_lshlrev_b32 v46, 2, v123
    ds_write_b32 v46, v10 offset:52480
    ds_write_b8_d16_hi v124, v47 offset:10496
    v_lshlrev_b32 v47, 2, v124
    ds_write_b32 v47, v11 offset:52480
p1_k21:
    s_cmp_ge_u32 s33, 1536
    s_cbranch_scc1 p1_k22
    s_cmp_lt_u32 s33, 1462
    s_cselect_b32 s14, 102400000, 0
    s_add_u32 s32, s31, 16384
    buffer_load_dwordx2 v[80:81], v2, s[12:15], s32 offen nt
p1_k22:
    s_cmp_lt_u32 s29, 1426
    s_cbranch_scc1 p1_pa2
    s_waitcnt lgkmcnt(0)
    s_branch p1_pb2
p1_pa2:
    v_and_b32 v121, 0xffff, v52
    ds_add_rtn_u32 v121, v121, v3 offset:0
    v_and_b32 v122, 0xffff, v53
    ds_add_rtn_u32 v122, v122, v3 offset:0
    v_and_b32 v123, 0xffff, v54
    ds_add_rtn_u32 v123, v123, v3 offset:0
    v_and_b32 v124, 0xffff, v55
    ds_add_rtn_u32 v124, v124, v3 offset:0
    s_waitcnt lgkmcnt(4)
p1_pb2:
    s_cmp_ge_u32 s29, 1462
    s_cbranch_scc1 p1_k23
    ds_write_b8_d16_hi v117, v48 offset:10496
    v_lshlrev_b32 v48, 2, v117
    ds_write_b32 v48, v12 offset:52480
    ds_write_b8_d16_hi v118, v49 offset:10496
    v_lshlrev_b32 v49, 2, v118
    ds_write_b32 v49, v13 offset:52480
    ds_write_b8_d16_hi v119, v50 offset:10496
    v_lshlrev_b32 v50, 2, v119
    ds_write_b32 v50, v14 offset:52480
    ds_write_b8_d16_hi v120, v51 offset:10496
    v_lshlrev_b32 v51, 2, v120
    ds_write_b32 v51, v15 offset:52480
p1_k23:
    s_cmp_ge_u32 s28, 10
    s_cbranch_scc1 p1_jn
    s_cmp_lt_u32 s33, 1536
    s_cbranch_scc1 p1_w24
    s_waitcnt vmcnt(0)
p1_w24:
    s_waitcnt vmcnt(5)
    v_mov_b32 v125, 0
    s_mov_b64 exec, 1
    ds_add_rtn_u32 v125, v125, v3 offset:10432
    s_waitcnt lgkmcnt(0)
    v_readfirstlane_b32 s52, v125
    s_lshr_b32 s53, s29, 1
    s_and_b32 s53, s53, 28
    s_cmp_lg_u32 s52, 9
    s_cbranch_scc1 p1_jn1
    s_lshl_b32 s54, 1, s53
    v_mov_b32 v127, s54
    s_lshr_b32 s54, s29, 6
    s_lshl_b32 s54, s54, 2
    s_mov_b32 s68, 1
    buffer_atomic_add v127, off, s[40:43], s54 sc0 sc1
p1_jn1:
    s_mov_b64 exec, -1
p1_jn:
    s_cmp_ge_u32 s33, 1536
    s_cbranch_scc1 p1_k25
    s_cmp_lt_u32 s33, 1426
    s_cselect_b32 s14, 102400000, 0
    s_add_u32 s32, s31, 24576
    buffer_load_dwordx2 v[82:83], v2, s[12:15], s32 offen nt
p1_k25:
    s_cmp_lt_u32 s29, 1389
    s_cbranch_scc1 p1_pa3
    s_waitcnt lgkmcnt(0)
    s_branch p1_pb3
p1_pa3:
    v_and_b32 v117, 0xffff, v56
    ds_add_rtn_u32 v117, v117, v3 offset:0
    v_and_b32 v118, 0xffff, v57
    ds_add_rtn_u32 v118, v118, v3 offset:0
    v_and_b32 v119, 0xffff, v58
    ds_add_rtn_u32 v119, v119, v3 offset:0
    v_and_b32 v120, 0xffff, v59
    ds_add_rtn_u32 v120, v120, v3 offset:0
    s_waitcnt lgkmcnt(4)
p1_pb3:
    s_cmp_ge_u32 s29, 1426
    s_cbranch_scc1 p1_k26
    ds_write_b8_d16_hi v121, v52 offset:10496
    v_lshlrev_b32 v52, 2, v121
    ds_write_b32 v52, v16 offset:52480
    ds_write_b8_d16_hi v122, v53 offset:10496
    v_lshlrev_b32 v53, 2, v122
    ds_write_b32 v53, v17 offset:52480
    ds_write_b8_d16_hi v123, v54 offset:10496
    v_lshlrev_b32 v54, 2, v123
    ds_write_b32 v54, v18 offset:52480
    ds_write_b8_d16_hi v124, v55 offset:10496
    v_lshlrev_b32 v55, 2, v124
    ds_write_b32 v55, v19 offset:52480
p1_k26:
    s_cmp_ge_u32 s33, 1536
    s_cbranch_scc1 p1_k27
    s_cmp_lt_u32 s33, 1389
    s_cselect_b32 s14, 102400000, 0
    s_add_u32 s32, s31, 32768
    buffer_load_dwordx2 v[84:85], v2, s[12:15], s32 offen nt
p1_k27:
    s_cmp_ge_u32 s33, 1536
    s_cbranch_scc1 p1_k28
    s_cmp_lt_u32 s33, 1499
    s_cselect_b32 s6, 204800000, 0
    s_cselect_b32 s10, 204800000, 0
    s_add_u32 s32, s30, 16384
    buffer_load_dwordx4 v[98:101], v1, s[4:7], s32 offen nt
    buffer_load_dwordx4 v[106:109], v1, s[8:11], s32 offen nt
p1_k28:
    s_cmp_lt_u32 s29, 1352
    s_cbranch_scc1 p1_pa4
    s_waitcnt lgkmcnt(0)
    s_branch p1_pb4
p1_pa4:
    v_and_b32 v121, 0xffff, v60
    ds_add_rtn_u32 v121, v121, v3 offset:0
    v_and_b32 v122, 0xffff, v61
    ds_add_rtn_u32 v122, v122, v3 offset:0
    v_and_b32 v123, 0xffff, v62
    ds_add_rtn_u32 v123, v123, v3 offset:0
    v_and_b32 v124, 0xffff, v63
    ds_add_rtn_u32 v124, v124, v3 offset:0
    s_waitcnt lgkmcnt(4)
p1_pb4:
    s_cmp_ge_u32 s29, 1389
    s_cbranch_scc1 p1_k29
    ds_write_b8_d16_hi v117, v56 offset:10496
    v_lshlrev_b32 v56, 2, v117
    ds_write_b32 v56, v20 offset:52480
    ds_write_b8_d16_hi v118, v57 offset:10496
    v_lshlrev_b32 v57, 2, v118
    ds_write_b32 v57, v21 offset:52480
    ds_write_b8_d16_hi v119, v58 offset:10496
    v_lshlrev_b32 v58, 2, v119
    ds_write_b32 v58, v22 offset:52480
    ds_write_b8_d16_hi v120, v59 offset:10496
    v_lshlrev_b32 v59, 2, v120
    ds_write_b32 v59, v23 offset:52480
p1_k29:
    s_cmp_ge_u32 s33, 1536
    s_cbranch_scc1 p1_k30
    s_cmp_lt_u32 s33, 1352
    s_cselect_b32 s14, 102400000, 0
    s_add_u32 s32, s31, 40960
    buffer_load_dwordx2 v[86:87], v2, s[12:15], s32 offen nt
p1_k30:
    s_cmp_lt_u32 s29, 1315
    s_cbranch_scc1 p1_pa5
    s_waitcnt lgkmcnt(0)
    s_branch p1_pb5
p1_pa5:
    v_and_b32 v117, 0xffff, v64
    ds_add_rtn_u32 v117, v117, v3 offset:0
    v_and_b32 v118, 0xffff, v65
    ds_add_rtn_u32 v118, v118, v3 offset:0
    v_and_b32 v119, 0xffff, v66
    ds_add_rtn_u32 v119, v119, v3 offset:0
    v_and_b32 v120, 0xffff, v67
    ds_add_rtn_u32 v120, v120, v3 offset:0
    s_waitcnt lgkmcnt(4)
p1_pb5:
    s_cmp_ge_u32 s29, 1352
    s_cbranch_scc1 p1_k31
    ds_write_b8_d16_hi v121, v60 offset:10496
    v_lshlrev_b32 v60, 2, v121
    ds_write_b32 v60, v24 offset:52480
    ds_write_b8_d16_hi v122, v61 offset:10496
    v_lshlrev_b32 v61, 2, v122
    ds_write_b32 v61, v25 offset:52480
    ds_write_b8_d16_hi v123, v62 offset:10496
    v_lshlrev_b32 v62, 2, v123
    ds_write_b32 v62, v26 offset:52480
    ds_write_b8_d16_hi v124, v63 offset:10496
    v_lshlrev_b32 v63, 2, v124
    ds_write_b32 v63, v27 offset:52480
p1_k31:
    s_cmp_ge_u32 s33, 1536
    s_cbranch_scc1 p1_k32
    s_cmp_lt_u32 s33, 1315
    s_cselect_b32 s14, 102400000, 0
    s_add_u32 s32, s31, 49152
    buffer_load_dwordx2 v[88:89], v2, s[12:15], s32 offen nt
p1_k32:
    s_cmp_lt_u32 s29, 1279
    s_cbranch_scc1 p1_pa6
    s_waitcnt lgkmcnt(0)
    s_branch p1_pb6
p1_pa6:
    v_and_b32 v121, 0xffff, v68
    ds_add_rtn_u32 v121, v121, v3 offset:0
    v_and_b32 v122, 0xffff, v69
    ds_add_rtn_u32 v122, v122, v3 offset:0
    v_and_b32 v123, 0xffff, v70
    ds_add_rtn_u32 v123, v123, v3 offset:0
    v_and_b32 v124, 0xffff, v71
    ds_add_rtn_u32 v124, v124, v3 offset:0
    s_waitcnt lgkmcnt(4)
p1_pb6:
    s_cmp_ge_u32 s29, 1315
    s_cbranch_scc1 p1_k33
    ds_write_b8_d16_hi v117, v64 offset:10496
    v_lshlrev_b32 v64, 2, v117
    ds_write_b32 v64, v28 offset:52480
    ds_write_b8_d16_hi v118, v65 offset:10496
    v_lshlrev_b32 v65, 2, v118
    ds_write_b32 v65, v29 offset:52480
    ds_write_b8_d16_hi v119, v66 offset:10496
    v_lshlrev_b32 v66, 2, v119
    ds_write_b32 v66, v30 offset:52480
    ds_write_b8_d16_hi v120, v67 offset:10496
    v_lshlrev_b32 v67, 2, v120
    ds_write_b32 v67, v31 offset:52480
p1_k33:
    s_cmp_ge_u32 s33, 1536
    s_cbranch_scc1 p1_k34
    s_cmp_lt_u32 s33, 1279
    s_cselect_b32 s14, 102400000, 0
    s_add_u32 s32, s31, 57344
    buffer_load_dwordx2 v[90:91], v2, s[12:15], s32 offen nt
p1_k34:
    s_cmp_lt_u32 s29, 1242
    s_cbranch_scc1 p1_pa7
    s_waitcnt lgkmcnt(0)
    s_branch p1_pb7
p1_pa7:
    v_and_b32 v117, 0xffff, v72
    ds_add_rtn_u32 v117, v117, v3 offset:0
    v_and_b32 v118, 0xffff, v73
    ds_add_rtn_u32 v118, v118, v3 offset:0
    v_and_b32 v119, 0xffff, v74
    ds_add_rtn_u32 v119, v119, v3 offset:0
    v_and_b32 v120, 0xffff, v75
    ds_add_rtn_u32 v120, v120, v3 offset:0
    s_waitcnt lgkmcnt(4)
p1_pb7:
    s_cmp_ge_u32 s29, 1279
    s_cbranch_scc1 p1_k35
    ds_write_b8_d16_hi v121, v68 offset:10496
    v_lshlrev_b32 v68, 2, v121
    ds_write_b32 v68, v32 offset:52480
    ds_write_b8_d16_hi v122, v69 offset:10496
    v_lshlrev_b32 v69, 2, v122
    ds_write_b32 v69, v33 offset:52480
    ds_write_b8_d16_hi v123, v70 offset:10496
    v_lshlrev_b32 v70, 2, v123
    ds_write_b32 v70, v34 offset:52480
    ds_write_b8_d16_hi v124, v71 offset:10496
    v_lshlrev_b32 v71, 2, v124
    ds_write_b32 v71, v35 offset:52480
p1_k35:
    s_cmp_ge_u32 s33, 1536
    s_cbranch_scc1 p1_k36
    s_cmp_lt_u32 s33, 1242
    s_cselect_b32 s14, 102400000, 0
    s_add_u32 s32, s31, 65536
    buffer_load_dwordx2 v[92:93], v2, s[12:15], s32 offen nt
p1_k36:
    s_waitcnt lgkmcnt(0)
    s_cmp_ge_u32 s29, 1242
    s_cbranch_scc1 p1_k37
    ds_write_b8_d16_hi v117, v72 offset:10496
    v_lshlrev_b32 v72, 2, v117
    ds_write_b32 v72, v36 offset:52480
    ds_write_b8_d16_hi v118, v73 offset:10496
    v_lshlrev_b32 v73, 2, v118
    ds_write_b32 v73, v37 offset:52480
    ds_write_b8_d16_hi v119, v74 offset:10496
    v_lshlrev_b32 v74, 2, v119
    ds_write_b32 v74, v38 offset:52480
    ds_write_b8_d16_hi v120, v75 offset:10496
    v_lshlrev_b32 v75, 2, v120
    ds_write_b32 v75, v39 offset:52480
p1_k37:
    s_cmp_eq_u32 s68, 0
    s_cbranch_scc1 p1_sg
    s_cmp_lt_u32 s33, 1536
    s_cbranch_scc1 p1_w38
    s_waitcnt vmcnt(0)
p1_w38:
    s_waitcnt vmcnt(8)
    v_bfe_u32 v127, v127, s53, 4
    v_mov_b32 v125, 0
    s_mov_b64 exec, 1
    ds_write_b32 v125, v127 offset:10452
    s_mov_b64 exec, -1
p1_sg:
    s_cmp_lt_u32 s33, 1536
    s_cbranch_scc1 p1_f1
    s_cmp_lg_u32 s28, 15
    s_cbranch_scc1 p1_hv1
    s_waitcnt vmcnt(0)
    v_bfe_u32 v127, v127, s58, 4
    v_mov_b32 v125, 0
    s_mov_b64 exec, 1
    ds_write_b32 v125, v127 offset:10448
    s_mov_b64 exec, -1
p1_hv1:
    s_cmp_ge_u32 s33, 1656
    s_cbranch_scc1 p1_f1
    s_sub_u32 s52, s33, 1536
    s_mul_i32 s53, s52, 53760
    s_add_u32 s53, s53, 485810176
    s_mul_i32 s54, s28, 3072
    v_lshl_add_u32 v93, v92, 4, s54
    s_lshl_b32 s54, s28, 9
    s_add_u32 s54, s54, 49152
    s_cmp_lt_u32 s28, 9
    s_cselect_b32 s54, s54, 0x40000000
    v_lshl_add_u32 v94, v92, 3, s54
    v_mov_b32 v96, 0
    v_mov_b32 v97, 0
    s_waitcnt vmcnt(0)
    buffer_store_dwordx4 v[76:79], v93, s[16:19], s53 offen offset:0
    buffer_store_dwordx4 v[80:83], v93, s[16:19], s53 offen offset:1024
    buffer_store_dwordx4 v[84:87], v93, s[16:19], s53 offen offset:2048
    buffer_store_dwordx2 v[88:89], v94, s[16:19], s53 offen
    v_and_b32 v98, 0x7fff7fff, v76
    v_pk_max_u16 v96, v96, v98
    v_lshlrev_b32 v99, 16, v98
    v_and_b32 v98, 0xffff0000, v98
    v_fmac_f32 v97, v99, v99
    v_fmac_f32 v97, v98, v98
    v_and_b32 v98, 0x7fff7fff, v77
    v_pk_max_u16 v96, v96, v98
    v_lshlrev_b32 v99, 16, v98
    v_and_b32 v98, 0xffff0000, v98
    v_fmac_f32 v97, v99, v99
    v_fmac_f32 v97, v98, v98
    v_and_b32 v98, 0x7fff7fff, v78
    v_pk_max_u16 v96, v96, v98
    v_lshlrev_b32 v99, 16, v98
    v_and_b32 v98, 0xffff0000, v98
    v_fmac_f32 v97, v99, v99
    v_fmac_f32 v97, v98, v98
    v_and_b32 v98, 0x7fff7fff, v79
    v_pk_max_u16 v96, v96, v98
    v_lshlrev_b32 v99, 16, v98
    v_and_b32 v98, 0xffff0000, v98
    v_fmac_f32 v97, v99, v99
    v_fmac_f32 v97, v98, v98
    v_and_b32 v98, 0x7fff7fff, v80
    v_pk_max_u16 v96, v96, v98
    v_lshlrev_b32 v99, 16, v98
    v_and_b32 v98, 0xffff0000, v98
    v_fmac_f32 v97, v99, v99
    v_fmac_f32 v97, v98, v98
    v_and_b32 v98, 0x7fff7fff, v81
    v_pk_max_u16 v96, v96, v98
    v_lshlrev_b32 v99, 16, v98
    v_and_b32 v98, 0xffff0000, v98
    v_fmac_f32 v97, v99, v99
    v_fmac_f32 v97, v98, v98
    v_and_b32 v98, 0x7fff7fff, v82
    v_pk_max_u16 v96, v96, v98
    v_lshlrev_b32 v99, 16, v98
    v_and_b32 v98, 0xffff0000, v98
    v_fmac_f32 v97, v99, v99
    v_fmac_f32 v97, v98, v98
    v_and_b32 v98, 0x7fff7fff, v83
    v_pk_max_u16 v96, v96, v98
    v_lshlrev_b32 v99, 16, v98
    v_and_b32 v98, 0xffff0000, v98
    v_fmac_f32 v97, v99, v99
    v_fmac_f32 v97, v98, v98
    v_and_b32 v98, 0x7fff7fff, v84
    v_pk_max_u16 v96, v96, v98
    v_lshlrev_b32 v99, 16, v98
    v_and_b32 v98, 0xffff0000, v98
    v_fmac_f32 v97, v99, v99
    v_fmac_f32 v97, v98, v98
    v_and_b32 v98, 0x7fff7fff, v85
    v_pk_max_u16 v96, v96, v98
    v_lshlrev_b32 v99, 16, v98
    v_and_b32 v98, 0xffff0000, v98
    v_fmac_f32 v97, v99, v99
    v_fmac_f32 v97, v98, v98
    v_and_b32 v98, 0x7fff7fff, v86
    v_pk_max_u16 v96, v96, v98
    v_lshlrev_b32 v99, 16, v98
    v_and_b32 v98, 0xffff0000, v98
    v_fmac_f32 v97, v99, v99
    v_fmac_f32 v97, v98, v98
    v_and_b32 v98, 0x7fff7fff, v87
    v_pk_max_u16 v96, v96, v98
    v_lshlrev_b32 v99, 16, v98
    v_and_b32 v98, 0xffff0000, v98
    v_fmac_f32 v97, v99, v99
    v_fmac_f32 v97, v98, v98
    v_and_b32 v98, 0x7fff7fff, v88
    v_pk_max_u16 v96, v96, v98
    v_lshlrev_b32 v99, 16, v98
    v_and_b32 v98, 0xffff0000, v98
    v_fmac_f32 v97, v99, v99
    v_fmac_f32 v97, v98, v98
    v_and_b32 v98, 0x7fff7fff, v89
    v_pk_max_u16 v96, v96, v98
    v_lshlrev_b32 v99, 16, v98
    v_and_b32 v98, 0xffff0000, v98
    v_fmac_f32 v97, v99, v99
    v_fmac_f32 v97, v98, v98
    v_lshrrev_b32 v98, 16, v96
    v_and_b32 v96, 0xffff, v96
    v_max_u32 v96, v96, v98
    s_nop 1
    v_max_u32_dpp v96, v96, v96 row_shr:1 row_mask:0xf bank_mask:0xf bound_ctrl:0
    v_add_f32_dpp v97, v97, v97 row_shr:1 row_mask:0xf bank_mask:0xf bound_ctrl:0
    s_nop 0
    v_max_u32_dpp v96, v96, v96 row_shr:2 row_mask:0xf bank_mask:0xf bound_ctrl:0
    v_add_f32_dpp v97, v97, v97 row_shr:2 row_mask:0xf bank_mask:0xf bound_ctrl:0
    s_nop 0
    v_max_u32_dpp v96, v96, v96 row_shr:4 row_mask:0xf bank_mask:0xf bound_ctrl:0
    v_add_f32_dpp v97, v97, v97 row_shr:4 row_mask:0xf bank_mask:0xf bound_ctrl:0
    s_nop 0
    v_max_u32_dpp v96, v96, v96 row_shr:8 row_mask:0xf bank_mask:0xf bound_ctrl:0
    v_add_f32_dpp v97, v97, v97 row_shr:8 row_mask:0xf bank_mask:0xf bound_ctrl:0
    s_nop 0
    v_max_u32_dpp v96, v96, v96 row_bcast:15 row_mask:0xa bank_mask:0xf
    v_add_f32_dpp v97, v97, v97 row_bcast:15 row_mask:0xa bank_mask:0xf
    s_nop 0
    v_max_u32_dpp v96, v96, v96 row_bcast:31 row_mask:0xc bank_mask:0xf
    v_add_f32_dpp v97, v97, v97 row_bcast:31 row_mask:0xc bank_mask:0xf
    s_nop 0
    s_nop 0
    s_lshl_b32 s52, s52, 4
    s_add_u32 s52, s52, s28
    s_lshl_b32 s52, s52, 3
    s_add_u32 s52, s52, 492261376
    s_mov_b64 exec, 1
    s_lshl_b64 exec, exec, 63
    buffer_store_dwordx2 v[96:97], off, s[16:19], s52
    s_mov_b64 exec, -1
p1_f1:
    s_waitcnt lgkmcnt(0)
    s_barrier
    v_mul_u32_u24 v119, 3, v0
    v_and_b32 v118, -4, v119
    v_add_u32 v120, s50, v1
    v_mov_b32 v122, 0
    v_mov_b32 v123, 0
    v_mov_b32 v124, 0
    v_mov_b32 v125, 0
    ds_read_b64 v[126:127], v122 offset:10448
    ds_write_b32 v122, v122 offset:10432
    v_cmp_gt_u32 vcc, 640, v0
    s_and_saveexec_b64 s[52:53], vcc
    ds_write_b128 v1, v[122:125] offset:0
    s_mov_b64 exec, -1
    s_waitcnt lgkmcnt(2)
    v_readfirstlane_b32 s70, v126
    v_readfirstlane_b32 s69, v127
    s_cmp_ge_u32 s33, 1536
    s_cselect_b32 s70, s70, 0
    s_cmp_gt_u32 s28, 10
    s_cselect_b32 s69, 0, s69
    s_cselect_b32 s70, 0, s70
    s_cmp_lg_u32 s70, 8
    s_cbranch_scc1 p1_h0
    s_sub_u32 s52, s33, 1536
    v_and_b32 v102, 63, v0
    s_cmp_eq_u32 s28, 10
    s_cbranch_scc1 p1_tr10
    s_mul_i32 s53, s28, 520
    v_lshl_add_u32 v100, v102, 3, s53
    s_mul_i32 s53, s28, 4160
    v_lshl_add_u32 v101, v102, 4, s53
    s_branch p1_tr20
p1_tr10:
    v_mul_u32_u24 v100, 520, v102
    v_add_u32 v100, 512, v100
    v_mul_u32_u24 v101, 4160, v102
    v_add_u32 v101, 1024, v101
    v_cmp_gt_u32 vcc, 10, v102
    v_mov_b32 v102, 0x40000000
    s_nop 0
    v_cndmask_b32 v100, v102, v100, vcc
    v_cndmask_b32 v101, v102, v101, vcc
p1_tr20:
    s_mul_i32 s52, s52, 41984
    s_add_u32 s52, s52, 469762048
    buffer_load_dwordx2 v[76:77], v100, s[16:19], s52 offen sc1
    s_add_u32 s52, s52, 5248
    buffer_load_dwordx2 v[78:79], v100, s[16:19], s52 offen sc1
    s_add_u32 s52, s52, 5248
    buffer_load_dwordx2 v[80:81], v100, s[16:19], s52 offen sc1
    s_add_u32 s52, s52, 5248
    buffer_load_dwordx2 v[82:83], v100, s[16:19], s52 offen sc1
    s_add_u32 s52, s52, 5248
    buffer_load_dwordx2 v[84:85], v100, s[16:19], s52 offen sc1
    s_add_u32 s52, s52, 5248
    buffer_load_dwordx2 v[86:87], v100, s[16:19], s52 offen sc1
    s_add_u32 s52, s52, 5248
    buffer_load_dwordx2 v[88:89], v100, s[16:19], s52 offen sc1
    s_add_u32 s52, s52, 5248
    buffer_load_dwordx2 v[90:91], v100, s[16:19], s52 offen sc1
    s_add_u32 s52, s52, 5248
p1_h0:
    v_lshlrev_b32 v117, 2, v119
    v_add_u32 v117, 52480, v117
    ds_read_b32 v110, v117 offset:0
    ds_read_b32 v111, v117 offset:4
    ds_read_b32 v112, v117 offset:8
    ds_read_b32 v113, v118 offset:10496
    ds_read_b32 v114, v118 offset:10500
    ds_read_b32 v122, v117 offset:12288
    ds_read_b32 v123, v117 offset:12292
    ds_read_b32 v124, v117 offset:12296
    ds_read_b32 v125, v118 offset:13568
    ds_read_b32 v121, v118 offset:13572
    s_waitcnt lgkmcnt(5)
    v_alignbyte_b32 v113, v114, v113, v119
    buffer_store_dwordx4 v[110:113], v120, s[20:23], 0 offen
    v_add_u32 v120, 33554432, v120
    s_nop 0
    ds_read_b32 v110, v117 offset:24576
    ds_read_b32 v111, v117 offset:24580
    ds_read_b32 v112, v117 offset:24584
    ds_read_b32 v113, v118 offset:16640
    ds_read_b32 v114, v118 offset:16644
    s_cmp_le_u32 s35, 1024
    s_cbranch_scc1 p1_ce0
    s_waitcnt lgkmcnt(5)
    v_alignbyte_b32 v125, v121, v125, v119
    buffer_store_dwordx4 v[122:125], v120, s[20:23], 0 offen
    v_add_u32 v120, 33554432, v120
    s_nop 0
    ds_read_b32 v122, v117 offset:36864
    ds_read_b32 v123, v117 offset:36868
    ds_read_b32 v124, v117 offset:36872
    ds_read_b32 v125, v118 offset:19712
    ds_read_b32 v121, v118 offset:19716
    s_cmp_le_u32 s35, 2048
    s_cbranch_scc1 p1_ce0
    s_waitcnt lgkmcnt(5)
    v_alignbyte_b32 v113, v114, v113, v119
    buffer_store_dwordx4 v[110:113], v120, s[20:23], 0 offen
    v_add_u32 v120, 33554432, v120
    s_nop 0
    ds_read_b32 v110, v117 offset:49152
    ds_read_b32 v111, v117 offset:49156
    ds_read_b32 v112, v117 offset:49160
    ds_read_b32 v113, v118 offset:22784
    ds_read_b32 v114, v118 offset:22788
    s_cmp_le_u32 s35, 3072
    s_cbranch_scc1 p1_ce0
    s_waitcnt lgkmcnt(5)
    v_alignbyte_b32 v125, v121, v125, v119
    buffer_store_dwordx4 v[122:125], v120, s[20:23], 0 offen
    v_add_u32 v120, 33554432, v120
    s_nop 0
    v_lshlrev_b32 v117, 2, v119
    v_add_u32 v117, 113920, v117
    ds_read_b32 v122, v117 offset:0
    ds_read_b32 v123, v117 offset:4
    ds_read_b32 v124, v117 offset:8
    ds_read_b32 v125, v118 offset:25856
    ds_read_b32 v121, v118 offset:25860
    s_cmp_le_u32 s35, 4096
    s_cbranch_scc1 p1_ce0
    s_waitcnt lgkmcnt(5)
    v_alignbyte_b32 v113, v114, v113, v119
    buffer_store_dwordx4 v[110:113], v120, s[20:23], 0 offen
    v_add_u32 v120, 33554432, v120
    s_nop 0
    ds_read_b32 v110, v117 offset:12288
    ds_read_b32 v111, v117 offset:12292
    ds_read_b32 v112, v117 offset:12296
    ds_read_b32 v113, v118 offset:28928
    ds_read_b32 v114, v118 offset:28932
    s_cmp_le_u32 s35, 5120
    s_cbranch_scc1 p1_ce0
    s_waitcnt lgkmcnt(5)
    v_alignbyte_b32 v125, v121, v125, v119
    buffer_store_dwordx4 v[122:125], v120, s[20:23], 0 offen
    v_add_u32 v120, 33554432, v120
    s_nop 0
    ds_read_b32 v122, v117 offset:24576
    ds_read_b32 v123, v117 offset:24580
    ds_read_b32 v124, v117 offset:24584
    ds_read_b32 v125, v118 offset:32000
    ds_read_b32 v121, v118 offset:32004
    s_cmp_le_u32 s35, 6144
    s_cbranch_scc1 p1_ce0
    s_waitcnt lgkmcnt(5)
    v_alignbyte_b32 v113, v114, v113, v119
    buffer_store_dwordx4 v[110:113], v120, s[20:23], 0 offen
    v_add_u32 v120, 33554432, v120
    s_nop 0
    ds_read_b32 v110, v117 offset:36864
    ds_read_b32 v111, v117 offset:36868
    ds_read_b32 v112, v117 offset:36872
    ds_read_b32 v113, v118 offset:35072
    ds_read_b32 v114, v118 offset:35076
    s_cmp_le_u32 s35, 7168
    s_cbranch_scc1 p1_ce0
    s_waitcnt lgkmcnt(5)
    v_alignbyte_b32 v125, v121, v125, v119
    buffer_store_dwordx4 v[122:125], v120, s[20:23], 0 offen nt
    v_add_u32 v120, 33554432, v120
    s_nop 0
    s_cmp_le_u32 s35, 8192
    s_cbranch_scc1 p1_ce0
    s_waitcnt lgkmcnt(0)
    v_alignbyte_b32 v113, v114, v113, v119
    buffer_store_dwordx4 v[110:113], v120, s[20:23], 0 offen nt
    v_add_u32 v120, 33554432, v120
    s_nop 0
p1_ce0:
    s_waitcnt lgkmcnt(0)
    s_cmp_lg_u32 s70, 8
    s_cbranch_scc1 p1_h1
    s_sub_u32 s52, s33, 1536
    s_mul_i32 s52, s52, 41600
    s_add_u32 s52, s52, 477822976
    s_mov_b32 s54, 0x05040100
    s_mov_b32 s55, 0x07060302
    s_waitcnt vmcnt(1)
    v_perm_b32 v92, v78, v76, s54
    v_perm_b32 v93, v82, v80, s54
    v_perm_b32 v94, v86, v84, s54
    v_perm_b32 v95, v90, v88, s54
    buffer_store_dwordx4 v[92:95], v101, s[16:19], s52 offen offset:0
    v_perm_b32 v96, v78, v76, s55
    v_perm_b32 v97, v82, v80, s55
    v_perm_b32 v98, v86, v84, s55
    v_perm_b32 v99, v90, v88, s55
    buffer_store_dwordx4 v[96:99], v101, s[16:19], s52 offen offset:1040
    v_perm_b32 v92, v79, v77, s54
    v_perm_b32 v93, v83, v81, s54
    v_perm_b32 v94, v87, v85, s54
    v_perm_b32 v95, v91, v89, s54
    buffer_store_dwordx4 v[92:95], v101, s[16:19], s52 offen offset:2080
    v_perm_b32 v96, v79, v77, s55
    v_perm_b32 v97, v83, v81, s55
    v_perm_b32 v98, v87, v85, s55
    v_perm_b32 v99, v91, v89, s55
    buffer_store_dwordx4 v[96:99], v101, s[16:19], s52 offen offset:3120
p1_h1:
    s_barrier
    s_cmp_ge_u32 s29, 1462
    s_cbranch_scc1 p1_k39
    s_cmp_le_u32 s35, 9216
    s_cbranch_scc1 p1_s1k2
    v_sub_u32 v48, 221180, v48
    ds_write_b32 v48, v12 offset:52480
    v_sub_u32 v49, 221180, v49
    ds_write_b32 v49, v13 offset:52480
    v_sub_u32 v50, 221180, v50
    ds_write_b32 v50, v14 offset:52480
    v_sub_u32 v51, 221180, v51
    ds_write_b32 v51, v15 offset:52480
p1_s1k2:
p1_k39:
    s_cmp_ge_u32 s33, 1536
    s_cbranch_scc1 p1_k40
    s_cmp_lt_u32 s33, 1462
    s_cselect_b32 s6, 204800000, 0
    s_cselect_b32 s10, 204800000, 0
    s_add_u32 s32, s30, 32768
    buffer_load_dwordx4 v[12:15], v1, s[4:7], s32 offen nt
    buffer_load_dwordx4 v[48:51], v1, s[8:11], s32 offen nt
p1_k40:
    s_cmp_ge_u32 s29, 1426
    s_cbranch_scc1 p1_k41
    s_cmp_le_u32 s35, 9216
    s_cbranch_scc1 p1_s1k3
    v_sub_u32 v52, 221180, v52
    ds_write_b32 v52, v16 offset:52480
    v_sub_u32 v53, 221180, v53
    ds_write_b32 v53, v17 offset:52480
    v_sub_u32 v54, 221180, v54
    ds_write_b32 v54, v18 offset:52480
    v_sub_u32 v55, 221180, v55
    ds_write_b32 v55, v19 offset:52480
p1_s1k3:
p1_k41:
    s_cmp_ge_u32 s29, 1389
    s_cbranch_scc1 p1_k42
    s_cmp_le_u32 s35, 9216
    s_cbranch_scc1 p1_s1k4
    v_sub_u32 v56, 221180, v56
    ds_write_b32 v56, v20 offset:52480
    v_sub_u32 v57, 221180, v57
    ds_write_b32 v57, v21 offset:52480
    v_sub_u32 v58, 221180, v58
    ds_write_b32 v58, v22 offset:52480
    v_sub_u32 v59, 221180, v59
    ds_write_b32 v59, v23 offset:52480
p1_s1k4:
p1_k42:
    s_cmp_ge_u32 s29, 1352
    s_cbranch_scc1 p1_k43
    s_cmp_le_u32 s35, 9216
    s_cbranch_scc1 p1_s1k5
    v_sub_u32 v60, 221180, v60
    ds_write_b32 v60, v24 offset:52480
    v_sub_u32 v61, 221180, v61
    ds_write_b32 v61, v25 offset:52480
    v_sub_u32 v62, 221180, v62
    ds_write_b32 v62, v26 offset:52480
    v_sub_u32 v63, 221180, v63
    ds_write_b32 v63, v27 offset:52480
p1_s1k5:
p1_k43:
    s_cmp_ge_u32 s29, 1315
    s_cbranch_scc1 p1_k44
    s_cmp_le_u32 s35, 9216
    s_cbranch_scc1 p1_s1k6
    v_sub_u32 v64, 221180, v64
    ds_write_b32 v64, v28 offset:52480
    v_sub_u32 v65, 221180, v65
    ds_write_b32 v65, v29 offset:52480
    v_sub_u32 v66, 221180, v66
    ds_write_b32 v66, v30 offset:52480
    v_sub_u32 v67, 221180, v67
    ds_write_b32 v67, v31 offset:52480
p1_s1k6:
p1_k44:
    s_cmp_ge_u32 s29, 1279
    s_cbranch_scc1 p1_k45
    s_cmp_le_u32 s35, 9216
    s_cbranch_scc1 p1_s1k7
    v_sub_u32 v68, 221180, v68
    ds_write_b32 v68, v32 offset:52480
    v_sub_u32 v69, 221180, v69
    ds_write_b32 v69, v33 offset:52480
    v_sub_u32 v70, 221180, v70
    ds_write_b32 v70, v34 offset:52480
    v_sub_u32 v71, 221180, v71
    ds_write_b32 v71, v35 offset:52480
p1_s1k7:
p1_k45:
    s_cmp_ge_u32 s29, 1242
    s_cbranch_scc1 p1_k46
    s_cmp_le_u32 s35, 9216
    s_cbranch_scc1 p1_s1k8
    v_sub_u32 v72, 221180, v72
    ds_write_b32 v72, v36 offset:52480
    v_sub_u32 v73, 221180, v73
    ds_write_b32 v73, v37 offset:52480
    v_sub_u32 v74, 221180, v74
    ds_write_b32 v74, v38 offset:52480
    v_sub_u32 v75, 221180, v75
    ds_write_b32 v75, v39 offset:52480
p1_s1k8:
p1_k46:
    s_cmp_le_u32 s35, 9216
    s_cbranch_scc1 p1_s1k0
    v_sub_u32 v40, 221180, v40
    ds_write_b32 v40, v4 offset:52480
    v_sub_u32 v41, 221180, v41
    ds_write_b32 v41, v5 offset:52480
    v_sub_u32 v42, 221180, v42
    ds_write_b32 v42, v6 offset:52480
    v_sub_u32 v43, 221180, v43
    ds_write_b32 v43, v7 offset:52480
p1_s1k0:
    s_cmp_ge_u32 s29, 1499
    s_cbranch_scc1 p1_k47
    s_cmp_le_u32 s35, 9216
    s_cbranch_scc1 p1_s1k1
    v_sub_u32 v44, 221180, v44
    ds_write_b32 v44, v8 offset:52480
    v_sub_u32 v45, 221180, v45
    ds_write_b32 v45, v9 offset:52480
    v_sub_u32 v46, 221180, v46
    ds_write_b32 v46, v10 offset:52480
    v_sub_u32 v47, 221180, v47
    ds_write_b32 v47, v11 offset:52480
p1_s1k1:
p1_k47:
    s_cmp_lg_u32 s69, 8
    s_cbranch_scc1 p1_o1
    s_lshr_b32 s52, s29, 3
    v_and_b32 v74, 63, v0
    s_cmp_eq_u32 s28, 10
    s_cbranch_scc1 p1_tr11
    s_mul_i32 s53, s28, 520
    v_lshl_add_u32 v72, v74, 3, s53
    s_mul_i32 s53, s28, 4160
    v_lshl_add_u32 v73, v74, 4, s53
    s_branch p1_tr21
p1_tr11:
    v_mul_u32_u24 v72, 520, v74
    v_add_u32 v72, 512, v72
    v_mul_u32_u24 v73, 4160, v74
    v_add_u32 v73, 1024, v73
    v_cmp_gt_u32 vcc, 10, v74
    v_mov_b32 v74, 0x40000000
    s_nop 0
    v_cndmask_b32 v72, v74, v72, vcc
    v_cndmask_b32 v73, v74, v73, vcc
p1_tr21:
    s_mul_i32 s52, s52, 41984
    s_add_u32 s52, s52, 469762048
    buffer_load_dwordx2 v[24:25], v72, s[16:19], s52 offen sc1
    s_add_u32 s52, s52, 5248
    buffer_load_dwordx2 v[26:27], v72, s[16:19], s52 offen sc1
    s_add_u32 s52, s52, 5248
    buffer_load_dwordx2 v[28:29], v72, s[16:19], s52 offen sc1
    s_add_u32 s52, s52, 5248
    buffer_load_dwordx2 v[30:31], v72, s[16:19], s52 offen sc1
    s_add_u32 s52, s52, 5248
    buffer_load_dwordx2 v[32:33], v72, s[16:19], s52 offen sc1
    s_add_u32 s52, s52, 5248
    buffer_load_dwordx2 v[34:35], v72, s[16:19], s52 offen sc1
    s_add_u32 s52, s52, 5248
    buffer_load_dwordx2 v[36:37], v72, s[16:19], s52 offen sc1
    s_add_u32 s52, s52, 5248
    buffer_load_dwordx2 v[38:39], v72, s[16:19], s52 offen sc1
    s_add_u32 s52, s52, 5248
    s_cmp_ge_u32 s33, 1536
    s_cbranch_scc1 p1_o1
    s_lshr_b32 s52, s29, 3
    s_mul_i32 s52, s52, 41600
    s_add_u32 s52, s52, 477822976
    s_mov_b32 s54, 0x05040100
    s_mov_b32 s55, 0x07060302
    s_waitcnt vmcnt(0)
    v_perm_b32 v64, v26, v24, s54
    v_perm_b32 v65, v30, v28, s54
    v_perm_b32 v66, v34, v32, s54
    v_perm_b32 v67, v38, v36, s54
    buffer_store_dwordx4 v[64:67], v73, s[16:19], s52 offen offset:0
    v_perm_b32 v68, v26, v24, s55
    v_perm_b32 v69, v30, v28, s55
    v_perm_b32 v70, v34, v32, s55
    v_perm_b32 v71, v38, v36, s55
    buffer_store_dwordx4 v[68:71], v73, s[16:19], s52 offen offset:1040
    v_perm_b32 v64, v27, v25, s54
    v_perm_b32 v65, v31, v29, s54
    v_perm_b32 v66, v35, v33, s54
    v_perm_b32 v67, v39, v37, s54
    buffer_store_dwordx4 v[64:67], v73, s[16:19], s52 offen offset:2080
    v_perm_b32 v68, v27, v25, s55
    v_perm_b32 v69, v31, v29, s55
    v_perm_b32 v70, v35, v33, s55
    v_perm_b32 v71, v39, v37, s55
    buffer_store_dwordx4 v[68:71], v73, s[16:19], s52 offen offset:3120
    s_mov_b32 s69, 0
p1_o1:
    s_waitcnt lgkmcnt(0)
    s_barrier
    s_cmp_le_u32 s35, 9216
    s_cbranch_scc1 p1_ce1
    v_lshlrev_b32 v117, 2, v119
    v_sub_u32 v117, 113908, v117
    ds_read_b32 v122, v117 offset:49160
    ds_read_b32 v123, v117 offset:49156
    ds_read_b32 v124, v117 offset:49152
    ds_read_b32 v125, v118 offset:38144
    ds_read_b32 v121, v118 offset:38148
    ds_read_b32 v110, v117 offset:36872
    ds_read_b32 v111, v117 offset:36868
    ds_read_b32 v112, v117 offset:36864
    ds_read_b32 v113, v118 offset:41216
    ds_read_b32 v114, v118 offset:41220
    s_waitcnt lgkmcnt(5)
    v_alignbyte_b32 v125, v121, v125, v119
    buffer_store_dwordx4 v[122:125], v120, s[20:23], 0 offen nt
    v_add_u32 v120, 33554432, v120
    s_nop 0
    ds_read_b32 v122, v117 offset:24584
    ds_read_b32 v123, v117 offset:24580
    ds_read_b32 v124, v117 offset:24576
    ds_read_b32 v125, v118 offset:44288
    ds_read_b32 v121, v118 offset:44292
    s_cmp_le_u32 s35, 10240
    s_cbranch_scc1 p1_ce1
    s_waitcnt lgkmcnt(5)
    v_alignbyte_b32 v113, v114, v113, v119
    buffer_store_dwordx4 v[110:113], v120, s[20:23], 0 offen nt
    v_add_u32 v120, 33554432, v120
    s_nop 0
    ds_read_b32 v110, v117 offset:12296
    ds_read_b32 v111, v117 offset:12292
    ds_read_b32 v112, v117 offset:12288
    ds_read_b32 v113, v118 offset:47360
    ds_read_b32 v114, v118 offset:47364
    s_cmp_le_u32 s35, 11264
    s_cbranch_scc1 p1_ce1
    s_waitcnt lgkmcnt(5)
    v_alignbyte_b32 v125, v121, v125, v119
    buffer_store_dwordx4 v[122:125], v120, s[20:23], 0 offen nt
    v_add_u32 v120, 33554432, v120
    s_nop 0
    ds_read_b32 v122, v117 offset:8
    ds_read_b32 v123, v117 offset:4
    ds_read_b32 v124, v117 offset:0
    ds_read_b32 v125, v118 offset:50432
    ds_read_b32 v121, v118 offset:50436
    s_cmp_le_u32 s35, 12288
    s_cbranch_scc1 p1_ce1
    s_waitcnt lgkmcnt(5)
    v_alignbyte_b32 v113, v114, v113, v119
    buffer_store_dwordx4 v[110:113], v120, s[20:23], 0 offen nt
    v_add_u32 v120, 33554432, v120
    s_nop 0
    s_cmp_le_u32 s35, 13312
    s_cbranch_scc1 p1_ce1
    s_waitcnt lgkmcnt(0)
    v_alignbyte_b32 v125, v121, v125, v119
    buffer_store_dwordx4 v[122:125], v120, s[20:23], 0 offen nt
    v_add_u32 v120, 33554432, v120
    s_nop 0
p1_ce1:
    s_waitcnt lgkmcnt(0)
    s_cmp_lg_u32 s69, 8
    s_cbranch_scc1 p1_o2
    s_lshr_b32 s52, s29, 3
    s_mul_i32 s52, s52, 41600
    s_add_u32 s52, s52, 477822976
    s_mov_b32 s54, 0x05040100
    s_mov_b32 s55, 0x07060302
    s_waitcnt vmcnt(0)
    v_perm_b32 v64, v26, v24, s54
    v_perm_b32 v65, v30, v28, s54
    v_perm_b32 v66, v34, v32, s54
    v_perm_b32 v67, v38, v36, s54
    buffer_store_dwordx4 v[64:67], v73, s[16:19], s52 offen offset:0
    v_perm_b32 v68, v26, v24, s55
    v_perm_b32 v69, v30, v28, s55
    v_perm_b32 v70, v34, v32, s55
    v_perm_b32 v71, v38, v36, s55
    buffer_store_dwordx4 v[68:71], v73, s[16:19], s52 offen offset:1040
    v_perm_b32 v64, v27, v25, s54
    v_perm_b32 v65, v31, v29, s54
    v_perm_b32 v66, v35, v33, s54
    v_perm_b32 v67, v39, v37, s54
    buffer_store_dwordx4 v[64:67], v73, s[16:19], s52 offen offset:2080
    v_perm_b32 v68, v27, v25, s55
    v_perm_b32 v69, v31, v29, s55
    v_perm_b32 v70, v35, v33, s55
    v_perm_b32 v71, v39, v37, s55
    buffer_store_dwordx4 v[68:71], v73, s[16:19], s52 offen offset:3120
p1_o2:
    s_barrier
    s_mov_b32 s29, s33
    s_cmp_lt_u32 s29, 1242
    s_cselect_b32 s34, 1, 0
    s_cmp_lt_u32 s29, 1536
    s_cbranch_scc1 p1_tile
p1_end:
    s_endpgm
.globl p2_kernel
.p2align 8
.type p2_kernel,@function
p2_kernel:
    s_cmp_ge_u32 s2, 256
    s_cbranch_scc1 p2_end
    s_load_dwordx2 s[8:9], s[0:1], 104
    v_and_b32 v112, 63, v0
    v_lshrrev_b32 v122, 6, v0
    v_lshlrev_b32 v112, 4, v112
    v_readfirstlane_b32 s10, v122
    v_mov_b32 v113, 0x83ff0000
    s_and_b32 s44, s2, 7
    s_lshr_b32 s11, s44, 1
    s_and_b32 s44, s44, 1
    s_lshl_b32 s12, s44, 5
    s_lshr_b32 s44, s2, 3
    s_add_u32 s12, s12, s44
    s_mov_b32 s25, 54272
    s_mov_b32 s31, 67175170
    s_mov_b32 s32, 83952386
    s_mov_b32 s33, 100729602
    s_mov_b32 s21, 0
    s_mul_i32 s23, s10, 3072
    s_lshl_b32 s24, s10, 9
    s_lshl_b32 s64, s10, 10
    s_sub_u32 s42, s24, s23
    s_add_u32 s42, s42, 49152
    s_movk_i32 s63, 2048
    s_mul_i32 s62, s11, 161280
    s_add_u32 s62, s62, 485810176
    s_add_u32 s62, s62, s23
    s_mov_b32 s40, 477822976
    s_mul_i32 s44, s11, 1040
    s_add_u32 s40, s40, s44
    s_lshl_b32 s44, s12, 4
    s_add_u32 s40, s40, s44
    s_waitcnt lgkmcnt(0)
    s_mov_b32 s4, s8
    s_and_b32 s5, s9, 0xffff
    s_mov_b32 s6, 819200000
    s_mov_b32 s7, 0x20000
    s_mov_b32 s68, s8
    s_and_b32 s69, s9, 0xffff
    s_mov_b32 s70, 469762048
    s_mov_b32 s71, 0x20000
    s_and_b32 s44, s2, 7
    s_lshl_b32 s44, s44, 2
    s_lshr_b32 s18, 0x00000000, s44
    s_and_b32 s18, s18, 15
p2_restart:
    s_mov_b32 s61, 0
    s_add_u32 s44, s61, s18
    s_cmp_ge_u32 s44, 10
    s_cselect_b32 s53, 10, 0
    s_sub_u32 s44, s44, s53
    s_mul_i32 s44, s44, 4160
    s_add_u32 s44, s44, s40
    v_bfe_i32 v111, v112, 6, 1
    v_lshrrev_b32 v110, 6, v112
    v_bitop3_b32 v111, v111, 15, s10 bitop3:0x6a
    v_lshl_or_b32 v110, v110, 4, v111
    v_bfe_u32 v111, v112, 2, 4
    v_mul_u32_u24 v110, 41600, v110
    v_add_u32 v111, v110, v111
    v_add_u32 v110, 256, v112
    v_and_b32 v110, 0x400, v110
    v_lshl_or_b32 v111, v110, 20, v111
    buffer_load_dword v110, v111, s[4:7], s44 offen
    buffer_load_dword v111, v111, s[4:7], s44 offen offset:16
    s_mov_b32 s61, 1
    s_add_u32 s44, s61, s18
    s_cmp_ge_u32 s44, 10
    s_cselect_b32 s53, 10, 0
    s_sub_u32 s44, s44, s53
    s_mul_i32 s44, s44, 4160
    s_add_u32 s44, s44, s40
    v_bfe_i32 v69, v112, 6, 1
    v_lshrrev_b32 v68, 6, v112
    v_bitop3_b32 v69, v69, 15, s10 bitop3:0x6a
    v_lshl_or_b32 v68, v68, 4, v69
    v_bfe_u32 v69, v112, 2, 4
    v_mul_u32_u24 v68, 41600, v68
    v_add_u32 v69, v68, v69
    v_add_u32 v68, 256, v112
    v_and_b32 v68, 0x400, v68
    v_lshl_or_b32 v69, v68, 20, v69
    buffer_load_dword v68, v69, s[4:7], s44 offen
    buffer_load_dword v69, v69, s[4:7], s44 offen offset:16
    s_mov_b32 s61, 0
    s_cmp_lt_u32 s10, 15
    s_cselect_b32 s44, s64, 0x40000000
    v_add_u32 v60, s44, v112
    s_mov_b32 s44, 492261376
    buffer_load_dwordx4 v[60:63], v60, s[4:7], s44 offen
    s_mul_i32 s20, s18, 645120
    s_add_u32 s20, s20, s62
    s_cmp_ge_u32 s10, 9
    s_cbranch_scc1 p2_nmp
    v_lshrrev_b32 v84, 1, v112
    s_add_u32 s44, s20, s42
    buffer_load_dwordx2 v[84:85], v84, s[4:7], s44 offen
p2_nmp:
    buffer_load_dwordx4 v[72:75], v112, s[4:7], s20 offen offset:0
    buffer_load_dwordx4 v[76:79], v112, s[4:7], s20 offen offset:1024
    buffer_load_dwordx4 v[80:83], v112, s[4:7], s20 offen offset:2048
    s_barrier
    v_mov_b32 v115, 0
    v_mov_b32 v116, 0
    v_mov_b32 v117, 0
    v_mov_b32 v118, 0
    v_mov_b32 v119, 0
    v_mov_b32 v120, 0
    v_mov_b32 v121, 0
    ds_write_b128 v115, v[116:119] offset:53760
    s_mov_b32 s19, 0
    s_cmp_eq_u32 s21, 2
    s_cselect_b64 s[66:67], -1, 0
    s_waitcnt lgkmcnt(0)
    s_barrier
    s_waitcnt vmcnt(6)
    s_mov_b32 m0, s23
    v_mov_b32 v53, 0x3c000
    s_movk_i32 s44, 512
    v_sub_u32_sdwa v4, v111, v110 dst_sel:DWORD dst_unused:UNUSED_PAD src0_sel:WORD_0 src1_sel:WORD_0
    v_sub_u32_sdwa v5, v111, v110 dst_sel:DWORD dst_unused:UNUSED_PAD src0_sel:WORD_1 src1_sel:WORD_1
    v_med3_i32 v4, v4, 0, s44
    v_med3_i32 v5, v5, 0, s44
    v_add_u32 v48, v4, v5
    ds_write_addtid_b32 v53 offset:0
    ds_write_addtid_b32 v53 offset:256
    ds_write_addtid_b32 v53 offset:512
    ds_write_addtid_b32 v53 offset:768
    ds_write_addtid_b32 v53 offset:1024
    ds_write_addtid_b32 v53 offset:1280
    ds_write_addtid_b32 v53 offset:1536
    ds_write_addtid_b32 v53 offset:1792
    v_bfe_i32 v53, v112, 6, 1
    v_lshrrev_b32 v49, 6, v112
    v_bitop3_b32 v53, v53, 15, s10 bitop3:0x6a
    v_lshl_or_b32 v49, v49, 4, v53
    v_and_b32 v53, 0x30, v112
    v_lshl_or_b32 v53, v49, 6, v53
    v_lshlrev_b32 v53, 15, v53
    s_nop 1
    v_add_u32_dpp v48, v48, v48 row_shr:1 row_mask:0xf bank_mask:0xf bound_ctrl:0
    s_nop 1
    v_add_u32_dpp v48, v48, v48 row_shr:2 row_mask:0xf bank_mask:0xf bound_ctrl:0
    s_nop 1
    v_add_u32_dpp v48, v48, v48 row_shr:4 row_mask:0xf bank_mask:0xf bound_ctrl:0
    s_nop 1
    v_add_u32_dpp v48, v48, v48 row_shr:8 row_mask:0xf bank_mask:0xf bound_ctrl:0
    s_nop 1
    v_add_u32_dpp v48, v48, v48 row_bcast:15 row_mask:0xa bank_mask:0xf
    s_nop 1
    v_add_u32_dpp v48, v48, v48 row_bcast:31 row_mask:0xc bank_mask:0xf
    s_nop 1
    s_nop 0
    v_readlane_b32 s38, v48, 63
    v_sub_u32 v50, v48, v5
    v_sub_u32 v49, v50, v4
    v_sub_u32 v10, 512, v49
    v_mad_u32_u16 v51, v110, 16, v53
    v_med3_i32 v10, v10, 0, v4
    v_lshl_add_u32 v49, v49, 2, s23
    v_sub_u32 v11, 512, v50
    v_mad_u32_u16 v52, v110, 16, v53 op_sel:[1,0,0,0]
    v_med3_i32 v11, v11, 0, v5
    v_lshl_add_u32 v50, v50, 2, s23
    v_lshl_add_u32 v48, v11, 16, v10
    v_add_u32 v52, 262144, v52
    v_add_u32 v110, v110, v48
    s_min_u32 s17, s38, 512
    s_add_u32 s17, s17, 63
    s_lshr_b32 s17, s17, 6
p2_xa_0:
    v_cmpx_lt_i32 vcc, 0, v10
    s_cbranch_execz p2_ya_0
    ds_write_b32 v49, v51 offset:0
    v_add_u32 v51, 16, v51
    v_cmpx_lt_i32 vcc, 1, v10
    s_cbranch_execz p2_ya_0
    ds_write_b32 v49, v51 offset:4
    v_add_u32 v51, 16, v51
    v_cmpx_lt_i32 vcc, 2, v10
    s_cbranch_execz p2_ya_0
    ds_write_b32 v49, v51 offset:8
    v_add_u32 v51, 16, v51
    v_cmpx_lt_i32 vcc, 3, v10
    s_cbranch_execz p2_ya_0
    ds_write_b32 v49, v51 offset:12
    v_add_u32 v51, 16, v51
    v_cmpx_lt_i32 vcc, 4, v10
    s_cbranch_execz p2_ya_0
    ds_write_b32 v49, v51 offset:16
    v_add_u32 v51, 16, v51
    v_cmpx_lt_i32 vcc, 5, v10
    s_cbranch_execz p2_ya_0
    ds_write_b32 v49, v51 offset:20
    v_add_u32 v51, 16, v51
    v_cmpx_lt_i32 vcc, 6, v10
    s_cbranch_execz p2_ya_0
    ds_write_b32 v49, v51 offset:24
    v_add_u32 v51, 16, v51
    v_cmpx_lt_i32 vcc, 7, v10
    s_cbranch_execz p2_ya_0
    ds_write_b32 v49, v51 offset:28
    v_add_u32 v51, 16, v51
    v_subrev_u32 v10, 8, v10
    v_add_u32 v49, 32, v49
    s_branch p2_xa_0
p2_ya_0:
    s_mov_b64 exec, -1
p2_xa_1:
    v_cmpx_lt_i32 vcc, 0, v11
    s_cbranch_execz p2_ya_1
    ds_write_b32 v50, v52 offset:0
    v_add_u32 v52, 16, v52
    v_cmpx_lt_i32 vcc, 1, v11
    s_cbranch_execz p2_ya_1
    ds_write_b32 v50, v52 offset:4
    v_add_u32 v52, 16, v52
    v_cmpx_lt_i32 vcc, 2, v11
    s_cbranch_execz p2_ya_1
    ds_write_b32 v50, v52 offset:8
    v_add_u32 v52, 16, v52
    v_cmpx_lt_i32 vcc, 3, v11
    s_cbranch_execz p2_ya_1
    ds_write_b32 v50, v52 offset:12
    v_add_u32 v52, 16, v52
    v_cmpx_lt_i32 vcc, 4, v11
    s_cbranch_execz p2_ya_1
    ds_write_b32 v50, v52 offset:16
    v_add_u32 v52, 16, v52
    v_cmpx_lt_i32 vcc, 5, v11
    s_cbranch_execz p2_ya_1
    ds_write_b32 v50, v52 offset:20
    v_add_u32 v52, 16, v52
    v_cmpx_lt_i32 vcc, 6, v11
    s_cbranch_execz p2_ya_1
    ds_write_b32 v50, v52 offset:24
    v_add_u32 v52, 16, v52
    v_cmpx_lt_i32 vcc, 7, v11
    s_cbranch_execz p2_ya_1
    ds_write_b32 v50, v52 offset:28
    v_add_u32 v52, 16, v52
    v_subrev_u32 v11, 8, v11
    v_add_u32 v50, 32, v50
    s_branch p2_xa_1
p2_ya_1:
    s_mov_b64 exec, -1
    s_cmp_lt_u32 s38, 512
    s_cbranch_scc1 p2_nomorea
    v_cmp_lt_u32_sdwa s[44:45], v110, v111 src0_sel:WORD_0 src1_sel:WORD_0
    v_cmp_lt_u32_sdwa s[46:47], v110, v111 src0_sel:WORD_1 src1_sel:WORD_1
    s_nop 0
    s_or_b64 s[44:45], s[44:45], s[46:47]
    s_cbranch_scc0 p2_nomorea
    v_mov_b32 v49, s19
    v_mov_b32 v50, 1
    ds_write_b32 v49, v50 offset:53760
p2_nomorea:
    s_mov_b32 m0, s23
    s_nop 0
    ds_read_addtid_b32 v2 offset:0
    ds_read_addtid_b32 v8 offset:256
    ds_read_addtid_b32 v14 offset:512
    ds_read_addtid_b32 v20 offset:768
    ds_read_addtid_b32 v88 offset:1024
    ds_read_addtid_b32 v92 offset:1280
    ds_read_addtid_b32 v96 offset:1536
    ds_read_addtid_b32 v100 offset:1792
    s_waitcnt lgkmcnt(0)
    v_bfe_u32 v0, v2, 14, 4
    v_lshrrev_b32 v1, 18, v2
    v_and_b32 v2, 0x3fff, v2
    v_mad_u32_u24 v0, v0, s63, v1
    v_lshl_or_b32 v2, v0, 14, v2
    buffer_load_dwordx4 v[0:3], v2, s[68:71], 0 offen
    v_bfe_u32 v6, v8, 14, 4
    v_lshrrev_b32 v7, 18, v8
    v_and_b32 v8, 0x3fff, v8
    v_mad_u32_u24 v6, v6, s63, v7
    v_lshl_or_b32 v8, v6, 14, v8
    buffer_load_dwordx4 v[6:9], v8, s[68:71], 0 offen
    s_cmp_eq_u32 s21, 0
    s_cselect_b32 s44, 1073758208, 0
    v_mov_b32 v124, s44
    v_mov_b32 v125, s44
    v_mov_b32 v126, s44
    v_mov_b32 v127, s44
    v_add_u32 v123, s64, v112
    v_add_u32 v122, s25, v123
    ds_write_b128 v122, v[124:127] offset:0
    ds_write_b128 v122, v[124:127] offset:16384
    ds_write_b128 v122, v[124:127] offset:32768
    v_add_u32 v122, 49152, v122
    ds_write_b128 v122, v[124:127] offset:0
    ds_write_b128 v122, v[124:127] offset:16384
    ds_write_b128 v122, v[124:127] offset:32768
    v_cmpx_gt_u32 vcc, 1792, v123
    ds_write_b128 v122, v[124:127] offset:49152
    s_mov_b64 exec, -1
    v_bfe_u32 v12, v14, 14, 4
    v_lshrrev_b32 v13, 18, v14
    v_and_b32 v14, 0x3fff, v14
    v_mad_u32_u24 v12, v12, s63, v13
    v_lshl_or_b32 v14, v12, 14, v14
    buffer_load_dwordx4 v[12:15], v14, s[68:71], 0 offen
    s_mov_b32 s16, s17
    s_waitcnt vmcnt(6)
    s_cmp_lg_u32 s21, 0
    s_cbranch_scc1 p2_nostat1
    v_max_u32 v60, v60, v62
    v_add_f32 v61, v61, v63
    s_nop 1
    v_max_u32_dpp v60, v60, v60 row_shr:1 row_mask:0xf bank_mask:0xf bound_ctrl:0
    v_add_f32_dpp v61, v61, v61 row_shr:1 row_mask:0xf bank_mask:0xf bound_ctrl:0
    s_nop 0
    v_max_u32_dpp v60, v60, v60 row_shr:2 row_mask:0xf bank_mask:0xf bound_ctrl:0
    v_add_f32_dpp v61, v61, v61 row_shr:2 row_mask:0xf bank_mask:0xf bound_ctrl:0
    s_nop 0
    v_max_u32_dpp v60, v60, v60 row_shr:4 row_mask:0xf bank_mask:0xf bound_ctrl:0
    v_add_f32_dpp v61, v61, v61 row_shr:4 row_mask:0xf bank_mask:0xf bound_ctrl:0
    s_nop 0
    v_max_u32_dpp v60, v60, v60 row_shr:8 row_mask:0xf bank_mask:0xf bound_ctrl:0
    v_add_f32_dpp v61, v61, v61 row_shr:8 row_mask:0xf bank_mask:0xf bound_ctrl:0
    s_nop 0
    v_max_u32_dpp v60, v60, v60 row_bcast:15 row_mask:0xa bank_mask:0xf
    v_add_f32_dpp v61, v61, v61 row_bcast:15 row_mask:0xa bank_mask:0xf
    s_nop 0
    v_max_u32_dpp v60, v60, v60 row_bcast:31 row_mask:0xc bank_mask:0xf
    v_add_f32_dpp v61, v61, v61 row_bcast:31 row_mask:0xc bank_mask:0xf
    s_nop 0
    s_nop 0
    s_lshl_b32 s44, s10, 3
    v_mov_b32 v62, s44
    s_mov_b64 exec, 1
    s_lshl_b64 exec, exec, 63
    ds_write_b64 v62, v[60:61] offset:53824
    s_mov_b64 exec, -1
p2_nostat1:
    s_waitcnt lgkmcnt(0)
    s_barrier
    v_bfe_u32 v18, v20, 14, 4
    v_lshrrev_b32 v19, 18, v20
    v_and_b32 v20, 0x3fff, v20
    v_mad_u32_u24 v18, v18, s63, v19
    v_lshl_or_b32 v20, v18, 14, v20
    buffer_load_dwordx4 v[18:21], v20, s[68:71], 0 offen
    v_mov_b32 v122, s19
    s_xor_b32 s19, s19, 4
    ds_read_b32 v125, v122 offset:53760
    s_cmp_lg_u32 s21, 0
    s_cbranch_scc1 p2_nostat2
    v_bfe_u32 v62, v112, 1, 7
    ds_read_b64 v[60:61], v62 offset:53824
    s_waitcnt lgkmcnt(0)
    s_nop 1
    v_max_u32_dpp v60, v60, v60 row_shr:1 row_mask:0xf bank_mask:0xf bound_ctrl:0
    v_add_f32_dpp v61, v61, v61 row_shr:1 row_mask:0xf bank_mask:0xf bound_ctrl:0
    s_nop 0
    v_max_u32_dpp v60, v60, v60 row_shr:2 row_mask:0xf bank_mask:0xf bound_ctrl:0
    v_add_f32_dpp v61, v61, v61 row_shr:2 row_mask:0xf bank_mask:0xf bound_ctrl:0
    s_nop 0
    v_max_u32_dpp v60, v60, v60 row_shr:4 row_mask:0xf bank_mask:0xf bound_ctrl:0
    v_add_f32_dpp v61, v61, v61 row_shr:4 row_mask:0xf bank_mask:0xf bound_ctrl:0
    s_nop 0
    v_max_u32_dpp v60, v60, v60 row_shr:8 row_mask:0xf bank_mask:0xf bound_ctrl:0
    v_add_f32_dpp v61, v61, v61 row_shr:8 row_mask:0xf bank_mask:0xf bound_ctrl:0
    s_nop 0
    v_max_u32_dpp v60, v60, v60 row_bcast:15 row_mask:0xa bank_mask:0xf
    v_add_f32_dpp v61, v61, v61 row_bcast:15 row_mask:0xa bank_mask:0xf
    s_nop 0
    v_max_u32_dpp v60, v60, v60 row_bcast:31 row_mask:0xc bank_mask:0xf
    v_add_f32_dpp v61, v61, v61 row_bcast:31 row_mask:0xc bank_mask:0xf
    s_nop 0
    s_nop 0
    v_readlane_b32 s44, v60, 15
    v_readlane_b32 s45, v61, 15
    s_nop 1
    s_lshl_b32 s44, s44, 16
    s_lshr_b32 s46, s44, 23
    s_sub_u32 s47, s46, 80
    s_cmp_lt_u32 s47, 100
    s_cselect_b32 s21, 0, 1
    v_mov_b32 v60, s45
    v_mul_f32 v60, 0x34a7c5ac, v60
    v_sqrt_f32 v60, v60
    v_mov_b32 v61, s44
    v_mul_f32 v62, 0x41800000, v60
    v_cmp_nle_f32 vcc, v61, v62
    v_mul_f32 v60, 0x3ac00000, v60
    v_mul_f32 v61, 0x3901742e, v61
    v_max_f32 v60, v60, v61
    s_cmp_lg_u64 vcc, 0
    s_cselect_b32 s21, 1, s21
    v_readfirstlane_b32 s44, v60
    s_nop 0
    s_and_b32 s47, s44, 0x7fffff
    s_or_b32 s47, s47, 0x3f000000
    s_and_b32 s48, s44, 0x7f800000
    s_add_u32 s48, s48, 0x800000
    v_rcp_f32 v60, s47
    s_nop 0
    v_rcp_f32 v61, v60
    v_mul_f32 v60, 0x7b800000, v60
    v_mul_f32 v61, s48, v61
    s_nop 0
    v_readfirstlane_b32 s26, v60
    v_readfirstlane_b32 s30, v61
    s_add_u32 s34, s48, 197132288
    s_mov_b32 s35, s34
    s_sub_u32 s36, 0, s34
    s_subb_u32 s37, 0, s34
    s_cmp_eq_u32 s21, 0
    s_cbranch_scc1 p2_nostat2
    s_waitcnt vmcnt(0) lgkmcnt(0)
    s_branch p2_restart
p2_nostat2:
    s_cmp_eq_u32 s21, 0
    s_cselect_b32 s26, s26, 0x7b800000
    v_mov_b32 v114, s26
    s_waitcnt lgkmcnt(0)
    v_readfirstlane_b32 s44, v125
    s_nop 0
    s_cmp_lg_u32 s44, 0
    s_cbranch_scc1 p2_adva
    s_mov_b32 s61, 1
    v_mov_b32 v110, v68
    v_mov_b32 v111, v69
p2_adva:
    v_bfe_u32 v86, v88, 14, 4
    v_lshrrev_b32 v87, 18, v88
    v_and_b32 v88, 0x3fff, v88
    v_mad_u32_u24 v86, v86, s63, v87
    v_lshl_or_b32 v88, v86, 14, v88
    buffer_load_dwordx4 v[86:89], v88, s[68:71], 0 offen
    s_mov_b32 m0, s23
    v_mov_b32 v53, 0x3c000
    s_movk_i32 s44, 512
    v_sub_u32_sdwa v4, v111, v110 dst_sel:DWORD dst_unused:UNUSED_PAD src0_sel:WORD_0 src1_sel:WORD_0
    v_sub_u32_sdwa v5, v111, v110 dst_sel:DWORD dst_unused:UNUSED_PAD src0_sel:WORD_1 src1_sel:WORD_1
    v_med3_i32 v4, v4, 0, s44
    v_med3_i32 v5, v5, 0, s44
    v_add_u32 v48, v4, v5
    ds_write_addtid_b32 v53 offset:0
    ds_write_addtid_b32 v53 offset:256
    ds_write_addtid_b32 v53 offset:512
    ds_write_addtid_b32 v53 offset:768
    ds_write_addtid_b32 v53 offset:1024
    ds_write_addtid_b32 v53 offset:1280
    ds_write_addtid_b32 v53 offset:1536
    ds_write_addtid_b32 v53 offset:1792
    v_bfe_i32 v53, v112, 6, 1
    v_lshrrev_b32 v49, 6, v112
    v_bitop3_b32 v53, v53, 15, s10 bitop3:0x6a
    v_lshl_or_b32 v49, v49, 4, v53
    v_and_b32 v53, 0x30, v112
    v_lshl_or_b32 v53, v49, 6, v53
    v_lshlrev_b32 v53, 15, v53
    s_nop 1
    v_add_u32_dpp v48, v48, v48 row_shr:1 row_mask:0xf bank_mask:0xf bound_ctrl:0
    s_nop 1
    v_add_u32_dpp v48, v48, v48 row_shr:2 row_mask:0xf bank_mask:0xf bound_ctrl:0
    s_nop 1
    v_add_u32_dpp v48, v48, v48 row_shr:4 row_mask:0xf bank_mask:0xf bound_ctrl:0
    s_nop 1
    v_add_u32_dpp v48, v48, v48 row_shr:8 row_mask:0xf bank_mask:0xf bound_ctrl:0
    s_nop 1
    v_add_u32_dpp v48, v48, v48 row_bcast:15 row_mask:0xa bank_mask:0xf
    s_nop 1
    v_add_u32_dpp v48, v48, v48 row_bcast:31 row_mask:0xc bank_mask:0xf
    s_nop 1
    s_nop 0
    v_readlane_b32 s38, v48, 63
    v_sub_u32 v50, v48, v5
    v_sub_u32 v49, v50, v4
    v_sub_u32 v10, 512, v49
    v_mad_u32_u16 v51, v110, 16, v53
    v_med3_i32 v10, v10, 0, v4
    v_lshl_add_u32 v49, v49, 2, s23
    v_sub_u32 v11, 512, v50
    v_mad_u32_u16 v52, v110, 16, v53 op_sel:[1,0,0,0]
    v_med3_i32 v11, v11, 0, v5
    v_lshl_add_u32 v50, v50, 2, s23
    v_lshl_add_u32 v48, v11, 16, v10
    v_add_u32 v52, 262144, v52
    v_add_u32 v110, v110, v48
    s_min_u32 s17, s38, 512
    s_add_u32 s17, s17, 63
    s_lshr_b32 s17, s17, 6
p2_xb_0:
    v_cmpx_lt_i32 vcc, 0, v10
    s_cbranch_execz p2_yb_0
    ds_write_b32 v49, v51 offset:0
    v_add_u32 v51, 16, v51
    v_cmpx_lt_i32 vcc, 1, v10
    s_cbranch_execz p2_yb_0
    ds_write_b32 v49, v51 offset:4
    v_add_u32 v51, 16, v51
    v_cmpx_lt_i32 vcc, 2, v10
    s_cbranch_execz p2_yb_0
    ds_write_b32 v49, v51 offset:8
    v_add_u32 v51, 16, v51
    v_cmpx_lt_i32 vcc, 3, v10
    s_cbranch_execz p2_yb_0
    ds_write_b32 v49, v51 offset:12
    v_add_u32 v51, 16, v51
    v_cmpx_lt_i32 vcc, 4, v10
    s_cbranch_execz p2_yb_0
    ds_write_b32 v49, v51 offset:16
    v_add_u32 v51, 16, v51
    v_cmpx_lt_i32 vcc, 5, v10
    s_cbranch_execz p2_yb_0
    ds_write_b32 v49, v51 offset:20
    v_add_u32 v51, 16, v51
    v_cmpx_lt_i32 vcc, 6, v10
    s_cbranch_execz p2_yb_0
    ds_write_b32 v49, v51 offset:24
    v_add_u32 v51, 16, v51
    v_cmpx_lt_i32 vcc, 7, v10
    s_cbranch_execz p2_yb_0
    ds_write_b32 v49, v51 offset:28
    v_add_u32 v51, 16, v51
    v_subrev_u32 v10, 8, v10
    v_add_u32 v49, 32, v49
    s_branch p2_xb_0
p2_yb_0:
    s_mov_b64 exec, -1
p2_xb_1:
    v_cmpx_lt_i32 vcc, 0, v11
    s_cbranch_execz p2_yb_1
    ds_write_b32 v50, v52 offset:0
    v_add_u32 v52, 16, v52
    v_cmpx_lt_i32 vcc, 1, v11
    s_cbranch_execz p2_yb_1
    ds_write_b32 v50, v52 offset:4
    v_add_u32 v52, 16, v52
    v_cmpx_lt_i32 vcc, 2, v11
    s_cbranch_execz p2_yb_1
    ds_write_b32 v50, v52 offset:8
    v_add_u32 v52, 16, v52
    v_cmpx_lt_i32 vcc, 3, v11
    s_cbranch_execz p2_yb_1
    ds_write_b32 v50, v52 offset:12
    v_add_u32 v52, 16, v52
    v_cmpx_lt_i32 vcc, 4, v11
    s_cbranch_execz p2_yb_1
    ds_write_b32 v50, v52 offset:16
    v_add_u32 v52, 16, v52
    v_cmpx_lt_i32 vcc, 5, v11
    s_cbranch_execz p2_yb_1
    ds_write_b32 v50, v52 offset:20
    v_add_u32 v52, 16, v52
    v_cmpx_lt_i32 vcc, 6, v11
    s_cbranch_execz p2_yb_1
    ds_write_b32 v50, v52 offset:24
    v_add_u32 v52, 16, v52
    v_cmpx_lt_i32 vcc, 7, v11
    s_cbranch_execz p2_yb_1
    ds_write_b32 v50, v52 offset:28
    v_add_u32 v52, 16, v52
    v_subrev_u32 v11, 8, v11
    v_add_u32 v50, 32, v50
    s_branch p2_xb_1
p2_yb_1:
    s_mov_b64 exec, -1
    s_cmp_lt_u32 s38, 512
    s_cbranch_scc1 p2_nomoreb
    v_cmp_lt_u32_sdwa s[44:45], v110, v111 src0_sel:WORD_0 src1_sel:WORD_0
    v_cmp_lt_u32_sdwa s[46:47], v110, v111 src0_sel:WORD_1 src1_sel:WORD_1
    s_nop 0
    s_or_b64 s[44:45], s[44:45], s[46:47]
    s_cbranch_scc0 p2_nomoreb
    v_mov_b32 v49, s19
    v_mov_b32 v50, 1
    ds_write_b32 v49, v50 offset:53760
p2_nomoreb:
    s_mov_b32 m0, s23
    s_nop 0
    ds_read_addtid_b32 v102 offset:0
    ds_read_addtid_b32 v103 offset:256
    ds_read_addtid_b32 v104 offset:512
    ds_read_addtid_b32 v105 offset:768
    ds_read_addtid_b32 v106 offset:1024
    ds_read_addtid_b32 v107 offset:1280
    ds_read_addtid_b32 v108 offset:1536
    ds_read_addtid_b32 v109 offset:1792
    v_bfe_u32 v90, v92, 14, 4
    v_lshrrev_b32 v91, 18, v92
    v_and_b32 v92, 0x3fff, v92
    v_mad_u32_u24 v90, v90, s63, v91
    v_lshl_or_b32 v92, v90, 14, v92
    buffer_load_dwordx4 v[90:93], v92, s[68:71], 0 offen
    s_waitcnt vmcnt(6)
    s_mov_b32 m0, s24
    s_cmp_ge_u32 s10, 9
    s_cbranch_scc1 p2_stp
    ds_write_addtid_b32 v84 offset:49152
    ds_write_addtid_b32 v85 offset:49408
p2_stp:
    s_mov_b32 m0, s23
    s_add_u32 s20, s20, 53760
    ds_write_addtid_b32 v72 offset:0
    ds_write_addtid_b32 v73 offset:256
    ds_write_addtid_b32 v74 offset:512
    ds_write_addtid_b32 v75 offset:768
    ds_write_addtid_b32 v76 offset:1024
    ds_write_addtid_b32 v77 offset:1280
    ds_write_addtid_b32 v78 offset:1536
    ds_write_addtid_b32 v79 offset:1792
    ds_write_addtid_b32 v80 offset:2048
    ds_write_addtid_b32 v81 offset:2304
    ds_write_addtid_b32 v82 offset:2560
    ds_write_addtid_b32 v83 offset:2816
    s_waitcnt lgkmcnt(0)
    s_barrier
    v_bfe_u32 v94, v96, 14, 4
    v_lshrrev_b32 v95, 18, v96
    v_and_b32 v96, 0x3fff, v96
    v_mad_u32_u24 v94, v94, s63, v95
    v_lshl_or_b32 v96, v94, 14, v96
    buffer_load_dwordx4 v[94:97], v96, s[68:71], 0 offen
    v_bfe_u32 v98, v100, 14, 4
    v_lshrrev_b32 v99, 18, v100
    v_and_b32 v100, 0x3fff, v100
    v_mad_u32_u24 v98, v98, s63, v99
    v_lshl_or_b32 v100, v98, 14, v100
    buffer_load_dwordx4 v[98:101], v100, s[68:71], 0 offen
    s_cmp_ge_u32 s10, 9
    s_cbranch_scc1 p2_nmq
    v_lshrrev_b32 v84, 1, v112
    s_add_u32 s44, s20, s42
    buffer_load_dwordx2 v[84:85], v84, s[4:7], s44 offen
p2_nmq:
    buffer_load_dwordx4 v[72:75], v112, s[4:7], s20 offen offset:0
    buffer_load_dwordx4 v[76:79], v112, s[4:7], s20 offen offset:1024
    buffer_load_dwordx4 v[80:83], v112, s[4:7], s20 offen offset:2048
    s_waitcnt vmcnt(10)
    v_perm_b32 v48, v3, v0, s31
    v_perm_b32 v49, v3, v1, s32
    v_perm_b32 v50, v3, v2, s33
    v_lshlrev_b16 v4, 3, v2
    v_lshlrev_b16 v2, 3, v1
    v_lshlrev_b16 v0, 3, v0
    v_cmpx_ge_u16 vcc, 0x3fff, v48
    ds_read_b64 v[0:1], v0
    s_mov_b64 exec, -1
    v_cmpx_ge_u16 vcc, 0x3fff, v49
    ds_read_b64 v[2:3], v2
    s_mov_b64 exec, -1
    v_cmpx_ge_u16 vcc, 0x3fff, v50
    ds_read_b64 v[4:5], v4
    s_mov_b64 exec, -1
    s_waitcnt vmcnt(9)
    v_perm_b32 v51, v9, v6, s31
    v_perm_b32 v52, v9, v7, s32
    v_perm_b32 v53, v9, v8, s33
    v_lshlrev_b16 v10, 3, v8
    v_lshlrev_b16 v8, 3, v7
    v_lshlrev_b16 v6, 3, v6
    v_cmpx_ge_u16 vcc, 0x3fff, v51
    ds_read_b64 v[6:7], v6
    s_mov_b64 exec, -1
    v_cmpx_ge_u16 vcc, 0x3fff, v52
    ds_read_b64 v[8:9], v8
    s_mov_b64 exec, -1
    v_cmpx_ge_u16 vcc, 0x3fff, v53
    ds_read_b64 v[10:11], v10
    s_mov_b64 exec, -1
    s_waitcnt vmcnt(8)
    v_perm_b32 v54, v15, v12, s31
    v_perm_b32 v55, v15, v13, s32
    v_perm_b32 v56, v15, v14, s33
    v_lshlrev_b16 v16, 3, v14
    v_lshlrev_b16 v14, 3, v13
    v_lshlrev_b16 v12, 3, v12
    v_cmpx_ge_u16 vcc, 0x3fff, v54
    ds_read_b64 v[12:13], v12
    s_mov_b64 exec, -1
    v_cmpx_ge_u16 vcc, 0x3fff, v55
    ds_read_b64 v[14:15], v14
    s_mov_b64 exec, -1
    v_cmpx_ge_u16 vcc, 0x3fff, v56
    ds_read_b64 v[16:17], v16
    s_mov_b64 exec, -1
    s_waitcnt vmcnt(7)
    v_perm_b32 v57, v21, v18, s31
    v_perm_b32 v58, v21, v19, s32
    v_perm_b32 v59, v21, v20, s33
    v_lshlrev_b16 v22, 3, v20
    v_lshlrev_b16 v20, 3, v19
    v_lshlrev_b16 v18, 3, v18
    v_cmpx_ge_u16 vcc, 0x3fff, v57
    ds_read_b64 v[18:19], v18
    s_mov_b64 exec, -1
    v_cmpx_ge_u16 vcc, 0x3fff, v58
    ds_read_b64 v[20:21], v20
    s_mov_b64 exec, -1
    v_cmpx_ge_u16 vcc, 0x3fff, v59
    ds_read_b64 v[22:23], v22
    s_mov_b64 exec, -1
    s_waitcnt vmcnt(6)
    v_perm_b32 v60, v89, v86, s31
    v_perm_b32 v61, v89, v87, s32
    v_perm_b32 v62, v89, v88, s33
    v_lshlrev_b16 v28, 3, v88
    v_lshlrev_b16 v26, 3, v87
    v_lshlrev_b16 v24, 3, v86
    v_cmpx_ge_u16 vcc, 0x3fff, v60
    ds_read_b64 v[24:25], v24
    s_mov_b64 exec, -1
    v_cmpx_ge_u16 vcc, 0x3fff, v61
    ds_read_b64 v[26:27], v26
    s_mov_b64 exec, -1
    v_cmpx_ge_u16 vcc, 0x3fff, v62
    ds_read_b64 v[28:29], v28
    s_mov_b64 exec, -1
    v_bfe_u32 v86, v106, 14, 4
    v_lshrrev_b32 v87, 18, v106
    v_and_b32 v106, 0x3fff, v106
    v_mad_u32_u24 v86, v86, s63, v87
    v_lshl_or_b32 v106, v86, 14, v106
    buffer_load_dwordx4 v[86:89], v106, s[68:71], 0 offen
    s_waitcnt vmcnt(6)
    v_perm_b32 v63, v93, v90, s31
    v_perm_b32 v64, v93, v91, s32
    v_perm_b32 v65, v93, v92, s33
    v_lshlrev_b16 v34, 3, v92
    v_lshlrev_b16 v32, 3, v91
    v_lshlrev_b16 v30, 3, v90
    v_cmpx_ge_u16 vcc, 0x3fff, v63
    ds_read_b64 v[30:31], v30
    s_mov_b64 exec, -1
    v_cmpx_ge_u16 vcc, 0x3fff, v64
    ds_read_b64 v[32:33], v32
    s_mov_b64 exec, -1
    v_cmpx_ge_u16 vcc, 0x3fff, v65
    ds_read_b64 v[34:35], v34
    s_mov_b64 exec, -1
    v_bfe_u32 v90, v107, 14, 4
    v_lshrrev_b32 v91, 18, v107
    v_and_b32 v107, 0x3fff, v107
    v_mad_u32_u24 v90, v90, s63, v91
    v_lshl_or_b32 v107, v90, 14, v107
    buffer_load_dwordx4 v[90:93], v107, s[68:71], 0 offen
    s_waitcnt vmcnt(6)
    v_perm_b32 v66, v97, v94, s31
    v_perm_b32 v67, v97, v95, s32
    v_perm_b32 v68, v97, v96, s33
    v_lshlrev_b16 v40, 3, v96
    v_lshlrev_b16 v38, 3, v95
    v_lshlrev_b16 v36, 3, v94
    v_cmpx_ge_u16 vcc, 0x3fff, v66
    ds_read_b64 v[36:37], v36
    s_mov_b64 exec, -1
    v_cmpx_ge_u16 vcc, 0x3fff, v67
    ds_read_b64 v[38:39], v38
    s_mov_b64 exec, -1
    v_cmpx_ge_u16 vcc, 0x3fff, v68
    ds_read_b64 v[40:41], v40
    s_mov_b64 exec, -1
    s_waitcnt vmcnt(5)
    v_perm_b32 v69, v101, v98, s31
    v_perm_b32 v70, v101, v99, s32
    v_perm_b32 v71, v101, v100, s33
    v_lshlrev_b16 v46, 3, v100
    v_lshlrev_b16 v44, 3, v99
    v_lshlrev_b16 v42, 3, v98
    s_cmp_le_u32 s16, 7
    s_cbranch_scc1 p2_gp
    v_cmpx_ge_u16 vcc, 0x3fff, v69
    ds_read_b64 v[42:43], v42
    s_mov_b64 exec, -1
    v_cmpx_ge_u16 vcc, 0x3fff, v70
    ds_read_b64 v[44:45], v44
    s_mov_b64 exec, -1
    v_cmpx_ge_u16 vcc, 0x3fff, v71
    ds_read_b64 v[46:47], v46
    s_mov_b64 exec, -1
p2_gp:
    s_waitcnt lgkmcnt(0)
    s_barrier
    s_branch p2_tail
p2_top:
    s_cmp_lg_u32 s21, 0
    s_cbranch_scc1 p2_topf
    s_cmp_eq_u32 s60, 10
    s_cbranch_scc1 p2_drain0
    v_cmpx_gt_i16 vcc, 0, v48
    ds_read_b64 v[0:1], v0
    s_mov_b64 exec, -1
    v_cmpx_gt_i16 vcc, 0, v49
    ds_read_b64 v[2:3], v2
    s_mov_b64 exec, -1
    v_cmpx_gt_i16 vcc, 0, v50
    ds_read_b64 v[4:5], v4
    s_mov_b64 exec, -1
    v_cmpx_gt_i16 vcc, 0, v51
    ds_read_b64 v[6:7], v6
    s_mov_b64 exec, -1
    v_cmpx_gt_i16 vcc, 0, v52
    ds_read_b64 v[8:9], v8
    s_mov_b64 exec, -1
    v_cmpx_gt_i16 vcc, 0, v53
    ds_read_b64 v[10:11], v10
    s_mov_b64 exec, -1
    v_cmpx_gt_i16 vcc, 0, v54
    ds_read_b64 v[12:13], v12
    s_mov_b64 exec, -1
    v_cmpx_gt_i16 vcc, 0, v55
    ds_read_b64 v[14:15], v14
    s_mov_b64 exec, -1
    v_cmpx_gt_i16 vcc, 0, v56
    ds_read_b64 v[16:17], v16
    s_mov_b64 exec, -1
    v_cmpx_gt_i16 vcc, 0, v57
    ds_read_b64 v[18:19], v18
    s_mov_b64 exec, -1
    v_cmpx_gt_i16 vcc, 0, v58
    ds_read_b64 v[20:21], v20
    s_mov_b64 exec, -1
    v_cmpx_gt_i16 vcc, 0, v59
    ds_read_b64 v[22:23], v22
    s_mov_b64 exec, -1
    s_cmp_ge_u32 s10, 9
    s_cbranch_scc1 p2_nm0m0a
    v_lshrrev_b32 v84, 1, v112
    s_add_u32 s44, s20, s42
    buffer_load_dwordx2 v[84:85], v84, s[4:7], s44 offen
p2_nm0m0a:
    buffer_load_dwordx4 v[72:75], v112, s[4:7], s20 offen offset:0
    buffer_load_dwordx4 v[76:79], v112, s[4:7], s20 offen offset:1024
    buffer_load_dwordx4 v[80:83], v112, s[4:7], s20 offen offset:2048
    v_cmpx_gt_i16 vcc, 0, v60
    ds_read_b64 v[24:25], v24
    s_mov_b64 exec, -1
    v_cmpx_gt_i16 vcc, 0, v61
    ds_read_b64 v[26:27], v26
    s_mov_b64 exec, -1
    v_cmpx_gt_i16 vcc, 0, v62
    ds_read_b64 v[28:29], v28
    s_mov_b64 exec, -1
    v_cmpx_gt_i16 vcc, 0, v63
    ds_read_b64 v[30:31], v30
    s_mov_b64 exec, -1
    v_cmpx_gt_i16 vcc, 0, v64
    ds_read_b64 v[32:33], v32
    s_mov_b64 exec, -1
    v_cmpx_gt_i16 vcc, 0, v65
    ds_read_b64 v[34:35], v34
    s_mov_b64 exec, -1
    v_cmpx_gt_i16 vcc, 0, v66
    ds_read_b64 v[36:37], v36
    s_mov_b64 exec, -1
    v_cmpx_gt_i16 vcc, 0, v67
    ds_read_b64 v[38:39], v38
    s_mov_b64 exec, -1
    v_cmpx_gt_i16 vcc, 0, v68
    ds_read_b64 v[40:41], v40
    s_mov_b64 exec, -1
    s_cmp_le_u32 s15, 7
    s_cbranch_scc1 p2_g0r27
    v_cmpx_gt_i16 vcc, 0, v69
    ds_read_b64 v[42:43], v42
    s_mov_b64 exec, -1
    v_cmpx_gt_i16 vcc, 0, v70
    ds_read_b64 v[44:45], v44
    s_mov_b64 exec, -1
    v_cmpx_gt_i16 vcc, 0, v71
    ds_read_b64 v[46:47], v46
    s_mov_b64 exec, -1
p2_g0r27:
    s_waitcnt lgkmcnt(15)
    v_ashrrev_i32 v122, 5, v48
    v_lshlrev_b16 v123, 2, v48
    v_lshlrev_b32 v124, 16, v0
    v_bitop3_b32 v122, v122, v113, v113 bitop3:0x0c
    v_and_b32 v125, 0xffff0000, v0
    v_lshlrev_b32 v126, 16, v1
    v_mul_f32 v122, v114, v122
    v_and_b32 v127, 0xffff0000, v1
    v_add_u32 v123, v123, v123
    v_pk_fma_f32 v[124:125], v[124:125], v[122:123], s[34:35] op_sel_hi:[1,0,1]
    v_pk_fma_f32 v[126:127], v[126:127], v[122:123], s[34:35] op_sel_hi:[1,0,1]
    v_lshl_add_u32 v124, v125, 16, v124
    v_lshl_add_u32 v125, v127, 16, v126
    s_waitcnt lgkmcnt(15)
    v_bitop3_b32 v115, v115, v116, v117 bitop3:0xfe
    v_lshl_add_u64 v[124:125], v[124:125], 0, s[36:37]
    v_cmpx_le_u32 vcc, 0x1000000, v48
    ds_add_rtn_u64 v[116:117], v123, v[124:125] offset:54272
    s_mov_b64 exec, -1
    v_ashrrev_i32 v122, 5, v49
    v_lshlrev_b16 v123, 2, v49
    v_lshlrev_b32 v124, 16, v2
    v_bitop3_b32 v122, v122, v113, v113 bitop3:0x0c
    v_and_b32 v125, 0xffff0000, v2
    v_lshlrev_b32 v126, 16, v3
    v_mul_f32 v122, v114, v122
    v_and_b32 v127, 0xffff0000, v3
    v_add_u32 v123, v123, v123
    v_pk_fma_f32 v[124:125], v[124:125], v[122:123], s[34:35] op_sel_hi:[1,0,1]
    v_pk_fma_f32 v[126:127], v[126:127], v[122:123], s[34:35] op_sel_hi:[1,0,1]
    v_lshl_add_u32 v124, v125, 16, v124
    v_lshl_add_u32 v125, v127, 16, v126
    s_waitcnt lgkmcnt(15)
    v_bitop3_b32 v115, v115, v118, v119 bitop3:0xfe
    v_lshl_add_u64 v[124:125], v[124:125], 0, s[36:37]
    v_cmpx_le_u32 vcc, 0x1000000, v49
    ds_add_rtn_u64 v[118:119], v123, v[124:125] offset:54272
    s_mov_b64 exec, -1
    v_ashrrev_i32 v122, 5, v50
    v_lshlrev_b16 v123, 2, v50
    v_lshlrev_b32 v124, 16, v4
    v_bitop3_b32 v122, v122, v113, v113 bitop3:0x0c
    v_and_b32 v125, 0xffff0000, v4
    v_lshlrev_b32 v126, 16, v5
    v_mul_f32 v122, v114, v122
    v_and_b32 v127, 0xffff0000, v5
    v_add_u32 v123, v123, v123
    v_pk_fma_f32 v[124:125], v[124:125], v[122:123], s[34:35] op_sel_hi:[1,0,1]
    v_pk_fma_f32 v[126:127], v[126:127], v[122:123], s[34:35] op_sel_hi:[1,0,1]
    v_lshl_add_u32 v124, v125, 16, v124
    v_lshl_add_u32 v125, v127, 16, v126
    s_waitcnt lgkmcnt(15)
    v_bitop3_b32 v115, v115, v120, v121 bitop3:0xfe
    v_lshl_add_u64 v[124:125], v[124:125], 0, s[36:37]
    v_cmpx_le_u32 vcc, 0x1000000, v50
    ds_add_rtn_u64 v[120:121], v123, v[124:125] offset:54272
    s_mov_b64 exec, -1
    v_bfe_u32 v0, v102, 14, 4
    v_lshrrev_b32 v1, 18, v102
    v_and_b32 v102, 0x3fff, v102
    v_mad_u32_u24 v0, v0, s63, v1
    v_lshl_or_b32 v102, v0, 14, v102
    buffer_load_dwordx4 v[0:3], v102, s[68:71], 0 offen
    s_waitcnt lgkmcnt(15)
    v_ashrrev_i32 v122, 5, v51
    v_lshlrev_b16 v123, 2, v51
    v_lshlrev_b32 v124, 16, v6
    v_bitop3_b32 v122, v122, v113, v113 bitop3:0x0c
    v_and_b32 v125, 0xffff0000, v6
    v_lshlrev_b32 v126, 16, v7
    v_mul_f32 v122, v114, v122
    v_and_b32 v127, 0xffff0000, v7
    v_add_u32 v123, v123, v123
    v_pk_fma_f32 v[124:125], v[124:125], v[122:123], s[34:35] op_sel_hi:[1,0,1]
    v_pk_fma_f32 v[126:127], v[126:127], v[122:123], s[34:35] op_sel_hi:[1,0,1]
    v_lshl_add_u32 v124, v125, 16, v124
    v_lshl_add_u32 v125, v127, 16, v126
    s_waitcnt lgkmcnt(2)
    v_bitop3_b32 v115, v115, v116, v117 bitop3:0xfe
    v_lshl_add_u64 v[124:125], v[124:125], 0, s[36:37]
    v_cmpx_le_u32 vcc, 0x1000000, v51
    ds_add_rtn_u64 v[116:117], v123, v[124:125] offset:54272
    s_mov_b64 exec, -1
    v_ashrrev_i32 v122, 5, v52
    v_lshlrev_b16 v123, 2, v52
    v_lshlrev_b32 v124, 16, v8
    v_bitop3_b32 v122, v122, v113, v113 bitop3:0x0c
    v_and_b32 v125, 0xffff0000, v8
    v_lshlrev_b32 v126, 16, v9
    v_mul_f32 v122, v114, v122
    v_and_b32 v127, 0xffff0000, v9
    v_add_u32 v123, v123, v123
    v_pk_fma_f32 v[124:125], v[124:125], v[122:123], s[34:35] op_sel_hi:[1,0,1]
    v_pk_fma_f32 v[126:127], v[126:127], v[122:123], s[34:35] op_sel_hi:[1,0,1]
    v_lshl_add_u32 v124, v125, 16, v124
    v_lshl_add_u32 v125, v127, 16, v126
    s_waitcnt lgkmcnt(2)
    v_bitop3_b32 v115, v115, v118, v119 bitop3:0xfe
    v_lshl_add_u64 v[124:125], v[124:125], 0, s[36:37]
    v_cmpx_le_u32 vcc, 0x1000000, v52
    ds_add_rtn_u64 v[118:119], v123, v[124:125] offset:54272
    s_mov_b64 exec, -1
    v_ashrrev_i32 v122, 5, v53
    v_lshlrev_b16 v123, 2, v53
    v_lshlrev_b32 v124, 16, v10
    v_bitop3_b32 v122, v122, v113, v113 bitop3:0x0c
    v_and_b32 v125, 0xffff0000, v10
    v_lshlrev_b32 v126, 16, v11
    v_mul_f32 v122, v114, v122
    v_and_b32 v127, 0xffff0000, v11
    v_add_u32 v123, v123, v123
    v_pk_fma_f32 v[124:125], v[124:125], v[122:123], s[34:35] op_sel_hi:[1,0,1]
    v_pk_fma_f32 v[126:127], v[126:127], v[122:123], s[34:35] op_sel_hi:[1,0,1]
    v_lshl_add_u32 v124, v125, 16, v124
    v_lshl_add_u32 v125, v127, 16, v126
    s_waitcnt lgkmcnt(2)
    v_bitop3_b32 v115, v115, v120, v121 bitop3:0xfe
    v_lshl_add_u64 v[124:125], v[124:125], 0, s[36:37]
    v_cmpx_le_u32 vcc, 0x1000000, v53
    ds_add_rtn_u64 v[120:121], v123, v[124:125] offset:54272
    s_mov_b64 exec, -1
    v_bfe_u32 v6, v103, 14, 4
    v_lshrrev_b32 v7, 18, v103
    v_and_b32 v103, 0x3fff, v103
    v_mad_u32_u24 v6, v6, s63, v7
    v_lshl_or_b32 v103, v6, 14, v103
    buffer_load_dwordx4 v[6:9], v103, s[68:71], 0 offen
    s_waitcnt lgkmcnt(6)
    s_barrier
    s_waitcnt lgkmcnt(15)
    v_ashrrev_i32 v122, 5, v54
    v_lshlrev_b16 v123, 2, v54
    v_lshlrev_b32 v124, 16, v12
    v_bitop3_b32 v122, v122, v113, v113 bitop3:0x0c
    v_and_b32 v125, 0xffff0000, v12
    v_lshlrev_b32 v126, 16, v13
    v_mul_f32 v122, v114, v122
    v_and_b32 v127, 0xffff0000, v13
    v_add_u32 v123, v123, v123
    v_pk_fma_f32 v[124:125], v[124:125], v[122:123], s[34:35] op_sel_hi:[1,0,1]
    v_pk_fma_f32 v[126:127], v[126:127], v[122:123], s[34:35] op_sel_hi:[1,0,1]
    v_lshl_add_u32 v124, v125, 16, v124
    v_lshl_add_u32 v125, v127, 16, v126
    s_waitcnt lgkmcnt(2)
    v_bitop3_b32 v115, v115, v116, v117 bitop3:0xfe
    v_lshl_add_u64 v[124:125], v[124:125], 0, s[36:37]
    v_cmpx_le_u32 vcc, 0x1000000, v54
    ds_add_rtn_u64 v[116:117], v123, v[124:125] offset:54272
    s_mov_b64 exec, -1
    v_ashrrev_i32 v122, 5, v55
    v_lshlrev_b16 v123, 2, v55
    v_lshlrev_b32 v124, 16, v14
    v_bitop3_b32 v122, v122, v113, v113 bitop3:0x0c
    v_and_b32 v125, 0xffff0000, v14
    v_lshlrev_b32 v126, 16, v15
    v_mul_f32 v122, v114, v122
    v_and_b32 v127, 0xffff0000, v15
    v_add_u32 v123, v123, v123
    v_pk_fma_f32 v[124:125], v[124:125], v[122:123], s[34:35] op_sel_hi:[1,0,1]
    v_pk_fma_f32 v[126:127], v[126:127], v[122:123], s[34:35] op_sel_hi:[1,0,1]
    v_lshl_add_u32 v124, v125, 16, v124
    v_lshl_add_u32 v125, v127, 16, v126
    s_waitcnt lgkmcnt(2)
    v_bitop3_b32 v115, v115, v118, v119 bitop3:0xfe
    v_lshl_add_u64 v[124:125], v[124:125], 0, s[36:37]
    v_cmpx_le_u32 vcc, 0x1000000, v55
    ds_add_rtn_u64 v[118:119], v123, v[124:125] offset:54272
    s_mov_b64 exec, -1
    v_ashrrev_i32 v122, 5, v56
    v_lshlrev_b16 v123, 2, v56
    v_lshlrev_b32 v124, 16, v16
    v_bitop3_b32 v122, v122, v113, v113 bitop3:0x0c
    v_and_b32 v125, 0xffff0000, v16
    v_lshlrev_b32 v126, 16, v17
    v_mul_f32 v122, v114, v122
    v_and_b32 v127, 0xffff0000, v17
    v_add_u32 v123, v123, v123
    v_pk_fma_f32 v[124:125], v[124:125], v[122:123], s[34:35] op_sel_hi:[1,0,1]
    v_pk_fma_f32 v[126:127], v[126:127], v[122:123], s[34:35] op_sel_hi:[1,0,1]
    v_lshl_add_u32 v124, v125, 16, v124
    v_lshl_add_u32 v125, v127, 16, v126
    s_waitcnt lgkmcnt(2)
    v_bitop3_b32 v115, v115, v120, v121 bitop3:0xfe
    v_lshl_add_u64 v[124:125], v[124:125], 0, s[36:37]
    v_cmpx_le_u32 vcc, 0x1000000, v56
    ds_add_rtn_u64 v[120:121], v123, v[124:125] offset:54272
    s_mov_b64 exec, -1
    v_bfe_u32 v12, v104, 14, 4
    v_lshrrev_b32 v13, 18, v104
    v_and_b32 v104, 0x3fff, v104
    v_mad_u32_u24 v12, v12, s63, v13
    v_lshl_or_b32 v104, v12, 14, v104
    buffer_load_dwordx4 v[12:15], v104, s[68:71], 0 offen
    s_waitcnt lgkmcnt(15)
    v_ashrrev_i32 v122, 5, v57
    v_lshlrev_b16 v123, 2, v57
    v_lshlrev_b32 v124, 16, v18
    v_bitop3_b32 v122, v122, v113, v113 bitop3:0x0c
    v_and_b32 v125, 0xffff0000, v18
    v_lshlrev_b32 v126, 16, v19
    v_mul_f32 v122, v114, v122
    v_and_b32 v127, 0xffff0000, v19
    v_add_u32 v123, v123, v123
    v_pk_fma_f32 v[124:125], v[124:125], v[122:123], s[34:35] op_sel_hi:[1,0,1]
    v_pk_fma_f32 v[126:127], v[126:127], v[122:123], s[34:35] op_sel_hi:[1,0,1]
    v_lshl_add_u32 v124, v125, 16, v124
    v_lshl_add_u32 v125, v127, 16, v126
    s_waitcnt lgkmcnt(2)
    v_bitop3_b32 v115, v115, v116, v117 bitop3:0xfe
    v_lshl_add_u64 v[124:125], v[124:125], 0, s[36:37]
    v_cmpx_le_u32 vcc, 0x1000000, v57
    ds_add_rtn_u64 v[116:117], v123, v[124:125] offset:54272
    s_mov_b64 exec, -1
    v_ashrrev_i32 v122, 5, v58
    v_lshlrev_b16 v123, 2, v58
    v_lshlrev_b32 v124, 16, v20
    v_bitop3_b32 v122, v122, v113, v113 bitop3:0x0c
    v_and_b32 v125, 0xffff0000, v20
    v_lshlrev_b32 v126, 16, v21
    v_mul_f32 v122, v114, v122
    v_and_b32 v127, 0xffff0000, v21
    v_add_u32 v123, v123, v123
    v_pk_fma_f32 v[124:125], v[124:125], v[122:123], s[34:35] op_sel_hi:[1,0,1]
    v_pk_fma_f32 v[126:127], v[126:127], v[122:123], s[34:35] op_sel_hi:[1,0,1]
    v_lshl_add_u32 v124, v125, 16, v124
    v_lshl_add_u32 v125, v127, 16, v126
    s_waitcnt lgkmcnt(2)
    v_bitop3_b32 v115, v115, v118, v119 bitop3:0xfe
    v_lshl_add_u64 v[124:125], v[124:125], 0, s[36:37]
    v_cmpx_le_u32 vcc, 0x1000000, v58
    ds_add_rtn_u64 v[118:119], v123, v[124:125] offset:54272
    s_mov_b64 exec, -1
    v_ashrrev_i32 v122, 5, v59
    v_lshlrev_b16 v123, 2, v59
    v_lshlrev_b32 v124, 16, v22
    v_bitop3_b32 v122, v122, v113, v113 bitop3:0x0c
    v_and_b32 v125, 0xffff0000, v22
    v_lshlrev_b32 v126, 16, v23
    v_mul_f32 v122, v114, v122
    v_and_b32 v127, 0xffff0000, v23
    v_add_u32 v123, v123, v123
    v_pk_fma_f32 v[124:125], v[124:125], v[122:123], s[34:35] op_sel_hi:[1,0,1]
    v_pk_fma_f32 v[126:127], v[126:127], v[122:123], s[34:35] op_sel_hi:[1,0,1]
    v_lshl_add_u32 v124, v125, 16, v124
    v_lshl_add_u32 v125, v127, 16, v126
    s_waitcnt lgkmcnt(2)
    v_bitop3_b32 v115, v115, v120, v121 bitop3:0xfe
    v_lshl_add_u64 v[124:125], v[124:125], 0, s[36:37]
    v_cmpx_le_u32 vcc, 0x1000000, v59
    ds_add_rtn_u64 v[120:121], v123, v[124:125] offset:54272
    s_mov_b64 exec, -1
    v_bfe_u32 v18, v105, 14, 4
    v_lshrrev_b32 v19, 18, v105
    v_and_b32 v105, 0x3fff, v105
    v_mad_u32_u24 v18, v18, s63, v19
    v_lshl_or_b32 v105, v18, 14, v105
    buffer_load_dwordx4 v[18:21], v105, s[68:71], 0 offen
    s_mov_b32 m0, s23
    v_mov_b32 v53, 0x3c000
    s_movk_i32 s44, 512
    v_sub_u32_sdwa v4, v111, v110 dst_sel:DWORD dst_unused:UNUSED_PAD src0_sel:WORD_0 src1_sel:WORD_0
    v_sub_u32_sdwa v5, v111, v110 dst_sel:DWORD dst_unused:UNUSED_PAD src0_sel:WORD_1 src1_sel:WORD_1
    v_med3_i32 v4, v4, 0, s44
    v_med3_i32 v5, v5, 0, s44
    v_add_u32 v48, v4, v5
    ds_write_addtid_b32 v53 offset:0
    ds_write_addtid_b32 v53 offset:256
    ds_write_addtid_b32 v53 offset:512
    ds_write_addtid_b32 v53 offset:768
    ds_write_addtid_b32 v53 offset:1024
    ds_write_addtid_b32 v53 offset:1280
    ds_write_addtid_b32 v53 offset:1536
    ds_write_addtid_b32 v53 offset:1792
    v_bfe_i32 v53, v112, 6, 1
    v_lshrrev_b32 v49, 6, v112
    v_bitop3_b32 v53, v53, 15, s10 bitop3:0x6a
    v_lshl_or_b32 v49, v49, 4, v53
    v_and_b32 v53, 0x30, v112
    v_lshl_or_b32 v53, v49, 6, v53
    v_lshlrev_b32 v53, 15, v53
    s_nop 1
    v_add_u32_dpp v48, v48, v48 row_shr:1 row_mask:0xf bank_mask:0xf bound_ctrl:0
    s_nop 1
    v_add_u32_dpp v48, v48, v48 row_shr:2 row_mask:0xf bank_mask:0xf bound_ctrl:0
    s_nop 1
    v_add_u32_dpp v48, v48, v48 row_shr:4 row_mask:0xf bank_mask:0xf bound_ctrl:0
    s_nop 1
    v_add_u32_dpp v48, v48, v48 row_shr:8 row_mask:0xf bank_mask:0xf bound_ctrl:0
    s_nop 1
    v_add_u32_dpp v48, v48, v48 row_bcast:15 row_mask:0xa bank_mask:0xf
    s_nop 1
    v_add_u32_dpp v48, v48, v48 row_bcast:31 row_mask:0xc bank_mask:0xf
    s_nop 1
    s_nop 0
    v_readlane_b32 s38, v48, 63
    v_sub_u32 v50, v48, v5
    v_sub_u32 v49, v50, v4
    v_sub_u32 v10, 512, v49
    v_mad_u32_u16 v51, v110, 16, v53
    v_med3_i32 v10, v10, 0, v4
    v_lshl_add_u32 v49, v49, 2, s23
    v_sub_u32 v11, 512, v50
    v_mad_u32_u16 v52, v110, 16, v53 op_sel:[1,0,0,0]
    v_med3_i32 v11, v11, 0, v5
    v_lshl_add_u32 v50, v50, 2, s23
    v_lshl_add_u32 v48, v11, 16, v10
    v_add_u32 v52, 262144, v52
    v_add_u32 v110, v110, v48
    s_min_u32 s17, s38, 512
    s_add_u32 s17, s17, 63
    s_lshr_b32 s17, s17, 6
p2_x0x_0:
    v_cmpx_lt_i32 vcc, 0, v10
    s_cbranch_execz p2_y0x_0
    ds_write_b32 v49, v51 offset:0
    v_add_u32 v51, 16, v51
    v_cmpx_lt_i32 vcc, 1, v10
    s_cbranch_execz p2_y0x_0
    ds_write_b32 v49, v51 offset:4
    v_add_u32 v51, 16, v51
    v_cmpx_lt_i32 vcc, 2, v10
    s_cbranch_execz p2_y0x_0
    ds_write_b32 v49, v51 offset:8
    v_add_u32 v51, 16, v51
    v_cmpx_lt_i32 vcc, 3, v10
    s_cbranch_execz p2_y0x_0
    ds_write_b32 v49, v51 offset:12
    v_add_u32 v51, 16, v51
    v_cmpx_lt_i32 vcc, 4, v10
    s_cbranch_execz p2_y0x_0
    ds_write_b32 v49, v51 offset:16
    v_add_u32 v51, 16, v51
    v_cmpx_lt_i32 vcc, 5, v10
    s_cbranch_execz p2_y0x_0
    ds_write_b32 v49, v51 offset:20
    v_add_u32 v51, 16, v51
    v_cmpx_lt_i32 vcc, 6, v10
    s_cbranch_execz p2_y0x_0
    ds_write_b32 v49, v51 offset:24
    v_add_u32 v51, 16, v51
    v_cmpx_lt_i32 vcc, 7, v10
    s_cbranch_execz p2_y0x_0
    ds_write_b32 v49, v51 offset:28
    v_add_u32 v51, 16, v51
    v_subrev_u32 v10, 8, v10
    v_add_u32 v49, 32, v49
    s_branch p2_x0x_0
p2_y0x_0:
    s_mov_b64 exec, -1
p2_x0x_1:
    v_cmpx_lt_i32 vcc, 0, v11
    s_cbranch_execz p2_y0x_1
    ds_write_b32 v50, v52 offset:0
    v_add_u32 v52, 16, v52
    v_cmpx_lt_i32 vcc, 1, v11
    s_cbranch_execz p2_y0x_1
    ds_write_b32 v50, v52 offset:4
    v_add_u32 v52, 16, v52
    v_cmpx_lt_i32 vcc, 2, v11
    s_cbranch_execz p2_y0x_1
    ds_write_b32 v50, v52 offset:8
    v_add_u32 v52, 16, v52
    v_cmpx_lt_i32 vcc, 3, v11
    s_cbranch_execz p2_y0x_1
    ds_write_b32 v50, v52 offset:12
    v_add_u32 v52, 16, v52
    v_cmpx_lt_i32 vcc, 4, v11
    s_cbranch_execz p2_y0x_1
    ds_write_b32 v50, v52 offset:16
    v_add_u32 v52, 16, v52
    v_cmpx_lt_i32 vcc, 5, v11
    s_cbranch_execz p2_y0x_1
    ds_write_b32 v50, v52 offset:20
    v_add_u32 v52, 16, v52
    v_cmpx_lt_i32 vcc, 6, v11
    s_cbranch_execz p2_y0x_1
    ds_write_b32 v50, v52 offset:24
    v_add_u32 v52, 16, v52
    v_cmpx_lt_i32 vcc, 7, v11
    s_cbranch_execz p2_y0x_1
    ds_write_b32 v50, v52 offset:28
    v_add_u32 v52, 16, v52
    v_subrev_u32 v11, 8, v11
    v_add_u32 v50, 32, v50
    s_branch p2_x0x_1
p2_y0x_1:
    s_mov_b64 exec, -1
    s_cmp_lt_u32 s38, 512
    s_cbranch_scc1 p2_nomore0x
    v_cmp_lt_u32_sdwa s[44:45], v110, v111 src0_sel:WORD_0 src1_sel:WORD_0
    v_cmp_lt_u32_sdwa s[46:47], v110, v111 src0_sel:WORD_1 src1_sel:WORD_1
    s_nop 0
    s_or_b64 s[44:45], s[44:45], s[46:47]
    s_cbranch_scc0 p2_nomore0x
    v_mov_b32 v49, s19
    v_mov_b32 v50, 1
    ds_write_b32 v49, v50 offset:53760
p2_nomore0x:
    s_mov_b32 m0, s23
    s_nop 0
    ds_read_addtid_b32 v102 offset:0
    ds_read_addtid_b32 v103 offset:256
    ds_read_addtid_b32 v104 offset:512
    ds_read_addtid_b32 v105 offset:768
    ds_read_addtid_b32 v106 offset:1024
    ds_read_addtid_b32 v107 offset:1280
    ds_read_addtid_b32 v108 offset:1536
    ds_read_addtid_b32 v109 offset:1792
    s_waitcnt vmcnt(4)
    s_mov_b32 m0, s24
    s_cmp_ge_u32 s10, 9
    s_cbranch_scc1 p2_st0s0
    ds_write_addtid_b32 v84 offset:49152
    ds_write_addtid_b32 v85 offset:49408
p2_st0s0:
    s_mov_b32 m0, s23
    s_add_u32 s20, s20, 53760
    ds_write_addtid_b32 v72 offset:0
    ds_write_addtid_b32 v73 offset:256
    ds_write_addtid_b32 v74 offset:512
    ds_write_addtid_b32 v75 offset:768
    ds_write_addtid_b32 v76 offset:1024
    ds_write_addtid_b32 v77 offset:1280
    ds_write_addtid_b32 v78 offset:1536
    ds_write_addtid_b32 v79 offset:1792
    ds_write_addtid_b32 v80 offset:2048
    ds_write_addtid_b32 v81 offset:2304
    ds_write_addtid_b32 v82 offset:2560
    ds_write_addtid_b32 v83 offset:2816
    s_waitcnt lgkmcnt(15)
    v_ashrrev_i32 v122, 5, v60
    v_lshlrev_b16 v123, 2, v60
    v_lshlrev_b32 v124, 16, v24
    v_bitop3_b32 v122, v122, v113, v113 bitop3:0x0c
    v_and_b32 v125, 0xffff0000, v24
    v_lshlrev_b32 v126, 16, v25
    v_mul_f32 v122, v114, v122
    v_and_b32 v127, 0xffff0000, v25
    v_add_u32 v123, v123, v123
    v_pk_fma_f32 v[124:125], v[124:125], v[122:123], s[34:35] op_sel_hi:[1,0,1]
    v_pk_fma_f32 v[126:127], v[126:127], v[122:123], s[34:35] op_sel_hi:[1,0,1]
    v_lshl_add_u32 v124, v125, 16, v124
    v_lshl_add_u32 v125, v127, 16, v126
    s_waitcnt lgkmcnt(15)
    v_bitop3_b32 v115, v115, v116, v117 bitop3:0xfe
    v_lshl_add_u64 v[124:125], v[124:125], 0, s[36:37]
    v_cmpx_le_u32 vcc, 0x1000000, v60
    ds_add_rtn_u64 v[116:117], v123, v[124:125] offset:54272
    s_mov_b64 exec, -1
    v_ashrrev_i32 v122, 5, v61
    v_lshlrev_b16 v123, 2, v61
    v_lshlrev_b32 v124, 16, v26
    v_bitop3_b32 v122, v122, v113, v113 bitop3:0x0c
    v_and_b32 v125, 0xffff0000, v26
    v_lshlrev_b32 v126, 16, v27
    v_mul_f32 v122, v114, v122
    v_and_b32 v127, 0xffff0000, v27
    v_add_u32 v123, v123, v123
    v_pk_fma_f32 v[124:125], v[124:125], v[122:123], s[34:35] op_sel_hi:[1,0,1]
    v_pk_fma_f32 v[126:127], v[126:127], v[122:123], s[34:35] op_sel_hi:[1,0,1]
    v_lshl_add_u32 v124, v125, 16, v124
    v_lshl_add_u32 v125, v127, 16, v126
    s_waitcnt lgkmcnt(15)
    v_bitop3_b32 v115, v115, v118, v119 bitop3:0xfe
    v_lshl_add_u64 v[124:125], v[124:125], 0, s[36:37]
    v_cmpx_le_u32 vcc, 0x1000000, v61
    ds_add_rtn_u64 v[118:119], v123, v[124:125] offset:54272
    s_mov_b64 exec, -1
    v_ashrrev_i32 v122, 5, v62
    v_lshlrev_b16 v123, 2, v62
    v_lshlrev_b32 v124, 16, v28
    v_bitop3_b32 v122, v122, v113, v113 bitop3:0x0c
    v_and_b32 v125, 0xffff0000, v28
    v_lshlrev_b32 v126, 16, v29
    v_mul_f32 v122, v114, v122
    v_and_b32 v127, 0xffff0000, v29
    v_add_u32 v123, v123, v123
    v_pk_fma_f32 v[124:125], v[124:125], v[122:123], s[34:35] op_sel_hi:[1,0,1]
    v_pk_fma_f32 v[126:127], v[126:127], v[122:123], s[34:35] op_sel_hi:[1,0,1]
    v_lshl_add_u32 v124, v125, 16, v124
    v_lshl_add_u32 v125, v127, 16, v126
    s_waitcnt lgkmcnt(15)
    v_bitop3_b32 v115, v115, v120, v121 bitop3:0xfe
    v_lshl_add_u64 v[124:125], v[124:125], 0, s[36:37]
    v_cmpx_le_u32 vcc, 0x1000000, v62
    ds_add_rtn_u64 v[120:121], v123, v[124:125] offset:54272
    s_mov_b64 exec, -1
    s_waitcnt vmcnt(13)
    v_perm_b32 v60, v89, v86, s31
    v_perm_b32 v61, v89, v87, s32
    v_perm_b32 v62, v89, v88, s33
    v_lshlrev_b16 v28, 3, v88
    v_lshlrev_b16 v26, 3, v87
    v_lshlrev_b16 v24, 3, v86
    s_waitcnt lgkmcnt(3)
    s_barrier
    s_cmp_ge_u32 s10, 9
    s_cbranch_scc1 p2_nm0m1a
    v_lshrrev_b32 v84, 1, v112
    s_add_u32 s44, s20, s42
    buffer_load_dwordx2 v[84:85], v84, s[4:7], s44 offen
p2_nm0m1a:
    buffer_load_dwordx4 v[72:75], v112, s[4:7], s20 offen offset:0
    buffer_load_dwordx4 v[76:79], v112, s[4:7], s20 offen offset:1024
    buffer_load_dwordx4 v[80:83], v112, s[4:7], s20 offen offset:2048
    v_cmpx_ge_u16 vcc, 0x3fff, v60
    ds_read_b64 v[24:25], v24
    s_mov_b64 exec, -1
    v_cmpx_ge_u16 vcc, 0x3fff, v61
    ds_read_b64 v[26:27], v26
    s_mov_b64 exec, -1
    v_cmpx_ge_u16 vcc, 0x3fff, v62
    ds_read_b64 v[28:29], v28
    s_mov_b64 exec, -1
    s_waitcnt lgkmcnt(15)
    v_ashrrev_i32 v122, 5, v63
    v_lshlrev_b16 v123, 2, v63
    v_lshlrev_b32 v124, 16, v30
    v_bitop3_b32 v122, v122, v113, v113 bitop3:0x0c
    v_and_b32 v125, 0xffff0000, v30
    v_lshlrev_b32 v126, 16, v31
    v_mul_f32 v122, v114, v122
    v_and_b32 v127, 0xffff0000, v31
    v_add_u32 v123, v123, v123
    v_pk_fma_f32 v[124:125], v[124:125], v[122:123], s[34:35] op_sel_hi:[1,0,1]
    v_pk_fma_f32 v[126:127], v[126:127], v[122:123], s[34:35] op_sel_hi:[1,0,1]
    v_lshl_add_u32 v124, v125, 16, v124
    v_lshl_add_u32 v125, v127, 16, v126
    s_waitcnt lgkmcnt(5)
    v_bitop3_b32 v115, v115, v116, v117 bitop3:0xfe
    v_lshl_add_u64 v[124:125], v[124:125], 0, s[36:37]
    v_cmpx_le_u32 vcc, 0x1000000, v63
    ds_add_rtn_u64 v[116:117], v123, v[124:125] offset:54272
    s_mov_b64 exec, -1
    v_ashrrev_i32 v122, 5, v64
    v_lshlrev_b16 v123, 2, v64
    v_lshlrev_b32 v124, 16, v32
    v_bitop3_b32 v122, v122, v113, v113 bitop3:0x0c
    v_and_b32 v125, 0xffff0000, v32
    v_lshlrev_b32 v126, 16, v33
    v_mul_f32 v122, v114, v122
    v_and_b32 v127, 0xffff0000, v33
    v_add_u32 v123, v123, v123
    v_pk_fma_f32 v[124:125], v[124:125], v[122:123], s[34:35] op_sel_hi:[1,0,1]
    v_pk_fma_f32 v[126:127], v[126:127], v[122:123], s[34:35] op_sel_hi:[1,0,1]
    v_lshl_add_u32 v124, v125, 16, v124
    v_lshl_add_u32 v125, v127, 16, v126
    s_waitcnt lgkmcnt(5)
    v_bitop3_b32 v115, v115, v118, v119 bitop3:0xfe
    v_lshl_add_u64 v[124:125], v[124:125], 0, s[36:37]
    v_cmpx_le_u32 vcc, 0x1000000, v64
    ds_add_rtn_u64 v[118:119], v123, v[124:125] offset:54272
    s_mov_b64 exec, -1
    v_ashrrev_i32 v122, 5, v65
    v_lshlrev_b16 v123, 2, v65
    v_lshlrev_b32 v124, 16, v34
    v_bitop3_b32 v122, v122, v113, v113 bitop3:0x0c
    v_and_b32 v125, 0xffff0000, v34
    v_lshlrev_b32 v126, 16, v35
    v_mul_f32 v122, v114, v122
    v_and_b32 v127, 0xffff0000, v35
    v_add_u32 v123, v123, v123
    v_pk_fma_f32 v[124:125], v[124:125], v[122:123], s[34:35] op_sel_hi:[1,0,1]
    v_pk_fma_f32 v[126:127], v[126:127], v[122:123], s[34:35] op_sel_hi:[1,0,1]
    v_lshl_add_u32 v124, v125, 16, v124
    v_lshl_add_u32 v125, v127, 16, v126
    s_waitcnt lgkmcnt(5)
    v_bitop3_b32 v115, v115, v120, v121 bitop3:0xfe
    v_lshl_add_u64 v[124:125], v[124:125], 0, s[36:37]
    v_cmpx_le_u32 vcc, 0x1000000, v65
    ds_add_rtn_u64 v[120:121], v123, v[124:125] offset:54272
    s_mov_b64 exec, -1
    s_waitcnt vmcnt(15)
    v_perm_b32 v63, v93, v90, s31
    v_perm_b32 v64, v93, v91, s32
    v_perm_b32 v65, v93, v92, s33
    v_lshlrev_b16 v34, 3, v92
    v_lshlrev_b16 v32, 3, v91
    v_lshlrev_b16 v30, 3, v90
    v_cmpx_ge_u16 vcc, 0x3fff, v63
    ds_read_b64 v[30:31], v30
    s_mov_b64 exec, -1
    v_cmpx_ge_u16 vcc, 0x3fff, v64
    ds_read_b64 v[32:33], v32
    s_mov_b64 exec, -1
    v_cmpx_ge_u16 vcc, 0x3fff, v65
    ds_read_b64 v[34:35], v34
    s_mov_b64 exec, -1
    s_waitcnt lgkmcnt(15)
    v_bfe_u32 v86, v106, 14, 4
    v_lshrrev_b32 v87, 18, v106
    v_and_b32 v106, 0x3fff, v106
    v_mad_u32_u24 v86, v86, s63, v87
    v_lshl_or_b32 v106, v86, 14, v106
    buffer_load_dwordx4 v[86:89], v106, s[68:71], 0 offen
    s_waitcnt lgkmcnt(15)
    v_ashrrev_i32 v122, 5, v66
    v_lshlrev_b16 v123, 2, v66
    v_lshlrev_b32 v124, 16, v36
    v_bitop3_b32 v122, v122, v113, v113 bitop3:0x0c
    v_and_b32 v125, 0xffff0000, v36
    v_lshlrev_b32 v126, 16, v37
    v_mul_f32 v122, v114, v122
    v_and_b32 v127, 0xffff0000, v37
    v_add_u32 v123, v123, v123
    v_pk_fma_f32 v[124:125], v[124:125], v[122:123], s[34:35] op_sel_hi:[1,0,1]
    v_pk_fma_f32 v[126:127], v[126:127], v[122:123], s[34:35] op_sel_hi:[1,0,1]
    v_lshl_add_u32 v124, v125, 16, v124
    v_lshl_add_u32 v125, v127, 16, v126
    s_waitcnt lgkmcnt(5)
    v_bitop3_b32 v115, v115, v116, v117 bitop3:0xfe
    v_lshl_add_u64 v[124:125], v[124:125], 0, s[36:37]
    v_cmpx_le_u32 vcc, 0x1000000, v66
    ds_add_rtn_u64 v[116:117], v123, v[124:125] offset:54272
    s_mov_b64 exec, -1
    v_ashrrev_i32 v122, 5, v67
    v_lshlrev_b16 v123, 2, v67
    v_lshlrev_b32 v124, 16, v38
    v_bitop3_b32 v122, v122, v113, v113 bitop3:0x0c
    v_and_b32 v125, 0xffff0000, v38
    v_lshlrev_b32 v126, 16, v39
    v_mul_f32 v122, v114, v122
    v_and_b32 v127, 0xffff0000, v39
    v_add_u32 v123, v123, v123
    v_pk_fma_f32 v[124:125], v[124:125], v[122:123], s[34:35] op_sel_hi:[1,0,1]
    v_pk_fma_f32 v[126:127], v[126:127], v[122:123], s[34:35] op_sel_hi:[1,0,1]
    v_lshl_add_u32 v124, v125, 16, v124
    v_lshl_add_u32 v125, v127, 16, v126
    s_waitcnt lgkmcnt(5)
    v_bitop3_b32 v115, v115, v118, v119 bitop3:0xfe
    v_lshl_add_u64 v[124:125], v[124:125], 0, s[36:37]
    v_cmpx_le_u32 vcc, 0x1000000, v67
    ds_add_rtn_u64 v[118:119], v123, v[124:125] offset:54272
    s_mov_b64 exec, -1
    v_ashrrev_i32 v122, 5, v68
    v_lshlrev_b16 v123, 2, v68
    v_lshlrev_b32 v124, 16, v40
    v_bitop3_b32 v122, v122, v113, v113 bitop3:0x0c
    v_and_b32 v125, 0xffff0000, v40
    v_lshlrev_b32 v126, 16, v41
    v_mul_f32 v122, v114, v122
    v_and_b32 v127, 0xffff0000, v41
    v_add_u32 v123, v123, v123
    v_pk_fma_f32 v[124:125], v[124:125], v[122:123], s[34:35] op_sel_hi:[1,0,1]
    v_pk_fma_f32 v[126:127], v[126:127], v[122:123], s[34:35] op_sel_hi:[1,0,1]
    v_lshl_add_u32 v124, v125, 16, v124
    v_lshl_add_u32 v125, v127, 16, v126
    s_waitcnt lgkmcnt(5)
    v_bitop3_b32 v115, v115, v120, v121 bitop3:0xfe
    v_lshl_add_u64 v[124:125], v[124:125], 0, s[36:37]
    v_cmpx_le_u32 vcc, 0x1000000, v68
    ds_add_rtn_u64 v[120:121], v123, v[124:125] offset:54272
    s_mov_b64 exec, -1
    s_waitcnt vmcnt(12)
    v_perm_b32 v66, v97, v94, s31
    v_perm_b32 v67, v97, v95, s32
    v_perm_b32 v68, v97, v96, s33
    v_lshlrev_b16 v40, 3, v96
    v_lshlrev_b16 v38, 3, v95
    v_lshlrev_b16 v36, 3, v94
    v_cmpx_ge_u16 vcc, 0x3fff, v66
    ds_read_b64 v[36:37], v36
    s_mov_b64 exec, -1
    v_cmpx_ge_u16 vcc, 0x3fff, v67
    ds_read_b64 v[38:39], v38
    s_mov_b64 exec, -1
    v_cmpx_ge_u16 vcc, 0x3fff, v68
    ds_read_b64 v[40:41], v40
    s_mov_b64 exec, -1
    s_cmp_le_u32 s15, 7
    s_cbranch_scc1 p2_na0a7
    s_waitcnt lgkmcnt(15)
    v_ashrrev_i32 v122, 5, v69
    v_lshlrev_b16 v123, 2, v69
    v_lshlrev_b32 v124, 16, v42
    v_bitop3_b32 v122, v122, v113, v113 bitop3:0x0c
    v_and_b32 v125, 0xffff0000, v42
    v_lshlrev_b32 v126, 16, v43
    v_mul_f32 v122, v114, v122
    v_and_b32 v127, 0xffff0000, v43
    v_add_u32 v123, v123, v123
    v_pk_fma_f32 v[124:125], v[124:125], v[122:123], s[34:35] op_sel_hi:[1,0,1]
    v_pk_fma_f32 v[126:127], v[126:127], v[122:123], s[34:35] op_sel_hi:[1,0,1]
    v_lshl_add_u32 v124, v125, 16, v124
    v_lshl_add_u32 v125, v127, 16, v126
    s_waitcnt lgkmcnt(5)
    v_bitop3_b32 v115, v115, v116, v117 bitop3:0xfe
    v_lshl_add_u64 v[124:125], v[124:125], 0, s[36:37]
    v_cmpx_le_u32 vcc, 0x1000000, v69
    ds_add_rtn_u64 v[116:117], v123, v[124:125] offset:54272
    s_mov_b64 exec, -1
    v_ashrrev_i32 v122, 5, v70
    v_lshlrev_b16 v123, 2, v70
    v_lshlrev_b32 v124, 16, v44
    v_bitop3_b32 v122, v122, v113, v113 bitop3:0x0c
    v_and_b32 v125, 0xffff0000, v44
    v_lshlrev_b32 v126, 16, v45
    v_mul_f32 v122, v114, v122
    v_and_b32 v127, 0xffff0000, v45
    v_add_u32 v123, v123, v123
    v_pk_fma_f32 v[124:125], v[124:125], v[122:123], s[34:35] op_sel_hi:[1,0,1]
    v_pk_fma_f32 v[126:127], v[126:127], v[122:123], s[34:35] op_sel_hi:[1,0,1]
    v_lshl_add_u32 v124, v125, 16, v124
    v_lshl_add_u32 v125, v127, 16, v126
    s_waitcnt lgkmcnt(5)
    v_bitop3_b32 v115, v115, v118, v119 bitop3:0xfe
    v_lshl_add_u64 v[124:125], v[124:125], 0, s[36:37]
    v_cmpx_le_u32 vcc, 0x1000000, v70
    ds_add_rtn_u64 v[118:119], v123, v[124:125] offset:54272
    s_mov_b64 exec, -1
    v_ashrrev_i32 v122, 5, v71
    v_lshlrev_b16 v123, 2, v71
    v_lshlrev_b32 v124, 16, v46
    v_bitop3_b32 v122, v122, v113, v113 bitop3:0x0c
    v_and_b32 v125, 0xffff0000, v46
    v_lshlrev_b32 v126, 16, v47
    v_mul_f32 v122, v114, v122
    v_and_b32 v127, 0xffff0000, v47
    v_add_u32 v123, v123, v123
    v_pk_fma_f32 v[124:125], v[124:125], v[122:123], s[34:35] op_sel_hi:[1,0,1]
    v_pk_fma_f32 v[126:127], v[126:127], v[122:123], s[34:35] op_sel_hi:[1,0,1]
    v_lshl_add_u32 v124, v125, 16, v124
    v_lshl_add_u32 v125, v127, 16, v126
    s_waitcnt lgkmcnt(5)
    v_bitop3_b32 v115, v115, v120, v121 bitop3:0xfe
    v_lshl_add_u64 v[124:125], v[124:125], 0, s[36:37]
    v_cmpx_le_u32 vcc, 0x1000000, v71
    ds_add_rtn_u64 v[120:121], v123, v[124:125] offset:54272
    s_mov_b64 exec, -1
p2_na0a7:
    s_waitcnt vmcnt(11)
    v_perm_b32 v69, v101, v98, s31
    v_perm_b32 v70, v101, v99, s32
    v_perm_b32 v71, v101, v100, s33
    v_lshlrev_b16 v46, 3, v100
    v_lshlrev_b16 v44, 3, v99
    v_lshlrev_b16 v42, 3, v98
    s_cmp_le_u32 s16, 7
    s_cbranch_scc1 p2_g0r07
    v_cmpx_ge_u16 vcc, 0x3fff, v69
    ds_read_b64 v[42:43], v42
    s_mov_b64 exec, -1
    v_cmpx_ge_u16 vcc, 0x3fff, v70
    ds_read_b64 v[44:45], v44
    s_mov_b64 exec, -1
    v_cmpx_ge_u16 vcc, 0x3fff, v71
    ds_read_b64 v[46:47], v46
    s_mov_b64 exec, -1
p2_g0r07:
    s_waitcnt lgkmcnt(15)
    v_bfe_u32 v90, v107, 14, 4
    v_lshrrev_b32 v91, 18, v107
    v_and_b32 v107, 0x3fff, v107
    v_mad_u32_u24 v90, v90, s63, v91
    v_lshl_or_b32 v107, v90, 14, v107
    buffer_load_dwordx4 v[90:93], v107, s[68:71], 0 offen
    s_waitcnt vmcnt(8)
    v_perm_b32 v48, v3, v0, s31
    v_perm_b32 v49, v3, v1, s32
    v_perm_b32 v50, v3, v2, s33
    v_lshlrev_b16 v4, 3, v2
    v_lshlrev_b16 v2, 3, v1
    v_lshlrev_b16 v0, 3, v0
    v_cmpx_ge_u16 vcc, 0x3fff, v48
    ds_read_b64 v[0:1], v0
    s_mov_b64 exec, -1
    v_cmpx_ge_u16 vcc, 0x3fff, v49
    ds_read_b64 v[2:3], v2
    s_mov_b64 exec, -1
    v_cmpx_ge_u16 vcc, 0x3fff, v50
    ds_read_b64 v[4:5], v4
    s_mov_b64 exec, -1
    s_waitcnt vmcnt(7)
    v_perm_b32 v51, v9, v6, s31
    v_perm_b32 v52, v9, v7, s32
    v_perm_b32 v53, v9, v8, s33
    v_lshlrev_b16 v10, 3, v8
    v_lshlrev_b16 v8, 3, v7
    v_lshlrev_b16 v6, 3, v6
    v_cmpx_ge_u16 vcc, 0x3fff, v51
    ds_read_b64 v[6:7], v6
    s_mov_b64 exec, -1
    v_cmpx_ge_u16 vcc, 0x3fff, v52
    ds_read_b64 v[8:9], v8
    s_mov_b64 exec, -1
    v_cmpx_ge_u16 vcc, 0x3fff, v53
    ds_read_b64 v[10:11], v10
    s_mov_b64 exec, -1
    s_waitcnt vmcnt(6)
    v_perm_b32 v54, v15, v12, s31
    v_perm_b32 v55, v15, v13, s32
    v_perm_b32 v56, v15, v14, s33
    v_lshlrev_b16 v16, 3, v14
    v_lshlrev_b16 v14, 3, v13
    v_lshlrev_b16 v12, 3, v12
    v_cmpx_ge_u16 vcc, 0x3fff, v54
    ds_read_b64 v[12:13], v12
    s_mov_b64 exec, -1
    v_cmpx_ge_u16 vcc, 0x3fff, v55
    ds_read_b64 v[14:15], v14
    s_mov_b64 exec, -1
    v_cmpx_ge_u16 vcc, 0x3fff, v56
    ds_read_b64 v[16:17], v16
    s_mov_b64 exec, -1
    s_waitcnt vmcnt(5)
    v_perm_b32 v57, v21, v18, s31
    v_perm_b32 v58, v21, v19, s32
    v_perm_b32 v59, v21, v20, s33
    v_lshlrev_b16 v22, 3, v20
    v_lshlrev_b16 v20, 3, v19
    v_lshlrev_b16 v18, 3, v18
    v_cmpx_ge_u16 vcc, 0x3fff, v57
    ds_read_b64 v[18:19], v18
    s_mov_b64 exec, -1
    v_cmpx_ge_u16 vcc, 0x3fff, v58
    ds_read_b64 v[20:21], v20
    s_mov_b64 exec, -1
    v_cmpx_ge_u16 vcc, 0x3fff, v59
    ds_read_b64 v[22:23], v22
    s_mov_b64 exec, -1
    s_waitcnt lgkmcnt(0)
    s_barrier
    s_waitcnt lgkmcnt(15)
    s_branch p2_tail
p2_drain0:
    v_cmpx_gt_i16 vcc, 0, v48
    ds_read_b64 v[0:1], v0
    s_mov_b64 exec, -1
    v_cmpx_gt_i16 vcc, 0, v49
    ds_read_b64 v[2:3], v2
    s_mov_b64 exec, -1
    v_cmpx_gt_i16 vcc, 0, v50
    ds_read_b64 v[4:5], v4
    s_mov_b64 exec, -1
    v_cmpx_gt_i16 vcc, 0, v51
    ds_read_b64 v[6:7], v6
    s_mov_b64 exec, -1
    v_cmpx_gt_i16 vcc, 0, v52
    ds_read_b64 v[8:9], v8
    s_mov_b64 exec, -1
    v_cmpx_gt_i16 vcc, 0, v53
    ds_read_b64 v[10:11], v10
    s_mov_b64 exec, -1
    v_cmpx_gt_i16 vcc, 0, v54
    ds_read_b64 v[12:13], v12
    s_mov_b64 exec, -1
    v_cmpx_gt_i16 vcc, 0, v55
    ds_read_b64 v[14:15], v14
    s_mov_b64 exec, -1
    v_cmpx_gt_i16 vcc, 0, v56
    ds_read_b64 v[16:17], v16
    s_mov_b64 exec, -1
    v_cmpx_gt_i16 vcc, 0, v57
    ds_read_b64 v[18:19], v18
    s_mov_b64 exec, -1
    v_cmpx_gt_i16 vcc, 0, v58
    ds_read_b64 v[20:21], v20
    s_mov_b64 exec, -1
    v_cmpx_gt_i16 vcc, 0, v59
    ds_read_b64 v[22:23], v22
    s_mov_b64 exec, -1
    v_cmpx_gt_i16 vcc, 0, v60
    ds_read_b64 v[24:25], v24
    s_mov_b64 exec, -1
    v_cmpx_gt_i16 vcc, 0, v61
    ds_read_b64 v[26:27], v26
    s_mov_b64 exec, -1
    v_cmpx_gt_i16 vcc, 0, v62
    ds_read_b64 v[28:29], v28
    s_mov_b64 exec, -1
    v_cmpx_gt_i16 vcc, 0, v63
    ds_read_b64 v[30:31], v30
    s_mov_b64 exec, -1
    v_cmpx_gt_i16 vcc, 0, v64
    ds_read_b64 v[32:33], v32
    s_mov_b64 exec, -1
    v_cmpx_gt_i16 vcc, 0, v65
    ds_read_b64 v[34:35], v34
    s_mov_b64 exec, -1
    v_cmpx_gt_i16 vcc, 0, v66
    ds_read_b64 v[36:37], v36
    s_mov_b64 exec, -1
    v_cmpx_gt_i16 vcc, 0, v67
    ds_read_b64 v[38:39], v38
    s_mov_b64 exec, -1
    v_cmpx_gt_i16 vcc, 0, v68
    ds_read_b64 v[40:41], v40
    s_mov_b64 exec, -1
    s_cmp_le_u32 s15, 7
    s_cbranch_scc1 p2_gd0
    v_cmpx_gt_i16 vcc, 0, v69
    ds_read_b64 v[42:43], v42
    s_mov_b64 exec, -1
    v_cmpx_gt_i16 vcc, 0, v70
    ds_read_b64 v[44:45], v44
    s_mov_b64 exec, -1
    v_cmpx_gt_i16 vcc, 0, v71
    ds_read_b64 v[46:47], v46
    s_mov_b64 exec, -1
p2_gd0:
    s_waitcnt lgkmcnt(15)
    v_ashrrev_i32 v122, 5, v48
    v_lshlrev_b16 v123, 2, v48
    v_lshlrev_b32 v124, 16, v0
    v_bitop3_b32 v122, v122, v113, v113 bitop3:0x0c
    v_and_b32 v125, 0xffff0000, v0
    v_lshlrev_b32 v126, 16, v1
    v_mul_f32 v122, v114, v122
    v_and_b32 v127, 0xffff0000, v1
    v_add_u32 v123, v123, v123
    v_pk_fma_f32 v[124:125], v[124:125], v[122:123], s[34:35] op_sel_hi:[1,0,1]
    v_pk_fma_f32 v[126:127], v[126:127], v[122:123], s[34:35] op_sel_hi:[1,0,1]
    v_lshl_add_u32 v124, v125, 16, v124
    v_lshl_add_u32 v125, v127, 16, v126
    s_waitcnt lgkmcnt(15)
    v_bitop3_b32 v115, v115, v116, v117 bitop3:0xfe
    v_lshl_add_u64 v[124:125], v[124:125], 0, s[36:37]
    v_cmpx_le_u32 vcc, 0x1000000, v48
    ds_add_rtn_u64 v[116:117], v123, v[124:125] offset:54272
    s_mov_b64 exec, -1
    v_ashrrev_i32 v122, 5, v49
    v_lshlrev_b16 v123, 2, v49
    v_lshlrev_b32 v124, 16, v2
    v_bitop3_b32 v122, v122, v113, v113 bitop3:0x0c
    v_and_b32 v125, 0xffff0000, v2
    v_lshlrev_b32 v126, 16, v3
    v_mul_f32 v122, v114, v122
    v_and_b32 v127, 0xffff0000, v3
    v_add_u32 v123, v123, v123
    v_pk_fma_f32 v[124:125], v[124:125], v[122:123], s[34:35] op_sel_hi:[1,0,1]
    v_pk_fma_f32 v[126:127], v[126:127], v[122:123], s[34:35] op_sel_hi:[1,0,1]
    v_lshl_add_u32 v124, v125, 16, v124
    v_lshl_add_u32 v125, v127, 16, v126
    s_waitcnt lgkmcnt(15)
    v_bitop3_b32 v115, v115, v118, v119 bitop3:0xfe
    v_lshl_add_u64 v[124:125], v[124:125], 0, s[36:37]
    v_cmpx_le_u32 vcc, 0x1000000, v49
    ds_add_rtn_u64 v[118:119], v123, v[124:125] offset:54272
    s_mov_b64 exec, -1
    v_ashrrev_i32 v122, 5, v50
    v_lshlrev_b16 v123, 2, v50
    v_lshlrev_b32 v124, 16, v4
    v_bitop3_b32 v122, v122, v113, v113 bitop3:0x0c
    v_and_b32 v125, 0xffff0000, v4
    v_lshlrev_b32 v126, 16, v5
    v_mul_f32 v122, v114, v122
    v_and_b32 v127, 0xffff0000, v5
    v_add_u32 v123, v123, v123
    v_pk_fma_f32 v[124:125], v[124:125], v[122:123], s[34:35] op_sel_hi:[1,0,1]
    v_pk_fma_f32 v[126:127], v[126:127], v[122:123], s[34:35] op_sel_hi:[1,0,1]
    v_lshl_add_u32 v124, v125, 16, v124
    v_lshl_add_u32 v125, v127, 16, v126
    s_waitcnt lgkmcnt(15)
    v_bitop3_b32 v115, v115, v120, v121 bitop3:0xfe
    v_lshl_add_u64 v[124:125], v[124:125], 0, s[36:37]
    v_cmpx_le_u32 vcc, 0x1000000, v50
    ds_add_rtn_u64 v[120:121], v123, v[124:125] offset:54272
    s_mov_b64 exec, -1
    s_waitcnt lgkmcnt(15)
    v_ashrrev_i32 v122, 5, v51
    v_lshlrev_b16 v123, 2, v51
    v_lshlrev_b32 v124, 16, v6
    v_bitop3_b32 v122, v122, v113, v113 bitop3:0x0c
    v_and_b32 v125, 0xffff0000, v6
    v_lshlrev_b32 v126, 16, v7
    v_mul_f32 v122, v114, v122
    v_and_b32 v127, 0xffff0000, v7
    v_add_u32 v123, v123, v123
    v_pk_fma_f32 v[124:125], v[124:125], v[122:123], s[34:35] op_sel_hi:[1,0,1]
    v_pk_fma_f32 v[126:127], v[126:127], v[122:123], s[34:35] op_sel_hi:[1,0,1]
    v_lshl_add_u32 v124, v125, 16, v124
    v_lshl_add_u32 v125, v127, 16, v126
    s_waitcnt lgkmcnt(2)
    v_bitop3_b32 v115, v115, v116, v117 bitop3:0xfe
    v_lshl_add_u64 v[124:125], v[124:125], 0, s[36:37]
    v_cmpx_le_u32 vcc, 0x1000000, v51
    ds_add_rtn_u64 v[116:117], v123, v[124:125] offset:54272
    s_mov_b64 exec, -1
    v_ashrrev_i32 v122, 5, v52
    v_lshlrev_b16 v123, 2, v52
    v_lshlrev_b32 v124, 16, v8
    v_bitop3_b32 v122, v122, v113, v113 bitop3:0x0c
    v_and_b32 v125, 0xffff0000, v8
    v_lshlrev_b32 v126, 16, v9
    v_mul_f32 v122, v114, v122
    v_and_b32 v127, 0xffff0000, v9
    v_add_u32 v123, v123, v123
    v_pk_fma_f32 v[124:125], v[124:125], v[122:123], s[34:35] op_sel_hi:[1,0,1]
    v_pk_fma_f32 v[126:127], v[126:127], v[122:123], s[34:35] op_sel_hi:[1,0,1]
    v_lshl_add_u32 v124, v125, 16, v124
    v_lshl_add_u32 v125, v127, 16, v126
    s_waitcnt lgkmcnt(2)
    v_bitop3_b32 v115, v115, v118, v119 bitop3:0xfe
    v_lshl_add_u64 v[124:125], v[124:125], 0, s[36:37]
    v_cmpx_le_u32 vcc, 0x1000000, v52
    ds_add_rtn_u64 v[118:119], v123, v[124:125] offset:54272
    s_mov_b64 exec, -1
    v_ashrrev_i32 v122, 5, v53
    v_lshlrev_b16 v123, 2, v53
    v_lshlrev_b32 v124, 16, v10
    v_bitop3_b32 v122, v122, v113, v113 bitop3:0x0c
    v_and_b32 v125, 0xffff0000, v10
    v_lshlrev_b32 v126, 16, v11
    v_mul_f32 v122, v114, v122
    v_and_b32 v127, 0xffff0000, v11
    v_add_u32 v123, v123, v123
    v_pk_fma_f32 v[124:125], v[124:125], v[122:123], s[34:35] op_sel_hi:[1,0,1]
    v_pk_fma_f32 v[126:127], v[126:127], v[122:123], s[34:35] op_sel_hi:[1,0,1]
    v_lshl_add_u32 v124, v125, 16, v124
    v_lshl_add_u32 v125, v127, 16, v126
    s_waitcnt lgkmcnt(2)
    v_bitop3_b32 v115, v115, v120, v121 bitop3:0xfe
    v_lshl_add_u64 v[124:125], v[124:125], 0, s[36:37]
    v_cmpx_le_u32 vcc, 0x1000000, v53
    ds_add_rtn_u64 v[120:121], v123, v[124:125] offset:54272
    s_mov_b64 exec, -1
    s_waitcnt lgkmcnt(15)
    v_ashrrev_i32 v122, 5, v54
    v_lshlrev_b16 v123, 2, v54
    v_lshlrev_b32 v124, 16, v12
    v_bitop3_b32 v122, v122, v113, v113 bitop3:0x0c
    v_and_b32 v125, 0xffff0000, v12
    v_lshlrev_b32 v126, 16, v13
    v_mul_f32 v122, v114, v122
    v_and_b32 v127, 0xffff0000, v13
    v_add_u32 v123, v123, v123
    v_pk_fma_f32 v[124:125], v[124:125], v[122:123], s[34:35] op_sel_hi:[1,0,1]
    v_pk_fma_f32 v[126:127], v[126:127], v[122:123], s[34:35] op_sel_hi:[1,0,1]
    v_lshl_add_u32 v124, v125, 16, v124
    v_lshl_add_u32 v125, v127, 16, v126
    s_waitcnt lgkmcnt(2)
    v_bitop3_b32 v115, v115, v116, v117 bitop3:0xfe
    v_lshl_add_u64 v[124:125], v[124:125], 0, s[36:37]
    v_cmpx_le_u32 vcc, 0x1000000, v54
    ds_add_rtn_u64 v[116:117], v123, v[124:125] offset:54272
    s_mov_b64 exec, -1
    v_ashrrev_i32 v122, 5, v55
    v_lshlrev_b16 v123, 2, v55
    v_lshlrev_b32 v124, 16, v14
    v_bitop3_b32 v122, v122, v113, v113 bitop3:0x0c
    v_and_b32 v125, 0xffff0000, v14
    v_lshlrev_b32 v126, 16, v15
    v_mul_f32 v122, v114, v122
    v_and_b32 v127, 0xffff0000, v15
    v_add_u32 v123, v123, v123
    v_pk_fma_f32 v[124:125], v[124:125], v[122:123], s[34:35] op_sel_hi:[1,0,1]
    v_pk_fma_f32 v[126:127], v[126:127], v[122:123], s[34:35] op_sel_hi:[1,0,1]
    v_lshl_add_u32 v124, v125, 16, v124
    v_lshl_add_u32 v125, v127, 16, v126
    s_waitcnt lgkmcnt(2)
    v_bitop3_b32 v115, v115, v118, v119 bitop3:0xfe
    v_lshl_add_u64 v[124:125], v[124:125], 0, s[36:37]
    v_cmpx_le_u32 vcc, 0x1000000, v55
    ds_add_rtn_u64 v[118:119], v123, v[124:125] offset:54272
    s_mov_b64 exec, -1
    v_ashrrev_i32 v122, 5, v56
    v_lshlrev_b16 v123, 2, v56
    v_lshlrev_b32 v124, 16, v16
    v_bitop3_b32 v122, v122, v113, v113 bitop3:0x0c
    v_and_b32 v125, 0xffff0000, v16
    v_lshlrev_b32 v126, 16, v17
    v_mul_f32 v122, v114, v122
    v_and_b32 v127, 0xffff0000, v17
    v_add_u32 v123, v123, v123
    v_pk_fma_f32 v[124:125], v[124:125], v[122:123], s[34:35] op_sel_hi:[1,0,1]
    v_pk_fma_f32 v[126:127], v[126:127], v[122:123], s[34:35] op_sel_hi:[1,0,1]
    v_lshl_add_u32 v124, v125, 16, v124
    v_lshl_add_u32 v125, v127, 16, v126
    s_waitcnt lgkmcnt(2)
    v_bitop3_b32 v115, v115, v120, v121 bitop3:0xfe
    v_lshl_add_u64 v[124:125], v[124:125], 0, s[36:37]
    v_cmpx_le_u32 vcc, 0x1000000, v56
    ds_add_rtn_u64 v[120:121], v123, v[124:125] offset:54272
    s_mov_b64 exec, -1
    s_waitcnt lgkmcnt(15)
    v_ashrrev_i32 v122, 5, v57
    v_lshlrev_b16 v123, 2, v57
    v_lshlrev_b32 v124, 16, v18
    v_bitop3_b32 v122, v122, v113, v113 bitop3:0x0c
    v_and_b32 v125, 0xffff0000, v18
    v_lshlrev_b32 v126, 16, v19
    v_mul_f32 v122, v114, v122
    v_and_b32 v127, 0xffff0000, v19
    v_add_u32 v123, v123, v123
    v_pk_fma_f32 v[124:125], v[124:125], v[122:123], s[34:35] op_sel_hi:[1,0,1]
    v_pk_fma_f32 v[126:127], v[126:127], v[122:123], s[34:35] op_sel_hi:[1,0,1]
    v_lshl_add_u32 v124, v125, 16, v124
    v_lshl_add_u32 v125, v127, 16, v126
    s_waitcnt lgkmcnt(2)
    v_bitop3_b32 v115, v115, v116, v117 bitop3:0xfe
    v_lshl_add_u64 v[124:125], v[124:125], 0, s[36:37]
    v_cmpx_le_u32 vcc, 0x1000000, v57
    ds_add_rtn_u64 v[116:117], v123, v[124:125] offset:54272
    s_mov_b64 exec, -1
    v_ashrrev_i32 v122, 5, v58
    v_lshlrev_b16 v123, 2, v58
    v_lshlrev_b32 v124, 16, v20
    v_bitop3_b32 v122, v122, v113, v113 bitop3:0x0c
    v_and_b32 v125, 0xffff0000, v20
    v_lshlrev_b32 v126, 16, v21
    v_mul_f32 v122, v114, v122
    v_and_b32 v127, 0xffff0000, v21
    v_add_u32 v123, v123, v123
    v_pk_fma_f32 v[124:125], v[124:125], v[122:123], s[34:35] op_sel_hi:[1,0,1]
    v_pk_fma_f32 v[126:127], v[126:127], v[122:123], s[34:35] op_sel_hi:[1,0,1]
    v_lshl_add_u32 v124, v125, 16, v124
    v_lshl_add_u32 v125, v127, 16, v126
    s_waitcnt lgkmcnt(2)
    v_bitop3_b32 v115, v115, v118, v119 bitop3:0xfe
    v_lshl_add_u64 v[124:125], v[124:125], 0, s[36:37]
    v_cmpx_le_u32 vcc, 0x1000000, v58
    ds_add_rtn_u64 v[118:119], v123, v[124:125] offset:54272
    s_mov_b64 exec, -1
    v_ashrrev_i32 v122, 5, v59
    v_lshlrev_b16 v123, 2, v59
    v_lshlrev_b32 v124, 16, v22
    v_bitop3_b32 v122, v122, v113, v113 bitop3:0x0c
    v_and_b32 v125, 0xffff0000, v22
    v_lshlrev_b32 v126, 16, v23
    v_mul_f32 v122, v114, v122
    v_and_b32 v127, 0xffff0000, v23
    v_add_u32 v123, v123, v123
    v_pk_fma_f32 v[124:125], v[124:125], v[122:123], s[34:35] op_sel_hi:[1,0,1]
    v_pk_fma_f32 v[126:127], v[126:127], v[122:123], s[34:35] op_sel_hi:[1,0,1]
    v_lshl_add_u32 v124, v125, 16, v124
    v_lshl_add_u32 v125, v127, 16, v126
    s_waitcnt lgkmcnt(2)
    v_bitop3_b32 v115, v115, v120, v121 bitop3:0xfe
    v_lshl_add_u64 v[124:125], v[124:125], 0, s[36:37]
    v_cmpx_le_u32 vcc, 0x1000000, v59
    ds_add_rtn_u64 v[120:121], v123, v[124:125] offset:54272
    s_mov_b64 exec, -1
    s_waitcnt lgkmcnt(15)
    v_ashrrev_i32 v122, 5, v60
    v_lshlrev_b16 v123, 2, v60
    v_lshlrev_b32 v124, 16, v24
    v_bitop3_b32 v122, v122, v113, v113 bitop3:0x0c
    v_and_b32 v125, 0xffff0000, v24
    v_lshlrev_b32 v126, 16, v25
    v_mul_f32 v122, v114, v122
    v_and_b32 v127, 0xffff0000, v25
    v_add_u32 v123, v123, v123
    v_pk_fma_f32 v[124:125], v[124:125], v[122:123], s[34:35] op_sel_hi:[1,0,1]
    v_pk_fma_f32 v[126:127], v[126:127], v[122:123], s[34:35] op_sel_hi:[1,0,1]
    v_lshl_add_u32 v124, v125, 16, v124
    v_lshl_add_u32 v125, v127, 16, v126
    s_waitcnt lgkmcnt(2)
    v_bitop3_b32 v115, v115, v116, v117 bitop3:0xfe
    v_lshl_add_u64 v[124:125], v[124:125], 0, s[36:37]
    v_cmpx_le_u32 vcc, 0x1000000, v60
    ds_add_rtn_u64 v[116:117], v123, v[124:125] offset:54272
    s_mov_b64 exec, -1
    v_ashrrev_i32 v122, 5, v61
    v_lshlrev_b16 v123, 2, v61
    v_lshlrev_b32 v124, 16, v26
    v_bitop3_b32 v122, v122, v113, v113 bitop3:0x0c
    v_and_b32 v125, 0xffff0000, v26
    v_lshlrev_b32 v126, 16, v27
    v_mul_f32 v122, v114, v122
    v_and_b32 v127, 0xffff0000, v27
    v_add_u32 v123, v123, v123
    v_pk_fma_f32 v[124:125], v[124:125], v[122:123], s[34:35] op_sel_hi:[1,0,1]
    v_pk_fma_f32 v[126:127], v[126:127], v[122:123], s[34:35] op_sel_hi:[1,0,1]
    v_lshl_add_u32 v124, v125, 16, v124
    v_lshl_add_u32 v125, v127, 16, v126
    s_waitcnt lgkmcnt(2)
    v_bitop3_b32 v115, v115, v118, v119 bitop3:0xfe
    v_lshl_add_u64 v[124:125], v[124:125], 0, s[36:37]
    v_cmpx_le_u32 vcc, 0x1000000, v61
    ds_add_rtn_u64 v[118:119], v123, v[124:125] offset:54272
    s_mov_b64 exec, -1
    v_ashrrev_i32 v122, 5, v62
    v_lshlrev_b16 v123, 2, v62
    v_lshlrev_b32 v124, 16, v28
    v_bitop3_b32 v122, v122, v113, v113 bitop3:0x0c
    v_and_b32 v125, 0xffff0000, v28
    v_lshlrev_b32 v126, 16, v29
    v_mul_f32 v122, v114, v122
    v_and_b32 v127, 0xffff0000, v29
    v_add_u32 v123, v123, v123
    v_pk_fma_f32 v[124:125], v[124:125], v[122:123], s[34:35] op_sel_hi:[1,0,1]
    v_pk_fma_f32 v[126:127], v[126:127], v[122:123], s[34:35] op_sel_hi:[1,0,1]
    v_lshl_add_u32 v124, v125, 16, v124
    v_lshl_add_u32 v125, v127, 16, v126
    s_waitcnt lgkmcnt(2)
    v_bitop3_b32 v115, v115, v120, v121 bitop3:0xfe
    v_lshl_add_u64 v[124:125], v[124:125], 0, s[36:37]
    v_cmpx_le_u32 vcc, 0x1000000, v62
    ds_add_rtn_u64 v[120:121], v123, v[124:125] offset:54272
    s_mov_b64 exec, -1
    s_waitcnt lgkmcnt(15)
    v_ashrrev_i32 v122, 5, v63
    v_lshlrev_b16 v123, 2, v63
    v_lshlrev_b32 v124, 16, v30
    v_bitop3_b32 v122, v122, v113, v113 bitop3:0x0c
    v_and_b32 v125, 0xffff0000, v30
    v_lshlrev_b32 v126, 16, v31
    v_mul_f32 v122, v114, v122
    v_and_b32 v127, 0xffff0000, v31
    v_add_u32 v123, v123, v123
    v_pk_fma_f32 v[124:125], v[124:125], v[122:123], s[34:35] op_sel_hi:[1,0,1]
    v_pk_fma_f32 v[126:127], v[126:127], v[122:123], s[34:35] op_sel_hi:[1,0,1]
    v_lshl_add_u32 v124, v125, 16, v124
    v_lshl_add_u32 v125, v127, 16, v126
    s_waitcnt lgkmcnt(2)
    v_bitop3_b32 v115, v115, v116, v117 bitop3:0xfe
    v_lshl_add_u64 v[124:125], v[124:125], 0, s[36:37]
    v_cmpx_le_u32 vcc, 0x1000000, v63
    ds_add_rtn_u64 v[116:117], v123, v[124:125] offset:54272
    s_mov_b64 exec, -1
    v_ashrrev_i32 v122, 5, v64
    v_lshlrev_b16 v123, 2, v64
    v_lshlrev_b32 v124, 16, v32
    v_bitop3_b32 v122, v122, v113, v113 bitop3:0x0c
    v_and_b32 v125, 0xffff0000, v32
    v_lshlrev_b32 v126, 16, v33
    v_mul_f32 v122, v114, v122
    v_and_b32 v127, 0xffff0000, v33
    v_add_u32 v123, v123, v123
    v_pk_fma_f32 v[124:125], v[124:125], v[122:123], s[34:35] op_sel_hi:[1,0,1]
    v_pk_fma_f32 v[126:127], v[126:127], v[122:123], s[34:35] op_sel_hi:[1,0,1]
    v_lshl_add_u32 v124, v125, 16, v124
    v_lshl_add_u32 v125, v127, 16, v126
    s_waitcnt lgkmcnt(2)
    v_bitop3_b32 v115, v115, v118, v119 bitop3:0xfe
    v_lshl_add_u64 v[124:125], v[124:125], 0, s[36:37]
    v_cmpx_le_u32 vcc, 0x1000000, v64
    ds_add_rtn_u64 v[118:119], v123, v[124:125] offset:54272
    s_mov_b64 exec, -1
    v_ashrrev_i32 v122, 5, v65
    v_lshlrev_b16 v123, 2, v65
    v_lshlrev_b32 v124, 16, v34
    v_bitop3_b32 v122, v122, v113, v113 bitop3:0x0c
    v_and_b32 v125, 0xffff0000, v34
    v_lshlrev_b32 v126, 16, v35
    v_mul_f32 v122, v114, v122
    v_and_b32 v127, 0xffff0000, v35
    v_add_u32 v123, v123, v123
    v_pk_fma_f32 v[124:125], v[124:125], v[122:123], s[34:35] op_sel_hi:[1,0,1]
    v_pk_fma_f32 v[126:127], v[126:127], v[122:123], s[34:35] op_sel_hi:[1,0,1]
    v_lshl_add_u32 v124, v125, 16, v124
    v_lshl_add_u32 v125, v127, 16, v126
    s_waitcnt lgkmcnt(2)
    v_bitop3_b32 v115, v115, v120, v121 bitop3:0xfe
    v_lshl_add_u64 v[124:125], v[124:125], 0, s[36:37]
    v_cmpx_le_u32 vcc, 0x1000000, v65
    ds_add_rtn_u64 v[120:121], v123, v[124:125] offset:54272
    s_mov_b64 exec, -1
    s_waitcnt lgkmcnt(15)
    v_ashrrev_i32 v122, 5, v66
    v_lshlrev_b16 v123, 2, v66
    v_lshlrev_b32 v124, 16, v36
    v_bitop3_b32 v122, v122, v113, v113 bitop3:0x0c
    v_and_b32 v125, 0xffff0000, v36
    v_lshlrev_b32 v126, 16, v37
    v_mul_f32 v122, v114, v122
    v_and_b32 v127, 0xffff0000, v37
    v_add_u32 v123, v123, v123
    v_pk_fma_f32 v[124:125], v[124:125], v[122:123], s[34:35] op_sel_hi:[1,0,1]
    v_pk_fma_f32 v[126:127], v[126:127], v[122:123], s[34:35] op_sel_hi:[1,0,1]
    v_lshl_add_u32 v124, v125, 16, v124
    v_lshl_add_u32 v125, v127, 16, v126
    s_waitcnt lgkmcnt(2)
    v_bitop3_b32 v115, v115, v116, v117 bitop3:0xfe
    v_lshl_add_u64 v[124:125], v[124:125], 0, s[36:37]
    v_cmpx_le_u32 vcc, 0x1000000, v66
    ds_add_rtn_u64 v[116:117], v123, v[124:125] offset:54272
    s_mov_b64 exec, -1
    v_ashrrev_i32 v122, 5, v67
    v_lshlrev_b16 v123, 2, v67
    v_lshlrev_b32 v124, 16, v38
    v_bitop3_b32 v122, v122, v113, v113 bitop3:0x0c
    v_and_b32 v125, 0xffff0000, v38
    v_lshlrev_b32 v126, 16, v39
    v_mul_f32 v122, v114, v122
    v_and_b32 v127, 0xffff0000, v39
    v_add_u32 v123, v123, v123
    v_pk_fma_f32 v[124:125], v[124:125], v[122:123], s[34:35] op_sel_hi:[1,0,1]
    v_pk_fma_f32 v[126:127], v[126:127], v[122:123], s[34:35] op_sel_hi:[1,0,1]
    v_lshl_add_u32 v124, v125, 16, v124
    v_lshl_add_u32 v125, v127, 16, v126
    s_waitcnt lgkmcnt(2)
    v_bitop3_b32 v115, v115, v118, v119 bitop3:0xfe
    v_lshl_add_u64 v[124:125], v[124:125], 0, s[36:37]
    v_cmpx_le_u32 vcc, 0x1000000, v67
    ds_add_rtn_u64 v[118:119], v123, v[124:125] offset:54272
    s_mov_b64 exec, -1
    v_ashrrev_i32 v122, 5, v68
    v_lshlrev_b16 v123, 2, v68
    v_lshlrev_b32 v124, 16, v40
    v_bitop3_b32 v122, v122, v113, v113 bitop3:0x0c
    v_and_b32 v125, 0xffff0000, v40
    v_lshlrev_b32 v126, 16, v41
    v_mul_f32 v122, v114, v122
    v_and_b32 v127, 0xffff0000, v41
    v_add_u32 v123, v123, v123
    v_pk_fma_f32 v[124:125], v[124:125], v[122:123], s[34:35] op_sel_hi:[1,0,1]
    v_pk_fma_f32 v[126:127], v[126:127], v[122:123], s[34:35] op_sel_hi:[1,0,1]
    v_lshl_add_u32 v124, v125, 16, v124
    v_lshl_add_u32 v125, v127, 16, v126
    s_waitcnt lgkmcnt(2)
    v_bitop3_b32 v115, v115, v120, v121 bitop3:0xfe
    v_lshl_add_u64 v[124:125], v[124:125], 0, s[36:37]
    v_cmpx_le_u32 vcc, 0x1000000, v68
    ds_add_rtn_u64 v[120:121], v123, v[124:125] offset:54272
    s_mov_b64 exec, -1
    s_cmp_le_u32 s15, 7
    s_cbranch_scc1 p2_nad0
    s_waitcnt lgkmcnt(15)
    v_ashrrev_i32 v122, 5, v69
    v_lshlrev_b16 v123, 2, v69
    v_lshlrev_b32 v124, 16, v42
    v_bitop3_b32 v122, v122, v113, v113 bitop3:0x0c
    v_and_b32 v125, 0xffff0000, v42
    v_lshlrev_b32 v126, 16, v43
    v_mul_f32 v122, v114, v122
    v_and_b32 v127, 0xffff0000, v43
    v_add_u32 v123, v123, v123
    v_pk_fma_f32 v[124:125], v[124:125], v[122:123], s[34:35] op_sel_hi:[1,0,1]
    v_pk_fma_f32 v[126:127], v[126:127], v[122:123], s[34:35] op_sel_hi:[1,0,1]
    v_lshl_add_u32 v124, v125, 16, v124
    v_lshl_add_u32 v125, v127, 16, v126
    s_waitcnt lgkmcnt(2)
    v_bitop3_b32 v115, v115, v116, v117 bitop3:0xfe
    v_lshl_add_u64 v[124:125], v[124:125], 0, s[36:37]
    v_cmpx_le_u32 vcc, 0x1000000, v69
    ds_add_rtn_u64 v[116:117], v123, v[124:125] offset:54272
    s_mov_b64 exec, -1
    v_ashrrev_i32 v122, 5, v70
    v_lshlrev_b16 v123, 2, v70
    v_lshlrev_b32 v124, 16, v44
    v_bitop3_b32 v122, v122, v113, v113 bitop3:0x0c
    v_and_b32 v125, 0xffff0000, v44
    v_lshlrev_b32 v126, 16, v45
    v_mul_f32 v122, v114, v122
    v_and_b32 v127, 0xffff0000, v45
    v_add_u32 v123, v123, v123
    v_pk_fma_f32 v[124:125], v[124:125], v[122:123], s[34:35] op_sel_hi:[1,0,1]
    v_pk_fma_f32 v[126:127], v[126:127], v[122:123], s[34:35] op_sel_hi:[1,0,1]
    v_lshl_add_u32 v124, v125, 16, v124
    v_lshl_add_u32 v125, v127, 16, v126
    s_waitcnt lgkmcnt(2)
    v_bitop3_b32 v115, v115, v118, v119 bitop3:0xfe
    v_lshl_add_u64 v[124:125], v[124:125], 0, s[36:37]
    v_cmpx_le_u32 vcc, 0x1000000, v70
    ds_add_rtn_u64 v[118:119], v123, v[124:125] offset:54272
    s_mov_b64 exec, -1
    v_ashrrev_i32 v122, 5, v71
    v_lshlrev_b16 v123, 2, v71
    v_lshlrev_b32 v124, 16, v46
    v_bitop3_b32 v122, v122, v113, v113 bitop3:0x0c
    v_and_b32 v125, 0xffff0000, v46
    v_lshlrev_b32 v126, 16, v47
    v_mul_f32 v122, v114, v122
    v_and_b32 v127, 0xffff0000, v47
    v_add_u32 v123, v123, v123
    v_pk_fma_f32 v[124:125], v[124:125], v[122:123], s[34:35] op_sel_hi:[1,0,1]
    v_pk_fma_f32 v[126:127], v[126:127], v[122:123], s[34:35] op_sel_hi:[1,0,1]
    v_lshl_add_u32 v124, v125, 16, v124
    v_lshl_add_u32 v125, v127, 16, v126
    s_waitcnt lgkmcnt(2)
    v_bitop3_b32 v115, v115, v120, v121 bitop3:0xfe
    v_lshl_add_u64 v[124:125], v[124:125], 0, s[36:37]
    v_cmpx_le_u32 vcc, 0x1000000, v71
    ds_add_rtn_u64 v[120:121], v123, v[124:125] offset:54272
    s_mov_b64 exec, -1
p2_nad0:
    s_branch p2_fin
p2_topf:
    s_cmp_eq_u32 s60, 10
    s_cbranch_scc1 p2_drain1
    v_cmpx_gt_i16 vcc, 0, v48
    ds_read_b64 v[0:1], v0
    s_mov_b64 exec, -1
    v_cmpx_gt_i16 vcc, 0, v49
    ds_read_b64 v[2:3], v2
    s_mov_b64 exec, -1
    v_cmpx_gt_i16 vcc, 0, v50
    ds_read_b64 v[4:5], v4
    s_mov_b64 exec, -1
    v_cmpx_gt_i16 vcc, 0, v51
    ds_read_b64 v[6:7], v6
    s_mov_b64 exec, -1
    v_cmpx_gt_i16 vcc, 0, v52
    ds_read_b64 v[8:9], v8
    s_mov_b64 exec, -1
    v_cmpx_gt_i16 vcc, 0, v53
    ds_read_b64 v[10:11], v10
    s_mov_b64 exec, -1
    v_cmpx_gt_i16 vcc, 0, v54
    ds_read_b64 v[12:13], v12
    s_mov_b64 exec, -1
    v_cmpx_gt_i16 vcc, 0, v55
    ds_read_b64 v[14:15], v14
    s_mov_b64 exec, -1
    v_cmpx_gt_i16 vcc, 0, v56
    ds_read_b64 v[16:17], v16
    s_mov_b64 exec, -1
    v_cmpx_gt_i16 vcc, 0, v57
    ds_read_b64 v[18:19], v18
    s_mov_b64 exec, -1
    v_cmpx_gt_i16 vcc, 0, v58
    ds_read_b64 v[20:21], v20
    s_mov_b64 exec, -1
    v_cmpx_gt_i16 vcc, 0, v59
    ds_read_b64 v[22:23], v22
    s_mov_b64 exec, -1
    s_cmp_ge_u32 s10, 9
    s_cbranch_scc1 p2_nm1m0a
    v_lshrrev_b32 v84, 1, v112
    s_add_u32 s44, s20, s42
    buffer_load_dwordx2 v[84:85], v84, s[4:7], s44 offen
p2_nm1m0a:
    buffer_load_dwordx4 v[72:75], v112, s[4:7], s20 offen offset:0
    buffer_load_dwordx4 v[76:79], v112, s[4:7], s20 offen offset:1024
    buffer_load_dwordx4 v[80:83], v112, s[4:7], s20 offen offset:2048
    v_cmpx_gt_i16 vcc, 0, v60
    ds_read_b64 v[24:25], v24
    s_mov_b64 exec, -1
    v_cmpx_gt_i16 vcc, 0, v61
    ds_read_b64 v[26:27], v26
    s_mov_b64 exec, -1
    v_cmpx_gt_i16 vcc, 0, v62
    ds_read_b64 v[28:29], v28
    s_mov_b64 exec, -1
    v_cmpx_gt_i16 vcc, 0, v63
    ds_read_b64 v[30:31], v30
    s_mov_b64 exec, -1
    v_cmpx_gt_i16 vcc, 0, v64
    ds_read_b64 v[32:33], v32
    s_mov_b64 exec, -1
    v_cmpx_gt_i16 vcc, 0, v65
    ds_read_b64 v[34:35], v34
    s_mov_b64 exec, -1
    v_cmpx_gt_i16 vcc, 0, v66
    ds_read_b64 v[36:37], v36
    s_mov_b64 exec, -1
    v_cmpx_gt_i16 vcc, 0, v67
    ds_read_b64 v[38:39], v38
    s_mov_b64 exec, -1
    v_cmpx_gt_i16 vcc, 0, v68
    ds_read_b64 v[40:41], v40
    s_mov_b64 exec, -1
    s_cmp_le_u32 s15, 7
    s_cbranch_scc1 p2_g1r27
    v_cmpx_gt_i16 vcc, 0, v69
    ds_read_b64 v[42:43], v42
    s_mov_b64 exec, -1
    v_cmpx_gt_i16 vcc, 0, v70
    ds_read_b64 v[44:45], v44
    s_mov_b64 exec, -1
    v_cmpx_gt_i16 vcc, 0, v71
    ds_read_b64 v[46:47], v46
    s_mov_b64 exec, -1
p2_g1r27:
    s_waitcnt lgkmcnt(15)
    v_ashrrev_i32 v122, 5, v48
    v_lshlrev_b16 v123, 2, v48
    v_cndmask_b32 v126, v0, v1, s[66:67]
    v_bitop3_b32 v122, v122, v113, v113 bitop3:0x0c
    v_lshlrev_b32 v124, 16, v126
    v_mul_f32 v122, v114, v122
    v_and_b32 v125, 0xffff0000, v126
    v_add_u32 v123, v123, v123
    v_mul_f32 v124, v122, v124
    v_mul_f32 v125, v122, v125
    v_cmpx_le_u32 vcc, 0x1000000, v48
    ds_add_f32 v123, v124 offset:54272
    ds_add_f32 v123, v125 offset:54276
    s_mov_b64 exec, -1
    v_ashrrev_i32 v122, 5, v49
    v_lshlrev_b16 v123, 2, v49
    v_cndmask_b32 v126, v2, v3, s[66:67]
    v_bitop3_b32 v122, v122, v113, v113 bitop3:0x0c
    v_lshlrev_b32 v124, 16, v126
    v_mul_f32 v122, v114, v122
    v_and_b32 v125, 0xffff0000, v126
    v_add_u32 v123, v123, v123
    v_mul_f32 v124, v122, v124
    v_mul_f32 v125, v122, v125
    v_cmpx_le_u32 vcc, 0x1000000, v49
    ds_add_f32 v123, v124 offset:54272
    ds_add_f32 v123, v125 offset:54276
    s_mov_b64 exec, -1
    v_ashrrev_i32 v122, 5, v50
    v_lshlrev_b16 v123, 2, v50
    v_cndmask_b32 v126, v4, v5, s[66:67]
    v_bitop3_b32 v122, v122, v113, v113 bitop3:0x0c
    v_lshlrev_b32 v124, 16, v126
    v_mul_f32 v122, v114, v122
    v_and_b32 v125, 0xffff0000, v126
    v_add_u32 v123, v123, v123
    v_mul_f32 v124, v122, v124
    v_mul_f32 v125, v122, v125
    v_cmpx_le_u32 vcc, 0x1000000, v50
    ds_add_f32 v123, v124 offset:54272
    ds_add_f32 v123, v125 offset:54276
    s_mov_b64 exec, -1
    v_bfe_u32 v0, v102, 14, 4
    v_lshrrev_b32 v1, 18, v102
    v_and_b32 v102, 0x3fff, v102
    v_mad_u32_u24 v0, v0, s63, v1
    v_lshl_or_b32 v102, v0, 14, v102
    buffer_load_dwordx4 v[0:3], v102, s[68:71], 0 offen
    s_waitcnt lgkmcnt(15)
    v_ashrrev_i32 v122, 5, v51
    v_lshlrev_b16 v123, 2, v51
    v_cndmask_b32 v126, v6, v7, s[66:67]
    v_bitop3_b32 v122, v122, v113, v113 bitop3:0x0c
    v_lshlrev_b32 v124, 16, v126
    v_mul_f32 v122, v114, v122
    v_and_b32 v125, 0xffff0000, v126
    v_add_u32 v123, v123, v123
    v_mul_f32 v124, v122, v124
    v_mul_f32 v125, v122, v125
    v_cmpx_le_u32 vcc, 0x1000000, v51
    ds_add_f32 v123, v124 offset:54272
    ds_add_f32 v123, v125 offset:54276
    s_mov_b64 exec, -1
    v_ashrrev_i32 v122, 5, v52
    v_lshlrev_b16 v123, 2, v52
    v_cndmask_b32 v126, v8, v9, s[66:67]
    v_bitop3_b32 v122, v122, v113, v113 bitop3:0x0c
    v_lshlrev_b32 v124, 16, v126
    v_mul_f32 v122, v114, v122
    v_and_b32 v125, 0xffff0000, v126
    v_add_u32 v123, v123, v123
    v_mul_f32 v124, v122, v124
    v_mul_f32 v125, v122, v125
    v_cmpx_le_u32 vcc, 0x1000000, v52
    ds_add_f32 v123, v124 offset:54272
    ds_add_f32 v123, v125 offset:54276
    s_mov_b64 exec, -1
    v_ashrrev_i32 v122, 5, v53
    v_lshlrev_b16 v123, 2, v53
    v_cndmask_b32 v126, v10, v11, s[66:67]
    v_bitop3_b32 v122, v122, v113, v113 bitop3:0x0c
    v_lshlrev_b32 v124, 16, v126
    v_mul_f32 v122, v114, v122
    v_and_b32 v125, 0xffff0000, v126
    v_add_u32 v123, v123, v123
    v_mul_f32 v124, v122, v124
    v_mul_f32 v125, v122, v125
    v_cmpx_le_u32 vcc, 0x1000000, v53
    ds_add_f32 v123, v124 offset:54272
    ds_add_f32 v123, v125 offset:54276
    s_mov_b64 exec, -1
    v_bfe_u32 v6, v103, 14, 4
    v_lshrrev_b32 v7, 18, v103
    v_and_b32 v103, 0x3fff, v103
    v_mad_u32_u24 v6, v6, s63, v7
    v_lshl_or_b32 v103, v6, 14, v103
    buffer_load_dwordx4 v[6:9], v103, s[68:71], 0 offen
    s_waitcnt lgkmcnt(12)
    s_barrier
    s_waitcnt lgkmcnt(15)
    v_ashrrev_i32 v122, 5, v54
    v_lshlrev_b16 v123, 2, v54
    v_cndmask_b32 v126, v12, v13, s[66:67]
    v_bitop3_b32 v122, v122, v113, v113 bitop3:0x0c
    v_lshlrev_b32 v124, 16, v126
    v_mul_f32 v122, v114, v122
    v_and_b32 v125, 0xffff0000, v126
    v_add_u32 v123, v123, v123
    v_mul_f32 v124, v122, v124
    v_mul_f32 v125, v122, v125
    v_cmpx_le_u32 vcc, 0x1000000, v54
    ds_add_f32 v123, v124 offset:54272
    ds_add_f32 v123, v125 offset:54276
    s_mov_b64 exec, -1
    v_ashrrev_i32 v122, 5, v55
    v_lshlrev_b16 v123, 2, v55
    v_cndmask_b32 v126, v14, v15, s[66:67]
    v_bitop3_b32 v122, v122, v113, v113 bitop3:0x0c
    v_lshlrev_b32 v124, 16, v126
    v_mul_f32 v122, v114, v122
    v_and_b32 v125, 0xffff0000, v126
    v_add_u32 v123, v123, v123
    v_mul_f32 v124, v122, v124
    v_mul_f32 v125, v122, v125
    v_cmpx_le_u32 vcc, 0x1000000, v55
    ds_add_f32 v123, v124 offset:54272
    ds_add_f32 v123, v125 offset:54276
    s_mov_b64 exec, -1
    v_ashrrev_i32 v122, 5, v56
    v_lshlrev_b16 v123, 2, v56
    v_cndmask_b32 v126, v16, v17, s[66:67]
    v_bitop3_b32 v122, v122, v113, v113 bitop3:0x0c
    v_lshlrev_b32 v124, 16, v126
    v_mul_f32 v122, v114, v122
    v_and_b32 v125, 0xffff0000, v126
    v_add_u32 v123, v123, v123
    v_mul_f32 v124, v122, v124
    v_mul_f32 v125, v122, v125
    v_cmpx_le_u32 vcc, 0x1000000, v56
    ds_add_f32 v123, v124 offset:54272
    ds_add_f32 v123, v125 offset:54276
    s_mov_b64 exec, -1
    v_bfe_u32 v12, v104, 14, 4
    v_lshrrev_b32 v13, 18, v104
    v_and_b32 v104, 0x3fff, v104
    v_mad_u32_u24 v12, v12, s63, v13
    v_lshl_or_b32 v104, v12, 14, v104
    buffer_load_dwordx4 v[12:15], v104, s[68:71], 0 offen
    s_waitcnt lgkmcnt(15)
    v_ashrrev_i32 v122, 5, v57
    v_lshlrev_b16 v123, 2, v57
    v_cndmask_b32 v126, v18, v19, s[66:67]
    v_bitop3_b32 v122, v122, v113, v113 bitop3:0x0c
    v_lshlrev_b32 v124, 16, v126
    v_mul_f32 v122, v114, v122
    v_and_b32 v125, 0xffff0000, v126
    v_add_u32 v123, v123, v123
    v_mul_f32 v124, v122, v124
    v_mul_f32 v125, v122, v125
    v_cmpx_le_u32 vcc, 0x1000000, v57
    ds_add_f32 v123, v124 offset:54272
    ds_add_f32 v123, v125 offset:54276
    s_mov_b64 exec, -1
    v_ashrrev_i32 v122, 5, v58
    v_lshlrev_b16 v123, 2, v58
    v_cndmask_b32 v126, v20, v21, s[66:67]
    v_bitop3_b32 v122, v122, v113, v113 bitop3:0x0c
    v_lshlrev_b32 v124, 16, v126
    v_mul_f32 v122, v114, v122
    v_and_b32 v125, 0xffff0000, v126
    v_add_u32 v123, v123, v123
    v_mul_f32 v124, v122, v124
    v_mul_f32 v125, v122, v125
    v_cmpx_le_u32 vcc, 0x1000000, v58
    ds_add_f32 v123, v124 offset:54272
    ds_add_f32 v123, v125 offset:54276
    s_mov_b64 exec, -1
    v_ashrrev_i32 v122, 5, v59
    v_lshlrev_b16 v123, 2, v59
    v_cndmask_b32 v126, v22, v23, s[66:67]
    v_bitop3_b32 v122, v122, v113, v113 bitop3:0x0c
    v_lshlrev_b32 v124, 16, v126
    v_mul_f32 v122, v114, v122
    v_and_b32 v125, 0xffff0000, v126
    v_add_u32 v123, v123, v123
    v_mul_f32 v124, v122, v124
    v_mul_f32 v125, v122, v125
    v_cmpx_le_u32 vcc, 0x1000000, v59
    ds_add_f32 v123, v124 offset:54272
    ds_add_f32 v123, v125 offset:54276
    s_mov_b64 exec, -1
    v_bfe_u32 v18, v105, 14, 4
    v_lshrrev_b32 v19, 18, v105
    v_and_b32 v105, 0x3fff, v105
    v_mad_u32_u24 v18, v18, s63, v19
    v_lshl_or_b32 v105, v18, 14, v105
    buffer_load_dwordx4 v[18:21], v105, s[68:71], 0 offen
    s_mov_b32 m0, s23
    v_mov_b32 v53, 0x3c000
    s_movk_i32 s44, 512
    v_sub_u32_sdwa v4, v111, v110 dst_sel:DWORD dst_unused:UNUSED_PAD src0_sel:WORD_0 src1_sel:WORD_0
    v_sub_u32_sdwa v5, v111, v110 dst_sel:DWORD dst_unused:UNUSED_PAD src0_sel:WORD_1 src1_sel:WORD_1
    v_med3_i32 v4, v4, 0, s44
    v_med3_i32 v5, v5, 0, s44
    v_add_u32 v48, v4, v5
    ds_write_addtid_b32 v53 offset:0
    ds_write_addtid_b32 v53 offset:256
    ds_write_addtid_b32 v53 offset:512
    ds_write_addtid_b32 v53 offset:768
    ds_write_addtid_b32 v53 offset:1024
    ds_write_addtid_b32 v53 offset:1280
    ds_write_addtid_b32 v53 offset:1536
    ds_write_addtid_b32 v53 offset:1792
    v_bfe_i32 v53, v112, 6, 1
    v_lshrrev_b32 v49, 6, v112
    v_bitop3_b32 v53, v53, 15, s10 bitop3:0x6a
    v_lshl_or_b32 v49, v49, 4, v53
    v_and_b32 v53, 0x30, v112
    v_lshl_or_b32 v53, v49, 6, v53
    v_lshlrev_b32 v53, 15, v53
    s_nop 1
    v_add_u32_dpp v48, v48, v48 row_shr:1 row_mask:0xf bank_mask:0xf bound_ctrl:0
    s_nop 1
    v_add_u32_dpp v48, v48, v48 row_shr:2 row_mask:0xf bank_mask:0xf bound_ctrl:0
    s_nop 1
    v_add_u32_dpp v48, v48, v48 row_shr:4 row_mask:0xf bank_mask:0xf bound_ctrl:0
    s_nop 1
    v_add_u32_dpp v48, v48, v48 row_shr:8 row_mask:0xf bank_mask:0xf bound_ctrl:0
    s_nop 1
    v_add_u32_dpp v48, v48, v48 row_bcast:15 row_mask:0xa bank_mask:0xf
    s_nop 1
    v_add_u32_dpp v48, v48, v48 row_bcast:31 row_mask:0xc bank_mask:0xf
    s_nop 1
    s_nop 0
    v_readlane_b32 s38, v48, 63
    v_sub_u32 v50, v48, v5
    v_sub_u32 v49, v50, v4
    v_sub_u32 v10, 512, v49
    v_mad_u32_u16 v51, v110, 16, v53
    v_med3_i32 v10, v10, 0, v4
    v_lshl_add_u32 v49, v49, 2, s23
    v_sub_u32 v11, 512, v50
    v_mad_u32_u16 v52, v110, 16, v53 op_sel:[1,0,0,0]
    v_med3_i32 v11, v11, 0, v5
    v_lshl_add_u32 v50, v50, 2, s23
    v_lshl_add_u32 v48, v11, 16, v10
    v_add_u32 v52, 262144, v52
    v_add_u32 v110, v110, v48
    s_min_u32 s17, s38, 512
    s_add_u32 s17, s17, 63
    s_lshr_b32 s17, s17, 6
p2_x1x_0:
    v_cmpx_lt_i32 vcc, 0, v10
    s_cbranch_execz p2_y1x_0
    ds_write_b32 v49, v51 offset:0
    v_add_u32 v51, 16, v51
    v_cmpx_lt_i32 vcc, 1, v10
    s_cbranch_execz p2_y1x_0
    ds_write_b32 v49, v51 offset:4
    v_add_u32 v51, 16, v51
    v_cmpx_lt_i32 vcc, 2, v10
    s_cbranch_execz p2_y1x_0
    ds_write_b32 v49, v51 offset:8
    v_add_u32 v51, 16, v51
    v_cmpx_lt_i32 vcc, 3, v10
    s_cbranch_execz p2_y1x_0
    ds_write_b32 v49, v51 offset:12
    v_add_u32 v51, 16, v51
    v_cmpx_lt_i32 vcc, 4, v10
    s_cbranch_execz p2_y1x_0
    ds_write_b32 v49, v51 offset:16
    v_add_u32 v51, 16, v51
    v_cmpx_lt_i32 vcc, 5, v10
    s_cbranch_execz p2_y1x_0
    ds_write_b32 v49, v51 offset:20
    v_add_u32 v51, 16, v51
    v_cmpx_lt_i32 vcc, 6, v10
    s_cbranch_execz p2_y1x_0
    ds_write_b32 v49, v51 offset:24
    v_add_u32 v51, 16, v51
    v_cmpx_lt_i32 vcc, 7, v10
    s_cbranch_execz p2_y1x_0
    ds_write_b32 v49, v51 offset:28
    v_add_u32 v51, 16, v51
    v_subrev_u32 v10, 8, v10
    v_add_u32 v49, 32, v49
    s_branch p2_x1x_0
p2_y1x_0:
    s_mov_b64 exec, -1
p2_x1x_1:
    v_cmpx_lt_i32 vcc, 0, v11
    s_cbranch_execz p2_y1x_1
    ds_write_b32 v50, v52 offset:0
    v_add_u32 v52, 16, v52
    v_cmpx_lt_i32 vcc, 1, v11
    s_cbranch_execz p2_y1x_1
    ds_write_b32 v50, v52 offset:4
    v_add_u32 v52, 16, v52
    v_cmpx_lt_i32 vcc, 2, v11
    s_cbranch_execz p2_y1x_1
    ds_write_b32 v50, v52 offset:8
    v_add_u32 v52, 16, v52
    v_cmpx_lt_i32 vcc, 3, v11
    s_cbranch_execz p2_y1x_1
    ds_write_b32 v50, v52 offset:12
    v_add_u32 v52, 16, v52
    v_cmpx_lt_i32 vcc, 4, v11
    s_cbranch_execz p2_y1x_1
    ds_write_b32 v50, v52 offset:16
    v_add_u32 v52, 16, v52
    v_cmpx_lt_i32 vcc, 5, v11
    s_cbranch_execz p2_y1x_1
    ds_write_b32 v50, v52 offset:20
    v_add_u32 v52, 16, v52
    v_cmpx_lt_i32 vcc, 6, v11
    s_cbranch_execz p2_y1x_1
    ds_write_b32 v50, v52 offset:24
    v_add_u32 v52, 16, v52
    v_cmpx_lt_i32 vcc, 7, v11
    s_cbranch_execz p2_y1x_1
    ds_write_b32 v50, v52 offset:28
    v_add_u32 v52, 16, v52
    v_subrev_u32 v11, 8, v11
    v_add_u32 v50, 32, v50
    s_branch p2_x1x_1
p2_y1x_1:
    s_mov_b64 exec, -1
    s_cmp_lt_u32 s38, 512
    s_cbranch_scc1 p2_nomore1x
    v_cmp_lt_u32_sdwa s[44:45], v110, v111 src0_sel:WORD_0 src1_sel:WORD_0
    v_cmp_lt_u32_sdwa s[46:47], v110, v111 src0_sel:WORD_1 src1_sel:WORD_1
    s_nop 0
    s_or_b64 s[44:45], s[44:45], s[46:47]
    s_cbranch_scc0 p2_nomore1x
    v_mov_b32 v49, s19
    v_mov_b32 v50, 1
    ds_write_b32 v49, v50 offset:53760
p2_nomore1x:
    s_mov_b32 m0, s23
    s_nop 0
    ds_read_addtid_b32 v102 offset:0
    ds_read_addtid_b32 v103 offset:256
    ds_read_addtid_b32 v104 offset:512
    ds_read_addtid_b32 v105 offset:768
    ds_read_addtid_b32 v106 offset:1024
    ds_read_addtid_b32 v107 offset:1280
    ds_read_addtid_b32 v108 offset:1536
    ds_read_addtid_b32 v109 offset:1792
    s_waitcnt vmcnt(4)
    s_mov_b32 m0, s24
    s_cmp_ge_u32 s10, 9
    s_cbranch_scc1 p2_st1s0
    ds_write_addtid_b32 v84 offset:49152
    ds_write_addtid_b32 v85 offset:49408
p2_st1s0:
    s_mov_b32 m0, s23
    s_add_u32 s20, s20, 53760
    ds_write_addtid_b32 v72 offset:0
    ds_write_addtid_b32 v73 offset:256
    ds_write_addtid_b32 v74 offset:512
    ds_write_addtid_b32 v75 offset:768
    ds_write_addtid_b32 v76 offset:1024
    ds_write_addtid_b32 v77 offset:1280
    ds_write_addtid_b32 v78 offset:1536
    ds_write_addtid_b32 v79 offset:1792
    ds_write_addtid_b32 v80 offset:2048
    ds_write_addtid_b32 v81 offset:2304
    ds_write_addtid_b32 v82 offset:2560
    ds_write_addtid_b32 v83 offset:2816
    s_waitcnt lgkmcnt(15)
    v_ashrrev_i32 v122, 5, v60
    v_lshlrev_b16 v123, 2, v60
    v_cndmask_b32 v126, v24, v25, s[66:67]
    v_bitop3_b32 v122, v122, v113, v113 bitop3:0x0c
    v_lshlrev_b32 v124, 16, v126
    v_mul_f32 v122, v114, v122
    v_and_b32 v125, 0xffff0000, v126
    v_add_u32 v123, v123, v123
    v_mul_f32 v124, v122, v124
    v_mul_f32 v125, v122, v125
    v_cmpx_le_u32 vcc, 0x1000000, v60
    ds_add_f32 v123, v124 offset:54272
    ds_add_f32 v123, v125 offset:54276
    s_mov_b64 exec, -1
    v_ashrrev_i32 v122, 5, v61
    v_lshlrev_b16 v123, 2, v61
    v_cndmask_b32 v126, v26, v27, s[66:67]
    v_bitop3_b32 v122, v122, v113, v113 bitop3:0x0c
    v_lshlrev_b32 v124, 16, v126
    v_mul_f32 v122, v114, v122
    v_and_b32 v125, 0xffff0000, v126
    v_add_u32 v123, v123, v123
    v_mul_f32 v124, v122, v124
    v_mul_f32 v125, v122, v125
    v_cmpx_le_u32 vcc, 0x1000000, v61
    ds_add_f32 v123, v124 offset:54272
    ds_add_f32 v123, v125 offset:54276
    s_mov_b64 exec, -1
    v_ashrrev_i32 v122, 5, v62
    v_lshlrev_b16 v123, 2, v62
    v_cndmask_b32 v126, v28, v29, s[66:67]
    v_bitop3_b32 v122, v122, v113, v113 bitop3:0x0c
    v_lshlrev_b32 v124, 16, v126
    v_mul_f32 v122, v114, v122
    v_and_b32 v125, 0xffff0000, v126
    v_add_u32 v123, v123, v123
    v_mul_f32 v124, v122, v124
    v_mul_f32 v125, v122, v125
    v_cmpx_le_u32 vcc, 0x1000000, v62
    ds_add_f32 v123, v124 offset:54272
    ds_add_f32 v123, v125 offset:54276
    s_mov_b64 exec, -1
    s_waitcnt vmcnt(13)
    v_perm_b32 v60, v89, v86, s31
    v_perm_b32 v61, v89, v87, s32
    v_perm_b32 v62, v89, v88, s33
    v_lshlrev_b16 v28, 3, v88
    v_lshlrev_b16 v26, 3, v87
    v_lshlrev_b16 v24, 3, v86
    s_waitcnt lgkmcnt(6)
    s_barrier
    s_cmp_ge_u32 s10, 9
    s_cbranch_scc1 p2_nm1m1a
    v_lshrrev_b32 v84, 1, v112
    s_add_u32 s44, s20, s42
    buffer_load_dwordx2 v[84:85], v84, s[4:7], s44 offen
p2_nm1m1a:
    buffer_load_dwordx4 v[72:75], v112, s[4:7], s20 offen offset:0
    buffer_load_dwordx4 v[76:79], v112, s[4:7], s20 offen offset:1024
    buffer_load_dwordx4 v[80:83], v112, s[4:7], s20 offen offset:2048
    v_cmpx_ge_u16 vcc, 0x3fff, v60
    ds_read_b64 v[24:25], v24
    s_mov_b64 exec, -1
    v_cmpx_ge_u16 vcc, 0x3fff, v61
    ds_read_b64 v[26:27], v26
    s_mov_b64 exec, -1
    v_cmpx_ge_u16 vcc, 0x3fff, v62
    ds_read_b64 v[28:29], v28
    s_mov_b64 exec, -1
    s_waitcnt lgkmcnt(15)
    v_ashrrev_i32 v122, 5, v63
    v_lshlrev_b16 v123, 2, v63
    v_cndmask_b32 v126, v30, v31, s[66:67]
    v_bitop3_b32 v122, v122, v113, v113 bitop3:0x0c
    v_lshlrev_b32 v124, 16, v126
    v_mul_f32 v122, v114, v122
    v_and_b32 v125, 0xffff0000, v126
    v_add_u32 v123, v123, v123
    v_mul_f32 v124, v122, v124
    v_mul_f32 v125, v122, v125
    v_cmpx_le_u32 vcc, 0x1000000, v63
    ds_add_f32 v123, v124 offset:54272
    ds_add_f32 v123, v125 offset:54276
    s_mov_b64 exec, -1
    v_ashrrev_i32 v122, 5, v64
    v_lshlrev_b16 v123, 2, v64
    v_cndmask_b32 v126, v32, v33, s[66:67]
    v_bitop3_b32 v122, v122, v113, v113 bitop3:0x0c
    v_lshlrev_b32 v124, 16, v126
    v_mul_f32 v122, v114, v122
    v_and_b32 v125, 0xffff0000, v126
    v_add_u32 v123, v123, v123
    v_mul_f32 v124, v122, v124
    v_mul_f32 v125, v122, v125
    v_cmpx_le_u32 vcc, 0x1000000, v64
    ds_add_f32 v123, v124 offset:54272
    ds_add_f32 v123, v125 offset:54276
    s_mov_b64 exec, -1
    v_ashrrev_i32 v122, 5, v65
    v_lshlrev_b16 v123, 2, v65
    v_cndmask_b32 v126, v34, v35, s[66:67]
    v_bitop3_b32 v122, v122, v113, v113 bitop3:0x0c
    v_lshlrev_b32 v124, 16, v126
    v_mul_f32 v122, v114, v122
    v_and_b32 v125, 0xffff0000, v126
    v_add_u32 v123, v123, v123
    v_mul_f32 v124, v122, v124
    v_mul_f32 v125, v122, v125
    v_cmpx_le_u32 vcc, 0x1000000, v65
    ds_add_f32 v123, v124 offset:54272
    ds_add_f32 v123, v125 offset:54276
    s_mov_b64 exec, -1
    s_waitcnt vmcnt(15)
    v_perm_b32 v63, v93, v90, s31
    v_perm_b32 v64, v93, v91, s32
    v_perm_b32 v65, v93, v92, s33
    v_lshlrev_b16 v34, 3, v92
    v_lshlrev_b16 v32, 3, v91
    v_lshlrev_b16 v30, 3, v90
    v_cmpx_ge_u16 vcc, 0x3fff, v63
    ds_read_b64 v[30:31], v30
    s_mov_b64 exec, -1
    v_cmpx_ge_u16 vcc, 0x3fff, v64
    ds_read_b64 v[32:33], v32
    s_mov_b64 exec, -1
    v_cmpx_ge_u16 vcc, 0x3fff, v65
    ds_read_b64 v[34:35], v34
    s_mov_b64 exec, -1
    s_waitcnt lgkmcnt(15)
    v_bfe_u32 v86, v106, 14, 4
    v_lshrrev_b32 v87, 18, v106
    v_and_b32 v106, 0x3fff, v106
    v_mad_u32_u24 v86, v86, s63, v87
    v_lshl_or_b32 v106, v86, 14, v106
    buffer_load_dwordx4 v[86:89], v106, s[68:71], 0 offen
    s_waitcnt lgkmcnt(15)
    v_ashrrev_i32 v122, 5, v66
    v_lshlrev_b16 v123, 2, v66
    v_cndmask_b32 v126, v36, v37, s[66:67]
    v_bitop3_b32 v122, v122, v113, v113 bitop3:0x0c
    v_lshlrev_b32 v124, 16, v126
    v_mul_f32 v122, v114, v122
    v_and_b32 v125, 0xffff0000, v126
    v_add_u32 v123, v123, v123
    v_mul_f32 v124, v122, v124
    v_mul_f32 v125, v122, v125
    v_cmpx_le_u32 vcc, 0x1000000, v66
    ds_add_f32 v123, v124 offset:54272
    ds_add_f32 v123, v125 offset:54276
    s_mov_b64 exec, -1
    v_ashrrev_i32 v122, 5, v67
    v_lshlrev_b16 v123, 2, v67
    v_cndmask_b32 v126, v38, v39, s[66:67]
    v_bitop3_b32 v122, v122, v113, v113 bitop3:0x0c
    v_lshlrev_b32 v124, 16, v126
    v_mul_f32 v122, v114, v122
    v_and_b32 v125, 0xffff0000, v126
    v_add_u32 v123, v123, v123
    v_mul_f32 v124, v122, v124
    v_mul_f32 v125, v122, v125
    v_cmpx_le_u32 vcc, 0x1000000, v67
    ds_add_f32 v123, v124 offset:54272
    ds_add_f32 v123, v125 offset:54276
    s_mov_b64 exec, -1
    v_ashrrev_i32 v122, 5, v68
    v_lshlrev_b16 v123, 2, v68
    v_cndmask_b32 v126, v40, v41, s[66:67]
    v_bitop3_b32 v122, v122, v113, v113 bitop3:0x0c
    v_lshlrev_b32 v124, 16, v126
    v_mul_f32 v122, v114, v122
    v_and_b32 v125, 0xffff0000, v126
    v_add_u32 v123, v123, v123
    v_mul_f32 v124, v122, v124
    v_mul_f32 v125, v122, v125
    v_cmpx_le_u32 vcc, 0x1000000, v68
    ds_add_f32 v123, v124 offset:54272
    ds_add_f32 v123, v125 offset:54276
    s_mov_b64 exec, -1
    s_waitcnt vmcnt(12)
    v_perm_b32 v66, v97, v94, s31
    v_perm_b32 v67, v97, v95, s32
    v_perm_b32 v68, v97, v96, s33
    v_lshlrev_b16 v40, 3, v96
    v_lshlrev_b16 v38, 3, v95
    v_lshlrev_b16 v36, 3, v94
    v_cmpx_ge_u16 vcc, 0x3fff, v66
    ds_read_b64 v[36:37], v36
    s_mov_b64 exec, -1
    v_cmpx_ge_u16 vcc, 0x3fff, v67
    ds_read_b64 v[38:39], v38
    s_mov_b64 exec, -1
    v_cmpx_ge_u16 vcc, 0x3fff, v68
    ds_read_b64 v[40:41], v40
    s_mov_b64 exec, -1
    s_cmp_le_u32 s15, 7
    s_cbranch_scc1 p2_na1a7
    s_waitcnt lgkmcnt(15)
    v_ashrrev_i32 v122, 5, v69
    v_lshlrev_b16 v123, 2, v69
    v_cndmask_b32 v126, v42, v43, s[66:67]
    v_bitop3_b32 v122, v122, v113, v113 bitop3:0x0c
    v_lshlrev_b32 v124, 16, v126
    v_mul_f32 v122, v114, v122
    v_and_b32 v125, 0xffff0000, v126
    v_add_u32 v123, v123, v123
    v_mul_f32 v124, v122, v124
    v_mul_f32 v125, v122, v125
    v_cmpx_le_u32 vcc, 0x1000000, v69
    ds_add_f32 v123, v124 offset:54272
    ds_add_f32 v123, v125 offset:54276
    s_mov_b64 exec, -1
    v_ashrrev_i32 v122, 5, v70
    v_lshlrev_b16 v123, 2, v70
    v_cndmask_b32 v126, v44, v45, s[66:67]
    v_bitop3_b32 v122, v122, v113, v113 bitop3:0x0c
    v_lshlrev_b32 v124, 16, v126
    v_mul_f32 v122, v114, v122
    v_and_b32 v125, 0xffff0000, v126
    v_add_u32 v123, v123, v123
    v_mul_f32 v124, v122, v124
    v_mul_f32 v125, v122, v125
    v_cmpx_le_u32 vcc, 0x1000000, v70
    ds_add_f32 v123, v124 offset:54272
    ds_add_f32 v123, v125 offset:54276
    s_mov_b64 exec, -1
    v_ashrrev_i32 v122, 5, v71
    v_lshlrev_b16 v123, 2, v71
    v_cndmask_b32 v126, v46, v47, s[66:67]
    v_bitop3_b32 v122, v122, v113, v113 bitop3:0x0c
    v_lshlrev_b32 v124, 16, v126
    v_mul_f32 v122, v114, v122
    v_and_b32 v125, 0xffff0000, v126
    v_add_u32 v123, v123, v123
    v_mul_f32 v124, v122, v124
    v_mul_f32 v125, v122, v125
    v_cmpx_le_u32 vcc, 0x1000000, v71
    ds_add_f32 v123, v124 offset:54272
    ds_add_f32 v123, v125 offset:54276
    s_mov_b64 exec, -1
p2_na1a7:
    s_waitcnt vmcnt(11)
    v_perm_b32 v69, v101, v98, s31
    v_perm_b32 v70, v101, v99, s32
    v_perm_b32 v71, v101, v100, s33
    v_lshlrev_b16 v46, 3, v100
    v_lshlrev_b16 v44, 3, v99
    v_lshlrev_b16 v42, 3, v98
    s_cmp_le_u32 s16, 7
    s_cbranch_scc1 p2_g1r07
    v_cmpx_ge_u16 vcc, 0x3fff, v69
    ds_read_b64 v[42:43], v42
    s_mov_b64 exec, -1
    v_cmpx_ge_u16 vcc, 0x3fff, v70
    ds_read_b64 v[44:45], v44
    s_mov_b64 exec, -1
    v_cmpx_ge_u16 vcc, 0x3fff, v71
    ds_read_b64 v[46:47], v46
    s_mov_b64 exec, -1
p2_g1r07:
    s_waitcnt lgkmcnt(15)
    v_bfe_u32 v90, v107, 14, 4
    v_lshrrev_b32 v91, 18, v107
    v_and_b32 v107, 0x3fff, v107
    v_mad_u32_u24 v90, v90, s63, v91
    v_lshl_or_b32 v107, v90, 14, v107
    buffer_load_dwordx4 v[90:93], v107, s[68:71], 0 offen
    s_waitcnt vmcnt(8)
    v_perm_b32 v48, v3, v0, s31
    v_perm_b32 v49, v3, v1, s32
    v_perm_b32 v50, v3, v2, s33
    v_lshlrev_b16 v4, 3, v2
    v_lshlrev_b16 v2, 3, v1
    v_lshlrev_b16 v0, 3, v0
    v_cmpx_ge_u16 vcc, 0x3fff, v48
    ds_read_b64 v[0:1], v0
    s_mov_b64 exec, -1
    v_cmpx_ge_u16 vcc, 0x3fff, v49
    ds_read_b64 v[2:3], v2
    s_mov_b64 exec, -1
    v_cmpx_ge_u16 vcc, 0x3fff, v50
    ds_read_b64 v[4:5], v4
    s_mov_b64 exec, -1
    s_waitcnt vmcnt(7)
    v_perm_b32 v51, v9, v6, s31
    v_perm_b32 v52, v9, v7, s32
    v_perm_b32 v53, v9, v8, s33
    v_lshlrev_b16 v10, 3, v8
    v_lshlrev_b16 v8, 3, v7
    v_lshlrev_b16 v6, 3, v6
    v_cmpx_ge_u16 vcc, 0x3fff, v51
    ds_read_b64 v[6:7], v6
    s_mov_b64 exec, -1
    v_cmpx_ge_u16 vcc, 0x3fff, v52
    ds_read_b64 v[8:9], v8
    s_mov_b64 exec, -1
    v_cmpx_ge_u16 vcc, 0x3fff, v53
    ds_read_b64 v[10:11], v10
    s_mov_b64 exec, -1
    s_waitcnt vmcnt(6)
    v_perm_b32 v54, v15, v12, s31
    v_perm_b32 v55, v15, v13, s32
    v_perm_b32 v56, v15, v14, s33
    v_lshlrev_b16 v16, 3, v14
    v_lshlrev_b16 v14, 3, v13
    v_lshlrev_b16 v12, 3, v12
    v_cmpx_ge_u16 vcc, 0x3fff, v54
    ds_read_b64 v[12:13], v12
    s_mov_b64 exec, -1
    v_cmpx_ge_u16 vcc, 0x3fff, v55
    ds_read_b64 v[14:15], v14
    s_mov_b64 exec, -1
    v_cmpx_ge_u16 vcc, 0x3fff, v56
    ds_read_b64 v[16:17], v16
    s_mov_b64 exec, -1
    s_waitcnt vmcnt(5)
    v_perm_b32 v57, v21, v18, s31
    v_perm_b32 v58, v21, v19, s32
    v_perm_b32 v59, v21, v20, s33
    v_lshlrev_b16 v22, 3, v20
    v_lshlrev_b16 v20, 3, v19
    v_lshlrev_b16 v18, 3, v18
    v_cmpx_ge_u16 vcc, 0x3fff, v57
    ds_read_b64 v[18:19], v18
    s_mov_b64 exec, -1
    v_cmpx_ge_u16 vcc, 0x3fff, v58
    ds_read_b64 v[20:21], v20
    s_mov_b64 exec, -1
    v_cmpx_ge_u16 vcc, 0x3fff, v59
    ds_read_b64 v[22:23], v22
    s_mov_b64 exec, -1
    s_waitcnt lgkmcnt(0)
    s_barrier
    s_waitcnt lgkmcnt(15)
    s_branch p2_tail
p2_drain1:
    v_cmpx_gt_i16 vcc, 0, v48
    ds_read_b64 v[0:1], v0
    s_mov_b64 exec, -1
    v_cmpx_gt_i16 vcc, 0, v49
    ds_read_b64 v[2:3], v2
    s_mov_b64 exec, -1
    v_cmpx_gt_i16 vcc, 0, v50
    ds_read_b64 v[4:5], v4
    s_mov_b64 exec, -1
    v_cmpx_gt_i16 vcc, 0, v51
    ds_read_b64 v[6:7], v6
    s_mov_b64 exec, -1
    v_cmpx_gt_i16 vcc, 0, v52
    ds_read_b64 v[8:9], v8
    s_mov_b64 exec, -1
    v_cmpx_gt_i16 vcc, 0, v53
    ds_read_b64 v[10:11], v10
    s_mov_b64 exec, -1
    v_cmpx_gt_i16 vcc, 0, v54
    ds_read_b64 v[12:13], v12
    s_mov_b64 exec, -1
    v_cmpx_gt_i16 vcc, 0, v55
    ds_read_b64 v[14:15], v14
    s_mov_b64 exec, -1
    v_cmpx_gt_i16 vcc, 0, v56
    ds_read_b64 v[16:17], v16
    s_mov_b64 exec, -1
    v_cmpx_gt_i16 vcc, 0, v57
    ds_read_b64 v[18:19], v18
    s_mov_b64 exec, -1
    v_cmpx_gt_i16 vcc, 0, v58
    ds_read_b64 v[20:21], v20
    s_mov_b64 exec, -1
    v_cmpx_gt_i16 vcc, 0, v59
    ds_read_b64 v[22:23], v22
    s_mov_b64 exec, -1
    v_cmpx_gt_i16 vcc, 0, v60
    ds_read_b64 v[24:25], v24
    s_mov_b64 exec, -1
    v_cmpx_gt_i16 vcc, 0, v61
    ds_read_b64 v[26:27], v26
    s_mov_b64 exec, -1
    v_cmpx_gt_i16 vcc, 0, v62
    ds_read_b64 v[28:29], v28
    s_mov_b64 exec, -1
    v_cmpx_gt_i16 vcc, 0, v63
    ds_read_b64 v[30:31], v30
    s_mov_b64 exec, -1
    v_cmpx_gt_i16 vcc, 0, v64
    ds_read_b64 v[32:33], v32
    s_mov_b64 exec, -1
    v_cmpx_gt_i16 vcc, 0, v65
    ds_read_b64 v[34:35], v34
    s_mov_b64 exec, -1
    v_cmpx_gt_i16 vcc, 0, v66
    ds_read_b64 v[36:37], v36
    s_mov_b64 exec, -1
    v_cmpx_gt_i16 vcc, 0, v67
    ds_read_b64 v[38:39], v38
    s_mov_b64 exec, -1
    v_cmpx_gt_i16 vcc, 0, v68
    ds_read_b64 v[40:41], v40
    s_mov_b64 exec, -1
    s_cmp_le_u32 s15, 7
    s_cbranch_scc1 p2_gd1
    v_cmpx_gt_i16 vcc, 0, v69
    ds_read_b64 v[42:43], v42
    s_mov_b64 exec, -1
    v_cmpx_gt_i16 vcc, 0, v70
    ds_read_b64 v[44:45], v44
    s_mov_b64 exec, -1
    v_cmpx_gt_i16 vcc, 0, v71
    ds_read_b64 v[46:47], v46
    s_mov_b64 exec, -1
p2_gd1:
    s_waitcnt lgkmcnt(15)
    v_ashrrev_i32 v122, 5, v48
    v_lshlrev_b16 v123, 2, v48
    v_cndmask_b32 v126, v0, v1, s[66:67]
    v_bitop3_b32 v122, v122, v113, v113 bitop3:0x0c
    v_lshlrev_b32 v124, 16, v126
    v_mul_f32 v122, v114, v122
    v_and_b32 v125, 0xffff0000, v126
    v_add_u32 v123, v123, v123
    v_mul_f32 v124, v122, v124
    v_mul_f32 v125, v122, v125
    v_cmpx_le_u32 vcc, 0x1000000, v48
    ds_add_f32 v123, v124 offset:54272
    ds_add_f32 v123, v125 offset:54276
    s_mov_b64 exec, -1
    v_ashrrev_i32 v122, 5, v49
    v_lshlrev_b16 v123, 2, v49
    v_cndmask_b32 v126, v2, v3, s[66:67]
    v_bitop3_b32 v122, v122, v113, v113 bitop3:0x0c
    v_lshlrev_b32 v124, 16, v126
    v_mul_f32 v122, v114, v122
    v_and_b32 v125, 0xffff0000, v126
    v_add_u32 v123, v123, v123
    v_mul_f32 v124, v122, v124
    v_mul_f32 v125, v122, v125
    v_cmpx_le_u32 vcc, 0x1000000, v49
    ds_add_f32 v123, v124 offset:54272
    ds_add_f32 v123, v125 offset:54276
    s_mov_b64 exec, -1
    v_ashrrev_i32 v122, 5, v50
    v_lshlrev_b16 v123, 2, v50
    v_cndmask_b32 v126, v4, v5, s[66:67]
    v_bitop3_b32 v122, v122, v113, v113 bitop3:0x0c
    v_lshlrev_b32 v124, 16, v126
    v_mul_f32 v122, v114, v122
    v_and_b32 v125, 0xffff0000, v126
    v_add_u32 v123, v123, v123
    v_mul_f32 v124, v122, v124
    v_mul_f32 v125, v122, v125
    v_cmpx_le_u32 vcc, 0x1000000, v50
    ds_add_f32 v123, v124 offset:54272
    ds_add_f32 v123, v125 offset:54276
    s_mov_b64 exec, -1
    s_waitcnt lgkmcnt(15)
    v_ashrrev_i32 v122, 5, v51
    v_lshlrev_b16 v123, 2, v51
    v_cndmask_b32 v126, v6, v7, s[66:67]
    v_bitop3_b32 v122, v122, v113, v113 bitop3:0x0c
    v_lshlrev_b32 v124, 16, v126
    v_mul_f32 v122, v114, v122
    v_and_b32 v125, 0xffff0000, v126
    v_add_u32 v123, v123, v123
    v_mul_f32 v124, v122, v124
    v_mul_f32 v125, v122, v125
    v_cmpx_le_u32 vcc, 0x1000000, v51
    ds_add_f32 v123, v124 offset:54272
    ds_add_f32 v123, v125 offset:54276
    s_mov_b64 exec, -1
    v_ashrrev_i32 v122, 5, v52
    v_lshlrev_b16 v123, 2, v52
    v_cndmask_b32 v126, v8, v9, s[66:67]
    v_bitop3_b32 v122, v122, v113, v113 bitop3:0x0c
    v_lshlrev_b32 v124, 16, v126
    v_mul_f32 v122, v114, v122
    v_and_b32 v125, 0xffff0000, v126
    v_add_u32 v123, v123, v123
    v_mul_f32 v124, v122, v124
    v_mul_f32 v125, v122, v125
    v_cmpx_le_u32 vcc, 0x1000000, v52
    ds_add_f32 v123, v124 offset:54272
    ds_add_f32 v123, v125 offset:54276
    s_mov_b64 exec, -1
    v_ashrrev_i32 v122, 5, v53
    v_lshlrev_b16 v123, 2, v53
    v_cndmask_b32 v126, v10, v11, s[66:67]
    v_bitop3_b32 v122, v122, v113, v113 bitop3:0x0c
    v_lshlrev_b32 v124, 16, v126
    v_mul_f32 v122, v114, v122
    v_and_b32 v125, 0xffff0000, v126
    v_add_u32 v123, v123, v123
    v_mul_f32 v124, v122, v124
    v_mul_f32 v125, v122, v125
    v_cmpx_le_u32 vcc, 0x1000000, v53
    ds_add_f32 v123, v124 offset:54272
    ds_add_f32 v123, v125 offset:54276
    s_mov_b64 exec, -1
    s_waitcnt lgkmcnt(15)
    v_ashrrev_i32 v122, 5, v54
    v_lshlrev_b16 v123, 2, v54
    v_cndmask_b32 v126, v12, v13, s[66:67]
    v_bitop3_b32 v122, v122, v113, v113 bitop3:0x0c
    v_lshlrev_b32 v124, 16, v126
    v_mul_f32 v122, v114, v122
    v_and_b32 v125, 0xffff0000, v126
    v_add_u32 v123, v123, v123
    v_mul_f32 v124, v122, v124
    v_mul_f32 v125, v122, v125
    v_cmpx_le_u32 vcc, 0x1000000, v54
    ds_add_f32 v123, v124 offset:54272
    ds_add_f32 v123, v125 offset:54276
    s_mov_b64 exec, -1
    v_ashrrev_i32 v122, 5, v55
    v_lshlrev_b16 v123, 2, v55
    v_cndmask_b32 v126, v14, v15, s[66:67]
    v_bitop3_b32 v122, v122, v113, v113 bitop3:0x0c
    v_lshlrev_b32 v124, 16, v126
    v_mul_f32 v122, v114, v122
    v_and_b32 v125, 0xffff0000, v126
    v_add_u32 v123, v123, v123
    v_mul_f32 v124, v122, v124
    v_mul_f32 v125, v122, v125
    v_cmpx_le_u32 vcc, 0x1000000, v55
    ds_add_f32 v123, v124 offset:54272
    ds_add_f32 v123, v125 offset:54276
    s_mov_b64 exec, -1
    v_ashrrev_i32 v122, 5, v56
    v_lshlrev_b16 v123, 2, v56
    v_cndmask_b32 v126, v16, v17, s[66:67]
    v_bitop3_b32 v122, v122, v113, v113 bitop3:0x0c
    v_lshlrev_b32 v124, 16, v126
    v_mul_f32 v122, v114, v122
    v_and_b32 v125, 0xffff0000, v126
    v_add_u32 v123, v123, v123
    v_mul_f32 v124, v122, v124
    v_mul_f32 v125, v122, v125
    v_cmpx_le_u32 vcc, 0x1000000, v56
    ds_add_f32 v123, v124 offset:54272
    ds_add_f32 v123, v125 offset:54276
    s_mov_b64 exec, -1
    s_waitcnt lgkmcnt(15)
    v_ashrrev_i32 v122, 5, v57
    v_lshlrev_b16 v123, 2, v57
    v_cndmask_b32 v126, v18, v19, s[66:67]
    v_bitop3_b32 v122, v122, v113, v113 bitop3:0x0c
    v_lshlrev_b32 v124, 16, v126
    v_mul_f32 v122, v114, v122
    v_and_b32 v125, 0xffff0000, v126
    v_add_u32 v123, v123, v123
    v_mul_f32 v124, v122, v124
    v_mul_f32 v125, v122, v125
    v_cmpx_le_u32 vcc, 0x1000000, v57
    ds_add_f32 v123, v124 offset:54272
    ds_add_f32 v123, v125 offset:54276
    s_mov_b64 exec, -1
    v_ashrrev_i32 v122, 5, v58
    v_lshlrev_b16 v123, 2, v58
    v_cndmask_b32 v126, v20, v21, s[66:67]
    v_bitop3_b32 v122, v122, v113, v113 bitop3:0x0c
    v_lshlrev_b32 v124, 16, v126
    v_mul_f32 v122, v114, v122
    v_and_b32 v125, 0xffff0000, v126
    v_add_u32 v123, v123, v123
    v_mul_f32 v124, v122, v124
    v_mul_f32 v125, v122, v125
    v_cmpx_le_u32 vcc, 0x1000000, v58
    ds_add_f32 v123, v124 offset:54272
    ds_add_f32 v123, v125 offset:54276
    s_mov_b64 exec, -1
    v_ashrrev_i32 v122, 5, v59
    v_lshlrev_b16 v123, 2, v59
    v_cndmask_b32 v126, v22, v23, s[66:67]
    v_bitop3_b32 v122, v122, v113, v113 bitop3:0x0c
    v_lshlrev_b32 v124, 16, v126
    v_mul_f32 v122, v114, v122
    v_and_b32 v125, 0xffff0000, v126
    v_add_u32 v123, v123, v123
    v_mul_f32 v124, v122, v124
    v_mul_f32 v125, v122, v125
    v_cmpx_le_u32 vcc, 0x1000000, v59
    ds_add_f32 v123, v124 offset:54272
    ds_add_f32 v123, v125 offset:54276
    s_mov_b64 exec, -1
    s_waitcnt lgkmcnt(15)
    v_ashrrev_i32 v122, 5, v60
    v_lshlrev_b16 v123, 2, v60
    v_cndmask_b32 v126, v24, v25, s[66:67]
    v_bitop3_b32 v122, v122, v113, v113 bitop3:0x0c
    v_lshlrev_b32 v124, 16, v126
    v_mul_f32 v122, v114, v122
    v_and_b32 v125, 0xffff0000, v126
    v_add_u32 v123, v123, v123
    v_mul_f32 v124, v122, v124
    v_mul_f32 v125, v122, v125
    v_cmpx_le_u32 vcc, 0x1000000, v60
    ds_add_f32 v123, v124 offset:54272
    ds_add_f32 v123, v125 offset:54276
    s_mov_b64 exec, -1
    v_ashrrev_i32 v122, 5, v61
    v_lshlrev_b16 v123, 2, v61
    v_cndmask_b32 v126, v26, v27, s[66:67]
    v_bitop3_b32 v122, v122, v113, v113 bitop3:0x0c
    v_lshlrev_b32 v124, 16, v126
    v_mul_f32 v122, v114, v122
    v_and_b32 v125, 0xffff0000, v126
    v_add_u32 v123, v123, v123
    v_mul_f32 v124, v122, v124
    v_mul_f32 v125, v122, v125
    v_cmpx_le_u32 vcc, 0x1000000, v61
    ds_add_f32 v123, v124 offset:54272
    ds_add_f32 v123, v125 offset:54276
    s_mov_b64 exec, -1
    v_ashrrev_i32 v122, 5, v62
    v_lshlrev_b16 v123, 2, v62
    v_cndmask_b32 v126, v28, v29, s[66:67]
    v_bitop3_b32 v122, v122, v113, v113 bitop3:0x0c
    v_lshlrev_b32 v124, 16, v126
    v_mul_f32 v122, v114, v122
    v_and_b32 v125, 0xffff0000, v126
    v_add_u32 v123, v123, v123
    v_mul_f32 v124, v122, v124
    v_mul_f32 v125, v122, v125
    v_cmpx_le_u32 vcc, 0x1000000, v62
    ds_add_f32 v123, v124 offset:54272
    ds_add_f32 v123, v125 offset:54276
    s_mov_b64 exec, -1
    s_waitcnt lgkmcnt(15)
    v_ashrrev_i32 v122, 5, v63
    v_lshlrev_b16 v123, 2, v63
    v_cndmask_b32 v126, v30, v31, s[66:67]
    v_bitop3_b32 v122, v122, v113, v113 bitop3:0x0c
    v_lshlrev_b32 v124, 16, v126
    v_mul_f32 v122, v114, v122
    v_and_b32 v125, 0xffff0000, v126
    v_add_u32 v123, v123, v123
    v_mul_f32 v124, v122, v124
    v_mul_f32 v125, v122, v125
    v_cmpx_le_u32 vcc, 0x1000000, v63
    ds_add_f32 v123, v124 offset:54272
    ds_add_f32 v123, v125 offset:54276
    s_mov_b64 exec, -1
    v_ashrrev_i32 v122, 5, v64
    v_lshlrev_b16 v123, 2, v64
    v_cndmask_b32 v126, v32, v33, s[66:67]
    v_bitop3_b32 v122, v122, v113, v113 bitop3:0x0c
    v_lshlrev_b32 v124, 16, v126
    v_mul_f32 v122, v114, v122
    v_and_b32 v125, 0xffff0000, v126
    v_add_u32 v123, v123, v123
    v_mul_f32 v124, v122, v124
    v_mul_f32 v125, v122, v125
    v_cmpx_le_u32 vcc, 0x1000000, v64
    ds_add_f32 v123, v124 offset:54272
    ds_add_f32 v123, v125 offset:54276
    s_mov_b64 exec, -1
    v_ashrrev_i32 v122, 5, v65
    v_lshlrev_b16 v123, 2, v65
    v_cndmask_b32 v126, v34, v35, s[66:67]
    v_bitop3_b32 v122, v122, v113, v113 bitop3:0x0c
    v_lshlrev_b32 v124, 16, v126
    v_mul_f32 v122, v114, v122
    v_and_b32 v125, 0xffff0000, v126
    v_add_u32 v123, v123, v123
    v_mul_f32 v124, v122, v124
    v_mul_f32 v125, v122, v125
    v_cmpx_le_u32 vcc, 0x1000000, v65
    ds_add_f32 v123, v124 offset:54272
    ds_add_f32 v123, v125 offset:54276
    s_mov_b64 exec, -1
    s_waitcnt lgkmcnt(15)
    v_ashrrev_i32 v122, 5, v66
    v_lshlrev_b16 v123, 2, v66
    v_cndmask_b32 v126, v36, v37, s[66:67]
    v_bitop3_b32 v122, v122, v113, v113 bitop3:0x0c
    v_lshlrev_b32 v124, 16, v126
    v_mul_f32 v122, v114, v122
    v_and_b32 v125, 0xffff0000, v126
    v_add_u32 v123, v123, v123
    v_mul_f32 v124, v122, v124
    v_mul_f32 v125, v122, v125
    v_cmpx_le_u32 vcc, 0x1000000, v66
    ds_add_f32 v123, v124 offset:54272
    ds_add_f32 v123, v125 offset:54276
    s_mov_b64 exec, -1
    v_ashrrev_i32 v122, 5, v67
    v_lshlrev_b16 v123, 2, v67
    v_cndmask_b32 v126, v38, v39, s[66:67]
    v_bitop3_b32 v122, v122, v113, v113 bitop3:0x0c
    v_lshlrev_b32 v124, 16, v126
    v_mul_f32 v122, v114, v122
    v_and_b32 v125, 0xffff0000, v126
    v_add_u32 v123, v123, v123
    v_mul_f32 v124, v122, v124
    v_mul_f32 v125, v122, v125
    v_cmpx_le_u32 vcc, 0x1000000, v67
    ds_add_f32 v123, v124 offset:54272
    ds_add_f32 v123, v125 offset:54276
    s_mov_b64 exec, -1
    v_ashrrev_i32 v122, 5, v68
    v_lshlrev_b16 v123, 2, v68
    v_cndmask_b32 v126, v40, v41, s[66:67]
    v_bitop3_b32 v122, v122, v113, v113 bitop3:0x0c
    v_lshlrev_b32 v124, 16, v126
    v_mul_f32 v122, v114, v122
    v_and_b32 v125, 0xffff0000, v126
    v_add_u32 v123, v123, v123
    v_mul_f32 v124, v122, v124
    v_mul_f32 v125, v122, v125
    v_cmpx_le_u32 vcc, 0x1000000, v68
    ds_add_f32 v123, v124 offset:54272
    ds_add_f32 v123, v125 offset:54276
    s_mov_b64 exec, -1
    s_cmp_le_u32 s15, 7
    s_cbranch_scc1 p2_nad1
    s_waitcnt lgkmcnt(15)
    v_ashrrev_i32 v122, 5, v69
    v_lshlrev_b16 v123, 2, v69
    v_cndmask_b32 v126, v42, v43, s[66:67]
    v_bitop3_b32 v122, v122, v113, v113 bitop3:0x0c
    v_lshlrev_b32 v124, 16, v126
    v_mul_f32 v122, v114, v122
    v_and_b32 v125, 0xffff0000, v126
    v_add_u32 v123, v123, v123
    v_mul_f32 v124, v122, v124
    v_mul_f32 v125, v122, v125
    v_cmpx_le_u32 vcc, 0x1000000, v69
    ds_add_f32 v123, v124 offset:54272
    ds_add_f32 v123, v125 offset:54276
    s_mov_b64 exec, -1
    v_ashrrev_i32 v122, 5, v70
    v_lshlrev_b16 v123, 2, v70
    v_cndmask_b32 v126, v44, v45, s[66:67]
    v_bitop3_b32 v122, v122, v113, v113 bitop3:0x0c
    v_lshlrev_b32 v124, 16, v126
    v_mul_f32 v122, v114, v122
    v_and_b32 v125, 0xffff0000, v126
    v_add_u32 v123, v123, v123
    v_mul_f32 v124, v122, v124
    v_mul_f32 v125, v122, v125
    v_cmpx_le_u32 vcc, 0x1000000, v70
    ds_add_f32 v123, v124 offset:54272
    ds_add_f32 v123, v125 offset:54276
    s_mov_b64 exec, -1
    v_ashrrev_i32 v122, 5, v71
    v_lshlrev_b16 v123, 2, v71
    v_cndmask_b32 v126, v46, v47, s[66:67]
    v_bitop3_b32 v122, v122, v113, v113 bitop3:0x0c
    v_lshlrev_b32 v124, 16, v126
    v_mul_f32 v122, v114, v122
    v_and_b32 v125, 0xffff0000, v126
    v_add_u32 v123, v123, v123
    v_mul_f32 v124, v122, v124
    v_mul_f32 v125, v122, v125
    v_cmpx_le_u32 vcc, 0x1000000, v71
    ds_add_f32 v123, v124 offset:54272
    ds_add_f32 v123, v125 offset:54276
    s_mov_b64 exec, -1
p2_nad1:
    s_branch p2_fin
p2_tail:
    s_mov_b32 s60, s61
    s_mov_b32 s15, s16
    s_mov_b32 s16, s17
    v_mov_b32 v122, s19
    s_xor_b32 s19, s19, 4
    ds_read_b32 v125, v122 offset:53760
    v_mov_b32 v123, s19
    v_mov_b32 v124, 0
    ds_write_b32 v123, v124 offset:53760
    s_waitcnt vmcnt(2)
    s_mov_b32 m0, s24
    s_cmp_ge_u32 s10, 9
    s_cbranch_scc1 p2_st2s1
    ds_write_addtid_b32 v84 offset:49152
    ds_write_addtid_b32 v85 offset:49408
p2_st2s1:
    s_mov_b32 m0, s23
    s_add_u32 s20, s20, 53760
    ds_write_addtid_b32 v72 offset:0
    ds_write_addtid_b32 v73 offset:256
    ds_write_addtid_b32 v74 offset:512
    ds_write_addtid_b32 v75 offset:768
    ds_write_addtid_b32 v76 offset:1024
    ds_write_addtid_b32 v77 offset:1280
    ds_write_addtid_b32 v78 offset:1536
    ds_write_addtid_b32 v79 offset:1792
    ds_write_addtid_b32 v80 offset:2048
    ds_write_addtid_b32 v81 offset:2304
    ds_write_addtid_b32 v82 offset:2560
    ds_write_addtid_b32 v83 offset:2816
    s_waitcnt lgkmcnt(0)
    s_barrier
    s_waitcnt lgkmcnt(13)
    v_readfirstlane_b32 s44, v125
    s_nop 0
    s_cmp_lg_u32 s44, 0
    s_cbranch_scc1 p2_advb
    s_add_u32 s61, s61, 1
    s_min_u32 s61, s61, 10
    v_mov_b32 v110, 0
    v_mov_b32 v111, 0
    s_cmp_eq_u32 s61, 10
    s_cbranch_scc1 p2_advb
    s_add_u32 s44, s61, s18
    s_cmp_ge_u32 s44, 10
    s_cselect_b32 s53, 10, 0
    s_sub_u32 s44, s44, s53
    s_mul_i32 s44, s44, 4160
    s_add_u32 s44, s44, s40
    v_bfe_i32 v111, v112, 6, 1
    v_lshrrev_b32 v110, 6, v112
    v_bitop3_b32 v111, v111, 15, s10 bitop3:0x6a
    v_lshl_or_b32 v110, v110, 4, v111
    v_bfe_u32 v111, v112, 2, 4
    v_mul_u32_u24 v110, 41600, v110
    v_add_u32 v111, v110, v111
    v_add_u32 v110, 256, v112
    v_and_b32 v110, 0x400, v110
    v_lshl_or_b32 v111, v110, 20, v111
    buffer_load_dword v110, v111, s[4:7], s44 offen
    buffer_load_dword v111, v111, s[4:7], s44 offen offset:16
p2_advb:
    s_cmp_lg_u32 s10, 0
    s_cbranch_scc1 p2_ntg
    s_lshr_b32 s44, s2, 3
    s_mul_i32 s44, s44, 5120
    s_add_u32 s45, s60, s18
    s_cmp_ge_u32 s45, 10
    s_cselect_b32 s53, 10, 0
    s_sub_u32 s45, s45, s53
    s_mul_i32 s45, s45, 645120
    s_add_u32 s44, s44, s45
    s_add_u32 s44, s44, s62
    v_lshlrev_b32 v127, 3, v112
    s_mov_b32 exec_hi, 0xff
    buffer_load_dword v127, v127, s[4:7], s44 offen
    s_mov_b64 exec, -1
p2_ntg:
    s_cmp_ge_u32 s10, 9
    s_cbranch_scc1 p2_nm2m2a
    v_lshrrev_b32 v84, 1, v112
    s_add_u32 s44, s20, s42
    buffer_load_dwordx2 v[84:85], v84, s[4:7], s44 offen
p2_nm2m2a:
    buffer_load_dwordx4 v[72:75], v112, s[4:7], s20 offen offset:0
    buffer_load_dwordx4 v[76:79], v112, s[4:7], s20 offen offset:1024
    buffer_load_dwordx4 v[80:83], v112, s[4:7], s20 offen offset:2048
    v_cmpx_lt_i16 vcc, 0x3fff, v48
    ds_read_b64 v[0:1], v0
    s_mov_b64 exec, -1
    v_cmpx_lt_i16 vcc, 0x3fff, v49
    ds_read_b64 v[2:3], v2
    s_mov_b64 exec, -1
    v_cmpx_lt_i16 vcc, 0x3fff, v50
    ds_read_b64 v[4:5], v4
    s_mov_b64 exec, -1
    v_cmpx_lt_i16 vcc, 0x3fff, v51
    ds_read_b64 v[6:7], v6
    s_mov_b64 exec, -1
    v_cmpx_lt_i16 vcc, 0x3fff, v52
    ds_read_b64 v[8:9], v8
    s_mov_b64 exec, -1
    v_cmpx_lt_i16 vcc, 0x3fff, v53
    ds_read_b64 v[10:11], v10
    s_mov_b64 exec, -1
    v_cmpx_lt_i16 vcc, 0x3fff, v54
    ds_read_b64 v[12:13], v12
    s_mov_b64 exec, -1
    v_cmpx_lt_i16 vcc, 0x3fff, v55
    ds_read_b64 v[14:15], v14
    s_mov_b64 exec, -1
    v_cmpx_lt_i16 vcc, 0x3fff, v56
    ds_read_b64 v[16:17], v16
    s_mov_b64 exec, -1
    v_cmpx_lt_i16 vcc, 0x3fff, v57
    ds_read_b64 v[18:19], v18
    s_mov_b64 exec, -1
    v_cmpx_lt_i16 vcc, 0x3fff, v58
    ds_read_b64 v[20:21], v20
    s_mov_b64 exec, -1
    v_cmpx_lt_i16 vcc, 0x3fff, v59
    ds_read_b64 v[22:23], v22
    s_mov_b64 exec, -1
    v_bfe_u32 v94, v108, 14, 4
    v_lshrrev_b32 v95, 18, v108
    v_and_b32 v108, 0x3fff, v108
    v_mad_u32_u24 v94, v94, s63, v95
    v_lshl_or_b32 v108, v94, 14, v108
    buffer_load_dwordx4 v[94:97], v108, s[68:71], 0 offen
    v_cmpx_lt_i16 vcc, 0x3fff, v60
    ds_read_b64 v[24:25], v24
    s_mov_b64 exec, -1
    v_cmpx_lt_i16 vcc, 0x3fff, v61
    ds_read_b64 v[26:27], v26
    s_mov_b64 exec, -1
    v_cmpx_lt_i16 vcc, 0x3fff, v62
    ds_read_b64 v[28:29], v28
    s_mov_b64 exec, -1
    v_cmpx_lt_i16 vcc, 0x3fff, v63
    ds_read_b64 v[30:31], v30
    s_mov_b64 exec, -1
    v_cmpx_lt_i16 vcc, 0x3fff, v64
    ds_read_b64 v[32:33], v32
    s_mov_b64 exec, -1
    v_cmpx_lt_i16 vcc, 0x3fff, v65
    ds_read_b64 v[34:35], v34
    s_mov_b64 exec, -1
    v_cmpx_lt_i16 vcc, 0x3fff, v66
    ds_read_b64 v[36:37], v36
    s_mov_b64 exec, -1
    v_cmpx_lt_i16 vcc, 0x3fff, v67
    ds_read_b64 v[38:39], v38
    s_mov_b64 exec, -1
    v_cmpx_lt_i16 vcc, 0x3fff, v68
    ds_read_b64 v[40:41], v40
    s_mov_b64 exec, -1
    s_cmp_le_u32 s15, 7
    s_cbranch_scc1 p2_g2r17
    v_cmpx_lt_i16 vcc, 0x3fff, v69
    ds_read_b64 v[42:43], v42
    s_mov_b64 exec, -1
    v_cmpx_lt_i16 vcc, 0x3fff, v70
    ds_read_b64 v[44:45], v44
    s_mov_b64 exec, -1
    v_cmpx_lt_i16 vcc, 0x3fff, v71
    ds_read_b64 v[46:47], v46
    s_mov_b64 exec, -1
p2_g2r17:
    v_bfe_u32 v98, v109, 14, 4
    v_lshrrev_b32 v99, 18, v109
    v_and_b32 v109, 0x3fff, v109
    v_mad_u32_u24 v98, v98, s63, v99
    v_lshl_or_b32 v109, v98, 14, v109
    buffer_load_dwordx4 v[98:101], v109, s[68:71], 0 offen
    s_waitcnt lgkmcnt(0)
    s_barrier
    s_waitcnt vmcnt(2)
    s_mov_b32 m0, s24
    s_cmp_ge_u32 s10, 9
    s_cbranch_scc1 p2_st2s2
    ds_write_addtid_b32 v84 offset:49152
    ds_write_addtid_b32 v85 offset:49408
p2_st2s2:
    s_mov_b32 m0, s23
    s_add_u32 s20, s60, s18
    s_cmp_ge_u32 s20, 10
    s_cselect_b32 s53, 10, 0
    s_sub_u32 s20, s20, s53
    s_mul_i32 s20, s20, 645120
    s_add_u32 s20, s20, s62
    ds_write_addtid_b32 v72 offset:0
    ds_write_addtid_b32 v73 offset:256
    ds_write_addtid_b32 v74 offset:512
    ds_write_addtid_b32 v75 offset:768
    ds_write_addtid_b32 v76 offset:1024
    ds_write_addtid_b32 v77 offset:1280
    ds_write_addtid_b32 v78 offset:1536
    ds_write_addtid_b32 v79 offset:1792
    ds_write_addtid_b32 v80 offset:2048
    ds_write_addtid_b32 v81 offset:2304
    ds_write_addtid_b32 v82 offset:2560
    ds_write_addtid_b32 v83 offset:2816
    s_waitcnt lgkmcnt(0)
    s_barrier
    s_branch p2_top
p2_fin:
    s_waitcnt vmcnt(0) lgkmcnt(0)
    s_barrier
    s_mov_b32 s48, s11
    s_mul_i32 s44, s48, 800768
    s_mul_i32 s45, s12, 12512
    s_add_u32 s49, s44, s45
    s_lshl_b32 s44, s49, 3
    s_add_u32 s44, s44, 492278784
    s_lshl_b32 s48, s48, 2
    s_lshl_b32 s45, s12, 4
    s_add_u32 s48, s48, s45
    s_add_u32 s48, s48, 492277760
    v_add_u32 v123, s64, v112
    v_add_u32 v122, s25, v123
    v_mov_b32 v24, 0
    v_mov_b32 v25, 0
    v_mov_b32 v26, 0
    v_mov_b32 v27, 0
    v_cmp_gt_u32 vcc, 1792, v123
    v_mov_b32 v124, 0x38000000
    v_mov_b32 v126, 0
    v_cndmask_b32 v124, v124, v123, vcc
    ds_read_b128 v[0:3], v122 offset:0
    ds_read_b128 v[4:7], v122 offset:16384
    ds_read_b128 v[8:11], v122 offset:32768
    v_add_u32 v122, 49152, v122
    ds_read_b128 v[12:15], v122 offset:0
    ds_read_b128 v[16:19], v122 offset:16384
    ds_read_b128 v[20:23], v122 offset:32768
    s_mov_b64 exec, vcc
    ds_read_b128 v[24:27], v122 offset:49152
    s_mov_b64 exec, -1
    s_cmp_lg_u32 s21, 0
    s_cbranch_scc1 p2_finf
    s_waitcnt lgkmcnt(6)
    buffer_store_dwordx4 v[0:3], v123, s[4:7], s44 offen
    s_add_u32 s44, s44, 16384
    s_waitcnt lgkmcnt(5)
    buffer_store_dwordx4 v[4:7], v123, s[4:7], s44 offen
    s_add_u32 s44, s44, 16384
    s_waitcnt lgkmcnt(4)
    buffer_store_dwordx4 v[8:11], v123, s[4:7], s44 offen
    s_add_u32 s44, s44, 16384
    s_waitcnt lgkmcnt(3)
    buffer_store_dwordx4 v[12:15], v123, s[4:7], s44 offen
    s_add_u32 s44, s44, 16384
    s_waitcnt lgkmcnt(2)
    buffer_store_dwordx4 v[16:19], v123, s[4:7], s44 offen
    s_add_u32 s44, s44, 16384
    s_waitcnt lgkmcnt(1)
    buffer_store_dwordx4 v[20:23], v123, s[4:7], s44 offen
    s_add_u32 s44, s44, 16384
    s_waitcnt lgkmcnt(0)
    buffer_store_dwordx4 v[24:27], v124, s[4:7], s44 offen
    s_add_u32 s44, s44, 16384
    v_bitop3_b32 v115, v115, v0, v1 bitop3:0xfe
    v_bitop3_b32 v115, v115, v2, v3 bitop3:0xfe
    v_bitop3_b32 v115, v115, v4, v5 bitop3:0xfe
    v_bitop3_b32 v115, v115, v6, v7 bitop3:0xfe
    v_bitop3_b32 v115, v115, v8, v9 bitop3:0xfe
    v_bitop3_b32 v115, v115, v10, v11 bitop3:0xfe
    v_bitop3_b32 v115, v115, v12, v13 bitop3:0xfe
    v_bitop3_b32 v115, v115, v14, v15 bitop3:0xfe
    v_bitop3_b32 v115, v115, v16, v17 bitop3:0xfe
    v_bitop3_b32 v115, v115, v18, v19 bitop3:0xfe
    v_bitop3_b32 v115, v115, v20, v21 bitop3:0xfe
    v_bitop3_b32 v115, v115, v22, v23 bitop3:0xfe
    v_bitop3_b32 v115, v115, v24, v25 bitop3:0xfe
    v_bitop3_b32 v115, v115, v26, v27 bitop3:0xfe
    v_bitop3_b32 v115, v115, v116, v117 bitop3:0xfe
    v_bitop3_b32 v115, v115, v118, v119 bitop3:0xfe
    v_bitop3_b32 v115, v115, v120, v121 bitop3:0xfe
    v_and_b32 v115, 0x80008000, v115
    v_cmpx_ne_u32 vcc, 0, v115
    ds_write_b32 v126, v115 offset:53768
    s_mov_b64 exec, -1
    s_waitcnt lgkmcnt(0)
    s_barrier
    ds_read_b32 v125, v126 offset:53768
    s_waitcnt lgkmcnt(0)
    v_readfirstlane_b32 s45, v125
    s_nop 0
    s_cmp_eq_u32 s45, 0
    s_cbranch_scc1 p2_done
    s_mov_b32 s21, 1
    s_waitcnt vmcnt(0)
    s_branch p2_restart
p2_finf:
    s_lshl_b32 s49, s49, 4
    s_lshl_b32 s45, s21, 3
    s_add_u32 s49, s49, s45
    s_add_u32 s49, s49, 517903352
    v_mov_b32 v28, 1073758208
    v_mov_b32 v29, 1073758208
    v_mov_b32 v30, 1073758208
    v_mov_b32 v31, 1073758208
    v_lshlrev_b32 v122, 1, v123
    v_lshlrev_b32 v125, 1, v124
    s_waitcnt lgkmcnt(0)
    buffer_store_dwordx4 v[28:31], v123, s[4:7], s44 offen
    s_add_u32 s44, s44, 16384
    buffer_store_dwordx2 v[0:1], v122, s[4:7], s49 offen offset:0
    buffer_store_dwordx2 v[2:3], v122, s[4:7], s49 offen offset:16
    s_add_u32 s49, s49, 32768
    buffer_store_dwordx4 v[28:31], v123, s[4:7], s44 offen
    s_add_u32 s44, s44, 16384
    buffer_store_dwordx2 v[4:5], v122, s[4:7], s49 offen offset:0
    buffer_store_dwordx2 v[6:7], v122, s[4:7], s49 offen offset:16
    s_add_u32 s49, s49, 32768
    buffer_store_dwordx4 v[28:31], v123, s[4:7], s44 offen
    s_add_u32 s44, s44, 16384
    buffer_store_dwordx2 v[8:9], v122, s[4:7], s49 offen offset:0
    buffer_store_dwordx2 v[10:11], v122, s[4:7], s49 offen offset:16
    s_add_u32 s49, s49, 32768
    buffer_store_dwordx4 v[28:31], v123, s[4:7], s44 offen
    s_add_u32 s44, s44, 16384
    buffer_store_dwordx2 v[12:13], v122, s[4:7], s49 offen offset:0
    buffer_store_dwordx2 v[14:15], v122, s[4:7], s49 offen offset:16
    s_add_u32 s49, s49, 32768
    buffer_store_dwordx4 v[28:31], v123, s[4:7], s44 offen
    s_add_u32 s44, s44, 16384
    buffer_store_dwordx2 v[16:17], v122, s[4:7], s49 offen offset:0
    buffer_store_dwordx2 v[18:19], v122, s[4:7], s49 offen offset:16
    s_add_u32 s49, s49, 32768
    buffer_store_dwordx4 v[28:31], v123, s[4:7], s44 offen
    s_add_u32 s44, s44, 16384
    buffer_store_dwordx2 v[20:21], v122, s[4:7], s49 offen offset:0
    buffer_store_dwordx2 v[22:23], v122, s[4:7], s49 offen offset:16
    s_add_u32 s49, s49, 32768
    buffer_store_dwordx4 v[28:31], v124, s[4:7], s44 offen
    s_add_u32 s44, s44, 16384
    buffer_store_dwordx2 v[24:25], v125, s[4:7], s49 offen offset:0
    buffer_store_dwordx2 v[26:27], v125, s[4:7], s49 offen offset:16
    s_add_u32 s49, s49, 32768
    s_add_u32 s21, s21, 1
    s_mov_b32 s30, 0
    s_waitcnt vmcnt(0)
    s_cmp_eq_u32 s21, 2
    s_cbranch_scc1 p2_restart
p2_done:
    v_mov_b32 v125, s30
    buffer_store_dword v125, v126, s[4:7], s48 offen
p2_end:
    s_endpgm
.globl p3_kernel
.p2align 8
.type p3_kernel,@function
p3_kernel:
    s_cmp_ge_u32 s2, 1563
    s_cbranch_scc1 p3_end
    s_load_dwordx2 s[4:5], s[0:1], 0
    s_load_dwordx2 s[6:7], s[0:1], 24
    s_load_dwordx2 s[8:9], s[0:1], 40
    s_load_dwordx8 s[12:19], s[0:1], 56
    s_load_dwordx2 s[10:11], s[0:1], 88
    s_load_dwordx2 s[20:21], s[0:1], 104
    s_lshl_b32 s3, s2, 8
    v_add_u32 v0, s3, v0
    v_lshlrev_b32 v2, 4, v0
    v_lshlrev_b32 v3, 2, v0
    v_add_u32 v0, v0, v0
    v_mul_hi_u32_u24 v1, 343268, v0
    v_lshlrev_b16 v1, 4, v1
    s_waitcnt lgkmcnt(0)
    s_load_dwordx4 s[32:35], s[8:9], 0
    s_load_dwordx16 s[36:51], s[12:13], 0
    s_load_dwordx16 s[52:67], s[14:15], 0
    s_load_dwordx8 s[68:75], s[16:17], 0
    s_load_dwordx8 s[76:83], s[18:19], 0
    s_mov_b32 s24, s6
    s_and_b32 s25, s7, 0xffff
    s_mov_b32 s26, 1600000
    s_mov_b32 s27, 0x20000
    buffer_load_dword v4, v3, s[24:27], 0 offen
    s_mov_b32 s28, s20
    s_and_b32 s29, s21, 0xffff
    s_mov_b32 s30, 819200000
    s_mov_b32 s31, 0x20000
    s_mov_b32 s22, 492278784
    buffer_load_dwordx4 v[40:43], v2, s[28:31], s22 offen
    s_mov_b32 s22, 498684928
    buffer_load_dwordx4 v[44:47], v2, s[28:31], s22 offen
    s_mov_b32 s22, 505091072
    buffer_load_dwordx4 v[48:51], v2, s[28:31], s22 offen
    s_mov_b32 s22, 511497216
    buffer_load_dwordx4 v[52:55], v2, s[28:31], s22 offen
    s_mov_b32 s22, 492277760
    buffer_load_dwordx4 v[56:59], v1, s[28:31], s22 offen
    s_mov_b32 s24, s4
    s_and_b32 s25, s5, 0xffff
    s_mov_b32 s26, 6400000
    s_mov_b32 s27, 0x20000
    buffer_load_dwordx4 v[60:63], v2, s[24:27], 0 offen
    s_mov_b32 s24, s10
    s_and_b32 s25, s11, 0xffff
    s_mov_b32 s26, 6400000
    s_mov_b32 s27, 0x20000
    s_waitcnt vmcnt(6) lgkmcnt(0)
    v_and_b32 v5, 0xffff0000, v4
    v_lshlrev_b32 v4, 16, v4
    s_lshl_b32 s14, s32, 16
    s_and_b32 s15, s32, 0xffff0000
    v_pk_add_f32 v[8:9], v[4:5], s[14:15] op_sel:[0,0] op_sel_hi:[0,1] neg_lo:[0,1] neg_hi:[0,1]
    v_pk_add_f32 v[16:17], v[4:5], s[14:15] op_sel:[1,0] op_sel_hi:[1,1] neg_lo:[0,1] neg_hi:[0,1]
    s_lshl_b32 s16, s33, 16
    s_and_b32 s17, s33, 0xffff0000
    v_pk_add_f32 v[10:11], v[4:5], s[16:17] op_sel:[0,0] op_sel_hi:[0,1] neg_lo:[0,1] neg_hi:[0,1]
    v_pk_add_f32 v[18:19], v[4:5], s[16:17] op_sel:[1,0] op_sel_hi:[1,1] neg_lo:[0,1] neg_hi:[0,1]
    s_lshl_b32 s18, s34, 16
    s_and_b32 s19, s34, 0xffff0000
    v_pk_add_f32 v[12:13], v[4:5], s[18:19] op_sel:[0,0] op_sel_hi:[0,1] neg_lo:[0,1] neg_hi:[0,1]
    v_pk_add_f32 v[20:21], v[4:5], s[18:19] op_sel:[1,0] op_sel_hi:[1,1] neg_lo:[0,1] neg_hi:[0,1]
    s_lshl_b32 s12, s35, 16
    s_and_b32 s13, s35, 0xffff0000
    v_pk_add_f32 v[14:15], v[4:5], s[12:13] op_sel:[0,0] op_sel_hi:[0,1] neg_lo:[0,1] neg_hi:[0,1]
    v_pk_add_f32 v[22:23], v[4:5], s[12:13] op_sel:[1,0] op_sel_hi:[1,1] neg_lo:[0,1] neg_hi:[0,1]
    v_cvt_pk_bf16_f32 v8, v8, v9
    v_cvt_pk_bf16_f32 v10, v10, v11
    v_cvt_pk_bf16_f32 v12, v12, v13
    v_cvt_pk_bf16_f32 v14, v14, v15
    v_cvt_pk_bf16_f32 v16, v16, v17
    v_cvt_pk_bf16_f32 v18, v18, v19
    v_cvt_pk_bf16_f32 v20, v20, v21
    v_cvt_pk_bf16_f32 v22, v22, v23
    v_and_b32 v9, 0xffff0000, v8
    v_lshlrev_b32 v8, 16, v8
    v_and_b32 v11, 0xffff0000, v10
    v_lshlrev_b32 v10, 16, v10
    v_and_b32 v13, 0xffff0000, v12
    v_lshlrev_b32 v12, 16, v12
    v_and_b32 v15, 0xffff0000, v14
    v_lshlrev_b32 v14, 16, v14
    v_and_b32 v17, 0xffff0000, v16
    v_lshlrev_b32 v16, 16, v16
    v_and_b32 v19, 0xffff0000, v18
    v_lshlrev_b32 v18, 16, v18
    v_and_b32 v21, 0xffff0000, v20
    v_lshlrev_b32 v20, 16, v20
    v_and_b32 v23, 0xffff0000, v22
    v_lshlrev_b32 v22, 16, v22
    v_mul_f32 v8, v8, v8
    v_mul_f32 v9, v9, v9
    v_mul_f32 v10, v10, v10
    v_mul_f32 v11, v11, v11
    v_mul_f32 v12, v12, v12
    v_mul_f32 v13, v13, v13
    v_mul_f32 v14, v14, v14
    v_mul_f32 v15, v15, v15
    v_mul_f32 v16, v16, v16
    v_mul_f32 v17, v17, v17
    v_mul_f32 v18, v18, v18
    v_mul_f32 v19, v19, v19
    v_mul_f32 v20, v20, v20
    v_mul_f32 v21, v21, v21
    v_mul_f32 v22, v22, v22
    v_mul_f32 v23, v23, v23
    v_cvt_pk_bf16_f32 v8, v8, v9
    v_cvt_pk_bf16_f32 v10, v10, v11
    v_cvt_pk_bf16_f32 v12, v12, v13
    v_cvt_pk_bf16_f32 v14, v14, v15
    v_cvt_pk_bf16_f32 v16, v16, v17
    v_cvt_pk_bf16_f32 v18, v18, v19
    v_cvt_pk_bf16_f32 v20, v20, v21
    v_cvt_pk_bf16_f32 v22, v22, v23
    v_and_b32 v9, 0xffff0000, v8
    v_lshlrev_b32 v8, 16, v8
    v_and_b32 v11, 0xffff0000, v10
    v_lshlrev_b32 v10, 16, v10
    v_and_b32 v13, 0xffff0000, v12
    v_lshlrev_b32 v12, 16, v12
    v_and_b32 v15, 0xffff0000, v14
    v_lshlrev_b32 v14, 16, v14
    v_and_b32 v17, 0xffff0000, v16
    v_lshlrev_b32 v16, 16, v16
    v_and_b32 v19, 0xffff0000, v18
    v_lshlrev_b32 v18, 16, v18
    v_and_b32 v21, 0xffff0000, v20
    v_lshlrev_b32 v20, 16, v20
    v_and_b32 v23, 0xffff0000, v22
    v_lshlrev_b32 v22, 16, v22
    v_mul_f32 v8, 0xc1200000, v8
    v_mul_f32 v9, 0xc1200000, v9
    v_mul_f32 v10, 0xc1200000, v10
    v_mul_f32 v11, 0xc1200000, v11
    v_mul_f32 v12, 0xc1200000, v12
    v_mul_f32 v13, 0xc1200000, v13
    v_mul_f32 v14, 0xc1200000, v14
    v_mul_f32 v15, 0xc1200000, v15
    v_mul_f32 v16, 0xc1200000, v16
    v_mul_f32 v17, 0xc1200000, v17
    v_mul_f32 v18, 0xc1200000, v18
    v_mul_f32 v19, 0xc1200000, v19
    v_mul_f32 v20, 0xc1200000, v20
    v_mul_f32 v21, 0xc1200000, v21
    v_mul_f32 v22, 0xc1200000, v22
    v_mul_f32 v23, 0xc1200000, v23
    v_cvt_pk_bf16_f32 v8, v8, v9
    v_cvt_pk_bf16_f32 v10, v10, v11
    v_cvt_pk_bf16_f32 v12, v12, v13
    v_cvt_pk_bf16_f32 v14, v14, v15
    v_cvt_pk_bf16_f32 v16, v16, v17
    v_cvt_pk_bf16_f32 v18, v18, v19
    v_cvt_pk_bf16_f32 v20, v20, v21
    v_cvt_pk_bf16_f32 v22, v22, v23
    v_and_b32 v9, 0xffff0000, v8
    v_lshlrev_b32 v8, 16, v8
    v_and_b32 v11, 0xffff0000, v10
    v_lshlrev_b32 v10, 16, v10
    v_and_b32 v13, 0xffff0000, v12
    v_lshlrev_b32 v12, 16, v12
    v_and_b32 v15, 0xffff0000, v14
    v_lshlrev_b32 v14, 16, v14
    v_and_b32 v17, 0xffff0000, v16
    v_lshlrev_b32 v16, 16, v16
    v_and_b32 v19, 0xffff0000, v18
    v_lshlrev_b32 v18, 16, v18
    v_and_b32 v21, 0xffff0000, v20
    v_lshlrev_b32 v20, 16, v20
    v_and_b32 v23, 0xffff0000, v22
    v_lshlrev_b32 v22, 16, v22
    v_mul_f32 v8, 0x3fb8aa3b, v8
    v_mul_f32 v9, 0x3fb8aa3b, v9
    v_mul_f32 v10, 0x3fb8aa3b, v10
    v_mul_f32 v11, 0x3fb8aa3b, v11
    v_mul_f32 v12, 0x3fb8aa3b, v12
    v_mul_f32 v13, 0x3fb8aa3b, v13
    v_mul_f32 v14, 0x3fb8aa3b, v14
    v_mul_f32 v15, 0x3fb8aa3b, v15
    v_mul_f32 v16, 0x3fb8aa3b, v16
    v_mul_f32 v17, 0x3fb8aa3b, v17
    v_mul_f32 v18, 0x3fb8aa3b, v18
    v_mul_f32 v19, 0x3fb8aa3b, v19
    v_mul_f32 v20, 0x3fb8aa3b, v20
    v_mul_f32 v21, 0x3fb8aa3b, v21
    v_mul_f32 v22, 0x3fb8aa3b, v22
    v_mul_f32 v23, 0x3fb8aa3b, v23
    v_exp_f32 v8, v8
    v_exp_f32 v9, v9
    v_exp_f32 v10, v10
    v_exp_f32 v11, v11
    v_exp_f32 v12, v12
    v_exp_f32 v13, v13
    v_exp_f32 v14, v14
    v_exp_f32 v15, v15
    v_exp_f32 v16, v16
    v_exp_f32 v17, v17
    v_exp_f32 v18, v18
    v_exp_f32 v19, v19
    v_exp_f32 v20, v20
    v_exp_f32 v21, v21
    v_exp_f32 v22, v22
    v_exp_f32 v23, v23
    s_nop 0
    v_cvt_pk_bf16_f32 v8, v8, v9
    v_cvt_pk_bf16_f32 v10, v10, v11
    v_cvt_pk_bf16_f32 v12, v12, v13
    v_cvt_pk_bf16_f32 v14, v14, v15
    v_cvt_pk_bf16_f32 v16, v16, v17
    v_cvt_pk_bf16_f32 v18, v18, v19
    v_cvt_pk_bf16_f32 v20, v20, v21
    v_cvt_pk_bf16_f32 v22, v22, v23
    v_and_b32 v9, 0xffff0000, v8
    v_lshlrev_b32 v8, 16, v8
    v_and_b32 v11, 0xffff0000, v10
    v_lshlrev_b32 v10, 16, v10
    v_and_b32 v13, 0xffff0000, v12
    v_lshlrev_b32 v12, 16, v12
    v_and_b32 v15, 0xffff0000, v14
    v_lshlrev_b32 v14, 16, v14
    v_and_b32 v17, 0xffff0000, v16
    v_lshlrev_b32 v16, 16, v16
    v_and_b32 v19, 0xffff0000, v18
    v_lshlrev_b32 v18, 16, v18
    v_and_b32 v21, 0xffff0000, v20
    v_lshlrev_b32 v20, 16, v20
    v_and_b32 v23, 0xffff0000, v22
    v_lshlrev_b32 v22, 16, v22
    s_lshl_b32 s14, s52, 16
    s_and_b32 s15, s52, 0xffff0000
    v_pk_mul_f32 v[24:25], v[8:9], s[14:15] op_sel:[0,0] op_sel_hi:[0,1]
    v_pk_mul_f32 v[28:29], v[16:17], s[14:15] op_sel:[0,0] op_sel_hi:[0,1]
    s_lshl_b32 s16, s53, 16
    s_and_b32 s17, s53, 0xffff0000
    v_pk_mul_f32 v[26:27], v[8:9], s[16:17] op_sel:[0,0] op_sel_hi:[0,1]
    v_pk_mul_f32 v[30:31], v[16:17], s[16:17] op_sel:[0,0] op_sel_hi:[0,1]
    s_lshl_b32 s18, s54, 16
    s_and_b32 s19, s54, 0xffff0000
    v_pk_fma_f32 v[24:25], v[8:9], s[18:19], v[24:25] op_sel:[1,0,0] op_sel_hi:[1,1,1]
    v_pk_fma_f32 v[28:29], v[16:17], s[18:19], v[28:29] op_sel:[1,0,0] op_sel_hi:[1,1,1]
    s_lshl_b32 s12, s55, 16
    s_and_b32 s13, s55, 0xffff0000
    v_pk_fma_f32 v[26:27], v[8:9], s[12:13], v[26:27] op_sel:[1,0,0] op_sel_hi:[1,1,1]
    v_pk_fma_f32 v[30:31], v[16:17], s[12:13], v[30:31] op_sel:[1,0,0] op_sel_hi:[1,1,1]
    s_lshl_b32 s14, s56, 16
    s_and_b32 s15, s56, 0xffff0000
    v_pk_fma_f32 v[24:25], v[10:11], s[14:15], v[24:25] op_sel:[0,0,0] op_sel_hi:[0,1,1]
    v_pk_fma_f32 v[28:29], v[18:19], s[14:15], v[28:29] op_sel:[0,0,0] op_sel_hi:[0,1,1]
    s_lshl_b32 s16, s57, 16
    s_and_b32 s17, s57, 0xffff0000
    v_pk_fma_f32 v[26:27], v[10:11], s[16:17], v[26:27] op_sel:[0,0,0] op_sel_hi:[0,1,1]
    v_pk_fma_f32 v[30:31], v[18:19], s[16:17], v[30:31] op_sel:[0,0,0] op_sel_hi:[0,1,1]
    s_lshl_b32 s18, s58, 16
    s_and_b32 s19, s58, 0xffff0000
    v_pk_fma_f32 v[24:25], v[10:11], s[18:19], v[24:25] op_sel:[1,0,0] op_sel_hi:[1,1,1]
    v_pk_fma_f32 v[28:29], v[18:19], s[18:19], v[28:29] op_sel:[1,0,0] op_sel_hi:[1,1,1]
    s_lshl_b32 s12, s59, 16
    s_and_b32 s13, s59, 0xffff0000
    v_pk_fma_f32 v[26:27], v[10:11], s[12:13], v[26:27] op_sel:[1,0,0] op_sel_hi:[1,1,1]
    v_pk_fma_f32 v[30:31], v[18:19], s[12:13], v[30:31] op_sel:[1,0,0] op_sel_hi:[1,1,1]
    s_lshl_b32 s14, s60, 16
    s_and_b32 s15, s60, 0xffff0000
    v_pk_fma_f32 v[24:25], v[12:13], s[14:15], v[24:25] op_sel:[0,0,0] op_sel_hi:[0,1,1]
    v_pk_fma_f32 v[28:29], v[20:21], s[14:15], v[28:29] op_sel:[0,0,0] op_sel_hi:[0,1,1]
    s_lshl_b32 s16, s61, 16
    s_and_b32 s17, s61, 0xffff0000
    v_pk_fma_f32 v[26:27], v[12:13], s[16:17], v[26:27] op_sel:[0,0,0] op_sel_hi:[0,1,1]
    v_pk_fma_f32 v[30:31], v[20:21], s[16:17], v[30:31] op_sel:[0,0,0] op_sel_hi:[0,1,1]
    s_lshl_b32 s18, s62, 16
    s_and_b32 s19, s62, 0xffff0000
    v_pk_fma_f32 v[24:25], v[12:13], s[18:19], v[24:25] op_sel:[1,0,0] op_sel_hi:[1,1,1]
    v_pk_fma_f32 v[28:29], v[20:21], s[18:19], v[28:29] op_sel:[1,0,0] op_sel_hi:[1,1,1]
    s_lshl_b32 s12, s63, 16
    s_and_b32 s13, s63, 0xffff0000
    v_pk_fma_f32 v[26:27], v[12:13], s[12:13], v[26:27] op_sel:[1,0,0] op_sel_hi:[1,1,1]
    v_pk_fma_f32 v[30:31], v[20:21], s[12:13], v[30:31] op_sel:[1,0,0] op_sel_hi:[1,1,1]
    s_lshl_b32 s14, s64, 16
    s_and_b32 s15, s64, 0xffff0000
    v_pk_fma_f32 v[24:25], v[14:15], s[14:15], v[24:25] op_sel:[0,0,0] op_sel_hi:[0,1,1]
    v_pk_fma_f32 v[28:29], v[22:23], s[14:15], v[28:29] op_sel:[0,0,0] op_sel_hi:[0,1,1]
    s_lshl_b32 s16, s65, 16
    s_and_b32 s17, s65, 0xffff0000
    v_pk_fma_f32 v[26:27], v[14:15], s[16:17], v[26:27] op_sel:[0,0,0] op_sel_hi:[0,1,1]
    v_pk_fma_f32 v[30:31], v[22:23], s[16:17], v[30:31] op_sel:[0,0,0] op_sel_hi:[0,1,1]
    s_lshl_b32 s18, s66, 16
    s_and_b32 s19, s66, 0xffff0000
    v_pk_fma_f32 v[24:25], v[14:15], s[18:19], v[24:25] op_sel:[1,0,0] op_sel_hi:[1,1,1]
    v_pk_fma_f32 v[28:29], v[22:23], s[18:19], v[28:29] op_sel:[1,0,0] op_sel_hi:[1,1,1]
    s_lshl_b32 s12, s67, 16
    s_and_b32 s13, s67, 0xffff0000
    v_pk_fma_f32 v[26:27], v[14:15], s[12:13], v[26:27] op_sel:[1,0,0] op_sel_hi:[1,1,1]
    v_pk_fma_f32 v[30:31], v[22:23], s[12:13], v[30:31] op_sel:[1,0,0] op_sel_hi:[1,1,1]
    s_lshl_b32 s14, s36, 16
    s_and_b32 s15, s36, 0xffff0000
    v_pk_mul_f32 v[32:33], v[8:9], s[14:15] op_sel:[0,0] op_sel_hi:[0,1]
    v_pk_mul_f32 v[36:37], v[16:17], s[14:15] op_sel:[0,0] op_sel_hi:[0,1]
    s_lshl_b32 s16, s37, 16
    s_and_b32 s17, s37, 0xffff0000
    v_pk_mul_f32 v[34:35], v[8:9], s[16:17] op_sel:[0,0] op_sel_hi:[0,1]
    v_pk_mul_f32 v[38:39], v[16:17], s[16:17] op_sel:[0,0] op_sel_hi:[0,1]
    s_lshl_b32 s18, s38, 16
    s_and_b32 s19, s38, 0xffff0000
    v_pk_fma_f32 v[32:33], v[8:9], s[18:19], v[32:33] op_sel:[1,0,0] op_sel_hi:[1,1,1]
    v_pk_fma_f32 v[36:37], v[16:17], s[18:19], v[36:37] op_sel:[1,0,0] op_sel_hi:[1,1,1]
    s_lshl_b32 s12, s39, 16
    s_and_b32 s13, s39, 0xffff0000
    v_pk_fma_f32 v[34:35], v[8:9], s[12:13], v[34:35] op_sel:[1,0,0] op_sel_hi:[1,1,1]
    v_pk_fma_f32 v[38:39], v[16:17], s[12:13], v[38:39] op_sel:[1,0,0] op_sel_hi:[1,1,1]
    s_lshl_b32 s14, s40, 16
    s_and_b32 s15, s40, 0xffff0000
    v_pk_fma_f32 v[32:33], v[10:11], s[14:15], v[32:33] op_sel:[0,0,0] op_sel_hi:[0,1,1]
    v_pk_fma_f32 v[36:37], v[18:19], s[14:15], v[36:37] op_sel:[0,0,0] op_sel_hi:[0,1,1]
    s_lshl_b32 s16, s41, 16
    s_and_b32 s17, s41, 0xffff0000
    v_pk_fma_f32 v[34:35], v[10:11], s[16:17], v[34:35] op_sel:[0,0,0] op_sel_hi:[0,1,1]
    v_pk_fma_f32 v[38:39], v[18:19], s[16:17], v[38:39] op_sel:[0,0,0] op_sel_hi:[0,1,1]
    s_lshl_b32 s18, s42, 16
    s_and_b32 s19, s42, 0xffff0000
    v_pk_fma_f32 v[32:33], v[10:11], s[18:19], v[32:33] op_sel:[1,0,0] op_sel_hi:[1,1,1]
    v_pk_fma_f32 v[36:37], v[18:19], s[18:19], v[36:37] op_sel:[1,0,0] op_sel_hi:[1,1,1]
    s_lshl_b32 s12, s43, 16
    s_and_b32 s13, s43, 0xffff0000
    v_pk_fma_f32 v[34:35], v[10:11], s[12:13], v[34:35] op_sel:[1,0,0] op_sel_hi:[1,1,1]
    v_pk_fma_f32 v[38:39], v[18:19], s[12:13], v[38:39] op_sel:[1,0,0] op_sel_hi:[1,1,1]
    s_lshl_b32 s14, s44, 16
    s_and_b32 s15, s44, 0xffff0000
    v_pk_fma_f32 v[32:33], v[12:13], s[14:15], v[32:33] op_sel:[0,0,0] op_sel_hi:[0,1,1]
    v_pk_fma_f32 v[36:37], v[20:21], s[14:15], v[36:37] op_sel:[0,0,0] op_sel_hi:[0,1,1]
    s_lshl_b32 s16, s45, 16
    s_and_b32 s17, s45, 0xffff0000
    v_pk_fma_f32 v[34:35], v[12:13], s[16:17], v[34:35] op_sel:[0,0,0] op_sel_hi:[0,1,1]
    v_pk_fma_f32 v[38:39], v[20:21], s[16:17], v[38:39] op_sel:[0,0,0] op_sel_hi:[0,1,1]
    s_lshl_b32 s18, s46, 16
    s_and_b32 s19, s46, 0xffff0000
    v_pk_fma_f32 v[32:33], v[12:13], s[18:19], v[32:33] op_sel:[1,0,0] op_sel_hi:[1,1,1]
    v_pk_fma_f32 v[36:37], v[20:21], s[18:19], v[36:37] op_sel:[1,0,0] op_sel_hi:[1,1,1]
    s_lshl_b32 s12, s47, 16
    s_and_b32 s13, s47, 0xffff0000
    v_pk_fma_f32 v[34:35], v[12:13], s[12:13], v[34:35] op_sel:[1,0,0] op_sel_hi:[1,1,1]
    v_pk_fma_f32 v[38:39], v[20:21], s[12:13], v[38:39] op_sel:[1,0,0] op_sel_hi:[1,1,1]
    s_lshl_b32 s14, s48, 16
    s_and_b32 s15, s48, 0xffff0000
    v_pk_fma_f32 v[32:33], v[14:15], s[14:15], v[32:33] op_sel:[0,0,0] op_sel_hi:[0,1,1]
    v_pk_fma_f32 v[36:37], v[22:23], s[14:15], v[36:37] op_sel:[0,0,0] op_sel_hi:[0,1,1]
    s_lshl_b32 s16, s49, 16
    s_and_b32 s17, s49, 0xffff0000
    v_pk_fma_f32 v[34:35], v[14:15], s[16:17], v[34:35] op_sel:[0,0,0] op_sel_hi:[0,1,1]
    v_pk_fma_f32 v[38:39], v[22:23], s[16:17], v[38:39] op_sel:[0,0,0] op_sel_hi:[0,1,1]
    s_lshl_b32 s18, s50, 16
    s_and_b32 s19, s50, 0xffff0000
    v_pk_fma_f32 v[32:33], v[14:15], s[18:19], v[32:33] op_sel:[1,0,0] op_sel_hi:[1,1,1]
    v_pk_fma_f32 v[36:37], v[22:23], s[18:19], v[36:37] op_sel:[1,0,0] op_sel_hi:[1,1,1]
    s_lshl_b32 s12, s51, 16
    s_and_b32 s13, s51, 0xffff0000
    v_pk_fma_f32 v[34:35], v[14:15], s[12:13], v[34:35] op_sel:[1,0,0] op_sel_hi:[1,1,1]
    v_pk_fma_f32 v[38:39], v[22:23], s[12:13], v[38:39] op_sel:[1,0,0] op_sel_hi:[1,1,1]
    v_cvt_pk_bf16_f32 v32, v32, v33
    v_cvt_pk_bf16_f32 v34, v34, v35
    v_cvt_pk_bf16_f32 v36, v36, v37
    v_cvt_pk_bf16_f32 v38, v38, v39
    v_and_b32 v33, 0xffff0000, v32
    v_lshlrev_b32 v32, 16, v32
    v_and_b32 v35, 0xffff0000, v34
    v_lshlrev_b32 v34, 16, v34
    v_and_b32 v37, 0xffff0000, v36
    v_lshlrev_b32 v36, 16, v36
    v_and_b32 v39, 0xffff0000, v38
    v_lshlrev_b32 v38, 16, v38
    s_waitcnt vmcnt(1)
    v_add_u32 v40, v40, v44
    v_add_u32 v48, v48, v52
    v_add_u32 v41, v41, v45
    v_add_u32 v49, v49, v53
    v_add_u32 v42, v42, v46
    v_add_u32 v50, v50, v54
    v_add_u32 v43, v43, v47
    v_add_u32 v51, v51, v55
    v_add_u32_sdwa v8, v40, v48 dst_sel:DWORD dst_unused:UNUSED_PAD src0_sel:WORD_0 src1_sel:WORD_0
    v_add_u32_sdwa v9, v40, v48 dst_sel:DWORD dst_unused:UNUSED_PAD src0_sel:WORD_1 src1_sel:WORD_1
    v_add_u32_sdwa v10, v41, v49 dst_sel:DWORD dst_unused:UNUSED_PAD src0_sel:WORD_0 src1_sel:WORD_0
    v_add_u32_sdwa v11, v41, v49 dst_sel:DWORD dst_unused:UNUSED_PAD src0_sel:WORD_1 src1_sel:WORD_1
    v_add_u32_sdwa v12, v42, v50 dst_sel:DWORD dst_unused:UNUSED_PAD src0_sel:WORD_0 src1_sel:WORD_0
    v_add_u32_sdwa v13, v42, v50 dst_sel:DWORD dst_unused:UNUSED_PAD src0_sel:WORD_1 src1_sel:WORD_1
    v_add_u32_sdwa v14, v43, v51 dst_sel:DWORD dst_unused:UNUSED_PAD src0_sel:WORD_0 src1_sel:WORD_0
    v_add_u32_sdwa v15, v43, v51 dst_sel:DWORD dst_unused:UNUSED_PAD src0_sel:WORD_1 src1_sel:WORD_1
    v_min3_u32 v5, v56, v57, v58
    v_bitop3_b32 v4, v56, v57, v58 bitop3:0xfe
    v_min_u32 v5, v5, v59
    v_or_b32 v4, v4, v59
    v_or_b32 v8, 0x4b000000, v8
    v_or_b32 v9, 0x4b000000, v9
    v_or_b32 v10, 0x4b000000, v10
    v_or_b32 v11, 0x4b000000, v11
    v_or_b32 v12, 0x4b000000, v12
    v_or_b32 v13, 0x4b000000, v13
    v_or_b32 v14, 0x4b000000, v14
    v_or_b32 v15, 0x4b000000, v15
    v_cmp_eq_u32 vcc, 0, v5
    v_add_f32 v8, 0xcb010000, v8
    v_add_f32 v9, 0xcb010000, v9
    v_add_f32 v10, 0xcb010000, v10
    v_add_f32 v11, 0xcb010000, v11
    v_add_f32 v12, 0xcb010000, v12
    v_add_f32 v13, 0xcb010000, v13
    v_add_f32 v14, 0xcb010000, v14
    v_add_f32 v15, 0xcb010000, v15
    v_mul_f32 v8, v4, v8
    v_mul_f32 v9, v4, v9
    v_mul_f32 v10, v4, v10
    v_mul_f32 v11, v4, v11
    v_mul_f32 v12, v4, v12
    v_mul_f32 v13, v4, v13
    v_mul_f32 v14, v4, v14
    v_mul_f32 v15, v4, v15
    s_cbranch_vccz p3_nof
    v_lshlrev_b32 v1, 4, v0
    v_mov_b32 v3, 0x70000000
    v_cmp_eq_u32 vcc, 0, v56
    s_mov_b32 s22, 517903360
    s_nop 0
    v_cndmask_b32 v5, v3, v1, vcc
    buffer_load_dwordx4 v[16:19], v5, s[28:31], s22 offen
    buffer_load_dwordx4 v[20:23], v5, s[28:31], s22 offen offset:16
    s_waitcnt vmcnt(0)
    v_add_f32 v8, v8, v16
    v_add_f32 v9, v9, v17
    v_add_f32 v10, v10, v18
    v_add_f32 v11, v11, v19
    v_add_f32 v12, v12, v20
    v_add_f32 v13, v13, v21
    v_add_f32 v14, v14, v22
    v_add_f32 v15, v15, v23
    v_cmp_eq_u32 vcc, 0, v57
    s_mov_b32 s22, 530715648
    s_nop 0
    v_cndmask_b32 v5, v3, v1, vcc
    buffer_load_dwordx4 v[16:19], v5, s[28:31], s22 offen
    buffer_load_dwordx4 v[20:23], v5, s[28:31], s22 offen offset:16
    s_waitcnt vmcnt(0)
    v_add_f32 v8, v8, v16
    v_add_f32 v9, v9, v17
    v_add_f32 v10, v10, v18
    v_add_f32 v11, v11, v19
    v_add_f32 v12, v12, v20
    v_add_f32 v13, v13, v21
    v_add_f32 v14, v14, v22
    v_add_f32 v15, v15, v23
    v_cmp_eq_u32 vcc, 0, v58
    s_mov_b32 s22, 543527936
    s_nop 0
    v_cndmask_b32 v5, v3, v1, vcc
    buffer_load_dwordx4 v[16:19], v5, s[28:31], s22 offen
    buffer_load_dwordx4 v[20:23], v5, s[28:31], s22 offen offset:16
    s_waitcnt vmcnt(0)
    v_add_f32 v8, v8, v16
    v_add_f32 v9, v9, v17
    v_add_f32 v10, v10, v18
    v_add_f32 v11, v11, v19
    v_add_f32 v12, v12, v20
    v_add_f32 v13, v13, v21
    v_add_f32 v14, v14, v22
    v_add_f32 v15, v15, v23
    v_cmp_eq_u32 vcc, 0, v59
    s_mov_b32 s22, 556340224
    s_nop 0
    v_cndmask_b32 v5, v3, v1, vcc
    buffer_load_dwordx4 v[16:19], v5, s[28:31], s22 offen
    buffer_load_dwordx4 v[20:23], v5, s[28:31], s22 offen offset:16
    s_waitcnt vmcnt(0)
    v_add_f32 v8, v8, v16
    v_add_f32 v9, v9, v17
    v_add_f32 v10, v10, v18
    v_add_f32 v11, v11, v19
    v_add_f32 v12, v12, v20
    v_add_f32 v13, v13, v21
    v_add_f32 v14, v14, v22
    v_add_f32 v15, v15, v23
p3_nof:
    s_lshl_b32 s14, s68, 16
    s_and_b32 s15, s68, 0xffff0000
    v_pk_mul_f32 v[16:17], v[8:9], s[14:15] op_sel:[0,0] op_sel_hi:[0,1]
    v_pk_mul_f32 v[20:21], v[12:13], s[14:15] op_sel:[0,0] op_sel_hi:[0,1]
    s_lshl_b32 s16, s69, 16
    s_and_b32 s17, s69, 0xffff0000
    v_pk_mul_f32 v[18:19], v[8:9], s[16:17] op_sel:[0,0] op_sel_hi:[0,1]
    v_pk_mul_f32 v[22:23], v[12:13], s[16:17] op_sel:[0,0] op_sel_hi:[0,1]
    s_lshl_b32 s18, s70, 16
    s_and_b32 s19, s70, 0xffff0000
    v_pk_fma_f32 v[16:17], v[8:9], s[18:19], v[16:17] op_sel:[1,0,0] op_sel_hi:[1,1,1]
    v_pk_fma_f32 v[20:21], v[12:13], s[18:19], v[20:21] op_sel:[1,0,0] op_sel_hi:[1,1,1]
    s_lshl_b32 s12, s71, 16
    s_and_b32 s13, s71, 0xffff0000
    v_pk_fma_f32 v[18:19], v[8:9], s[12:13], v[18:19] op_sel:[1,0,0] op_sel_hi:[1,1,1]
    v_pk_fma_f32 v[22:23], v[12:13], s[12:13], v[22:23] op_sel:[1,0,0] op_sel_hi:[1,1,1]
    s_lshl_b32 s14, s72, 16
    s_and_b32 s15, s72, 0xffff0000
    v_pk_fma_f32 v[16:17], v[10:11], s[14:15], v[16:17] op_sel:[0,0,0] op_sel_hi:[0,1,1]
    v_pk_fma_f32 v[20:21], v[14:15], s[14:15], v[20:21] op_sel:[0,0,0] op_sel_hi:[0,1,1]
    s_lshl_b32 s16, s73, 16
    s_and_b32 s17, s73, 0xffff0000
    v_pk_fma_f32 v[18:19], v[10:11], s[16:17], v[18:19] op_sel:[0,0,0] op_sel_hi:[0,1,1]
    v_pk_fma_f32 v[22:23], v[14:15], s[16:17], v[22:23] op_sel:[0,0,0] op_sel_hi:[0,1,1]
    s_lshl_b32 s18, s74, 16
    s_and_b32 s19, s74, 0xffff0000
    v_pk_fma_f32 v[16:17], v[10:11], s[18:19], v[16:17] op_sel:[1,0,0] op_sel_hi:[1,1,1]
    v_pk_fma_f32 v[20:21], v[14:15], s[18:19], v[20:21] op_sel:[1,0,0] op_sel_hi:[1,1,1]
    s_lshl_b32 s12, s75, 16
    s_and_b32 s13, s75, 0xffff0000
    v_pk_fma_f32 v[18:19], v[10:11], s[12:13], v[18:19] op_sel:[1,0,0] op_sel_hi:[1,1,1]
    v_pk_fma_f32 v[22:23], v[14:15], s[12:13], v[22:23] op_sel:[1,0,0] op_sel_hi:[1,1,1]
    v_mul_f32 v24, v24, v16
    v_mul_f32 v25, v25, v17
    v_mul_f32 v26, v26, v18
    v_mul_f32 v27, v27, v19
    v_mul_f32 v28, v28, v20
    v_mul_f32 v29, v29, v21
    v_mul_f32 v30, v30, v22
    v_mul_f32 v31, v31, v23
    v_cvt_pk_bf16_f32 v24, v24, v25
    v_cvt_pk_bf16_f32 v26, v26, v27
    v_cvt_pk_bf16_f32 v28, v28, v29
    v_cvt_pk_bf16_f32 v30, v30, v31
    v_and_b32 v25, 0xffff0000, v24
    v_lshlrev_b32 v24, 16, v24
    v_and_b32 v27, 0xffff0000, v26
    v_lshlrev_b32 v26, 16, v26
    v_and_b32 v29, 0xffff0000, v28
    v_lshlrev_b32 v28, 16, v28
    v_and_b32 v31, 0xffff0000, v30
    v_lshlrev_b32 v30, 16, v30
    s_lshl_b32 s14, s76, 16
    s_and_b32 s15, s76, 0xffff0000
    v_pk_mul_f32 v[16:17], v[24:25], s[14:15] op_sel:[0,0] op_sel_hi:[0,1]
    v_pk_mul_f32 v[20:21], v[28:29], s[14:15] op_sel:[0,0] op_sel_hi:[0,1]
    s_lshl_b32 s16, s77, 16
    s_and_b32 s17, s77, 0xffff0000
    v_pk_mul_f32 v[18:19], v[24:25], s[16:17] op_sel:[0,0] op_sel_hi:[0,1]
    v_pk_mul_f32 v[22:23], v[28:29], s[16:17] op_sel:[0,0] op_sel_hi:[0,1]
    s_lshl_b32 s18, s78, 16
    s_and_b32 s19, s78, 0xffff0000
    v_pk_fma_f32 v[16:17], v[24:25], s[18:19], v[16:17] op_sel:[1,0,0] op_sel_hi:[1,1,1]
    v_pk_fma_f32 v[20:21], v[28:29], s[18:19], v[20:21] op_sel:[1,0,0] op_sel_hi:[1,1,1]
    s_lshl_b32 s12, s79, 16
    s_and_b32 s13, s79, 0xffff0000
    v_pk_fma_f32 v[18:19], v[24:25], s[12:13], v[18:19] op_sel:[1,0,0] op_sel_hi:[1,1,1]
    v_pk_fma_f32 v[22:23], v[28:29], s[12:13], v[22:23] op_sel:[1,0,0] op_sel_hi:[1,1,1]
    s_lshl_b32 s14, s80, 16
    s_and_b32 s15, s80, 0xffff0000
    v_pk_fma_f32 v[16:17], v[26:27], s[14:15], v[16:17] op_sel:[0,0,0] op_sel_hi:[0,1,1]
    v_pk_fma_f32 v[20:21], v[30:31], s[14:15], v[20:21] op_sel:[0,0,0] op_sel_hi:[0,1,1]
    s_lshl_b32 s16, s81, 16
    s_and_b32 s17, s81, 0xffff0000
    v_pk_fma_f32 v[18:19], v[26:27], s[16:17], v[18:19] op_sel:[0,0,0] op_sel_hi:[0,1,1]
    v_pk_fma_f32 v[22:23], v[30:31], s[16:17], v[22:23] op_sel:[0,0,0] op_sel_hi:[0,1,1]
    s_lshl_b32 s18, s82, 16
    s_and_b32 s19, s82, 0xffff0000
    v_pk_fma_f32 v[16:17], v[26:27], s[18:19], v[16:17] op_sel:[1,0,0] op_sel_hi:[1,1,1]
    v_pk_fma_f32 v[20:21], v[30:31], s[18:19], v[20:21] op_sel:[1,0,0] op_sel_hi:[1,1,1]
    s_lshl_b32 s12, s83, 16
    s_and_b32 s13, s83, 0xffff0000
    v_pk_fma_f32 v[18:19], v[26:27], s[12:13], v[18:19] op_sel:[1,0,0] op_sel_hi:[1,1,1]
    v_pk_fma_f32 v[22:23], v[30:31], s[12:13], v[22:23] op_sel:[1,0,0] op_sel_hi:[1,1,1]
    v_cvt_pk_bf16_f32 v16, v16, v17
    v_cvt_pk_bf16_f32 v18, v18, v19
    v_cvt_pk_bf16_f32 v20, v20, v21
    v_cvt_pk_bf16_f32 v22, v22, v23
    v_and_b32 v17, 0xffff0000, v16
    v_lshlrev_b32 v16, 16, v16
    v_and_b32 v19, 0xffff0000, v18
    v_lshlrev_b32 v18, 16, v18
    v_and_b32 v21, 0xffff0000, v20
    v_lshlrev_b32 v20, 16, v20
    v_and_b32 v23, 0xffff0000, v22
    v_lshlrev_b32 v22, 16, v22
    v_mul_f32 v16, v16, v32
    v_mul_f32 v17, v17, v33
    v_mul_f32 v18, v18, v34
    v_mul_f32 v19, v19, v35
    v_mul_f32 v20, v20, v36
    v_mul_f32 v21, v21, v37
    v_mul_f32 v22, v22, v38
    v_mul_f32 v23, v23, v39
    v_cvt_pk_bf16_f32 v16, v16, v17
    v_cvt_pk_bf16_f32 v18, v18, v19
    v_cvt_pk_bf16_f32 v20, v20, v21
    v_cvt_pk_bf16_f32 v22, v22, v23
    v_and_b32 v17, 0xffff0000, v16
    v_lshlrev_b32 v16, 16, v16
    v_and_b32 v19, 0xffff0000, v18
    v_lshlrev_b32 v18, 16, v18
    v_and_b32 v21, 0xffff0000, v20
    v_lshlrev_b32 v20, 16, v20
    v_and_b32 v23, 0xffff0000, v22
    v_lshlrev_b32 v22, 16, v22
    s_waitcnt vmcnt(0)
    v_lshlrev_b32 v8, 16, v60
    v_and_b32 v9, 0xffff0000, v60
    v_lshlrev_b32 v10, 16, v61
    v_and_b32 v11, 0xffff0000, v61
    v_lshlrev_b32 v12, 16, v62
    v_and_b32 v13, 0xffff0000, v62
    v_lshlrev_b32 v14, 16, v63
    v_and_b32 v15, 0xffff0000, v63
    v_add_f32 v8, v8, v16
    v_add_f32 v9, v9, v17
    v_add_f32 v10, v10, v18
    v_add_f32 v11, v11, v19
    v_add_f32 v12, v12, v20
    v_add_f32 v13, v13, v21
    v_add_f32 v14, v14, v22
    v_add_f32 v15, v15, v23
    v_cvt_pk_bf16_f32 v4, v8, v9
    v_cvt_pk_bf16_f32 v5, v10, v11
    v_cvt_pk_bf16_f32 v6, v12, v13
    v_cvt_pk_bf16_f32 v7, v14, v15
    buffer_store_dwordx4 v[4:7], v2, s[24:27], 0 offen
p3_end:
    s_endpgm
.section .rodata,"a"
.p2align 6
.amdhsa_kernel p1_kernel
  .amdhsa_next_free_vgpr 128
  .amdhsa_next_free_sgpr 72
  .amdhsa_accum_offset 128
  .amdhsa_group_segment_fixed_size 0
  .amdhsa_kernarg_size 112
  .amdhsa_user_sgpr_count 2
  .amdhsa_user_sgpr_kernarg_segment_ptr 1
  .amdhsa_system_sgpr_workgroup_id_x 1
  .amdhsa_float_denorm_mode_32 3
.end_amdhsa_kernel
.p2align 6
.amdhsa_kernel p2_kernel
  .amdhsa_next_free_vgpr 128
  .amdhsa_next_free_sgpr 72
  .amdhsa_accum_offset 128
  .amdhsa_group_segment_fixed_size 0
  .amdhsa_kernarg_size 112
  .amdhsa_user_sgpr_count 2
  .amdhsa_user_sgpr_kernarg_segment_ptr 1
  .amdhsa_system_sgpr_workgroup_id_x 1
  .amdhsa_float_denorm_mode_32 3
.end_amdhsa_kernel
.p2align 6
.amdhsa_kernel p3_kernel
  .amdhsa_next_free_vgpr 64
  .amdhsa_next_free_sgpr 84
  .amdhsa_accum_offset 64
  .amdhsa_group_segment_fixed_size 0
  .amdhsa_kernarg_size 112
  .amdhsa_user_sgpr_count 2
  .amdhsa_user_sgpr_kernarg_segment_ptr 1
  .amdhsa_system_sgpr_workgroup_id_x 1
  .amdhsa_float_denorm_mode_32 3
.end_amdhsa_kernel
```

```asm
; @launch kernel=p1_kernel grid=(256,1,1) block=(1024,1,1) lds=163072
; @launch kernel=p2_kernel grid=(256,1,1) block=(1024,1,1) lds=154368
; @launch kernel=p3_kernel grid=(1563,1,1) block=(256,1,1) lds=0
.amdgcn_target "amdgcn-amd-amdhsa--gfx950"
.text
.globl p1_kernel
.p2align 8
.type p1_kernel,@function
p1_kernel:
    s_cmp_ge_u32 s2, 256
    s_cbranch_scc1 p1_end
    s_load_dwordx2 s[52:53], s[0:1], 0
    s_load_dwordx4 s[56:59], s[0:1], 8
    s_load_dwordx2 s[54:55], s[0:1], 32
    s_load_dwordx2 s[60:61], s[0:1], 48
    s_load_dwordx2 s[48:49], s[0:1], 104
    s_load_dwordx2 s[62:63], s[0:1], 96
    v_lshlrev_b32 v1, 4, v0
    v_lshlrev_b32 v2, 3, v0
    v_mov_b32 v3, 1
    v_lshrrev_b32 v117, 6, v0
    s_nop 0
    v_readfirstlane_b32 s28, v117
    s_waitcnt lgkmcnt(0)
    s_load_dword s45, s[60:61], 0
    s_mov_b32 s24, s52
    s_and_b32 s25, s53, 0xffff
    s_mov_b32 s26, 6400000
    s_mov_b32 s27, 0x20000
    s_mov_b32 s4, s56
    s_and_b32 s5, s57, 0xffff
    s_mov_b32 s6, 204800000
    s_mov_b32 s7, 0x20000
    s_mov_b32 s8, s58
    s_and_b32 s9, s59, 0xffff
    s_mov_b32 s10, 204800000
    s_mov_b32 s11, 0x20000
    s_mov_b32 s12, s54
    s_and_b32 s13, s55, 0xffff
    s_mov_b32 s14, 102400000
    s_mov_b32 s15, 0x20000
    s_mov_b32 s16, s48
    s_and_b32 s17, s49, 0xffff
    s_mov_b32 s18, 819200000
    s_mov_b32 s19, 0x20000
    s_mov_b32 s20, s48
    s_and_b32 s21, s49, 0xffff
    s_mov_b32 s22, 0
    s_mov_b32 s23, 0x20000
    s_mov_b32 s40, s62
    s_and_b32 s41, s63, 0xffff
    s_mov_b32 s42, 256
    s_mov_b32 s43, 0x20000
    s_mov_b32 s36, 643827
    s_mov_b32 s37, 214609
    s_mov_b32 s38, 343268
    s_mov_b32 s39, -6671
    s_mov_b32 s44, -12512
    s_mov_b32 s34, 1
    s_waitcnt lgkmcnt(0)
    s_lshl_b32 s45, s45, 16
    s_mov_b32 s29, s2
    s_mul_i32 s46, s29, 1
    s_min_u32 s47, s29, 1499
    s_add_u32 s46, s46, s47
    s_min_u32 s47, s29, 1462
    s_add_u32 s46, s46, s47
    s_min_u32 s47, s29, 1426
    s_add_u32 s46, s46, s47
    s_min_u32 s47, s29, 1389
    s_add_u32 s46, s46, s47
    s_min_u32 s47, s29, 1352
    s_add_u32 s46, s46, s47
    s_min_u32 s47, s29, 1315
    s_add_u32 s46, s46, s47
    s_min_u32 s47, s29, 1279
    s_add_u32 s46, s46, s47
    s_min_u32 s47, s29, 1242
    s_add_u32 s46, s46, s47
    s_lshl_b32 s30, s46, 14
    s_lshl_b32 s31, s46, 13
    s_add_u32 s32, s30, 0
    buffer_load_dwordx4 v[94:97], v1, s[4:7], s32 offen nt
    buffer_load_dwordx4 v[102:105], v1, s[8:11], s32 offen nt
    s_add_u32 s32, s31, 0
    buffer_load_dwordx2 v[76:77], v2, s[12:15], s32 offen nt
    s_add_u32 s32, s30, 16384
    buffer_load_dwordx4 v[98:101], v1, s[4:7], s32 offen nt
    buffer_load_dwordx4 v[106:109], v1, s[8:11], s32 offen nt
    s_add_u32 s32, s31, 8192
    buffer_load_dwordx2 v[78:79], v2, s[12:15], s32 offen nt
    s_add_u32 s32, s30, 32768
    buffer_load_dwordx4 v[12:15], v1, s[4:7], s32 offen nt
    buffer_load_dwordx4 v[48:51], v1, s[8:11], s32 offen nt
    s_add_u32 s32, s31, 16384
    buffer_load_dwordx2 v[80:81], v2, s[12:15], s32 offen nt
    s_add_u32 s32, s31, 24576
    buffer_load_dwordx2 v[82:83], v2, s[12:15], s32 offen nt
    s_add_u32 s32, s31, 32768
    buffer_load_dwordx2 v[84:85], v2, s[12:15], s32 offen nt
    s_add_u32 s32, s31, 40960
    buffer_load_dwordx2 v[86:87], v2, s[12:15], s32 offen nt
    s_add_u32 s32, s31, 49152
    buffer_load_dwordx2 v[88:89], v2, s[12:15], s32 offen nt
    s_add_u32 s32, s31, 57344
    buffer_load_dwordx2 v[90:91], v2, s[12:15], s32 offen nt
    s_add_u32 s32, s31, 65536
    buffer_load_dwordx2 v[92:93], v2, s[12:15], s32 offen nt
    v_mov_b32 v73, 0x40000000
    v_mov_b32 v122, 0
    v_mov_b32 v123, 0
    v_mov_b32 v124, 0
    v_mov_b32 v125, 0
    ds_write_b128 v1, v[122:125] offset:0
    s_waitcnt lgkmcnt(0)
    s_barrier
p1_tile:
    v_mov_b32 v122, 0
    v_mov_b32 v123, 0
    v_mov_b32 v124, 0
    v_mov_b32 v125, 0
    ds_write_b128 v1, v[122:125] offset:10496
    ds_write_b128 v1, v[122:125] offset:26880
    ds_write_b128 v1, v[122:125] offset:43264
    s_cmp_lg_u32 s28, 15
    s_cbranch_scc1 p1_tk0
    v_mov_b32 v127, 1
    s_mov_b64 exec, 1
    buffer_atomic_add v127, off, s[40:43], 0 offset:128 sc0 sc1
    s_mov_b64 exec, -1
p1_tk0:
    v_mov_b32 v123, s45
    v_mov_b32 v124, 0x007f007f
    v_mov_b32 v125, 0xe000
    v_mov_b32 v126, 0xffff0000
    s_cmp_lt_u32 s29, 1426
    s_cselect_b32 s6, 204800000, 0
    s_cselect_b32 s10, 204800000, 0
    s_add_u32 s32, s30, 49152
    buffer_load_dwordx4 v[16:19], v1, s[4:7], s32 offen nt
    buffer_load_dwordx4 v[52:55], v1, s[8:11], s32 offen nt
    s_waitcnt vmcnt(14)
    v_lshlrev_b32 v117, 16, v76
    v_and_b32 v118, v126, v76
    v_mul_f32 v117, v123, v117
    v_mul_f32 v118, v123, v118
    v_cvt_pk_bf16_f32 v117, v117, v118
    v_and_b32 v118, v126, v117
    v_lshlrev_b32 v117, 16, v117
    v_mul_f32 v117, 0.15915494, v117
    v_mul_f32 v118, 0.15915494, v118
    v_fract_f32 v117, v117
    v_fract_f32 v118, v118
    v_cos_f32 v117, v117
    v_cos_f32 v118, v118
    v_mul_hi_u32_u24 v122, s38, v102
    v_mul_hi_u32_u24 v121, s37, v94
    v_mul_hi_u32_u24 v120, s36, v94
    v_mad_i32_i24 v110, v122, s44, v102
    v_mad_u32_u24 v40, v122, 40, v121
    v_mad_i32_i24 v4, v120, s39, v94
    v_lshlrev_b16 v40, 2, v40
    v_mad_i32_i24 v120, v121, -3, v120
    ds_add_u32 v40, v3 offset:0
    v_lshl_or_b32 v4, v110, 16, v4
    v_lshl_or_b32 v4, v120, 30, v4
    v_mul_f32 v117, 0x03800000, v117
    v_mul_f32 v118, 0x03800000, v118
    v_cvt_pk_bf16_f32 v117, v117, v118
    v_mul_hi_u32_u24 v122, s38, v103
    v_mul_hi_u32_u24 v121, s37, v95
    v_mul_hi_u32_u24 v120, s36, v95
    v_mad_i32_i24 v110, v122, s44, v103
    v_mad_u32_u24 v41, v122, 40, v121
    v_mad_i32_i24 v5, v120, s39, v95
    v_lshlrev_b16 v41, 2, v41
    v_mad_i32_i24 v120, v121, -3, v120
    ds_add_u32 v41, v3 offset:0
    v_lshl_or_b32 v5, v110, 16, v5
    v_lshl_or_b32 v5, v120, 30, v5
    v_lshrrev_b32 v118, 3, v117
    v_lshrrev_b32 v119, 8, v117
    v_lshlrev_b16 v117, 13, v117
    v_bitop3_b32 v119, v118, v119, v124 bitop3:0x1b
    v_bitop3_b32 v4, v117, v125, v4 bitop3:0xae
    v_lshl_or_b32 v40, v119, 16, v40
    v_bitop3_b32 v5, v118, v125, v5 bitop3:0xae
    v_bitop3_b32 v41, v119, v126, v41 bitop3:0xea
    v_lshlrev_b32 v117, 16, v77
    v_and_b32 v118, v126, v77
    v_mul_f32 v117, v123, v117
    v_mul_f32 v118, v123, v118
    v_cvt_pk_bf16_f32 v117, v117, v118
    v_and_b32 v118, v126, v117
    v_lshlrev_b32 v117, 16, v117
    v_mul_f32 v117, 0.15915494, v117
    v_mul_f32 v118, 0.15915494, v118
    v_fract_f32 v117, v117
    v_fract_f32 v118, v118
    v_cos_f32 v117, v117
    v_cos_f32 v118, v118
    v_mul_hi_u32_u24 v122, s38, v104
    v_mul_hi_u32_u24 v121, s37, v96
    v_mul_hi_u32_u24 v120, s36, v96
    v_mad_i32_i24 v110, v122, s44, v104
    v_mad_u32_u24 v42, v122, 40, v121
    v_mad_i32_i24 v6, v120, s39, v96
    v_lshlrev_b16 v42, 2, v42
    v_mad_i32_i24 v120, v121, -3, v120
    ds_add_u32 v42, v3 offset:0
    v_lshl_or_b32 v6, v110, 16, v6
    v_lshl_or_b32 v6, v120, 30, v6
    v_mul_f32 v117, 0x03800000, v117
    v_mul_f32 v118, 0x03800000, v118
    v_cvt_pk_bf16_f32 v117, v117, v118
    v_mul_hi_u32_u24 v122, s38, v105
    v_mul_hi_u32_u24 v121, s37, v97
    v_mul_hi_u32_u24 v120, s36, v97
    v_mad_i32_i24 v110, v122, s44, v105
    v_mad_u32_u24 v43, v122, 40, v121
    v_mad_i32_i24 v7, v120, s39, v97
    v_lshlrev_b16 v43, 2, v43
    v_mad_i32_i24 v120, v121, -3, v120
    ds_add_u32 v43, v3 offset:0
    v_lshl_or_b32 v7, v110, 16, v7
    v_lshl_or_b32 v7, v120, 30, v7
    v_lshrrev_b32 v118, 3, v117
    v_lshrrev_b32 v119, 8, v117
    v_lshlrev_b16 v117, 13, v117
    v_bitop3_b32 v119, v118, v119, v124 bitop3:0x1b
    v_bitop3_b32 v6, v117, v125, v6 bitop3:0xae
    v_lshl_or_b32 v42, v119, 16, v42
    v_bitop3_b32 v7, v118, v125, v7 bitop3:0xae
    v_bitop3_b32 v43, v119, v126, v43 bitop3:0xea
    s_cmp_lt_u32 s29, 1389
    s_cselect_b32 s6, 204800000, 0
    s_cselect_b32 s10, 204800000, 0
    s_add_u32 s32, s30, 65536
    buffer_load_dwordx4 v[20:23], v1, s[4:7], s32 offen nt
    buffer_load_dwordx4 v[56:59], v1, s[8:11], s32 offen nt
    s_cmp_ge_u32 s29, 1499
    s_cbranch_scc1 p1_k2
    s_cmp_lg_u32 s34, 0
    s_cbranch_scc1 p1_w3
    s_waitcnt vmcnt(10)
p1_w3:
    s_waitcnt vmcnt(13)
    v_lshlrev_b32 v117, 16, v78
    v_and_b32 v118, v126, v78
    v_mul_f32 v117, v123, v117
    v_mul_f32 v118, v123, v118
    v_cvt_pk_bf16_f32 v117, v117, v118
    v_and_b32 v118, v126, v117
    v_lshlrev_b32 v117, 16, v117
    v_mul_f32 v117, 0.15915494, v117
    v_mul_f32 v118, 0.15915494, v118
    v_fract_f32 v117, v117
    v_fract_f32 v118, v118
    v_cos_f32 v117, v117
    v_cos_f32 v118, v118
    v_mul_hi_u32_u24 v122, s38, v106
    v_mul_hi_u32_u24 v121, s37, v98
    v_mul_hi_u32_u24 v120, s36, v98
    v_mad_i32_i24 v110, v122, s44, v106
    v_mad_u32_u24 v44, v122, 40, v121
    v_mad_i32_i24 v8, v120, s39, v98
    v_lshlrev_b16 v44, 2, v44
    v_mad_i32_i24 v120, v121, -3, v120
    ds_add_u32 v44, v3 offset:0
    v_lshl_or_b32 v8, v110, 16, v8
    v_lshl_or_b32 v8, v120, 30, v8
    v_mul_f32 v117, 0x03800000, v117
    v_mul_f32 v118, 0x03800000, v118
    v_cvt_pk_bf16_f32 v117, v117, v118
    v_mul_hi_u32_u24 v122, s38, v107
    v_mul_hi_u32_u24 v121, s37, v99
    v_mul_hi_u32_u24 v120, s36, v99
    v_mad_i32_i24 v110, v122, s44, v107
    v_mad_u32_u24 v45, v122, 40, v121
    v_mad_i32_i24 v9, v120, s39, v99
    v_lshlrev_b16 v45, 2, v45
    v_mad_i32_i24 v120, v121, -3, v120
    ds_add_u32 v45, v3 offset:0
    v_lshl_or_b32 v9, v110, 16, v9
    v_lshl_or_b32 v9, v120, 30, v9
    v_lshrrev_b32 v118, 3, v117
    v_lshrrev_b32 v119, 8, v117
    v_lshlrev_b16 v117, 13, v117
    v_bitop3_b32 v119, v118, v119, v124 bitop3:0x1b
    v_bitop3_b32 v8, v117, v125, v8 bitop3:0xae
    v_lshl_or_b32 v44, v119, 16, v44
    v_bitop3_b32 v9, v118, v125, v9 bitop3:0xae
    v_bitop3_b32 v45, v119, v126, v45 bitop3:0xea
    v_lshlrev_b32 v117, 16, v79
    v_and_b32 v118, v126, v79
    v_mul_f32 v117, v123, v117
    v_mul_f32 v118, v123, v118
    v_cvt_pk_bf16_f32 v117, v117, v118
    v_and_b32 v118, v126, v117
    v_lshlrev_b32 v117, 16, v117
    v_mul_f32 v117, 0.15915494, v117
    v_mul_f32 v118, 0.15915494, v118
    v_fract_f32 v117, v117
    v_fract_f32 v118, v118
    v_cos_f32 v117, v117
    v_cos_f32 v118, v118
    v_mul_hi_u32_u24 v122, s38, v108
    v_mul_hi_u32_u24 v121, s37, v100
    v_mul_hi_u32_u24 v120, s36, v100
    v_mad_i32_i24 v110, v122, s44, v108
    v_mad_u32_u24 v46, v122, 40, v121
    v_mad_i32_i24 v10, v120, s39, v100
    v_lshlrev_b16 v46, 2, v46
    v_mad_i32_i24 v120, v121, -3, v120
    ds_add_u32 v46, v3 offset:0
    v_lshl_or_b32 v10, v110, 16, v10
    v_lshl_or_b32 v10, v120, 30, v10
    v_mul_f32 v117, 0x03800000, v117
    v_mul_f32 v118, 0x03800000, v118
    v_cvt_pk_bf16_f32 v117, v117, v118
    v_mul_hi_u32_u24 v122, s38, v109
    v_mul_hi_u32_u24 v121, s37, v101
    v_mul_hi_u32_u24 v120, s36, v101
    v_mad_i32_i24 v110, v122, s44, v109
    v_mad_u32_u24 v47, v122, 40, v121
    v_mad_i32_i24 v11, v120, s39, v101
    v_lshlrev_b16 v47, 2, v47
    v_mad_i32_i24 v120, v121, -3, v120
    ds_add_u32 v47, v3 offset:0
    v_lshl_or_b32 v11, v110, 16, v11
    v_lshl_or_b32 v11, v120, 30, v11
    v_lshrrev_b32 v118, 3, v117
    v_lshrrev_b32 v119, 8, v117
    v_lshlrev_b16 v117, 13, v117
    v_bitop3_b32 v119, v118, v119, v124 bitop3:0x1b
    v_bitop3_b32 v10, v117, v125, v10 bitop3:0xae
    v_lshl_or_b32 v46, v119, 16, v46
    v_bitop3_b32 v11, v118, v125, v11 bitop3:0xae
    v_bitop3_b32 v47, v119, v126, v47 bitop3:0xea
p1_k2:
    s_cmp_lt_u32 s29, 1352
    s_cselect_b32 s6, 204800000, 0
    s_cselect_b32 s10, 204800000, 0
    s_add_u32 s32, s30, 81920
    buffer_load_dwordx4 v[24:27], v1, s[4:7], s32 offen nt
    buffer_load_dwordx4 v[60:63], v1, s[8:11], s32 offen nt
    s_cmp_ge_u32 s29, 1462
    s_cbranch_scc1 p1_k4
    s_cmp_lg_u32 s34, 0
    s_cbranch_scc1 p1_w5
    s_waitcnt vmcnt(6)
p1_w5:
    s_waitcnt vmcnt(11)
    v_lshlrev_b32 v117, 16, v80
    v_and_b32 v118, v126, v80
    v_mul_f32 v117, v123, v117
    v_mul_f32 v118, v123, v118
    v_cvt_pk_bf16_f32 v117, v117, v118
    v_and_b32 v118, v126, v117
    v_lshlrev_b32 v117, 16, v117
    v_mul_f32 v117, 0.15915494, v117
    v_mul_f32 v118, 0.15915494, v118
    v_fract_f32 v117, v117
    v_fract_f32 v118, v118
    v_cos_f32 v117, v117
    v_cos_f32 v118, v118
    v_mul_hi_u32_u24 v122, s38, v48
    v_mul_hi_u32_u24 v121, s37, v12
    v_mul_hi_u32_u24 v120, s36, v12
    v_mad_i32_i24 v110, v122, s44, v48
    v_mad_u32_u24 v48, v122, 40, v121
    v_mad_i32_i24 v12, v120, s39, v12
    v_lshlrev_b16 v48, 2, v48
    v_mad_i32_i24 v120, v121, -3, v120
    ds_add_u32 v48, v3 offset:0
    v_lshl_or_b32 v12, v110, 16, v12
    v_lshl_or_b32 v12, v120, 30, v12
    v_mul_f32 v117, 0x03800000, v117
    v_mul_f32 v118, 0x03800000, v118
    v_cvt_pk_bf16_f32 v117, v117, v118
    v_mul_hi_u32_u24 v122, s38, v49
    v_mul_hi_u32_u24 v121, s37, v13
    v_mul_hi_u32_u24 v120, s36, v13
    v_mad_i32_i24 v110, v122, s44, v49
    v_mad_u32_u24 v49, v122, 40, v121
    v_mad_i32_i24 v13, v120, s39, v13
    v_lshlrev_b16 v49, 2, v49
    v_mad_i32_i24 v120, v121, -3, v120
    ds_add_u32 v49, v3 offset:0
    v_lshl_or_b32 v13, v110, 16, v13
    v_lshl_or_b32 v13, v120, 30, v13
    v_lshrrev_b32 v118, 3, v117
    v_lshrrev_b32 v119, 8, v117
    v_lshlrev_b16 v117, 13, v117
    v_bitop3_b32 v119, v118, v119, v124 bitop3:0x1b
    v_bitop3_b32 v12, v117, v125, v12 bitop3:0xae
    v_lshl_or_b32 v48, v119, 16, v48
    v_bitop3_b32 v13, v118, v125, v13 bitop3:0xae
    v_bitop3_b32 v49, v119, v126, v49 bitop3:0xea
    v_lshlrev_b32 v117, 16, v81
    v_and_b32 v118, v126, v81
    v_mul_f32 v117, v123, v117
    v_mul_f32 v118, v123, v118
    v_cvt_pk_bf16_f32 v117, v117, v118
    v_and_b32 v118, v126, v117
    v_lshlrev_b32 v117, 16, v117
    v_mul_f32 v117, 0.15915494, v117
    v_mul_f32 v118, 0.15915494, v118
    v_fract_f32 v117, v117
    v_fract_f32 v118, v118
    v_cos_f32 v117, v117
    v_cos_f32 v118, v118
    v_mul_hi_u32_u24 v122, s38, v50
    v_mul_hi_u32_u24 v121, s37, v14
    v_mul_hi_u32_u24 v120, s36, v14
    v_mad_i32_i24 v110, v122, s44, v50
    v_mad_u32_u24 v50, v122, 40, v121
    v_mad_i32_i24 v14, v120, s39, v14
    v_lshlrev_b16 v50, 2, v50
    v_mad_i32_i24 v120, v121, -3, v120
    ds_add_u32 v50, v3 offset:0
    v_lshl_or_b32 v14, v110, 16, v14
    v_lshl_or_b32 v14, v120, 30, v14
    v_mul_f32 v117, 0x03800000, v117
    v_mul_f32 v118, 0x03800000, v118
    v_cvt_pk_bf16_f32 v117, v117, v118
    v_mul_hi_u32_u24 v122, s38, v51
    v_mul_hi_u32_u24 v121, s37, v15
    v_mul_hi_u32_u24 v120, s36, v15
    v_mad_i32_i24 v110, v122, s44, v51
    v_mad_u32_u24 v51, v122, 40, v121
    v_mad_i32_i24 v15, v120, s39, v15
    v_lshlrev_b16 v51, 2, v51
    v_mad_i32_i24 v120, v121, -3, v120
    ds_add_u32 v51, v3 offset:0
    v_lshl_or_b32 v15, v110, 16, v15
    v_lshl_or_b32 v15, v120, 30, v15
    v_lshrrev_b32 v118, 3, v117
    v_lshrrev_b32 v119, 8, v117
    v_lshlrev_b16 v117, 13, v117
    v_bitop3_b32 v119, v118, v119, v124 bitop3:0x1b
    v_bitop3_b32 v14, v117, v125, v14 bitop3:0xae
    v_lshl_or_b32 v50, v119, 16, v50
    v_bitop3_b32 v15, v118, v125, v15 bitop3:0xae
    v_bitop3_b32 v51, v119, v126, v51 bitop3:0xea
p1_k4:
    s_cmp_lt_u32 s29, 1315
    s_cselect_b32 s6, 204800000, 0
    s_cselect_b32 s10, 204800000, 0
    s_add_u32 s32, s30, 98304
    buffer_load_dwordx4 v[28:31], v1, s[4:7], s32 offen nt
    buffer_load_dwordx4 v[64:67], v1, s[8:11], s32 offen nt
    s_cmp_ge_u32 s29, 1426
    s_cbranch_scc1 p1_k6
    s_waitcnt vmcnt(6)
    v_lshlrev_b32 v117, 16, v82
    v_and_b32 v118, v126, v82
    v_mul_f32 v117, v123, v117
    v_mul_f32 v118, v123, v118
    v_cvt_pk_bf16_f32 v117, v117, v118
    v_and_b32 v118, v126, v117
    v_lshlrev_b32 v117, 16, v117
    v_mul_f32 v117, 0.15915494, v117
    v_mul_f32 v118, 0.15915494, v118
    v_fract_f32 v117, v117
    v_fract_f32 v118, v118
    v_cos_f32 v117, v117
    v_cos_f32 v118, v118
    v_mul_hi_u32_u24 v122, s38, v52
    v_mul_hi_u32_u24 v121, s37, v16
    v_mul_hi_u32_u24 v120, s36, v16
    v_mad_i32_i24 v110, v122, s44, v52
    v_mad_u32_u24 v52, v122, 40, v121
    v_mad_i32_i24 v16, v120, s39, v16
    v_lshlrev_b16 v52, 2, v52
    v_mad_i32_i24 v120, v121, -3, v120
    ds_add_u32 v52, v3 offset:0
    v_lshl_or_b32 v16, v110, 16, v16
    v_lshl_or_b32 v16, v120, 30, v16
    v_mul_f32 v117, 0x03800000, v117
    v_mul_f32 v118, 0x03800000, v118
    v_cvt_pk_bf16_f32 v117, v117, v118
    v_mul_hi_u32_u24 v122, s38, v53
    v_mul_hi_u32_u24 v121, s37, v17
    v_mul_hi_u32_u24 v120, s36, v17
    v_mad_i32_i24 v110, v122, s44, v53
    v_mad_u32_u24 v53, v122, 40, v121
    v_mad_i32_i24 v17, v120, s39, v17
    v_lshlrev_b16 v53, 2, v53
    v_mad_i32_i24 v120, v121, -3, v120
    ds_add_u32 v53, v3 offset:0
    v_lshl_or_b32 v17, v110, 16, v17
    v_lshl_or_b32 v17, v120, 30, v17
    v_lshrrev_b32 v118, 3, v117
    v_lshrrev_b32 v119, 8, v117
    v_lshlrev_b16 v117, 13, v117
    v_bitop3_b32 v119, v118, v119, v124 bitop3:0x1b
    v_bitop3_b32 v16, v117, v125, v16 bitop3:0xae
    v_lshl_or_b32 v52, v119, 16, v52
    v_bitop3_b32 v17, v118, v125, v17 bitop3:0xae
    v_bitop3_b32 v53, v119, v126, v53 bitop3:0xea
    v_lshlrev_b32 v117, 16, v83
    v_and_b32 v118, v126, v83
    v_mul_f32 v117, v123, v117
    v_mul_f32 v118, v123, v118
    v_cvt_pk_bf16_f32 v117, v117, v118
    v_and_b32 v118, v126, v117
    v_lshlrev_b32 v117, 16, v117
    v_mul_f32 v117, 0.15915494, v117
    v_mul_f32 v118, 0.15915494, v118
    v_fract_f32 v117, v117
    v_fract_f32 v118, v118
    v_cos_f32 v117, v117
    v_cos_f32 v118, v118
    v_mul_hi_u32_u24 v122, s38, v54
    v_mul_hi_u32_u24 v121, s37, v18
    v_mul_hi_u32_u24 v120, s36, v18
    v_mad_i32_i24 v110, v122, s44, v54
    v_mad_u32_u24 v54, v122, 40, v121
    v_mad_i32_i24 v18, v120, s39, v18
    v_lshlrev_b16 v54, 2, v54
    v_mad_i32_i24 v120, v121, -3, v120
    ds_add_u32 v54, v3 offset:0
    v_lshl_or_b32 v18, v110, 16, v18
    v_lshl_or_b32 v18, v120, 30, v18
    v_mul_f32 v117, 0x03800000, v117
    v_mul_f32 v118, 0x03800000, v118
    v_cvt_pk_bf16_f32 v117, v117, v118
    v_mul_hi_u32_u24 v122, s38, v55
    v_mul_hi_u32_u24 v121, s37, v19
    v_mul_hi_u32_u24 v120, s36, v19
    v_mad_i32_i24 v110, v122, s44, v55
    v_mad_u32_u24 v55, v122, 40, v121
    v_mad_i32_i24 v19, v120, s39, v19
    v_lshlrev_b16 v55, 2, v55
    v_mad_i32_i24 v120, v121, -3, v120
    ds_add_u32 v55, v3 offset:0
    v_lshl_or_b32 v19, v110, 16, v19
    v_lshl_or_b32 v19, v120, 30, v19
    v_lshrrev_b32 v118, 3, v117
    v_lshrrev_b32 v119, 8, v117
    v_lshlrev_b16 v117, 13, v117
    v_bitop3_b32 v119, v118, v119, v124 bitop3:0x1b
    v_bitop3_b32 v18, v117, v125, v18 bitop3:0xae
    v_lshl_or_b32 v54, v119, 16, v54
    v_bitop3_b32 v19, v118, v125, v19 bitop3:0xae
    v_bitop3_b32 v55, v119, v126, v55 bitop3:0xea
p1_k6:
    s_cmp_lt_u32 s29, 1279
    s_cselect_b32 s6, 204800000, 0
    s_cselect_b32 s10, 204800000, 0
    s_add_u32 s32, s30, 114688
    buffer_load_dwordx4 v[32:35], v1, s[4:7], s32 offen nt
    buffer_load_dwordx4 v[68:71], v1, s[8:11], s32 offen nt
    s_cmp_ge_u32 s29, 1389
    s_cbranch_scc1 p1_k8
    s_waitcnt vmcnt(6)
    v_lshlrev_b32 v117, 16, v84
    v_and_b32 v118, v126, v84
    v_mul_f32 v117, v123, v117
    v_mul_f32 v118, v123, v118
    v_cvt_pk_bf16_f32 v117, v117, v118
    v_and_b32 v118, v126, v117
    v_lshlrev_b32 v117, 16, v117
    v_mul_f32 v117, 0.15915494, v117
    v_mul_f32 v118, 0.15915494, v118
    v_fract_f32 v117, v117
    v_fract_f32 v118, v118
    v_cos_f32 v117, v117
    v_cos_f32 v118, v118
    v_mul_hi_u32_u24 v122, s38, v56
    v_mul_hi_u32_u24 v121, s37, v20
    v_mul_hi_u32_u24 v120, s36, v20
    v_mad_i32_i24 v110, v122, s44, v56
    v_mad_u32_u24 v56, v122, 40, v121
    v_mad_i32_i24 v20, v120, s39, v20
    v_lshlrev_b16 v56, 2, v56
    v_mad_i32_i24 v120, v121, -3, v120
    ds_add_u32 v56, v3 offset:0
    v_lshl_or_b32 v20, v110, 16, v20
    v_lshl_or_b32 v20, v120, 30, v20
    v_mul_f32 v117, 0x03800000, v117
    v_mul_f32 v118, 0x03800000, v118
    v_cvt_pk_bf16_f32 v117, v117, v118
    v_mul_hi_u32_u24 v122, s38, v57
    v_mul_hi_u32_u24 v121, s37, v21
    v_mul_hi_u32_u24 v120, s36, v21
    v_mad_i32_i24 v110, v122, s44, v57
    v_mad_u32_u24 v57, v122, 40, v121
    v_mad_i32_i24 v21, v120, s39, v21
    v_lshlrev_b16 v57, 2, v57
    v_mad_i32_i24 v120, v121, -3, v120
    ds_add_u32 v57, v3 offset:0
    v_lshl_or_b32 v21, v110, 16, v21
    v_lshl_or_b32 v21, v120, 30, v21
    v_lshrrev_b32 v118, 3, v117
    v_lshrrev_b32 v119, 8, v117
    v_lshlrev_b16 v117, 13, v117
    v_bitop3_b32 v119, v118, v119, v124 bitop3:0x1b
    v_bitop3_b32 v20, v117, v125, v20 bitop3:0xae
    v_lshl_or_b32 v56, v119, 16, v56
    v_bitop3_b32 v21, v118, v125, v21 bitop3:0xae
    v_bitop3_b32 v57, v119, v126, v57 bitop3:0xea
    v_lshlrev_b32 v117, 16, v85
    v_and_b32 v118, v126, v85
    v_mul_f32 v117, v123, v117
    v_mul_f32 v118, v123, v118
    v_cvt_pk_bf16_f32 v117, v117, v118
    v_and_b32 v118, v126, v117
    v_lshlrev_b32 v117, 16, v117
    v_mul_f32 v117, 0.15915494, v117
    v_mul_f32 v118, 0.15915494, v118
    v_fract_f32 v117, v117
    v_fract_f32 v118, v118
    v_cos_f32 v117, v117
    v_cos_f32 v118, v118
    v_mul_hi_u32_u24 v122, s38, v58
    v_mul_hi_u32_u24 v121, s37, v22
    v_mul_hi_u32_u24 v120, s36, v22
    v_mad_i32_i24 v110, v122, s44, v58
    v_mad_u32_u24 v58, v122, 40, v121
    v_mad_i32_i24 v22, v120, s39, v22
    v_lshlrev_b16 v58, 2, v58
    v_mad_i32_i24 v120, v121, -3, v120
    ds_add_u32 v58, v3 offset:0
    v_lshl_or_b32 v22, v110, 16, v22
    v_lshl_or_b32 v22, v120, 30, v22
    v_mul_f32 v117, 0x03800000, v117
    v_mul_f32 v118, 0x03800000, v118
    v_cvt_pk_bf16_f32 v117, v117, v118
    v_mul_hi_u32_u24 v122, s38, v59
    v_mul_hi_u32_u24 v121, s37, v23
    v_mul_hi_u32_u24 v120, s36, v23
    v_mad_i32_i24 v110, v122, s44, v59
    v_mad_u32_u24 v59, v122, 40, v121
    v_mad_i32_i24 v23, v120, s39, v23
    v_lshlrev_b16 v59, 2, v59
    v_mad_i32_i24 v120, v121, -3, v120
    ds_add_u32 v59, v3 offset:0
    v_lshl_or_b32 v23, v110, 16, v23
    v_lshl_or_b32 v23, v120, 30, v23
    v_lshrrev_b32 v118, 3, v117
    v_lshrrev_b32 v119, 8, v117
    v_lshlrev_b16 v117, 13, v117
    v_bitop3_b32 v119, v118, v119, v124 bitop3:0x1b
    v_bitop3_b32 v22, v117, v125, v22 bitop3:0xae
    v_lshl_or_b32 v58, v119, 16, v58
    v_bitop3_b32 v23, v118, v125, v23 bitop3:0xae
    v_bitop3_b32 v59, v119, v126, v59 bitop3:0xea
p1_k8:
    s_cmp_lt_u32 s29, 1242
    s_cselect_b32 s6, 204800000, 0
    s_cselect_b32 s10, 204800000, 0
    s_add_u32 s32, s30, 131072
    buffer_load_dwordx4 v[36:39], v1, s[4:7], s32 offen nt
    buffer_load_dwordx4 v[72:75], v1, s[8:11], s32 offen nt
    s_cmp_ge_u32 s29, 1352
    s_cbranch_scc1 p1_k10
    s_waitcnt vmcnt(6)
    v_lshlrev_b32 v117, 16, v86
    v_and_b32 v118, v126, v86
    v_mul_f32 v117, v123, v117
    v_mul_f32 v118, v123, v118
    v_cvt_pk_bf16_f32 v117, v117, v118
    v_and_b32 v118, v126, v117
    v_lshlrev_b32 v117, 16, v117
    v_mul_f32 v117, 0.15915494, v117
    v_mul_f32 v118, 0.15915494, v118
    v_fract_f32 v117, v117
    v_fract_f32 v118, v118
    v_cos_f32 v117, v117
    v_cos_f32 v118, v118
    v_mul_hi_u32_u24 v122, s38, v60
    v_mul_hi_u32_u24 v121, s37, v24
    v_mul_hi_u32_u24 v120, s36, v24
    v_mad_i32_i24 v110, v122, s44, v60
    v_mad_u32_u24 v60, v122, 40, v121
    v_mad_i32_i24 v24, v120, s39, v24
    v_lshlrev_b16 v60, 2, v60
    v_mad_i32_i24 v120, v121, -3, v120
    ds_add_u32 v60, v3 offset:0
    v_lshl_or_b32 v24, v110, 16, v24
    v_lshl_or_b32 v24, v120, 30, v24
    v_mul_f32 v117, 0x03800000, v117
    v_mul_f32 v118, 0x03800000, v118
    v_cvt_pk_bf16_f32 v117, v117, v118
    v_mul_hi_u32_u24 v122, s38, v61
    v_mul_hi_u32_u24 v121, s37, v25
    v_mul_hi_u32_u24 v120, s36, v25
    v_mad_i32_i24 v110, v122, s44, v61
    v_mad_u32_u24 v61, v122, 40, v121
    v_mad_i32_i24 v25, v120, s39, v25
    v_lshlrev_b16 v61, 2, v61
    v_mad_i32_i24 v120, v121, -3, v120
    ds_add_u32 v61, v3 offset:0
    v_lshl_or_b32 v25, v110, 16, v25
    v_lshl_or_b32 v25, v120, 30, v25
    v_lshrrev_b32 v118, 3, v117
    v_lshrrev_b32 v119, 8, v117
    v_lshlrev_b16 v117, 13, v117
    v_bitop3_b32 v119, v118, v119, v124 bitop3:0x1b
    v_bitop3_b32 v24, v117, v125, v24 bitop3:0xae
    v_lshl_or_b32 v60, v119, 16, v60
    v_bitop3_b32 v25, v118, v125, v25 bitop3:0xae
    v_bitop3_b32 v61, v119, v126, v61 bitop3:0xea
    v_lshlrev_b32 v117, 16, v87
    v_and_b32 v118, v126, v87
    v_mul_f32 v117, v123, v117
    v_mul_f32 v118, v123, v118
    v_cvt_pk_bf16_f32 v117, v117, v118
    v_and_b32 v118, v126, v117
    v_lshlrev_b32 v117, 16, v117
    v_mul_f32 v117, 0.15915494, v117
    v_mul_f32 v118, 0.15915494, v118
    v_fract_f32 v117, v117
    v_fract_f32 v118, v118
    v_cos_f32 v117, v117
    v_cos_f32 v118, v118
    v_mul_hi_u32_u24 v122, s38, v62
    v_mul_hi_u32_u24 v121, s37, v26
    v_mul_hi_u32_u24 v120, s36, v26
    v_mad_i32_i24 v110, v122, s44, v62
    v_mad_u32_u24 v62, v122, 40, v121
    v_mad_i32_i24 v26, v120, s39, v26
    v_lshlrev_b16 v62, 2, v62
    v_mad_i32_i24 v120, v121, -3, v120
    ds_add_u32 v62, v3 offset:0
    v_lshl_or_b32 v26, v110, 16, v26
    v_lshl_or_b32 v26, v120, 30, v26
    v_mul_f32 v117, 0x03800000, v117
    v_mul_f32 v118, 0x03800000, v118
    v_cvt_pk_bf16_f32 v117, v117, v118
    v_mul_hi_u32_u24 v122, s38, v63
    v_mul_hi_u32_u24 v121, s37, v27
    v_mul_hi_u32_u24 v120, s36, v27
    v_mad_i32_i24 v110, v122, s44, v63
    v_mad_u32_u24 v63, v122, 40, v121
    v_mad_i32_i24 v27, v120, s39, v27
    v_lshlrev_b16 v63, 2, v63
    v_mad_i32_i24 v120, v121, -3, v120
    ds_add_u32 v63, v3 offset:0
    v_lshl_or_b32 v27, v110, 16, v27
    v_lshl_or_b32 v27, v120, 30, v27
    v_lshrrev_b32 v118, 3, v117
    v_lshrrev_b32 v119, 8, v117
    v_lshlrev_b16 v117, 13, v117
    v_bitop3_b32 v119, v118, v119, v124 bitop3:0x1b
    v_bitop3_b32 v26, v117, v125, v26 bitop3:0xae
    v_lshl_or_b32 v62, v119, 16, v62
    v_bitop3_b32 v27, v118, v125, v27 bitop3:0xae
    v_bitop3_b32 v63, v119, v126, v63 bitop3:0xea
p1_k10:
    s_cmp_ge_u32 s29, 1315
    s_cbranch_scc1 p1_k12
    s_waitcnt vmcnt(4)
    v_lshlrev_b32 v117, 16, v88
    v_and_b32 v118, v126, v88
    v_mul_f32 v117, v123, v117
    v_mul_f32 v118, v123, v118
    v_cvt_pk_bf16_f32 v117, v117, v118
    v_and_b32 v118, v126, v117
    v_lshlrev_b32 v117, 16, v117
    v_mul_f32 v117, 0.15915494, v117
    v_mul_f32 v118, 0.15915494, v118
    v_fract_f32 v117, v117
    v_fract_f32 v118, v118
    v_cos_f32 v117, v117
    v_cos_f32 v118, v118
    v_mul_hi_u32_u24 v122, s38, v64
    v_mul_hi_u32_u24 v121, s37, v28
    v_mul_hi_u32_u24 v120, s36, v28
    v_mad_i32_i24 v110, v122, s44, v64
    v_mad_u32_u24 v64, v122, 40, v121
    v_mad_i32_i24 v28, v120, s39, v28
    v_lshlrev_b16 v64, 2, v64
    v_mad_i32_i24 v120, v121, -3, v120
    ds_add_u32 v64, v3 offset:0
    v_lshl_or_b32 v28, v110, 16, v28
    v_lshl_or_b32 v28, v120, 30, v28
    v_mul_f32 v117, 0x03800000, v117
    v_mul_f32 v118, 0x03800000, v118
    v_cvt_pk_bf16_f32 v117, v117, v118
    v_mul_hi_u32_u24 v122, s38, v65
    v_mul_hi_u32_u24 v121, s37, v29
    v_mul_hi_u32_u24 v120, s36, v29
    v_mad_i32_i24 v110, v122, s44, v65
    v_mad_u32_u24 v65, v122, 40, v121
    v_mad_i32_i24 v29, v120, s39, v29
    v_lshlrev_b16 v65, 2, v65
    v_mad_i32_i24 v120, v121, -3, v120
    ds_add_u32 v65, v3 offset:0
    v_lshl_or_b32 v29, v110, 16, v29
    v_lshl_or_b32 v29, v120, 30, v29
    v_lshrrev_b32 v118, 3, v117
    v_lshrrev_b32 v119, 8, v117
    v_lshlrev_b16 v117, 13, v117
    v_bitop3_b32 v119, v118, v119, v124 bitop3:0x1b
    v_bitop3_b32 v28, v117, v125, v28 bitop3:0xae
    v_lshl_or_b32 v64, v119, 16, v64
    v_bitop3_b32 v29, v118, v125, v29 bitop3:0xae
    v_bitop3_b32 v65, v119, v126, v65 bitop3:0xea
    v_lshlrev_b32 v117, 16, v89
    v_and_b32 v118, v126, v89
    v_mul_f32 v117, v123, v117
    v_mul_f32 v118, v123, v118
    v_cvt_pk_bf16_f32 v117, v117, v118
    v_and_b32 v118, v126, v117
    v_lshlrev_b32 v117, 16, v117
    v_mul_f32 v117, 0.15915494, v117
    v_mul_f32 v118, 0.15915494, v118
    v_fract_f32 v117, v117
    v_fract_f32 v118, v118
    v_cos_f32 v117, v117
    v_cos_f32 v118, v118
    v_mul_hi_u32_u24 v122, s38, v66
    v_mul_hi_u32_u24 v121, s37, v30
    v_mul_hi_u32_u24 v120, s36, v30
    v_mad_i32_i24 v110, v122, s44, v66
    v_mad_u32_u24 v66, v122, 40, v121
    v_mad_i32_i24 v30, v120, s39, v30
    v_lshlrev_b16 v66, 2, v66
    v_mad_i32_i24 v120, v121, -3, v120
    ds_add_u32 v66, v3 offset:0
    v_lshl_or_b32 v30, v110, 16, v30
    v_lshl_or_b32 v30, v120, 30, v30
    v_mul_f32 v117, 0x03800000, v117
    v_mul_f32 v118, 0x03800000, v118
    v_cvt_pk_bf16_f32 v117, v117, v118
    v_mul_hi_u32_u24 v122, s38, v67
    v_mul_hi_u32_u24 v121, s37, v31
    v_mul_hi_u32_u24 v120, s36, v31
    v_mad_i32_i24 v110, v122, s44, v67
    v_mad_u32_u24 v67, v122, 40, v121
    v_mad_i32_i24 v31, v120, s39, v31
    v_lshlrev_b16 v67, 2, v67
    v_mad_i32_i24 v120, v121, -3, v120
    ds_add_u32 v67, v3 offset:0
    v_lshl_or_b32 v31, v110, 16, v31
    v_lshl_or_b32 v31, v120, 30, v31
    v_lshrrev_b32 v118, 3, v117
    v_lshrrev_b32 v119, 8, v117
    v_lshlrev_b16 v117, 13, v117
    v_bitop3_b32 v119, v118, v119, v124 bitop3:0x1b
    v_bitop3_b32 v30, v117, v125, v30 bitop3:0xae
    v_lshl_or_b32 v66, v119, 16, v66
    v_bitop3_b32 v31, v118, v125, v31 bitop3:0xae
    v_bitop3_b32 v67, v119, v126, v67 bitop3:0xea
p1_k12:
    s_cmp_ge_u32 s29, 1279
    s_cbranch_scc1 p1_k14
    s_waitcnt vmcnt(2)
    v_lshlrev_b32 v117, 16, v90
    v_and_b32 v118, v126, v90
    v_mul_f32 v117, v123, v117
    v_mul_f32 v118, v123, v118
    v_cvt_pk_bf16_f32 v117, v117, v118
    v_and_b32 v118, v126, v117
    v_lshlrev_b32 v117, 16, v117
    v_mul_f32 v117, 0.15915494, v117
    v_mul_f32 v118, 0.15915494, v118
    v_fract_f32 v117, v117
    v_fract_f32 v118, v118
    v_cos_f32 v117, v117
    v_cos_f32 v118, v118
    v_mul_hi_u32_u24 v122, s38, v68
    v_mul_hi_u32_u24 v121, s37, v32
    v_mul_hi_u32_u24 v120, s36, v32
    v_mad_i32_i24 v110, v122, s44, v68
    v_mad_u32_u24 v68, v122, 40, v121
    v_mad_i32_i24 v32, v120, s39, v32
    v_lshlrev_b16 v68, 2, v68
    v_mad_i32_i24 v120, v121, -3, v120
    ds_add_u32 v68, v3 offset:0
    v_lshl_or_b32 v32, v110, 16, v32
    v_lshl_or_b32 v32, v120, 30, v32
    v_mul_f32 v117, 0x03800000, v117
    v_mul_f32 v118, 0x03800000, v118
    v_cvt_pk_bf16_f32 v117, v117, v118
    v_mul_hi_u32_u24 v122, s38, v69
    v_mul_hi_u32_u24 v121, s37, v33
    v_mul_hi_u32_u24 v120, s36, v33
    v_mad_i32_i24 v110, v122, s44, v69
    v_mad_u32_u24 v69, v122, 40, v121
    v_mad_i32_i24 v33, v120, s39, v33
    v_lshlrev_b16 v69, 2, v69
    v_mad_i32_i24 v120, v121, -3, v120
    ds_add_u32 v69, v3 offset:0
    v_lshl_or_b32 v33, v110, 16, v33
    v_lshl_or_b32 v33, v120, 30, v33
    v_lshrrev_b32 v118, 3, v117
    v_lshrrev_b32 v119, 8, v117
    v_lshlrev_b16 v117, 13, v117
    v_bitop3_b32 v119, v118, v119, v124 bitop3:0x1b
    v_bitop3_b32 v32, v117, v125, v32 bitop3:0xae
    v_lshl_or_b32 v68, v119, 16, v68
    v_bitop3_b32 v33, v118, v125, v33 bitop3:0xae
    v_bitop3_b32 v69, v119, v126, v69 bitop3:0xea
    v_lshlrev_b32 v117, 16, v91
    v_and_b32 v118, v126, v91
    v_mul_f32 v117, v123, v117
    v_mul_f32 v118, v123, v118
    v_cvt_pk_bf16_f32 v117, v117, v118
    v_and_b32 v118, v126, v117
    v_lshlrev_b32 v117, 16, v117
    v_mul_f32 v117, 0.15915494, v117
    v_mul_f32 v118, 0.15915494, v118
    v_fract_f32 v117, v117
    v_fract_f32 v118, v118
    v_cos_f32 v117, v117
    v_cos_f32 v118, v118
    v_mul_hi_u32_u24 v122, s38, v70
    v_mul_hi_u32_u24 v121, s37, v34
    v_mul_hi_u32_u24 v120, s36, v34
    v_mad_i32_i24 v110, v122, s44, v70
    v_mad_u32_u24 v70, v122, 40, v121
    v_mad_i32_i24 v34, v120, s39, v34
    v_lshlrev_b16 v70, 2, v70
    v_mad_i32_i24 v120, v121, -3, v120
    ds_add_u32 v70, v3 offset:0
    v_lshl_or_b32 v34, v110, 16, v34
    v_lshl_or_b32 v34, v120, 30, v34
    v_mul_f32 v117, 0x03800000, v117
    v_mul_f32 v118, 0x03800000, v118
    v_cvt_pk_bf16_f32 v117, v117, v118
    v_mul_hi_u32_u24 v122, s38, v71
    v_mul_hi_u32_u24 v121, s37, v35
    v_mul_hi_u32_u24 v120, s36, v35
    v_mad_i32_i24 v110, v122, s44, v71
    v_mad_u32_u24 v71, v122, 40, v121
    v_mad_i32_i24 v35, v120, s39, v35
    v_lshlrev_b16 v71, 2, v71
    v_mad_i32_i24 v120, v121, -3, v120
    ds_add_u32 v71, v3 offset:0
    v_lshl_or_b32 v35, v110, 16, v35
    v_lshl_or_b32 v35, v120, 30, v35
    v_lshrrev_b32 v118, 3, v117
    v_lshrrev_b32 v119, 8, v117
    v_lshlrev_b16 v117, 13, v117
    v_bitop3_b32 v119, v118, v119, v124 bitop3:0x1b
    v_bitop3_b32 v34, v117, v125, v34 bitop3:0xae
    v_lshl_or_b32 v70, v119, 16, v70
    v_bitop3_b32 v35, v118, v125, v35 bitop3:0xae
    v_bitop3_b32 v71, v119, v126, v71 bitop3:0xea
p1_k14:
    s_cmp_ge_u32 s29, 1242
    s_cbranch_scc1 p1_k16
    s_waitcnt vmcnt(0)
    v_lshlrev_b32 v117, 16, v92
    v_and_b32 v118, v126, v92
    v_mul_f32 v117, v123, v117
    v_mul_f32 v118, v123, v118
    v_cvt_pk_bf16_f32 v117, v117, v118
    v_and_b32 v118, v126, v117
    v_lshlrev_b32 v117, 16, v117
    v_mul_f32 v117, 0.15915494, v117
    v_mul_f32 v118, 0.15915494, v118
    v_fract_f32 v117, v117
    v_fract_f32 v118, v118
    v_cos_f32 v117, v117
    v_cos_f32 v118, v118
    v_mul_hi_u32_u24 v122, s38, v72
    v_mul_hi_u32_u24 v121, s37, v36
    v_mul_hi_u32_u24 v120, s36, v36
    v_mad_i32_i24 v110, v122, s44, v72
    v_mad_u32_u24 v72, v122, 40, v121
    v_mad_i32_i24 v36, v120, s39, v36
    v_lshlrev_b16 v72, 2, v72
    v_mad_i32_i24 v120, v121, -3, v120
    ds_add_u32 v72, v3 offset:0
    v_lshl_or_b32 v36, v110, 16, v36
    v_lshl_or_b32 v36, v120, 30, v36
    v_mul_f32 v117, 0x03800000, v117
    v_mul_f32 v118, 0x03800000, v118
    v_cvt_pk_bf16_f32 v117, v117, v118
    v_mul_hi_u32_u24 v122, s38, v73
    v_mul_hi_u32_u24 v121, s37, v37
    v_mul_hi_u32_u24 v120, s36, v37
    v_mad_i32_i24 v110, v122, s44, v73
    v_mad_u32_u24 v73, v122, 40, v121
    v_mad_i32_i24 v37, v120, s39, v37
    v_lshlrev_b16 v73, 2, v73
    v_mad_i32_i24 v120, v121, -3, v120
    ds_add_u32 v73, v3 offset:0
    v_lshl_or_b32 v37, v110, 16, v37
    v_lshl_or_b32 v37, v120, 30, v37
    v_lshrrev_b32 v118, 3, v117
    v_lshrrev_b32 v119, 8, v117
    v_lshlrev_b16 v117, 13, v117
    v_bitop3_b32 v119, v118, v119, v124 bitop3:0x1b
    v_bitop3_b32 v36, v117, v125, v36 bitop3:0xae
    v_lshl_or_b32 v72, v119, 16, v72
    v_bitop3_b32 v37, v118, v125, v37 bitop3:0xae
    v_bitop3_b32 v73, v119, v126, v73 bitop3:0xea
    v_lshlrev_b32 v117, 16, v93
    v_and_b32 v118, v126, v93
    v_mul_f32 v117, v123, v117
    v_mul_f32 v118, v123, v118
    v_cvt_pk_bf16_f32 v117, v117, v118
    v_and_b32 v118, v126, v117
    v_lshlrev_b32 v117, 16, v117
    v_mul_f32 v117, 0.15915494, v117
    v_mul_f32 v118, 0.15915494, v118
    v_fract_f32 v117, v117
    v_fract_f32 v118, v118
    v_cos_f32 v117, v117
    v_cos_f32 v118, v118
    v_mul_hi_u32_u24 v122, s38, v74
    v_mul_hi_u32_u24 v121, s37, v38
    v_mul_hi_u32_u24 v120, s36, v38
    v_mad_i32_i24 v110, v122, s44, v74
    v_mad_u32_u24 v74, v122, 40, v121
    v_mad_i32_i24 v38, v120, s39, v38
    v_lshlrev_b16 v74, 2, v74
    v_mad_i32_i24 v120, v121, -3, v120
    ds_add_u32 v74, v3 offset:0
    v_lshl_or_b32 v38, v110, 16, v38
    v_lshl_or_b32 v38, v120, 30, v38
    v_mul_f32 v117, 0x03800000, v117
    v_mul_f32 v118, 0x03800000, v118
    v_cvt_pk_bf16_f32 v117, v117, v118
    v_mul_hi_u32_u24 v122, s38, v75
    v_mul_hi_u32_u24 v121, s37, v39
    v_mul_hi_u32_u24 v120, s36, v39
    v_mad_i32_i24 v110, v122, s44, v75
    v_mad_u32_u24 v75, v122, 40, v121
    v_mad_i32_i24 v39, v120, s39, v39
    v_lshlrev_b16 v75, 2, v75
    v_mad_i32_i24 v120, v121, -3, v120
    ds_add_u32 v75, v3 offset:0
    v_lshl_or_b32 v39, v110, 16, v39
    v_lshl_or_b32 v39, v120, 30, v39
    v_lshrrev_b32 v118, 3, v117
    v_lshrrev_b32 v119, 8, v117
    v_lshlrev_b16 v117, 13, v117
    v_bitop3_b32 v119, v118, v119, v124 bitop3:0x1b
    v_bitop3_b32 v38, v117, v125, v38 bitop3:0xae
    v_lshl_or_b32 v74, v119, 16, v74
    v_bitop3_b32 v39, v118, v125, v39 bitop3:0xae
    v_bitop3_b32 v75, v119, v126, v75 bitop3:0xea
p1_k16:
    s_waitcnt vmcnt(0)
    s_cmp_lg_u32 s28, 15
    s_cbranch_scc1 p1_tk1
    v_mov_b32 v126, 0
    s_mov_b64 exec, 1
    ds_write_b32 v126, v127 offset:10456
    s_mov_b64 exec, -1
p1_tk1:
    s_waitcnt lgkmcnt(0)
    s_barrier
    s_cmp_ge_u32 s28, 10
    s_cbranch_scc1 p1_s1_skip
    v_and_b32 v126, 63, v0
    s_lshl_b32 s54, s28, 4
    v_mul_u32_u24 v117, 160, v126
    v_add_u32 v117, s54, v117
    ds_read_b128 v[118:121], v117 offset:0
    s_waitcnt lgkmcnt(0)
    v_add_u32 v118, 2, v118
    v_add_u32 v119, 2, v119
    v_add_u32 v120, 2, v120
    v_add_u32 v121, 2, v121
    v_mul_u32_u24 v118, 43691, v118
    v_mul_u32_u24 v119, 43691, v119
    v_mul_u32_u24 v120, 43691, v120
    v_mul_u32_u24 v121, 43691, v121
    v_lshrrev_b32 v118, 17, v118
    v_lshrrev_b32 v119, 17, v119
    v_lshrrev_b32 v120, 17, v120
    v_lshrrev_b32 v121, 17, v121
    v_lshl_or_b32 v122, v119, 16, v118
    v_lshl_or_b32 v123, v121, 16, v120
    v_mov_b32 v124, v122
    v_mov_b32 v125, v123
    s_nop 1
    v_add_u32_dpp v124, v124, v124 row_shr:1 row_mask:0xf bank_mask:0xf bound_ctrl:0
    v_add_u32_dpp v125, v125, v125 row_shr:1 row_mask:0xf bank_mask:0xf bound_ctrl:0
    s_nop 0
    v_add_u32_dpp v124, v124, v124 row_shr:2 row_mask:0xf bank_mask:0xf bound_ctrl:0
    v_add_u32_dpp v125, v125, v125 row_shr:2 row_mask:0xf bank_mask:0xf bound_ctrl:0
    s_nop 0
    v_add_u32_dpp v124, v124, v124 row_shr:4 row_mask:0xf bank_mask:0xf bound_ctrl:0
    v_add_u32_dpp v125, v125, v125 row_shr:4 row_mask:0xf bank_mask:0xf bound_ctrl:0
    s_nop 0
    v_add_u32_dpp v124, v124, v124 row_shr:8 row_mask:0xf bank_mask:0xf bound_ctrl:0
    v_add_u32_dpp v125, v125, v125 row_shr:8 row_mask:0xf bank_mask:0xf bound_ctrl:0
    s_nop 0
    v_add_u32_dpp v124, v124, v124 row_bcast:15 row_mask:0xa bank_mask:0xf
    v_add_u32_dpp v125, v125, v125 row_bcast:15 row_mask:0xa bank_mask:0xf
    s_nop 0
    v_add_u32_dpp v124, v124, v124 row_bcast:31 row_mask:0xc bank_mask:0xf
    v_add_u32_dpp v125, v125, v125 row_bcast:31 row_mask:0xc bank_mask:0xf
    s_nop 0
    s_nop 0
    v_mov_b32 v127, s54
    v_and_b32 v118, 0xffff, v124
    v_lshrrev_b32 v119, 16, v124
    v_and_b32 v120, 0xffff, v125
    v_lshrrev_b32 v121, 16, v125
    s_mov_b64 exec, 1
    s_lshl_b64 exec, exec, 63
    ds_write_b128 v127, v[118:121] offset:10240
    s_mov_b64 exec, -1
p1_s1_skip:
    s_waitcnt lgkmcnt(0)
    s_barrier
    v_and_b32 v127, 63, v0
    v_lshlrev_b32 v118, 2, v127
    v_cmp_gt_u32 vcc, 40, v127
    ds_read_b32 v119, v118 offset:10240
    s_waitcnt lgkmcnt(0)
    v_readlane_b32 s33, v119, 54
    v_cndmask_b32 v119, 0, v119, vcc
    v_mov_b32 v120, v119
    s_nop 1
    v_add_u32_dpp v120, v120, v120 row_shr:1 row_mask:0xf bank_mask:0xf bound_ctrl:0
    s_nop 1
    v_add_u32_dpp v120, v120, v120 row_shr:2 row_mask:0xf bank_mask:0xf bound_ctrl:0
    s_nop 1
    v_add_u32_dpp v120, v120, v120 row_shr:4 row_mask:0xf bank_mask:0xf bound_ctrl:0
    s_nop 1
    v_add_u32_dpp v120, v120, v120 row_shr:8 row_mask:0xf bank_mask:0xf bound_ctrl:0
    s_nop 1
    v_add_u32_dpp v120, v120, v120 row_bcast:15 row_mask:0xa bank_mask:0xf
    s_nop 1
    v_add_u32_dpp v120, v120, v120 row_bcast:31 row_mask:0xc bank_mask:0xf
    s_nop 1
    s_nop 0
    v_sub_u32 v119, v120, v119
    v_readlane_b32 s35, v120, 63
    s_add_u32 s33, s33, 256
    s_mul_i32 s46, s33, 1
    s_min_u32 s47, s33, 1499
    s_add_u32 s46, s46, s47
    s_min_u32 s47, s33, 1462
    s_add_u32 s46, s46, s47
    s_min_u32 s47, s33, 1426
    s_add_u32 s46, s46, s47
    s_min_u32 s47, s33, 1389
    s_add_u32 s46, s46, s47
    s_min_u32 s47, s33, 1352
    s_add_u32 s46, s46, s47
    s_min_u32 s47, s33, 1315
    s_add_u32 s46, s46, s47
    s_min_u32 s47, s33, 1279
    s_add_u32 s46, s46, s47
    s_min_u32 s47, s33, 1242
    s_add_u32 s46, s46, s47
    s_lshl_b32 s30, s46, 14
    s_lshl_b32 s31, s46, 13
    s_cmp_ge_u32 s28, 10
    s_cbranch_scc1 p1_s2_skip
    s_lshl_b32 s54, s28, 2
    s_add_u32 s55, s54, 0
    v_readlane_b32 s56, v119, s55
    s_add_u32 s55, s54, 1
    v_readlane_b32 s57, v119, s55
    s_add_u32 s55, s54, 2
    v_readlane_b32 s58, v119, s55
    s_add_u32 s55, s54, 3
    v_readlane_b32 s59, v119, s55
    s_nop 0
    s_lshl_b32 s57, s57, 16
    s_or_b32 s56, s56, s57
    s_lshl_b32 s59, s59, 16
    s_or_b32 s58, s58, s59
    v_add_u32 v124, s56, v124
    v_add_u32 v125, s58, v125
    v_sub_u32 v122, v124, v122
    v_sub_u32 v123, v125, v123
    v_and_b32 v118, 0xffff, v122
    v_lshrrev_b32 v119, 16, v122
    v_and_b32 v120, 0xffff, v123
    v_lshrrev_b32 v121, 16, v123
    v_mul_u32_u24 v118, 3, v118
    v_mul_u32_u24 v119, 3, v119
    v_mul_u32_u24 v120, 3, v120
    v_mul_u32_u24 v121, 3, v121
    ds_write_b128 v117, v[118:121] offset:0
    s_mul_i32 s55, s29, 5248
    s_mul_i32 s56, s28, 520
    s_add_u32 s55, s55, s56
    s_add_u32 s55, s55, 469762048
    v_lshlrev_b32 v127, 3, v126
    buffer_store_dwordx2 v[122:123], v127, s[16:19], s55 offen sc1
    s_mov_b64 exec, 1
    s_lshl_b64 exec, exec, 63
    buffer_store_dwordx2 v[124:125], v127, s[16:19], s55 offen offset:8 sc1
    s_mov_b64 exec, -1
p1_s2_skip:
    s_mul_i32 s50, s29, 16384
    s_lshr_b32 s52, s35, 10
    s_mul_i32 s52, s52, 33554432
    s_and_b32 s53, s35, 1023
    s_lshl_b32 s53, s53, 4
    s_add_u32 s52, s52, s53
    s_add_u32 s52, s52, s50
    s_min_u32 s22, s52, 469762048
    s_mov_b32 s68, 0
    s_cmp_lt_u32 s29, 1242
    s_cselect_b32 s35, 13994, s35
    s_waitcnt lgkmcnt(0)
    s_barrier
    s_cmp_lt_u32 s33, 1536
    s_cbranch_scc1 p1_f0
    s_cmp_lg_u32 s28, 15
    s_cbranch_scc1 p1_hv0
    s_sub_u32 s52, s33, 1536
    s_and_b32 s52, s52, 255
    s_lshl_b32 s58, s52, 2
    s_and_b32 s58, s58, 28
    s_lshl_b32 s53, 1, s58
    v_mov_b32 v127, s53
    s_lshr_b32 s52, s52, 3
    s_lshl_b32 s52, s52, 2
    s_mov_b64 exec, 1
    buffer_atomic_add v127, off, s[40:43], s52 sc0 sc1
    s_mov_b64 exec, -1
p1_hv0:
    s_cmp_ge_u32 s33, 1656
    s_cbranch_scc1 p1_f0
    s_sub_u32 s52, s33, 1536
    s_mul_i32 s52, s52, 53368
    s_mul_i32 s53, s28, 3072
    s_add_u32 s53, s53, s52
    v_and_b32 v92, 63, v0
    v_lshl_add_u32 v93, v92, 2, s53
    s_lshl_b32 s53, s28, 9
    s_add_u32 s53, s53, s52
    s_add_u32 s53, s53, 49152
    s_cmp_lt_u32 s28, 9
    s_cselect_b32 s53, s53, 0x40000000
    v_lshl_add_u32 v94, v92, 2, s53
    buffer_load_dword v76, v93, s[24:27], 0 offen offset:0
    buffer_load_dword v77, v93, s[24:27], 0 offen offset:256
    buffer_load_dword v78, v93, s[24:27], 0 offen offset:512
    buffer_load_dword v79, v93, s[24:27], 0 offen offset:768
    buffer_load_dword v80, v93, s[24:27], 0 offen offset:1024
    buffer_load_dword v81, v93, s[24:27], 0 offen offset:1280
    buffer_load_dword v82, v93, s[24:27], 0 offen offset:1536
    buffer_load_dword v83, v93, s[24:27], 0 offen offset:1792
    buffer_load_dword v84, v93, s[24:27], 0 offen offset:2048
    buffer_load_dword v85, v93, s[24:27], 0 offen offset:2304
    buffer_load_dword v86, v93, s[24:27], 0 offen offset:2560
    buffer_load_dword v87, v93, s[24:27], 0 offen offset:2816
    buffer_load_dword v88, v94, s[24:27], 0 offen offset:0
    buffer_load_dword v89, v94, s[24:27], 0 offen offset:256
p1_f0:
    v_and_b32 v117, 0xffff, v40
    ds_add_rtn_u32 v117, v117, v3 offset:0
    v_and_b32 v118, 0xffff, v41
    ds_add_rtn_u32 v118, v118, v3 offset:0
    v_and_b32 v119, 0xffff, v42
    ds_add_rtn_u32 v119, v119, v3 offset:0
    v_and_b32 v120, 0xffff, v43
    ds_add_rtn_u32 v120, v120, v3 offset:0
    s_cmp_ge_u32 s33, 1536
    s_cbranch_scc1 p1_k18
    s_cmp_lt_u32 s33, 1536
    s_cselect_b32 s14, 102400000, 0
    s_add_u32 s32, s31, 0
    buffer_load_dwordx2 v[76:77], v2, s[12:15], s32 offen nt
p1_k18:
    s_cmp_ge_u32 s33, 1536
    s_cbranch_scc1 p1_k19
    s_cmp_lt_u32 s33, 1536
    s_cselect_b32 s6, 204800000, 0
    s_cselect_b32 s10, 204800000, 0
    s_add_u32 s32, s30, 0
    buffer_load_dwordx4 v[94:97], v1, s[4:7], s32 offen nt
    buffer_load_dwordx4 v[102:105], v1, s[8:11], s32 offen nt
p1_k19:
    s_cmp_lt_u32 s29, 1499
    s_cbranch_scc1 p1_pa0
    s_waitcnt lgkmcnt(0)
    s_branch p1_pb0
p1_pa0:
    v_and_b32 v121, 0xffff, v44
    ds_add_rtn_u32 v121, v121, v3 offset:0
    v_and_b32 v122, 0xffff, v45
    ds_add_rtn_u32 v122, v122, v3 offset:0
    v_and_b32 v123, 0xffff, v46
    ds_add_rtn_u32 v123, v123, v3 offset:0
    v_and_b32 v124, 0xffff, v47
    ds_add_rtn_u32 v124, v124, v3 offset:0
    s_waitcnt lgkmcnt(4)
p1_pb0:
    ds_write_b8_d16_hi v117, v40 offset:10496
    v_lshlrev_b32 v40, 2, v117
    ds_write_b32 v40, v4 offset:52480
    ds_write_b8_d16_hi v118, v41 offset:10496
    v_lshlrev_b32 v41, 2, v118
    ds_write_b32 v41, v5 offset:52480
    ds_write_b8_d16_hi v119, v42 offset:10496
    v_lshlrev_b32 v42, 2, v119
    ds_write_b32 v42, v6 offset:52480
    ds_write_b8_d16_hi v120, v43 offset:10496
    v_lshlrev_b32 v43, 2, v120
    ds_write_b32 v43, v7 offset:52480
    s_cmp_ge_u32 s33, 1536
    s_cbranch_scc1 p1_k20
    s_cmp_lt_u32 s33, 1499
    s_cselect_b32 s14, 102400000, 0
    s_add_u32 s32, s31, 8192
    buffer_load_dwordx2 v[78:79], v2, s[12:15], s32 offen nt
p1_k20:
    s_cmp_lt_u32 s29, 1462
    s_cbranch_scc1 p1_pa1
    s_waitcnt lgkmcnt(0)
    s_branch p1_pb1
p1_pa1:
    v_and_b32 v117, 0xffff, v48
    ds_add_rtn_u32 v117, v117, v3 offset:0
    v_and_b32 v118, 0xffff, v49
    ds_add_rtn_u32 v118, v118, v3 offset:0
    v_and_b32 v119, 0xffff, v50
    ds_add_rtn_u32 v119, v119, v3 offset:0
    v_and_b32 v120, 0xffff, v51
    ds_add_rtn_u32 v120, v120, v3 offset:0
    s_waitcnt lgkmcnt(4)
p1_pb1:
    s_cmp_ge_u32 s29, 1499
    s_cbranch_scc1 p1_k21
    ds_write_b8_d16_hi v121, v44 offset:10496
    v_lshlrev_b32 v44, 2, v121
    ds_write_b32 v44, v8 offset:52480
    ds_write_b8_d16_hi v122, v45 offset:10496
    v_lshlrev_b32 v45, 2, v122
    ds_write_b32 v45, v9 offset:52480
    ds_write_b8_d16_hi v123, v46 offset:10496
    v_lshlrev_b32 v46, 2, v123
    ds_write_b32 v46, v10 offset:52480
    ds_write_b8_d16_hi v124, v47 offset:10496
    v_lshlrev_b32 v47, 2, v124
    ds_write_b32 v47, v11 offset:52480
p1_k21:
    s_cmp_ge_u32 s33, 1536
    s_cbranch_scc1 p1_k22
    s_cmp_lt_u32 s33, 1462
    s_cselect_b32 s14, 102400000, 0
    s_add_u32 s32, s31, 16384
    buffer_load_dwordx2 v[80:81], v2, s[12:15], s32 offen nt
p1_k22:
    s_cmp_lt_u32 s29, 1426
    s_cbranch_scc1 p1_pa2
    s_waitcnt lgkmcnt(0)
    s_branch p1_pb2
p1_pa2:
    v_and_b32 v121, 0xffff, v52
    ds_add_rtn_u32 v121, v121, v3 offset:0
    v_and_b32 v122, 0xffff, v53
    ds_add_rtn_u32 v122, v122, v3 offset:0
    v_and_b32 v123, 0xffff, v54
    ds_add_rtn_u32 v123, v123, v3 offset:0
    v_and_b32 v124, 0xffff, v55
    ds_add_rtn_u32 v124, v124, v3 offset:0
    s_waitcnt lgkmcnt(4)
p1_pb2:
    s_cmp_ge_u32 s29, 1462
    s_cbranch_scc1 p1_k23
    ds_write_b8_d16_hi v117, v48 offset:10496
    v_lshlrev_b32 v48, 2, v117
    ds_write_b32 v48, v12 offset:52480
    ds_write_b8_d16_hi v118, v49 offset:10496
    v_lshlrev_b32 v49, 2, v118
    ds_write_b32 v49, v13 offset:52480
    ds_write_b8_d16_hi v119, v50 offset:10496
    v_lshlrev_b32 v50, 2, v119
    ds_write_b32 v50, v14 offset:52480
    ds_write_b8_d16_hi v120, v51 offset:10496
    v_lshlrev_b32 v51, 2, v120
    ds_write_b32 v51, v15 offset:52480
p1_k23:
    s_cmp_ge_u32 s28, 10
    s_cbranch_scc1 p1_jn
    s_cmp_lt_u32 s33, 1536
    s_cbranch_scc1 p1_w24
    s_waitcnt vmcnt(0)
p1_w24:
    s_waitcnt vmcnt(5)
    v_mov_b32 v125, 0
    s_mov_b64 exec, 1
    ds_add_rtn_u32 v125, v125, v3 offset:10432
    s_waitcnt lgkmcnt(0)
    v_readfirstlane_b32 s52, v125
    s_lshr_b32 s53, s29, 1
    s_and_b32 s53, s53, 28
    s_cmp_lg_u32 s52, 9
    s_cbranch_scc1 p1_jn1
    s_lshl_b32 s54, 1, s53
    v_mov_b32 v127, s54
    s_lshr_b32 s54, s29, 6
    s_lshl_b32 s54, s54, 2
    s_mov_b32 s68, 1
    buffer_atomic_add v127, off, s[40:43], s54 sc0 sc1
p1_jn1:
    s_mov_b64 exec, -1
p1_jn:
    s_cmp_ge_u32 s33, 1536
    s_cbranch_scc1 p1_k25
    s_cmp_lt_u32 s33, 1426
    s_cselect_b32 s14, 102400000, 0
    s_add_u32 s32, s31, 24576
    buffer_load_dwordx2 v[82:83], v2, s[12:15], s32 offen nt
p1_k25:
    s_cmp_lt_u32 s29, 1389
    s_cbranch_scc1 p1_pa3
    s_waitcnt lgkmcnt(0)
    s_branch p1_pb3
p1_pa3:
    v_and_b32 v117, 0xffff, v56
    ds_add_rtn_u32 v117, v117, v3 offset:0
    v_and_b32 v118, 0xffff, v57
    ds_add_rtn_u32 v118, v118, v3 offset:0
    v_and_b32 v119, 0xffff, v58
    ds_add_rtn_u32 v119, v119, v3 offset:0
    v_and_b32 v120, 0xffff, v59
    ds_add_rtn_u32 v120, v120, v3 offset:0
    s_waitcnt lgkmcnt(4)
p1_pb3:
    s_cmp_ge_u32 s29, 1426
    s_cbranch_scc1 p1_k26
    ds_write_b8_d16_hi v121, v52 offset:10496
    v_lshlrev_b32 v52, 2, v121
    ds_write_b32 v52, v16 offset:52480
    ds_write_b8_d16_hi v122, v53 offset:10496
    v_lshlrev_b32 v53, 2, v122
    ds_write_b32 v53, v17 offset:52480
    ds_write_b8_d16_hi v123, v54 offset:10496
    v_lshlrev_b32 v54, 2, v123
    ds_write_b32 v54, v18 offset:52480
    ds_write_b8_d16_hi v124, v55 offset:10496
    v_lshlrev_b32 v55, 2, v124
    ds_write_b32 v55, v19 offset:52480
p1_k26:
    s_cmp_ge_u32 s33, 1536
    s_cbranch_scc1 p1_k27
    s_cmp_lt_u32 s33, 1389
    s_cselect_b32 s14, 102400000, 0
    s_add_u32 s32, s31, 32768
    buffer_load_dwordx2 v[84:85], v2, s[12:15], s32 offen nt
p1_k27:
    s_cmp_ge_u32 s33, 1536
    s_cbranch_scc1 p1_k28
    s_cmp_lt_u32 s33, 1499
    s_cselect_b32 s6, 204800000, 0
    s_cselect_b32 s10, 204800000, 0
    s_add_u32 s32, s30, 16384
    buffer_load_dwordx4 v[98:101], v1, s[4:7], s32 offen nt
    buffer_load_dwordx4 v[106:109], v1, s[8:11], s32 offen nt
p1_k28:
    s_cmp_lt_u32 s29, 1352
    s_cbranch_scc1 p1_pa4
    s_waitcnt lgkmcnt(0)
    s_branch p1_pb4
p1_pa4:
    v_and_b32 v121, 0xffff, v60
    ds_add_rtn_u32 v121, v121, v3 offset:0
    v_and_b32 v122, 0xffff, v61
    ds_add_rtn_u32 v122, v122, v3 offset:0
    v_and_b32 v123, 0xffff, v62
    ds_add_rtn_u32 v123, v123, v3 offset:0
    v_and_b32 v124, 0xffff, v63
    ds_add_rtn_u32 v124, v124, v3 offset:0
    s_waitcnt lgkmcnt(4)
p1_pb4:
    s_cmp_ge_u32 s29, 1389
    s_cbranch_scc1 p1_k29
    ds_write_b8_d16_hi v117, v56 offset:10496
    v_lshlrev_b32 v56, 2, v117
    ds_write_b32 v56, v20 offset:52480
    ds_write_b8_d16_hi v118, v57 offset:10496
    v_lshlrev_b32 v57, 2, v118
    ds_write_b32 v57, v21 offset:52480
    ds_write_b8_d16_hi v119, v58 offset:10496
    v_lshlrev_b32 v58, 2, v119
    ds_write_b32 v58, v22 offset:52480
    ds_write_b8_d16_hi v120, v59 offset:10496
    v_lshlrev_b32 v59, 2, v120
    ds_write_b32 v59, v23 offset:52480
p1_k29:
    s_cmp_ge_u32 s33, 1536
    s_cbranch_scc1 p1_k30
    s_cmp_lt_u32 s33, 1352
    s_cselect_b32 s14, 102400000, 0
    s_add_u32 s32, s31, 40960
    buffer_load_dwordx2 v[86:87], v2, s[12:15], s32 offen nt
p1_k30:
    s_cmp_lt_u32 s29, 1315
    s_cbranch_scc1 p1_pa5
    s_waitcnt lgkmcnt(0)
    s_branch p1_pb5
p1_pa5:
    v_and_b32 v117, 0xffff, v64
    ds_add_rtn_u32 v117, v117, v3 offset:0
    v_and_b32 v118, 0xffff, v65
    ds_add_rtn_u32 v118, v118, v3 offset:0
    v_and_b32 v119, 0xffff, v66
    ds_add_rtn_u32 v119, v119, v3 offset:0
    v_and_b32 v120, 0xffff, v67
    ds_add_rtn_u32 v120, v120, v3 offset:0
    s_waitcnt lgkmcnt(4)
p1_pb5:
    s_cmp_ge_u32 s29, 1352
    s_cbranch_scc1 p1_k31
    ds_write_b8_d16_hi v121, v60 offset:10496
    v_lshlrev_b32 v60, 2, v121
    ds_write_b32 v60, v24 offset:52480
    ds_write_b8_d16_hi v122, v61 offset:10496
    v_lshlrev_b32 v61, 2, v122
    ds_write_b32 v61, v25 offset:52480
    ds_write_b8_d16_hi v123, v62 offset:10496
    v_lshlrev_b32 v62, 2, v123
    ds_write_b32 v62, v26 offset:52480
    ds_write_b8_d16_hi v124, v63 offset:10496
    v_lshlrev_b32 v63, 2, v124
    ds_write_b32 v63, v27 offset:52480
p1_k31:
    s_cmp_ge_u32 s33, 1536
    s_cbranch_scc1 p1_k32
    s_cmp_lt_u32 s33, 1315
    s_cselect_b32 s14, 102400000, 0
    s_add_u32 s32, s31, 49152
    buffer_load_dwordx2 v[88:89], v2, s[12:15], s32 offen nt
p1_k32:
    s_cmp_lt_u32 s29, 1279
    s_cbranch_scc1 p1_pa6
    s_waitcnt lgkmcnt(0)
    s_branch p1_pb6
p1_pa6:
    v_and_b32 v121, 0xffff, v68
    ds_add_rtn_u32 v121, v121, v3 offset:0
    v_and_b32 v122, 0xffff, v69
    ds_add_rtn_u32 v122, v122, v3 offset:0
    v_and_b32 v123, 0xffff, v70
    ds_add_rtn_u32 v123, v123, v3 offset:0
    v_and_b32 v124, 0xffff, v71
    ds_add_rtn_u32 v124, v124, v3 offset:0
    s_waitcnt lgkmcnt(4)
p1_pb6:
    s_cmp_ge_u32 s29, 1315
    s_cbranch_scc1 p1_k33
    ds_write_b8_d16_hi v117, v64 offset:10496
    v_lshlrev_b32 v64, 2, v117
    ds_write_b32 v64, v28 offset:52480
    ds_write_b8_d16_hi v118, v65 offset:10496
    v_lshlrev_b32 v65, 2, v118
    ds_write_b32 v65, v29 offset:52480
    ds_write_b8_d16_hi v119, v66 offset:10496
    v_lshlrev_b32 v66, 2, v119
    ds_write_b32 v66, v30 offset:52480
    ds_write_b8_d16_hi v120, v67 offset:10496
    v_lshlrev_b32 v67, 2, v120
    ds_write_b32 v67, v31 offset:52480
p1_k33:
    s_cmp_ge_u32 s33, 1536
    s_cbranch_scc1 p1_k34
    s_cmp_lt_u32 s33, 1279
    s_cselect_b32 s14, 102400000, 0
    s_add_u32 s32, s31, 57344
    buffer_load_dwordx2 v[90:91], v2, s[12:15], s32 offen nt
p1_k34:
    s_cmp_lt_u32 s29, 1242
    s_cbranch_scc1 p1_pa7
    s_waitcnt lgkmcnt(0)
    s_branch p1_pb7
p1_pa7:
    v_and_b32 v117, 0xffff, v72
    ds_add_rtn_u32 v117, v117, v3 offset:0
    v_and_b32 v118, 0xffff, v73
    ds_add_rtn_u32 v118, v118, v3 offset:0
    v_and_b32 v119, 0xffff, v74
    ds_add_rtn_u32 v119, v119, v3 offset:0
    v_and_b32 v120, 0xffff, v75
    ds_add_rtn_u32 v120, v120, v3 offset:0
    s_waitcnt lgkmcnt(4)
p1_pb7:
    s_cmp_ge_u32 s29, 1279
    s_cbranch_scc1 p1_k35
    ds_write_b8_d16_hi v121, v68 offset:10496
    v_lshlrev_b32 v68, 2, v121
    ds_write_b32 v68, v32 offset:52480
    ds_write_b8_d16_hi v122, v69 offset:10496
    v_lshlrev_b32 v69, 2, v122
    ds_write_b32 v69, v33 offset:52480
    ds_write_b8_d16_hi v123, v70 offset:10496
    v_lshlrev_b32 v70, 2, v123
    ds_write_b32 v70, v34 offset:52480
    ds_write_b8_d16_hi v124, v71 offset:10496
    v_lshlrev_b32 v71, 2, v124
    ds_write_b32 v71, v35 offset:52480
p1_k35:
    s_cmp_ge_u32 s33, 1536
    s_cbranch_scc1 p1_k36
    s_cmp_lt_u32 s33, 1242
    s_cselect_b32 s14, 102400000, 0
    s_add_u32 s32, s31, 65536
    buffer_load_dwordx2 v[92:93], v2, s[12:15], s32 offen nt
p1_k36:
    s_waitcnt lgkmcnt(0)
    s_cmp_ge_u32 s29, 1242
    s_cbranch_scc1 p1_k37
    ds_write_b8_d16_hi v117, v72 offset:10496
    v_lshlrev_b32 v72, 2, v117
    ds_write_b32 v72, v36 offset:52480
    ds_write_b8_d16_hi v118, v73 offset:10496
    v_lshlrev_b32 v73, 2, v118
    ds_write_b32 v73, v37 offset:52480
    ds_write_b8_d16_hi v119, v74 offset:10496
    v_lshlrev_b32 v74, 2, v119
    ds_write_b32 v74, v38 offset:52480
    ds_write_b8_d16_hi v120, v75 offset:10496
    v_lshlrev_b32 v75, 2, v120
    ds_write_b32 v75, v39 offset:52480
p1_k37:
    s_cmp_eq_u32 s68, 0
    s_cbranch_scc1 p1_sg
    s_cmp_lt_u32 s33, 1536
    s_cbranch_scc1 p1_w38
    s_waitcnt vmcnt(0)
p1_w38:
    s_waitcnt vmcnt(8)
    v_bfe_u32 v127, v127, s53, 4
    v_mov_b32 v125, 0
    s_mov_b64 exec, 1
    ds_write_b32 v125, v127 offset:10452
    s_mov_b64 exec, -1
p1_sg:
    s_cmp_lt_u32 s33, 1536
    s_cbranch_scc1 p1_f1
    s_cmp_lg_u32 s28, 15
    s_cbranch_scc1 p1_hv1
    s_waitcnt vmcnt(0)
    v_bfe_u32 v127, v127, s58, 4
    v_mov_b32 v125, 0
    s_mov_b64 exec, 1
    ds_write_b32 v125, v127 offset:10448
    s_mov_b64 exec, -1
p1_hv1:
    s_cmp_ge_u32 s33, 1656
    s_cbranch_scc1 p1_f1
    s_sub_u32 s52, s33, 1536
    s_mul_i32 s53, s52, 53760
    s_add_u32 s53, s53, 485810176
    s_mul_i32 s54, s28, 3072
    v_lshl_add_u32 v93, v92, 4, s54
    s_lshl_b32 s54, s28, 9
    s_add_u32 s54, s54, 49152
    s_cmp_lt_u32 s28, 9
    s_cselect_b32 s54, s54, 0x40000000
    v_lshl_add_u32 v94, v92, 3, s54
    v_mov_b32 v96, 0
    v_mov_b32 v97, 0
    s_waitcnt vmcnt(0)
    buffer_store_dwordx4 v[76:79], v93, s[16:19], s53 offen offset:0
    buffer_store_dwordx4 v[80:83], v93, s[16:19], s53 offen offset:1024
    buffer_store_dwordx4 v[84:87], v93, s[16:19], s53 offen offset:2048
    buffer_store_dwordx2 v[88:89], v94, s[16:19], s53 offen
    v_and_b32 v98, 0x7fff7fff, v76
    v_pk_max_u16 v96, v96, v98
    v_lshlrev_b32 v99, 16, v98
    v_and_b32 v98, 0xffff0000, v98
    v_fmac_f32 v97, v99, v99
    v_fmac_f32 v97, v98, v98
    v_and_b32 v98, 0x7fff7fff, v77
    v_pk_max_u16 v96, v96, v98
    v_lshlrev_b32 v99, 16, v98
    v_and_b32 v98, 0xffff0000, v98
    v_fmac_f32 v97, v99, v99
    v_fmac_f32 v97, v98, v98
    v_and_b32 v98, 0x7fff7fff, v78
    v_pk_max_u16 v96, v96, v98
    v_lshlrev_b32 v99, 16, v98
    v_and_b32 v98, 0xffff0000, v98
    v_fmac_f32 v97, v99, v99
    v_fmac_f32 v97, v98, v98
    v_and_b32 v98, 0x7fff7fff, v79
    v_pk_max_u16 v96, v96, v98
    v_lshlrev_b32 v99, 16, v98
    v_and_b32 v98, 0xffff0000, v98
    v_fmac_f32 v97, v99, v99
    v_fmac_f32 v97, v98, v98
    v_and_b32 v98, 0x7fff7fff, v80
    v_pk_max_u16 v96, v96, v98
    v_lshlrev_b32 v99, 16, v98
    v_and_b32 v98, 0xffff0000, v98
    v_fmac_f32 v97, v99, v99
    v_fmac_f32 v97, v98, v98
    v_and_b32 v98, 0x7fff7fff, v81
    v_pk_max_u16 v96, v96, v98
    v_lshlrev_b32 v99, 16, v98
    v_and_b32 v98, 0xffff0000, v98
    v_fmac_f32 v97, v99, v99
    v_fmac_f32 v97, v98, v98
    v_and_b32 v98, 0x7fff7fff, v82
    v_pk_max_u16 v96, v96, v98
    v_lshlrev_b32 v99, 16, v98
    v_and_b32 v98, 0xffff0000, v98
    v_fmac_f32 v97, v99, v99
    v_fmac_f32 v97, v98, v98
    v_and_b32 v98, 0x7fff7fff, v83
    v_pk_max_u16 v96, v96, v98
    v_lshlrev_b32 v99, 16, v98
    v_and_b32 v98, 0xffff0000, v98
    v_fmac_f32 v97, v99, v99
    v_fmac_f32 v97, v98, v98
    v_and_b32 v98, 0x7fff7fff, v84
    v_pk_max_u16 v96, v96, v98
    v_lshlrev_b32 v99, 16, v98
    v_and_b32 v98, 0xffff0000, v98
    v_fmac_f32 v97, v99, v99
    v_fmac_f32 v97, v98, v98
    v_and_b32 v98, 0x7fff7fff, v85
    v_pk_max_u16 v96, v96, v98
    v_lshlrev_b32 v99, 16, v98
    v_and_b32 v98, 0xffff0000, v98
    v_fmac_f32 v97, v99, v99
    v_fmac_f32 v97, v98, v98
    v_and_b32 v98, 0x7fff7fff, v86
    v_pk_max_u16 v96, v96, v98
    v_lshlrev_b32 v99, 16, v98
    v_and_b32 v98, 0xffff0000, v98
    v_fmac_f32 v97, v99, v99
    v_fmac_f32 v97, v98, v98
    v_and_b32 v98, 0x7fff7fff, v87
    v_pk_max_u16 v96, v96, v98
    v_lshlrev_b32 v99, 16, v98
    v_and_b32 v98, 0xffff0000, v98
    v_fmac_f32 v97, v99, v99
    v_fmac_f32 v97, v98, v98
    v_and_b32 v98, 0x7fff7fff, v88
    v_pk_max_u16 v96, v96, v98
    v_lshlrev_b32 v99, 16, v98
    v_and_b32 v98, 0xffff0000, v98
    v_fmac_f32 v97, v99, v99
    v_fmac_f32 v97, v98, v98
    v_and_b32 v98, 0x7fff7fff, v89
    v_pk_max_u16 v96, v96, v98
    v_lshlrev_b32 v99, 16, v98
    v_and_b32 v98, 0xffff0000, v98
    v_fmac_f32 v97, v99, v99
    v_fmac_f32 v97, v98, v98
    v_lshrrev_b32 v98, 16, v96
    v_and_b32 v96, 0xffff, v96
    v_max_u32 v96, v96, v98
    s_nop 1
    v_max_u32_dpp v96, v96, v96 row_shr:1 row_mask:0xf bank_mask:0xf bound_ctrl:0
    v_add_f32_dpp v97, v97, v97 row_shr:1 row_mask:0xf bank_mask:0xf bound_ctrl:0
    s_nop 0
    v_max_u32_dpp v96, v96, v96 row_shr:2 row_mask:0xf bank_mask:0xf bound_ctrl:0
    v_add_f32_dpp v97, v97, v97 row_shr:2 row_mask:0xf bank_mask:0xf bound_ctrl:0
    s_nop 0
    v_max_u32_dpp v96, v96, v96 row_shr:4 row_mask:0xf bank_mask:0xf bound_ctrl:0
    v_add_f32_dpp v97, v97, v97 row_shr:4 row_mask:0xf bank_mask:0xf bound_ctrl:0
    s_nop 0
    v_max_u32_dpp v96, v96, v96 row_shr:8 row_mask:0xf bank_mask:0xf bound_ctrl:0
    v_add_f32_dpp v97, v97, v97 row_shr:8 row_mask:0xf bank_mask:0xf bound_ctrl:0
    s_nop 0
    v_max_u32_dpp v96, v96, v96 row_bcast:15 row_mask:0xa bank_mask:0xf
    v_add_f32_dpp v97, v97, v97 row_bcast:15 row_mask:0xa bank_mask:0xf
    s_nop 0
    v_max_u32_dpp v96, v96, v96 row_bcast:31 row_mask:0xc bank_mask:0xf
    v_add_f32_dpp v97, v97, v97 row_bcast:31 row_mask:0xc bank_mask:0xf
    s_nop 0
    s_nop 0
    s_lshl_b32 s52, s52, 4
    s_add_u32 s52, s52, s28
    s_lshl_b32 s52, s52, 3
    s_add_u32 s52, s52, 492261376
    s_mov_b64 exec, 1
    s_lshl_b64 exec, exec, 63
    buffer_store_dwordx2 v[96:97], off, s[16:19], s52
    s_mov_b64 exec, -1
p1_f1:
    s_waitcnt lgkmcnt(0)
    s_barrier
    v_mul_u32_u24 v119, 3, v0
    v_and_b32 v118, -4, v119
    v_add_u32 v120, s50, v1
    v_mov_b32 v122, 0
    v_mov_b32 v123, 0
    v_mov_b32 v124, 0
    v_mov_b32 v125, 0
    ds_read_b64 v[126:127], v122 offset:10448
    ds_write_b32 v122, v122 offset:10432
    v_cmp_gt_u32 vcc, 640, v0
    s_and_saveexec_b64 s[52:53], vcc
    ds_write_b128 v1, v[122:125] offset:0
    s_mov_b64 exec, -1
    s_waitcnt lgkmcnt(2)
    v_readfirstlane_b32 s70, v126
    v_readfirstlane_b32 s69, v127
    s_cmp_ge_u32 s33, 1536
    s_cselect_b32 s70, s70, 0
    s_cmp_gt_u32 s28, 10
    s_cselect_b32 s69, 0, s69
    s_cselect_b32 s70, 0, s70
    s_cmp_lg_u32 s70, 8
    s_cbranch_scc1 p1_h0
    s_sub_u32 s52, s33, 1536
    v_and_b32 v102, 63, v0
    s_cmp_eq_u32 s28, 10
    s_cbranch_scc1 p1_tr10
    s_mul_i32 s53, s28, 520
    v_lshl_add_u32 v100, v102, 3, s53
    s_mul_i32 s53, s28, 4160
    v_lshl_add_u32 v101, v102, 4, s53
    s_branch p1_tr20
p1_tr10:
    v_mul_u32_u24 v100, 520, v102
    v_add_u32 v100, 512, v100
    v_mul_u32_u24 v101, 4160, v102
    v_add_u32 v101, 1024, v101
    v_cmp_gt_u32 vcc, 10, v102
    v_mov_b32 v102, 0x40000000
    s_nop 0
    v_cndmask_b32 v100, v102, v100, vcc
    v_cndmask_b32 v101, v102, v101, vcc
p1_tr20:
    s_mul_i32 s52, s52, 41984
    s_add_u32 s52, s52, 469762048
    buffer_load_dwordx2 v[76:77], v100, s[16:19], s52 offen sc1
    s_add_u32 s52, s52, 5248
    buffer_load_dwordx2 v[78:79], v100, s[16:19], s52 offen sc1
    s_add_u32 s52, s52, 5248
    buffer_load_dwordx2 v[80:81], v100, s[16:19], s52 offen sc1
    s_add_u32 s52, s52, 5248
    buffer_load_dwordx2 v[82:83], v100, s[16:19], s52 offen sc1
    s_add_u32 s52, s52, 5248
    buffer_load_dwordx2 v[84:85], v100, s[16:19], s52 offen sc1
    s_add_u32 s52, s52, 5248
    buffer_load_dwordx2 v[86:87], v100, s[16:19], s52 offen sc1
    s_add_u32 s52, s52, 5248
    buffer_load_dwordx2 v[88:89], v100, s[16:19], s52 offen sc1
    s_add_u32 s52, s52, 5248
    buffer_load_dwordx2 v[90:91], v100, s[16:19], s52 offen sc1
    s_add_u32 s52, s52, 5248
p1_h0:
    v_lshlrev_b32 v117, 2, v119
    v_add_u32 v117, 52480, v117
    ds_read_b32 v110, v117 offset:0
    ds_read_b32 v111, v117 offset:4
    ds_read_b32 v112, v117 offset:8
    ds_read_b32 v113, v118 offset:10496
    ds_read_b32 v114, v118 offset:10500
    ds_read_b32 v122, v117 offset:12288
    ds_read_b32 v123, v117 offset:12292
    ds_read_b32 v124, v117 offset:12296
    ds_read_b32 v125, v118 offset:13568
    ds_read_b32 v121, v118 offset:13572
    s_waitcnt lgkmcnt(5)
    v_alignbyte_b32 v113, v114, v113, v119
    buffer_store_dwordx4 v[110:113], v120, s[20:23], 0 offen
    v_add_u32 v120, 33554432, v120
    s_nop 0
    ds_read_b32 v110, v117 offset:24576
    ds_read_b32 v111, v117 offset:24580
    ds_read_b32 v112, v117 offset:24584
    ds_read_b32 v113, v118 offset:16640
    ds_read_b32 v114, v118 offset:16644
    s_cmp_le_u32 s35, 1024
    s_cbranch_scc1 p1_ce0
    s_waitcnt lgkmcnt(5)
    v_alignbyte_b32 v125, v121, v125, v119
    buffer_store_dwordx4 v[122:125], v120, s[20:23], 0 offen
    v_add_u32 v120, 33554432, v120
    s_nop 0
    ds_read_b32 v122, v117 offset:36864
    ds_read_b32 v123, v117 offset:36868
    ds_read_b32 v124, v117 offset:36872
    ds_read_b32 v125, v118 offset:19712
    ds_read_b32 v121, v118 offset:19716
    s_cmp_le_u32 s35, 2048
    s_cbranch_scc1 p1_ce0
    s_waitcnt lgkmcnt(5)
    v_alignbyte_b32 v113, v114, v113, v119
    buffer_store_dwordx4 v[110:113], v120, s[20:23], 0 offen
    v_add_u32 v120, 33554432, v120
    s_nop 0
    ds_read_b32 v110, v117 offset:49152
    ds_read_b32 v111, v117 offset:49156
    ds_read_b32 v112, v117 offset:49160
    ds_read_b32 v113, v118 offset:22784
    ds_read_b32 v114, v118 offset:22788
    s_cmp_le_u32 s35, 3072
    s_cbranch_scc1 p1_ce0
    s_waitcnt lgkmcnt(5)
    v_alignbyte_b32 v125, v121, v125, v119
    buffer_store_dwordx4 v[122:125], v120, s[20:23], 0 offen
    v_add_u32 v120, 33554432, v120
    s_nop 0
    v_lshlrev_b32 v117, 2, v119
    v_add_u32 v117, 113920, v117
    ds_read_b32 v122, v117 offset:0
    ds_read_b32 v123, v117 offset:4
    ds_read_b32 v124, v117 offset:8
    ds_read_b32 v125, v118 offset:25856
    ds_read_b32 v121, v118 offset:25860
    s_cmp_le_u32 s35, 4096
    s_cbranch_scc1 p1_ce0
    s_waitcnt lgkmcnt(5)
    v_alignbyte_b32 v113, v114, v113, v119
    buffer_store_dwordx4 v[110:113], v120, s[20:23], 0 offen
    v_add_u32 v120, 33554432, v120
    s_nop 0
    ds_read_b32 v110, v117 offset:12288
    ds_read_b32 v111, v117 offset:12292
    ds_read_b32 v112, v117 offset:12296
    ds_read_b32 v113, v118 offset:28928
    ds_read_b32 v114, v118 offset:28932
    s_cmp_le_u32 s35, 5120
    s_cbranch_scc1 p1_ce0
    s_waitcnt lgkmcnt(5)
    v_alignbyte_b32 v125, v121, v125, v119
    buffer_store_dwordx4 v[122:125], v120, s[20:23], 0 offen
    v_add_u32 v120, 33554432, v120
    s_nop 0
    ds_read_b32 v122, v117 offset:24576
    ds_read_b32 v123, v117 offset:24580
    ds_read_b32 v124, v117 offset:24584
    ds_read_b32 v125, v118 offset:32000
    ds_read_b32 v121, v118 offset:32004
    s_cmp_le_u32 s35, 6144
    s_cbranch_scc1 p1_ce0
    s_waitcnt lgkmcnt(5)
    v_alignbyte_b32 v113, v114, v113, v119
    buffer_store_dwordx4 v[110:113], v120, s[20:23], 0 offen
    v_add_u32 v120, 33554432, v120
    s_nop 0
    ds_read_b32 v110, v117 offset:36864
    ds_read_b32 v111, v117 offset:36868
    ds_read_b32 v112, v117 offset:36872
    ds_read_b32 v113, v118 offset:35072
    ds_read_b32 v114, v118 offset:35076
    s_cmp_le_u32 s35, 7168
    s_cbranch_scc1 p1_ce0
    s_waitcnt lgkmcnt(5)
    v_alignbyte_b32 v125, v121, v125, v119
    buffer_store_dwordx4 v[122:125], v120, s[20:23], 0 offen
    v_add_u32 v120, 33554432, v120
    s_nop 0
    s_cmp_le_u32 s35, 8192
    s_cbranch_scc1 p1_ce0
    s_waitcnt lgkmcnt(0)
    v_alignbyte_b32 v113, v114, v113, v119
    buffer_store_dwordx4 v[110:113], v120, s[20:23], 0 offen nt
    v_add_u32 v120, 33554432, v120
    s_nop 0
p1_ce0:
    s_waitcnt lgkmcnt(0)
    s_cmp_lg_u32 s70, 8
    s_cbranch_scc1 p1_h1
    s_sub_u32 s52, s33, 1536
    s_mul_i32 s52, s52, 41600
    s_add_u32 s52, s52, 477822976
    s_mov_b32 s54, 0x05040100
    s_mov_b32 s55, 0x07060302
    s_waitcnt vmcnt(1)
    v_perm_b32 v92, v78, v76, s54
    v_perm_b32 v93, v82, v80, s54
    v_perm_b32 v94, v86, v84, s54
    v_perm_b32 v95, v90, v88, s54
    buffer_store_dwordx4 v[92:95], v101, s[16:19], s52 offen offset:0
    v_perm_b32 v96, v78, v76, s55
    v_perm_b32 v97, v82, v80, s55
    v_perm_b32 v98, v86, v84, s55
    v_perm_b32 v99, v90, v88, s55
    buffer_store_dwordx4 v[96:99], v101, s[16:19], s52 offen offset:1040
    v_perm_b32 v92, v79, v77, s54
    v_perm_b32 v93, v83, v81, s54
    v_perm_b32 v94, v87, v85, s54
    v_perm_b32 v95, v91, v89, s54
    buffer_store_dwordx4 v[92:95], v101, s[16:19], s52 offen offset:2080
    v_perm_b32 v96, v79, v77, s55
    v_perm_b32 v97, v83, v81, s55
    v_perm_b32 v98, v87, v85, s55
    v_perm_b32 v99, v91, v89, s55
    buffer_store_dwordx4 v[96:99], v101, s[16:19], s52 offen offset:3120
p1_h1:
    s_barrier
    s_cmp_ge_u32 s29, 1462
    s_cbranch_scc1 p1_k39
    s_cmp_le_u32 s35, 9216
    s_cbranch_scc1 p1_s1k2
    v_sub_u32 v48, 221180, v48
    ds_write_b32 v48, v12 offset:52480
    v_sub_u32 v49, 221180, v49
    ds_write_b32 v49, v13 offset:52480
    v_sub_u32 v50, 221180, v50
    ds_write_b32 v50, v14 offset:52480
    v_sub_u32 v51, 221180, v51
    ds_write_b32 v51, v15 offset:52480
p1_s1k2:
p1_k39:
    s_cmp_ge_u32 s33, 1536
    s_cbranch_scc1 p1_k40
    s_cmp_lt_u32 s33, 1462
    s_cselect_b32 s6, 204800000, 0
    s_cselect_b32 s10, 204800000, 0
    s_add_u32 s32, s30, 32768
    buffer_load_dwordx4 v[12:15], v1, s[4:7], s32 offen nt
    buffer_load_dwordx4 v[48:51], v1, s[8:11], s32 offen nt
p1_k40:
    s_cmp_ge_u32 s29, 1426
    s_cbranch_scc1 p1_k41
    s_cmp_le_u32 s35, 9216
    s_cbranch_scc1 p1_s1k3
    v_sub_u32 v52, 221180, v52
    ds_write_b32 v52, v16 offset:52480
    v_sub_u32 v53, 221180, v53
    ds_write_b32 v53, v17 offset:52480
    v_sub_u32 v54, 221180, v54
    ds_write_b32 v54, v18 offset:52480
    v_sub_u32 v55, 221180, v55
    ds_write_b32 v55, v19 offset:52480
p1_s1k3:
p1_k41:
    s_cmp_ge_u32 s29, 1389
    s_cbranch_scc1 p1_k42
    s_cmp_le_u32 s35, 9216
    s_cbranch_scc1 p1_s1k4
    v_sub_u32 v56, 221180, v56
    ds_write_b32 v56, v20 offset:52480
    v_sub_u32 v57, 221180, v57
    ds_write_b32 v57, v21 offset:52480
    v_sub_u32 v58, 221180, v58
    ds_write_b32 v58, v22 offset:52480
    v_sub_u32 v59, 221180, v59
    ds_write_b32 v59, v23 offset:52480
p1_s1k4:
p1_k42:
    s_cmp_ge_u32 s29, 1352
    s_cbranch_scc1 p1_k43
    s_cmp_le_u32 s35, 9216
    s_cbranch_scc1 p1_s1k5
    v_sub_u32 v60, 221180, v60
    ds_write_b32 v60, v24 offset:52480
    v_sub_u32 v61, 221180, v61
    ds_write_b32 v61, v25 offset:52480
    v_sub_u32 v62, 221180, v62
    ds_write_b32 v62, v26 offset:52480
    v_sub_u32 v63, 221180, v63
    ds_write_b32 v63, v27 offset:52480
p1_s1k5:
p1_k43:
    s_cmp_ge_u32 s29, 1315
    s_cbranch_scc1 p1_k44
    s_cmp_le_u32 s35, 9216
    s_cbranch_scc1 p1_s1k6
    v_sub_u32 v64, 221180, v64
    ds_write_b32 v64, v28 offset:52480
    v_sub_u32 v65, 221180, v65
    ds_write_b32 v65, v29 offset:52480
    v_sub_u32 v66, 221180, v66
    ds_write_b32 v66, v30 offset:52480
    v_sub_u32 v67, 221180, v67
    ds_write_b32 v67, v31 offset:52480
p1_s1k6:
p1_k44:
    s_cmp_ge_u32 s29, 1279
    s_cbranch_scc1 p1_k45
    s_cmp_le_u32 s35, 9216
    s_cbranch_scc1 p1_s1k7
    v_sub_u32 v68, 221180, v68
    ds_write_b32 v68, v32 offset:52480
    v_sub_u32 v69, 221180, v69
    ds_write_b32 v69, v33 offset:52480
    v_sub_u32 v70, 221180, v70
    ds_write_b32 v70, v34 offset:52480
    v_sub_u32 v71, 221180, v71
    ds_write_b32 v71, v35 offset:52480
p1_s1k7:
p1_k45:
    s_cmp_ge_u32 s29, 1242
    s_cbranch_scc1 p1_k46
    s_cmp_le_u32 s35, 9216
    s_cbranch_scc1 p1_s1k8
    v_sub_u32 v72, 221180, v72
    ds_write_b32 v72, v36 offset:52480
    v_sub_u32 v73, 221180, v73
    ds_write_b32 v73, v37 offset:52480
    v_sub_u32 v74, 221180, v74
    ds_write_b32 v74, v38 offset:52480
    v_sub_u32 v75, 221180, v75
    ds_write_b32 v75, v39 offset:52480
p1_s1k8:
p1_k46:
    s_cmp_le_u32 s35, 9216
    s_cbranch_scc1 p1_s1k0
    v_sub_u32 v40, 221180, v40
    ds_write_b32 v40, v4 offset:52480
    v_sub_u32 v41, 221180, v41
    ds_write_b32 v41, v5 offset:52480
    v_sub_u32 v42, 221180, v42
    ds_write_b32 v42, v6 offset:52480
    v_sub_u32 v43, 221180, v43
    ds_write_b32 v43, v7 offset:52480
p1_s1k0:
    s_cmp_ge_u32 s29, 1499
    s_cbranch_scc1 p1_k47
    s_cmp_le_u32 s35, 9216
    s_cbranch_scc1 p1_s1k1
    v_sub_u32 v44, 221180, v44
    ds_write_b32 v44, v8 offset:52480
    v_sub_u32 v45, 221180, v45
    ds_write_b32 v45, v9 offset:52480
    v_sub_u32 v46, 221180, v46
    ds_write_b32 v46, v10 offset:52480
    v_sub_u32 v47, 221180, v47
    ds_write_b32 v47, v11 offset:52480
p1_s1k1:
p1_k47:
    s_cmp_lg_u32 s69, 8
    s_cbranch_scc1 p1_o1
    s_lshr_b32 s52, s29, 3
    v_and_b32 v74, 63, v0
    s_cmp_eq_u32 s28, 10
    s_cbranch_scc1 p1_tr11
    s_mul_i32 s53, s28, 520
    v_lshl_add_u32 v72, v74, 3, s53
    s_mul_i32 s53, s28, 4160
    v_lshl_add_u32 v73, v74, 4, s53
    s_branch p1_tr21
p1_tr11:
    v_mul_u32_u24 v72, 520, v74
    v_add_u32 v72, 512, v72
    v_mul_u32_u24 v73, 4160, v74
    v_add_u32 v73, 1024, v73
    v_cmp_gt_u32 vcc, 10, v74
    v_mov_b32 v74, 0x40000000
    s_nop 0
    v_cndmask_b32 v72, v74, v72, vcc
    v_cndmask_b32 v73, v74, v73, vcc
p1_tr21:
    s_mul_i32 s52, s52, 41984
    s_add_u32 s52, s52, 469762048
    buffer_load_dwordx2 v[24:25], v72, s[16:19], s52 offen sc1
    s_add_u32 s52, s52, 5248
    buffer_load_dwordx2 v[26:27], v72, s[16:19], s52 offen sc1
    s_add_u32 s52, s52, 5248
    buffer_load_dwordx2 v[28:29], v72, s[16:19], s52 offen sc1
    s_add_u32 s52, s52, 5248
    buffer_load_dwordx2 v[30:31], v72, s[16:19], s52 offen sc1
    s_add_u32 s52, s52, 5248
    buffer_load_dwordx2 v[32:33], v72, s[16:19], s52 offen sc1
    s_add_u32 s52, s52, 5248
    buffer_load_dwordx2 v[34:35], v72, s[16:19], s52 offen sc1
    s_add_u32 s52, s52, 5248
    buffer_load_dwordx2 v[36:37], v72, s[16:19], s52 offen sc1
    s_add_u32 s52, s52, 5248
    buffer_load_dwordx2 v[38:39], v72, s[16:19], s52 offen sc1
    s_add_u32 s52, s52, 5248
    s_cmp_ge_u32 s33, 1536
    s_cbranch_scc1 p1_o1
    s_lshr_b32 s52, s29, 3
    s_mul_i32 s52, s52, 41600
    s_add_u32 s52, s52, 477822976
    s_mov_b32 s54, 0x05040100
    s_mov_b32 s55, 0x07060302
    s_waitcnt vmcnt(0)
    v_perm_b32 v64, v26, v24, s54
    v_perm_b32 v65, v30, v28, s54
    v_perm_b32 v66, v34, v32, s54
    v_perm_b32 v67, v38, v36, s54
    buffer_store_dwordx4 v[64:67], v73, s[16:19], s52 offen offset:0
    v_perm_b32 v68, v26, v24, s55
    v_perm_b32 v69, v30, v28, s55
    v_perm_b32 v70, v34, v32, s55
    v_perm_b32 v71, v38, v36, s55
    buffer_store_dwordx4 v[68:71], v73, s[16:19], s52 offen offset:1040
    v_perm_b32 v64, v27, v25, s54
    v_perm_b32 v65, v31, v29, s54
    v_perm_b32 v66, v35, v33, s54
    v_perm_b32 v67, v39, v37, s54
    buffer_store_dwordx4 v[64:67], v73, s[16:19], s52 offen offset:2080
    v_perm_b32 v68, v27, v25, s55
    v_perm_b32 v69, v31, v29, s55
    v_perm_b32 v70, v35, v33, s55
    v_perm_b32 v71, v39, v37, s55
    buffer_store_dwordx4 v[68:71], v73, s[16:19], s52 offen offset:3120
    s_mov_b32 s69, 0
p1_o1:
    s_waitcnt lgkmcnt(0)
    s_barrier
    s_cmp_le_u32 s35, 9216
    s_cbranch_scc1 p1_ce1
    v_lshlrev_b32 v117, 2, v119
    v_sub_u32 v117, 113908, v117
    ds_read_b32 v122, v117 offset:49160
    ds_read_b32 v123, v117 offset:49156
    ds_read_b32 v124, v117 offset:49152
    ds_read_b32 v125, v118 offset:38144
    ds_read_b32 v121, v118 offset:38148
    ds_read_b32 v110, v117 offset:36872
    ds_read_b32 v111, v117 offset:36868
    ds_read_b32 v112, v117 offset:36864
    ds_read_b32 v113, v118 offset:41216
    ds_read_b32 v114, v118 offset:41220
    s_waitcnt lgkmcnt(5)
    v_alignbyte_b32 v125, v121, v125, v119
    buffer_store_dwordx4 v[122:125], v120, s[20:23], 0 offen nt
    v_add_u32 v120, 33554432, v120
    s_nop 0
    ds_read_b32 v122, v117 offset:24584
    ds_read_b32 v123, v117 offset:24580
    ds_read_b32 v124, v117 offset:24576
    ds_read_b32 v125, v118 offset:44288
    ds_read_b32 v121, v118 offset:44292
    s_cmp_le_u32 s35, 10240
    s_cbranch_scc1 p1_ce1
    s_waitcnt lgkmcnt(5)
    v_alignbyte_b32 v113, v114, v113, v119
    buffer_store_dwordx4 v[110:113], v120, s[20:23], 0 offen nt
    v_add_u32 v120, 33554432, v120
    s_nop 0
    ds_read_b32 v110, v117 offset:12296
    ds_read_b32 v111, v117 offset:12292
    ds_read_b32 v112, v117 offset:12288
    ds_read_b32 v113, v118 offset:47360
    ds_read_b32 v114, v118 offset:47364
    s_cmp_le_u32 s35, 11264
    s_cbranch_scc1 p1_ce1
    s_waitcnt lgkmcnt(5)
    v_alignbyte_b32 v125, v121, v125, v119
    buffer_store_dwordx4 v[122:125], v120, s[20:23], 0 offen nt
    v_add_u32 v120, 33554432, v120
    s_nop 0
    ds_read_b32 v122, v117 offset:8
    ds_read_b32 v123, v117 offset:4
    ds_read_b32 v124, v117 offset:0
    ds_read_b32 v125, v118 offset:50432
    ds_read_b32 v121, v118 offset:50436
    s_cmp_le_u32 s35, 12288
    s_cbranch_scc1 p1_ce1
    s_waitcnt lgkmcnt(5)
    v_alignbyte_b32 v113, v114, v113, v119
    buffer_store_dwordx4 v[110:113], v120, s[20:23], 0 offen nt
    v_add_u32 v120, 33554432, v120
    s_nop 0
    s_cmp_le_u32 s35, 13312
    s_cbranch_scc1 p1_ce1
    s_waitcnt lgkmcnt(0)
    v_alignbyte_b32 v125, v121, v125, v119
    buffer_store_dwordx4 v[122:125], v120, s[20:23], 0 offen nt
    v_add_u32 v120, 33554432, v120
    s_nop 0
p1_ce1:
    s_waitcnt lgkmcnt(0)
    s_cmp_lg_u32 s69, 8
    s_cbranch_scc1 p1_o2
    s_lshr_b32 s52, s29, 3
    s_mul_i32 s52, s52, 41600
    s_add_u32 s52, s52, 477822976
    s_mov_b32 s54, 0x05040100
    s_mov_b32 s55, 0x07060302
    s_waitcnt vmcnt(0)
    v_perm_b32 v64, v26, v24, s54
    v_perm_b32 v65, v30, v28, s54
    v_perm_b32 v66, v34, v32, s54
    v_perm_b32 v67, v38, v36, s54
    buffer_store_dwordx4 v[64:67], v73, s[16:19], s52 offen offset:0
    v_perm_b32 v68, v26, v24, s55
    v_perm_b32 v69, v30, v28, s55
    v_perm_b32 v70, v34, v32, s55
    v_perm_b32 v71, v38, v36, s55
    buffer_store_dwordx4 v[68:71], v73, s[16:19], s52 offen offset:1040
    v_perm_b32 v64, v27, v25, s54
    v_perm_b32 v65, v31, v29, s54
    v_perm_b32 v66, v35, v33, s54
    v_perm_b32 v67, v39, v37, s54
    buffer_store_dwordx4 v[64:67], v73, s[16:19], s52 offen offset:2080
    v_perm_b32 v68, v27, v25, s55
    v_perm_b32 v69, v31, v29, s55
    v_perm_b32 v70, v35, v33, s55
    v_perm_b32 v71, v39, v37, s55
    buffer_store_dwordx4 v[68:71], v73, s[16:19], s52 offen offset:3120
p1_o2:
    s_barrier
    s_mov_b32 s29, s33
    s_cmp_lt_u32 s29, 1242
    s_cselect_b32 s34, 1, 0
    s_cmp_lt_u32 s29, 1536
    s_cbranch_scc1 p1_tile
p1_end:
    s_endpgm
.globl p2_kernel
.p2align 8
.type p2_kernel,@function
p2_kernel:
    s_cmp_ge_u32 s2, 256
    s_cbranch_scc1 p2_end
    s_load_dwordx2 s[8:9], s[0:1], 104
    v_and_b32 v112, 63, v0
    v_lshrrev_b32 v122, 6, v0
    v_lshlrev_b32 v112, 4, v112
    v_readfirstlane_b32 s10, v122
    v_mov_b32 v113, 0x83ff0000
    s_and_b32 s44, s2, 7
    s_lshr_b32 s11, s44, 1
    s_and_b32 s44, s44, 1
    s_lshl_b32 s12, s44, 5
    s_lshr_b32 s44, s2, 3
    s_add_u32 s12, s12, s44
    s_mov_b32 s25, 54272
    s_mov_b32 s31, 67175170
    s_mov_b32 s32, 83952386
    s_mov_b32 s33, 100729602
    s_mov_b32 s21, 0
    s_mul_i32 s23, s10, 3072
    s_lshl_b32 s24, s10, 9
    s_lshl_b32 s64, s10, 10
    s_sub_u32 s42, s24, s23
    s_add_u32 s42, s42, 49152
    s_movk_i32 s63, 2048
    s_mul_i32 s62, s11, 161280
    s_add_u32 s62, s62, 485810176
    s_add_u32 s62, s62, s23
    s_mov_b32 s40, 477822976
    s_mul_i32 s44, s11, 1040
    s_add_u32 s40, s40, s44
    s_lshl_b32 s44, s12, 4
    s_add_u32 s40, s40, s44
    s_waitcnt lgkmcnt(0)
    s_mov_b32 s4, s8
    s_and_b32 s5, s9, 0xffff
    s_mov_b32 s6, 819200000
    s_mov_b32 s7, 0x20000
    s_mov_b32 s68, s8
    s_and_b32 s69, s9, 0xffff
    s_mov_b32 s70, 469762048
    s_mov_b32 s71, 0x20000
    s_and_b32 s44, s2, 7
    s_lshl_b32 s44, s44, 2
    s_lshr_b32 s18, 0x00000000, s44
    s_and_b32 s18, s18, 15
p2_restart:
    s_mov_b32 s61, 0
    s_add_u32 s44, s61, s18
    s_cmp_ge_u32 s44, 10
    s_cselect_b32 s53, 10, 0
    s_sub_u32 s44, s44, s53
    s_mul_i32 s44, s44, 4160
    s_add_u32 s44, s44, s40
    v_bfe_i32 v111, v112, 6, 1
    v_lshrrev_b32 v110, 6, v112
    v_bitop3_b32 v111, v111, 15, s10 bitop3:0x6a
    v_lshl_or_b32 v110, v110, 4, v111
    v_bfe_u32 v111, v112, 2, 4
    v_mul_u32_u24 v110, 41600, v110
    v_add_u32 v111, v110, v111
    v_add_u32 v110, 256, v112
    v_and_b32 v110, 0x400, v110
    v_lshl_or_b32 v111, v110, 20, v111
    buffer_load_dword v110, v111, s[4:7], s44 offen
    buffer_load_dword v111, v111, s[4:7], s44 offen offset:16
    s_mov_b32 s61, 1
    s_add_u32 s44, s61, s18
    s_cmp_ge_u32 s44, 10
    s_cselect_b32 s53, 10, 0
    s_sub_u32 s44, s44, s53
    s_mul_i32 s44, s44, 4160
    s_add_u32 s44, s44, s40
    v_bfe_i32 v69, v112, 6, 1
    v_lshrrev_b32 v68, 6, v112
    v_bitop3_b32 v69, v69, 15, s10 bitop3:0x6a
    v_lshl_or_b32 v68, v68, 4, v69
    v_bfe_u32 v69, v112, 2, 4
    v_mul_u32_u24 v68, 41600, v68
    v_add_u32 v69, v68, v69
    v_add_u32 v68, 256, v112
    v_and_b32 v68, 0x400, v68
    v_lshl_or_b32 v69, v68, 20, v69
    buffer_load_dword v68, v69, s[4:7], s44 offen
    buffer_load_dword v69, v69, s[4:7], s44 offen offset:16
    s_mov_b32 s61, 0
    s_cmp_lt_u32 s10, 15
    s_cselect_b32 s44, s64, 0x40000000
    v_add_u32 v60, s44, v112
    s_mov_b32 s44, 492261376
    buffer_load_dwordx4 v[60:63], v60, s[4:7], s44 offen
    s_mul_i32 s20, s18, 645120
    s_add_u32 s20, s20, s62
    s_cmp_ge_u32 s10, 9
    s_cbranch_scc1 p2_nmp
    v_lshrrev_b32 v84, 1, v112
    s_add_u32 s44, s20, s42
    buffer_load_dwordx2 v[84:85], v84, s[4:7], s44 offen
p2_nmp:
    buffer_load_dwordx4 v[72:75], v112, s[4:7], s20 offen offset:0
    buffer_load_dwordx4 v[76:79], v112, s[4:7], s20 offen offset:1024
    buffer_load_dwordx4 v[80:83], v112, s[4:7], s20 offen offset:2048
    s_barrier
    v_mov_b32 v115, 0
    v_mov_b32 v116, 0
    v_mov_b32 v117, 0
    v_mov_b32 v118, 0
    v_mov_b32 v119, 0
    v_mov_b32 v120, 0
    v_mov_b32 v121, 0
    ds_write_b128 v115, v[116:119] offset:53760
    s_mov_b32 s19, 0
    s_cmp_eq_u32 s21, 2
    s_cselect_b64 s[66:67], -1, 0
    s_waitcnt lgkmcnt(0)
    s_barrier
    s_waitcnt vmcnt(6)
    s_mov_b32 m0, s23
    v_mov_b32 v53, 0x3c000
    s_movk_i32 s44, 512
    v_sub_u32_sdwa v4, v111, v110 dst_sel:DWORD dst_unused:UNUSED_PAD src0_sel:WORD_0 src1_sel:WORD_0
    v_sub_u32_sdwa v5, v111, v110 dst_sel:DWORD dst_unused:UNUSED_PAD src0_sel:WORD_1 src1_sel:WORD_1
    v_med3_i32 v4, v4, 0, s44
    v_med3_i32 v5, v5, 0, s44
    v_add_u32 v48, v4, v5
    ds_write_addtid_b32 v53 offset:0
    ds_write_addtid_b32 v53 offset:256
    ds_write_addtid_b32 v53 offset:512
    ds_write_addtid_b32 v53 offset:768
    ds_write_addtid_b32 v53 offset:1024
    ds_write_addtid_b32 v53 offset:1280
    ds_write_addtid_b32 v53 offset:1536
    ds_write_addtid_b32 v53 offset:1792
    v_bfe_i32 v53, v112, 6, 1
    v_lshrrev_b32 v49, 6, v112
    v_bitop3_b32 v53, v53, 15, s10 bitop3:0x6a
    v_lshl_or_b32 v49, v49, 4, v53
    v_and_b32 v53, 0x30, v112
    v_lshl_or_b32 v53, v49, 6, v53
    v_lshlrev_b32 v53, 15, v53
    s_nop 1
    v_add_u32_dpp v48, v48, v48 row_shr:1 row_mask:0xf bank_mask:0xf bound_ctrl:0
    s_nop 1
    v_add_u32_dpp v48, v48, v48 row_shr:2 row_mask:0xf bank_mask:0xf bound_ctrl:0
    s_nop 1
    v_add_u32_dpp v48, v48, v48 row_shr:4 row_mask:0xf bank_mask:0xf bound_ctrl:0
    s_nop 1
    v_add_u32_dpp v48, v48, v48 row_shr:8 row_mask:0xf bank_mask:0xf bound_ctrl:0
    s_nop 1
    v_add_u32_dpp v48, v48, v48 row_bcast:15 row_mask:0xa bank_mask:0xf
    s_nop 1
    v_add_u32_dpp v48, v48, v48 row_bcast:31 row_mask:0xc bank_mask:0xf
    s_nop 1
    s_nop 0
    v_readlane_b32 s38, v48, 63
    v_sub_u32 v50, v48, v5
    v_sub_u32 v49, v50, v4
    v_sub_u32 v10, 512, v49
    v_mad_u32_u16 v51, v110, 16, v53
    v_med3_i32 v10, v10, 0, v4
    v_lshl_add_u32 v49, v49, 2, s23
    v_sub_u32 v11, 512, v50
    v_mad_u32_u16 v52, v110, 16, v53 op_sel:[1,0,0,0]
    v_med3_i32 v11, v11, 0, v5
    v_lshl_add_u32 v50, v50, 2, s23
    v_lshl_add_u32 v48, v11, 16, v10
    v_add_u32 v52, 262144, v52
    v_add_u32 v110, v110, v48
    s_min_u32 s17, s38, 512
    s_add_u32 s17, s17, 63
    s_lshr_b32 s17, s17, 6
p2_xa_0:
    v_cmpx_lt_i32 vcc, 0, v10
    s_cbranch_execz p2_ya_0
    ds_write_b32 v49, v51 offset:0
    v_add_u32 v51, 16, v51
    v_cmpx_lt_i32 vcc, 1, v10
    s_cbranch_execz p2_ya_0
    ds_write_b32 v49, v51 offset:4
    v_add_u32 v51, 16, v51
    v_cmpx_lt_i32 vcc, 2, v10
    s_cbranch_execz p2_ya_0
    ds_write_b32 v49, v51 offset:8
    v_add_u32 v51, 16, v51
    v_cmpx_lt_i32 vcc, 3, v10
    s_cbranch_execz p2_ya_0
    ds_write_b32 v49, v51 offset:12
    v_add_u32 v51, 16, v51
    v_cmpx_lt_i32 vcc, 4, v10
    s_cbranch_execz p2_ya_0
    ds_write_b32 v49, v51 offset:16
    v_add_u32 v51, 16, v51
    v_cmpx_lt_i32 vcc, 5, v10
    s_cbranch_execz p2_ya_0
    ds_write_b32 v49, v51 offset:20
    v_add_u32 v51, 16, v51
    v_cmpx_lt_i32 vcc, 6, v10
    s_cbranch_execz p2_ya_0
    ds_write_b32 v49, v51 offset:24
    v_add_u32 v51, 16, v51
    v_cmpx_lt_i32 vcc, 7, v10
    s_cbranch_execz p2_ya_0
    ds_write_b32 v49, v51 offset:28
    v_add_u32 v51, 16, v51
    v_subrev_u32 v10, 8, v10
    v_add_u32 v49, 32, v49
    s_branch p2_xa_0
p2_ya_0:
    s_mov_b64 exec, -1
p2_xa_1:
    v_cmpx_lt_i32 vcc, 0, v11
    s_cbranch_execz p2_ya_1
    ds_write_b32 v50, v52 offset:0
    v_add_u32 v52, 16, v52
    v_cmpx_lt_i32 vcc, 1, v11
    s_cbranch_execz p2_ya_1
    ds_write_b32 v50, v52 offset:4
    v_add_u32 v52, 16, v52
    v_cmpx_lt_i32 vcc, 2, v11
    s_cbranch_execz p2_ya_1
    ds_write_b32 v50, v52 offset:8
    v_add_u32 v52, 16, v52
    v_cmpx_lt_i32 vcc, 3, v11
    s_cbranch_execz p2_ya_1
    ds_write_b32 v50, v52 offset:12
    v_add_u32 v52, 16, v52
    v_cmpx_lt_i32 vcc, 4, v11
    s_cbranch_execz p2_ya_1
    ds_write_b32 v50, v52 offset:16
    v_add_u32 v52, 16, v52
    v_cmpx_lt_i32 vcc, 5, v11
    s_cbranch_execz p2_ya_1
    ds_write_b32 v50, v52 offset:20
    v_add_u32 v52, 16, v52
    v_cmpx_lt_i32 vcc, 6, v11
    s_cbranch_execz p2_ya_1
    ds_write_b32 v50, v52 offset:24
    v_add_u32 v52, 16, v52
    v_cmpx_lt_i32 vcc, 7, v11
    s_cbranch_execz p2_ya_1
    ds_write_b32 v50, v52 offset:28
    v_add_u32 v52, 16, v52
    v_subrev_u32 v11, 8, v11
    v_add_u32 v50, 32, v50
    s_branch p2_xa_1
p2_ya_1:
    s_mov_b64 exec, -1
    s_cmp_lt_u32 s38, 512
    s_cbranch_scc1 p2_nomorea
    v_cmp_lt_u32_sdwa s[44:45], v110, v111 src0_sel:WORD_0 src1_sel:WORD_0
    v_cmp_lt_u32_sdwa s[46:47], v110, v111 src0_sel:WORD_1 src1_sel:WORD_1
    s_nop 0
    s_or_b64 s[44:45], s[44:45], s[46:47]
    s_cbranch_scc0 p2_nomorea
    v_mov_b32 v49, s19
    v_mov_b32 v50, 1
    ds_write_b32 v49, v50 offset:53760
p2_nomorea:
    s_mov_b32 m0, s23
    s_nop 0
    ds_read_addtid_b32 v2 offset:0
    ds_read_addtid_b32 v8 offset:256
    ds_read_addtid_b32 v14 offset:512
    ds_read_addtid_b32 v20 offset:768
    ds_read_addtid_b32 v88 offset:1024
    ds_read_addtid_b32 v92 offset:1280
    ds_read_addtid_b32 v96 offset:1536
    ds_read_addtid_b32 v100 offset:1792
    s_waitcnt lgkmcnt(0)
    v_bfe_u32 v0, v2, 14, 4
    v_lshrrev_b32 v1, 18, v2
    v_and_b32 v2, 0x3fff, v2
    v_mad_u32_u24 v0, v0, s63, v1
    v_lshl_or_b32 v2, v0, 14, v2
    buffer_load_dwordx4 v[0:3], v2, s[68:71], 0 offen
    v_bfe_u32 v6, v8, 14, 4
    v_lshrrev_b32 v7, 18, v8
    v_and_b32 v8, 0x3fff, v8
    v_mad_u32_u24 v6, v6, s63, v7
    v_lshl_or_b32 v8, v6, 14, v8
    buffer_load_dwordx4 v[6:9], v8, s[68:71], 0 offen
    s_cmp_eq_u32 s21, 0
    s_cselect_b32 s44, 1073758208, 0
    v_mov_b32 v124, s44
    v_mov_b32 v125, s44
    v_mov_b32 v126, s44
    v_mov_b32 v127, s44
    v_add_u32 v123, s64, v112
    v_add_u32 v122, s25, v123
    ds_write_b128 v122, v[124:127] offset:0
    ds_write_b128 v122, v[124:127] offset:16384
    ds_write_b128 v122, v[124:127] offset:32768
    v_add_u32 v122, 49152, v122
    ds_write_b128 v122, v[124:127] offset:0
    ds_write_b128 v122, v[124:127] offset:16384
    ds_write_b128 v122, v[124:127] offset:32768
    v_cmpx_gt_u32 vcc, 1792, v123
    ds_write_b128 v122, v[124:127] offset:49152
    s_mov_b64 exec, -1
    v_bfe_u32 v12, v14, 14, 4
    v_lshrrev_b32 v13, 18, v14
    v_and_b32 v14, 0x3fff, v14
    v_mad_u32_u24 v12, v12, s63, v13
    v_lshl_or_b32 v14, v12, 14, v14
    buffer_load_dwordx4 v[12:15], v14, s[68:71], 0 offen
    s_mov_b32 s16, s17
    s_waitcnt vmcnt(6)
    s_cmp_lg_u32 s21, 0
    s_cbranch_scc1 p2_nostat1
    v_max_u32 v60, v60, v62
    v_add_f32 v61, v61, v63
    s_nop 1
    v_max_u32_dpp v60, v60, v60 row_shr:1 row_mask:0xf bank_mask:0xf bound_ctrl:0
    v_add_f32_dpp v61, v61, v61 row_shr:1 row_mask:0xf bank_mask:0xf bound_ctrl:0
    s_nop 0
    v_max_u32_dpp v60, v60, v60 row_shr:2 row_mask:0xf bank_mask:0xf bound_ctrl:0
    v_add_f32_dpp v61, v61, v61 row_shr:2 row_mask:0xf bank_mask:0xf bound_ctrl:0
    s_nop 0
    v_max_u32_dpp v60, v60, v60 row_shr:4 row_mask:0xf bank_mask:0xf bound_ctrl:0
    v_add_f32_dpp v61, v61, v61 row_shr:4 row_mask:0xf bank_mask:0xf bound_ctrl:0
    s_nop 0
    v_max_u32_dpp v60, v60, v60 row_shr:8 row_mask:0xf bank_mask:0xf bound_ctrl:0
    v_add_f32_dpp v61, v61, v61 row_shr:8 row_mask:0xf bank_mask:0xf bound_ctrl:0
    s_nop 0
    v_max_u32_dpp v60, v60, v60 row_bcast:15 row_mask:0xa bank_mask:0xf
    v_add_f32_dpp v61, v61, v61 row_bcast:15 row_mask:0xa bank_mask:0xf
    s_nop 0
    v_max_u32_dpp v60, v60, v60 row_bcast:31 row_mask:0xc bank_mask:0xf
    v_add_f32_dpp v61, v61, v61 row_bcast:31 row_mask:0xc bank_mask:0xf
    s_nop 0
    s_nop 0
    s_lshl_b32 s44, s10, 3
    v_mov_b32 v62, s44
    s_mov_b64 exec, 1
    s_lshl_b64 exec, exec, 63
    ds_write_b64 v62, v[60:61] offset:53824
    s_mov_b64 exec, -1
p2_nostat1:
    s_waitcnt lgkmcnt(0)
    s_barrier
    v_bfe_u32 v18, v20, 14, 4
    v_lshrrev_b32 v19, 18, v20
    v_and_b32 v20, 0x3fff, v20
    v_mad_u32_u24 v18, v18, s63, v19
    v_lshl_or_b32 v20, v18, 14, v20
    buffer_load_dwordx4 v[18:21], v20, s[68:71], 0 offen
    v_mov_b32 v122, s19
    s_xor_b32 s19, s19, 4
    ds_read_b32 v125, v122 offset:53760
    s_cmp_lg_u32 s21, 0
    s_cbranch_scc1 p2_nostat2
    v_bfe_u32 v62, v112, 1, 7
    ds_read_b64 v[60:61], v62 offset:53824
    s_waitcnt lgkmcnt(0)
    s_nop 1
    v_max_u32_dpp v60, v60, v60 row_shr:1 row_mask:0xf bank_mask:0xf bound_ctrl:0
    v_add_f32_dpp v61, v61, v61 row_shr:1 row_mask:0xf bank_mask:0xf bound_ctrl:0
    s_nop 0
    v_max_u32_dpp v60, v60, v60 row_shr:2 row_mask:0xf bank_mask:0xf bound_ctrl:0
    v_add_f32_dpp v61, v61, v61 row_shr:2 row_mask:0xf bank_mask:0xf bound_ctrl:0
    s_nop 0
    v_max_u32_dpp v60, v60, v60 row_shr:4 row_mask:0xf bank_mask:0xf bound_ctrl:0
    v_add_f32_dpp v61, v61, v61 row_shr:4 row_mask:0xf bank_mask:0xf bound_ctrl:0
    s_nop 0
    v_max_u32_dpp v60, v60, v60 row_shr:8 row_mask:0xf bank_mask:0xf bound_ctrl:0
    v_add_f32_dpp v61, v61, v61 row_shr:8 row_mask:0xf bank_mask:0xf bound_ctrl:0
    s_nop 0
    v_max_u32_dpp v60, v60, v60 row_bcast:15 row_mask:0xa bank_mask:0xf
    v_add_f32_dpp v61, v61, v61 row_bcast:15 row_mask:0xa bank_mask:0xf
    s_nop 0
    v_max_u32_dpp v60, v60, v60 row_bcast:31 row_mask:0xc bank_mask:0xf
    v_add_f32_dpp v61, v61, v61 row_bcast:31 row_mask:0xc bank_mask:0xf
    s_nop 0
    s_nop 0
    v_readlane_b32 s44, v60, 15
    v_readlane_b32 s45, v61, 15
    s_nop 1
    s_lshl_b32 s44, s44, 16
    s_lshr_b32 s46, s44, 23
    s_sub_u32 s47, s46, 80
    s_cmp_lt_u32 s47, 100
    s_cselect_b32 s21, 0, 1
    v_mov_b32 v60, s45
    v_mul_f32 v60, 0x34a7c5ac, v60
    v_sqrt_f32 v60, v60
    v_mov_b32 v61, s44
    v_mul_f32 v62, 0x41800000, v60
    v_cmp_nle_f32 vcc, v61, v62
    v_mul_f32 v60, 0x3ac00000, v60
    v_mul_f32 v61, 0x3901742e, v61
    v_max_f32 v60, v60, v61
    s_cmp_lg_u64 vcc, 0
    s_cselect_b32 s21, 1, s21
    v_readfirstlane_b32 s44, v60
    s_nop 0
    s_and_b32 s47, s44, 0x7fffff
    s_or_b32 s47, s47, 0x3f000000
    s_and_b32 s48, s44, 0x7f800000
    s_add_u32 s48, s48, 0x800000
    v_rcp_f32 v60, s47
    s_nop 0
    v_rcp_f32 v61, v60
    v_mul_f32 v60, 0x7b800000, v60
    v_mul_f32 v61, s48, v61
    s_nop 0
    v_readfirstlane_b32 s26, v60
    v_readfirstlane_b32 s30, v61
    s_add_u32 s34, s48, 197132288
    s_mov_b32 s35, s34
    s_sub_u32 s36, 0, s34
    s_subb_u32 s37, 0, s34
    s_cmp_eq_u32 s21, 0
    s_cbranch_scc1 p2_nostat2
    s_waitcnt vmcnt(0) lgkmcnt(0)
    s_branch p2_restart
p2_nostat2:
    s_cmp_eq_u32 s21, 0
    s_cselect_b32 s26, s26, 0x7b800000
    v_mov_b32 v114, s26
    s_waitcnt lgkmcnt(0)
    v_readfirstlane_b32 s44, v125
    s_nop 0
    s_cmp_lg_u32 s44, 0
    s_cbranch_scc1 p2_adva
    s_mov_b32 s61, 1
    v_mov_b32 v110, v68
    v_mov_b32 v111, v69
p2_adva:
    v_bfe_u32 v86, v88, 14, 4
    v_lshrrev_b32 v87, 18, v88
    v_and_b32 v88, 0x3fff, v88
    v_mad_u32_u24 v86, v86, s63, v87
    v_lshl_or_b32 v88, v86, 14, v88
    buffer_load_dwordx4 v[86:89], v88, s[68:71], 0 offen
    s_mov_b32 m0, s23
    v_mov_b32 v53, 0x3c000
    s_movk_i32 s44, 512
    v_sub_u32_sdwa v4, v111, v110 dst_sel:DWORD dst_unused:UNUSED_PAD src0_sel:WORD_0 src1_sel:WORD_0
    v_sub_u32_sdwa v5, v111, v110 dst_sel:DWORD dst_unused:UNUSED_PAD src0_sel:WORD_1 src1_sel:WORD_1
    v_med3_i32 v4, v4, 0, s44
    v_med3_i32 v5, v5, 0, s44
    v_add_u32 v48, v4, v5
    ds_write_addtid_b32 v53 offset:0
    ds_write_addtid_b32 v53 offset:256
    ds_write_addtid_b32 v53 offset:512
    ds_write_addtid_b32 v53 offset:768
    ds_write_addtid_b32 v53 offset:1024
    ds_write_addtid_b32 v53 offset:1280
    ds_write_addtid_b32 v53 offset:1536
    ds_write_addtid_b32 v53 offset:1792
    v_bfe_i32 v53, v112, 6, 1
    v_lshrrev_b32 v49, 6, v112
    v_bitop3_b32 v53, v53, 15, s10 bitop3:0x6a
    v_lshl_or_b32 v49, v49, 4, v53
    v_and_b32 v53, 0x30, v112
    v_lshl_or_b32 v53, v49, 6, v53
    v_lshlrev_b32 v53, 15, v53
    s_nop 1
    v_add_u32_dpp v48, v48, v48 row_shr:1 row_mask:0xf bank_mask:0xf bound_ctrl:0
    s_nop 1
    v_add_u32_dpp v48, v48, v48 row_shr:2 row_mask:0xf bank_mask:0xf bound_ctrl:0
    s_nop 1
    v_add_u32_dpp v48, v48, v48 row_shr:4 row_mask:0xf bank_mask:0xf bound_ctrl:0
    s_nop 1
    v_add_u32_dpp v48, v48, v48 row_shr:8 row_mask:0xf bank_mask:0xf bound_ctrl:0
    s_nop 1
    v_add_u32_dpp v48, v48, v48 row_bcast:15 row_mask:0xa bank_mask:0xf
    s_nop 1
    v_add_u32_dpp v48, v48, v48 row_bcast:31 row_mask:0xc bank_mask:0xf
    s_nop 1
    s_nop 0
    v_readlane_b32 s38, v48, 63
    v_sub_u32 v50, v48, v5
    v_sub_u32 v49, v50, v4
    v_sub_u32 v10, 512, v49
    v_mad_u32_u16 v51, v110, 16, v53
    v_med3_i32 v10, v10, 0, v4
    v_lshl_add_u32 v49, v49, 2, s23
    v_sub_u32 v11, 512, v50
    v_mad_u32_u16 v52, v110, 16, v53 op_sel:[1,0,0,0]
    v_med3_i32 v11, v11, 0, v5
    v_lshl_add_u32 v50, v50, 2, s23
    v_lshl_add_u32 v48, v11, 16, v10
    v_add_u32 v52, 262144, v52
    v_add_u32 v110, v110, v48
    s_min_u32 s17, s38, 512
    s_add_u32 s17, s17, 63
    s_lshr_b32 s17, s17, 6
p2_xb_0:
    v_cmpx_lt_i32 vcc, 0, v10
    s_cbranch_execz p2_yb_0
    ds_write_b32 v49, v51 offset:0
    v_add_u32 v51, 16, v51
    v_cmpx_lt_i32 vcc, 1, v10
    s_cbranch_execz p2_yb_0
    ds_write_b32 v49, v51 offset:4
    v_add_u32 v51, 16, v51
    v_cmpx_lt_i32 vcc, 2, v10
    s_cbranch_execz p2_yb_0
    ds_write_b32 v49, v51 offset:8
    v_add_u32 v51, 16, v51
    v_cmpx_lt_i32 vcc, 3, v10
    s_cbranch_execz p2_yb_0
    ds_write_b32 v49, v51 offset:12
    v_add_u32 v51, 16, v51
    v_cmpx_lt_i32 vcc, 4, v10
    s_cbranch_execz p2_yb_0
    ds_write_b32 v49, v51 offset:16
    v_add_u32 v51, 16, v51
    v_cmpx_lt_i32 vcc, 5, v10
    s_cbranch_execz p2_yb_0
    ds_write_b32 v49, v51 offset:20
    v_add_u32 v51, 16, v51
    v_cmpx_lt_i32 vcc, 6, v10
    s_cbranch_execz p2_yb_0
    ds_write_b32 v49, v51 offset:24
    v_add_u32 v51, 16, v51
    v_cmpx_lt_i32 vcc, 7, v10
    s_cbranch_execz p2_yb_0
    ds_write_b32 v49, v51 offset:28
    v_add_u32 v51, 16, v51
    v_subrev_u32 v10, 8, v10
    v_add_u32 v49, 32, v49
    s_branch p2_xb_0
p2_yb_0:
    s_mov_b64 exec, -1
p2_xb_1:
    v_cmpx_lt_i32 vcc, 0, v11
    s_cbranch_execz p2_yb_1
    ds_write_b32 v50, v52 offset:0
    v_add_u32 v52, 16, v52
    v_cmpx_lt_i32 vcc, 1, v11
    s_cbranch_execz p2_yb_1
    ds_write_b32 v50, v52 offset:4
    v_add_u32 v52, 16, v52
    v_cmpx_lt_i32 vcc, 2, v11
    s_cbranch_execz p2_yb_1
    ds_write_b32 v50, v52 offset:8
    v_add_u32 v52, 16, v52
    v_cmpx_lt_i32 vcc, 3, v11
    s_cbranch_execz p2_yb_1
    ds_write_b32 v50, v52 offset:12
    v_add_u32 v52, 16, v52
    v_cmpx_lt_i32 vcc, 4, v11
    s_cbranch_execz p2_yb_1
    ds_write_b32 v50, v52 offset:16
    v_add_u32 v52, 16, v52
    v_cmpx_lt_i32 vcc, 5, v11
    s_cbranch_execz p2_yb_1
    ds_write_b32 v50, v52 offset:20
    v_add_u32 v52, 16, v52
    v_cmpx_lt_i32 vcc, 6, v11
    s_cbranch_execz p2_yb_1
    ds_write_b32 v50, v52 offset:24
    v_add_u32 v52, 16, v52
    v_cmpx_lt_i32 vcc, 7, v11
    s_cbranch_execz p2_yb_1
    ds_write_b32 v50, v52 offset:28
    v_add_u32 v52, 16, v52
    v_subrev_u32 v11, 8, v11
    v_add_u32 v50, 32, v50
    s_branch p2_xb_1
p2_yb_1:
    s_mov_b64 exec, -1
    s_cmp_lt_u32 s38, 512
    s_cbranch_scc1 p2_nomoreb
    v_cmp_lt_u32_sdwa s[44:45], v110, v111 src0_sel:WORD_0 src1_sel:WORD_0
    v_cmp_lt_u32_sdwa s[46:47], v110, v111 src0_sel:WORD_1 src1_sel:WORD_1
    s_nop 0
    s_or_b64 s[44:45], s[44:45], s[46:47]
    s_cbranch_scc0 p2_nomoreb
    v_mov_b32 v49, s19
    v_mov_b32 v50, 1
    ds_write_b32 v49, v50 offset:53760
p2_nomoreb:
    s_mov_b32 m0, s23
    s_nop 0
    ds_read_addtid_b32 v102 offset:0
    ds_read_addtid_b32 v103 offset:256
    ds_read_addtid_b32 v104 offset:512
    ds_read_addtid_b32 v105 offset:768
    ds_read_addtid_b32 v106 offset:1024
    ds_read_addtid_b32 v107 offset:1280
    ds_read_addtid_b32 v108 offset:1536
    ds_read_addtid_b32 v109 offset:1792
    v_bfe_u32 v90, v92, 14, 4
    v_lshrrev_b32 v91, 18, v92
    v_and_b32 v92, 0x3fff, v92
    v_mad_u32_u24 v90, v90, s63, v91
    v_lshl_or_b32 v92, v90, 14, v92
    buffer_load_dwordx4 v[90:93], v92, s[68:71], 0 offen
    s_waitcnt vmcnt(6)
    s_mov_b32 m0, s24
    s_cmp_ge_u32 s10, 9
    s_cbranch_scc1 p2_stp
    ds_write_addtid_b32 v84 offset:49152
    ds_write_addtid_b32 v85 offset:49408
p2_stp:
    s_mov_b32 m0, s23
    s_add_u32 s20, s20, 53760
    ds_write_addtid_b32 v72 offset:0
    ds_write_addtid_b32 v73 offset:256
    ds_write_addtid_b32 v74 offset:512
    ds_write_addtid_b32 v75 offset:768
    ds_write_addtid_b32 v76 offset:1024
    ds_write_addtid_b32 v77 offset:1280
    ds_write_addtid_b32 v78 offset:1536
    ds_write_addtid_b32 v79 offset:1792
    ds_write_addtid_b32 v80 offset:2048
    ds_write_addtid_b32 v81 offset:2304
    ds_write_addtid_b32 v82 offset:2560
    ds_write_addtid_b32 v83 offset:2816
    s_waitcnt lgkmcnt(0)
    s_barrier
    v_bfe_u32 v94, v96, 14, 4
    v_lshrrev_b32 v95, 18, v96
    v_and_b32 v96, 0x3fff, v96
    v_mad_u32_u24 v94, v94, s63, v95
    v_lshl_or_b32 v96, v94, 14, v96
    buffer_load_dwordx4 v[94:97], v96, s[68:71], 0 offen
    v_bfe_u32 v98, v100, 14, 4
    v_lshrrev_b32 v99, 18, v100
    v_and_b32 v100, 0x3fff, v100
    v_mad_u32_u24 v98, v98, s63, v99
    v_lshl_or_b32 v100, v98, 14, v100
    buffer_load_dwordx4 v[98:101], v100, s[68:71], 0 offen
    s_cmp_ge_u32 s10, 9
    s_cbranch_scc1 p2_nmq
    v_lshrrev_b32 v84, 1, v112
    s_add_u32 s44, s20, s42
    buffer_load_dwordx2 v[84:85], v84, s[4:7], s44 offen
p2_nmq:
    buffer_load_dwordx4 v[72:75], v112, s[4:7], s20 offen offset:0
    buffer_load_dwordx4 v[76:79], v112, s[4:7], s20 offen offset:1024
    buffer_load_dwordx4 v[80:83], v112, s[4:7], s20 offen offset:2048
    s_waitcnt vmcnt(10)
    v_perm_b32 v48, v3, v0, s31
    v_perm_b32 v49, v3, v1, s32
    v_perm_b32 v50, v3, v2, s33
    v_lshlrev_b16 v4, 3, v2
    v_lshlrev_b16 v2, 3, v1
    v_lshlrev_b16 v0, 3, v0
    v_cmpx_ge_u16 vcc, 0x3fff, v48
    ds_read_b64 v[0:1], v0
    s_mov_b64 exec, -1
    v_cmpx_ge_u16 vcc, 0x3fff, v49
    ds_read_b64 v[2:3], v2
    s_mov_b64 exec, -1
    v_cmpx_ge_u16 vcc, 0x3fff, v50
    ds_read_b64 v[4:5], v4
    s_mov_b64 exec, -1
    s_waitcnt vmcnt(9)
    v_perm_b32 v51, v9, v6, s31
    v_perm_b32 v52, v9, v7, s32
    v_perm_b32 v53, v9, v8, s33
    v_lshlrev_b16 v10, 3, v8
    v_lshlrev_b16 v8, 3, v7
    v_lshlrev_b16 v6, 3, v6
    v_cmpx_ge_u16 vcc, 0x3fff, v51
    ds_read_b64 v[6:7], v6
    s_mov_b64 exec, -1
    v_cmpx_ge_u16 vcc, 0x3fff, v52
    ds_read_b64 v[8:9], v8
    s_mov_b64 exec, -1
    v_cmpx_ge_u16 vcc, 0x3fff, v53
    ds_read_b64 v[10:11], v10
    s_mov_b64 exec, -1
    s_waitcnt vmcnt(8)
    v_perm_b32 v54, v15, v12, s31
    v_perm_b32 v55, v15, v13, s32
    v_perm_b32 v56, v15, v14, s33
    v_lshlrev_b16 v16, 3, v14
    v_lshlrev_b16 v14, 3, v13
    v_lshlrev_b16 v12, 3, v12
    v_cmpx_ge_u16 vcc, 0x3fff, v54
    ds_read_b64 v[12:13], v12
    s_mov_b64 exec, -1
    v_cmpx_ge_u16 vcc, 0x3fff, v55
    ds_read_b64 v[14:15], v14
    s_mov_b64 exec, -1
    v_cmpx_ge_u16 vcc, 0x3fff, v56
    ds_read_b64 v[16:17], v16
    s_mov_b64 exec, -1
    s_waitcnt vmcnt(7)
    v_perm_b32 v57, v21, v18, s31
    v_perm_b32 v58, v21, v19, s32
    v_perm_b32 v59, v21, v20, s33
    v_lshlrev_b16 v22, 3, v20
    v_lshlrev_b16 v20, 3, v19
    v_lshlrev_b16 v18, 3, v18
    v_cmpx_ge_u16 vcc, 0x3fff, v57
    ds_read_b64 v[18:19], v18
    s_mov_b64 exec, -1
    v_cmpx_ge_u16 vcc, 0x3fff, v58
    ds_read_b64 v[20:21], v20
    s_mov_b64 exec, -1
    v_cmpx_ge_u16 vcc, 0x3fff, v59
    ds_read_b64 v[22:23], v22
    s_mov_b64 exec, -1
    s_waitcnt vmcnt(6)
    v_perm_b32 v60, v89, v86, s31
    v_perm_b32 v61, v89, v87, s32
    v_perm_b32 v62, v89, v88, s33
    v_lshlrev_b16 v28, 3, v88
    v_lshlrev_b16 v26, 3, v87
    v_lshlrev_b16 v24, 3, v86
    v_cmpx_ge_u16 vcc, 0x3fff, v60
    ds_read_b64 v[24:25], v24
    s_mov_b64 exec, -1
    v_cmpx_ge_u16 vcc, 0x3fff, v61
    ds_read_b64 v[26:27], v26
    s_mov_b64 exec, -1
    v_cmpx_ge_u16 vcc, 0x3fff, v62
    ds_read_b64 v[28:29], v28
    s_mov_b64 exec, -1
    v_bfe_u32 v86, v106, 14, 4
    v_lshrrev_b32 v87, 18, v106
    v_and_b32 v106, 0x3fff, v106
    v_mad_u32_u24 v86, v86, s63, v87
    v_lshl_or_b32 v106, v86, 14, v106
    buffer_load_dwordx4 v[86:89], v106, s[68:71], 0 offen
    s_waitcnt vmcnt(6)
    v_perm_b32 v63, v93, v90, s31
    v_perm_b32 v64, v93, v91, s32
    v_perm_b32 v65, v93, v92, s33
    v_lshlrev_b16 v34, 3, v92
    v_lshlrev_b16 v32, 3, v91
    v_lshlrev_b16 v30, 3, v90
    v_cmpx_ge_u16 vcc, 0x3fff, v63
    ds_read_b64 v[30:31], v30
    s_mov_b64 exec, -1
    v_cmpx_ge_u16 vcc, 0x3fff, v64
    ds_read_b64 v[32:33], v32
    s_mov_b64 exec, -1
    v_cmpx_ge_u16 vcc, 0x3fff, v65
    ds_read_b64 v[34:35], v34
    s_mov_b64 exec, -1
    v_bfe_u32 v90, v107, 14, 4
    v_lshrrev_b32 v91, 18, v107
    v_and_b32 v107, 0x3fff, v107
    v_mad_u32_u24 v90, v90, s63, v91
    v_lshl_or_b32 v107, v90, 14, v107
    buffer_load_dwordx4 v[90:93], v107, s[68:71], 0 offen
    s_waitcnt vmcnt(6)
    v_perm_b32 v66, v97, v94, s31
    v_perm_b32 v67, v97, v95, s32
    v_perm_b32 v68, v97, v96, s33
    v_lshlrev_b16 v40, 3, v96
    v_lshlrev_b16 v38, 3, v95
    v_lshlrev_b16 v36, 3, v94
    v_cmpx_ge_u16 vcc, 0x3fff, v66
    ds_read_b64 v[36:37], v36
    s_mov_b64 exec, -1
    v_cmpx_ge_u16 vcc, 0x3fff, v67
    ds_read_b64 v[38:39], v38
    s_mov_b64 exec, -1
    v_cmpx_ge_u16 vcc, 0x3fff, v68
    ds_read_b64 v[40:41], v40
    s_mov_b64 exec, -1
    s_waitcnt vmcnt(5)
    v_perm_b32 v69, v101, v98, s31
    v_perm_b32 v70, v101, v99, s32
    v_perm_b32 v71, v101, v100, s33
    v_lshlrev_b16 v46, 3, v100
    v_lshlrev_b16 v44, 3, v99
    v_lshlrev_b16 v42, 3, v98
    s_cmp_le_u32 s16, 7
    s_cbranch_scc1 p2_gp
    v_cmpx_ge_u16 vcc, 0x3fff, v69
    ds_read_b64 v[42:43], v42
    s_mov_b64 exec, -1
    v_cmpx_ge_u16 vcc, 0x3fff, v70
    ds_read_b64 v[44:45], v44
    s_mov_b64 exec, -1
    v_cmpx_ge_u16 vcc, 0x3fff, v71
    ds_read_b64 v[46:47], v46
    s_mov_b64 exec, -1
p2_gp:
    s_waitcnt lgkmcnt(0)
    s_barrier
    s_branch p2_tail
p2_top:
    s_cmp_lg_u32 s21, 0
    s_cbranch_scc1 p2_topf
    s_cmp_eq_u32 s60, 10
    s_cbranch_scc1 p2_drain0
    v_cmpx_gt_i16 vcc, 0, v48
    ds_read_b64 v[0:1], v0
    s_mov_b64 exec, -1
    v_cmpx_gt_i16 vcc, 0, v49
    ds_read_b64 v[2:3], v2
    s_mov_b64 exec, -1
    v_cmpx_gt_i16 vcc, 0, v50
    ds_read_b64 v[4:5], v4
    s_mov_b64 exec, -1
    v_cmpx_gt_i16 vcc, 0, v51
    ds_read_b64 v[6:7], v6
    s_mov_b64 exec, -1
    v_cmpx_gt_i16 vcc, 0, v52
    ds_read_b64 v[8:9], v8
    s_mov_b64 exec, -1
    v_cmpx_gt_i16 vcc, 0, v53
    ds_read_b64 v[10:11], v10
    s_mov_b64 exec, -1
    v_cmpx_gt_i16 vcc, 0, v54
    ds_read_b64 v[12:13], v12
    s_mov_b64 exec, -1
    v_cmpx_gt_i16 vcc, 0, v55
    ds_read_b64 v[14:15], v14
    s_mov_b64 exec, -1
    v_cmpx_gt_i16 vcc, 0, v56
    ds_read_b64 v[16:17], v16
    s_mov_b64 exec, -1
    v_cmpx_gt_i16 vcc, 0, v57
    ds_read_b64 v[18:19], v18
    s_mov_b64 exec, -1
    v_cmpx_gt_i16 vcc, 0, v58
    ds_read_b64 v[20:21], v20
    s_mov_b64 exec, -1
    v_cmpx_gt_i16 vcc, 0, v59
    ds_read_b64 v[22:23], v22
    s_mov_b64 exec, -1
    s_cmp_ge_u32 s10, 9
    s_cbranch_scc1 p2_nm0m0a
    v_lshrrev_b32 v84, 1, v112
    s_add_u32 s44, s20, s42
    buffer_load_dwordx2 v[84:85], v84, s[4:7], s44 offen
p2_nm0m0a:
    buffer_load_dwordx4 v[72:75], v112, s[4:7], s20 offen offset:0
    buffer_load_dwordx4 v[76:79], v112, s[4:7], s20 offen offset:1024
    buffer_load_dwordx4 v[80:83], v112, s[4:7], s20 offen offset:2048
    v_cmpx_gt_i16 vcc, 0, v60
    ds_read_b64 v[24:25], v24
    s_mov_b64 exec, -1
    v_cmpx_gt_i16 vcc, 0, v61
    ds_read_b64 v[26:27], v26
    s_mov_b64 exec, -1
    v_cmpx_gt_i16 vcc, 0, v62
    ds_read_b64 v[28:29], v28
    s_mov_b64 exec, -1
    v_cmpx_gt_i16 vcc, 0, v63
    ds_read_b64 v[30:31], v30
    s_mov_b64 exec, -1
    v_cmpx_gt_i16 vcc, 0, v64
    ds_read_b64 v[32:33], v32
    s_mov_b64 exec, -1
    v_cmpx_gt_i16 vcc, 0, v65
    ds_read_b64 v[34:35], v34
    s_mov_b64 exec, -1
    v_cmpx_gt_i16 vcc, 0, v66
    ds_read_b64 v[36:37], v36
    s_mov_b64 exec, -1
    v_cmpx_gt_i16 vcc, 0, v67
    ds_read_b64 v[38:39], v38
    s_mov_b64 exec, -1
    v_cmpx_gt_i16 vcc, 0, v68
    ds_read_b64 v[40:41], v40
    s_mov_b64 exec, -1
    s_cmp_le_u32 s15, 7
    s_cbranch_scc1 p2_g0r27
    v_cmpx_gt_i16 vcc, 0, v69
    ds_read_b64 v[42:43], v42
    s_mov_b64 exec, -1
    v_cmpx_gt_i16 vcc, 0, v70
    ds_read_b64 v[44:45], v44
    s_mov_b64 exec, -1
    v_cmpx_gt_i16 vcc, 0, v71
    ds_read_b64 v[46:47], v46
    s_mov_b64 exec, -1
p2_g0r27:
    s_waitcnt lgkmcnt(15)
    v_ashrrev_i32 v122, 5, v48
    v_lshlrev_b16 v123, 2, v48
    v_lshlrev_b32 v124, 16, v0
    v_bitop3_b32 v122, v122, v113, v113 bitop3:0x0c
    v_and_b32 v125, 0xffff0000, v0
    v_lshlrev_b32 v126, 16, v1
    v_mul_f32 v122, v114, v122
    v_and_b32 v127, 0xffff0000, v1
    v_add_u32 v123, v123, v123
    v_pk_fma_f32 v[124:125], v[124:125], v[122:123], s[34:35] op_sel_hi:[1,0,1]
    v_pk_fma_f32 v[126:127], v[126:127], v[122:123], s[34:35] op_sel_hi:[1,0,1]
    v_lshl_add_u32 v124, v125, 16, v124
    v_lshl_add_u32 v125, v127, 16, v126
    s_waitcnt lgkmcnt(15)
    v_bitop3_b32 v115, v115, v116, v117 bitop3:0xfe
    v_lshl_add_u64 v[124:125], v[124:125], 0, s[36:37]
    v_cmpx_le_u32 vcc, 0x1000000, v48
    ds_add_rtn_u64 v[116:117], v123, v[124:125] offset:54272
    s_mov_b64 exec, -1
    v_ashrrev_i32 v122, 5, v49
    v_lshlrev_b16 v123, 2, v49
    v_lshlrev_b32 v124, 16, v2
    v_bitop3_b32 v122, v122, v113, v113 bitop3:0x0c
    v_and_b32 v125, 0xffff0000, v2
    v_lshlrev_b32 v126, 16, v3
    v_mul_f32 v122, v114, v122
    v_and_b32 v127, 0xffff0000, v3
    v_add_u32 v123, v123, v123
    v_pk_fma_f32 v[124:125], v[124:125], v[122:123], s[34:35] op_sel_hi:[1,0,1]
    v_pk_fma_f32 v[126:127], v[126:127], v[122:123], s[34:35] op_sel_hi:[1,0,1]
    v_lshl_add_u32 v124, v125, 16, v124
    v_lshl_add_u32 v125, v127, 16, v126
    s_waitcnt lgkmcnt(15)
    v_bitop3_b32 v115, v115, v118, v119 bitop3:0xfe
    v_lshl_add_u64 v[124:125], v[124:125], 0, s[36:37]
    v_cmpx_le_u32 vcc, 0x1000000, v49
    ds_add_rtn_u64 v[118:119], v123, v[124:125] offset:54272
    s_mov_b64 exec, -1
    v_ashrrev_i32 v122, 5, v50
    v_lshlrev_b16 v123, 2, v50
    v_lshlrev_b32 v124, 16, v4
    v_bitop3_b32 v122, v122, v113, v113 bitop3:0x0c
    v_and_b32 v125, 0xffff0000, v4
    v_lshlrev_b32 v126, 16, v5
    v_mul_f32 v122, v114, v122
    v_and_b32 v127, 0xffff0000, v5
    v_add_u32 v123, v123, v123
    v_pk_fma_f32 v[124:125], v[124:125], v[122:123], s[34:35] op_sel_hi:[1,0,1]
    v_pk_fma_f32 v[126:127], v[126:127], v[122:123], s[34:35] op_sel_hi:[1,0,1]
    v_lshl_add_u32 v124, v125, 16, v124
    v_lshl_add_u32 v125, v127, 16, v126
    s_waitcnt lgkmcnt(15)
    v_bitop3_b32 v115, v115, v120, v121 bitop3:0xfe
    v_lshl_add_u64 v[124:125], v[124:125], 0, s[36:37]
    v_cmpx_le_u32 vcc, 0x1000000, v50
    ds_add_rtn_u64 v[120:121], v123, v[124:125] offset:54272
    s_mov_b64 exec, -1
    v_bfe_u32 v0, v102, 14, 4
    v_lshrrev_b32 v1, 18, v102
    v_and_b32 v102, 0x3fff, v102
    v_mad_u32_u24 v0, v0, s63, v1
    v_lshl_or_b32 v102, v0, 14, v102
    buffer_load_dwordx4 v[0:3], v102, s[68:71], 0 offen
    s_waitcnt lgkmcnt(15)
    v_ashrrev_i32 v122, 5, v51
    v_lshlrev_b16 v123, 2, v51
    v_lshlrev_b32 v124, 16, v6
    v_bitop3_b32 v122, v122, v113, v113 bitop3:0x0c
    v_and_b32 v125, 0xffff0000, v6
    v_lshlrev_b32 v126, 16, v7
    v_mul_f32 v122, v114, v122
    v_and_b32 v127, 0xffff0000, v7
    v_add_u32 v123, v123, v123
    v_pk_fma_f32 v[124:125], v[124:125], v[122:123], s[34:35] op_sel_hi:[1,0,1]
    v_pk_fma_f32 v[126:127], v[126:127], v[122:123], s[34:35] op_sel_hi:[1,0,1]
    v_lshl_add_u32 v124, v125, 16, v124
    v_lshl_add_u32 v125, v127, 16, v126
    s_waitcnt lgkmcnt(2)
    v_bitop3_b32 v115, v115, v116, v117 bitop3:0xfe
    v_lshl_add_u64 v[124:125], v[124:125], 0, s[36:37]
    v_cmpx_le_u32 vcc, 0x1000000, v51
    ds_add_rtn_u64 v[116:117], v123, v[124:125] offset:54272
    s_mov_b64 exec, -1
    v_ashrrev_i32 v122, 5, v52
    v_lshlrev_b16 v123, 2, v52
    v_lshlrev_b32 v124, 16, v8
    v_bitop3_b32 v122, v122, v113, v113 bitop3:0x0c
    v_and_b32 v125, 0xffff0000, v8
    v_lshlrev_b32 v126, 16, v9
    v_mul_f32 v122, v114, v122
    v_and_b32 v127, 0xffff0000, v9
    v_add_u32 v123, v123, v123
    v_pk_fma_f32 v[124:125], v[124:125], v[122:123], s[34:35] op_sel_hi:[1,0,1]
    v_pk_fma_f32 v[126:127], v[126:127], v[122:123], s[34:35] op_sel_hi:[1,0,1]
    v_lshl_add_u32 v124, v125, 16, v124
    v_lshl_add_u32 v125, v127, 16, v126
    s_waitcnt lgkmcnt(2)
    v_bitop3_b32 v115, v115, v118, v119 bitop3:0xfe
    v_lshl_add_u64 v[124:125], v[124:125], 0, s[36:37]
    v_cmpx_le_u32 vcc, 0x1000000, v52
    ds_add_rtn_u64 v[118:119], v123, v[124:125] offset:54272
    s_mov_b64 exec, -1
    v_ashrrev_i32 v122, 5, v53
    v_lshlrev_b16 v123, 2, v53
    v_lshlrev_b32 v124, 16, v10
    v_bitop3_b32 v122, v122, v113, v113 bitop3:0x0c
    v_and_b32 v125, 0xffff0000, v10
    v_lshlrev_b32 v126, 16, v11
    v_mul_f32 v122, v114, v122
    v_and_b32 v127, 0xffff0000, v11
    v_add_u32 v123, v123, v123
    v_pk_fma_f32 v[124:125], v[124:125], v[122:123], s[34:35] op_sel_hi:[1,0,1]
    v_pk_fma_f32 v[126:127], v[126:127], v[122:123], s[34:35] op_sel_hi:[1,0,1]
    v_lshl_add_u32 v124, v125, 16, v124
    v_lshl_add_u32 v125, v127, 16, v126
    s_waitcnt lgkmcnt(2)
    v_bitop3_b32 v115, v115, v120, v121 bitop3:0xfe
    v_lshl_add_u64 v[124:125], v[124:125], 0, s[36:37]
    v_cmpx_le_u32 vcc, 0x1000000, v53
    ds_add_rtn_u64 v[120:121], v123, v[124:125] offset:54272
    s_mov_b64 exec, -1
    v_bfe_u32 v6, v103, 14, 4
    v_lshrrev_b32 v7, 18, v103
    v_and_b32 v103, 0x3fff, v103
    v_mad_u32_u24 v6, v6, s63, v7
    v_lshl_or_b32 v103, v6, 14, v103
    buffer_load_dwordx4 v[6:9], v103, s[68:71], 0 offen
    s_waitcnt lgkmcnt(6)
    s_barrier
    s_waitcnt vmcnt(6)
    s_mov_b32 m0, s23
    v_mov_b32 v53, 0x3c000
    s_movk_i32 s44, 512
    v_sub_u32_sdwa v4, v111, v110 dst_sel:DWORD dst_unused:UNUSED_PAD src0_sel:WORD_0 src1_sel:WORD_0
    v_sub_u32_sdwa v5, v111, v110 dst_sel:DWORD dst_unused:UNUSED_PAD src0_sel:WORD_1 src1_sel:WORD_1
    v_med3_i32 v4, v4, 0, s44
    v_med3_i32 v5, v5, 0, s44
    v_add_u32 v48, v4, v5
    ds_write_addtid_b32 v53 offset:0
    ds_write_addtid_b32 v53 offset:256
    ds_write_addtid_b32 v53 offset:512
    ds_write_addtid_b32 v53 offset:768
    ds_write_addtid_b32 v53 offset:1024
    ds_write_addtid_b32 v53 offset:1280
    ds_write_addtid_b32 v53 offset:1536
    ds_write_addtid_b32 v53 offset:1792
    v_bfe_i32 v53, v112, 6, 1
    v_lshrrev_b32 v49, 6, v112
    v_bitop3_b32 v53, v53, 15, s10 bitop3:0x6a
    v_lshl_or_b32 v49, v49, 4, v53
    v_and_b32 v53, 0x30, v112
    v_lshl_or_b32 v53, v49, 6, v53
    v_lshlrev_b32 v53, 15, v53
    s_nop 1
    v_add_u32_dpp v48, v48, v48 row_shr:1 row_mask:0xf bank_mask:0xf bound_ctrl:0
    s_nop 1
    v_add_u32_dpp v48, v48, v48 row_shr:2 row_mask:0xf bank_mask:0xf bound_ctrl:0
    s_nop 1
    v_add_u32_dpp v48, v48, v48 row_shr:4 row_mask:0xf bank_mask:0xf bound_ctrl:0
    s_nop 1
    v_add_u32_dpp v48, v48, v48 row_shr:8 row_mask:0xf bank_mask:0xf bound_ctrl:0
    s_nop 1
    v_add_u32_dpp v48, v48, v48 row_bcast:15 row_mask:0xa bank_mask:0xf
    s_nop 1
    v_add_u32_dpp v48, v48, v48 row_bcast:31 row_mask:0xc bank_mask:0xf
    s_nop 1
    s_nop 0
    v_readlane_b32 s38, v48, 63
    v_sub_u32 v50, v48, v5
    v_sub_u32 v49, v50, v4
    v_sub_u32 v10, 512, v49
    v_mad_u32_u16 v51, v110, 16, v53
    v_med3_i32 v10, v10, 0, v4
    v_lshl_add_u32 v49, v49, 2, s23
    v_sub_u32 v11, 512, v50
    v_mad_u32_u16 v52, v110, 16, v53 op_sel:[1,0,0,0]
    v_med3_i32 v11, v11, 0, v5
    v_lshl_add_u32 v50, v50, 2, s23
    v_lshl_add_u32 v48, v11, 16, v10
    v_add_u32 v52, 262144, v52
    v_add_u32 v110, v110, v48
    s_min_u32 s17, s38, 512
    s_add_u32 s17, s17, 63
    s_lshr_b32 s17, s17, 6
p2_x0x_0:
    v_cmpx_lt_i32 vcc, 0, v10
    s_cbranch_execz p2_y0x_0
    ds_write_b32 v49, v51 offset:0
    v_add_u32 v51, 16, v51
    v_cmpx_lt_i32 vcc, 1, v10
    s_cbranch_execz p2_y0x_0
    ds_write_b32 v49, v51 offset:4
    v_add_u32 v51, 16, v51
    v_cmpx_lt_i32 vcc, 2, v10
    s_cbranch_execz p2_y0x_0
    ds_write_b32 v49, v51 offset:8
    v_add_u32 v51, 16, v51
    v_cmpx_lt_i32 vcc, 3, v10
    s_cbranch_execz p2_y0x_0
    ds_write_b32 v49, v51 offset:12
    v_add_u32 v51, 16, v51
    v_cmpx_lt_i32 vcc, 4, v10
    s_cbranch_execz p2_y0x_0
    ds_write_b32 v49, v51 offset:16
    v_add_u32 v51, 16, v51
    v_cmpx_lt_i32 vcc, 5, v10
    s_cbranch_execz p2_y0x_0
    ds_write_b32 v49, v51 offset:20
    v_add_u32 v51, 16, v51
    v_cmpx_lt_i32 vcc, 6, v10
    s_cbranch_execz p2_y0x_0
    ds_write_b32 v49, v51 offset:24
    v_add_u32 v51, 16, v51
    v_cmpx_lt_i32 vcc, 7, v10
    s_cbranch_execz p2_y0x_0
    ds_write_b32 v49, v51 offset:28
    v_add_u32 v51, 16, v51
    v_subrev_u32 v10, 8, v10
    v_add_u32 v49, 32, v49
    s_branch p2_x0x_0
p2_y0x_0:
    s_mov_b64 exec, -1
p2_x0x_1:
    v_cmpx_lt_i32 vcc, 0, v11
    s_cbranch_execz p2_y0x_1
    ds_write_b32 v50, v52 offset:0
    v_add_u32 v52, 16, v52
    v_cmpx_lt_i32 vcc, 1, v11
    s_cbranch_execz p2_y0x_1
    ds_write_b32 v50, v52 offset:4
    v_add_u32 v52, 16, v52
    v_cmpx_lt_i32 vcc, 2, v11
    s_cbranch_execz p2_y0x_1
    ds_write_b32 v50, v52 offset:8
    v_add_u32 v52, 16, v52
    v_cmpx_lt_i32 vcc, 3, v11
    s_cbranch_execz p2_y0x_1
    ds_write_b32 v50, v52 offset:12
    v_add_u32 v52, 16, v52
    v_cmpx_lt_i32 vcc, 4, v11
    s_cbranch_execz p2_y0x_1
    ds_write_b32 v50, v52 offset:16
    v_add_u32 v52, 16, v52
    v_cmpx_lt_i32 vcc, 5, v11
    s_cbranch_execz p2_y0x_1
    ds_write_b32 v50, v52 offset:20
    v_add_u32 v52, 16, v52
    v_cmpx_lt_i32 vcc, 6, v11
    s_cbranch_execz p2_y0x_1
    ds_write_b32 v50, v52 offset:24
    v_add_u32 v52, 16, v52
    v_cmpx_lt_i32 vcc, 7, v11
    s_cbranch_execz p2_y0x_1
    ds_write_b32 v50, v52 offset:28
    v_add_u32 v52, 16, v52
    v_subrev_u32 v11, 8, v11
    v_add_u32 v50, 32, v50
    s_branch p2_x0x_1
p2_y0x_1:
    s_mov_b64 exec, -1
    s_cmp_lt_u32 s38, 512
    s_cbranch_scc1 p2_nomore0x
    v_cmp_lt_u32_sdwa s[44:45], v110, v111 src0_sel:WORD_0 src1_sel:WORD_0
    v_cmp_lt_u32_sdwa s[46:47], v110, v111 src0_sel:WORD_1 src1_sel:WORD_1
    s_nop 0
    s_or_b64 s[44:45], s[44:45], s[46:47]
    s_cbranch_scc0 p2_nomore0x
    v_mov_b32 v49, s19
    v_mov_b32 v50, 1
    ds_write_b32 v49, v50 offset:53760
p2_nomore0x:
    s_waitcnt lgkmcnt(15)
    v_ashrrev_i32 v122, 5, v54
    v_lshlrev_b16 v123, 2, v54
    v_lshlrev_b32 v124, 16, v12
    v_bitop3_b32 v122, v122, v113, v113 bitop3:0x0c
    v_and_b32 v125, 0xffff0000, v12
    v_lshlrev_b32 v126, 16, v13
    v_mul_f32 v122, v114, v122
    v_and_b32 v127, 0xffff0000, v13
    v_add_u32 v123, v123, v123
    v_pk_fma_f32 v[124:125], v[124:125], v[122:123], s[34:35] op_sel_hi:[1,0,1]
    v_pk_fma_f32 v[126:127], v[126:127], v[122:123], s[34:35] op_sel_hi:[1,0,1]
    v_lshl_add_u32 v124, v125, 16, v124
    v_lshl_add_u32 v125, v127, 16, v126
    s_waitcnt lgkmcnt(10)
    v_bitop3_b32 v115, v115, v116, v117 bitop3:0xfe
    v_lshl_add_u64 v[124:125], v[124:125], 0, s[36:37]
    v_cmpx_le_u32 vcc, 0x1000000, v54
    ds_add_rtn_u64 v[116:117], v123, v[124:125] offset:54272
    s_mov_b64 exec, -1
    v_ashrrev_i32 v122, 5, v55
    v_lshlrev_b16 v123, 2, v55
    v_lshlrev_b32 v124, 16, v14
    v_bitop3_b32 v122, v122, v113, v113 bitop3:0x0c
    v_and_b32 v125, 0xffff0000, v14
    v_lshlrev_b32 v126, 16, v15
    v_mul_f32 v122, v114, v122
    v_and_b32 v127, 0xffff0000, v15
    v_add_u32 v123, v123, v123
    v_pk_fma_f32 v[124:125], v[124:125], v[122:123], s[34:35] op_sel_hi:[1,0,1]
    v_pk_fma_f32 v[126:127], v[126:127], v[122:123], s[34:35] op_sel_hi:[1,0,1]
    v_lshl_add_u32 v124, v125, 16, v124
    v_lshl_add_u32 v125, v127, 16, v126
    s_waitcnt lgkmcnt(10)
    v_bitop3_b32 v115, v115, v118, v119 bitop3:0xfe
    v_lshl_add_u64 v[124:125], v[124:125], 0, s[36:37]
    v_cmpx_le_u32 vcc, 0x1000000, v55
    ds_add_rtn_u64 v[118:119], v123, v[124:125] offset:54272
    s_mov_b64 exec, -1
    v_ashrrev_i32 v122, 5, v56
    v_lshlrev_b16 v123, 2, v56
    v_lshlrev_b32 v124, 16, v16
    v_bitop3_b32 v122, v122, v113, v113 bitop3:0x0c
    v_and_b32 v125, 0xffff0000, v16
    v_lshlrev_b32 v126, 16, v17
    v_mul_f32 v122, v114, v122
    v_and_b32 v127, 0xffff0000, v17
    v_add_u32 v123, v123, v123
    v_pk_fma_f32 v[124:125], v[124:125], v[122:123], s[34:35] op_sel_hi:[1,0,1]
    v_pk_fma_f32 v[126:127], v[126:127], v[122:123], s[34:35] op_sel_hi:[1,0,1]
    v_lshl_add_u32 v124, v125, 16, v124
    v_lshl_add_u32 v125, v127, 16, v126
    s_waitcnt lgkmcnt(10)
    v_bitop3_b32 v115, v115, v120, v121 bitop3:0xfe
    v_lshl_add_u64 v[124:125], v[124:125], 0, s[36:37]
    v_cmpx_le_u32 vcc, 0x1000000, v56
    ds_add_rtn_u64 v[120:121], v123, v[124:125] offset:54272
    s_mov_b64 exec, -1
    v_bfe_u32 v12, v104, 14, 4
    v_lshrrev_b32 v13, 18, v104
    v_and_b32 v104, 0x3fff, v104
    v_mad_u32_u24 v12, v12, s63, v13
    v_lshl_or_b32 v104, v12, 14, v104
    buffer_load_dwordx4 v[12:15], v104, s[68:71], 0 offen
    s_waitcnt lgkmcnt(15)
    v_ashrrev_i32 v122, 5, v57
    v_lshlrev_b16 v123, 2, v57
    v_lshlrev_b32 v124, 16, v18
    v_bitop3_b32 v122, v122, v113, v113 bitop3:0x0c
    v_and_b32 v125, 0xffff0000, v18
    v_lshlrev_b32 v126, 16, v19
    v_mul_f32 v122, v114, v122
    v_and_b32 v127, 0xffff0000, v19
    v_add_u32 v123, v123, v123
    v_pk_fma_f32 v[124:125], v[124:125], v[122:123], s[34:35] op_sel_hi:[1,0,1]
    v_pk_fma_f32 v[126:127], v[126:127], v[122:123], s[34:35] op_sel_hi:[1,0,1]
    v_lshl_add_u32 v124, v125, 16, v124
    v_lshl_add_u32 v125, v127, 16, v126
    s_waitcnt lgkmcnt(2)
    v_bitop3_b32 v115, v115, v116, v117 bitop3:0xfe
    v_lshl_add_u64 v[124:125], v[124:125], 0, s[36:37]
    v_cmpx_le_u32 vcc, 0x1000000, v57
    ds_add_rtn_u64 v[116:117], v123, v[124:125] offset:54272
    s_mov_b64 exec, -1
    v_ashrrev_i32 v122, 5, v58
    v_lshlrev_b16 v123, 2, v58
    v_lshlrev_b32 v124, 16, v20
    v_bitop3_b32 v122, v122, v113, v113 bitop3:0x0c
    v_and_b32 v125, 0xffff0000, v20
    v_lshlrev_b32 v126, 16, v21
    v_mul_f32 v122, v114, v122
    v_and_b32 v127, 0xffff0000, v21
    v_add_u32 v123, v123, v123
    v_pk_fma_f32 v[124:125], v[124:125], v[122:123], s[34:35] op_sel_hi:[1,0,1]
    v_pk_fma_f32 v[126:127], v[126:127], v[122:123], s[34:35] op_sel_hi:[1,0,1]
    v_lshl_add_u32 v124, v125, 16, v124
    v_lshl_add_u32 v125, v127, 16, v126
    s_waitcnt lgkmcnt(2)
    v_bitop3_b32 v115, v115, v118, v119 bitop3:0xfe
    v_lshl_add_u64 v[124:125], v[124:125], 0, s[36:37]
    v_cmpx_le_u32 vcc, 0x1000000, v58
    ds_add_rtn_u64 v[118:119], v123, v[124:125] offset:54272
    s_mov_b64 exec, -1
    v_ashrrev_i32 v122, 5, v59
    v_lshlrev_b16 v123, 2, v59
    v_lshlrev_b32 v124, 16, v22
    v_bitop3_b32 v122, v122, v113, v113 bitop3:0x0c
    v_and_b32 v125, 0xffff0000, v22
    v_lshlrev_b32 v126, 16, v23
    v_mul_f32 v122, v114, v122
    v_and_b32 v127, 0xffff0000, v23
    v_add_u32 v123, v123, v123
    v_pk_fma_f32 v[124:125], v[124:125], v[122:123], s[34:35] op_sel_hi:[1,0,1]
    v_pk_fma_f32 v[126:127], v[126:127], v[122:123], s[34:35] op_sel_hi:[1,0,1]
    v_lshl_add_u32 v124, v125, 16, v124
    v_lshl_add_u32 v125, v127, 16, v126
    s_waitcnt lgkmcnt(2)
    v_bitop3_b32 v115, v115, v120, v121 bitop3:0xfe
    v_lshl_add_u64 v[124:125], v[124:125], 0, s[36:37]
    v_cmpx_le_u32 vcc, 0x1000000, v59
    ds_add_rtn_u64 v[120:121], v123, v[124:125] offset:54272
    s_mov_b64 exec, -1
    v_bfe_u32 v18, v105, 14, 4
    v_lshrrev_b32 v19, 18, v105
    v_and_b32 v105, 0x3fff, v105
    v_mad_u32_u24 v18, v18, s63, v19
    v_lshl_or_b32 v105, v18, 14, v105
    buffer_load_dwordx4 v[18:21], v105, s[68:71], 0 offen
    s_mov_b32 m0, s23
    s_nop 0
    ds_read_addtid_b32 v102 offset:0
    ds_read_addtid_b32 v103 offset:256
    ds_read_addtid_b32 v104 offset:512
    ds_read_addtid_b32 v105 offset:768
    ds_read_addtid_b32 v106 offset:1024
    ds_read_addtid_b32 v107 offset:1280
    ds_read_addtid_b32 v108 offset:1536
    ds_read_addtid_b32 v109 offset:1792
    s_waitcnt vmcnt(4)
    s_mov_b32 m0, s24
    s_cmp_ge_u32 s10, 9
    s_cbranch_scc1 p2_st0s0
    ds_write_addtid_b32 v84 offset:49152
    ds_write_addtid_b32 v85 offset:49408
p2_st0s0:
    s_mov_b32 m0, s23
    s_add_u32 s20, s20, 53760
    ds_write_addtid_b32 v72 offset:0
    ds_write_addtid_b32 v73 offset:256
    ds_write_addtid_b32 v74 offset:512
    ds_write_addtid_b32 v75 offset:768
    ds_write_addtid_b32 v76 offset:1024
    ds_write_addtid_b32 v77 offset:1280
    ds_write_addtid_b32 v78 offset:1536
    ds_write_addtid_b32 v79 offset:1792
    ds_write_addtid_b32 v80 offset:2048
    ds_write_addtid_b32 v81 offset:2304
    ds_write_addtid_b32 v82 offset:2560
    ds_write_addtid_b32 v83 offset:2816
    s_waitcnt lgkmcnt(15)
    v_ashrrev_i32 v122, 5, v60
    v_lshlrev_b16 v123, 2, v60
    v_lshlrev_b32 v124, 16, v24
    v_bitop3_b32 v122, v122, v113, v113 bitop3:0x0c
    v_and_b32 v125, 0xffff0000, v24
    v_lshlrev_b32 v126, 16, v25
    v_mul_f32 v122, v114, v122
    v_and_b32 v127, 0xffff0000, v25
    v_add_u32 v123, v123, v123
    v_pk_fma_f32 v[124:125], v[124:125], v[122:123], s[34:35] op_sel_hi:[1,0,1]
    v_pk_fma_f32 v[126:127], v[126:127], v[122:123], s[34:35] op_sel_hi:[1,0,1]
    v_lshl_add_u32 v124, v125, 16, v124
    v_lshl_add_u32 v125, v127, 16, v126
    s_waitcnt lgkmcnt(15)
    v_bitop3_b32 v115, v115, v116, v117 bitop3:0xfe
    v_lshl_add_u64 v[124:125], v[124:125], 0, s[36:37]
    v_cmpx_le_u32 vcc, 0x1000000, v60
    ds_add_rtn_u64 v[116:117], v123, v[124:125] offset:54272
    s_mov_b64 exec, -1
    v_ashrrev_i32 v122, 5, v61
    v_lshlrev_b16 v123, 2, v61
    v_lshlrev_b32 v124, 16, v26
    v_bitop3_b32 v122, v122, v113, v113 bitop3:0x0c
    v_and_b32 v125, 0xffff0000, v26
    v_lshlrev_b32 v126, 16, v27
    v_mul_f32 v122, v114, v122
    v_and_b32 v127, 0xffff0000, v27
    v_add_u32 v123, v123, v123
    v_pk_fma_f32 v[124:125], v[124:125], v[122:123], s[34:35] op_sel_hi:[1,0,1]
    v_pk_fma_f32 v[126:127], v[126:127], v[122:123], s[34:35] op_sel_hi:[1,0,1]
    v_lshl_add_u32 v124, v125, 16, v124
    v_lshl_add_u32 v125, v127, 16, v126
    s_waitcnt lgkmcnt(15)
    v_bitop3_b32 v115, v115, v118, v119 bitop3:0xfe
    v_lshl_add_u64 v[124:125], v[124:125], 0, s[36:37]
    v_cmpx_le_u32 vcc, 0x1000000, v61
    ds_add_rtn_u64 v[118:119], v123, v[124:125] offset:54272
    s_mov_b64 exec, -1
    v_ashrrev_i32 v122, 5, v62
    v_lshlrev_b16 v123, 2, v62
    v_lshlrev_b32 v124, 16, v28
    v_bitop3_b32 v122, v122, v113, v113 bitop3:0x0c
    v_and_b32 v125, 0xffff0000, v28
    v_lshlrev_b32 v126, 16, v29
    v_mul_f32 v122, v114, v122
    v_and_b32 v127, 0xffff0000, v29
    v_add_u32 v123, v123, v123
    v_pk_fma_f32 v[124:125], v[124:125], v[122:123], s[34:35] op_sel_hi:[1,0,1]
    v_pk_fma_f32 v[126:127], v[126:127], v[122:123], s[34:35] op_sel_hi:[1,0,1]
    v_lshl_add_u32 v124, v125, 16, v124
    v_lshl_add_u32 v125, v127, 16, v126
    s_waitcnt lgkmcnt(15)
    v_bitop3_b32 v115, v115, v120, v121 bitop3:0xfe
    v_lshl_add_u64 v[124:125], v[124:125], 0, s[36:37]
    v_cmpx_le_u32 vcc, 0x1000000, v62
    ds_add_rtn_u64 v[120:121], v123, v[124:125] offset:54272
    s_mov_b64 exec, -1
    s_waitcnt vmcnt(13)
    v_perm_b32 v60, v89, v86, s31
    v_perm_b32 v61, v89, v87, s32
    v_perm_b32 v62, v89, v88, s33
    v_lshlrev_b16 v28, 3, v88
    v_lshlrev_b16 v26, 3, v87
    v_lshlrev_b16 v24, 3, v86
    s_waitcnt lgkmcnt(3)
    s_barrier
    s_cmp_ge_u32 s10, 9
    s_cbranch_scc1 p2_nm0m1a
    v_lshrrev_b32 v84, 1, v112
    s_add_u32 s44, s20, s42
    buffer_load_dwordx2 v[84:85], v84, s[4:7], s44 offen
p2_nm0m1a:
    buffer_load_dwordx4 v[72:75], v112, s[4:7], s20 offen offset:0
    buffer_load_dwordx4 v[76:79], v112, s[4:7], s20 offen offset:1024
    buffer_load_dwordx4 v[80:83], v112, s[4:7], s20 offen offset:2048
    v_cmpx_ge_u16 vcc, 0x3fff, v60
    ds_read_b64 v[24:25], v24
    s_mov_b64 exec, -1
    v_cmpx_ge_u16 vcc, 0x3fff, v61
    ds_read_b64 v[26:27], v26
    s_mov_b64 exec, -1
    v_cmpx_ge_u16 vcc, 0x3fff, v62
    ds_read_b64 v[28:29], v28
    s_mov_b64 exec, -1
    s_waitcnt lgkmcnt(15)
    v_ashrrev_i32 v122, 5, v63
    v_lshlrev_b16 v123, 2, v63
    v_lshlrev_b32 v124, 16, v30
    v_bitop3_b32 v122, v122, v113, v113 bitop3:0x0c
    v_and_b32 v125, 0xffff0000, v30
    v_lshlrev_b32 v126, 16, v31
    v_mul_f32 v122, v114, v122
    v_and_b32 v127, 0xffff0000, v31
    v_add_u32 v123, v123, v123
    v_pk_fma_f32 v[124:125], v[124:125], v[122:123], s[34:35] op_sel_hi:[1,0,1]
    v_pk_fma_f32 v[126:127], v[126:127], v[122:123], s[34:35] op_sel_hi:[1,0,1]
    v_lshl_add_u32 v124, v125, 16, v124
    v_lshl_add_u32 v125, v127, 16, v126
    s_waitcnt lgkmcnt(5)
    v_bitop3_b32 v115, v115, v116, v117 bitop3:0xfe
    v_lshl_add_u64 v[124:125], v[124:125], 0, s[36:37]
    v_cmpx_le_u32 vcc, 0x1000000, v63
    ds_add_rtn_u64 v[116:117], v123, v[124:125] offset:54272
    s_mov_b64 exec, -1
    v_ashrrev_i32 v122, 5, v64
    v_lshlrev_b16 v123, 2, v64
    v_lshlrev_b32 v124, 16, v32
    v_bitop3_b32 v122, v122, v113, v113 bitop3:0x0c
    v_and_b32 v125, 0xffff0000, v32
    v_lshlrev_b32 v126, 16, v33
    v_mul_f32 v122, v114, v122
    v_and_b32 v127, 0xffff0000, v33
    v_add_u32 v123, v123, v123
    v_pk_fma_f32 v[124:125], v[124:125], v[122:123], s[34:35] op_sel_hi:[1,0,1]
    v_pk_fma_f32 v[126:127], v[126:127], v[122:123], s[34:35] op_sel_hi:[1,0,1]
    v_lshl_add_u32 v124, v125, 16, v124
    v_lshl_add_u32 v125, v127, 16, v126
    s_waitcnt lgkmcnt(5)
    v_bitop3_b32 v115, v115, v118, v119 bitop3:0xfe
    v_lshl_add_u64 v[124:125], v[124:125], 0, s[36:37]
    v_cmpx_le_u32 vcc, 0x1000000, v64
    ds_add_rtn_u64 v[118:119], v123, v[124:125] offset:54272
    s_mov_b64 exec, -1
    v_ashrrev_i32 v122, 5, v65
    v_lshlrev_b16 v123, 2, v65
    v_lshlrev_b32 v124, 16, v34
    v_bitop3_b32 v122, v122, v113, v113 bitop3:0x0c
    v_and_b32 v125, 0xffff0000, v34
    v_lshlrev_b32 v126, 16, v35
    v_mul_f32 v122, v114, v122
    v_and_b32 v127, 0xffff0000, v35
    v_add_u32 v123, v123, v123
    v_pk_fma_f32 v[124:125], v[124:125], v[122:123], s[34:35] op_sel_hi:[1,0,1]
    v_pk_fma_f32 v[126:127], v[126:127], v[122:123], s[34:35] op_sel_hi:[1,0,1]
    v_lshl_add_u32 v124, v125, 16, v124
    v_lshl_add_u32 v125, v127, 16, v126
    s_waitcnt lgkmcnt(5)
    v_bitop3_b32 v115, v115, v120, v121 bitop3:0xfe
    v_lshl_add_u64 v[124:125], v[124:125], 0, s[36:37]
    v_cmpx_le_u32 vcc, 0x1000000, v65
    ds_add_rtn_u64 v[120:121], v123, v[124:125] offset:54272
    s_mov_b64 exec, -1
    s_waitcnt vmcnt(15)
    v_perm_b32 v63, v93, v90, s31
    v_perm_b32 v64, v93, v91, s32
    v_perm_b32 v65, v93, v92, s33
    v_lshlrev_b16 v34, 3, v92
    v_lshlrev_b16 v32, 3, v91
    v_lshlrev_b16 v30, 3, v90
    v_cmpx_ge_u16 vcc, 0x3fff, v63
    ds_read_b64 v[30:31], v30
    s_mov_b64 exec, -1
    v_cmpx_ge_u16 vcc, 0x3fff, v64
    ds_read_b64 v[32:33], v32
    s_mov_b64 exec, -1
    v_cmpx_ge_u16 vcc, 0x3fff, v65
    ds_read_b64 v[34:35], v34
    s_mov_b64 exec, -1
    s_waitcnt lgkmcnt(15)
    v_bfe_u32 v86, v106, 14, 4
    v_lshrrev_b32 v87, 18, v106
    v_and_b32 v106, 0x3fff, v106
    v_mad_u32_u24 v86, v86, s63, v87
    v_lshl_or_b32 v106, v86, 14, v106
    buffer_load_dwordx4 v[86:89], v106, s[68:71], 0 offen
    s_waitcnt lgkmcnt(15)
    v_ashrrev_i32 v122, 5, v66
    v_lshlrev_b16 v123, 2, v66
    v_lshlrev_b32 v124, 16, v36
    v_bitop3_b32 v122, v122, v113, v113 bitop3:0x0c
    v_and_b32 v125, 0xffff0000, v36
    v_lshlrev_b32 v126, 16, v37
    v_mul_f32 v122, v114, v122
    v_and_b32 v127, 0xffff0000, v37
    v_add_u32 v123, v123, v123
    v_pk_fma_f32 v[124:125], v[124:125], v[122:123], s[34:35] op_sel_hi:[1,0,1]
    v_pk_fma_f32 v[126:127], v[126:127], v[122:123], s[34:35] op_sel_hi:[1,0,1]
    v_lshl_add_u32 v124, v125, 16, v124
    v_lshl_add_u32 v125, v127, 16, v126
    s_waitcnt lgkmcnt(5)
    v_bitop3_b32 v115, v115, v116, v117 bitop3:0xfe
    v_lshl_add_u64 v[124:125], v[124:125], 0, s[36:37]
    v_cmpx_le_u32 vcc, 0x1000000, v66
    ds_add_rtn_u64 v[116:117], v123, v[124:125] offset:54272
    s_mov_b64 exec, -1
    v_ashrrev_i32 v122, 5, v67
    v_lshlrev_b16 v123, 2, v67
    v_lshlrev_b32 v124, 16, v38
    v_bitop3_b32 v122, v122, v113, v113 bitop3:0x0c
    v_and_b32 v125, 0xffff0000, v38
    v_lshlrev_b32 v126, 16, v39
    v_mul_f32 v122, v114, v122
    v_and_b32 v127, 0xffff0000, v39
    v_add_u32 v123, v123, v123
    v_pk_fma_f32 v[124:125], v[124:125], v[122:123], s[34:35] op_sel_hi:[1,0,1]
    v_pk_fma_f32 v[126:127], v[126:127], v[122:123], s[34:35] op_sel_hi:[1,0,1]
    v_lshl_add_u32 v124, v125, 16, v124
    v_lshl_add_u32 v125, v127, 16, v126
    s_waitcnt lgkmcnt(5)
    v_bitop3_b32 v115, v115, v118, v119 bitop3:0xfe
    v_lshl_add_u64 v[124:125], v[124:125], 0, s[36:37]
    v_cmpx_le_u32 vcc, 0x1000000, v67
    ds_add_rtn_u64 v[118:119], v123, v[124:125] offset:54272
    s_mov_b64 exec, -1
    v_ashrrev_i32 v122, 5, v68
    v_lshlrev_b16 v123, 2, v68
    v_lshlrev_b32 v124, 16, v40
    v_bitop3_b32 v122, v122, v113, v113 bitop3:0x0c
    v_and_b32 v125, 0xffff0000, v40
    v_lshlrev_b32 v126, 16, v41
    v_mul_f32 v122, v114, v122
    v_and_b32 v127, 0xffff0000, v41
    v_add_u32 v123, v123, v123
    v_pk_fma_f32 v[124:125], v[124:125], v[122:123], s[34:35] op_sel_hi:[1,0,1]
    v_pk_fma_f32 v[126:127], v[126:127], v[122:123], s[34:35] op_sel_hi:[1,0,1]
    v_lshl_add_u32 v124, v125, 16, v124
    v_lshl_add_u32 v125, v127, 16, v126
    s_waitcnt lgkmcnt(5)
    v_bitop3_b32 v115, v115, v120, v121 bitop3:0xfe
    v_lshl_add_u64 v[124:125], v[124:125], 0, s[36:37]
    v_cmpx_le_u32 vcc, 0x1000000, v68
    ds_add_rtn_u64 v[120:121], v123, v[124:125] offset:54272
    s_mov_b64 exec, -1
    s_waitcnt vmcnt(12)
    v_perm_b32 v66, v97, v94, s31
    v_perm_b32 v67, v97, v95, s32
    v_perm_b32 v68, v97, v96, s33
    v_lshlrev_b16 v40, 3, v96
    v_lshlrev_b16 v38, 3, v95
    v_lshlrev_b16 v36, 3, v94
    v_cmpx_ge_u16 vcc, 0x3fff, v66
    ds_read_b64 v[36:37], v36
    s_mov_b64 exec, -1
    v_cmpx_ge_u16 vcc, 0x3fff, v67
    ds_read_b64 v[38:39], v38
    s_mov_b64 exec, -1
    v_cmpx_ge_u16 vcc, 0x3fff, v68
    ds_read_b64 v[40:41], v40
    s_mov_b64 exec, -1
    s_waitcnt lgkmcnt(15)
    v_bfe_u32 v90, v107, 14, 4
    v_lshrrev_b32 v91, 18, v107
    v_and_b32 v107, 0x3fff, v107
    v_mad_u32_u24 v90, v90, s63, v91
    v_lshl_or_b32 v107, v90, 14, v107
    buffer_load_dwordx4 v[90:93], v107, s[68:71], 0 offen
    s_cmp_le_u32 s15, 7
    s_cbranch_scc1 p2_na0a7
    s_waitcnt lgkmcnt(15)
    v_ashrrev_i32 v122, 5, v69
    v_lshlrev_b16 v123, 2, v69
    v_lshlrev_b32 v124, 16, v42
    v_bitop3_b32 v122, v122, v113, v113 bitop3:0x0c
    v_and_b32 v125, 0xffff0000, v42
    v_lshlrev_b32 v126, 16, v43
    v_mul_f32 v122, v114, v122
    v_and_b32 v127, 0xffff0000, v43
    v_add_u32 v123, v123, v123
    v_pk_fma_f32 v[124:125], v[124:125], v[122:123], s[34:35] op_sel_hi:[1,0,1]
    v_pk_fma_f32 v[126:127], v[126:127], v[122:123], s[34:35] op_sel_hi:[1,0,1]
    v_lshl_add_u32 v124, v125, 16, v124
    v_lshl_add_u32 v125, v127, 16, v126
    s_waitcnt lgkmcnt(5)
    v_bitop3_b32 v115, v115, v116, v117 bitop3:0xfe
    v_lshl_add_u64 v[124:125], v[124:125], 0, s[36:37]
    v_cmpx_le_u32 vcc, 0x1000000, v69
    ds_add_rtn_u64 v[116:117], v123, v[124:125] offset:54272
    s_mov_b64 exec, -1
    v_ashrrev_i32 v122, 5, v70
    v_lshlrev_b16 v123, 2, v70
    v_lshlrev_b32 v124, 16, v44
    v_bitop3_b32 v122, v122, v113, v113 bitop3:0x0c
    v_and_b32 v125, 0xffff0000, v44
    v_lshlrev_b32 v126, 16, v45
    v_mul_f32 v122, v114, v122
    v_and_b32 v127, 0xffff0000, v45
    v_add_u32 v123, v123, v123
    v_pk_fma_f32 v[124:125], v[124:125], v[122:123], s[34:35] op_sel_hi:[1,0,1]
    v_pk_fma_f32 v[126:127], v[126:127], v[122:123], s[34:35] op_sel_hi:[1,0,1]
    v_lshl_add_u32 v124, v125, 16, v124
    v_lshl_add_u32 v125, v127, 16, v126
    s_waitcnt lgkmcnt(5)
    v_bitop3_b32 v115, v115, v118, v119 bitop3:0xfe
    v_lshl_add_u64 v[124:125], v[124:125], 0, s[36:37]
    v_cmpx_le_u32 vcc, 0x1000000, v70
    ds_add_rtn_u64 v[118:119], v123, v[124:125] offset:54272
    s_mov_b64 exec, -1
    v_ashrrev_i32 v122, 5, v71
    v_lshlrev_b16 v123, 2, v71
    v_lshlrev_b32 v124, 16, v46
    v_bitop3_b32 v122, v122, v113, v113 bitop3:0x0c
    v_and_b32 v125, 0xffff0000, v46
    v_lshlrev_b32 v126, 16, v47
    v_mul_f32 v122, v114, v122
    v_and_b32 v127, 0xffff0000, v47
    v_add_u32 v123, v123, v123
    v_pk_fma_f32 v[124:125], v[124:125], v[122:123], s[34:35] op_sel_hi:[1,0,1]
    v_pk_fma_f32 v[126:127], v[126:127], v[122:123], s[34:35] op_sel_hi:[1,0,1]
    v_lshl_add_u32 v124, v125, 16, v124
    v_lshl_add_u32 v125, v127, 16, v126
    s_waitcnt lgkmcnt(5)
    v_bitop3_b32 v115, v115, v120, v121 bitop3:0xfe
    v_lshl_add_u64 v[124:125], v[124:125], 0, s[36:37]
    v_cmpx_le_u32 vcc, 0x1000000, v71
    ds_add_rtn_u64 v[120:121], v123, v[124:125] offset:54272
    s_mov_b64 exec, -1
p2_na0a7:
    s_waitcnt vmcnt(12)
    v_perm_b32 v69, v101, v98, s31
    v_perm_b32 v70, v101, v99, s32
    v_perm_b32 v71, v101, v100, s33
    v_lshlrev_b16 v46, 3, v100
    v_lshlrev_b16 v44, 3, v99
    v_lshlrev_b16 v42, 3, v98
    s_cmp_le_u32 s16, 7
    s_cbranch_scc1 p2_g0r07
    v_cmpx_ge_u16 vcc, 0x3fff, v69
    ds_read_b64 v[42:43], v42
    s_mov_b64 exec, -1
    v_cmpx_ge_u16 vcc, 0x3fff, v70
    ds_read_b64 v[44:45], v44
    s_mov_b64 exec, -1
    v_cmpx_ge_u16 vcc, 0x3fff, v71
    ds_read_b64 v[46:47], v46
    s_mov_b64 exec, -1
p2_g0r07:
    s_waitcnt vmcnt(8)
    v_perm_b32 v48, v3, v0, s31
    v_perm_b32 v49, v3, v1, s32
    v_perm_b32 v50, v3, v2, s33
    v_lshlrev_b16 v4, 3, v2
    v_lshlrev_b16 v2, 3, v1
    v_lshlrev_b16 v0, 3, v0
    v_cmpx_ge_u16 vcc, 0x3fff, v48
    ds_read_b64 v[0:1], v0
    s_mov_b64 exec, -1
    v_cmpx_ge_u16 vcc, 0x3fff, v49
    ds_read_b64 v[2:3], v2
    s_mov_b64 exec, -1
    v_cmpx_ge_u16 vcc, 0x3fff, v50
    ds_read_b64 v[4:5], v4
    s_mov_b64 exec, -1
    s_waitcnt vmcnt(7)
    v_perm_b32 v51, v9, v6, s31
    v_perm_b32 v52, v9, v7, s32
    v_perm_b32 v53, v9, v8, s33
    v_lshlrev_b16 v10, 3, v8
    v_lshlrev_b16 v8, 3, v7
    v_lshlrev_b16 v6, 3, v6
    v_cmpx_ge_u16 vcc, 0x3fff, v51
    ds_read_b64 v[6:7], v6
    s_mov_b64 exec, -1
    v_cmpx_ge_u16 vcc, 0x3fff, v52
    ds_read_b64 v[8:9], v8
    s_mov_b64 exec, -1
    v_cmpx_ge_u16 vcc, 0x3fff, v53
    ds_read_b64 v[10:11], v10
    s_mov_b64 exec, -1
    s_waitcnt vmcnt(6)
    v_perm_b32 v54, v15, v12, s31
    v_perm_b32 v55, v15, v13, s32
    v_perm_b32 v56, v15, v14, s33
    v_lshlrev_b16 v16, 3, v14
    v_lshlrev_b16 v14, 3, v13
    v_lshlrev_b16 v12, 3, v12
    v_cmpx_ge_u16 vcc, 0x3fff, v54
    ds_read_b64 v[12:13], v12
    s_mov_b64 exec, -1
    v_cmpx_ge_u16 vcc, 0x3fff, v55
    ds_read_b64 v[14:15], v14
    s_mov_b64 exec, -1
    v_cmpx_ge_u16 vcc, 0x3fff, v56
    ds_read_b64 v[16:17], v16
    s_mov_b64 exec, -1
    s_waitcnt vmcnt(5)
    v_perm_b32 v57, v21, v18, s31
    v_perm_b32 v58, v21, v19, s32
    v_perm_b32 v59, v21, v20, s33
    v_lshlrev_b16 v22, 3, v20
    v_lshlrev_b16 v20, 3, v19
    v_lshlrev_b16 v18, 3, v18
    v_cmpx_ge_u16 vcc, 0x3fff, v57
    ds_read_b64 v[18:19], v18
    s_mov_b64 exec, -1
    v_cmpx_ge_u16 vcc, 0x3fff, v58
    ds_read_b64 v[20:21], v20
    s_mov_b64 exec, -1
    v_cmpx_ge_u16 vcc, 0x3fff, v59
    ds_read_b64 v[22:23], v22
    s_mov_b64 exec, -1
    s_waitcnt lgkmcnt(0)
    s_barrier
    s_waitcnt lgkmcnt(15)
    s_branch p2_tail
p2_drain0:
    v_cmpx_gt_i16 vcc, 0, v48
    ds_read_b64 v[0:1], v0
    s_mov_b64 exec, -1
    v_cmpx_gt_i16 vcc, 0, v49
    ds_read_b64 v[2:3], v2
    s_mov_b64 exec, -1
    v_cmpx_gt_i16 vcc, 0, v50
    ds_read_b64 v[4:5], v4
    s_mov_b64 exec, -1
    v_cmpx_gt_i16 vcc, 0, v51
    ds_read_b64 v[6:7], v6
    s_mov_b64 exec, -1
    v_cmpx_gt_i16 vcc, 0, v52
    ds_read_b64 v[8:9], v8
    s_mov_b64 exec, -1
    v_cmpx_gt_i16 vcc, 0, v53
    ds_read_b64 v[10:11], v10
    s_mov_b64 exec, -1
    v_cmpx_gt_i16 vcc, 0, v54
    ds_read_b64 v[12:13], v12
    s_mov_b64 exec, -1
    v_cmpx_gt_i16 vcc, 0, v55
    ds_read_b64 v[14:15], v14
    s_mov_b64 exec, -1
    v_cmpx_gt_i16 vcc, 0, v56
    ds_read_b64 v[16:17], v16
    s_mov_b64 exec, -1
    v_cmpx_gt_i16 vcc, 0, v57
    ds_read_b64 v[18:19], v18
    s_mov_b64 exec, -1
    v_cmpx_gt_i16 vcc, 0, v58
    ds_read_b64 v[20:21], v20
    s_mov_b64 exec, -1
    v_cmpx_gt_i16 vcc, 0, v59
    ds_read_b64 v[22:23], v22
    s_mov_b64 exec, -1
    v_cmpx_gt_i16 vcc, 0, v60
    ds_read_b64 v[24:25], v24
    s_mov_b64 exec, -1
    v_cmpx_gt_i16 vcc, 0, v61
    ds_read_b64 v[26:27], v26
    s_mov_b64 exec, -1
    v_cmpx_gt_i16 vcc, 0, v62
    ds_read_b64 v[28:29], v28
    s_mov_b64 exec, -1
    v_cmpx_gt_i16 vcc, 0, v63
    ds_read_b64 v[30:31], v30
    s_mov_b64 exec, -1
    v_cmpx_gt_i16 vcc, 0, v64
    ds_read_b64 v[32:33], v32
    s_mov_b64 exec, -1
    v_cmpx_gt_i16 vcc, 0, v65
    ds_read_b64 v[34:35], v34
    s_mov_b64 exec, -1
    v_cmpx_gt_i16 vcc, 0, v66
    ds_read_b64 v[36:37], v36
    s_mov_b64 exec, -1
    v_cmpx_gt_i16 vcc, 0, v67
    ds_read_b64 v[38:39], v38
    s_mov_b64 exec, -1
    v_cmpx_gt_i16 vcc, 0, v68
    ds_read_b64 v[40:41], v40
    s_mov_b64 exec, -1
    s_cmp_le_u32 s15, 7
    s_cbranch_scc1 p2_gd0
    v_cmpx_gt_i16 vcc, 0, v69
    ds_read_b64 v[42:43], v42
    s_mov_b64 exec, -1
    v_cmpx_gt_i16 vcc, 0, v70
    ds_read_b64 v[44:45], v44
    s_mov_b64 exec, -1
    v_cmpx_gt_i16 vcc, 0, v71
    ds_read_b64 v[46:47], v46
    s_mov_b64 exec, -1
p2_gd0:
    s_waitcnt lgkmcnt(15)
    v_ashrrev_i32 v122, 5, v48
    v_lshlrev_b16 v123, 2, v48
    v_lshlrev_b32 v124, 16, v0
    v_bitop3_b32 v122, v122, v113, v113 bitop3:0x0c
    v_and_b32 v125, 0xffff0000, v0
    v_lshlrev_b32 v126, 16, v1
    v_mul_f32 v122, v114, v122
    v_and_b32 v127, 0xffff0000, v1
    v_add_u32 v123, v123, v123
    v_pk_fma_f32 v[124:125], v[124:125], v[122:123], s[34:35] op_sel_hi:[1,0,1]
    v_pk_fma_f32 v[126:127], v[126:127], v[122:123], s[34:35] op_sel_hi:[1,0,1]
    v_lshl_add_u32 v124, v125, 16, v124
    v_lshl_add_u32 v125, v127, 16, v126
    s_waitcnt lgkmcnt(15)
    v_bitop3_b32 v115, v115, v116, v117 bitop3:0xfe
    v_lshl_add_u64 v[124:125], v[124:125], 0, s[36:37]
    v_cmpx_le_u32 vcc, 0x1000000, v48
    ds_add_rtn_u64 v[116:117], v123, v[124:125] offset:54272
    s_mov_b64 exec, -1
    v_ashrrev_i32 v122, 5, v49
    v_lshlrev_b16 v123, 2, v49
    v_lshlrev_b32 v124, 16, v2
    v_bitop3_b32 v122, v122, v113, v113 bitop3:0x0c
    v_and_b32 v125, 0xffff0000, v2
    v_lshlrev_b32 v126, 16, v3
    v_mul_f32 v122, v114, v122
    v_and_b32 v127, 0xffff0000, v3
    v_add_u32 v123, v123, v123
    v_pk_fma_f32 v[124:125], v[124:125], v[122:123], s[34:35] op_sel_hi:[1,0,1]
    v_pk_fma_f32 v[126:127], v[126:127], v[122:123], s[34:35] op_sel_hi:[1,0,1]
    v_lshl_add_u32 v124, v125, 16, v124
    v_lshl_add_u32 v125, v127, 16, v126
    s_waitcnt lgkmcnt(15)
    v_bitop3_b32 v115, v115, v118, v119 bitop3:0xfe
    v_lshl_add_u64 v[124:125], v[124:125], 0, s[36:37]
    v_cmpx_le_u32 vcc, 0x1000000, v49
    ds_add_rtn_u64 v[118:119], v123, v[124:125] offset:54272
    s_mov_b64 exec, -1
    v_ashrrev_i32 v122, 5, v50
    v_lshlrev_b16 v123, 2, v50
    v_lshlrev_b32 v124, 16, v4
    v_bitop3_b32 v122, v122, v113, v113 bitop3:0x0c
    v_and_b32 v125, 0xffff0000, v4
    v_lshlrev_b32 v126, 16, v5
    v_mul_f32 v122, v114, v122
    v_and_b32 v127, 0xffff0000, v5
    v_add_u32 v123, v123, v123
    v_pk_fma_f32 v[124:125], v[124:125], v[122:123], s[34:35] op_sel_hi:[1,0,1]
    v_pk_fma_f32 v[126:127], v[126:127], v[122:123], s[34:35] op_sel_hi:[1,0,1]
    v_lshl_add_u32 v124, v125, 16, v124
    v_lshl_add_u32 v125, v127, 16, v126
    s_waitcnt lgkmcnt(15)
    v_bitop3_b32 v115, v115, v120, v121 bitop3:0xfe
    v_lshl_add_u64 v[124:125], v[124:125], 0, s[36:37]
    v_cmpx_le_u32 vcc, 0x1000000, v50
    ds_add_rtn_u64 v[120:121], v123, v[124:125] offset:54272
    s_mov_b64 exec, -1
    s_waitcnt lgkmcnt(15)
    v_ashrrev_i32 v122, 5, v51
    v_lshlrev_b16 v123, 2, v51
    v_lshlrev_b32 v124, 16, v6
    v_bitop3_b32 v122, v122, v113, v113 bitop3:0x0c
    v_and_b32 v125, 0xffff0000, v6
    v_lshlrev_b32 v126, 16, v7
    v_mul_f32 v122, v114, v122
    v_and_b32 v127, 0xffff0000, v7
    v_add_u32 v123, v123, v123
    v_pk_fma_f32 v[124:125], v[124:125], v[122:123], s[34:35] op_sel_hi:[1,0,1]
    v_pk_fma_f32 v[126:127], v[126:127], v[122:123], s[34:35] op_sel_hi:[1,0,1]
    v_lshl_add_u32 v124, v125, 16, v124
    v_lshl_add_u32 v125, v127, 16, v126
    s_waitcnt lgkmcnt(2)
    v_bitop3_b32 v115, v115, v116, v117 bitop3:0xfe
    v_lshl_add_u64 v[124:125], v[124:125], 0, s[36:37]
    v_cmpx_le_u32 vcc, 0x1000000, v51
    ds_add_rtn_u64 v[116:117], v123, v[124:125] offset:54272
    s_mov_b64 exec, -1
    v_ashrrev_i32 v122, 5, v52
    v_lshlrev_b16 v123, 2, v52
    v_lshlrev_b32 v124, 16, v8
    v_bitop3_b32 v122, v122, v113, v113 bitop3:0x0c
    v_and_b32 v125, 0xffff0000, v8
    v_lshlrev_b32 v126, 16, v9
    v_mul_f32 v122, v114, v122
    v_and_b32 v127, 0xffff0000, v9
    v_add_u32 v123, v123, v123
    v_pk_fma_f32 v[124:125], v[124:125], v[122:123], s[34:35] op_sel_hi:[1,0,1]
    v_pk_fma_f32 v[126:127], v[126:127], v[122:123], s[34:35] op_sel_hi:[1,0,1]
    v_lshl_add_u32 v124, v125, 16, v124
    v_lshl_add_u32 v125, v127, 16, v126
    s_waitcnt lgkmcnt(2)
    v_bitop3_b32 v115, v115, v118, v119 bitop3:0xfe
    v_lshl_add_u64 v[124:125], v[124:125], 0, s[36:37]
    v_cmpx_le_u32 vcc, 0x1000000, v52
    ds_add_rtn_u64 v[118:119], v123, v[124:125] offset:54272
    s_mov_b64 exec, -1
    v_ashrrev_i32 v122, 5, v53
    v_lshlrev_b16 v123, 2, v53
    v_lshlrev_b32 v124, 16, v10
    v_bitop3_b32 v122, v122, v113, v113 bitop3:0x0c
    v_and_b32 v125, 0xffff0000, v10
    v_lshlrev_b32 v126, 16, v11
    v_mul_f32 v122, v114, v122
    v_and_b32 v127, 0xffff0000, v11
    v_add_u32 v123, v123, v123
    v_pk_fma_f32 v[124:125], v[124:125], v[122:123], s[34:35] op_sel_hi:[1,0,1]
    v_pk_fma_f32 v[126:127], v[126:127], v[122:123], s[34:35] op_sel_hi:[1,0,1]
    v_lshl_add_u32 v124, v125, 16, v124
    v_lshl_add_u32 v125, v127, 16, v126
    s_waitcnt lgkmcnt(2)
    v_bitop3_b32 v115, v115, v120, v121 bitop3:0xfe
    v_lshl_add_u64 v[124:125], v[124:125], 0, s[36:37]
    v_cmpx_le_u32 vcc, 0x1000000, v53
    ds_add_rtn_u64 v[120:121], v123, v[124:125] offset:54272
    s_mov_b64 exec, -1
    s_waitcnt lgkmcnt(15)
    v_ashrrev_i32 v122, 5, v54
    v_lshlrev_b16 v123, 2, v54
    v_lshlrev_b32 v124, 16, v12
    v_bitop3_b32 v122, v122, v113, v113 bitop3:0x0c
    v_and_b32 v125, 0xffff0000, v12
    v_lshlrev_b32 v126, 16, v13
    v_mul_f32 v122, v114, v122
    v_and_b32 v127, 0xffff0000, v13
    v_add_u32 v123, v123, v123
    v_pk_fma_f32 v[124:125], v[124:125], v[122:123], s[34:35] op_sel_hi:[1,0,1]
    v_pk_fma_f32 v[126:127], v[126:127], v[122:123], s[34:35] op_sel_hi:[1,0,1]
    v_lshl_add_u32 v124, v125, 16, v124
    v_lshl_add_u32 v125, v127, 16, v126
    s_waitcnt lgkmcnt(2)
    v_bitop3_b32 v115, v115, v116, v117 bitop3:0xfe
    v_lshl_add_u64 v[124:125], v[124:125], 0, s[36:37]
    v_cmpx_le_u32 vcc, 0x1000000, v54
    ds_add_rtn_u64 v[116:117], v123, v[124:125] offset:54272
    s_mov_b64 exec, -1
    v_ashrrev_i32 v122, 5, v55
    v_lshlrev_b16 v123, 2, v55
    v_lshlrev_b32 v124, 16, v14
    v_bitop3_b32 v122, v122, v113, v113 bitop3:0x0c
    v_and_b32 v125, 0xffff0000, v14
    v_lshlrev_b32 v126, 16, v15
    v_mul_f32 v122, v114, v122
    v_and_b32 v127, 0xffff0000, v15
    v_add_u32 v123, v123, v123
    v_pk_fma_f32 v[124:125], v[124:125], v[122:123], s[34:35] op_sel_hi:[1,0,1]
    v_pk_fma_f32 v[126:127], v[126:127], v[122:123], s[34:35] op_sel_hi:[1,0,1]
    v_lshl_add_u32 v124, v125, 16, v124
    v_lshl_add_u32 v125, v127, 16, v126
    s_waitcnt lgkmcnt(2)
    v_bitop3_b32 v115, v115, v118, v119 bitop3:0xfe
    v_lshl_add_u64 v[124:125], v[124:125], 0, s[36:37]
    v_cmpx_le_u32 vcc, 0x1000000, v55
    ds_add_rtn_u64 v[118:119], v123, v[124:125] offset:54272
    s_mov_b64 exec, -1
    v_ashrrev_i32 v122, 5, v56
    v_lshlrev_b16 v123, 2, v56
    v_lshlrev_b32 v124, 16, v16
    v_bitop3_b32 v122, v122, v113, v113 bitop3:0x0c
    v_and_b32 v125, 0xffff0000, v16
    v_lshlrev_b32 v126, 16, v17
    v_mul_f32 v122, v114, v122
    v_and_b32 v127, 0xffff0000, v17
    v_add_u32 v123, v123, v123
    v_pk_fma_f32 v[124:125], v[124:125], v[122:123], s[34:35] op_sel_hi:[1,0,1]
    v_pk_fma_f32 v[126:127], v[126:127], v[122:123], s[34:35] op_sel_hi:[1,0,1]
    v_lshl_add_u32 v124, v125, 16, v124
    v_lshl_add_u32 v125, v127, 16, v126
    s_waitcnt lgkmcnt(2)
    v_bitop3_b32 v115, v115, v120, v121 bitop3:0xfe
    v_lshl_add_u64 v[124:125], v[124:125], 0, s[36:37]
    v_cmpx_le_u32 vcc, 0x1000000, v56
    ds_add_rtn_u64 v[120:121], v123, v[124:125] offset:54272
    s_mov_b64 exec, -1
    s_waitcnt lgkmcnt(15)
    v_ashrrev_i32 v122, 5, v57
    v_lshlrev_b16 v123, 2, v57
    v_lshlrev_b32 v124, 16, v18
    v_bitop3_b32 v122, v122, v113, v113 bitop3:0x0c
    v_and_b32 v125, 0xffff0000, v18
    v_lshlrev_b32 v126, 16, v19
    v_mul_f32 v122, v114, v122
    v_and_b32 v127, 0xffff0000, v19
    v_add_u32 v123, v123, v123
    v_pk_fma_f32 v[124:125], v[124:125], v[122:123], s[34:35] op_sel_hi:[1,0,1]
    v_pk_fma_f32 v[126:127], v[126:127], v[122:123], s[34:35] op_sel_hi:[1,0,1]
    v_lshl_add_u32 v124, v125, 16, v124
    v_lshl_add_u32 v125, v127, 16, v126
    s_waitcnt lgkmcnt(2)
    v_bitop3_b32 v115, v115, v116, v117 bitop3:0xfe
    v_lshl_add_u64 v[124:125], v[124:125], 0, s[36:37]
    v_cmpx_le_u32 vcc, 0x1000000, v57
    ds_add_rtn_u64 v[116:117], v123, v[124:125] offset:54272
    s_mov_b64 exec, -1
    v_ashrrev_i32 v122, 5, v58
    v_lshlrev_b16 v123, 2, v58
    v_lshlrev_b32 v124, 16, v20
    v_bitop3_b32 v122, v122, v113, v113 bitop3:0x0c
    v_and_b32 v125, 0xffff0000, v20
    v_lshlrev_b32 v126, 16, v21
    v_mul_f32 v122, v114, v122
    v_and_b32 v127, 0xffff0000, v21
    v_add_u32 v123, v123, v123
    v_pk_fma_f32 v[124:125], v[124:125], v[122:123], s[34:35] op_sel_hi:[1,0,1]
    v_pk_fma_f32 v[126:127], v[126:127], v[122:123], s[34:35] op_sel_hi:[1,0,1]
    v_lshl_add_u32 v124, v125, 16, v124
    v_lshl_add_u32 v125, v127, 16, v126
    s_waitcnt lgkmcnt(2)
    v_bitop3_b32 v115, v115, v118, v119 bitop3:0xfe
    v_lshl_add_u64 v[124:125], v[124:125], 0, s[36:37]
    v_cmpx_le_u32 vcc, 0x1000000, v58
    ds_add_rtn_u64 v[118:119], v123, v[124:125] offset:54272
    s_mov_b64 exec, -1
    v_ashrrev_i32 v122, 5, v59
    v_lshlrev_b16 v123, 2, v59
    v_lshlrev_b32 v124, 16, v22
    v_bitop3_b32 v122, v122, v113, v113 bitop3:0x0c
    v_and_b32 v125, 0xffff0000, v22
    v_lshlrev_b32 v126, 16, v23
    v_mul_f32 v122, v114, v122
    v_and_b32 v127, 0xffff0000, v23
    v_add_u32 v123, v123, v123
    v_pk_fma_f32 v[124:125], v[124:125], v[122:123], s[34:35] op_sel_hi:[1,0,1]
    v_pk_fma_f32 v[126:127], v[126:127], v[122:123], s[34:35] op_sel_hi:[1,0,1]
    v_lshl_add_u32 v124, v125, 16, v124
    v_lshl_add_u32 v125, v127, 16, v126
    s_waitcnt lgkmcnt(2)
    v_bitop3_b32 v115, v115, v120, v121 bitop3:0xfe
    v_lshl_add_u64 v[124:125], v[124:125], 0, s[36:37]
    v_cmpx_le_u32 vcc, 0x1000000, v59
    ds_add_rtn_u64 v[120:121], v123, v[124:125] offset:54272
    s_mov_b64 exec, -1
    s_waitcnt lgkmcnt(15)
    v_ashrrev_i32 v122, 5, v60
    v_lshlrev_b16 v123, 2, v60
    v_lshlrev_b32 v124, 16, v24
    v_bitop3_b32 v122, v122, v113, v113 bitop3:0x0c
    v_and_b32 v125, 0xffff0000, v24
    v_lshlrev_b32 v126, 16, v25
    v_mul_f32 v122, v114, v122
    v_and_b32 v127, 0xffff0000, v25
    v_add_u32 v123, v123, v123
    v_pk_fma_f32 v[124:125], v[124:125], v[122:123], s[34:35] op_sel_hi:[1,0,1]
    v_pk_fma_f32 v[126:127], v[126:127], v[122:123], s[34:35] op_sel_hi:[1,0,1]
    v_lshl_add_u32 v124, v125, 16, v124
    v_lshl_add_u32 v125, v127, 16, v126
    s_waitcnt lgkmcnt(2)
    v_bitop3_b32 v115, v115, v116, v117 bitop3:0xfe
    v_lshl_add_u64 v[124:125], v[124:125], 0, s[36:37]
    v_cmpx_le_u32 vcc, 0x1000000, v60
    ds_add_rtn_u64 v[116:117], v123, v[124:125] offset:54272
    s_mov_b64 exec, -1
    v_ashrrev_i32 v122, 5, v61
    v_lshlrev_b16 v123, 2, v61
    v_lshlrev_b32 v124, 16, v26
    v_bitop3_b32 v122, v122, v113, v113 bitop3:0x0c
    v_and_b32 v125, 0xffff0000, v26
    v_lshlrev_b32 v126, 16, v27
    v_mul_f32 v122, v114, v122
    v_and_b32 v127, 0xffff0000, v27
    v_add_u32 v123, v123, v123
    v_pk_fma_f32 v[124:125], v[124:125], v[122:123], s[34:35] op_sel_hi:[1,0,1]
    v_pk_fma_f32 v[126:127], v[126:127], v[122:123], s[34:35] op_sel_hi:[1,0,1]
    v_lshl_add_u32 v124, v125, 16, v124
    v_lshl_add_u32 v125, v127, 16, v126
    s_waitcnt lgkmcnt(2)
    v_bitop3_b32 v115, v115, v118, v119 bitop3:0xfe
    v_lshl_add_u64 v[124:125], v[124:125], 0, s[36:37]
    v_cmpx_le_u32 vcc, 0x1000000, v61
    ds_add_rtn_u64 v[118:119], v123, v[124:125] offset:54272
    s_mov_b64 exec, -1
    v_ashrrev_i32 v122, 5, v62
    v_lshlrev_b16 v123, 2, v62
    v_lshlrev_b32 v124, 16, v28
    v_bitop3_b32 v122, v122, v113, v113 bitop3:0x0c
    v_and_b32 v125, 0xffff0000, v28
    v_lshlrev_b32 v126, 16, v29
    v_mul_f32 v122, v114, v122
    v_and_b32 v127, 0xffff0000, v29
    v_add_u32 v123, v123, v123
    v_pk_fma_f32 v[124:125], v[124:125], v[122:123], s[34:35] op_sel_hi:[1,0,1]
    v_pk_fma_f32 v[126:127], v[126:127], v[122:123], s[34:35] op_sel_hi:[1,0,1]
    v_lshl_add_u32 v124, v125, 16, v124
    v_lshl_add_u32 v125, v127, 16, v126
    s_waitcnt lgkmcnt(2)
    v_bitop3_b32 v115, v115, v120, v121 bitop3:0xfe
    v_lshl_add_u64 v[124:125], v[124:125], 0, s[36:37]
    v_cmpx_le_u32 vcc, 0x1000000, v62
    ds_add_rtn_u64 v[120:121], v123, v[124:125] offset:54272
    s_mov_b64 exec, -1
    s_waitcnt lgkmcnt(15)
    v_ashrrev_i32 v122, 5, v63
    v_lshlrev_b16 v123, 2, v63
    v_lshlrev_b32 v124, 16, v30
    v_bitop3_b32 v122, v122, v113, v113 bitop3:0x0c
    v_and_b32 v125, 0xffff0000, v30
    v_lshlrev_b32 v126, 16, v31
    v_mul_f32 v122, v114, v122
    v_and_b32 v127, 0xffff0000, v31
    v_add_u32 v123, v123, v123
    v_pk_fma_f32 v[124:125], v[124:125], v[122:123], s[34:35] op_sel_hi:[1,0,1]
    v_pk_fma_f32 v[126:127], v[126:127], v[122:123], s[34:35] op_sel_hi:[1,0,1]
    v_lshl_add_u32 v124, v125, 16, v124
    v_lshl_add_u32 v125, v127, 16, v126
    s_waitcnt lgkmcnt(2)
    v_bitop3_b32 v115, v115, v116, v117 bitop3:0xfe
    v_lshl_add_u64 v[124:125], v[124:125], 0, s[36:37]
    v_cmpx_le_u32 vcc, 0x1000000, v63
    ds_add_rtn_u64 v[116:117], v123, v[124:125] offset:54272
    s_mov_b64 exec, -1
    v_ashrrev_i32 v122, 5, v64
    v_lshlrev_b16 v123, 2, v64
    v_lshlrev_b32 v124, 16, v32
    v_bitop3_b32 v122, v122, v113, v113 bitop3:0x0c
    v_and_b32 v125, 0xffff0000, v32
    v_lshlrev_b32 v126, 16, v33
    v_mul_f32 v122, v114, v122
    v_and_b32 v127, 0xffff0000, v33
    v_add_u32 v123, v123, v123
    v_pk_fma_f32 v[124:125], v[124:125], v[122:123], s[34:35] op_sel_hi:[1,0,1]
    v_pk_fma_f32 v[126:127], v[126:127], v[122:123], s[34:35] op_sel_hi:[1,0,1]
    v_lshl_add_u32 v124, v125, 16, v124
    v_lshl_add_u32 v125, v127, 16, v126
    s_waitcnt lgkmcnt(2)
    v_bitop3_b32 v115, v115, v118, v119 bitop3:0xfe
    v_lshl_add_u64 v[124:125], v[124:125], 0, s[36:37]
    v_cmpx_le_u32 vcc, 0x1000000, v64
    ds_add_rtn_u64 v[118:119], v123, v[124:125] offset:54272
    s_mov_b64 exec, -1
    v_ashrrev_i32 v122, 5, v65
    v_lshlrev_b16 v123, 2, v65
    v_lshlrev_b32 v124, 16, v34
    v_bitop3_b32 v122, v122, v113, v113 bitop3:0x0c
    v_and_b32 v125, 0xffff0000, v34
    v_lshlrev_b32 v126, 16, v35
    v_mul_f32 v122, v114, v122
    v_and_b32 v127, 0xffff0000, v35
    v_add_u32 v123, v123, v123
    v_pk_fma_f32 v[124:125], v[124:125], v[122:123], s[34:35] op_sel_hi:[1,0,1]
    v_pk_fma_f32 v[126:127], v[126:127], v[122:123], s[34:35] op_sel_hi:[1,0,1]
    v_lshl_add_u32 v124, v125, 16, v124
    v_lshl_add_u32 v125, v127, 16, v126
    s_waitcnt lgkmcnt(2)
    v_bitop3_b32 v115, v115, v120, v121 bitop3:0xfe
    v_lshl_add_u64 v[124:125], v[124:125], 0, s[36:37]
    v_cmpx_le_u32 vcc, 0x1000000, v65
    ds_add_rtn_u64 v[120:121], v123, v[124:125] offset:54272
    s_mov_b64 exec, -1
    s_waitcnt lgkmcnt(15)
    v_ashrrev_i32 v122, 5, v66
    v_lshlrev_b16 v123, 2, v66
    v_lshlrev_b32 v124, 16, v36
    v_bitop3_b32 v122, v122, v113, v113 bitop3:0x0c
    v_and_b32 v125, 0xffff0000, v36
    v_lshlrev_b32 v126, 16, v37
    v_mul_f32 v122, v114, v122
    v_and_b32 v127, 0xffff0000, v37
    v_add_u32 v123, v123, v123
    v_pk_fma_f32 v[124:125], v[124:125], v[122:123], s[34:35] op_sel_hi:[1,0,1]
    v_pk_fma_f32 v[126:127], v[126:127], v[122:123], s[34:35] op_sel_hi:[1,0,1]
    v_lshl_add_u32 v124, v125, 16, v124
    v_lshl_add_u32 v125, v127, 16, v126
    s_waitcnt lgkmcnt(2)
    v_bitop3_b32 v115, v115, v116, v117 bitop3:0xfe
    v_lshl_add_u64 v[124:125], v[124:125], 0, s[36:37]
    v_cmpx_le_u32 vcc, 0x1000000, v66
    ds_add_rtn_u64 v[116:117], v123, v[124:125] offset:54272
    s_mov_b64 exec, -1
    v_ashrrev_i32 v122, 5, v67
    v_lshlrev_b16 v123, 2, v67
    v_lshlrev_b32 v124, 16, v38
    v_bitop3_b32 v122, v122, v113, v113 bitop3:0x0c
    v_and_b32 v125, 0xffff0000, v38
    v_lshlrev_b32 v126, 16, v39
    v_mul_f32 v122, v114, v122
    v_and_b32 v127, 0xffff0000, v39
    v_add_u32 v123, v123, v123
    v_pk_fma_f32 v[124:125], v[124:125], v[122:123], s[34:35] op_sel_hi:[1,0,1]
    v_pk_fma_f32 v[126:127], v[126:127], v[122:123], s[34:35] op_sel_hi:[1,0,1]
    v_lshl_add_u32 v124, v125, 16, v124
    v_lshl_add_u32 v125, v127, 16, v126
    s_waitcnt lgkmcnt(2)
    v_bitop3_b32 v115, v115, v118, v119 bitop3:0xfe
    v_lshl_add_u64 v[124:125], v[124:125], 0, s[36:37]
    v_cmpx_le_u32 vcc, 0x1000000, v67
    ds_add_rtn_u64 v[118:119], v123, v[124:125] offset:54272
    s_mov_b64 exec, -1
    v_ashrrev_i32 v122, 5, v68
    v_lshlrev_b16 v123, 2, v68
    v_lshlrev_b32 v124, 16, v40
    v_bitop3_b32 v122, v122, v113, v113 bitop3:0x0c
    v_and_b32 v125, 0xffff0000, v40
    v_lshlrev_b32 v126, 16, v41
    v_mul_f32 v122, v114, v122
    v_and_b32 v127, 0xffff0000, v41
    v_add_u32 v123, v123, v123
    v_pk_fma_f32 v[124:125], v[124:125], v[122:123], s[34:35] op_sel_hi:[1,0,1]
    v_pk_fma_f32 v[126:127], v[126:127], v[122:123], s[34:35] op_sel_hi:[1,0,1]
    v_lshl_add_u32 v124, v125, 16, v124
    v_lshl_add_u32 v125, v127, 16, v126
    s_waitcnt lgkmcnt(2)
    v_bitop3_b32 v115, v115, v120, v121 bitop3:0xfe
    v_lshl_add_u64 v[124:125], v[124:125], 0, s[36:37]
    v_cmpx_le_u32 vcc, 0x1000000, v68
    ds_add_rtn_u64 v[120:121], v123, v[124:125] offset:54272
    s_mov_b64 exec, -1
    s_cmp_le_u32 s15, 7
    s_cbranch_scc1 p2_nad0
    s_waitcnt lgkmcnt(15)
    v_ashrrev_i32 v122, 5, v69
    v_lshlrev_b16 v123, 2, v69
    v_lshlrev_b32 v124, 16, v42
    v_bitop3_b32 v122, v122, v113, v113 bitop3:0x0c
    v_and_b32 v125, 0xffff0000, v42
    v_lshlrev_b32 v126, 16, v43
    v_mul_f32 v122, v114, v122
    v_and_b32 v127, 0xffff0000, v43
    v_add_u32 v123, v123, v123
    v_pk_fma_f32 v[124:125], v[124:125], v[122:123], s[34:35] op_sel_hi:[1,0,1]
    v_pk_fma_f32 v[126:127], v[126:127], v[122:123], s[34:35] op_sel_hi:[1,0,1]
    v_lshl_add_u32 v124, v125, 16, v124
    v_lshl_add_u32 v125, v127, 16, v126
    s_waitcnt lgkmcnt(2)
    v_bitop3_b32 v115, v115, v116, v117 bitop3:0xfe
    v_lshl_add_u64 v[124:125], v[124:125], 0, s[36:37]
    v_cmpx_le_u32 vcc, 0x1000000, v69
    ds_add_rtn_u64 v[116:117], v123, v[124:125] offset:54272
    s_mov_b64 exec, -1
    v_ashrrev_i32 v122, 5, v70
    v_lshlrev_b16 v123, 2, v70
    v_lshlrev_b32 v124, 16, v44
    v_bitop3_b32 v122, v122, v113, v113 bitop3:0x0c
    v_and_b32 v125, 0xffff0000, v44
    v_lshlrev_b32 v126, 16, v45
    v_mul_f32 v122, v114, v122
    v_and_b32 v127, 0xffff0000, v45
    v_add_u32 v123, v123, v123
    v_pk_fma_f32 v[124:125], v[124:125], v[122:123], s[34:35] op_sel_hi:[1,0,1]
    v_pk_fma_f32 v[126:127], v[126:127], v[122:123], s[34:35] op_sel_hi:[1,0,1]
    v_lshl_add_u32 v124, v125, 16, v124
    v_lshl_add_u32 v125, v127, 16, v126
    s_waitcnt lgkmcnt(2)
    v_bitop3_b32 v115, v115, v118, v119 bitop3:0xfe
    v_lshl_add_u64 v[124:125], v[124:125], 0, s[36:37]
    v_cmpx_le_u32 vcc, 0x1000000, v70
    ds_add_rtn_u64 v[118:119], v123, v[124:125] offset:54272
    s_mov_b64 exec, -1
    v_ashrrev_i32 v122, 5, v71
    v_lshlrev_b16 v123, 2, v71
    v_lshlrev_b32 v124, 16, v46
    v_bitop3_b32 v122, v122, v113, v113 bitop3:0x0c
    v_and_b32 v125, 0xffff0000, v46
    v_lshlrev_b32 v126, 16, v47
    v_mul_f32 v122, v114, v122
    v_and_b32 v127, 0xffff0000, v47
    v_add_u32 v123, v123, v123
    v_pk_fma_f32 v[124:125], v[124:125], v[122:123], s[34:35] op_sel_hi:[1,0,1]
    v_pk_fma_f32 v[126:127], v[126:127], v[122:123], s[34:35] op_sel_hi:[1,0,1]
    v_lshl_add_u32 v124, v125, 16, v124
    v_lshl_add_u32 v125, v127, 16, v126
    s_waitcnt lgkmcnt(2)
    v_bitop3_b32 v115, v115, v120, v121 bitop3:0xfe
    v_lshl_add_u64 v[124:125], v[124:125], 0, s[36:37]
    v_cmpx_le_u32 vcc, 0x1000000, v71
    ds_add_rtn_u64 v[120:121], v123, v[124:125] offset:54272
    s_mov_b64 exec, -1
p2_nad0:
    s_branch p2_fin
p2_topf:
    s_cmp_eq_u32 s60, 10
    s_cbranch_scc1 p2_drain1
    v_cmpx_gt_i16 vcc, 0, v48
    ds_read_b64 v[0:1], v0
    s_mov_b64 exec, -1
    v_cmpx_gt_i16 vcc, 0, v49
    ds_read_b64 v[2:3], v2
    s_mov_b64 exec, -1
    v_cmpx_gt_i16 vcc, 0, v50
    ds_read_b64 v[4:5], v4
    s_mov_b64 exec, -1
    v_cmpx_gt_i16 vcc, 0, v51
    ds_read_b64 v[6:7], v6
    s_mov_b64 exec, -1
    v_cmpx_gt_i16 vcc, 0, v52
    ds_read_b64 v[8:9], v8
    s_mov_b64 exec, -1
    v_cmpx_gt_i16 vcc, 0, v53
    ds_read_b64 v[10:11], v10
    s_mov_b64 exec, -1
    v_cmpx_gt_i16 vcc, 0, v54
    ds_read_b64 v[12:13], v12
    s_mov_b64 exec, -1
    v_cmpx_gt_i16 vcc, 0, v55
    ds_read_b64 v[14:15], v14
    s_mov_b64 exec, -1
    v_cmpx_gt_i16 vcc, 0, v56
    ds_read_b64 v[16:17], v16
    s_mov_b64 exec, -1
    v_cmpx_gt_i16 vcc, 0, v57
    ds_read_b64 v[18:19], v18
    s_mov_b64 exec, -1
    v_cmpx_gt_i16 vcc, 0, v58
    ds_read_b64 v[20:21], v20
    s_mov_b64 exec, -1
    v_cmpx_gt_i16 vcc, 0, v59
    ds_read_b64 v[22:23], v22
    s_mov_b64 exec, -1
    s_cmp_ge_u32 s10, 9
    s_cbranch_scc1 p2_nm1m0a
    v_lshrrev_b32 v84, 1, v112
    s_add_u32 s44, s20, s42
    buffer_load_dwordx2 v[84:85], v84, s[4:7], s44 offen
p2_nm1m0a:
    buffer_load_dwordx4 v[72:75], v112, s[4:7], s20 offen offset:0
    buffer_load_dwordx4 v[76:79], v112, s[4:7], s20 offen offset:1024
    buffer_load_dwordx4 v[80:83], v112, s[4:7], s20 offen offset:2048
    v_cmpx_gt_i16 vcc, 0, v60
    ds_read_b64 v[24:25], v24
    s_mov_b64 exec, -1
    v_cmpx_gt_i16 vcc, 0, v61
    ds_read_b64 v[26:27], v26
    s_mov_b64 exec, -1
    v_cmpx_gt_i16 vcc, 0, v62
    ds_read_b64 v[28:29], v28
    s_mov_b64 exec, -1
    v_cmpx_gt_i16 vcc, 0, v63
    ds_read_b64 v[30:31], v30
    s_mov_b64 exec, -1
    v_cmpx_gt_i16 vcc, 0, v64
    ds_read_b64 v[32:33], v32
    s_mov_b64 exec, -1
    v_cmpx_gt_i16 vcc, 0, v65
    ds_read_b64 v[34:35], v34
    s_mov_b64 exec, -1
    v_cmpx_gt_i16 vcc, 0, v66
    ds_read_b64 v[36:37], v36
    s_mov_b64 exec, -1
    v_cmpx_gt_i16 vcc, 0, v67
    ds_read_b64 v[38:39], v38
    s_mov_b64 exec, -1
    v_cmpx_gt_i16 vcc, 0, v68
    ds_read_b64 v[40:41], v40
    s_mov_b64 exec, -1
    s_cmp_le_u32 s15, 7
    s_cbranch_scc1 p2_g1r27
    v_cmpx_gt_i16 vcc, 0, v69
    ds_read_b64 v[42:43], v42
    s_mov_b64 exec, -1
    v_cmpx_gt_i16 vcc, 0, v70
    ds_read_b64 v[44:45], v44
    s_mov_b64 exec, -1
    v_cmpx_gt_i16 vcc, 0, v71
    ds_read_b64 v[46:47], v46
    s_mov_b64 exec, -1
p2_g1r27:
    s_waitcnt lgkmcnt(15)
    v_ashrrev_i32 v122, 5, v48
    v_lshlrev_b16 v123, 2, v48
    v_cndmask_b32 v126, v0, v1, s[66:67]
    v_bitop3_b32 v122, v122, v113, v113 bitop3:0x0c
    v_lshlrev_b32 v124, 16, v126
    v_mul_f32 v122, v114, v122
    v_and_b32 v125, 0xffff0000, v126
    v_add_u32 v123, v123, v123
    v_mul_f32 v124, v122, v124
    v_mul_f32 v125, v122, v125
    v_cmpx_le_u32 vcc, 0x1000000, v48
    ds_add_f32 v123, v124 offset:54272
    ds_add_f32 v123, v125 offset:54276
    s_mov_b64 exec, -1
    v_ashrrev_i32 v122, 5, v49
    v_lshlrev_b16 v123, 2, v49
    v_cndmask_b32 v126, v2, v3, s[66:67]
    v_bitop3_b32 v122, v122, v113, v113 bitop3:0x0c
    v_lshlrev_b32 v124, 16, v126
    v_mul_f32 v122, v114, v122
    v_and_b32 v125, 0xffff0000, v126
    v_add_u32 v123, v123, v123
    v_mul_f32 v124, v122, v124
    v_mul_f32 v125, v122, v125
    v_cmpx_le_u32 vcc, 0x1000000, v49
    ds_add_f32 v123, v124 offset:54272
    ds_add_f32 v123, v125 offset:54276
    s_mov_b64 exec, -1
    v_ashrrev_i32 v122, 5, v50
    v_lshlrev_b16 v123, 2, v50
    v_cndmask_b32 v126, v4, v5, s[66:67]
    v_bitop3_b32 v122, v122, v113, v113 bitop3:0x0c
    v_lshlrev_b32 v124, 16, v126
    v_mul_f32 v122, v114, v122
    v_and_b32 v125, 0xffff0000, v126
    v_add_u32 v123, v123, v123
    v_mul_f32 v124, v122, v124
    v_mul_f32 v125, v122, v125
    v_cmpx_le_u32 vcc, 0x1000000, v50
    ds_add_f32 v123, v124 offset:54272
    ds_add_f32 v123, v125 offset:54276
    s_mov_b64 exec, -1
    v_bfe_u32 v0, v102, 14, 4
    v_lshrrev_b32 v1, 18, v102
    v_and_b32 v102, 0x3fff, v102
    v_mad_u32_u24 v0, v0, s63, v1
    v_lshl_or_b32 v102, v0, 14, v102
    buffer_load_dwordx4 v[0:3], v102, s[68:71], 0 offen
    s_waitcnt lgkmcnt(15)
    v_ashrrev_i32 v122, 5, v51
    v_lshlrev_b16 v123, 2, v51
    v_cndmask_b32 v126, v6, v7, s[66:67]
    v_bitop3_b32 v122, v122, v113, v113 bitop3:0x0c
    v_lshlrev_b32 v124, 16, v126
    v_mul_f32 v122, v114, v122
    v_and_b32 v125, 0xffff0000, v126
    v_add_u32 v123, v123, v123
    v_mul_f32 v124, v122, v124
    v_mul_f32 v125, v122, v125
    v_cmpx_le_u32 vcc, 0x1000000, v51
    ds_add_f32 v123, v124 offset:54272
    ds_add_f32 v123, v125 offset:54276
    s_mov_b64 exec, -1
    v_ashrrev_i32 v122, 5, v52
    v_lshlrev_b16 v123, 2, v52
    v_cndmask_b32 v126, v8, v9, s[66:67]
    v_bitop3_b32 v122, v122, v113, v113 bitop3:0x0c
    v_lshlrev_b32 v124, 16, v126
    v_mul_f32 v122, v114, v122
    v_and_b32 v125, 0xffff0000, v126
    v_add_u32 v123, v123, v123
    v_mul_f32 v124, v122, v124
    v_mul_f32 v125, v122, v125
    v_cmpx_le_u32 vcc, 0x1000000, v52
    ds_add_f32 v123, v124 offset:54272
    ds_add_f32 v123, v125 offset:54276
    s_mov_b64 exec, -1
    v_ashrrev_i32 v122, 5, v53
    v_lshlrev_b16 v123, 2, v53
    v_cndmask_b32 v126, v10, v11, s[66:67]
    v_bitop3_b32 v122, v122, v113, v113 bitop3:0x0c
    v_lshlrev_b32 v124, 16, v126
    v_mul_f32 v122, v114, v122
    v_and_b32 v125, 0xffff0000, v126
    v_add_u32 v123, v123, v123
    v_mul_f32 v124, v122, v124
    v_mul_f32 v125, v122, v125
    v_cmpx_le_u32 vcc, 0x1000000, v53
    ds_add_f32 v123, v124 offset:54272
    ds_add_f32 v123, v125 offset:54276
    s_mov_b64 exec, -1
    v_bfe_u32 v6, v103, 14, 4
    v_lshrrev_b32 v7, 18, v103
    v_and_b32 v103, 0x3fff, v103
    v_mad_u32_u24 v6, v6, s63, v7
    v_lshl_or_b32 v103, v6, 14, v103
    buffer_load_dwordx4 v[6:9], v103, s[68:71], 0 offen
    s_waitcnt lgkmcnt(12)
    s_barrier
    s_waitcnt vmcnt(6)
    s_mov_b32 m0, s23
    v_mov_b32 v53, 0x3c000
    s_movk_i32 s44, 512
    v_sub_u32_sdwa v4, v111, v110 dst_sel:DWORD dst_unused:UNUSED_PAD src0_sel:WORD_0 src1_sel:WORD_0
    v_sub_u32_sdwa v5, v111, v110 dst_sel:DWORD dst_unused:UNUSED_PAD src0_sel:WORD_1 src1_sel:WORD_1
    v_med3_i32 v4, v4, 0, s44
    v_med3_i32 v5, v5, 0, s44
    v_add_u32 v48, v4, v5
    ds_write_addtid_b32 v53 offset:0
    ds_write_addtid_b32 v53 offset:256
    ds_write_addtid_b32 v53 offset:512
    ds_write_addtid_b32 v53 offset:768
    ds_write_addtid_b32 v53 offset:1024
    ds_write_addtid_b32 v53 offset:1280
    ds_write_addtid_b32 v53 offset:1536
    ds_write_addtid_b32 v53 offset:1792
    v_bfe_i32 v53, v112, 6, 1
    v_lshrrev_b32 v49, 6, v112
    v_bitop3_b32 v53, v53, 15, s10 bitop3:0x6a
    v_lshl_or_b32 v49, v49, 4, v53
    v_and_b32 v53, 0x30, v112
    v_lshl_or_b32 v53, v49, 6, v53
    v_lshlrev_b32 v53, 15, v53
    s_nop 1
    v_add_u32_dpp v48, v48, v48 row_shr:1 row_mask:0xf bank_mask:0xf bound_ctrl:0
    s_nop 1
    v_add_u32_dpp v48, v48, v48 row_shr:2 row_mask:0xf bank_mask:0xf bound_ctrl:0
    s_nop 1
    v_add_u32_dpp v48, v48, v48 row_shr:4 row_mask:0xf bank_mask:0xf bound_ctrl:0
    s_nop 1
    v_add_u32_dpp v48, v48, v48 row_shr:8 row_mask:0xf bank_mask:0xf bound_ctrl:0
    s_nop 1
    v_add_u32_dpp v48, v48, v48 row_bcast:15 row_mask:0xa bank_mask:0xf
    s_nop 1
    v_add_u32_dpp v48, v48, v48 row_bcast:31 row_mask:0xc bank_mask:0xf
    s_nop 1
    s_nop 0
    v_readlane_b32 s38, v48, 63
    v_sub_u32 v50, v48, v5
    v_sub_u32 v49, v50, v4
    v_sub_u32 v10, 512, v49
    v_mad_u32_u16 v51, v110, 16, v53
    v_med3_i32 v10, v10, 0, v4
    v_lshl_add_u32 v49, v49, 2, s23
    v_sub_u32 v11, 512, v50
    v_mad_u32_u16 v52, v110, 16, v53 op_sel:[1,0,0,0]
    v_med3_i32 v11, v11, 0, v5
    v_lshl_add_u32 v50, v50, 2, s23
    v_lshl_add_u32 v48, v11, 16, v10
    v_add_u32 v52, 262144, v52
    v_add_u32 v110, v110, v48
    s_min_u32 s17, s38, 512
    s_add_u32 s17, s17, 63
    s_lshr_b32 s17, s17, 6
p2_x1x_0:
    v_cmpx_lt_i32 vcc, 0, v10
    s_cbranch_execz p2_y1x_0
    ds_write_b32 v49, v51 offset:0
    v_add_u32 v51, 16, v51
    v_cmpx_lt_i32 vcc, 1, v10
    s_cbranch_execz p2_y1x_0
    ds_write_b32 v49, v51 offset:4
    v_add_u32 v51, 16, v51
    v_cmpx_lt_i32 vcc, 2, v10
    s_cbranch_execz p2_y1x_0
    ds_write_b32 v49, v51 offset:8
    v_add_u32 v51, 16, v51
    v_cmpx_lt_i32 vcc, 3, v10
    s_cbranch_execz p2_y1x_0
    ds_write_b32 v49, v51 offset:12
    v_add_u32 v51, 16, v51
    v_cmpx_lt_i32 vcc, 4, v10
    s_cbranch_execz p2_y1x_0
    ds_write_b32 v49, v51 offset:16
    v_add_u32 v51, 16, v51
    v_cmpx_lt_i32 vcc, 5, v10
    s_cbranch_execz p2_y1x_0
    ds_write_b32 v49, v51 offset:20
    v_add_u32 v51, 16, v51
    v_cmpx_lt_i32 vcc, 6, v10
    s_cbranch_execz p2_y1x_0
    ds_write_b32 v49, v51 offset:24
    v_add_u32 v51, 16, v51
    v_cmpx_lt_i32 vcc, 7, v10
    s_cbranch_execz p2_y1x_0
    ds_write_b32 v49, v51 offset:28
    v_add_u32 v51, 16, v51
    v_subrev_u32 v10, 8, v10
    v_add_u32 v49, 32, v49
    s_branch p2_x1x_0
p2_y1x_0:
    s_mov_b64 exec, -1
p2_x1x_1:
    v_cmpx_lt_i32 vcc, 0, v11
    s_cbranch_execz p2_y1x_1
    ds_write_b32 v50, v52 offset:0
    v_add_u32 v52, 16, v52
    v_cmpx_lt_i32 vcc, 1, v11
    s_cbranch_execz p2_y1x_1
    ds_write_b32 v50, v52 offset:4
    v_add_u32 v52, 16, v52
    v_cmpx_lt_i32 vcc, 2, v11
    s_cbranch_execz p2_y1x_1
    ds_write_b32 v50, v52 offset:8
    v_add_u32 v52, 16, v52
    v_cmpx_lt_i32 vcc, 3, v11
    s_cbranch_execz p2_y1x_1
    ds_write_b32 v50, v52 offset:12
    v_add_u32 v52, 16, v52
    v_cmpx_lt_i32 vcc, 4, v11
    s_cbranch_execz p2_y1x_1
    ds_write_b32 v50, v52 offset:16
    v_add_u32 v52, 16, v52
    v_cmpx_lt_i32 vcc, 5, v11
    s_cbranch_execz p2_y1x_1
    ds_write_b32 v50, v52 offset:20
    v_add_u32 v52, 16, v52
    v_cmpx_lt_i32 vcc, 6, v11
    s_cbranch_execz p2_y1x_1
    ds_write_b32 v50, v52 offset:24
    v_add_u32 v52, 16, v52
    v_cmpx_lt_i32 vcc, 7, v11
    s_cbranch_execz p2_y1x_1
    ds_write_b32 v50, v52 offset:28
    v_add_u32 v52, 16, v52
    v_subrev_u32 v11, 8, v11
    v_add_u32 v50, 32, v50
    s_branch p2_x1x_1
p2_y1x_1:
    s_mov_b64 exec, -1
    s_cmp_lt_u32 s38, 512
    s_cbranch_scc1 p2_nomore1x
    v_cmp_lt_u32_sdwa s[44:45], v110, v111 src0_sel:WORD_0 src1_sel:WORD_0
    v_cmp_lt_u32_sdwa s[46:47], v110, v111 src0_sel:WORD_1 src1_sel:WORD_1
    s_nop 0
    s_or_b64 s[44:45], s[44:45], s[46:47]
    s_cbranch_scc0 p2_nomore1x
    v_mov_b32 v49, s19
    v_mov_b32 v50, 1
    ds_write_b32 v49, v50 offset:53760
p2_nomore1x:
    s_waitcnt lgkmcnt(15)
    v_ashrrev_i32 v122, 5, v54
    v_lshlrev_b16 v123, 2, v54
    v_cndmask_b32 v126, v12, v13, s[66:67]
    v_bitop3_b32 v122, v122, v113, v113 bitop3:0x0c
    v_lshlrev_b32 v124, 16, v126
    v_mul_f32 v122, v114, v122
    v_and_b32 v125, 0xffff0000, v126
    v_add_u32 v123, v123, v123
    v_mul_f32 v124, v122, v124
    v_mul_f32 v125, v122, v125
    v_cmpx_le_u32 vcc, 0x1000000, v54
    ds_add_f32 v123, v124 offset:54272
    ds_add_f32 v123, v125 offset:54276
    s_mov_b64 exec, -1
    v_ashrrev_i32 v122, 5, v55
    v_lshlrev_b16 v123, 2, v55
    v_cndmask_b32 v126, v14, v15, s[66:67]
    v_bitop3_b32 v122, v122, v113, v113 bitop3:0x0c
    v_lshlrev_b32 v124, 16, v126
    v_mul_f32 v122, v114, v122
    v_and_b32 v125, 0xffff0000, v126
    v_add_u32 v123, v123, v123
    v_mul_f32 v124, v122, v124
    v_mul_f32 v125, v122, v125
    v_cmpx_le_u32 vcc, 0x1000000, v55
    ds_add_f32 v123, v124 offset:54272
    ds_add_f32 v123, v125 offset:54276
    s_mov_b64 exec, -1
    v_ashrrev_i32 v122, 5, v56
    v_lshlrev_b16 v123, 2, v56
    v_cndmask_b32 v126, v16, v17, s[66:67]
    v_bitop3_b32 v122, v122, v113, v113 bitop3:0x0c
    v_lshlrev_b32 v124, 16, v126
    v_mul_f32 v122, v114, v122
    v_and_b32 v125, 0xffff0000, v126
    v_add_u32 v123, v123, v123
    v_mul_f32 v124, v122, v124
    v_mul_f32 v125, v122, v125
    v_cmpx_le_u32 vcc, 0x1000000, v56
    ds_add_f32 v123, v124 offset:54272
    ds_add_f32 v123, v125 offset:54276
    s_mov_b64 exec, -1
    v_bfe_u32 v12, v104, 14, 4
    v_lshrrev_b32 v13, 18, v104
    v_and_b32 v104, 0x3fff, v104
    v_mad_u32_u24 v12, v12, s63, v13
    v_lshl_or_b32 v104, v12, 14, v104
    buffer_load_dwordx4 v[12:15], v104, s[68:71], 0 offen
    s_waitcnt lgkmcnt(15)
    v_ashrrev_i32 v122, 5, v57
    v_lshlrev_b16 v123, 2, v57
    v_cndmask_b32 v126, v18, v19, s[66:67]
    v_bitop3_b32 v122, v122, v113, v113 bitop3:0x0c
    v_lshlrev_b32 v124, 16, v126
    v_mul_f32 v122, v114, v122
    v_and_b32 v125, 0xffff0000, v126
    v_add_u32 v123, v123, v123
    v_mul_f32 v124, v122, v124
    v_mul_f32 v125, v122, v125
    v_cmpx_le_u32 vcc, 0x1000000, v57
    ds_add_f32 v123, v124 offset:54272
    ds_add_f32 v123, v125 offset:54276
    s_mov_b64 exec, -1
    v_ashrrev_i32 v122, 5, v58
    v_lshlrev_b16 v123, 2, v58
    v_cndmask_b32 v126, v20, v21, s[66:67]
    v_bitop3_b32 v122, v122, v113, v113 bitop3:0x0c
    v_lshlrev_b32 v124, 16, v126
    v_mul_f32 v122, v114, v122
    v_and_b32 v125, 0xffff0000, v126
    v_add_u32 v123, v123, v123
    v_mul_f32 v124, v122, v124
    v_mul_f32 v125, v122, v125
    v_cmpx_le_u32 vcc, 0x1000000, v58
    ds_add_f32 v123, v124 offset:54272
    ds_add_f32 v123, v125 offset:54276
    s_mov_b64 exec, -1
    v_ashrrev_i32 v122, 5, v59
    v_lshlrev_b16 v123, 2, v59
    v_cndmask_b32 v126, v22, v23, s[66:67]
    v_bitop3_b32 v122, v122, v113, v113 bitop3:0x0c
    v_lshlrev_b32 v124, 16, v126
    v_mul_f32 v122, v114, v122
    v_and_b32 v125, 0xffff0000, v126
    v_add_u32 v123, v123, v123
    v_mul_f32 v124, v122, v124
    v_mul_f32 v125, v122, v125
    v_cmpx_le_u32 vcc, 0x1000000, v59
    ds_add_f32 v123, v124 offset:54272
    ds_add_f32 v123, v125 offset:54276
    s_mov_b64 exec, -1
    v_bfe_u32 v18, v105, 14, 4
    v_lshrrev_b32 v19, 18, v105
    v_and_b32 v105, 0x3fff, v105
    v_mad_u32_u24 v18, v18, s63, v19
    v_lshl_or_b32 v105, v18, 14, v105
    buffer_load_dwordx4 v[18:21], v105, s[68:71], 0 offen
    s_mov_b32 m0, s23
    s_nop 0
    ds_read_addtid_b32 v102 offset:0
    ds_read_addtid_b32 v103 offset:256
    ds_read_addtid_b32 v104 offset:512
    ds_read_addtid_b32 v105 offset:768
    ds_read_addtid_b32 v106 offset:1024
    ds_read_addtid_b32 v107 offset:1280
    ds_read_addtid_b32 v108 offset:1536
    ds_read_addtid_b32 v109 offset:1792
    s_waitcnt vmcnt(4)
    s_mov_b32 m0, s24
    s_cmp_ge_u32 s10, 9
    s_cbranch_scc1 p2_st1s0
    ds_write_addtid_b32 v84 offset:49152
    ds_write_addtid_b32 v85 offset:49408
p2_st1s0:
    s_mov_b32 m0, s23
    s_add_u32 s20, s20, 53760
    ds_write_addtid_b32 v72 offset:0
    ds_write_addtid_b32 v73 offset:256
    ds_write_addtid_b32 v74 offset:512
    ds_write_addtid_b32 v75 offset:768
    ds_write_addtid_b32 v76 offset:1024
    ds_write_addtid_b32 v77 offset:1280
    ds_write_addtid_b32 v78 offset:1536
    ds_write_addtid_b32 v79 offset:1792
    ds_write_addtid_b32 v80 offset:2048
    ds_write_addtid_b32 v81 offset:2304
    ds_write_addtid_b32 v82 offset:2560
    ds_write_addtid_b32 v83 offset:2816
    s_waitcnt lgkmcnt(15)
    v_ashrrev_i32 v122, 5, v60
    v_lshlrev_b16 v123, 2, v60
    v_cndmask_b32 v126, v24, v25, s[66:67]
    v_bitop3_b32 v122, v122, v113, v113 bitop3:0x0c
    v_lshlrev_b32 v124, 16, v126
    v_mul_f32 v122, v114, v122
    v_and_b32 v125, 0xffff0000, v126
    v_add_u32 v123, v123, v123
    v_mul_f32 v124, v122, v124
    v_mul_f32 v125, v122, v125
    v_cmpx_le_u32 vcc, 0x1000000, v60
    ds_add_f32 v123, v124 offset:54272
    ds_add_f32 v123, v125 offset:54276
    s_mov_b64 exec, -1
    v_ashrrev_i32 v122, 5, v61
    v_lshlrev_b16 v123, 2, v61
    v_cndmask_b32 v126, v26, v27, s[66:67]
    v_bitop3_b32 v122, v122, v113, v113 bitop3:0x0c
    v_lshlrev_b32 v124, 16, v126
    v_mul_f32 v122, v114, v122
    v_and_b32 v125, 0xffff0000, v126
    v_add_u32 v123, v123, v123
    v_mul_f32 v124, v122, v124
    v_mul_f32 v125, v122, v125
    v_cmpx_le_u32 vcc, 0x1000000, v61
    ds_add_f32 v123, v124 offset:54272
    ds_add_f32 v123, v125 offset:54276
    s_mov_b64 exec, -1
    v_ashrrev_i32 v122, 5, v62
    v_lshlrev_b16 v123, 2, v62
    v_cndmask_b32 v126, v28, v29, s[66:67]
    v_bitop3_b32 v122, v122, v113, v113 bitop3:0x0c
    v_lshlrev_b32 v124, 16, v126
    v_mul_f32 v122, v114, v122
    v_and_b32 v125, 0xffff0000, v126
    v_add_u32 v123, v123, v123
    v_mul_f32 v124, v122, v124
    v_mul_f32 v125, v122, v125
    v_cmpx_le_u32 vcc, 0x1000000, v62
    ds_add_f32 v123, v124 offset:54272
    ds_add_f32 v123, v125 offset:54276
    s_mov_b64 exec, -1
    s_waitcnt vmcnt(13)
    v_perm_b32 v60, v89, v86, s31
    v_perm_b32 v61, v89, v87, s32
    v_perm_b32 v62, v89, v88, s33
    v_lshlrev_b16 v28, 3, v88
    v_lshlrev_b16 v26, 3, v87
    v_lshlrev_b16 v24, 3, v86
    s_waitcnt lgkmcnt(6)
    s_barrier
    s_cmp_ge_u32 s10, 9
    s_cbranch_scc1 p2_nm1m1a
    v_lshrrev_b32 v84, 1, v112
    s_add_u32 s44, s20, s42
    buffer_load_dwordx2 v[84:85], v84, s[4:7], s44 offen
p2_nm1m1a:
    buffer_load_dwordx4 v[72:75], v112, s[4:7], s20 offen offset:0
    buffer_load_dwordx4 v[76:79], v112, s[4:7], s20 offen offset:1024
    buffer_load_dwordx4 v[80:83], v112, s[4:7], s20 offen offset:2048
    v_cmpx_ge_u16 vcc, 0x3fff, v60
    ds_read_b64 v[24:25], v24
    s_mov_b64 exec, -1
    v_cmpx_ge_u16 vcc, 0x3fff, v61
    ds_read_b64 v[26:27], v26
    s_mov_b64 exec, -1
    v_cmpx_ge_u16 vcc, 0x3fff, v62
    ds_read_b64 v[28:29], v28
    s_mov_b64 exec, -1
    s_waitcnt lgkmcnt(15)
    v_ashrrev_i32 v122, 5, v63
    v_lshlrev_b16 v123, 2, v63
    v_cndmask_b32 v126, v30, v31, s[66:67]
    v_bitop3_b32 v122, v122, v113, v113 bitop3:0x0c
    v_lshlrev_b32 v124, 16, v126
    v_mul_f32 v122, v114, v122
    v_and_b32 v125, 0xffff0000, v126
    v_add_u32 v123, v123, v123
    v_mul_f32 v124, v122, v124
    v_mul_f32 v125, v122, v125
    v_cmpx_le_u32 vcc, 0x1000000, v63
    ds_add_f32 v123, v124 offset:54272
    ds_add_f32 v123, v125 offset:54276
    s_mov_b64 exec, -1
    v_ashrrev_i32 v122, 5, v64
    v_lshlrev_b16 v123, 2, v64
    v_cndmask_b32 v126, v32, v33, s[66:67]
    v_bitop3_b32 v122, v122, v113, v113 bitop3:0x0c
    v_lshlrev_b32 v124, 16, v126
    v_mul_f32 v122, v114, v122
    v_and_b32 v125, 0xffff0000, v126
    v_add_u32 v123, v123, v123
    v_mul_f32 v124, v122, v124
    v_mul_f32 v125, v122, v125
    v_cmpx_le_u32 vcc, 0x1000000, v64
    ds_add_f32 v123, v124 offset:54272
    ds_add_f32 v123, v125 offset:54276
    s_mov_b64 exec, -1
    v_ashrrev_i32 v122, 5, v65
    v_lshlrev_b16 v123, 2, v65
    v_cndmask_b32 v126, v34, v35, s[66:67]
    v_bitop3_b32 v122, v122, v113, v113 bitop3:0x0c
    v_lshlrev_b32 v124, 16, v126
    v_mul_f32 v122, v114, v122
    v_and_b32 v125, 0xffff0000, v126
    v_add_u32 v123, v123, v123
    v_mul_f32 v124, v122, v124
    v_mul_f32 v125, v122, v125
    v_cmpx_le_u32 vcc, 0x1000000, v65
    ds_add_f32 v123, v124 offset:54272
    ds_add_f32 v123, v125 offset:54276
    s_mov_b64 exec, -1
    s_waitcnt vmcnt(15)
    v_perm_b32 v63, v93, v90, s31
    v_perm_b32 v64, v93, v91, s32
    v_perm_b32 v65, v93, v92, s33
    v_lshlrev_b16 v34, 3, v92
    v_lshlrev_b16 v32, 3, v91
    v_lshlrev_b16 v30, 3, v90
    v_cmpx_ge_u16 vcc, 0x3fff, v63
    ds_read_b64 v[30:31], v30
    s_mov_b64 exec, -1
    v_cmpx_ge_u16 vcc, 0x3fff, v64
    ds_read_b64 v[32:33], v32
    s_mov_b64 exec, -1
    v_cmpx_ge_u16 vcc, 0x3fff, v65
    ds_read_b64 v[34:35], v34
    s_mov_b64 exec, -1
    s_waitcnt lgkmcnt(15)
    v_bfe_u32 v86, v106, 14, 4
    v_lshrrev_b32 v87, 18, v106
    v_and_b32 v106, 0x3fff, v106
    v_mad_u32_u24 v86, v86, s63, v87
    v_lshl_or_b32 v106, v86, 14, v106
    buffer_load_dwordx4 v[86:89], v106, s[68:71], 0 offen
    s_waitcnt lgkmcnt(15)
    v_ashrrev_i32 v122, 5, v66
    v_lshlrev_b16 v123, 2, v66
    v_cndmask_b32 v126, v36, v37, s[66:67]
    v_bitop3_b32 v122, v122, v113, v113 bitop3:0x0c
    v_lshlrev_b32 v124, 16, v126
    v_mul_f32 v122, v114, v122
    v_and_b32 v125, 0xffff0000, v126
    v_add_u32 v123, v123, v123
    v_mul_f32 v124, v122, v124
    v_mul_f32 v125, v122, v125
    v_cmpx_le_u32 vcc, 0x1000000, v66
    ds_add_f32 v123, v124 offset:54272
    ds_add_f32 v123, v125 offset:54276
    s_mov_b64 exec, -1
    v_ashrrev_i32 v122, 5, v67
    v_lshlrev_b16 v123, 2, v67
    v_cndmask_b32 v126, v38, v39, s[66:67]
    v_bitop3_b32 v122, v122, v113, v113 bitop3:0x0c
    v_lshlrev_b32 v124, 16, v126
    v_mul_f32 v122, v114, v122
    v_and_b32 v125, 0xffff0000, v126
    v_add_u32 v123, v123, v123
    v_mul_f32 v124, v122, v124
    v_mul_f32 v125, v122, v125
    v_cmpx_le_u32 vcc, 0x1000000, v67
    ds_add_f32 v123, v124 offset:54272
    ds_add_f32 v123, v125 offset:54276
    s_mov_b64 exec, -1
    v_ashrrev_i32 v122, 5, v68
    v_lshlrev_b16 v123, 2, v68
    v_cndmask_b32 v126, v40, v41, s[66:67]
    v_bitop3_b32 v122, v122, v113, v113 bitop3:0x0c
    v_lshlrev_b32 v124, 16, v126
    v_mul_f32 v122, v114, v122
    v_and_b32 v125, 0xffff0000, v126
    v_add_u32 v123, v123, v123
    v_mul_f32 v124, v122, v124
    v_mul_f32 v125, v122, v125
    v_cmpx_le_u32 vcc, 0x1000000, v68
    ds_add_f32 v123, v124 offset:54272
    ds_add_f32 v123, v125 offset:54276
    s_mov_b64 exec, -1
    s_waitcnt vmcnt(12)
    v_perm_b32 v66, v97, v94, s31
    v_perm_b32 v67, v97, v95, s32
    v_perm_b32 v68, v97, v96, s33
    v_lshlrev_b16 v40, 3, v96
    v_lshlrev_b16 v38, 3, v95
    v_lshlrev_b16 v36, 3, v94
    v_cmpx_ge_u16 vcc, 0x3fff, v66
    ds_read_b64 v[36:37], v36
    s_mov_b64 exec, -1
    v_cmpx_ge_u16 vcc, 0x3fff, v67
    ds_read_b64 v[38:39], v38
    s_mov_b64 exec, -1
    v_cmpx_ge_u16 vcc, 0x3fff, v68
    ds_read_b64 v[40:41], v40
    s_mov_b64 exec, -1
    s_waitcnt lgkmcnt(15)
    v_bfe_u32 v90, v107, 14, 4
    v_lshrrev_b32 v91, 18, v107
    v_and_b32 v107, 0x3fff, v107
    v_mad_u32_u24 v90, v90, s63, v91
    v_lshl_or_b32 v107, v90, 14, v107
    buffer_load_dwordx4 v[90:93], v107, s[68:71], 0 offen
    s_cmp_le_u32 s15, 7
    s_cbranch_scc1 p2_na1a7
    s_waitcnt lgkmcnt(15)
    v_ashrrev_i32 v122, 5, v69
    v_lshlrev_b16 v123, 2, v69
    v_cndmask_b32 v126, v42, v43, s[66:67]
    v_bitop3_b32 v122, v122, v113, v113 bitop3:0x0c
    v_lshlrev_b32 v124, 16, v126
    v_mul_f32 v122, v114, v122
    v_and_b32 v125, 0xffff0000, v126
    v_add_u32 v123, v123, v123
    v_mul_f32 v124, v122, v124
    v_mul_f32 v125, v122, v125
    v_cmpx_le_u32 vcc, 0x1000000, v69
    ds_add_f32 v123, v124 offset:54272
    ds_add_f32 v123, v125 offset:54276
    s_mov_b64 exec, -1
    v_ashrrev_i32 v122, 5, v70
    v_lshlrev_b16 v123, 2, v70
    v_cndmask_b32 v126, v44, v45, s[66:67]
    v_bitop3_b32 v122, v122, v113, v113 bitop3:0x0c
    v_lshlrev_b32 v124, 16, v126
    v_mul_f32 v122, v114, v122
    v_and_b32 v125, 0xffff0000, v126
    v_add_u32 v123, v123, v123
    v_mul_f32 v124, v122, v124
    v_mul_f32 v125, v122, v125
    v_cmpx_le_u32 vcc, 0x1000000, v70
    ds_add_f32 v123, v124 offset:54272
    ds_add_f32 v123, v125 offset:54276
    s_mov_b64 exec, -1
    v_ashrrev_i32 v122, 5, v71
    v_lshlrev_b16 v123, 2, v71
    v_cndmask_b32 v126, v46, v47, s[66:67]
    v_bitop3_b32 v122, v122, v113, v113 bitop3:0x0c
    v_lshlrev_b32 v124, 16, v126
    v_mul_f32 v122, v114, v122
    v_and_b32 v125, 0xffff0000, v126
    v_add_u32 v123, v123, v123
    v_mul_f32 v124, v122, v124
    v_mul_f32 v125, v122, v125
    v_cmpx_le_u32 vcc, 0x1000000, v71
    ds_add_f32 v123, v124 offset:54272
    ds_add_f32 v123, v125 offset:54276
    s_mov_b64 exec, -1
p2_na1a7:
    s_waitcnt vmcnt(12)
    v_perm_b32 v69, v101, v98, s31
    v_perm_b32 v70, v101, v99, s32
    v_perm_b32 v71, v101, v100, s33
    v_lshlrev_b16 v46, 3, v100
    v_lshlrev_b16 v44, 3, v99
    v_lshlrev_b16 v42, 3, v98
    s_cmp_le_u32 s16, 7
    s_cbranch_scc1 p2_g1r07
    v_cmpx_ge_u16 vcc, 0x3fff, v69
    ds_read_b64 v[42:43], v42
    s_mov_b64 exec, -1
    v_cmpx_ge_u16 vcc, 0x3fff, v70
    ds_read_b64 v[44:45], v44
    s_mov_b64 exec, -1
    v_cmpx_ge_u16 vcc, 0x3fff, v71
    ds_read_b64 v[46:47], v46
    s_mov_b64 exec, -1
p2_g1r07:
    s_waitcnt vmcnt(8)
    v_perm_b32 v48, v3, v0, s31
    v_perm_b32 v49, v3, v1, s32
    v_perm_b32 v50, v3, v2, s33
    v_lshlrev_b16 v4, 3, v2
    v_lshlrev_b16 v2, 3, v1
    v_lshlrev_b16 v0, 3, v0
    v_cmpx_ge_u16 vcc, 0x3fff, v48
    ds_read_b64 v[0:1], v0
    s_mov_b64 exec, -1
    v_cmpx_ge_u16 vcc, 0x3fff, v49
    ds_read_b64 v[2:3], v2
    s_mov_b64 exec, -1
    v_cmpx_ge_u16 vcc, 0x3fff, v50
    ds_read_b64 v[4:5], v4
    s_mov_b64 exec, -1
    s_waitcnt vmcnt(7)
    v_perm_b32 v51, v9, v6, s31
    v_perm_b32 v52, v9, v7, s32
    v_perm_b32 v53, v9, v8, s33
    v_lshlrev_b16 v10, 3, v8
    v_lshlrev_b16 v8, 3, v7
    v_lshlrev_b16 v6, 3, v6
    v_cmpx_ge_u16 vcc, 0x3fff, v51
    ds_read_b64 v[6:7], v6
    s_mov_b64 exec, -1
    v_cmpx_ge_u16 vcc, 0x3fff, v52
    ds_read_b64 v[8:9], v8
    s_mov_b64 exec, -1
    v_cmpx_ge_u16 vcc, 0x3fff, v53
    ds_read_b64 v[10:11], v10
    s_mov_b64 exec, -1
    s_waitcnt vmcnt(6)
    v_perm_b32 v54, v15, v12, s31
    v_perm_b32 v55, v15, v13, s32
    v_perm_b32 v56, v15, v14, s33
    v_lshlrev_b16 v16, 3, v14
    v_lshlrev_b16 v14, 3, v13
    v_lshlrev_b16 v12, 3, v12
    v_cmpx_ge_u16 vcc, 0x3fff, v54
    ds_read_b64 v[12:13], v12
    s_mov_b64 exec, -1
    v_cmpx_ge_u16 vcc, 0x3fff, v55
    ds_read_b64 v[14:15], v14
    s_mov_b64 exec, -1
    v_cmpx_ge_u16 vcc, 0x3fff, v56
    ds_read_b64 v[16:17], v16
    s_mov_b64 exec, -1
    s_waitcnt vmcnt(5)
    v_perm_b32 v57, v21, v18, s31
    v_perm_b32 v58, v21, v19, s32
    v_perm_b32 v59, v21, v20, s33
    v_lshlrev_b16 v22, 3, v20
    v_lshlrev_b16 v20, 3, v19
    v_lshlrev_b16 v18, 3, v18
    v_cmpx_ge_u16 vcc, 0x3fff, v57
    ds_read_b64 v[18:19], v18
    s_mov_b64 exec, -1
    v_cmpx_ge_u16 vcc, 0x3fff, v58
    ds_read_b64 v[20:21], v20
    s_mov_b64 exec, -1
    v_cmpx_ge_u16 vcc, 0x3fff, v59
    ds_read_b64 v[22:23], v22
    s_mov_b64 exec, -1
    s_waitcnt lgkmcnt(0)
    s_barrier
    s_waitcnt lgkmcnt(15)
    s_branch p2_tail
p2_drain1:
    v_cmpx_gt_i16 vcc, 0, v48
    ds_read_b64 v[0:1], v0
    s_mov_b64 exec, -1
    v_cmpx_gt_i16 vcc, 0, v49
    ds_read_b64 v[2:3], v2
    s_mov_b64 exec, -1
    v_cmpx_gt_i16 vcc, 0, v50
    ds_read_b64 v[4:5], v4
    s_mov_b64 exec, -1
    v_cmpx_gt_i16 vcc, 0, v51
    ds_read_b64 v[6:7], v6
    s_mov_b64 exec, -1
    v_cmpx_gt_i16 vcc, 0, v52
    ds_read_b64 v[8:9], v8
    s_mov_b64 exec, -1
    v_cmpx_gt_i16 vcc, 0, v53
    ds_read_b64 v[10:11], v10
    s_mov_b64 exec, -1
    v_cmpx_gt_i16 vcc, 0, v54
    ds_read_b64 v[12:13], v12
    s_mov_b64 exec, -1
    v_cmpx_gt_i16 vcc, 0, v55
    ds_read_b64 v[14:15], v14
    s_mov_b64 exec, -1
    v_cmpx_gt_i16 vcc, 0, v56
    ds_read_b64 v[16:17], v16
    s_mov_b64 exec, -1
    v_cmpx_gt_i16 vcc, 0, v57
    ds_read_b64 v[18:19], v18
    s_mov_b64 exec, -1
    v_cmpx_gt_i16 vcc, 0, v58
    ds_read_b64 v[20:21], v20
    s_mov_b64 exec, -1
    v_cmpx_gt_i16 vcc, 0, v59
    ds_read_b64 v[22:23], v22
    s_mov_b64 exec, -1
    v_cmpx_gt_i16 vcc, 0, v60
    ds_read_b64 v[24:25], v24
    s_mov_b64 exec, -1
    v_cmpx_gt_i16 vcc, 0, v61
    ds_read_b64 v[26:27], v26
    s_mov_b64 exec, -1
    v_cmpx_gt_i16 vcc, 0, v62
    ds_read_b64 v[28:29], v28
    s_mov_b64 exec, -1
    v_cmpx_gt_i16 vcc, 0, v63
    ds_read_b64 v[30:31], v30
    s_mov_b64 exec, -1
    v_cmpx_gt_i16 vcc, 0, v64
    ds_read_b64 v[32:33], v32
    s_mov_b64 exec, -1
    v_cmpx_gt_i16 vcc, 0, v65
    ds_read_b64 v[34:35], v34
    s_mov_b64 exec, -1
    v_cmpx_gt_i16 vcc, 0, v66
    ds_read_b64 v[36:37], v36
    s_mov_b64 exec, -1
    v_cmpx_gt_i16 vcc, 0, v67
    ds_read_b64 v[38:39], v38
    s_mov_b64 exec, -1
    v_cmpx_gt_i16 vcc, 0, v68
    ds_read_b64 v[40:41], v40
    s_mov_b64 exec, -1
    s_cmp_le_u32 s15, 7
    s_cbranch_scc1 p2_gd1
    v_cmpx_gt_i16 vcc, 0, v69
    ds_read_b64 v[42:43], v42
    s_mov_b64 exec, -1
    v_cmpx_gt_i16 vcc, 0, v70
    ds_read_b64 v[44:45], v44
    s_mov_b64 exec, -1
    v_cmpx_gt_i16 vcc, 0, v71
    ds_read_b64 v[46:47], v46
    s_mov_b64 exec, -1
p2_gd1:
    s_waitcnt lgkmcnt(15)
    v_ashrrev_i32 v122, 5, v48
    v_lshlrev_b16 v123, 2, v48
    v_cndmask_b32 v126, v0, v1, s[66:67]
    v_bitop3_b32 v122, v122, v113, v113 bitop3:0x0c
    v_lshlrev_b32 v124, 16, v126
    v_mul_f32 v122, v114, v122
    v_and_b32 v125, 0xffff0000, v126
    v_add_u32 v123, v123, v123
    v_mul_f32 v124, v122, v124
    v_mul_f32 v125, v122, v125
    v_cmpx_le_u32 vcc, 0x1000000, v48
    ds_add_f32 v123, v124 offset:54272
    ds_add_f32 v123, v125 offset:54276
    s_mov_b64 exec, -1
    v_ashrrev_i32 v122, 5, v49
    v_lshlrev_b16 v123, 2, v49
    v_cndmask_b32 v126, v2, v3, s[66:67]
    v_bitop3_b32 v122, v122, v113, v113 bitop3:0x0c
    v_lshlrev_b32 v124, 16, v126
    v_mul_f32 v122, v114, v122
    v_and_b32 v125, 0xffff0000, v126
    v_add_u32 v123, v123, v123
    v_mul_f32 v124, v122, v124
    v_mul_f32 v125, v122, v125
    v_cmpx_le_u32 vcc, 0x1000000, v49
    ds_add_f32 v123, v124 offset:54272
    ds_add_f32 v123, v125 offset:54276
    s_mov_b64 exec, -1
    v_ashrrev_i32 v122, 5, v50
    v_lshlrev_b16 v123, 2, v50
    v_cndmask_b32 v126, v4, v5, s[66:67]
    v_bitop3_b32 v122, v122, v113, v113 bitop3:0x0c
    v_lshlrev_b32 v124, 16, v126
    v_mul_f32 v122, v114, v122
    v_and_b32 v125, 0xffff0000, v126
    v_add_u32 v123, v123, v123
    v_mul_f32 v124, v122, v124
    v_mul_f32 v125, v122, v125
    v_cmpx_le_u32 vcc, 0x1000000, v50
    ds_add_f32 v123, v124 offset:54272
    ds_add_f32 v123, v125 offset:54276
    s_mov_b64 exec, -1
    s_waitcnt lgkmcnt(15)
    v_ashrrev_i32 v122, 5, v51
    v_lshlrev_b16 v123, 2, v51
    v_cndmask_b32 v126, v6, v7, s[66:67]
    v_bitop3_b32 v122, v122, v113, v113 bitop3:0x0c
    v_lshlrev_b32 v124, 16, v126
    v_mul_f32 v122, v114, v122
    v_and_b32 v125, 0xffff0000, v126
    v_add_u32 v123, v123, v123
    v_mul_f32 v124, v122, v124
    v_mul_f32 v125, v122, v125
    v_cmpx_le_u32 vcc, 0x1000000, v51
    ds_add_f32 v123, v124 offset:54272
    ds_add_f32 v123, v125 offset:54276
    s_mov_b64 exec, -1
    v_ashrrev_i32 v122, 5, v52
    v_lshlrev_b16 v123, 2, v52
    v_cndmask_b32 v126, v8, v9, s[66:67]
    v_bitop3_b32 v122, v122, v113, v113 bitop3:0x0c
    v_lshlrev_b32 v124, 16, v126
    v_mul_f32 v122, v114, v122
    v_and_b32 v125, 0xffff0000, v126
    v_add_u32 v123, v123, v123
    v_mul_f32 v124, v122, v124
    v_mul_f32 v125, v122, v125
    v_cmpx_le_u32 vcc, 0x1000000, v52
    ds_add_f32 v123, v124 offset:54272
    ds_add_f32 v123, v125 offset:54276
    s_mov_b64 exec, -1
    v_ashrrev_i32 v122, 5, v53
    v_lshlrev_b16 v123, 2, v53
    v_cndmask_b32 v126, v10, v11, s[66:67]
    v_bitop3_b32 v122, v122, v113, v113 bitop3:0x0c
    v_lshlrev_b32 v124, 16, v126
    v_mul_f32 v122, v114, v122
    v_and_b32 v125, 0xffff0000, v126
    v_add_u32 v123, v123, v123
    v_mul_f32 v124, v122, v124
    v_mul_f32 v125, v122, v125
    v_cmpx_le_u32 vcc, 0x1000000, v53
    ds_add_f32 v123, v124 offset:54272
    ds_add_f32 v123, v125 offset:54276
    s_mov_b64 exec, -1
    s_waitcnt lgkmcnt(15)
    v_ashrrev_i32 v122, 5, v54
    v_lshlrev_b16 v123, 2, v54
    v_cndmask_b32 v126, v12, v13, s[66:67]
    v_bitop3_b32 v122, v122, v113, v113 bitop3:0x0c
    v_lshlrev_b32 v124, 16, v126
    v_mul_f32 v122, v114, v122
    v_and_b32 v125, 0xffff0000, v126
    v_add_u32 v123, v123, v123
    v_mul_f32 v124, v122, v124
    v_mul_f32 v125, v122, v125
    v_cmpx_le_u32 vcc, 0x1000000, v54
    ds_add_f32 v123, v124 offset:54272
    ds_add_f32 v123, v125 offset:54276
    s_mov_b64 exec, -1
    v_ashrrev_i32 v122, 5, v55
    v_lshlrev_b16 v123, 2, v55
    v_cndmask_b32 v126, v14, v15, s[66:67]
    v_bitop3_b32 v122, v122, v113, v113 bitop3:0x0c
    v_lshlrev_b32 v124, 16, v126
    v_mul_f32 v122, v114, v122
    v_and_b32 v125, 0xffff0000, v126
    v_add_u32 v123, v123, v123
    v_mul_f32 v124, v122, v124
    v_mul_f32 v125, v122, v125
    v_cmpx_le_u32 vcc, 0x1000000, v55
    ds_add_f32 v123, v124 offset:54272
    ds_add_f32 v123, v125 offset:54276
    s_mov_b64 exec, -1
    v_ashrrev_i32 v122, 5, v56
    v_lshlrev_b16 v123, 2, v56
    v_cndmask_b32 v126, v16, v17, s[66:67]
    v_bitop3_b32 v122, v122, v113, v113 bitop3:0x0c
    v_lshlrev_b32 v124, 16, v126
    v_mul_f32 v122, v114, v122
    v_and_b32 v125, 0xffff0000, v126
    v_add_u32 v123, v123, v123
    v_mul_f32 v124, v122, v124
    v_mul_f32 v125, v122, v125
    v_cmpx_le_u32 vcc, 0x1000000, v56
    ds_add_f32 v123, v124 offset:54272
    ds_add_f32 v123, v125 offset:54276
    s_mov_b64 exec, -1
    s_waitcnt lgkmcnt(15)
    v_ashrrev_i32 v122, 5, v57
    v_lshlrev_b16 v123, 2, v57
    v_cndmask_b32 v126, v18, v19, s[66:67]
    v_bitop3_b32 v122, v122, v113, v113 bitop3:0x0c
    v_lshlrev_b32 v124, 16, v126
    v_mul_f32 v122, v114, v122
    v_and_b32 v125, 0xffff0000, v126
    v_add_u32 v123, v123, v123
    v_mul_f32 v124, v122, v124
    v_mul_f32 v125, v122, v125
    v_cmpx_le_u32 vcc, 0x1000000, v57
    ds_add_f32 v123, v124 offset:54272
    ds_add_f32 v123, v125 offset:54276
    s_mov_b64 exec, -1
    v_ashrrev_i32 v122, 5, v58
    v_lshlrev_b16 v123, 2, v58
    v_cndmask_b32 v126, v20, v21, s[66:67]
    v_bitop3_b32 v122, v122, v113, v113 bitop3:0x0c
    v_lshlrev_b32 v124, 16, v126
    v_mul_f32 v122, v114, v122
    v_and_b32 v125, 0xffff0000, v126
    v_add_u32 v123, v123, v123
    v_mul_f32 v124, v122, v124
    v_mul_f32 v125, v122, v125
    v_cmpx_le_u32 vcc, 0x1000000, v58
    ds_add_f32 v123, v124 offset:54272
    ds_add_f32 v123, v125 offset:54276
    s_mov_b64 exec, -1
    v_ashrrev_i32 v122, 5, v59
    v_lshlrev_b16 v123, 2, v59
    v_cndmask_b32 v126, v22, v23, s[66:67]
    v_bitop3_b32 v122, v122, v113, v113 bitop3:0x0c
    v_lshlrev_b32 v124, 16, v126
    v_mul_f32 v122, v114, v122
    v_and_b32 v125, 0xffff0000, v126
    v_add_u32 v123, v123, v123
    v_mul_f32 v124, v122, v124
    v_mul_f32 v125, v122, v125
    v_cmpx_le_u32 vcc, 0x1000000, v59
    ds_add_f32 v123, v124 offset:54272
    ds_add_f32 v123, v125 offset:54276
    s_mov_b64 exec, -1
    s_waitcnt lgkmcnt(15)
    v_ashrrev_i32 v122, 5, v60
    v_lshlrev_b16 v123, 2, v60
    v_cndmask_b32 v126, v24, v25, s[66:67]
    v_bitop3_b32 v122, v122, v113, v113 bitop3:0x0c
    v_lshlrev_b32 v124, 16, v126
    v_mul_f32 v122, v114, v122
    v_and_b32 v125, 0xffff0000, v126
    v_add_u32 v123, v123, v123
    v_mul_f32 v124, v122, v124
    v_mul_f32 v125, v122, v125
    v_cmpx_le_u32 vcc, 0x1000000, v60
    ds_add_f32 v123, v124 offset:54272
    ds_add_f32 v123, v125 offset:54276
    s_mov_b64 exec, -1
    v_ashrrev_i32 v122, 5, v61
    v_lshlrev_b16 v123, 2, v61
    v_cndmask_b32 v126, v26, v27, s[66:67]
    v_bitop3_b32 v122, v122, v113, v113 bitop3:0x0c
    v_lshlrev_b32 v124, 16, v126
    v_mul_f32 v122, v114, v122
    v_and_b32 v125, 0xffff0000, v126
    v_add_u32 v123, v123, v123
    v_mul_f32 v124, v122, v124
    v_mul_f32 v125, v122, v125
    v_cmpx_le_u32 vcc, 0x1000000, v61
    ds_add_f32 v123, v124 offset:54272
    ds_add_f32 v123, v125 offset:54276
    s_mov_b64 exec, -1
    v_ashrrev_i32 v122, 5, v62
    v_lshlrev_b16 v123, 2, v62
    v_cndmask_b32 v126, v28, v29, s[66:67]
    v_bitop3_b32 v122, v122, v113, v113 bitop3:0x0c
    v_lshlrev_b32 v124, 16, v126
    v_mul_f32 v122, v114, v122
    v_and_b32 v125, 0xffff0000, v126
    v_add_u32 v123, v123, v123
    v_mul_f32 v124, v122, v124
    v_mul_f32 v125, v122, v125
    v_cmpx_le_u32 vcc, 0x1000000, v62
    ds_add_f32 v123, v124 offset:54272
    ds_add_f32 v123, v125 offset:54276
    s_mov_b64 exec, -1
    s_waitcnt lgkmcnt(15)
    v_ashrrev_i32 v122, 5, v63
    v_lshlrev_b16 v123, 2, v63
    v_cndmask_b32 v126, v30, v31, s[66:67]
    v_bitop3_b32 v122, v122, v113, v113 bitop3:0x0c
    v_lshlrev_b32 v124, 16, v126
    v_mul_f32 v122, v114, v122
    v_and_b32 v125, 0xffff0000, v126
    v_add_u32 v123, v123, v123
    v_mul_f32 v124, v122, v124
    v_mul_f32 v125, v122, v125
    v_cmpx_le_u32 vcc, 0x1000000, v63
    ds_add_f32 v123, v124 offset:54272
    ds_add_f32 v123, v125 offset:54276
    s_mov_b64 exec, -1
    v_ashrrev_i32 v122, 5, v64
    v_lshlrev_b16 v123, 2, v64
    v_cndmask_b32 v126, v32, v33, s[66:67]
    v_bitop3_b32 v122, v122, v113, v113 bitop3:0x0c
    v_lshlrev_b32 v124, 16, v126
    v_mul_f32 v122, v114, v122
    v_and_b32 v125, 0xffff0000, v126
    v_add_u32 v123, v123, v123
    v_mul_f32 v124, v122, v124
    v_mul_f32 v125, v122, v125
    v_cmpx_le_u32 vcc, 0x1000000, v64
    ds_add_f32 v123, v124 offset:54272
    ds_add_f32 v123, v125 offset:54276
    s_mov_b64 exec, -1
    v_ashrrev_i32 v122, 5, v65
    v_lshlrev_b16 v123, 2, v65
    v_cndmask_b32 v126, v34, v35, s[66:67]
    v_bitop3_b32 v122, v122, v113, v113 bitop3:0x0c
    v_lshlrev_b32 v124, 16, v126
    v_mul_f32 v122, v114, v122
    v_and_b32 v125, 0xffff0000, v126
    v_add_u32 v123, v123, v123
    v_mul_f32 v124, v122, v124
    v_mul_f32 v125, v122, v125
    v_cmpx_le_u32 vcc, 0x1000000, v65
    ds_add_f32 v123, v124 offset:54272
    ds_add_f32 v123, v125 offset:54276
    s_mov_b64 exec, -1
    s_waitcnt lgkmcnt(15)
    v_ashrrev_i32 v122, 5, v66
    v_lshlrev_b16 v123, 2, v66
    v_cndmask_b32 v126, v36, v37, s[66:67]
    v_bitop3_b32 v122, v122, v113, v113 bitop3:0x0c
    v_lshlrev_b32 v124, 16, v126
    v_mul_f32 v122, v114, v122
    v_and_b32 v125, 0xffff0000, v126
    v_add_u32 v123, v123, v123
    v_mul_f32 v124, v122, v124
    v_mul_f32 v125, v122, v125
    v_cmpx_le_u32 vcc, 0x1000000, v66
    ds_add_f32 v123, v124 offset:54272
    ds_add_f32 v123, v125 offset:54276
    s_mov_b64 exec, -1
    v_ashrrev_i32 v122, 5, v67
    v_lshlrev_b16 v123, 2, v67
    v_cndmask_b32 v126, v38, v39, s[66:67]
    v_bitop3_b32 v122, v122, v113, v113 bitop3:0x0c
    v_lshlrev_b32 v124, 16, v126
    v_mul_f32 v122, v114, v122
    v_and_b32 v125, 0xffff0000, v126
    v_add_u32 v123, v123, v123
    v_mul_f32 v124, v122, v124
    v_mul_f32 v125, v122, v125
    v_cmpx_le_u32 vcc, 0x1000000, v67
    ds_add_f32 v123, v124 offset:54272
    ds_add_f32 v123, v125 offset:54276
    s_mov_b64 exec, -1
    v_ashrrev_i32 v122, 5, v68
    v_lshlrev_b16 v123, 2, v68
    v_cndmask_b32 v126, v40, v41, s[66:67]
    v_bitop3_b32 v122, v122, v113, v113 bitop3:0x0c
    v_lshlrev_b32 v124, 16, v126
    v_mul_f32 v122, v114, v122
    v_and_b32 v125, 0xffff0000, v126
    v_add_u32 v123, v123, v123
    v_mul_f32 v124, v122, v124
    v_mul_f32 v125, v122, v125
    v_cmpx_le_u32 vcc, 0x1000000, v68
    ds_add_f32 v123, v124 offset:54272
    ds_add_f32 v123, v125 offset:54276
    s_mov_b64 exec, -1
    s_cmp_le_u32 s15, 7
    s_cbranch_scc1 p2_nad1
    s_waitcnt lgkmcnt(15)
    v_ashrrev_i32 v122, 5, v69
    v_lshlrev_b16 v123, 2, v69
    v_cndmask_b32 v126, v42, v43, s[66:67]
    v_bitop3_b32 v122, v122, v113, v113 bitop3:0x0c
    v_lshlrev_b32 v124, 16, v126
    v_mul_f32 v122, v114, v122
    v_and_b32 v125, 0xffff0000, v126
    v_add_u32 v123, v123, v123
    v_mul_f32 v124, v122, v124
    v_mul_f32 v125, v122, v125
    v_cmpx_le_u32 vcc, 0x1000000, v69
    ds_add_f32 v123, v124 offset:54272
    ds_add_f32 v123, v125 offset:54276
    s_mov_b64 exec, -1
    v_ashrrev_i32 v122, 5, v70
    v_lshlrev_b16 v123, 2, v70
    v_cndmask_b32 v126, v44, v45, s[66:67]
    v_bitop3_b32 v122, v122, v113, v113 bitop3:0x0c
    v_lshlrev_b32 v124, 16, v126
    v_mul_f32 v122, v114, v122
    v_and_b32 v125, 0xffff0000, v126
    v_add_u32 v123, v123, v123
    v_mul_f32 v124, v122, v124
    v_mul_f32 v125, v122, v125
    v_cmpx_le_u32 vcc, 0x1000000, v70
    ds_add_f32 v123, v124 offset:54272
    ds_add_f32 v123, v125 offset:54276
    s_mov_b64 exec, -1
    v_ashrrev_i32 v122, 5, v71
    v_lshlrev_b16 v123, 2, v71
    v_cndmask_b32 v126, v46, v47, s[66:67]
    v_bitop3_b32 v122, v122, v113, v113 bitop3:0x0c
    v_lshlrev_b32 v124, 16, v126
    v_mul_f32 v122, v114, v122
    v_and_b32 v125, 0xffff0000, v126
    v_add_u32 v123, v123, v123
    v_mul_f32 v124, v122, v124
    v_mul_f32 v125, v122, v125
    v_cmpx_le_u32 vcc, 0x1000000, v71
    ds_add_f32 v123, v124 offset:54272
    ds_add_f32 v123, v125 offset:54276
    s_mov_b64 exec, -1
p2_nad1:
    s_branch p2_fin
p2_tail:
    s_mov_b32 s60, s61
    s_mov_b32 s15, s16
    s_mov_b32 s16, s17
    v_mov_b32 v122, s19
    s_xor_b32 s19, s19, 4
    ds_read_b32 v125, v122 offset:53760
    v_mov_b32 v123, s19
    v_mov_b32 v124, 0
    ds_write_b32 v123, v124 offset:53760
    s_waitcnt vmcnt(2)
    s_mov_b32 m0, s24
    s_cmp_ge_u32 s10, 9
    s_cbranch_scc1 p2_st2s1
    ds_write_addtid_b32 v84 offset:49152
    ds_write_addtid_b32 v85 offset:49408
p2_st2s1:
    s_mov_b32 m0, s23
    s_add_u32 s20, s20, 53760
    ds_write_addtid_b32 v72 offset:0
    ds_write_addtid_b32 v73 offset:256
    ds_write_addtid_b32 v74 offset:512
    ds_write_addtid_b32 v75 offset:768
    ds_write_addtid_b32 v76 offset:1024
    ds_write_addtid_b32 v77 offset:1280
    ds_write_addtid_b32 v78 offset:1536
    ds_write_addtid_b32 v79 offset:1792
    ds_write_addtid_b32 v80 offset:2048
    ds_write_addtid_b32 v81 offset:2304
    ds_write_addtid_b32 v82 offset:2560
    ds_write_addtid_b32 v83 offset:2816
    s_cmp_ge_u32 s10, 9
    s_cbranch_scc1 p2_nm2m2a
    v_lshrrev_b32 v84, 1, v112
    s_add_u32 s44, s20, s42
    buffer_load_dwordx2 v[84:85], v84, s[4:7], s44 offen
p2_nm2m2a:
    buffer_load_dwordx4 v[72:75], v112, s[4:7], s20 offen offset:0
    buffer_load_dwordx4 v[76:79], v112, s[4:7], s20 offen offset:1024
    buffer_load_dwordx4 v[80:83], v112, s[4:7], s20 offen offset:2048
    s_waitcnt lgkmcnt(0)
    s_barrier
    v_cmpx_lt_i16 vcc, 0x3fff, v48
    ds_read_b64 v[0:1], v0
    s_mov_b64 exec, -1
    v_cmpx_lt_i16 vcc, 0x3fff, v49
    ds_read_b64 v[2:3], v2
    s_mov_b64 exec, -1
    v_cmpx_lt_i16 vcc, 0x3fff, v50
    ds_read_b64 v[4:5], v4
    s_mov_b64 exec, -1
    v_cmpx_lt_i16 vcc, 0x3fff, v51
    ds_read_b64 v[6:7], v6
    s_mov_b64 exec, -1
    v_cmpx_lt_i16 vcc, 0x3fff, v52
    ds_read_b64 v[8:9], v8
    s_mov_b64 exec, -1
    v_cmpx_lt_i16 vcc, 0x3fff, v53
    ds_read_b64 v[10:11], v10
    s_mov_b64 exec, -1
    s_waitcnt lgkmcnt(15)
    v_readfirstlane_b32 s44, v125
    s_nop 0
    s_cmp_lg_u32 s44, 0
    s_cbranch_scc1 p2_advb
    s_add_u32 s61, s61, 1
    s_min_u32 s61, s61, 10
    v_mov_b32 v110, 0
    v_mov_b32 v111, 0
    s_cmp_eq_u32 s61, 10
    s_cbranch_scc1 p2_advb
    s_add_u32 s44, s61, s18
    s_cmp_ge_u32 s44, 10
    s_cselect_b32 s53, 10, 0
    s_sub_u32 s44, s44, s53
    s_mul_i32 s44, s44, 4160
    s_add_u32 s44, s44, s40
    v_bfe_i32 v111, v112, 6, 1
    v_lshrrev_b32 v110, 6, v112
    v_bitop3_b32 v111, v111, 15, s10 bitop3:0x6a
    v_lshl_or_b32 v110, v110, 4, v111
    v_bfe_u32 v111, v112, 2, 4
    v_mul_u32_u24 v110, 41600, v110
    v_add_u32 v111, v110, v111
    v_add_u32 v110, 256, v112
    v_and_b32 v110, 0x400, v110
    v_lshl_or_b32 v111, v110, 20, v111
    buffer_load_dword v110, v111, s[4:7], s44 offen
    buffer_load_dword v111, v111, s[4:7], s44 offen offset:16
p2_advb:
    s_cmp_lg_u32 s10, 15
    s_cbranch_scc1 p2_ntg
    s_lshr_b32 s44, s2, 3
    s_mul_i32 s44, s44, 5120
    s_add_u32 s45, s60, s18
    s_cmp_ge_u32 s45, 10
    s_cselect_b32 s53, 10, 0
    s_sub_u32 s45, s45, s53
    s_mul_i32 s45, s45, 645120
    s_add_u32 s44, s44, s45
    s_add_u32 s44, s44, s62
    s_sub_u32 s44, s44, s23
    v_lshlrev_b32 v84, 3, v112
    s_mov_b32 exec_hi, 0xff
    buffer_load_dword v85, v84, s[4:7], s44 offen
    s_mov_b64 exec, -1
p2_ntg:
    v_cmpx_lt_i16 vcc, 0x3fff, v54
    ds_read_b64 v[12:13], v12
    s_mov_b64 exec, -1
    v_cmpx_lt_i16 vcc, 0x3fff, v55
    ds_read_b64 v[14:15], v14
    s_mov_b64 exec, -1
    v_cmpx_lt_i16 vcc, 0x3fff, v56
    ds_read_b64 v[16:17], v16
    s_mov_b64 exec, -1
    v_cmpx_lt_i16 vcc, 0x3fff, v57
    ds_read_b64 v[18:19], v18
    s_mov_b64 exec, -1
    v_cmpx_lt_i16 vcc, 0x3fff, v58
    ds_read_b64 v[20:21], v20
    s_mov_b64 exec, -1
    v_cmpx_lt_i16 vcc, 0x3fff, v59
    ds_read_b64 v[22:23], v22
    s_mov_b64 exec, -1
    v_bfe_u32 v94, v108, 14, 4
    v_lshrrev_b32 v95, 18, v108
    v_and_b32 v108, 0x3fff, v108
    v_mad_u32_u24 v94, v94, s63, v95
    v_lshl_or_b32 v108, v94, 14, v108
    buffer_load_dwordx4 v[94:97], v108, s[68:71], 0 offen
    v_cmpx_lt_i16 vcc, 0x3fff, v60
    ds_read_b64 v[24:25], v24
    s_mov_b64 exec, -1
    v_cmpx_lt_i16 vcc, 0x3fff, v61
    ds_read_b64 v[26:27], v26
    s_mov_b64 exec, -1
    v_cmpx_lt_i16 vcc, 0x3fff, v62
    ds_read_b64 v[28:29], v28
    s_mov_b64 exec, -1
    v_cmpx_lt_i16 vcc, 0x3fff, v63
    ds_read_b64 v[30:31], v30
    s_mov_b64 exec, -1
    v_cmpx_lt_i16 vcc, 0x3fff, v64
    ds_read_b64 v[32:33], v32
    s_mov_b64 exec, -1
    v_cmpx_lt_i16 vcc, 0x3fff, v65
    ds_read_b64 v[34:35], v34
    s_mov_b64 exec, -1
    v_cmpx_lt_i16 vcc, 0x3fff, v66
    ds_read_b64 v[36:37], v36
    s_mov_b64 exec, -1
    v_cmpx_lt_i16 vcc, 0x3fff, v67
    ds_read_b64 v[38:39], v38
    s_mov_b64 exec, -1
    v_cmpx_lt_i16 vcc, 0x3fff, v68
    ds_read_b64 v[40:41], v40
    s_mov_b64 exec, -1
    s_cmp_le_u32 s15, 7
    s_cbranch_scc1 p2_g2r17
    v_cmpx_lt_i16 vcc, 0x3fff, v69
    ds_read_b64 v[42:43], v42
    s_mov_b64 exec, -1
    v_cmpx_lt_i16 vcc, 0x3fff, v70
    ds_read_b64 v[44:45], v44
    s_mov_b64 exec, -1
    v_cmpx_lt_i16 vcc, 0x3fff, v71
    ds_read_b64 v[46:47], v46
    s_mov_b64 exec, -1
p2_g2r17:
    v_bfe_u32 v98, v109, 14, 4
    v_lshrrev_b32 v99, 18, v109
    v_and_b32 v109, 0x3fff, v109
    v_mad_u32_u24 v98, v98, s63, v99
    v_lshl_or_b32 v109, v98, 14, v109
    buffer_load_dwordx4 v[98:101], v109, s[68:71], 0 offen
    s_waitcnt lgkmcnt(0)
    s_barrier
    s_waitcnt vmcnt(2)
    s_mov_b32 m0, s24
    s_cmp_ge_u32 s10, 9
    s_cbranch_scc1 p2_st2s2
    ds_write_addtid_b32 v84 offset:49152
    ds_write_addtid_b32 v85 offset:49408
p2_st2s2:
    s_mov_b32 m0, s23
    s_add_u32 s20, s60, s18
    s_cmp_ge_u32 s20, 10
    s_cselect_b32 s53, 10, 0
    s_sub_u32 s20, s20, s53
    s_mul_i32 s20, s20, 645120
    s_add_u32 s20, s20, s62
    ds_write_addtid_b32 v72 offset:0
    ds_write_addtid_b32 v73 offset:256
    ds_write_addtid_b32 v74 offset:512
    ds_write_addtid_b32 v75 offset:768
    ds_write_addtid_b32 v76 offset:1024
    ds_write_addtid_b32 v77 offset:1280
    ds_write_addtid_b32 v78 offset:1536
    ds_write_addtid_b32 v79 offset:1792
    ds_write_addtid_b32 v80 offset:2048
    ds_write_addtid_b32 v81 offset:2304
    ds_write_addtid_b32 v82 offset:2560
    ds_write_addtid_b32 v83 offset:2816
    s_waitcnt lgkmcnt(0)
    s_barrier
    s_branch p2_top
p2_fin:
    s_waitcnt vmcnt(0) lgkmcnt(0)
    s_barrier
    s_mov_b32 s48, s11
    s_mul_i32 s44, s48, 800768
    s_mul_i32 s45, s12, 12512
    s_add_u32 s49, s44, s45
    s_lshl_b32 s44, s49, 3
    s_add_u32 s44, s44, 492278784
    s_lshl_b32 s48, s48, 2
    s_lshl_b32 s45, s12, 4
    s_add_u32 s48, s48, s45
    s_add_u32 s48, s48, 492277760
    v_add_u32 v123, s64, v112
    v_add_u32 v122, s25, v123
    v_mov_b32 v24, 0
    v_mov_b32 v25, 0
    v_mov_b32 v26, 0
    v_mov_b32 v27, 0
    v_cmp_gt_u32 vcc, 1792, v123
    v_mov_b32 v124, 0x38000000
    v_mov_b32 v126, 0
    v_cndmask_b32 v124, v124, v123, vcc
    ds_read_b128 v[0:3], v122 offset:0
    ds_read_b128 v[4:7], v122 offset:16384
    ds_read_b128 v[8:11], v122 offset:32768
    v_add_u32 v122, 49152, v122
    ds_read_b128 v[12:15], v122 offset:0
    ds_read_b128 v[16:19], v122 offset:16384
    ds_read_b128 v[20:23], v122 offset:32768
    s_mov_b64 exec, vcc
    ds_read_b128 v[24:27], v122 offset:49152
    s_mov_b64 exec, -1
    s_cmp_lg_u32 s21, 0
    s_cbranch_scc1 p2_finf
    s_waitcnt lgkmcnt(6)
    buffer_store_dwordx4 v[0:3], v123, s[4:7], s44 offen nt
    s_add_u32 s44, s44, 16384
    s_waitcnt lgkmcnt(5)
    buffer_store_dwordx4 v[4:7], v123, s[4:7], s44 offen nt
    s_add_u32 s44, s44, 16384
    s_waitcnt lgkmcnt(4)
    buffer_store_dwordx4 v[8:11], v123, s[4:7], s44 offen nt
    s_add_u32 s44, s44, 16384
    s_waitcnt lgkmcnt(3)
    buffer_store_dwordx4 v[12:15], v123, s[4:7], s44 offen nt
    s_add_u32 s44, s44, 16384
    s_waitcnt lgkmcnt(2)
    buffer_store_dwordx4 v[16:19], v123, s[4:7], s44 offen nt
    s_add_u32 s44, s44, 16384
    s_waitcnt lgkmcnt(1)
    buffer_store_dwordx4 v[20:23], v123, s[4:7], s44 offen nt
    s_add_u32 s44, s44, 16384
    s_waitcnt lgkmcnt(0)
    buffer_store_dwordx4 v[24:27], v124, s[4:7], s44 offen nt
    s_add_u32 s44, s44, 16384
    v_bitop3_b32 v115, v115, v0, v1 bitop3:0xfe
    v_bitop3_b32 v115, v115, v2, v3 bitop3:0xfe
    v_bitop3_b32 v115, v115, v4, v5 bitop3:0xfe
    v_bitop3_b32 v115, v115, v6, v7 bitop3:0xfe
    v_bitop3_b32 v115, v115, v8, v9 bitop3:0xfe
    v_bitop3_b32 v115, v115, v10, v11 bitop3:0xfe
    v_bitop3_b32 v115, v115, v12, v13 bitop3:0xfe
    v_bitop3_b32 v115, v115, v14, v15 bitop3:0xfe
    v_bitop3_b32 v115, v115, v16, v17 bitop3:0xfe
    v_bitop3_b32 v115, v115, v18, v19 bitop3:0xfe
    v_bitop3_b32 v115, v115, v20, v21 bitop3:0xfe
    v_bitop3_b32 v115, v115, v22, v23 bitop3:0xfe
    v_bitop3_b32 v115, v115, v24, v25 bitop3:0xfe
    v_bitop3_b32 v115, v115, v26, v27 bitop3:0xfe
    v_bitop3_b32 v115, v115, v116, v117 bitop3:0xfe
    v_bitop3_b32 v115, v115, v118, v119 bitop3:0xfe
    v_bitop3_b32 v115, v115, v120, v121 bitop3:0xfe
    v_and_b32 v115, 0x80008000, v115
    v_cmpx_ne_u32 vcc, 0, v115
    ds_write_b32 v126, v115 offset:53768
    s_mov_b64 exec, -1
    s_waitcnt lgkmcnt(0)
    s_barrier
    ds_read_b32 v125, v126 offset:53768
    s_waitcnt lgkmcnt(0)
    v_readfirstlane_b32 s45, v125
    s_nop 0
    s_cmp_eq_u32 s45, 0
    s_cbranch_scc1 p2_done
    s_mov_b32 s21, 1
    s_waitcnt vmcnt(0)
    s_branch p2_restart
p2_finf:
    s_lshl_b32 s49, s49, 4
    s_lshl_b32 s45, s21, 3
    s_add_u32 s49, s49, s45
    s_add_u32 s49, s49, 517903352
    v_mov_b32 v28, 1073758208
    v_mov_b32 v29, 1073758208
    v_mov_b32 v30, 1073758208
    v_mov_b32 v31, 1073758208
    v_lshlrev_b32 v122, 1, v123
    v_lshlrev_b32 v125, 1, v124
    s_waitcnt lgkmcnt(0)
    buffer_store_dwordx4 v[28:31], v123, s[4:7], s44 offen
    s_add_u32 s44, s44, 16384
    buffer_store_dwordx2 v[0:1], v122, s[4:7], s49 offen offset:0
    buffer_store_dwordx2 v[2:3], v122, s[4:7], s49 offen offset:16
    s_add_u32 s49, s49, 32768
    buffer_store_dwordx4 v[28:31], v123, s[4:7], s44 offen
    s_add_u32 s44, s44, 16384
    buffer_store_dwordx2 v[4:5], v122, s[4:7], s49 offen offset:0
    buffer_store_dwordx2 v[6:7], v122, s[4:7], s49 offen offset:16
    s_add_u32 s49, s49, 32768
    buffer_store_dwordx4 v[28:31], v123, s[4:7], s44 offen
    s_add_u32 s44, s44, 16384
    buffer_store_dwordx2 v[8:9], v122, s[4:7], s49 offen offset:0
    buffer_store_dwordx2 v[10:11], v122, s[4:7], s49 offen offset:16
    s_add_u32 s49, s49, 32768
    buffer_store_dwordx4 v[28:31], v123, s[4:7], s44 offen
    s_add_u32 s44, s44, 16384
    buffer_store_dwordx2 v[12:13], v122, s[4:7], s49 offen offset:0
    buffer_store_dwordx2 v[14:15], v122, s[4:7], s49 offen offset:16
    s_add_u32 s49, s49, 32768
    buffer_store_dwordx4 v[28:31], v123, s[4:7], s44 offen
    s_add_u32 s44, s44, 16384
    buffer_store_dwordx2 v[16:17], v122, s[4:7], s49 offen offset:0
    buffer_store_dwordx2 v[18:19], v122, s[4:7], s49 offen offset:16
    s_add_u32 s49, s49, 32768
    buffer_store_dwordx4 v[28:31], v123, s[4:7], s44 offen
    s_add_u32 s44, s44, 16384
    buffer_store_dwordx2 v[20:21], v122, s[4:7], s49 offen offset:0
    buffer_store_dwordx2 v[22:23], v122, s[4:7], s49 offen offset:16
    s_add_u32 s49, s49, 32768
    buffer_store_dwordx4 v[28:31], v124, s[4:7], s44 offen
    s_add_u32 s44, s44, 16384
    buffer_store_dwordx2 v[24:25], v125, s[4:7], s49 offen offset:0
    buffer_store_dwordx2 v[26:27], v125, s[4:7], s49 offen offset:16
    s_add_u32 s49, s49, 32768
    s_add_u32 s21, s21, 1
    s_mov_b32 s30, 0
    s_waitcnt vmcnt(0)
    s_cmp_eq_u32 s21, 2
    s_cbranch_scc1 p2_restart
p2_done:
    v_mov_b32 v125, s30
    buffer_store_dword v125, v126, s[4:7], s48 offen
p2_end:
    s_endpgm
.globl p3_kernel
.p2align 8
.type p3_kernel,@function
p3_kernel:
    s_cmp_ge_u32 s2, 1563
    s_cbranch_scc1 p3_end
    s_load_dwordx2 s[4:5], s[0:1], 0
    s_load_dwordx2 s[6:7], s[0:1], 24
    s_load_dwordx2 s[8:9], s[0:1], 40
    s_load_dwordx8 s[12:19], s[0:1], 56
    s_load_dwordx2 s[10:11], s[0:1], 88
    s_load_dwordx2 s[20:21], s[0:1], 104
    s_lshl_b32 s3, s2, 8
    v_add_u32 v0, s3, v0
    v_lshlrev_b32 v2, 4, v0
    v_lshlrev_b32 v3, 2, v0
    v_add_u32 v0, v0, v0
    v_mul_hi_u32_u24 v1, 343268, v0
    v_lshlrev_b16 v1, 4, v1
    s_waitcnt lgkmcnt(0)
    s_load_dwordx4 s[32:35], s[8:9], 0
    s_load_dwordx16 s[36:51], s[12:13], 0
    s_load_dwordx16 s[52:67], s[14:15], 0
    s_load_dwordx8 s[68:75], s[16:17], 0
    s_load_dwordx8 s[76:83], s[18:19], 0
    s_mov_b32 s24, s6
    s_and_b32 s25, s7, 0xffff
    s_mov_b32 s26, 1600000
    s_mov_b32 s27, 0x20000
    buffer_load_dword v4, v3, s[24:27], 0 offen nt
    s_mov_b32 s28, s20
    s_and_b32 s29, s21, 0xffff
    s_mov_b32 s30, 819200000
    s_mov_b32 s31, 0x20000
    s_mov_b32 s22, 492278784
    buffer_load_dwordx4 v[40:43], v2, s[28:31], s22 offen nt
    s_mov_b32 s22, 498684928
    buffer_load_dwordx4 v[44:47], v2, s[28:31], s22 offen nt
    s_mov_b32 s22, 505091072
    buffer_load_dwordx4 v[48:51], v2, s[28:31], s22 offen nt
    s_mov_b32 s22, 511497216
    buffer_load_dwordx4 v[52:55], v2, s[28:31], s22 offen nt
    s_mov_b32 s22, 492277760
    buffer_load_dwordx4 v[56:59], v1, s[28:31], s22 offen
    s_mov_b32 s24, s4
    s_and_b32 s25, s5, 0xffff
    s_mov_b32 s26, 6400000
    s_mov_b32 s27, 0x20000
    buffer_load_dwordx4 v[60:63], v2, s[24:27], 0 offen nt
    s_mov_b32 s24, s10
    s_and_b32 s25, s11, 0xffff
    s_mov_b32 s26, 6400000
    s_mov_b32 s27, 0x20000
    s_waitcnt vmcnt(6) lgkmcnt(0)
    v_and_b32 v5, 0xffff0000, v4
    v_lshlrev_b32 v4, 16, v4
    s_lshl_b32 s14, s32, 16
    s_and_b32 s15, s32, 0xffff0000
    v_pk_add_f32 v[8:9], v[4:5], s[14:15] op_sel:[0,0] op_sel_hi:[0,1] neg_lo:[0,1] neg_hi:[0,1]
    v_pk_add_f32 v[16:17], v[4:5], s[14:15] op_sel:[1,0] op_sel_hi:[1,1] neg_lo:[0,1] neg_hi:[0,1]
    s_lshl_b32 s16, s33, 16
    s_and_b32 s17, s33, 0xffff0000
    v_pk_add_f32 v[10:11], v[4:5], s[16:17] op_sel:[0,0] op_sel_hi:[0,1] neg_lo:[0,1] neg_hi:[0,1]
    v_pk_add_f32 v[18:19], v[4:5], s[16:17] op_sel:[1,0] op_sel_hi:[1,1] neg_lo:[0,1] neg_hi:[0,1]
    s_lshl_b32 s18, s34, 16
    s_and_b32 s19, s34, 0xffff0000
    v_pk_add_f32 v[12:13], v[4:5], s[18:19] op_sel:[0,0] op_sel_hi:[0,1] neg_lo:[0,1] neg_hi:[0,1]
    v_pk_add_f32 v[20:21], v[4:5], s[18:19] op_sel:[1,0] op_sel_hi:[1,1] neg_lo:[0,1] neg_hi:[0,1]
    s_lshl_b32 s12, s35, 16
    s_and_b32 s13, s35, 0xffff0000
    v_pk_add_f32 v[14:15], v[4:5], s[12:13] op_sel:[0,0] op_sel_hi:[0,1] neg_lo:[0,1] neg_hi:[0,1]
    v_pk_add_f32 v[22:23], v[4:5], s[12:13] op_sel:[1,0] op_sel_hi:[1,1] neg_lo:[0,1] neg_hi:[0,1]
    v_cvt_pk_bf16_f32 v8, v8, v9
    v_cvt_pk_bf16_f32 v10, v10, v11
    v_cvt_pk_bf16_f32 v12, v12, v13
    v_cvt_pk_bf16_f32 v14, v14, v15
    v_cvt_pk_bf16_f32 v16, v16, v17
    v_cvt_pk_bf16_f32 v18, v18, v19
    v_cvt_pk_bf16_f32 v20, v20, v21
    v_cvt_pk_bf16_f32 v22, v22, v23
    v_and_b32 v9, 0xffff0000, v8
    v_lshlrev_b32 v8, 16, v8
    v_and_b32 v11, 0xffff0000, v10
    v_lshlrev_b32 v10, 16, v10
    v_and_b32 v13, 0xffff0000, v12
    v_lshlrev_b32 v12, 16, v12
    v_and_b32 v15, 0xffff0000, v14
    v_lshlrev_b32 v14, 16, v14
    v_and_b32 v17, 0xffff0000, v16
    v_lshlrev_b32 v16, 16, v16
    v_and_b32 v19, 0xffff0000, v18
    v_lshlrev_b32 v18, 16, v18
    v_and_b32 v21, 0xffff0000, v20
    v_lshlrev_b32 v20, 16, v20
    v_and_b32 v23, 0xffff0000, v22
    v_lshlrev_b32 v22, 16, v22
    v_mul_f32 v8, v8, v8
    v_mul_f32 v9, v9, v9
    v_mul_f32 v10, v10, v10
    v_mul_f32 v11, v11, v11
    v_mul_f32 v12, v12, v12
    v_mul_f32 v13, v13, v13
    v_mul_f32 v14, v14, v14
    v_mul_f32 v15, v15, v15
    v_mul_f32 v16, v16, v16
    v_mul_f32 v17, v17, v17
    v_mul_f32 v18, v18, v18
    v_mul_f32 v19, v19, v19
    v_mul_f32 v20, v20, v20
    v_mul_f32 v21, v21, v21
    v_mul_f32 v22, v22, v22
    v_mul_f32 v23, v23, v23
    v_cvt_pk_bf16_f32 v8, v8, v9
    v_cvt_pk_bf16_f32 v10, v10, v11
    v_cvt_pk_bf16_f32 v12, v12, v13
    v_cvt_pk_bf16_f32 v14, v14, v15
    v_cvt_pk_bf16_f32 v16, v16, v17
    v_cvt_pk_bf16_f32 v18, v18, v19
    v_cvt_pk_bf16_f32 v20, v20, v21
    v_cvt_pk_bf16_f32 v22, v22, v23
    v_and_b32 v9, 0xffff0000, v8
    v_lshlrev_b32 v8, 16, v8
    v_and_b32 v11, 0xffff0000, v10
    v_lshlrev_b32 v10, 16, v10
    v_and_b32 v13, 0xffff0000, v12
    v_lshlrev_b32 v12, 16, v12
    v_and_b32 v15, 0xffff0000, v14
    v_lshlrev_b32 v14, 16, v14
    v_and_b32 v17, 0xffff0000, v16
    v_lshlrev_b32 v16, 16, v16
    v_and_b32 v19, 0xffff0000, v18
    v_lshlrev_b32 v18, 16, v18
    v_and_b32 v21, 0xffff0000, v20
    v_lshlrev_b32 v20, 16, v20
    v_and_b32 v23, 0xffff0000, v22
    v_lshlrev_b32 v22, 16, v22
    v_mul_f32 v8, 0xc1200000, v8
    v_mul_f32 v9, 0xc1200000, v9
    v_mul_f32 v10, 0xc1200000, v10
    v_mul_f32 v11, 0xc1200000, v11
    v_mul_f32 v12, 0xc1200000, v12
    v_mul_f32 v13, 0xc1200000, v13
    v_mul_f32 v14, 0xc1200000, v14
    v_mul_f32 v15, 0xc1200000, v15
    v_mul_f32 v16, 0xc1200000, v16
    v_mul_f32 v17, 0xc1200000, v17
    v_mul_f32 v18, 0xc1200000, v18
    v_mul_f32 v19, 0xc1200000, v19
    v_mul_f32 v20, 0xc1200000, v20
    v_mul_f32 v21, 0xc1200000, v21
    v_mul_f32 v22, 0xc1200000, v22
    v_mul_f32 v23, 0xc1200000, v23
    v_cvt_pk_bf16_f32 v8, v8, v9
    v_cvt_pk_bf16_f32 v10, v10, v11
    v_cvt_pk_bf16_f32 v12, v12, v13
    v_cvt_pk_bf16_f32 v14, v14, v15
    v_cvt_pk_bf16_f32 v16, v16, v17
    v_cvt_pk_bf16_f32 v18, v18, v19
    v_cvt_pk_bf16_f32 v20, v20, v21
    v_cvt_pk_bf16_f32 v22, v22, v23
    v_and_b32 v9, 0xffff0000, v8
    v_lshlrev_b32 v8, 16, v8
    v_and_b32 v11, 0xffff0000, v10
    v_lshlrev_b32 v10, 16, v10
    v_and_b32 v13, 0xffff0000, v12
    v_lshlrev_b32 v12, 16, v12
    v_and_b32 v15, 0xffff0000, v14
    v_lshlrev_b32 v14, 16, v14
    v_and_b32 v17, 0xffff0000, v16
    v_lshlrev_b32 v16, 16, v16
    v_and_b32 v19, 0xffff0000, v18
    v_lshlrev_b32 v18, 16, v18
    v_and_b32 v21, 0xffff0000, v20
    v_lshlrev_b32 v20, 16, v20
    v_and_b32 v23, 0xffff0000, v22
    v_lshlrev_b32 v22, 16, v22
    v_mul_f32 v8, 0x3fb8aa3b, v8
    v_mul_f32 v9, 0x3fb8aa3b, v9
    v_mul_f32 v10, 0x3fb8aa3b, v10
    v_mul_f32 v11, 0x3fb8aa3b, v11
    v_mul_f32 v12, 0x3fb8aa3b, v12
    v_mul_f32 v13, 0x3fb8aa3b, v13
    v_mul_f32 v14, 0x3fb8aa3b, v14
    v_mul_f32 v15, 0x3fb8aa3b, v15
    v_mul_f32 v16, 0x3fb8aa3b, v16
    v_mul_f32 v17, 0x3fb8aa3b, v17
    v_mul_f32 v18, 0x3fb8aa3b, v18
    v_mul_f32 v19, 0x3fb8aa3b, v19
    v_mul_f32 v20, 0x3fb8aa3b, v20
    v_mul_f32 v21, 0x3fb8aa3b, v21
    v_mul_f32 v22, 0x3fb8aa3b, v22
    v_mul_f32 v23, 0x3fb8aa3b, v23
    v_exp_f32 v8, v8
    v_exp_f32 v9, v9
    v_exp_f32 v10, v10
    v_exp_f32 v11, v11
    v_exp_f32 v12, v12
    v_exp_f32 v13, v13
    v_exp_f32 v14, v14
    v_exp_f32 v15, v15
    v_exp_f32 v16, v16
    v_exp_f32 v17, v17
    v_exp_f32 v18, v18
    v_exp_f32 v19, v19
    v_exp_f32 v20, v20
    v_exp_f32 v21, v21
    v_exp_f32 v22, v22
    v_exp_f32 v23, v23
    s_nop 0
    v_cvt_pk_bf16_f32 v8, v8, v9
    v_cvt_pk_bf16_f32 v10, v10, v11
    v_cvt_pk_bf16_f32 v12, v12, v13
    v_cvt_pk_bf16_f32 v14, v14, v15
    v_cvt_pk_bf16_f32 v16, v16, v17
    v_cvt_pk_bf16_f32 v18, v18, v19
    v_cvt_pk_bf16_f32 v20, v20, v21
    v_cvt_pk_bf16_f32 v22, v22, v23
    v_and_b32 v9, 0xffff0000, v8
    v_lshlrev_b32 v8, 16, v8
    v_and_b32 v11, 0xffff0000, v10
    v_lshlrev_b32 v10, 16, v10
    v_and_b32 v13, 0xffff0000, v12
    v_lshlrev_b32 v12, 16, v12
    v_and_b32 v15, 0xffff0000, v14
    v_lshlrev_b32 v14, 16, v14
    v_and_b32 v17, 0xffff0000, v16
    v_lshlrev_b32 v16, 16, v16
    v_and_b32 v19, 0xffff0000, v18
    v_lshlrev_b32 v18, 16, v18
    v_and_b32 v21, 0xffff0000, v20
    v_lshlrev_b32 v20, 16, v20
    v_and_b32 v23, 0xffff0000, v22
    v_lshlrev_b32 v22, 16, v22
    s_lshl_b32 s14, s52, 16
    s_and_b32 s15, s52, 0xffff0000
    v_pk_mul_f32 v[24:25], v[8:9], s[14:15] op_sel:[0,0] op_sel_hi:[0,1]
    v_pk_mul_f32 v[28:29], v[16:17], s[14:15] op_sel:[0,0] op_sel_hi:[0,1]
    s_lshl_b32 s16, s53, 16
    s_and_b32 s17, s53, 0xffff0000
    v_pk_mul_f32 v[26:27], v[8:9], s[16:17] op_sel:[0,0] op_sel_hi:[0,1]
    v_pk_mul_f32 v[30:31], v[16:17], s[16:17] op_sel:[0,0] op_sel_hi:[0,1]
    s_lshl_b32 s18, s54, 16
    s_and_b32 s19, s54, 0xffff0000
    v_pk_fma_f32 v[24:25], v[8:9], s[18:19], v[24:25] op_sel:[1,0,0] op_sel_hi:[1,1,1]
    v_pk_fma_f32 v[28:29], v[16:17], s[18:19], v[28:29] op_sel:[1,0,0] op_sel_hi:[1,1,1]
    s_lshl_b32 s12, s55, 16
    s_and_b32 s13, s55, 0xffff0000
    v_pk_fma_f32 v[26:27], v[8:9], s[12:13], v[26:27] op_sel:[1,0,0] op_sel_hi:[1,1,1]
    v_pk_fma_f32 v[30:31], v[16:17], s[12:13], v[30:31] op_sel:[1,0,0] op_sel_hi:[1,1,1]
    s_lshl_b32 s14, s56, 16
    s_and_b32 s15, s56, 0xffff0000
    v_pk_fma_f32 v[24:25], v[10:11], s[14:15], v[24:25] op_sel:[0,0,0] op_sel_hi:[0,1,1]
    v_pk_fma_f32 v[28:29], v[18:19], s[14:15], v[28:29] op_sel:[0,0,0] op_sel_hi:[0,1,1]
    s_lshl_b32 s16, s57, 16
    s_and_b32 s17, s57, 0xffff0000
    v_pk_fma_f32 v[26:27], v[10:11], s[16:17], v[26:27] op_sel:[0,0,0] op_sel_hi:[0,1,1]
    v_pk_fma_f32 v[30:31], v[18:19], s[16:17], v[30:31] op_sel:[0,0,0] op_sel_hi:[0,1,1]
    s_lshl_b32 s18, s58, 16
    s_and_b32 s19, s58, 0xffff0000
    v_pk_fma_f32 v[24:25], v[10:11], s[18:19], v[24:25] op_sel:[1,0,0] op_sel_hi:[1,1,1]
    v_pk_fma_f32 v[28:29], v[18:19], s[18:19], v[28:29] op_sel:[1,0,0] op_sel_hi:[1,1,1]
    s_lshl_b32 s12, s59, 16
    s_and_b32 s13, s59, 0xffff0000
    v_pk_fma_f32 v[26:27], v[10:11], s[12:13], v[26:27] op_sel:[1,0,0] op_sel_hi:[1,1,1]
    v_pk_fma_f32 v[30:31], v[18:19], s[12:13], v[30:31] op_sel:[1,0,0] op_sel_hi:[1,1,1]
    s_lshl_b32 s14, s60, 16
    s_and_b32 s15, s60, 0xffff0000
    v_pk_fma_f32 v[24:25], v[12:13], s[14:15], v[24:25] op_sel:[0,0,0] op_sel_hi:[0,1,1]
    v_pk_fma_f32 v[28:29], v[20:21], s[14:15], v[28:29] op_sel:[0,0,0] op_sel_hi:[0,1,1]
    s_lshl_b32 s16, s61, 16
    s_and_b32 s17, s61, 0xffff0000
    v_pk_fma_f32 v[26:27], v[12:13], s[16:17], v[26:27] op_sel:[0,0,0] op_sel_hi:[0,1,1]
    v_pk_fma_f32 v[30:31], v[20:21], s[16:17], v[30:31] op_sel:[0,0,0] op_sel_hi:[0,1,1]
    s_lshl_b32 s18, s62, 16
    s_and_b32 s19, s62, 0xffff0000
    v_pk_fma_f32 v[24:25], v[12:13], s[18:19], v[24:25] op_sel:[1,0,0] op_sel_hi:[1,1,1]
    v_pk_fma_f32 v[28:29], v[20:21], s[18:19], v[28:29] op_sel:[1,0,0] op_sel_hi:[1,1,1]
    s_lshl_b32 s12, s63, 16
    s_and_b32 s13, s63, 0xffff0000
    v_pk_fma_f32 v[26:27], v[12:13], s[12:13], v[26:27] op_sel:[1,0,0] op_sel_hi:[1,1,1]
    v_pk_fma_f32 v[30:31], v[20:21], s[12:13], v[30:31] op_sel:[1,0,0] op_sel_hi:[1,1,1]
    s_lshl_b32 s14, s64, 16
    s_and_b32 s15, s64, 0xffff0000
    v_pk_fma_f32 v[24:25], v[14:15], s[14:15], v[24:25] op_sel:[0,0,0] op_sel_hi:[0,1,1]
    v_pk_fma_f32 v[28:29], v[22:23], s[14:15], v[28:29] op_sel:[0,0,0] op_sel_hi:[0,1,1]
    s_lshl_b32 s16, s65, 16
    s_and_b32 s17, s65, 0xffff0000
    v_pk_fma_f32 v[26:27], v[14:15], s[16:17], v[26:27] op_sel:[0,0,0] op_sel_hi:[0,1,1]
    v_pk_fma_f32 v[30:31], v[22:23], s[16:17], v[30:31] op_sel:[0,0,0] op_sel_hi:[0,1,1]
    s_lshl_b32 s18, s66, 16
    s_and_b32 s19, s66, 0xffff0000
    v_pk_fma_f32 v[24:25], v[14:15], s[18:19], v[24:25] op_sel:[1,0,0] op_sel_hi:[1,1,1]
    v_pk_fma_f32 v[28:29], v[22:23], s[18:19], v[28:29] op_sel:[1,0,0] op_sel_hi:[1,1,1]
    s_lshl_b32 s12, s67, 16
    s_and_b32 s13, s67, 0xffff0000
    v_pk_fma_f32 v[26:27], v[14:15], s[12:13], v[26:27] op_sel:[1,0,0] op_sel_hi:[1,1,1]
    v_pk_fma_f32 v[30:31], v[22:23], s[12:13], v[30:31] op_sel:[1,0,0] op_sel_hi:[1,1,1]
    s_lshl_b32 s14, s36, 16
    s_and_b32 s15, s36, 0xffff0000
    v_pk_mul_f32 v[32:33], v[8:9], s[14:15] op_sel:[0,0] op_sel_hi:[0,1]
    v_pk_mul_f32 v[36:37], v[16:17], s[14:15] op_sel:[0,0] op_sel_hi:[0,1]
    s_lshl_b32 s16, s37, 16
    s_and_b32 s17, s37, 0xffff0000
    v_pk_mul_f32 v[34:35], v[8:9], s[16:17] op_sel:[0,0] op_sel_hi:[0,1]
    v_pk_mul_f32 v[38:39], v[16:17], s[16:17] op_sel:[0,0] op_sel_hi:[0,1]
    s_lshl_b32 s18, s38, 16
    s_and_b32 s19, s38, 0xffff0000
    v_pk_fma_f32 v[32:33], v[8:9], s[18:19], v[32:33] op_sel:[1,0,0] op_sel_hi:[1,1,1]
    v_pk_fma_f32 v[36:37], v[16:17], s[18:19], v[36:37] op_sel:[1,0,0] op_sel_hi:[1,1,1]
    s_lshl_b32 s12, s39, 16
    s_and_b32 s13, s39, 0xffff0000
    v_pk_fma_f32 v[34:35], v[8:9], s[12:13], v[34:35] op_sel:[1,0,0] op_sel_hi:[1,1,1]
    v_pk_fma_f32 v[38:39], v[16:17], s[12:13], v[38:39] op_sel:[1,0,0] op_sel_hi:[1,1,1]
    s_lshl_b32 s14, s40, 16
    s_and_b32 s15, s40, 0xffff0000
    v_pk_fma_f32 v[32:33], v[10:11], s[14:15], v[32:33] op_sel:[0,0,0] op_sel_hi:[0,1,1]
    v_pk_fma_f32 v[36:37], v[18:19], s[14:15], v[36:37] op_sel:[0,0,0] op_sel_hi:[0,1,1]
    s_lshl_b32 s16, s41, 16
    s_and_b32 s17, s41, 0xffff0000
    v_pk_fma_f32 v[34:35], v[10:11], s[16:17], v[34:35] op_sel:[0,0,0] op_sel_hi:[0,1,1]
    v_pk_fma_f32 v[38:39], v[18:19], s[16:17], v[38:39] op_sel:[0,0,0] op_sel_hi:[0,1,1]
    s_lshl_b32 s18, s42, 16
    s_and_b32 s19, s42, 0xffff0000
    v_pk_fma_f32 v[32:33], v[10:11], s[18:19], v[32:33] op_sel:[1,0,0] op_sel_hi:[1,1,1]
    v_pk_fma_f32 v[36:37], v[18:19], s[18:19], v[36:37] op_sel:[1,0,0] op_sel_hi:[1,1,1]
    s_lshl_b32 s12, s43, 16
    s_and_b32 s13, s43, 0xffff0000
    v_pk_fma_f32 v[34:35], v[10:11], s[12:13], v[34:35] op_sel:[1,0,0] op_sel_hi:[1,1,1]
    v_pk_fma_f32 v[38:39], v[18:19], s[12:13], v[38:39] op_sel:[1,0,0] op_sel_hi:[1,1,1]
    s_lshl_b32 s14, s44, 16
    s_and_b32 s15, s44, 0xffff0000
    v_pk_fma_f32 v[32:33], v[12:13], s[14:15], v[32:33] op_sel:[0,0,0] op_sel_hi:[0,1,1]
    v_pk_fma_f32 v[36:37], v[20:21], s[14:15], v[36:37] op_sel:[0,0,0] op_sel_hi:[0,1,1]
    s_lshl_b32 s16, s45, 16
    s_and_b32 s17, s45, 0xffff0000
    v_pk_fma_f32 v[34:35], v[12:13], s[16:17], v[34:35] op_sel:[0,0,0] op_sel_hi:[0,1,1]
    v_pk_fma_f32 v[38:39], v[20:21], s[16:17], v[38:39] op_sel:[0,0,0] op_sel_hi:[0,1,1]
    s_lshl_b32 s18, s46, 16
    s_and_b32 s19, s46, 0xffff0000
    v_pk_fma_f32 v[32:33], v[12:13], s[18:19], v[32:33] op_sel:[1,0,0] op_sel_hi:[1,1,1]
    v_pk_fma_f32 v[36:37], v[20:21], s[18:19], v[36:37] op_sel:[1,0,0] op_sel_hi:[1,1,1]
    s_lshl_b32 s12, s47, 16
    s_and_b32 s13, s47, 0xffff0000
    v_pk_fma_f32 v[34:35], v[12:13], s[12:13], v[34:35] op_sel:[1,0,0] op_sel_hi:[1,1,1]
    v_pk_fma_f32 v[38:39], v[20:21], s[12:13], v[38:39] op_sel:[1,0,0] op_sel_hi:[1,1,1]
    s_lshl_b32 s14, s48, 16
    s_and_b32 s15, s48, 0xffff0000
    v_pk_fma_f32 v[32:33], v[14:15], s[14:15], v[32:33] op_sel:[0,0,0] op_sel_hi:[0,1,1]
    v_pk_fma_f32 v[36:37], v[22:23], s[14:15], v[36:37] op_sel:[0,0,0] op_sel_hi:[0,1,1]
    s_lshl_b32 s16, s49, 16
    s_and_b32 s17, s49, 0xffff0000
    v_pk_fma_f32 v[34:35], v[14:15], s[16:17], v[34:35] op_sel:[0,0,0] op_sel_hi:[0,1,1]
    v_pk_fma_f32 v[38:39], v[22:23], s[16:17], v[38:39] op_sel:[0,0,0] op_sel_hi:[0,1,1]
    s_lshl_b32 s18, s50, 16
    s_and_b32 s19, s50, 0xffff0000
    v_pk_fma_f32 v[32:33], v[14:15], s[18:19], v[32:33] op_sel:[1,0,0] op_sel_hi:[1,1,1]
    v_pk_fma_f32 v[36:37], v[22:23], s[18:19], v[36:37] op_sel:[1,0,0] op_sel_hi:[1,1,1]
    s_lshl_b32 s12, s51, 16
    s_and_b32 s13, s51, 0xffff0000
    v_pk_fma_f32 v[34:35], v[14:15], s[12:13], v[34:35] op_sel:[1,0,0] op_sel_hi:[1,1,1]
    v_pk_fma_f32 v[38:39], v[22:23], s[12:13], v[38:39] op_sel:[1,0,0] op_sel_hi:[1,1,1]
    v_cvt_pk_bf16_f32 v32, v32, v33
    v_cvt_pk_bf16_f32 v34, v34, v35
    v_cvt_pk_bf16_f32 v36, v36, v37
    v_cvt_pk_bf16_f32 v38, v38, v39
    v_and_b32 v33, 0xffff0000, v32
    v_lshlrev_b32 v32, 16, v32
    v_and_b32 v35, 0xffff0000, v34
    v_lshlrev_b32 v34, 16, v34
    v_and_b32 v37, 0xffff0000, v36
    v_lshlrev_b32 v36, 16, v36
    v_and_b32 v39, 0xffff0000, v38
    v_lshlrev_b32 v38, 16, v38
    s_waitcnt vmcnt(1)
    v_add_u32 v40, v40, v44
    v_add_u32 v48, v48, v52
    v_add_u32 v41, v41, v45
    v_add_u32 v49, v49, v53
    v_add_u32 v42, v42, v46
    v_add_u32 v50, v50, v54
    v_add_u32 v43, v43, v47
    v_add_u32 v51, v51, v55
    v_add_u32_sdwa v8, v40, v48 dst_sel:DWORD dst_unused:UNUSED_PAD src0_sel:WORD_0 src1_sel:WORD_0
    v_add_u32_sdwa v9, v40, v48 dst_sel:DWORD dst_unused:UNUSED_PAD src0_sel:WORD_1 src1_sel:WORD_1
    v_add_u32_sdwa v10, v41, v49 dst_sel:DWORD dst_unused:UNUSED_PAD src0_sel:WORD_0 src1_sel:WORD_0
    v_add_u32_sdwa v11, v41, v49 dst_sel:DWORD dst_unused:UNUSED_PAD src0_sel:WORD_1 src1_sel:WORD_1
    v_add_u32_sdwa v12, v42, v50 dst_sel:DWORD dst_unused:UNUSED_PAD src0_sel:WORD_0 src1_sel:WORD_0
    v_add_u32_sdwa v13, v42, v50 dst_sel:DWORD dst_unused:UNUSED_PAD src0_sel:WORD_1 src1_sel:WORD_1
    v_add_u32_sdwa v14, v43, v51 dst_sel:DWORD dst_unused:UNUSED_PAD src0_sel:WORD_0 src1_sel:WORD_0
    v_add_u32_sdwa v15, v43, v51 dst_sel:DWORD dst_unused:UNUSED_PAD src0_sel:WORD_1 src1_sel:WORD_1
    v_min3_u32 v5, v56, v57, v58
    v_bitop3_b32 v4, v56, v57, v58 bitop3:0xfe
    v_min_u32 v5, v5, v59
    v_or_b32 v4, v4, v59
    v_or_b32 v8, 0x4b000000, v8
    v_or_b32 v9, 0x4b000000, v9
    v_or_b32 v10, 0x4b000000, v10
    v_or_b32 v11, 0x4b000000, v11
    v_or_b32 v12, 0x4b000000, v12
    v_or_b32 v13, 0x4b000000, v13
    v_or_b32 v14, 0x4b000000, v14
    v_or_b32 v15, 0x4b000000, v15
    v_cmp_eq_u32 vcc, 0, v5
    v_add_f32 v8, 0xcb010000, v8
    v_add_f32 v9, 0xcb010000, v9
    v_add_f32 v10, 0xcb010000, v10
    v_add_f32 v11, 0xcb010000, v11
    v_add_f32 v12, 0xcb010000, v12
    v_add_f32 v13, 0xcb010000, v13
    v_add_f32 v14, 0xcb010000, v14
    v_add_f32 v15, 0xcb010000, v15
    v_mul_f32 v8, v4, v8
    v_mul_f32 v9, v4, v9
    v_mul_f32 v10, v4, v10
    v_mul_f32 v11, v4, v11
    v_mul_f32 v12, v4, v12
    v_mul_f32 v13, v4, v13
    v_mul_f32 v14, v4, v14
    v_mul_f32 v15, v4, v15
    s_cbranch_vccz p3_nof
    v_lshlrev_b32 v1, 4, v0
    v_mov_b32 v3, 0x70000000
    v_cmp_eq_u32 vcc, 0, v56
    s_mov_b32 s22, 517903360
    s_nop 0
    v_cndmask_b32 v5, v3, v1, vcc
    buffer_load_dwordx4 v[16:19], v5, s[28:31], s22 offen
    buffer_load_dwordx4 v[20:23], v5, s[28:31], s22 offen offset:16
    s_waitcnt vmcnt(0)
    v_add_f32 v8, v8, v16
    v_add_f32 v9, v9, v17
    v_add_f32 v10, v10, v18
    v_add_f32 v11, v11, v19
    v_add_f32 v12, v12, v20
    v_add_f32 v13, v13, v21
    v_add_f32 v14, v14, v22
    v_add_f32 v15, v15, v23
    v_cmp_eq_u32 vcc, 0, v57
    s_mov_b32 s22, 530715648
    s_nop 0
    v_cndmask_b32 v5, v3, v1, vcc
    buffer_load_dwordx4 v[16:19], v5, s[28:31], s22 offen
    buffer_load_dwordx4 v[20:23], v5, s[28:31], s22 offen offset:16
    s_waitcnt vmcnt(0)
    v_add_f32 v8, v8, v16
    v_add_f32 v9, v9, v17
    v_add_f32 v10, v10, v18
    v_add_f32 v11, v11, v19
    v_add_f32 v12, v12, v20
    v_add_f32 v13, v13, v21
    v_add_f32 v14, v14, v22
    v_add_f32 v15, v15, v23
    v_cmp_eq_u32 vcc, 0, v58
    s_mov_b32 s22, 543527936
    s_nop 0
    v_cndmask_b32 v5, v3, v1, vcc
    buffer_load_dwordx4 v[16:19], v5, s[28:31], s22 offen
    buffer_load_dwordx4 v[20:23], v5, s[28:31], s22 offen offset:16
    s_waitcnt vmcnt(0)
    v_add_f32 v8, v8, v16
    v_add_f32 v9, v9, v17
    v_add_f32 v10, v10, v18
    v_add_f32 v11, v11, v19
    v_add_f32 v12, v12, v20
    v_add_f32 v13, v13, v21
    v_add_f32 v14, v14, v22
    v_add_f32 v15, v15, v23
    v_cmp_eq_u32 vcc, 0, v59
    s_mov_b32 s22, 556340224
    s_nop 0
    v_cndmask_b32 v5, v3, v1, vcc
    buffer_load_dwordx4 v[16:19], v5, s[28:31], s22 offen
    buffer_load_dwordx4 v[20:23], v5, s[28:31], s22 offen offset:16
    s_waitcnt vmcnt(0)
    v_add_f32 v8, v8, v16
    v_add_f32 v9, v9, v17
    v_add_f32 v10, v10, v18
    v_add_f32 v11, v11, v19
    v_add_f32 v12, v12, v20
    v_add_f32 v13, v13, v21
    v_add_f32 v14, v14, v22
    v_add_f32 v15, v15, v23
p3_nof:
    s_lshl_b32 s14, s68, 16
    s_and_b32 s15, s68, 0xffff0000
    v_pk_mul_f32 v[16:17], v[8:9], s[14:15] op_sel:[0,0] op_sel_hi:[0,1]
    v_pk_mul_f32 v[20:21], v[12:13], s[14:15] op_sel:[0,0] op_sel_hi:[0,1]
    s_lshl_b32 s16, s69, 16
    s_and_b32 s17, s69, 0xffff0000
    v_pk_mul_f32 v[18:19], v[8:9], s[16:17] op_sel:[0,0] op_sel_hi:[0,1]
    v_pk_mul_f32 v[22:23], v[12:13], s[16:17] op_sel:[0,0] op_sel_hi:[0,1]
    s_lshl_b32 s18, s70, 16
    s_and_b32 s19, s70, 0xffff0000
    v_pk_fma_f32 v[16:17], v[8:9], s[18:19], v[16:17] op_sel:[1,0,0] op_sel_hi:[1,1,1]
    v_pk_fma_f32 v[20:21], v[12:13], s[18:19], v[20:21] op_sel:[1,0,0] op_sel_hi:[1,1,1]
    s_lshl_b32 s12, s71, 16
    s_and_b32 s13, s71, 0xffff0000
    v_pk_fma_f32 v[18:19], v[8:9], s[12:13], v[18:19] op_sel:[1,0,0] op_sel_hi:[1,1,1]
    v_pk_fma_f32 v[22:23], v[12:13], s[12:13], v[22:23] op_sel:[1,0,0] op_sel_hi:[1,1,1]
    s_lshl_b32 s14, s72, 16
    s_and_b32 s15, s72, 0xffff0000
    v_pk_fma_f32 v[16:17], v[10:11], s[14:15], v[16:17] op_sel:[0,0,0] op_sel_hi:[0,1,1]
    v_pk_fma_f32 v[20:21], v[14:15], s[14:15], v[20:21] op_sel:[0,0,0] op_sel_hi:[0,1,1]
    s_lshl_b32 s16, s73, 16
    s_and_b32 s17, s73, 0xffff0000
    v_pk_fma_f32 v[18:19], v[10:11], s[16:17], v[18:19] op_sel:[0,0,0] op_sel_hi:[0,1,1]
    v_pk_fma_f32 v[22:23], v[14:15], s[16:17], v[22:23] op_sel:[0,0,0] op_sel_hi:[0,1,1]
    s_lshl_b32 s18, s74, 16
    s_and_b32 s19, s74, 0xffff0000
    v_pk_fma_f32 v[16:17], v[10:11], s[18:19], v[16:17] op_sel:[1,0,0] op_sel_hi:[1,1,1]
    v_pk_fma_f32 v[20:21], v[14:15], s[18:19], v[20:21] op_sel:[1,0,0] op_sel_hi:[1,1,1]
    s_lshl_b32 s12, s75, 16
    s_and_b32 s13, s75, 0xffff0000
    v_pk_fma_f32 v[18:19], v[10:11], s[12:13], v[18:19] op_sel:[1,0,0] op_sel_hi:[1,1,1]
    v_pk_fma_f32 v[22:23], v[14:15], s[12:13], v[22:23] op_sel:[1,0,0] op_sel_hi:[1,1,1]
    v_mul_f32 v24, v24, v16
    v_mul_f32 v25, v25, v17
    v_mul_f32 v26, v26, v18
    v_mul_f32 v27, v27, v19
    v_mul_f32 v28, v28, v20
    v_mul_f32 v29, v29, v21
    v_mul_f32 v30, v30, v22
    v_mul_f32 v31, v31, v23
    v_cvt_pk_bf16_f32 v24, v24, v25
    v_cvt_pk_bf16_f32 v26, v26, v27
    v_cvt_pk_bf16_f32 v28, v28, v29
    v_cvt_pk_bf16_f32 v30, v30, v31
    v_and_b32 v25, 0xffff0000, v24
    v_lshlrev_b32 v24, 16, v24
    v_and_b32 v27, 0xffff0000, v26
    v_lshlrev_b32 v26, 16, v26
    v_and_b32 v29, 0xffff0000, v28
    v_lshlrev_b32 v28, 16, v28
    v_and_b32 v31, 0xffff0000, v30
    v_lshlrev_b32 v30, 16, v30
    s_lshl_b32 s14, s76, 16
    s_and_b32 s15, s76, 0xffff0000
    v_pk_mul_f32 v[16:17], v[24:25], s[14:15] op_sel:[0,0] op_sel_hi:[0,1]
    v_pk_mul_f32 v[20:21], v[28:29], s[14:15] op_sel:[0,0] op_sel_hi:[0,1]
    s_lshl_b32 s16, s77, 16
    s_and_b32 s17, s77, 0xffff0000
    v_pk_mul_f32 v[18:19], v[24:25], s[16:17] op_sel:[0,0] op_sel_hi:[0,1]
    v_pk_mul_f32 v[22:23], v[28:29], s[16:17] op_sel:[0,0] op_sel_hi:[0,1]
    s_lshl_b32 s18, s78, 16
    s_and_b32 s19, s78, 0xffff0000
    v_pk_fma_f32 v[16:17], v[24:25], s[18:19], v[16:17] op_sel:[1,0,0] op_sel_hi:[1,1,1]
    v_pk_fma_f32 v[20:21], v[28:29], s[18:19], v[20:21] op_sel:[1,0,0] op_sel_hi:[1,1,1]
    s_lshl_b32 s12, s79, 16
    s_and_b32 s13, s79, 0xffff0000
    v_pk_fma_f32 v[18:19], v[24:25], s[12:13], v[18:19] op_sel:[1,0,0] op_sel_hi:[1,1,1]
    v_pk_fma_f32 v[22:23], v[28:29], s[12:13], v[22:23] op_sel:[1,0,0] op_sel_hi:[1,1,1]
    s_lshl_b32 s14, s80, 16
    s_and_b32 s15, s80, 0xffff0000
    v_pk_fma_f32 v[16:17], v[26:27], s[14:15], v[16:17] op_sel:[0,0,0] op_sel_hi:[0,1,1]
    v_pk_fma_f32 v[20:21], v[30:31], s[14:15], v[20:21] op_sel:[0,0,0] op_sel_hi:[0,1,1]
    s_lshl_b32 s16, s81, 16
    s_and_b32 s17, s81, 0xffff0000
    v_pk_fma_f32 v[18:19], v[26:27], s[16:17], v[18:19] op_sel:[0,0,0] op_sel_hi:[0,1,1]
    v_pk_fma_f32 v[22:23], v[30:31], s[16:17], v[22:23] op_sel:[0,0,0] op_sel_hi:[0,1,1]
    s_lshl_b32 s18, s82, 16
    s_and_b32 s19, s82, 0xffff0000
    v_pk_fma_f32 v[16:17], v[26:27], s[18:19], v[16:17] op_sel:[1,0,0] op_sel_hi:[1,1,1]
    v_pk_fma_f32 v[20:21], v[30:31], s[18:19], v[20:21] op_sel:[1,0,0] op_sel_hi:[1,1,1]
    s_lshl_b32 s12, s83, 16
    s_and_b32 s13, s83, 0xffff0000
    v_pk_fma_f32 v[18:19], v[26:27], s[12:13], v[18:19] op_sel:[1,0,0] op_sel_hi:[1,1,1]
    v_pk_fma_f32 v[22:23], v[30:31], s[12:13], v[22:23] op_sel:[1,0,0] op_sel_hi:[1,1,1]
    v_cvt_pk_bf16_f32 v16, v16, v17
    v_cvt_pk_bf16_f32 v18, v18, v19
    v_cvt_pk_bf16_f32 v20, v20, v21
    v_cvt_pk_bf16_f32 v22, v22, v23
    v_and_b32 v17, 0xffff0000, v16
    v_lshlrev_b32 v16, 16, v16
    v_and_b32 v19, 0xffff0000, v18
    v_lshlrev_b32 v18, 16, v18
    v_and_b32 v21, 0xffff0000, v20
    v_lshlrev_b32 v20, 16, v20
    v_and_b32 v23, 0xffff0000, v22
    v_lshlrev_b32 v22, 16, v22
    v_mul_f32 v16, v16, v32
    v_mul_f32 v17, v17, v33
    v_mul_f32 v18, v18, v34
    v_mul_f32 v19, v19, v35
    v_mul_f32 v20, v20, v36
    v_mul_f32 v21, v21, v37
    v_mul_f32 v22, v22, v38
    v_mul_f32 v23, v23, v39
    v_cvt_pk_bf16_f32 v16, v16, v17
    v_cvt_pk_bf16_f32 v18, v18, v19
    v_cvt_pk_bf16_f32 v20, v20, v21
    v_cvt_pk_bf16_f32 v22, v22, v23
    v_and_b32 v17, 0xffff0000, v16
    v_lshlrev_b32 v16, 16, v16
    v_and_b32 v19, 0xffff0000, v18
    v_lshlrev_b32 v18, 16, v18
    v_and_b32 v21, 0xffff0000, v20
    v_lshlrev_b32 v20, 16, v20
    v_and_b32 v23, 0xffff0000, v22
    v_lshlrev_b32 v22, 16, v22
    s_waitcnt vmcnt(0)
    v_lshlrev_b32 v8, 16, v60
    v_and_b32 v9, 0xffff0000, v60
    v_lshlrev_b32 v10, 16, v61
    v_and_b32 v11, 0xffff0000, v61
    v_lshlrev_b32 v12, 16, v62
    v_and_b32 v13, 0xffff0000, v62
    v_lshlrev_b32 v14, 16, v63
    v_and_b32 v15, 0xffff0000, v63
    v_add_f32 v8, v8, v16
    v_add_f32 v9, v9, v17
    v_add_f32 v10, v10, v18
    v_add_f32 v11, v11, v19
    v_add_f32 v12, v12, v20
    v_add_f32 v13, v13, v21
    v_add_f32 v14, v14, v22
    v_add_f32 v15, v15, v23
    v_cvt_pk_bf16_f32 v4, v8, v9
    v_cvt_pk_bf16_f32 v5, v10, v11
    v_cvt_pk_bf16_f32 v6, v12, v13
    v_cvt_pk_bf16_f32 v7, v14, v15
    buffer_store_dwordx4 v[4:7], v2, s[24:27], 0 offen nt
p3_end:
    s_endpgm
.section .rodata,"a"
.p2align 6
.amdhsa_kernel p1_kernel
  .amdhsa_next_free_vgpr 128
  .amdhsa_next_free_sgpr 72
  .amdhsa_accum_offset 128
  .amdhsa_group_segment_fixed_size 0
  .amdhsa_kernarg_size 112
  .amdhsa_user_sgpr_count 2
  .amdhsa_user_sgpr_kernarg_segment_ptr 1
  .amdhsa_system_sgpr_workgroup_id_x 1
  .amdhsa_float_denorm_mode_32 3
.end_amdhsa_kernel
.p2align 6
.amdhsa_kernel p2_kernel
  .amdhsa_next_free_vgpr 128
  .amdhsa_next_free_sgpr 72
  .amdhsa_accum_offset 128
  .amdhsa_group_segment_fixed_size 0
  .amdhsa_kernarg_size 112
  .amdhsa_user_sgpr_count 2
  .amdhsa_user_sgpr_kernarg_segment_ptr 1
  .amdhsa_system_sgpr_workgroup_id_x 1
  .amdhsa_float_denorm_mode_32 3
.end_amdhsa_kernel
.p2align 6
.amdhsa_kernel p3_kernel
  .amdhsa_next_free_vgpr 64
  .amdhsa_next_free_sgpr 84
  .amdhsa_accum_offset 64
  .amdhsa_group_segment_fixed_size 0
  .amdhsa_kernarg_size 112
  .amdhsa_user_sgpr_count 2
  .amdhsa_user_sgpr_kernarg_segment_ptr 1
  .amdhsa_system_sgpr_workgroup_id_x 1
  .amdhsa_float_denorm_mode_32 3
.end_amdhsa_kernel
```

```asm
; @launch kernel=p1_kernel grid=(256,1,1) block=(1024,1,1) lds=163072
; @launch kernel=p2_kernel grid=(256,1,1) block=(1024,1,1) lds=154368
; @launch kernel=p3_kernel grid=(1563,1,1) block=(256,1,1) lds=0
.amdgcn_target "amdgcn-amd-amdhsa--gfx950"
.text
.globl p1_kernel
.p2align 8
.type p1_kernel,@function
p1_kernel:
    s_cmp_ge_u32 s2, 256
    s_cbranch_scc1 p1_end
    s_load_dwordx2 s[52:53], s[0:1], 0
    s_load_dwordx4 s[56:59], s[0:1], 8
    s_load_dwordx2 s[54:55], s[0:1], 32
    s_load_dwordx2 s[60:61], s[0:1], 48
    s_load_dwordx2 s[48:49], s[0:1], 104
    s_load_dwordx2 s[62:63], s[0:1], 96
    v_lshlrev_b32 v1, 4, v0
    v_lshlrev_b32 v2, 3, v0
    v_mov_b32 v3, 1
    v_lshrrev_b32 v117, 6, v0
    s_nop 0
    v_readfirstlane_b32 s28, v117
    s_waitcnt lgkmcnt(0)
    s_load_dword s45, s[60:61], 0
    s_mov_b32 s24, s52
    s_and_b32 s25, s53, 0xffff
    s_mov_b32 s26, 6400000
    s_mov_b32 s27, 0x20000
    s_mov_b32 s4, s56
    s_and_b32 s5, s57, 0xffff
    s_mov_b32 s6, 204800000
    s_mov_b32 s7, 0x20000
    s_mov_b32 s8, s58
    s_and_b32 s9, s59, 0xffff
    s_mov_b32 s10, 204800000
    s_mov_b32 s11, 0x20000
    s_mov_b32 s12, s54
    s_and_b32 s13, s55, 0xffff
    s_mov_b32 s14, 102400000
    s_mov_b32 s15, 0x20000
    s_mov_b32 s16, s48
    s_and_b32 s17, s49, 0xffff
    s_mov_b32 s18, 819200000
    s_mov_b32 s19, 0x20000
    s_mov_b32 s20, s48
    s_and_b32 s21, s49, 0xffff
    s_mov_b32 s22, 0
    s_mov_b32 s23, 0x20000
    s_mov_b32 s40, s62
    s_and_b32 s41, s63, 0xffff
    s_mov_b32 s42, 256
    s_mov_b32 s43, 0x20000
    s_mov_b32 s36, 643827
    s_mov_b32 s37, 214609
    s_mov_b32 s38, 343268
    s_mov_b32 s39, -6671
    s_mov_b32 s44, -12512
    s_mov_b32 s34, 1
    s_waitcnt lgkmcnt(0)
    s_lshl_b32 s45, s45, 16
    s_mov_b32 s29, s2
    s_mul_i32 s46, s29, 1
    s_min_u32 s47, s29, 1499
    s_add_u32 s46, s46, s47
    s_min_u32 s47, s29, 1462
    s_add_u32 s46, s46, s47
    s_min_u32 s47, s29, 1426
    s_add_u32 s46, s46, s47
    s_min_u32 s47, s29, 1389
    s_add_u32 s46, s46, s47
    s_min_u32 s47, s29, 1352
    s_add_u32 s46, s46, s47
    s_min_u32 s47, s29, 1315
    s_add_u32 s46, s46, s47
    s_min_u32 s47, s29, 1279
    s_add_u32 s46, s46, s47
    s_min_u32 s47, s29, 1242
    s_add_u32 s46, s46, s47
    s_lshl_b32 s30, s46, 14
    s_lshl_b32 s31, s46, 13
    s_add_u32 s32, s30, 0
    buffer_load_dwordx4 v[94:97], v1, s[4:7], s32 offen nt
    buffer_load_dwordx4 v[102:105], v1, s[8:11], s32 offen nt
    s_add_u32 s32, s31, 0
    buffer_load_dwordx2 v[76:77], v2, s[12:15], s32 offen nt
    s_add_u32 s32, s30, 16384
    buffer_load_dwordx4 v[98:101], v1, s[4:7], s32 offen nt
    buffer_load_dwordx4 v[106:109], v1, s[8:11], s32 offen nt
    s_add_u32 s32, s31, 8192
    buffer_load_dwordx2 v[78:79], v2, s[12:15], s32 offen nt
    s_add_u32 s32, s30, 32768
    buffer_load_dwordx4 v[12:15], v1, s[4:7], s32 offen nt
    buffer_load_dwordx4 v[48:51], v1, s[8:11], s32 offen nt
    s_add_u32 s32, s31, 16384
    buffer_load_dwordx2 v[80:81], v2, s[12:15], s32 offen nt
    s_add_u32 s32, s31, 24576
    buffer_load_dwordx2 v[82:83], v2, s[12:15], s32 offen nt
    s_add_u32 s32, s31, 32768
    buffer_load_dwordx2 v[84:85], v2, s[12:15], s32 offen nt
    s_add_u32 s32, s31, 40960
    buffer_load_dwordx2 v[86:87], v2, s[12:15], s32 offen nt
    s_add_u32 s32, s31, 49152
    buffer_load_dwordx2 v[88:89], v2, s[12:15], s32 offen nt
    s_add_u32 s32, s31, 57344
    buffer_load_dwordx2 v[90:91], v2, s[12:15], s32 offen nt
    s_add_u32 s32, s31, 65536
    buffer_load_dwordx2 v[92:93], v2, s[12:15], s32 offen nt
    v_mov_b32 v73, 0x40000000
    v_mov_b32 v122, 0
    v_mov_b32 v123, 0
    v_mov_b32 v124, 0
    v_mov_b32 v125, 0
    ds_write_b128 v1, v[122:125] offset:0
    s_waitcnt lgkmcnt(0)
    s_barrier
p1_tile:
    v_mov_b32 v122, 0
    v_mov_b32 v123, 0
    v_mov_b32 v124, 0
    v_mov_b32 v125, 0
    ds_write_b128 v1, v[122:125] offset:10496
    ds_write_b128 v1, v[122:125] offset:26880
    ds_write_b128 v1, v[122:125] offset:43264
    s_cmp_lg_u32 s28, 15
    s_cbranch_scc1 p1_tk0
    v_mov_b32 v127, 1
    s_mov_b64 exec, 1
    buffer_atomic_add v127, off, s[40:43], 0 offset:128 sc0 sc1
    s_mov_b64 exec, -1
p1_tk0:
    v_mov_b32 v123, s45
    v_mov_b32 v124, 0x007f007f
    v_mov_b32 v125, 0xe000
    v_mov_b32 v126, 0xffff0000
    s_cmp_lt_u32 s29, 1426
    s_cselect_b32 s6, 204800000, 0
    s_cselect_b32 s10, 204800000, 0
    s_add_u32 s32, s30, 49152
    buffer_load_dwordx4 v[16:19], v1, s[4:7], s32 offen nt
    buffer_load_dwordx4 v[52:55], v1, s[8:11], s32 offen nt
    s_waitcnt vmcnt(14)
    v_lshlrev_b32 v117, 16, v76
    v_and_b32 v118, v126, v76
    v_mul_f32 v117, v123, v117
    v_mul_f32 v118, v123, v118
    v_cvt_pk_bf16_f32 v117, v117, v118
    v_and_b32 v118, v126, v117
    v_lshlrev_b32 v117, 16, v117
    v_mul_f32 v117, 0.15915494, v117
    v_mul_f32 v118, 0.15915494, v118
    v_fract_f32 v117, v117
    v_fract_f32 v118, v118
    v_cos_f32 v117, v117
    v_cos_f32 v118, v118
    v_mul_hi_u32_u24 v122, s38, v102
    v_mul_hi_u32_u24 v121, s37, v94
    v_mul_hi_u32_u24 v120, s36, v94
    v_mad_i32_i24 v110, v122, s44, v102
    v_mad_u32_u24 v40, v122, 40, v121
    v_mad_i32_i24 v4, v120, s39, v94
    v_lshlrev_b16 v40, 2, v40
    v_mad_i32_i24 v120, v121, -3, v120
    ds_add_u32 v40, v3 offset:0
    v_lshl_or_b32 v4, v110, 16, v4
    v_lshl_or_b32 v4, v120, 30, v4
    v_mul_f32 v117, 0x03800000, v117
    v_mul_f32 v118, 0x03800000, v118
    v_cvt_pk_bf16_f32 v117, v117, v118
    v_mul_hi_u32_u24 v122, s38, v103
    v_mul_hi_u32_u24 v121, s37, v95
    v_mul_hi_u32_u24 v120, s36, v95
    v_mad_i32_i24 v110, v122, s44, v103
    v_mad_u32_u24 v41, v122, 40, v121
    v_mad_i32_i24 v5, v120, s39, v95
    v_lshlrev_b16 v41, 2, v41
    v_mad_i32_i24 v120, v121, -3, v120
    ds_add_u32 v41, v3 offset:0
    v_lshl_or_b32 v5, v110, 16, v5
    v_lshl_or_b32 v5, v120, 30, v5
    v_lshrrev_b32 v118, 3, v117
    v_lshrrev_b32 v119, 8, v117
    v_lshlrev_b16 v117, 13, v117
    v_bitop3_b32 v119, v118, v119, v124 bitop3:0x1b
    v_bitop3_b32 v4, v117, v125, v4 bitop3:0xae
    v_lshl_or_b32 v40, v119, 16, v40
    v_bitop3_b32 v5, v118, v125, v5 bitop3:0xae
    v_bitop3_b32 v41, v119, v126, v41 bitop3:0xea
    v_lshlrev_b32 v117, 16, v77
    v_and_b32 v118, v126, v77
    v_mul_f32 v117, v123, v117
    v_mul_f32 v118, v123, v118
    v_cvt_pk_bf16_f32 v117, v117, v118
    v_and_b32 v118, v126, v117
    v_lshlrev_b32 v117, 16, v117
    v_mul_f32 v117, 0.15915494, v117
    v_mul_f32 v118, 0.15915494, v118
    v_fract_f32 v117, v117
    v_fract_f32 v118, v118
    v_cos_f32 v117, v117
    v_cos_f32 v118, v118
    v_mul_hi_u32_u24 v122, s38, v104
    v_mul_hi_u32_u24 v121, s37, v96
    v_mul_hi_u32_u24 v120, s36, v96
    v_mad_i32_i24 v110, v122, s44, v104
    v_mad_u32_u24 v42, v122, 40, v121
    v_mad_i32_i24 v6, v120, s39, v96
    v_lshlrev_b16 v42, 2, v42
    v_mad_i32_i24 v120, v121, -3, v120
    ds_add_u32 v42, v3 offset:0
    v_lshl_or_b32 v6, v110, 16, v6
    v_lshl_or_b32 v6, v120, 30, v6
    v_mul_f32 v117, 0x03800000, v117
    v_mul_f32 v118, 0x03800000, v118
    v_cvt_pk_bf16_f32 v117, v117, v118
    v_mul_hi_u32_u24 v122, s38, v105
    v_mul_hi_u32_u24 v121, s37, v97
    v_mul_hi_u32_u24 v120, s36, v97
    v_mad_i32_i24 v110, v122, s44, v105
    v_mad_u32_u24 v43, v122, 40, v121
    v_mad_i32_i24 v7, v120, s39, v97
    v_lshlrev_b16 v43, 2, v43
    v_mad_i32_i24 v120, v121, -3, v120
    ds_add_u32 v43, v3 offset:0
    v_lshl_or_b32 v7, v110, 16, v7
    v_lshl_or_b32 v7, v120, 30, v7
    v_lshrrev_b32 v118, 3, v117
    v_lshrrev_b32 v119, 8, v117
    v_lshlrev_b16 v117, 13, v117
    v_bitop3_b32 v119, v118, v119, v124 bitop3:0x1b
    v_bitop3_b32 v6, v117, v125, v6 bitop3:0xae
    v_lshl_or_b32 v42, v119, 16, v42
    v_bitop3_b32 v7, v118, v125, v7 bitop3:0xae
    v_bitop3_b32 v43, v119, v126, v43 bitop3:0xea
    s_cmp_lt_u32 s29, 1389
    s_cselect_b32 s6, 204800000, 0
    s_cselect_b32 s10, 204800000, 0
    s_add_u32 s32, s30, 65536
    buffer_load_dwordx4 v[20:23], v1, s[4:7], s32 offen nt
    buffer_load_dwordx4 v[56:59], v1, s[8:11], s32 offen nt
    s_cmp_ge_u32 s29, 1499
    s_cbranch_scc1 p1_k2
    s_cmp_lg_u32 s34, 0
    s_cbranch_scc1 p1_w3
    s_waitcnt vmcnt(10)
p1_w3:
    s_waitcnt vmcnt(13)
    v_lshlrev_b32 v117, 16, v78
    v_and_b32 v118, v126, v78
    v_mul_f32 v117, v123, v117
    v_mul_f32 v118, v123, v118
    v_cvt_pk_bf16_f32 v117, v117, v118
    v_and_b32 v118, v126, v117
    v_lshlrev_b32 v117, 16, v117
    v_mul_f32 v117, 0.15915494, v117
    v_mul_f32 v118, 0.15915494, v118
    v_fract_f32 v117, v117
    v_fract_f32 v118, v118
    v_cos_f32 v117, v117
    v_cos_f32 v118, v118
    v_mul_hi_u32_u24 v122, s38, v106
    v_mul_hi_u32_u24 v121, s37, v98
    v_mul_hi_u32_u24 v120, s36, v98
    v_mad_i32_i24 v110, v122, s44, v106
    v_mad_u32_u24 v44, v122, 40, v121
    v_mad_i32_i24 v8, v120, s39, v98
    v_lshlrev_b16 v44, 2, v44
    v_mad_i32_i24 v120, v121, -3, v120
    ds_add_u32 v44, v3 offset:0
    v_lshl_or_b32 v8, v110, 16, v8
    v_lshl_or_b32 v8, v120, 30, v8
    v_mul_f32 v117, 0x03800000, v117
    v_mul_f32 v118, 0x03800000, v118
    v_cvt_pk_bf16_f32 v117, v117, v118
    v_mul_hi_u32_u24 v122, s38, v107
    v_mul_hi_u32_u24 v121, s37, v99
    v_mul_hi_u32_u24 v120, s36, v99
    v_mad_i32_i24 v110, v122, s44, v107
    v_mad_u32_u24 v45, v122, 40, v121
    v_mad_i32_i24 v9, v120, s39, v99
    v_lshlrev_b16 v45, 2, v45
    v_mad_i32_i24 v120, v121, -3, v120
    ds_add_u32 v45, v3 offset:0
    v_lshl_or_b32 v9, v110, 16, v9
    v_lshl_or_b32 v9, v120, 30, v9
    v_lshrrev_b32 v118, 3, v117
    v_lshrrev_b32 v119, 8, v117
    v_lshlrev_b16 v117, 13, v117
    v_bitop3_b32 v119, v118, v119, v124 bitop3:0x1b
    v_bitop3_b32 v8, v117, v125, v8 bitop3:0xae
    v_lshl_or_b32 v44, v119, 16, v44
    v_bitop3_b32 v9, v118, v125, v9 bitop3:0xae
    v_bitop3_b32 v45, v119, v126, v45 bitop3:0xea
    v_lshlrev_b32 v117, 16, v79
    v_and_b32 v118, v126, v79
    v_mul_f32 v117, v123, v117
    v_mul_f32 v118, v123, v118
    v_cvt_pk_bf16_f32 v117, v117, v118
    v_and_b32 v118, v126, v117
    v_lshlrev_b32 v117, 16, v117
    v_mul_f32 v117, 0.15915494, v117
    v_mul_f32 v118, 0.15915494, v118
    v_fract_f32 v117, v117
    v_fract_f32 v118, v118
    v_cos_f32 v117, v117
    v_cos_f32 v118, v118
    v_mul_hi_u32_u24 v122, s38, v108
    v_mul_hi_u32_u24 v121, s37, v100
    v_mul_hi_u32_u24 v120, s36, v100
    v_mad_i32_i24 v110, v122, s44, v108
    v_mad_u32_u24 v46, v122, 40, v121
    v_mad_i32_i24 v10, v120, s39, v100
    v_lshlrev_b16 v46, 2, v46
    v_mad_i32_i24 v120, v121, -3, v120
    ds_add_u32 v46, v3 offset:0
    v_lshl_or_b32 v10, v110, 16, v10
    v_lshl_or_b32 v10, v120, 30, v10
    v_mul_f32 v117, 0x03800000, v117
    v_mul_f32 v118, 0x03800000, v118
    v_cvt_pk_bf16_f32 v117, v117, v118
    v_mul_hi_u32_u24 v122, s38, v109
    v_mul_hi_u32_u24 v121, s37, v101
    v_mul_hi_u32_u24 v120, s36, v101
    v_mad_i32_i24 v110, v122, s44, v109
    v_mad_u32_u24 v47, v122, 40, v121
    v_mad_i32_i24 v11, v120, s39, v101
    v_lshlrev_b16 v47, 2, v47
    v_mad_i32_i24 v120, v121, -3, v120
    ds_add_u32 v47, v3 offset:0
    v_lshl_or_b32 v11, v110, 16, v11
    v_lshl_or_b32 v11, v120, 30, v11
    v_lshrrev_b32 v118, 3, v117
    v_lshrrev_b32 v119, 8, v117
    v_lshlrev_b16 v117, 13, v117
    v_bitop3_b32 v119, v118, v119, v124 bitop3:0x1b
    v_bitop3_b32 v10, v117, v125, v10 bitop3:0xae
    v_lshl_or_b32 v46, v119, 16, v46
    v_bitop3_b32 v11, v118, v125, v11 bitop3:0xae
    v_bitop3_b32 v47, v119, v126, v47 bitop3:0xea
p1_k2:
    s_cmp_lt_u32 s29, 1352
    s_cselect_b32 s6, 204800000, 0
    s_cselect_b32 s10, 204800000, 0
    s_add_u32 s32, s30, 81920
    buffer_load_dwordx4 v[24:27], v1, s[4:7], s32 offen nt
    buffer_load_dwordx4 v[60:63], v1, s[8:11], s32 offen nt
    s_cmp_ge_u32 s29, 1462
    s_cbranch_scc1 p1_k4
    s_cmp_lg_u32 s34, 0
    s_cbranch_scc1 p1_w5
    s_waitcnt vmcnt(6)
p1_w5:
    s_waitcnt vmcnt(11)
    v_lshlrev_b32 v117, 16, v80
    v_and_b32 v118, v126, v80
    v_mul_f32 v117, v123, v117
    v_mul_f32 v118, v123, v118
    v_cvt_pk_bf16_f32 v117, v117, v118
    v_and_b32 v118, v126, v117
    v_lshlrev_b32 v117, 16, v117
    v_mul_f32 v117, 0.15915494, v117
    v_mul_f32 v118, 0.15915494, v118
    v_fract_f32 v117, v117
    v_fract_f32 v118, v118
    v_cos_f32 v117, v117
    v_cos_f32 v118, v118
    v_mul_hi_u32_u24 v122, s38, v48
    v_mul_hi_u32_u24 v121, s37, v12
    v_mul_hi_u32_u24 v120, s36, v12
    v_mad_i32_i24 v110, v122, s44, v48
    v_mad_u32_u24 v48, v122, 40, v121
    v_mad_i32_i24 v12, v120, s39, v12
    v_lshlrev_b16 v48, 2, v48
    v_mad_i32_i24 v120, v121, -3, v120
    ds_add_u32 v48, v3 offset:0
    v_lshl_or_b32 v12, v110, 16, v12
    v_lshl_or_b32 v12, v120, 30, v12
    v_mul_f32 v117, 0x03800000, v117
    v_mul_f32 v118, 0x03800000, v118
    v_cvt_pk_bf16_f32 v117, v117, v118
    v_mul_hi_u32_u24 v122, s38, v49
    v_mul_hi_u32_u24 v121, s37, v13
    v_mul_hi_u32_u24 v120, s36, v13
    v_mad_i32_i24 v110, v122, s44, v49
    v_mad_u32_u24 v49, v122, 40, v121
    v_mad_i32_i24 v13, v120, s39, v13
    v_lshlrev_b16 v49, 2, v49
    v_mad_i32_i24 v120, v121, -3, v120
    ds_add_u32 v49, v3 offset:0
    v_lshl_or_b32 v13, v110, 16, v13
    v_lshl_or_b32 v13, v120, 30, v13
    v_lshrrev_b32 v118, 3, v117
    v_lshrrev_b32 v119, 8, v117
    v_lshlrev_b16 v117, 13, v117
    v_bitop3_b32 v119, v118, v119, v124 bitop3:0x1b
    v_bitop3_b32 v12, v117, v125, v12 bitop3:0xae
    v_lshl_or_b32 v48, v119, 16, v48
    v_bitop3_b32 v13, v118, v125, v13 bitop3:0xae
    v_bitop3_b32 v49, v119, v126, v49 bitop3:0xea
    v_lshlrev_b32 v117, 16, v81
    v_and_b32 v118, v126, v81
    v_mul_f32 v117, v123, v117
    v_mul_f32 v118, v123, v118
    v_cvt_pk_bf16_f32 v117, v117, v118
    v_and_b32 v118, v126, v117
    v_lshlrev_b32 v117, 16, v117
    v_mul_f32 v117, 0.15915494, v117
    v_mul_f32 v118, 0.15915494, v118
    v_fract_f32 v117, v117
    v_fract_f32 v118, v118
    v_cos_f32 v117, v117
    v_cos_f32 v118, v118
    v_mul_hi_u32_u24 v122, s38, v50
    v_mul_hi_u32_u24 v121, s37, v14
    v_mul_hi_u32_u24 v120, s36, v14
    v_mad_i32_i24 v110, v122, s44, v50
    v_mad_u32_u24 v50, v122, 40, v121
    v_mad_i32_i24 v14, v120, s39, v14
    v_lshlrev_b16 v50, 2, v50
    v_mad_i32_i24 v120, v121, -3, v120
    ds_add_u32 v50, v3 offset:0
    v_lshl_or_b32 v14, v110, 16, v14
    v_lshl_or_b32 v14, v120, 30, v14
    v_mul_f32 v117, 0x03800000, v117
    v_mul_f32 v118, 0x03800000, v118
    v_cvt_pk_bf16_f32 v117, v117, v118
    v_mul_hi_u32_u24 v122, s38, v51
    v_mul_hi_u32_u24 v121, s37, v15
    v_mul_hi_u32_u24 v120, s36, v15
    v_mad_i32_i24 v110, v122, s44, v51
    v_mad_u32_u24 v51, v122, 40, v121
    v_mad_i32_i24 v15, v120, s39, v15
    v_lshlrev_b16 v51, 2, v51
    v_mad_i32_i24 v120, v121, -3, v120
    ds_add_u32 v51, v3 offset:0
    v_lshl_or_b32 v15, v110, 16, v15
    v_lshl_or_b32 v15, v120, 30, v15
    v_lshrrev_b32 v118, 3, v117
    v_lshrrev_b32 v119, 8, v117
    v_lshlrev_b16 v117, 13, v117
    v_bitop3_b32 v119, v118, v119, v124 bitop3:0x1b
    v_bitop3_b32 v14, v117, v125, v14 bitop3:0xae
    v_lshl_or_b32 v50, v119, 16, v50
    v_bitop3_b32 v15, v118, v125, v15 bitop3:0xae
    v_bitop3_b32 v51, v119, v126, v51 bitop3:0xea
p1_k4:
    s_cmp_lt_u32 s29, 1315
    s_cselect_b32 s6, 204800000, 0
    s_cselect_b32 s10, 204800000, 0
    s_add_u32 s32, s30, 98304
    buffer_load_dwordx4 v[28:31], v1, s[4:7], s32 offen nt
    buffer_load_dwordx4 v[64:67], v1, s[8:11], s32 offen nt
    s_cmp_ge_u32 s29, 1426
    s_cbranch_scc1 p1_k6
    s_waitcnt vmcnt(6)
    v_lshlrev_b32 v117, 16, v82
    v_and_b32 v118, v126, v82
    v_mul_f32 v117, v123, v117
    v_mul_f32 v118, v123, v118
    v_cvt_pk_bf16_f32 v117, v117, v118
    v_and_b32 v118, v126, v117
    v_lshlrev_b32 v117, 16, v117
    v_mul_f32 v117, 0.15915494, v117
    v_mul_f32 v118, 0.15915494, v118
    v_fract_f32 v117, v117
    v_fract_f32 v118, v118
    v_cos_f32 v117, v117
    v_cos_f32 v118, v118
    v_mul_hi_u32_u24 v122, s38, v52
    v_mul_hi_u32_u24 v121, s37, v16
    v_mul_hi_u32_u24 v120, s36, v16
    v_mad_i32_i24 v110, v122, s44, v52
    v_mad_u32_u24 v52, v122, 40, v121
    v_mad_i32_i24 v16, v120, s39, v16
    v_lshlrev_b16 v52, 2, v52
    v_mad_i32_i24 v120, v121, -3, v120
    ds_add_u32 v52, v3 offset:0
    v_lshl_or_b32 v16, v110, 16, v16
    v_lshl_or_b32 v16, v120, 30, v16
    v_mul_f32 v117, 0x03800000, v117
    v_mul_f32 v118, 0x03800000, v118
    v_cvt_pk_bf16_f32 v117, v117, v118
    v_mul_hi_u32_u24 v122, s38, v53
    v_mul_hi_u32_u24 v121, s37, v17
    v_mul_hi_u32_u24 v120, s36, v17
    v_mad_i32_i24 v110, v122, s44, v53
    v_mad_u32_u24 v53, v122, 40, v121
    v_mad_i32_i24 v17, v120, s39, v17
    v_lshlrev_b16 v53, 2, v53
    v_mad_i32_i24 v120, v121, -3, v120
    ds_add_u32 v53, v3 offset:0
    v_lshl_or_b32 v17, v110, 16, v17
    v_lshl_or_b32 v17, v120, 30, v17
    v_lshrrev_b32 v118, 3, v117
    v_lshrrev_b32 v119, 8, v117
    v_lshlrev_b16 v117, 13, v117
    v_bitop3_b32 v119, v118, v119, v124 bitop3:0x1b
    v_bitop3_b32 v16, v117, v125, v16 bitop3:0xae
    v_lshl_or_b32 v52, v119, 16, v52
    v_bitop3_b32 v17, v118, v125, v17 bitop3:0xae
    v_bitop3_b32 v53, v119, v126, v53 bitop3:0xea
    v_lshlrev_b32 v117, 16, v83
    v_and_b32 v118, v126, v83
    v_mul_f32 v117, v123, v117
    v_mul_f32 v118, v123, v118
    v_cvt_pk_bf16_f32 v117, v117, v118
    v_and_b32 v118, v126, v117
    v_lshlrev_b32 v117, 16, v117
    v_mul_f32 v117, 0.15915494, v117
    v_mul_f32 v118, 0.15915494, v118
    v_fract_f32 v117, v117
    v_fract_f32 v118, v118
    v_cos_f32 v117, v117
    v_cos_f32 v118, v118
    v_mul_hi_u32_u24 v122, s38, v54
    v_mul_hi_u32_u24 v121, s37, v18
    v_mul_hi_u32_u24 v120, s36, v18
    v_mad_i32_i24 v110, v122, s44, v54
    v_mad_u32_u24 v54, v122, 40, v121
    v_mad_i32_i24 v18, v120, s39, v18
    v_lshlrev_b16 v54, 2, v54
    v_mad_i32_i24 v120, v121, -3, v120
    ds_add_u32 v54, v3 offset:0
    v_lshl_or_b32 v18, v110, 16, v18
    v_lshl_or_b32 v18, v120, 30, v18
    v_mul_f32 v117, 0x03800000, v117
    v_mul_f32 v118, 0x03800000, v118
    v_cvt_pk_bf16_f32 v117, v117, v118
    v_mul_hi_u32_u24 v122, s38, v55
    v_mul_hi_u32_u24 v121, s37, v19
    v_mul_hi_u32_u24 v120, s36, v19
    v_mad_i32_i24 v110, v122, s44, v55
    v_mad_u32_u24 v55, v122, 40, v121
    v_mad_i32_i24 v19, v120, s39, v19
    v_lshlrev_b16 v55, 2, v55
    v_mad_i32_i24 v120, v121, -3, v120
    ds_add_u32 v55, v3 offset:0
    v_lshl_or_b32 v19, v110, 16, v19
    v_lshl_or_b32 v19, v120, 30, v19
    v_lshrrev_b32 v118, 3, v117
    v_lshrrev_b32 v119, 8, v117
    v_lshlrev_b16 v117, 13, v117
    v_bitop3_b32 v119, v118, v119, v124 bitop3:0x1b
    v_bitop3_b32 v18, v117, v125, v18 bitop3:0xae
    v_lshl_or_b32 v54, v119, 16, v54
    v_bitop3_b32 v19, v118, v125, v19 bitop3:0xae
    v_bitop3_b32 v55, v119, v126, v55 bitop3:0xea
p1_k6:
    s_cmp_lt_u32 s29, 1279
    s_cselect_b32 s6, 204800000, 0
    s_cselect_b32 s10, 204800000, 0
    s_add_u32 s32, s30, 114688
    buffer_load_dwordx4 v[32:35], v1, s[4:7], s32 offen nt
    buffer_load_dwordx4 v[68:71], v1, s[8:11], s32 offen nt
    s_cmp_ge_u32 s29, 1389
    s_cbranch_scc1 p1_k8
    s_waitcnt vmcnt(6)
    v_lshlrev_b32 v117, 16, v84
    v_and_b32 v118, v126, v84
    v_mul_f32 v117, v123, v117
    v_mul_f32 v118, v123, v118
    v_cvt_pk_bf16_f32 v117, v117, v118
    v_and_b32 v118, v126, v117
    v_lshlrev_b32 v117, 16, v117
    v_mul_f32 v117, 0.15915494, v117
    v_mul_f32 v118, 0.15915494, v118
    v_fract_f32 v117, v117
    v_fract_f32 v118, v118
    v_cos_f32 v117, v117
    v_cos_f32 v118, v118
    v_mul_hi_u32_u24 v122, s38, v56
    v_mul_hi_u32_u24 v121, s37, v20
    v_mul_hi_u32_u24 v120, s36, v20
    v_mad_i32_i24 v110, v122, s44, v56
    v_mad_u32_u24 v56, v122, 40, v121
    v_mad_i32_i24 v20, v120, s39, v20
    v_lshlrev_b16 v56, 2, v56
    v_mad_i32_i24 v120, v121, -3, v120
    ds_add_u32 v56, v3 offset:0
    v_lshl_or_b32 v20, v110, 16, v20
    v_lshl_or_b32 v20, v120, 30, v20
    v_mul_f32 v117, 0x03800000, v117
    v_mul_f32 v118, 0x03800000, v118
    v_cvt_pk_bf16_f32 v117, v117, v118
    v_mul_hi_u32_u24 v122, s38, v57
    v_mul_hi_u32_u24 v121, s37, v21
    v_mul_hi_u32_u24 v120, s36, v21
    v_mad_i32_i24 v110, v122, s44, v57
    v_mad_u32_u24 v57, v122, 40, v121
    v_mad_i32_i24 v21, v120, s39, v21
    v_lshlrev_b16 v57, 2, v57
    v_mad_i32_i24 v120, v121, -3, v120
    ds_add_u32 v57, v3 offset:0
    v_lshl_or_b32 v21, v110, 16, v21
    v_lshl_or_b32 v21, v120, 30, v21
    v_lshrrev_b32 v118, 3, v117
    v_lshrrev_b32 v119, 8, v117
    v_lshlrev_b16 v117, 13, v117
    v_bitop3_b32 v119, v118, v119, v124 bitop3:0x1b
    v_bitop3_b32 v20, v117, v125, v20 bitop3:0xae
    v_lshl_or_b32 v56, v119, 16, v56
    v_bitop3_b32 v21, v118, v125, v21 bitop3:0xae
    v_bitop3_b32 v57, v119, v126, v57 bitop3:0xea
    v_lshlrev_b32 v117, 16, v85
    v_and_b32 v118, v126, v85
    v_mul_f32 v117, v123, v117
    v_mul_f32 v118, v123, v118
    v_cvt_pk_bf16_f32 v117, v117, v118
    v_and_b32 v118, v126, v117
    v_lshlrev_b32 v117, 16, v117
    v_mul_f32 v117, 0.15915494, v117
    v_mul_f32 v118, 0.15915494, v118
    v_fract_f32 v117, v117
    v_fract_f32 v118, v118
    v_cos_f32 v117, v117
    v_cos_f32 v118, v118
    v_mul_hi_u32_u24 v122, s38, v58
    v_mul_hi_u32_u24 v121, s37, v22
    v_mul_hi_u32_u24 v120, s36, v22
    v_mad_i32_i24 v110, v122, s44, v58
    v_mad_u32_u24 v58, v122, 40, v121
    v_mad_i32_i24 v22, v120, s39, v22
    v_lshlrev_b16 v58, 2, v58
    v_mad_i32_i24 v120, v121, -3, v120
    ds_add_u32 v58, v3 offset:0
    v_lshl_or_b32 v22, v110, 16, v22
    v_lshl_or_b32 v22, v120, 30, v22
    v_mul_f32 v117, 0x03800000, v117
    v_mul_f32 v118, 0x03800000, v118
    v_cvt_pk_bf16_f32 v117, v117, v118
    v_mul_hi_u32_u24 v122, s38, v59
    v_mul_hi_u32_u24 v121, s37, v23
    v_mul_hi_u32_u24 v120, s36, v23
    v_mad_i32_i24 v110, v122, s44, v59
    v_mad_u32_u24 v59, v122, 40, v121
    v_mad_i32_i24 v23, v120, s39, v23
    v_lshlrev_b16 v59, 2, v59
    v_mad_i32_i24 v120, v121, -3, v120
    ds_add_u32 v59, v3 offset:0
    v_lshl_or_b32 v23, v110, 16, v23
    v_lshl_or_b32 v23, v120, 30, v23
    v_lshrrev_b32 v118, 3, v117
    v_lshrrev_b32 v119, 8, v117
    v_lshlrev_b16 v117, 13, v117
    v_bitop3_b32 v119, v118, v119, v124 bitop3:0x1b
    v_bitop3_b32 v22, v117, v125, v22 bitop3:0xae
    v_lshl_or_b32 v58, v119, 16, v58
    v_bitop3_b32 v23, v118, v125, v23 bitop3:0xae
    v_bitop3_b32 v59, v119, v126, v59 bitop3:0xea
p1_k8:
    s_cmp_lt_u32 s29, 1242
    s_cselect_b32 s6, 204800000, 0
    s_cselect_b32 s10, 204800000, 0
    s_add_u32 s32, s30, 131072
    buffer_load_dwordx4 v[36:39], v1, s[4:7], s32 offen nt
    buffer_load_dwordx4 v[72:75], v1, s[8:11], s32 offen nt
    s_cmp_ge_u32 s29, 1352
    s_cbranch_scc1 p1_k10
    s_waitcnt vmcnt(6)
    v_lshlrev_b32 v117, 16, v86
    v_and_b32 v118, v126, v86
    v_mul_f32 v117, v123, v117
    v_mul_f32 v118, v123, v118
    v_cvt_pk_bf16_f32 v117, v117, v118
    v_and_b32 v118, v126, v117
    v_lshlrev_b32 v117, 16, v117
    v_mul_f32 v117, 0.15915494, v117
    v_mul_f32 v118, 0.15915494, v118
    v_fract_f32 v117, v117
    v_fract_f32 v118, v118
    v_cos_f32 v117, v117
    v_cos_f32 v118, v118
    v_mul_hi_u32_u24 v122, s38, v60
    v_mul_hi_u32_u24 v121, s37, v24
    v_mul_hi_u32_u24 v120, s36, v24
    v_mad_i32_i24 v110, v122, s44, v60
    v_mad_u32_u24 v60, v122, 40, v121
    v_mad_i32_i24 v24, v120, s39, v24
    v_lshlrev_b16 v60, 2, v60
    v_mad_i32_i24 v120, v121, -3, v120
    ds_add_u32 v60, v3 offset:0
    v_lshl_or_b32 v24, v110, 16, v24
    v_lshl_or_b32 v24, v120, 30, v24
    v_mul_f32 v117, 0x03800000, v117
    v_mul_f32 v118, 0x03800000, v118
    v_cvt_pk_bf16_f32 v117, v117, v118
    v_mul_hi_u32_u24 v122, s38, v61
    v_mul_hi_u32_u24 v121, s37, v25
    v_mul_hi_u32_u24 v120, s36, v25
    v_mad_i32_i24 v110, v122, s44, v61
    v_mad_u32_u24 v61, v122, 40, v121
    v_mad_i32_i24 v25, v120, s39, v25
    v_lshlrev_b16 v61, 2, v61
    v_mad_i32_i24 v120, v121, -3, v120
    ds_add_u32 v61, v3 offset:0
    v_lshl_or_b32 v25, v110, 16, v25
    v_lshl_or_b32 v25, v120, 30, v25
    v_lshrrev_b32 v118, 3, v117
    v_lshrrev_b32 v119, 8, v117
    v_lshlrev_b16 v117, 13, v117
    v_bitop3_b32 v119, v118, v119, v124 bitop3:0x1b
    v_bitop3_b32 v24, v117, v125, v24 bitop3:0xae
    v_lshl_or_b32 v60, v119, 16, v60
    v_bitop3_b32 v25, v118, v125, v25 bitop3:0xae
    v_bitop3_b32 v61, v119, v126, v61 bitop3:0xea
    v_lshlrev_b32 v117, 16, v87
    v_and_b32 v118, v126, v87
    v_mul_f32 v117, v123, v117
    v_mul_f32 v118, v123, v118
    v_cvt_pk_bf16_f32 v117, v117, v118
    v_and_b32 v118, v126, v117
    v_lshlrev_b32 v117, 16, v117
    v_mul_f32 v117, 0.15915494, v117
    v_mul_f32 v118, 0.15915494, v118
    v_fract_f32 v117, v117
    v_fract_f32 v118, v118
    v_cos_f32 v117, v117
    v_cos_f32 v118, v118
    v_mul_hi_u32_u24 v122, s38, v62
    v_mul_hi_u32_u24 v121, s37, v26
    v_mul_hi_u32_u24 v120, s36, v26
    v_mad_i32_i24 v110, v122, s44, v62
    v_mad_u32_u24 v62, v122, 40, v121
    v_mad_i32_i24 v26, v120, s39, v26
    v_lshlrev_b16 v62, 2, v62
    v_mad_i32_i24 v120, v121, -3, v120
    ds_add_u32 v62, v3 offset:0
    v_lshl_or_b32 v26, v110, 16, v26
    v_lshl_or_b32 v26, v120, 30, v26
    v_mul_f32 v117, 0x03800000, v117
    v_mul_f32 v118, 0x03800000, v118
    v_cvt_pk_bf16_f32 v117, v117, v118
    v_mul_hi_u32_u24 v122, s38, v63
    v_mul_hi_u32_u24 v121, s37, v27
    v_mul_hi_u32_u24 v120, s36, v27
    v_mad_i32_i24 v110, v122, s44, v63
    v_mad_u32_u24 v63, v122, 40, v121
    v_mad_i32_i24 v27, v120, s39, v27
    v_lshlrev_b16 v63, 2, v63
    v_mad_i32_i24 v120, v121, -3, v120
    ds_add_u32 v63, v3 offset:0
    v_lshl_or_b32 v27, v110, 16, v27
    v_lshl_or_b32 v27, v120, 30, v27
    v_lshrrev_b32 v118, 3, v117
    v_lshrrev_b32 v119, 8, v117
    v_lshlrev_b16 v117, 13, v117
    v_bitop3_b32 v119, v118, v119, v124 bitop3:0x1b
    v_bitop3_b32 v26, v117, v125, v26 bitop3:0xae
    v_lshl_or_b32 v62, v119, 16, v62
    v_bitop3_b32 v27, v118, v125, v27 bitop3:0xae
    v_bitop3_b32 v63, v119, v126, v63 bitop3:0xea
p1_k10:
    s_cmp_ge_u32 s29, 1315
    s_cbranch_scc1 p1_k12
    s_waitcnt vmcnt(4)
    v_lshlrev_b32 v117, 16, v88
    v_and_b32 v118, v126, v88
    v_mul_f32 v117, v123, v117
    v_mul_f32 v118, v123, v118
    v_cvt_pk_bf16_f32 v117, v117, v118
    v_and_b32 v118, v126, v117
    v_lshlrev_b32 v117, 16, v117
    v_mul_f32 v117, 0.15915494, v117
    v_mul_f32 v118, 0.15915494, v118
    v_fract_f32 v117, v117
    v_fract_f32 v118, v118
    v_cos_f32 v117, v117
    v_cos_f32 v118, v118
    v_mul_hi_u32_u24 v122, s38, v64
    v_mul_hi_u32_u24 v121, s37, v28
    v_mul_hi_u32_u24 v120, s36, v28
    v_mad_i32_i24 v110, v122, s44, v64
    v_mad_u32_u24 v64, v122, 40, v121
    v_mad_i32_i24 v28, v120, s39, v28
    v_lshlrev_b16 v64, 2, v64
    v_mad_i32_i24 v120, v121, -3, v120
    ds_add_u32 v64, v3 offset:0
    v_lshl_or_b32 v28, v110, 16, v28
    v_lshl_or_b32 v28, v120, 30, v28
    v_mul_f32 v117, 0x03800000, v117
    v_mul_f32 v118, 0x03800000, v118
    v_cvt_pk_bf16_f32 v117, v117, v118
    v_mul_hi_u32_u24 v122, s38, v65
    v_mul_hi_u32_u24 v121, s37, v29
    v_mul_hi_u32_u24 v120, s36, v29
    v_mad_i32_i24 v110, v122, s44, v65
    v_mad_u32_u24 v65, v122, 40, v121
    v_mad_i32_i24 v29, v120, s39, v29
    v_lshlrev_b16 v65, 2, v65
    v_mad_i32_i24 v120, v121, -3, v120
    ds_add_u32 v65, v3 offset:0
    v_lshl_or_b32 v29, v110, 16, v29
    v_lshl_or_b32 v29, v120, 30, v29
    v_lshrrev_b32 v118, 3, v117
    v_lshrrev_b32 v119, 8, v117
    v_lshlrev_b16 v117, 13, v117
    v_bitop3_b32 v119, v118, v119, v124 bitop3:0x1b
    v_bitop3_b32 v28, v117, v125, v28 bitop3:0xae
    v_lshl_or_b32 v64, v119, 16, v64
    v_bitop3_b32 v29, v118, v125, v29 bitop3:0xae
    v_bitop3_b32 v65, v119, v126, v65 bitop3:0xea
    v_lshlrev_b32 v117, 16, v89
    v_and_b32 v118, v126, v89
    v_mul_f32 v117, v123, v117
    v_mul_f32 v118, v123, v118
    v_cvt_pk_bf16_f32 v117, v117, v118
    v_and_b32 v118, v126, v117
    v_lshlrev_b32 v117, 16, v117
    v_mul_f32 v117, 0.15915494, v117
    v_mul_f32 v118, 0.15915494, v118
    v_fract_f32 v117, v117
    v_fract_f32 v118, v118
    v_cos_f32 v117, v117
    v_cos_f32 v118, v118
    v_mul_hi_u32_u24 v122, s38, v66
    v_mul_hi_u32_u24 v121, s37, v30
    v_mul_hi_u32_u24 v120, s36, v30
    v_mad_i32_i24 v110, v122, s44, v66
    v_mad_u32_u24 v66, v122, 40, v121
    v_mad_i32_i24 v30, v120, s39, v30
    v_lshlrev_b16 v66, 2, v66
    v_mad_i32_i24 v120, v121, -3, v120
    ds_add_u32 v66, v3 offset:0
    v_lshl_or_b32 v30, v110, 16, v30
    v_lshl_or_b32 v30, v120, 30, v30
    v_mul_f32 v117, 0x03800000, v117
    v_mul_f32 v118, 0x03800000, v118
    v_cvt_pk_bf16_f32 v117, v117, v118
    v_mul_hi_u32_u24 v122, s38, v67
    v_mul_hi_u32_u24 v121, s37, v31
    v_mul_hi_u32_u24 v120, s36, v31
    v_mad_i32_i24 v110, v122, s44, v67
    v_mad_u32_u24 v67, v122, 40, v121
    v_mad_i32_i24 v31, v120, s39, v31
    v_lshlrev_b16 v67, 2, v67
    v_mad_i32_i24 v120, v121, -3, v120
    ds_add_u32 v67, v3 offset:0
    v_lshl_or_b32 v31, v110, 16, v31
    v_lshl_or_b32 v31, v120, 30, v31
    v_lshrrev_b32 v118, 3, v117
    v_lshrrev_b32 v119, 8, v117
    v_lshlrev_b16 v117, 13, v117
    v_bitop3_b32 v119, v118, v119, v124 bitop3:0x1b
    v_bitop3_b32 v30, v117, v125, v30 bitop3:0xae
    v_lshl_or_b32 v66, v119, 16, v66
    v_bitop3_b32 v31, v118, v125, v31 bitop3:0xae
    v_bitop3_b32 v67, v119, v126, v67 bitop3:0xea
p1_k12:
    s_cmp_ge_u32 s29, 1279
    s_cbranch_scc1 p1_k14
    s_waitcnt vmcnt(2)
    v_lshlrev_b32 v117, 16, v90
    v_and_b32 v118, v126, v90
    v_mul_f32 v117, v123, v117
    v_mul_f32 v118, v123, v118
    v_cvt_pk_bf16_f32 v117, v117, v118
    v_and_b32 v118, v126, v117
    v_lshlrev_b32 v117, 16, v117
    v_mul_f32 v117, 0.15915494, v117
    v_mul_f32 v118, 0.15915494, v118
    v_fract_f32 v117, v117
    v_fract_f32 v118, v118
    v_cos_f32 v117, v117
    v_cos_f32 v118, v118
    v_mul_hi_u32_u24 v122, s38, v68
    v_mul_hi_u32_u24 v121, s37, v32
    v_mul_hi_u32_u24 v120, s36, v32
    v_mad_i32_i24 v110, v122, s44, v68
    v_mad_u32_u24 v68, v122, 40, v121
    v_mad_i32_i24 v32, v120, s39, v32
    v_lshlrev_b16 v68, 2, v68
    v_mad_i32_i24 v120, v121, -3, v120
    ds_add_u32 v68, v3 offset:0
    v_lshl_or_b32 v32, v110, 16, v32
    v_lshl_or_b32 v32, v120, 30, v32
    v_mul_f32 v117, 0x03800000, v117
    v_mul_f32 v118, 0x03800000, v118
    v_cvt_pk_bf16_f32 v117, v117, v118
    v_mul_hi_u32_u24 v122, s38, v69
    v_mul_hi_u32_u24 v121, s37, v33
    v_mul_hi_u32_u24 v120, s36, v33
    v_mad_i32_i24 v110, v122, s44, v69
    v_mad_u32_u24 v69, v122, 40, v121
    v_mad_i32_i24 v33, v120, s39, v33
    v_lshlrev_b16 v69, 2, v69
    v_mad_i32_i24 v120, v121, -3, v120
    ds_add_u32 v69, v3 offset:0
    v_lshl_or_b32 v33, v110, 16, v33
    v_lshl_or_b32 v33, v120, 30, v33
    v_lshrrev_b32 v118, 3, v117
    v_lshrrev_b32 v119, 8, v117
    v_lshlrev_b16 v117, 13, v117
    v_bitop3_b32 v119, v118, v119, v124 bitop3:0x1b
    v_bitop3_b32 v32, v117, v125, v32 bitop3:0xae
    v_lshl_or_b32 v68, v119, 16, v68
    v_bitop3_b32 v33, v118, v125, v33 bitop3:0xae
    v_bitop3_b32 v69, v119, v126, v69 bitop3:0xea
    v_lshlrev_b32 v117, 16, v91
    v_and_b32 v118, v126, v91
    v_mul_f32 v117, v123, v117
    v_mul_f32 v118, v123, v118
    v_cvt_pk_bf16_f32 v117, v117, v118
    v_and_b32 v118, v126, v117
    v_lshlrev_b32 v117, 16, v117
    v_mul_f32 v117, 0.15915494, v117
    v_mul_f32 v118, 0.15915494, v118
    v_fract_f32 v117, v117
    v_fract_f32 v118, v118
    v_cos_f32 v117, v117
    v_cos_f32 v118, v118
    v_mul_hi_u32_u24 v122, s38, v70
    v_mul_hi_u32_u24 v121, s37, v34
    v_mul_hi_u32_u24 v120, s36, v34
    v_mad_i32_i24 v110, v122, s44, v70
    v_mad_u32_u24 v70, v122, 40, v121
    v_mad_i32_i24 v34, v120, s39, v34
    v_lshlrev_b16 v70, 2, v70
    v_mad_i32_i24 v120, v121, -3, v120
    ds_add_u32 v70, v3 offset:0
    v_lshl_or_b32 v34, v110, 16, v34
    v_lshl_or_b32 v34, v120, 30, v34
    v_mul_f32 v117, 0x03800000, v117
    v_mul_f32 v118, 0x03800000, v118
    v_cvt_pk_bf16_f32 v117, v117, v118
    v_mul_hi_u32_u24 v122, s38, v71
    v_mul_hi_u32_u24 v121, s37, v35
    v_mul_hi_u32_u24 v120, s36, v35
    v_mad_i32_i24 v110, v122, s44, v71
    v_mad_u32_u24 v71, v122, 40, v121
    v_mad_i32_i24 v35, v120, s39, v35
    v_lshlrev_b16 v71, 2, v71
    v_mad_i32_i24 v120, v121, -3, v120
    ds_add_u32 v71, v3 offset:0
    v_lshl_or_b32 v35, v110, 16, v35
    v_lshl_or_b32 v35, v120, 30, v35
    v_lshrrev_b32 v118, 3, v117
    v_lshrrev_b32 v119, 8, v117
    v_lshlrev_b16 v117, 13, v117
    v_bitop3_b32 v119, v118, v119, v124 bitop3:0x1b
    v_bitop3_b32 v34, v117, v125, v34 bitop3:0xae
    v_lshl_or_b32 v70, v119, 16, v70
    v_bitop3_b32 v35, v118, v125, v35 bitop3:0xae
    v_bitop3_b32 v71, v119, v126, v71 bitop3:0xea
p1_k14:
    s_cmp_ge_u32 s29, 1242
    s_cbranch_scc1 p1_k16
    s_waitcnt vmcnt(0)
    v_lshlrev_b32 v117, 16, v92
    v_and_b32 v118, v126, v92
    v_mul_f32 v117, v123, v117
    v_mul_f32 v118, v123, v118
    v_cvt_pk_bf16_f32 v117, v117, v118
    v_and_b32 v118, v126, v117
    v_lshlrev_b32 v117, 16, v117
    v_mul_f32 v117, 0.15915494, v117
    v_mul_f32 v118, 0.15915494, v118
    v_fract_f32 v117, v117
    v_fract_f32 v118, v118
    v_cos_f32 v117, v117
    v_cos_f32 v118, v118
    v_mul_hi_u32_u24 v122, s38, v72
    v_mul_hi_u32_u24 v121, s37, v36
    v_mul_hi_u32_u24 v120, s36, v36
    v_mad_i32_i24 v110, v122, s44, v72
    v_mad_u32_u24 v72, v122, 40, v121
    v_mad_i32_i24 v36, v120, s39, v36
    v_lshlrev_b16 v72, 2, v72
    v_mad_i32_i24 v120, v121, -3, v120
    ds_add_u32 v72, v3 offset:0
    v_lshl_or_b32 v36, v110, 16, v36
    v_lshl_or_b32 v36, v120, 30, v36
    v_mul_f32 v117, 0x03800000, v117
    v_mul_f32 v118, 0x03800000, v118
    v_cvt_pk_bf16_f32 v117, v117, v118
    v_mul_hi_u32_u24 v122, s38, v73
    v_mul_hi_u32_u24 v121, s37, v37
    v_mul_hi_u32_u24 v120, s36, v37
    v_mad_i32_i24 v110, v122, s44, v73
    v_mad_u32_u24 v73, v122, 40, v121
    v_mad_i32_i24 v37, v120, s39, v37
    v_lshlrev_b16 v73, 2, v73
    v_mad_i32_i24 v120, v121, -3, v120
    ds_add_u32 v73, v3 offset:0
    v_lshl_or_b32 v37, v110, 16, v37
    v_lshl_or_b32 v37, v120, 30, v37
    v_lshrrev_b32 v118, 3, v117
    v_lshrrev_b32 v119, 8, v117
    v_lshlrev_b16 v117, 13, v117
    v_bitop3_b32 v119, v118, v119, v124 bitop3:0x1b
    v_bitop3_b32 v36, v117, v125, v36 bitop3:0xae
    v_lshl_or_b32 v72, v119, 16, v72
    v_bitop3_b32 v37, v118, v125, v37 bitop3:0xae
    v_bitop3_b32 v73, v119, v126, v73 bitop3:0xea
    v_lshlrev_b32 v117, 16, v93
    v_and_b32 v118, v126, v93
    v_mul_f32 v117, v123, v117
    v_mul_f32 v118, v123, v118
    v_cvt_pk_bf16_f32 v117, v117, v118
    v_and_b32 v118, v126, v117
    v_lshlrev_b32 v117, 16, v117
    v_mul_f32 v117, 0.15915494, v117
    v_mul_f32 v118, 0.15915494, v118
    v_fract_f32 v117, v117
    v_fract_f32 v118, v118
    v_cos_f32 v117, v117
    v_cos_f32 v118, v118
    v_mul_hi_u32_u24 v122, s38, v74
    v_mul_hi_u32_u24 v121, s37, v38
    v_mul_hi_u32_u24 v120, s36, v38
    v_mad_i32_i24 v110, v122, s44, v74
    v_mad_u32_u24 v74, v122, 40, v121
    v_mad_i32_i24 v38, v120, s39, v38
    v_lshlrev_b16 v74, 2, v74
    v_mad_i32_i24 v120, v121, -3, v120
    ds_add_u32 v74, v3 offset:0
    v_lshl_or_b32 v38, v110, 16, v38
    v_lshl_or_b32 v38, v120, 30, v38
    v_mul_f32 v117, 0x03800000, v117
    v_mul_f32 v118, 0x03800000, v118
    v_cvt_pk_bf16_f32 v117, v117, v118
    v_mul_hi_u32_u24 v122, s38, v75
    v_mul_hi_u32_u24 v121, s37, v39
    v_mul_hi_u32_u24 v120, s36, v39
    v_mad_i32_i24 v110, v122, s44, v75
    v_mad_u32_u24 v75, v122, 40, v121
    v_mad_i32_i24 v39, v120, s39, v39
    v_lshlrev_b16 v75, 2, v75
    v_mad_i32_i24 v120, v121, -3, v120
    ds_add_u32 v75, v3 offset:0
    v_lshl_or_b32 v39, v110, 16, v39
    v_lshl_or_b32 v39, v120, 30, v39
    v_lshrrev_b32 v118, 3, v117
    v_lshrrev_b32 v119, 8, v117
    v_lshlrev_b16 v117, 13, v117
    v_bitop3_b32 v119, v118, v119, v124 bitop3:0x1b
    v_bitop3_b32 v38, v117, v125, v38 bitop3:0xae
    v_lshl_or_b32 v74, v119, 16, v74
    v_bitop3_b32 v39, v118, v125, v39 bitop3:0xae
    v_bitop3_b32 v75, v119, v126, v75 bitop3:0xea
p1_k16:
    s_waitcnt vmcnt(0)
    s_cmp_lg_u32 s28, 15
    s_cbranch_scc1 p1_tk1
    v_mov_b32 v126, 0
    s_mov_b64 exec, 1
    ds_write_b32 v126, v127 offset:10456
    s_mov_b64 exec, -1
p1_tk1:
    s_waitcnt lgkmcnt(0)
    s_barrier
    s_cmp_ge_u32 s28, 10
    s_cbranch_scc1 p1_s1_skip
    v_and_b32 v126, 63, v0
    s_lshl_b32 s54, s28, 4
    v_mul_u32_u24 v117, 160, v126
    v_add_u32 v117, s54, v117
    ds_read_b128 v[118:121], v117 offset:0
    s_waitcnt lgkmcnt(0)
    v_add_u32 v118, 2, v118
    v_add_u32 v119, 2, v119
    v_add_u32 v120, 2, v120
    v_add_u32 v121, 2, v121
    v_mul_u32_u24 v118, 43691, v118
    v_mul_u32_u24 v119, 43691, v119
    v_mul_u32_u24 v120, 43691, v120
    v_mul_u32_u24 v121, 43691, v121
    v_lshrrev_b32 v118, 17, v118
    v_lshrrev_b32 v119, 17, v119
    v_lshrrev_b32 v120, 17, v120
    v_lshrrev_b32 v121, 17, v121
    v_lshl_or_b32 v122, v119, 16, v118
    v_lshl_or_b32 v123, v121, 16, v120
    v_mov_b32 v124, v122
    v_mov_b32 v125, v123
    s_nop 1
    v_add_u32_dpp v124, v124, v124 row_shr:1 row_mask:0xf bank_mask:0xf bound_ctrl:0
    v_add_u32_dpp v125, v125, v125 row_shr:1 row_mask:0xf bank_mask:0xf bound_ctrl:0
    s_nop 0
    v_add_u32_dpp v124, v124, v124 row_shr:2 row_mask:0xf bank_mask:0xf bound_ctrl:0
    v_add_u32_dpp v125, v125, v125 row_shr:2 row_mask:0xf bank_mask:0xf bound_ctrl:0
    s_nop 0
    v_add_u32_dpp v124, v124, v124 row_shr:4 row_mask:0xf bank_mask:0xf bound_ctrl:0
    v_add_u32_dpp v125, v125, v125 row_shr:4 row_mask:0xf bank_mask:0xf bound_ctrl:0
    s_nop 0
    v_add_u32_dpp v124, v124, v124 row_shr:8 row_mask:0xf bank_mask:0xf bound_ctrl:0
    v_add_u32_dpp v125, v125, v125 row_shr:8 row_mask:0xf bank_mask:0xf bound_ctrl:0
    s_nop 0
    v_add_u32_dpp v124, v124, v124 row_bcast:15 row_mask:0xa bank_mask:0xf
    v_add_u32_dpp v125, v125, v125 row_bcast:15 row_mask:0xa bank_mask:0xf
    s_nop 0
    v_add_u32_dpp v124, v124, v124 row_bcast:31 row_mask:0xc bank_mask:0xf
    v_add_u32_dpp v125, v125, v125 row_bcast:31 row_mask:0xc bank_mask:0xf
    s_nop 0
    s_nop 0
    v_mov_b32 v127, s54
    v_and_b32 v118, 0xffff, v124
    v_lshrrev_b32 v119, 16, v124
    v_and_b32 v120, 0xffff, v125
    v_lshrrev_b32 v121, 16, v125
    s_mov_b64 exec, 1
    s_lshl_b64 exec, exec, 63
    ds_write_b128 v127, v[118:121] offset:10240
    s_mov_b64 exec, -1
p1_s1_skip:
    s_waitcnt lgkmcnt(0)
    s_barrier
    v_and_b32 v127, 63, v0
    v_lshlrev_b32 v118, 2, v127
    v_cmp_gt_u32 vcc, 40, v127
    ds_read_b32 v119, v118 offset:10240
    s_waitcnt lgkmcnt(0)
    v_readlane_b32 s33, v119, 54
    v_cndmask_b32 v119, 0, v119, vcc
    v_mov_b32 v120, v119
    s_nop 1
    v_add_u32_dpp v120, v120, v120 row_shr:1 row_mask:0xf bank_mask:0xf bound_ctrl:0
    s_nop 1
    v_add_u32_dpp v120, v120, v120 row_shr:2 row_mask:0xf bank_mask:0xf bound_ctrl:0
    s_nop 1
    v_add_u32_dpp v120, v120, v120 row_shr:4 row_mask:0xf bank_mask:0xf bound_ctrl:0
    s_nop 1
    v_add_u32_dpp v120, v120, v120 row_shr:8 row_mask:0xf bank_mask:0xf bound_ctrl:0
    s_nop 1
    v_add_u32_dpp v120, v120, v120 row_bcast:15 row_mask:0xa bank_mask:0xf
    s_nop 1
    v_add_u32_dpp v120, v120, v120 row_bcast:31 row_mask:0xc bank_mask:0xf
    s_nop 1
    s_nop 0
    v_sub_u32 v119, v120, v119
    v_readlane_b32 s35, v120, 63
    s_add_u32 s33, s33, 256
    s_mul_i32 s46, s33, 1
    s_min_u32 s47, s33, 1499
    s_add_u32 s46, s46, s47
    s_min_u32 s47, s33, 1462
    s_add_u32 s46, s46, s47
    s_min_u32 s47, s33, 1426
    s_add_u32 s46, s46, s47
    s_min_u32 s47, s33, 1389
    s_add_u32 s46, s46, s47
    s_min_u32 s47, s33, 1352
    s_add_u32 s46, s46, s47
    s_min_u32 s47, s33, 1315
    s_add_u32 s46, s46, s47
    s_min_u32 s47, s33, 1279
    s_add_u32 s46, s46, s47
    s_min_u32 s47, s33, 1242
    s_add_u32 s46, s46, s47
    s_lshl_b32 s30, s46, 14
    s_lshl_b32 s31, s46, 13
    s_cmp_ge_u32 s28, 10
    s_cbranch_scc1 p1_s2_skip
    s_lshl_b32 s54, s28, 2
    s_add_u32 s55, s54, 0
    v_readlane_b32 s56, v119, s55
    s_add_u32 s55, s54, 1
    v_readlane_b32 s57, v119, s55
    s_add_u32 s55, s54, 2
    v_readlane_b32 s58, v119, s55
    s_add_u32 s55, s54, 3
    v_readlane_b32 s59, v119, s55
    s_nop 0
    s_lshl_b32 s57, s57, 16
    s_or_b32 s56, s56, s57
    s_lshl_b32 s59, s59, 16
    s_or_b32 s58, s58, s59
    v_add_u32 v124, s56, v124
    v_add_u32 v125, s58, v125
    v_sub_u32 v122, v124, v122
    v_sub_u32 v123, v125, v123
    v_and_b32 v118, 0xffff, v122
    v_lshrrev_b32 v119, 16, v122
    v_and_b32 v120, 0xffff, v123
    v_lshrrev_b32 v121, 16, v123
    v_mul_u32_u24 v118, 3, v118
    v_mul_u32_u24 v119, 3, v119
    v_mul_u32_u24 v120, 3, v120
    v_mul_u32_u24 v121, 3, v121
    ds_write_b128 v117, v[118:121] offset:0
    s_mul_i32 s55, s29, 5248
    s_mul_i32 s56, s28, 520
    s_add_u32 s55, s55, s56
    s_add_u32 s55, s55, 469762048
    v_lshlrev_b32 v127, 3, v126
    buffer_store_dwordx2 v[122:123], v127, s[16:19], s55 offen sc1
    s_mov_b64 exec, 1
    s_lshl_b64 exec, exec, 63
    buffer_store_dwordx2 v[124:125], v127, s[16:19], s55 offen offset:8 sc1
    s_mov_b64 exec, -1
p1_s2_skip:
    s_mul_i32 s50, s29, 16384
    s_lshr_b32 s52, s35, 10
    s_mul_i32 s52, s52, 33554432
    s_and_b32 s53, s35, 1023
    s_lshl_b32 s53, s53, 4
    s_add_u32 s52, s52, s53
    s_add_u32 s52, s52, s50
    s_min_u32 s22, s52, 469762048
    s_mov_b32 s68, 0
    s_cmp_lt_u32 s29, 1242
    s_cselect_b32 s35, 13994, s35
    s_waitcnt lgkmcnt(0)
    s_barrier
    s_cmp_lt_u32 s33, 1536
    s_cbranch_scc1 p1_f0
    s_cmp_lg_u32 s28, 15
    s_cbranch_scc1 p1_hv0
    s_sub_u32 s52, s33, 1536
    s_and_b32 s52, s52, 255
    s_lshl_b32 s58, s52, 2
    s_and_b32 s58, s58, 28
    s_lshl_b32 s53, 1, s58
    v_mov_b32 v127, s53
    s_lshr_b32 s52, s52, 3
    s_lshl_b32 s52, s52, 2
    s_mov_b64 exec, 1
    buffer_atomic_add v127, off, s[40:43], s52 sc0 sc1
    s_mov_b64 exec, -1
p1_hv0:
    s_cmp_ge_u32 s33, 1656
    s_cbranch_scc1 p1_f0
    s_sub_u32 s52, s33, 1536
    s_mul_i32 s52, s52, 53368
    s_mul_i32 s53, s28, 3072
    s_add_u32 s53, s53, s52
    v_and_b32 v92, 63, v0
    v_lshl_add_u32 v93, v92, 2, s53
    s_lshl_b32 s53, s28, 9
    s_add_u32 s53, s53, s52
    s_add_u32 s53, s53, 49152
    s_cmp_lt_u32 s28, 9
    s_cselect_b32 s53, s53, 0x40000000
    v_lshl_add_u32 v94, v92, 2, s53
    buffer_load_dword v76, v93, s[24:27], 0 offen offset:0
    buffer_load_dword v77, v93, s[24:27], 0 offen offset:256
    buffer_load_dword v78, v93, s[24:27], 0 offen offset:512
    buffer_load_dword v79, v93, s[24:27], 0 offen offset:768
    buffer_load_dword v80, v93, s[24:27], 0 offen offset:1024
    buffer_load_dword v81, v93, s[24:27], 0 offen offset:1280
    buffer_load_dword v82, v93, s[24:27], 0 offen offset:1536
    buffer_load_dword v83, v93, s[24:27], 0 offen offset:1792
    buffer_load_dword v84, v93, s[24:27], 0 offen offset:2048
    buffer_load_dword v85, v93, s[24:27], 0 offen offset:2304
    buffer_load_dword v86, v93, s[24:27], 0 offen offset:2560
    buffer_load_dword v87, v93, s[24:27], 0 offen offset:2816
    buffer_load_dword v88, v94, s[24:27], 0 offen offset:0
    buffer_load_dword v89, v94, s[24:27], 0 offen offset:256
p1_f0:
    v_and_b32 v117, 0xffff, v40
    ds_add_rtn_u32 v117, v117, v3 offset:0
    v_and_b32 v118, 0xffff, v41
    ds_add_rtn_u32 v118, v118, v3 offset:0
    v_and_b32 v119, 0xffff, v42
    ds_add_rtn_u32 v119, v119, v3 offset:0
    v_and_b32 v120, 0xffff, v43
    ds_add_rtn_u32 v120, v120, v3 offset:0
    s_cmp_ge_u32 s33, 1536
    s_cbranch_scc1 p1_k18
    s_cmp_lt_u32 s33, 1536
    s_cselect_b32 s14, 102400000, 0
    s_add_u32 s32, s31, 0
    buffer_load_dwordx2 v[76:77], v2, s[12:15], s32 offen nt
p1_k18:
    s_cmp_ge_u32 s33, 1536
    s_cbranch_scc1 p1_k19
    s_cmp_lt_u32 s33, 1536
    s_cselect_b32 s6, 204800000, 0
    s_cselect_b32 s10, 204800000, 0
    s_add_u32 s32, s30, 0
    buffer_load_dwordx4 v[94:97], v1, s[4:7], s32 offen nt
    buffer_load_dwordx4 v[102:105], v1, s[8:11], s32 offen nt
p1_k19:
    s_cmp_lt_u32 s29, 1499
    s_cbranch_scc1 p1_pa0
    s_waitcnt lgkmcnt(0)
    s_branch p1_pb0
p1_pa0:
    v_and_b32 v121, 0xffff, v44
    ds_add_rtn_u32 v121, v121, v3 offset:0
    v_and_b32 v122, 0xffff, v45
    ds_add_rtn_u32 v122, v122, v3 offset:0
    v_and_b32 v123, 0xffff, v46
    ds_add_rtn_u32 v123, v123, v3 offset:0
    v_and_b32 v124, 0xffff, v47
    ds_add_rtn_u32 v124, v124, v3 offset:0
    s_waitcnt lgkmcnt(4)
p1_pb0:
    ds_write_b8_d16_hi v117, v40 offset:10496
    v_lshlrev_b32 v40, 2, v117
    ds_write_b32 v40, v4 offset:52480
    ds_write_b8_d16_hi v118, v41 offset:10496
    v_lshlrev_b32 v41, 2, v118
    ds_write_b32 v41, v5 offset:52480
    ds_write_b8_d16_hi v119, v42 offset:10496
    v_lshlrev_b32 v42, 2, v119
    ds_write_b32 v42, v6 offset:52480
    ds_write_b8_d16_hi v120, v43 offset:10496
    v_lshlrev_b32 v43, 2, v120
    ds_write_b32 v43, v7 offset:52480
    s_cmp_ge_u32 s33, 1536
    s_cbranch_scc1 p1_k20
    s_cmp_lt_u32 s33, 1499
    s_cselect_b32 s14, 102400000, 0
    s_add_u32 s32, s31, 8192
    buffer_load_dwordx2 v[78:79], v2, s[12:15], s32 offen nt
p1_k20:
    s_cmp_lt_u32 s29, 1462
    s_cbranch_scc1 p1_pa1
    s_waitcnt lgkmcnt(0)
    s_branch p1_pb1
p1_pa1:
    v_and_b32 v117, 0xffff, v48
    ds_add_rtn_u32 v117, v117, v3 offset:0
    v_and_b32 v118, 0xffff, v49
    ds_add_rtn_u32 v118, v118, v3 offset:0
    v_and_b32 v119, 0xffff, v50
    ds_add_rtn_u32 v119, v119, v3 offset:0
    v_and_b32 v120, 0xffff, v51
    ds_add_rtn_u32 v120, v120, v3 offset:0
    s_waitcnt lgkmcnt(4)
p1_pb1:
    s_cmp_ge_u32 s29, 1499
    s_cbranch_scc1 p1_k21
    ds_write_b8_d16_hi v121, v44 offset:10496
    v_lshlrev_b32 v44, 2, v121
    ds_write_b32 v44, v8 offset:52480
    ds_write_b8_d16_hi v122, v45 offset:10496
    v_lshlrev_b32 v45, 2, v122
    ds_write_b32 v45, v9 offset:52480
    ds_write_b8_d16_hi v123, v46 offset:10496
    v_lshlrev_b32 v46, 2, v123
    ds_write_b32 v46, v10 offset:52480
    ds_write_b8_d16_hi v124, v47 offset:10496
    v_lshlrev_b32 v47, 2, v124
    ds_write_b32 v47, v11 offset:52480
p1_k21:
    s_cmp_ge_u32 s33, 1536
    s_cbranch_scc1 p1_k22
    s_cmp_lt_u32 s33, 1462
    s_cselect_b32 s14, 102400000, 0
    s_add_u32 s32, s31, 16384
    buffer_load_dwordx2 v[80:81], v2, s[12:15], s32 offen nt
p1_k22:
    s_cmp_lt_u32 s29, 1426
    s_cbranch_scc1 p1_pa2
    s_waitcnt lgkmcnt(0)
    s_branch p1_pb2
p1_pa2:
    v_and_b32 v121, 0xffff, v52
    ds_add_rtn_u32 v121, v121, v3 offset:0
    v_and_b32 v122, 0xffff, v53
    ds_add_rtn_u32 v122, v122, v3 offset:0
    v_and_b32 v123, 0xffff, v54
    ds_add_rtn_u32 v123, v123, v3 offset:0
    v_and_b32 v124, 0xffff, v55
    ds_add_rtn_u32 v124, v124, v3 offset:0
    s_waitcnt lgkmcnt(4)
p1_pb2:
    s_cmp_ge_u32 s29, 1462
    s_cbranch_scc1 p1_k23
    ds_write_b8_d16_hi v117, v48 offset:10496
    v_lshlrev_b32 v48, 2, v117
    ds_write_b32 v48, v12 offset:52480
    ds_write_b8_d16_hi v118, v49 offset:10496
    v_lshlrev_b32 v49, 2, v118
    ds_write_b32 v49, v13 offset:52480
    ds_write_b8_d16_hi v119, v50 offset:10496
    v_lshlrev_b32 v50, 2, v119
    ds_write_b32 v50, v14 offset:52480
    ds_write_b8_d16_hi v120, v51 offset:10496
    v_lshlrev_b32 v51, 2, v120
    ds_write_b32 v51, v15 offset:52480
p1_k23:
    s_cmp_ge_u32 s28, 10
    s_cbranch_scc1 p1_jn
    s_waitcnt vmcnt(0)
    v_mov_b32 v125, 0
    s_mov_b64 exec, 1
    ds_add_rtn_u32 v125, v125, v3 offset:10432
    s_waitcnt lgkmcnt(0)
    v_readfirstlane_b32 s52, v125
    s_lshr_b32 s53, s29, 1
    s_and_b32 s53, s53, 28
    s_cmp_lg_u32 s52, 9
    s_cbranch_scc1 p1_jn1
    s_lshl_b32 s54, 1, s53
    v_mov_b32 v127, s54
    s_lshr_b32 s54, s29, 6
    s_lshl_b32 s54, s54, 2
    s_mov_b32 s68, 1
    buffer_atomic_add v127, off, s[40:43], s54 sc0 sc1
p1_jn1:
    s_mov_b64 exec, -1
p1_jn:
    s_cmp_ge_u32 s33, 1536
    s_cbranch_scc1 p1_k24
    s_cmp_lt_u32 s33, 1426
    s_cselect_b32 s14, 102400000, 0
    s_add_u32 s32, s31, 24576
    buffer_load_dwordx2 v[82:83], v2, s[12:15], s32 offen nt
p1_k24:
    s_cmp_lt_u32 s29, 1389
    s_cbranch_scc1 p1_pa3
    s_waitcnt lgkmcnt(0)
    s_branch p1_pb3
p1_pa3:
    v_and_b32 v117, 0xffff, v56
    ds_add_rtn_u32 v117, v117, v3 offset:0
    v_and_b32 v118, 0xffff, v57
    ds_add_rtn_u32 v118, v118, v3 offset:0
    v_and_b32 v119, 0xffff, v58
    ds_add_rtn_u32 v119, v119, v3 offset:0
    v_and_b32 v120, 0xffff, v59
    ds_add_rtn_u32 v120, v120, v3 offset:0
    s_waitcnt lgkmcnt(4)
p1_pb3:
    s_cmp_ge_u32 s29, 1426
    s_cbranch_scc1 p1_k25
    ds_write_b8_d16_hi v121, v52 offset:10496
    v_lshlrev_b32 v52, 2, v121
    ds_write_b32 v52, v16 offset:52480
    ds_write_b8_d16_hi v122, v53 offset:10496
    v_lshlrev_b32 v53, 2, v122
    ds_write_b32 v53, v17 offset:52480
    ds_write_b8_d16_hi v123, v54 offset:10496
    v_lshlrev_b32 v54, 2, v123
    ds_write_b32 v54, v18 offset:52480
    ds_write_b8_d16_hi v124, v55 offset:10496
    v_lshlrev_b32 v55, 2, v124
    ds_write_b32 v55, v19 offset:52480
p1_k25:
    s_cmp_ge_u32 s33, 1536
    s_cbranch_scc1 p1_k26
    s_cmp_lt_u32 s33, 1389
    s_cselect_b32 s14, 102400000, 0
    s_add_u32 s32, s31, 32768
    buffer_load_dwordx2 v[84:85], v2, s[12:15], s32 offen nt
p1_k26:
    s_cmp_ge_u32 s33, 1536
    s_cbranch_scc1 p1_k27
    s_cmp_lt_u32 s33, 1499
    s_cselect_b32 s6, 204800000, 0
    s_cselect_b32 s10, 204800000, 0
    s_add_u32 s32, s30, 16384
    buffer_load_dwordx4 v[98:101], v1, s[4:7], s32 offen nt
    buffer_load_dwordx4 v[106:109], v1, s[8:11], s32 offen nt
p1_k27:
    s_cmp_lt_u32 s29, 1352
    s_cbranch_scc1 p1_pa4
    s_waitcnt lgkmcnt(0)
    s_branch p1_pb4
p1_pa4:
    v_and_b32 v121, 0xffff, v60
    ds_add_rtn_u32 v121, v121, v3 offset:0
    v_and_b32 v122, 0xffff, v61
    ds_add_rtn_u32 v122, v122, v3 offset:0
    v_and_b32 v123, 0xffff, v62
    ds_add_rtn_u32 v123, v123, v3 offset:0
    v_and_b32 v124, 0xffff, v63
    ds_add_rtn_u32 v124, v124, v3 offset:0
    s_waitcnt lgkmcnt(4)
p1_pb4:
    s_cmp_ge_u32 s29, 1389
    s_cbranch_scc1 p1_k28
    ds_write_b8_d16_hi v117, v56 offset:10496
    v_lshlrev_b32 v56, 2, v117
    ds_write_b32 v56, v20 offset:52480
    ds_write_b8_d16_hi v118, v57 offset:10496
    v_lshlrev_b32 v57, 2, v118
    ds_write_b32 v57, v21 offset:52480
    ds_write_b8_d16_hi v119, v58 offset:10496
    v_lshlrev_b32 v58, 2, v119
    ds_write_b32 v58, v22 offset:52480
    ds_write_b8_d16_hi v120, v59 offset:10496
    v_lshlrev_b32 v59, 2, v120
    ds_write_b32 v59, v23 offset:52480
p1_k28:
    s_cmp_ge_u32 s33, 1536
    s_cbranch_scc1 p1_k29
    s_cmp_lt_u32 s33, 1352
    s_cselect_b32 s14, 102400000, 0
    s_add_u32 s32, s31, 40960
    buffer_load_dwordx2 v[86:87], v2, s[12:15], s32 offen nt
p1_k29:
    s_cmp_lt_u32 s29, 1315
    s_cbranch_scc1 p1_pa5
    s_waitcnt lgkmcnt(0)
    s_branch p1_pb5
p1_pa5:
    v_and_b32 v117, 0xffff, v64
    ds_add_rtn_u32 v117, v117, v3 offset:0
    v_and_b32 v118, 0xffff, v65
    ds_add_rtn_u32 v118, v118, v3 offset:0
    v_and_b32 v119, 0xffff, v66
    ds_add_rtn_u32 v119, v119, v3 offset:0
    v_and_b32 v120, 0xffff, v67
    ds_add_rtn_u32 v120, v120, v3 offset:0
    s_waitcnt lgkmcnt(4)
p1_pb5:
    s_cmp_ge_u32 s29, 1352
    s_cbranch_scc1 p1_k30
    ds_write_b8_d16_hi v121, v60 offset:10496
    v_lshlrev_b32 v60, 2, v121
    ds_write_b32 v60, v24 offset:52480
    ds_write_b8_d16_hi v122, v61 offset:10496
    v_lshlrev_b32 v61, 2, v122
    ds_write_b32 v61, v25 offset:52480
    ds_write_b8_d16_hi v123, v62 offset:10496
    v_lshlrev_b32 v62, 2, v123
    ds_write_b32 v62, v26 offset:52480
    ds_write_b8_d16_hi v124, v63 offset:10496
    v_lshlrev_b32 v63, 2, v124
    ds_write_b32 v63, v27 offset:52480
p1_k30:
    s_cmp_ge_u32 s33, 1536
    s_cbranch_scc1 p1_k31
    s_cmp_lt_u32 s33, 1315
    s_cselect_b32 s14, 102400000, 0
    s_add_u32 s32, s31, 49152
    buffer_load_dwordx2 v[88:89], v2, s[12:15], s32 offen nt
p1_k31:
    s_cmp_lt_u32 s29, 1279
    s_cbranch_scc1 p1_pa6
    s_waitcnt lgkmcnt(0)
    s_branch p1_pb6
p1_pa6:
    v_and_b32 v121, 0xffff, v68
    ds_add_rtn_u32 v121, v121, v3 offset:0
    v_and_b32 v122, 0xffff, v69
    ds_add_rtn_u32 v122, v122, v3 offset:0
    v_and_b32 v123, 0xffff, v70
    ds_add_rtn_u32 v123, v123, v3 offset:0
    v_and_b32 v124, 0xffff, v71
    ds_add_rtn_u32 v124, v124, v3 offset:0
    s_waitcnt lgkmcnt(4)
p1_pb6:
    s_cmp_ge_u32 s29, 1315
    s_cbranch_scc1 p1_k32
    ds_write_b8_d16_hi v117, v64 offset:10496
    v_lshlrev_b32 v64, 2, v117
    ds_write_b32 v64, v28 offset:52480
    ds_write_b8_d16_hi v118, v65 offset:10496
    v_lshlrev_b32 v65, 2, v118
    ds_write_b32 v65, v29 offset:52480
    ds_write_b8_d16_hi v119, v66 offset:10496
    v_lshlrev_b32 v66, 2, v119
    ds_write_b32 v66, v30 offset:52480
    ds_write_b8_d16_hi v120, v67 offset:10496
    v_lshlrev_b32 v67, 2, v120
    ds_write_b32 v67, v31 offset:52480
p1_k32:
    s_cmp_ge_u32 s33, 1536
    s_cbranch_scc1 p1_k33
    s_cmp_lt_u32 s33, 1279
    s_cselect_b32 s14, 102400000, 0
    s_add_u32 s32, s31, 57344
    buffer_load_dwordx2 v[90:91], v2, s[12:15], s32 offen nt
p1_k33:
    s_cmp_lt_u32 s29, 1242
    s_cbranch_scc1 p1_pa7
    s_waitcnt lgkmcnt(0)
    s_branch p1_pb7
p1_pa7:
    v_and_b32 v117, 0xffff, v72
    ds_add_rtn_u32 v117, v117, v3 offset:0
    v_and_b32 v118, 0xffff, v73
    ds_add_rtn_u32 v118, v118, v3 offset:0
    v_and_b32 v119, 0xffff, v74
    ds_add_rtn_u32 v119, v119, v3 offset:0
    v_and_b32 v120, 0xffff, v75
    ds_add_rtn_u32 v120, v120, v3 offset:0
    s_waitcnt lgkmcnt(4)
p1_pb7:
    s_cmp_ge_u32 s29, 1279
    s_cbranch_scc1 p1_k34
    ds_write_b8_d16_hi v121, v68 offset:10496
    v_lshlrev_b32 v68, 2, v121
    ds_write_b32 v68, v32 offset:52480
    ds_write_b8_d16_hi v122, v69 offset:10496
    v_lshlrev_b32 v69, 2, v122
    ds_write_b32 v69, v33 offset:52480
    ds_write_b8_d16_hi v123, v70 offset:10496
    v_lshlrev_b32 v70, 2, v123
    ds_write_b32 v70, v34 offset:52480
    ds_write_b8_d16_hi v124, v71 offset:10496
    v_lshlrev_b32 v71, 2, v124
    ds_write_b32 v71, v35 offset:52480
p1_k34:
    s_cmp_ge_u32 s33, 1536
    s_cbranch_scc1 p1_k35
    s_cmp_lt_u32 s33, 1242
    s_cselect_b32 s14, 102400000, 0
    s_add_u32 s32, s31, 65536
    buffer_load_dwordx2 v[92:93], v2, s[12:15], s32 offen nt
p1_k35:
    s_waitcnt lgkmcnt(0)
    s_cmp_ge_u32 s29, 1242
    s_cbranch_scc1 p1_k36
    ds_write_b8_d16_hi v117, v72 offset:10496
    v_lshlrev_b32 v72, 2, v117
    ds_write_b32 v72, v36 offset:52480
    ds_write_b8_d16_hi v118, v73 offset:10496
    v_lshlrev_b32 v73, 2, v118
    ds_write_b32 v73, v37 offset:52480
    ds_write_b8_d16_hi v119, v74 offset:10496
    v_lshlrev_b32 v74, 2, v119
    ds_write_b32 v74, v38 offset:52480
    ds_write_b8_d16_hi v120, v75 offset:10496
    v_lshlrev_b32 v75, 2, v120
    ds_write_b32 v75, v39 offset:52480
p1_k36:
    s_cmp_eq_u32 s68, 0
    s_cbranch_scc1 p1_sg
    s_cmp_lt_u32 s33, 1536
    s_cbranch_scc1 p1_w37
    s_waitcnt vmcnt(0)
p1_w37:
    s_waitcnt vmcnt(8)
    v_bfe_u32 v127, v127, s53, 4
    v_mov_b32 v125, 0
    s_mov_b64 exec, 1
    ds_write_b32 v125, v127 offset:10452
    s_mov_b64 exec, -1
p1_sg:
    s_cmp_lt_u32 s33, 1536
    s_cbranch_scc1 p1_f1
    s_cmp_lg_u32 s28, 15
    s_cbranch_scc1 p1_hv1
    s_waitcnt vmcnt(0)
    v_bfe_u32 v127, v127, s58, 4
    v_mov_b32 v125, 0
    s_mov_b64 exec, 1
    ds_write_b32 v125, v127 offset:10448
    s_mov_b64 exec, -1
p1_hv1:
    s_cmp_ge_u32 s33, 1656
    s_cbranch_scc1 p1_f1
    s_sub_u32 s52, s33, 1536
    s_mul_i32 s53, s52, 53760
    s_add_u32 s53, s53, 485810176
    s_mul_i32 s54, s28, 3072
    v_lshl_add_u32 v93, v92, 4, s54
    s_lshl_b32 s54, s28, 9
    s_add_u32 s54, s54, 49152
    s_cmp_lt_u32 s28, 9
    s_cselect_b32 s54, s54, 0x40000000
    v_lshl_add_u32 v94, v92, 3, s54
    v_mov_b32 v96, 0
    v_mov_b32 v97, 0
    s_waitcnt vmcnt(0)
    buffer_store_dwordx4 v[76:79], v93, s[16:19], s53 offen offset:0
    buffer_store_dwordx4 v[80:83], v93, s[16:19], s53 offen offset:1024
    buffer_store_dwordx4 v[84:87], v93, s[16:19], s53 offen offset:2048
    buffer_store_dwordx2 v[88:89], v94, s[16:19], s53 offen
    v_and_b32 v98, 0x7fff7fff, v76
    v_pk_max_u16 v96, v96, v98
    v_lshlrev_b32 v99, 16, v98
    v_and_b32 v98, 0xffff0000, v98
    v_fmac_f32 v97, v99, v99
    v_fmac_f32 v97, v98, v98
    v_and_b32 v98, 0x7fff7fff, v77
    v_pk_max_u16 v96, v96, v98
    v_lshlrev_b32 v99, 16, v98
    v_and_b32 v98, 0xffff0000, v98
    v_fmac_f32 v97, v99, v99
    v_fmac_f32 v97, v98, v98
    v_and_b32 v98, 0x7fff7fff, v78
    v_pk_max_u16 v96, v96, v98
    v_lshlrev_b32 v99, 16, v98
    v_and_b32 v98, 0xffff0000, v98
    v_fmac_f32 v97, v99, v99
    v_fmac_f32 v97, v98, v98
    v_and_b32 v98, 0x7fff7fff, v79
    v_pk_max_u16 v96, v96, v98
    v_lshlrev_b32 v99, 16, v98
    v_and_b32 v98, 0xffff0000, v98
    v_fmac_f32 v97, v99, v99
    v_fmac_f32 v97, v98, v98
    v_and_b32 v98, 0x7fff7fff, v80
    v_pk_max_u16 v96, v96, v98
    v_lshlrev_b32 v99, 16, v98
    v_and_b32 v98, 0xffff0000, v98
    v_fmac_f32 v97, v99, v99
    v_fmac_f32 v97, v98, v98
    v_and_b32 v98, 0x7fff7fff, v81
    v_pk_max_u16 v96, v96, v98
    v_lshlrev_b32 v99, 16, v98
    v_and_b32 v98, 0xffff0000, v98
    v_fmac_f32 v97, v99, v99
    v_fmac_f32 v97, v98, v98
    v_and_b32 v98, 0x7fff7fff, v82
    v_pk_max_u16 v96, v96, v98
    v_lshlrev_b32 v99, 16, v98
    v_and_b32 v98, 0xffff0000, v98
    v_fmac_f32 v97, v99, v99
    v_fmac_f32 v97, v98, v98
    v_and_b32 v98, 0x7fff7fff, v83
    v_pk_max_u16 v96, v96, v98
    v_lshlrev_b32 v99, 16, v98
    v_and_b32 v98, 0xffff0000, v98
    v_fmac_f32 v97, v99, v99
    v_fmac_f32 v97, v98, v98
    v_and_b32 v98, 0x7fff7fff, v84
    v_pk_max_u16 v96, v96, v98
    v_lshlrev_b32 v99, 16, v98
    v_and_b32 v98, 0xffff0000, v98
    v_fmac_f32 v97, v99, v99
    v_fmac_f32 v97, v98, v98
    v_and_b32 v98, 0x7fff7fff, v85
    v_pk_max_u16 v96, v96, v98
    v_lshlrev_b32 v99, 16, v98
    v_and_b32 v98, 0xffff0000, v98
    v_fmac_f32 v97, v99, v99
    v_fmac_f32 v97, v98, v98
    v_and_b32 v98, 0x7fff7fff, v86
    v_pk_max_u16 v96, v96, v98
    v_lshlrev_b32 v99, 16, v98
    v_and_b32 v98, 0xffff0000, v98
    v_fmac_f32 v97, v99, v99
    v_fmac_f32 v97, v98, v98
    v_and_b32 v98, 0x7fff7fff, v87
    v_pk_max_u16 v96, v96, v98
    v_lshlrev_b32 v99, 16, v98
    v_and_b32 v98, 0xffff0000, v98
    v_fmac_f32 v97, v99, v99
    v_fmac_f32 v97, v98, v98
    v_and_b32 v98, 0x7fff7fff, v88
    v_pk_max_u16 v96, v96, v98
    v_lshlrev_b32 v99, 16, v98
    v_and_b32 v98, 0xffff0000, v98
    v_fmac_f32 v97, v99, v99
    v_fmac_f32 v97, v98, v98
    v_and_b32 v98, 0x7fff7fff, v89
    v_pk_max_u16 v96, v96, v98
    v_lshlrev_b32 v99, 16, v98
    v_and_b32 v98, 0xffff0000, v98
    v_fmac_f32 v97, v99, v99
    v_fmac_f32 v97, v98, v98
    v_lshrrev_b32 v98, 16, v96
    v_and_b32 v96, 0xffff, v96
    v_max_u32 v96, v96, v98
    s_nop 1
    v_max_u32_dpp v96, v96, v96 row_shr:1 row_mask:0xf bank_mask:0xf bound_ctrl:0
    v_add_f32_dpp v97, v97, v97 row_shr:1 row_mask:0xf bank_mask:0xf bound_ctrl:0
    s_nop 0
    v_max_u32_dpp v96, v96, v96 row_shr:2 row_mask:0xf bank_mask:0xf bound_ctrl:0
    v_add_f32_dpp v97, v97, v97 row_shr:2 row_mask:0xf bank_mask:0xf bound_ctrl:0
    s_nop 0
    v_max_u32_dpp v96, v96, v96 row_shr:4 row_mask:0xf bank_mask:0xf bound_ctrl:0
    v_add_f32_dpp v97, v97, v97 row_shr:4 row_mask:0xf bank_mask:0xf bound_ctrl:0
    s_nop 0
    v_max_u32_dpp v96, v96, v96 row_shr:8 row_mask:0xf bank_mask:0xf bound_ctrl:0
    v_add_f32_dpp v97, v97, v97 row_shr:8 row_mask:0xf bank_mask:0xf bound_ctrl:0
    s_nop 0
    v_max_u32_dpp v96, v96, v96 row_bcast:15 row_mask:0xa bank_mask:0xf
    v_add_f32_dpp v97, v97, v97 row_bcast:15 row_mask:0xa bank_mask:0xf
    s_nop 0
    v_max_u32_dpp v96, v96, v96 row_bcast:31 row_mask:0xc bank_mask:0xf
    v_add_f32_dpp v97, v97, v97 row_bcast:31 row_mask:0xc bank_mask:0xf
    s_nop 0
    s_nop 0
    s_lshl_b32 s52, s52, 4
    s_add_u32 s52, s52, s28
    s_lshl_b32 s52, s52, 3
    s_add_u32 s52, s52, 492261376
    s_mov_b64 exec, 1
    s_lshl_b64 exec, exec, 63
    buffer_store_dwordx2 v[96:97], off, s[16:19], s52
    s_mov_b64 exec, -1
p1_f1:
    s_waitcnt lgkmcnt(0)
    s_barrier
    v_mul_u32_u24 v119, 3, v0
    v_and_b32 v118, -4, v119
    v_add_u32 v120, s50, v1
    v_mov_b32 v122, 0
    v_mov_b32 v123, 0
    v_mov_b32 v124, 0
    v_mov_b32 v125, 0
    ds_read_b64 v[126:127], v122 offset:10448
    ds_write_b32 v122, v122 offset:10432
    v_cmp_gt_u32 vcc, 640, v0
    s_and_saveexec_b64 s[52:53], vcc
    ds_write_b128 v1, v[122:125] offset:0
    s_mov_b64 exec, -1
    s_waitcnt lgkmcnt(2)
    v_readfirstlane_b32 s70, v126
    v_readfirstlane_b32 s69, v127
    s_cmp_ge_u32 s33, 1536
    s_cselect_b32 s70, s70, 0
    s_cmp_gt_u32 s28, 10
    s_cselect_b32 s69, 0, s69
    s_cselect_b32 s70, 0, s70
    s_cmp_lg_u32 s70, 8
    s_cbranch_scc1 p1_h0
    s_sub_u32 s52, s33, 1536
    v_and_b32 v102, 63, v0
    s_cmp_eq_u32 s28, 10
    s_cbranch_scc1 p1_tr10
    s_mul_i32 s53, s28, 520
    v_lshl_add_u32 v100, v102, 3, s53
    s_mul_i32 s53, s28, 4160
    v_lshl_add_u32 v101, v102, 4, s53
    s_branch p1_tr20
p1_tr10:
    v_mul_u32_u24 v100, 520, v102
    v_add_u32 v100, 512, v100
    v_mul_u32_u24 v101, 4160, v102
    v_add_u32 v101, 1024, v101
    v_cmp_gt_u32 vcc, 10, v102
    v_mov_b32 v102, 0x40000000
    s_nop 0
    v_cndmask_b32 v100, v102, v100, vcc
    v_cndmask_b32 v101, v102, v101, vcc
p1_tr20:
    s_mul_i32 s52, s52, 41984
    s_add_u32 s52, s52, 469762048
    buffer_load_dwordx2 v[76:77], v100, s[16:19], s52 offen sc1
    s_add_u32 s52, s52, 5248
    buffer_load_dwordx2 v[78:79], v100, s[16:19], s52 offen sc1
    s_add_u32 s52, s52, 5248
    buffer_load_dwordx2 v[80:81], v100, s[16:19], s52 offen sc1
    s_add_u32 s52, s52, 5248
    buffer_load_dwordx2 v[82:83], v100, s[16:19], s52 offen sc1
    s_add_u32 s52, s52, 5248
    buffer_load_dwordx2 v[84:85], v100, s[16:19], s52 offen sc1
    s_add_u32 s52, s52, 5248
    buffer_load_dwordx2 v[86:87], v100, s[16:19], s52 offen sc1
    s_add_u32 s52, s52, 5248
    buffer_load_dwordx2 v[88:89], v100, s[16:19], s52 offen sc1
    s_add_u32 s52, s52, 5248
    buffer_load_dwordx2 v[90:91], v100, s[16:19], s52 offen sc1
    s_add_u32 s52, s52, 5248
p1_h0:
    v_lshlrev_b32 v117, 2, v119
    v_add_u32 v117, 52480, v117
    ds_read_b32 v110, v117 offset:0
    ds_read_b32 v111, v117 offset:4
    ds_read_b32 v112, v117 offset:8
    ds_read_b32 v113, v118 offset:10496
    ds_read_b32 v114, v118 offset:10500
    ds_read_b32 v122, v117 offset:12288
    ds_read_b32 v123, v117 offset:12292
    ds_read_b32 v124, v117 offset:12296
    ds_read_b32 v125, v118 offset:13568
    ds_read_b32 v121, v118 offset:13572
    s_waitcnt lgkmcnt(5)
    v_alignbyte_b32 v113, v114, v113, v119
    buffer_store_dwordx4 v[110:113], v120, s[20:23], 0 offen
    v_add_u32 v120, 33554432, v120
    s_nop 0
    ds_read_b32 v110, v117 offset:24576
    ds_read_b32 v111, v117 offset:24580
    ds_read_b32 v112, v117 offset:24584
    ds_read_b32 v113, v118 offset:16640
    ds_read_b32 v114, v118 offset:16644
    s_cmp_le_u32 s35, 1024
    s_cbranch_scc1 p1_ce0
    s_waitcnt lgkmcnt(5)
    v_alignbyte_b32 v125, v121, v125, v119
    buffer_store_dwordx4 v[122:125], v120, s[20:23], 0 offen
    v_add_u32 v120, 33554432, v120
    s_nop 0
    ds_read_b32 v122, v117 offset:36864
    ds_read_b32 v123, v117 offset:36868
    ds_read_b32 v124, v117 offset:36872
    ds_read_b32 v125, v118 offset:19712
    ds_read_b32 v121, v118 offset:19716
    s_cmp_le_u32 s35, 2048
    s_cbranch_scc1 p1_ce0
    s_waitcnt lgkmcnt(5)
    v_alignbyte_b32 v113, v114, v113, v119
    buffer_store_dwordx4 v[110:113], v120, s[20:23], 0 offen
    v_add_u32 v120, 33554432, v120
    s_nop 0
    ds_read_b32 v110, v117 offset:49152
    ds_read_b32 v111, v117 offset:49156
    ds_read_b32 v112, v117 offset:49160
    ds_read_b32 v113, v118 offset:22784
    ds_read_b32 v114, v118 offset:22788
    s_cmp_le_u32 s35, 3072
    s_cbranch_scc1 p1_ce0
    s_waitcnt lgkmcnt(5)
    v_alignbyte_b32 v125, v121, v125, v119
    buffer_store_dwordx4 v[122:125], v120, s[20:23], 0 offen
    v_add_u32 v120, 33554432, v120
    s_nop 0
    v_lshlrev_b32 v117, 2, v119
    v_add_u32 v117, 113920, v117
    ds_read_b32 v122, v117 offset:0
    ds_read_b32 v123, v117 offset:4
    ds_read_b32 v124, v117 offset:8
    ds_read_b32 v125, v118 offset:25856
    ds_read_b32 v121, v118 offset:25860
    s_cmp_le_u32 s35, 4096
    s_cbranch_scc1 p1_ce0
    s_waitcnt lgkmcnt(5)
    v_alignbyte_b32 v113, v114, v113, v119
    buffer_store_dwordx4 v[110:113], v120, s[20:23], 0 offen
    v_add_u32 v120, 33554432, v120
    s_nop 0
    ds_read_b32 v110, v117 offset:12288
    ds_read_b32 v111, v117 offset:12292
    ds_read_b32 v112, v117 offset:12296
    ds_read_b32 v113, v118 offset:28928
    ds_read_b32 v114, v118 offset:28932
    s_cmp_le_u32 s35, 5120
    s_cbranch_scc1 p1_ce0
    s_waitcnt lgkmcnt(5)
    v_alignbyte_b32 v125, v121, v125, v119
    buffer_store_dwordx4 v[122:125], v120, s[20:23], 0 offen
    v_add_u32 v120, 33554432, v120
    s_nop 0
    ds_read_b32 v122, v117 offset:24576
    ds_read_b32 v123, v117 offset:24580
    ds_read_b32 v124, v117 offset:24584
    ds_read_b32 v125, v118 offset:32000
    ds_read_b32 v121, v118 offset:32004
    s_cmp_le_u32 s35, 6144
    s_cbranch_scc1 p1_ce0
    s_waitcnt lgkmcnt(5)
    v_alignbyte_b32 v113, v114, v113, v119
    buffer_store_dwordx4 v[110:113], v120, s[20:23], 0 offen
    v_add_u32 v120, 33554432, v120
    s_nop 0
    ds_read_b32 v110, v117 offset:36864
    ds_read_b32 v111, v117 offset:36868
    ds_read_b32 v112, v117 offset:36872
    ds_read_b32 v113, v118 offset:35072
    ds_read_b32 v114, v118 offset:35076
    s_cmp_le_u32 s35, 7168
    s_cbranch_scc1 p1_ce0
    s_waitcnt lgkmcnt(5)
    v_alignbyte_b32 v125, v121, v125, v119
    buffer_store_dwordx4 v[122:125], v120, s[20:23], 0 offen
    v_add_u32 v120, 33554432, v120
    s_nop 0
    s_cmp_le_u32 s35, 8192
    s_cbranch_scc1 p1_ce0
    s_waitcnt lgkmcnt(0)
    v_alignbyte_b32 v113, v114, v113, v119
    buffer_store_dwordx4 v[110:113], v120, s[20:23], 0 offen nt
    v_add_u32 v120, 33554432, v120
    s_nop 0
p1_ce0:
    s_waitcnt lgkmcnt(0)
    s_cmp_lg_u32 s70, 8
    s_cbranch_scc1 p1_h1
    s_sub_u32 s52, s33, 1536
    s_mul_i32 s52, s52, 41600
    s_add_u32 s52, s52, 477822976
    s_mov_b32 s54, 0x05040100
    s_mov_b32 s55, 0x07060302
    s_waitcnt vmcnt(1)
    v_perm_b32 v92, v78, v76, s54
    v_perm_b32 v93, v82, v80, s54
    v_perm_b32 v94, v86, v84, s54
    v_perm_b32 v95, v90, v88, s54
    buffer_store_dwordx4 v[92:95], v101, s[16:19], s52 offen offset:0
    v_perm_b32 v96, v78, v76, s55
    v_perm_b32 v97, v82, v80, s55
    v_perm_b32 v98, v86, v84, s55
    v_perm_b32 v99, v90, v88, s55
    buffer_store_dwordx4 v[96:99], v101, s[16:19], s52 offen offset:1040
    v_perm_b32 v92, v79, v77, s54
    v_perm_b32 v93, v83, v81, s54
    v_perm_b32 v94, v87, v85, s54
    v_perm_b32 v95, v91, v89, s54
    buffer_store_dwordx4 v[92:95], v101, s[16:19], s52 offen offset:2080
    v_perm_b32 v96, v79, v77, s55
    v_perm_b32 v97, v83, v81, s55
    v_perm_b32 v98, v87, v85, s55
    v_perm_b32 v99, v91, v89, s55
    buffer_store_dwordx4 v[96:99], v101, s[16:19], s52 offen offset:3120
p1_h1:
    s_barrier
    s_cmp_ge_u32 s29, 1462
    s_cbranch_scc1 p1_k38
    s_cmp_le_u32 s35, 9216
    s_cbranch_scc1 p1_s1k2
    v_sub_u32 v48, 221180, v48
    ds_write_b32 v48, v12 offset:52480
    v_sub_u32 v49, 221180, v49
    ds_write_b32 v49, v13 offset:52480
    v_sub_u32 v50, 221180, v50
    ds_write_b32 v50, v14 offset:52480
    v_sub_u32 v51, 221180, v51
    ds_write_b32 v51, v15 offset:52480
p1_s1k2:
p1_k38:
    s_cmp_ge_u32 s33, 1536
    s_cbranch_scc1 p1_k39
    s_cmp_lt_u32 s33, 1462
    s_cselect_b32 s6, 204800000, 0
    s_cselect_b32 s10, 204800000, 0
    s_add_u32 s32, s30, 32768
    buffer_load_dwordx4 v[12:15], v1, s[4:7], s32 offen nt
    buffer_load_dwordx4 v[48:51], v1, s[8:11], s32 offen nt
p1_k39:
    s_cmp_ge_u32 s29, 1426
    s_cbranch_scc1 p1_k40
    s_cmp_le_u32 s35, 9216
    s_cbranch_scc1 p1_s1k3
    v_sub_u32 v52, 221180, v52
    ds_write_b32 v52, v16 offset:52480
    v_sub_u32 v53, 221180, v53
    ds_write_b32 v53, v17 offset:52480
    v_sub_u32 v54, 221180, v54
    ds_write_b32 v54, v18 offset:52480
    v_sub_u32 v55, 221180, v55
    ds_write_b32 v55, v19 offset:52480
p1_s1k3:
p1_k40:
    s_cmp_ge_u32 s29, 1389
    s_cbranch_scc1 p1_k41
    s_cmp_le_u32 s35, 9216
    s_cbranch_scc1 p1_s1k4
    v_sub_u32 v56, 221180, v56
    ds_write_b32 v56, v20 offset:52480
    v_sub_u32 v57, 221180, v57
    ds_write_b32 v57, v21 offset:52480
    v_sub_u32 v58, 221180, v58
    ds_write_b32 v58, v22 offset:52480
    v_sub_u32 v59, 221180, v59
    ds_write_b32 v59, v23 offset:52480
p1_s1k4:
p1_k41:
    s_cmp_ge_u32 s29, 1352
    s_cbranch_scc1 p1_k42
    s_cmp_le_u32 s35, 9216
    s_cbranch_scc1 p1_s1k5
    v_sub_u32 v60, 221180, v60
    ds_write_b32 v60, v24 offset:52480
    v_sub_u32 v61, 221180, v61
    ds_write_b32 v61, v25 offset:52480
    v_sub_u32 v62, 221180, v62
    ds_write_b32 v62, v26 offset:52480
    v_sub_u32 v63, 221180, v63
    ds_write_b32 v63, v27 offset:52480
p1_s1k5:
p1_k42:
    s_cmp_ge_u32 s29, 1315
    s_cbranch_scc1 p1_k43
    s_cmp_le_u32 s35, 9216
    s_cbranch_scc1 p1_s1k6
    v_sub_u32 v64, 221180, v64
    ds_write_b32 v64, v28 offset:52480
    v_sub_u32 v65, 221180, v65
    ds_write_b32 v65, v29 offset:52480
    v_sub_u32 v66, 221180, v66
    ds_write_b32 v66, v30 offset:52480
    v_sub_u32 v67, 221180, v67
    ds_write_b32 v67, v31 offset:52480
p1_s1k6:
p1_k43:
    s_cmp_ge_u32 s29, 1279
    s_cbranch_scc1 p1_k44
    s_cmp_le_u32 s35, 9216
    s_cbranch_scc1 p1_s1k7
    v_sub_u32 v68, 221180, v68
    ds_write_b32 v68, v32 offset:52480
    v_sub_u32 v69, 221180, v69
    ds_write_b32 v69, v33 offset:52480
    v_sub_u32 v70, 221180, v70
    ds_write_b32 v70, v34 offset:52480
    v_sub_u32 v71, 221180, v71
    ds_write_b32 v71, v35 offset:52480
p1_s1k7:
p1_k44:
    s_cmp_ge_u32 s29, 1242
    s_cbranch_scc1 p1_k45
    s_cmp_le_u32 s35, 9216
    s_cbranch_scc1 p1_s1k8
    v_sub_u32 v72, 221180, v72
    ds_write_b32 v72, v36 offset:52480
    v_sub_u32 v73, 221180, v73
    ds_write_b32 v73, v37 offset:52480
    v_sub_u32 v74, 221180, v74
    ds_write_b32 v74, v38 offset:52480
    v_sub_u32 v75, 221180, v75
    ds_write_b32 v75, v39 offset:52480
p1_s1k8:
p1_k45:
    s_cmp_le_u32 s35, 9216
    s_cbranch_scc1 p1_s1k0
    v_sub_u32 v40, 221180, v40
    ds_write_b32 v40, v4 offset:52480
    v_sub_u32 v41, 221180, v41
    ds_write_b32 v41, v5 offset:52480
    v_sub_u32 v42, 221180, v42
    ds_write_b32 v42, v6 offset:52480
    v_sub_u32 v43, 221180, v43
    ds_write_b32 v43, v7 offset:52480
p1_s1k0:
    s_cmp_ge_u32 s29, 1499
    s_cbranch_scc1 p1_k46
    s_cmp_le_u32 s35, 9216
    s_cbranch_scc1 p1_s1k1
    v_sub_u32 v44, 221180, v44
    ds_write_b32 v44, v8 offset:52480
    v_sub_u32 v45, 221180, v45
    ds_write_b32 v45, v9 offset:52480
    v_sub_u32 v46, 221180, v46
    ds_write_b32 v46, v10 offset:52480
    v_sub_u32 v47, 221180, v47
    ds_write_b32 v47, v11 offset:52480
p1_s1k1:
p1_k46:
    s_cmp_lg_u32 s69, 8
    s_cbranch_scc1 p1_o1
    s_lshr_b32 s52, s29, 3
    v_and_b32 v74, 63, v0
    s_cmp_eq_u32 s28, 10
    s_cbranch_scc1 p1_tr11
    s_mul_i32 s53, s28, 520
    v_lshl_add_u32 v72, v74, 3, s53
    s_mul_i32 s53, s28, 4160
    v_lshl_add_u32 v73, v74, 4, s53
    s_branch p1_tr21
p1_tr11:
    v_mul_u32_u24 v72, 520, v74
    v_add_u32 v72, 512, v72
    v_mul_u32_u24 v73, 4160, v74
    v_add_u32 v73, 1024, v73
    v_cmp_gt_u32 vcc, 10, v74
    v_mov_b32 v74, 0x40000000
    s_nop 0
    v_cndmask_b32 v72, v74, v72, vcc
    v_cndmask_b32 v73, v74, v73, vcc
p1_tr21:
    s_mul_i32 s52, s52, 41984
    s_add_u32 s52, s52, 469762048
    buffer_load_dwordx2 v[24:25], v72, s[16:19], s52 offen sc1
    s_add_u32 s52, s52, 5248
    buffer_load_dwordx2 v[26:27], v72, s[16:19], s52 offen sc1
    s_add_u32 s52, s52, 5248
    buffer_load_dwordx2 v[28:29], v72, s[16:19], s52 offen sc1
    s_add_u32 s52, s52, 5248
    buffer_load_dwordx2 v[30:31], v72, s[16:19], s52 offen sc1
    s_add_u32 s52, s52, 5248
    buffer_load_dwordx2 v[32:33], v72, s[16:19], s52 offen sc1
    s_add_u32 s52, s52, 5248
    buffer_load_dwordx2 v[34:35], v72, s[16:19], s52 offen sc1
    s_add_u32 s52, s52, 5248
    buffer_load_dwordx2 v[36:37], v72, s[16:19], s52 offen sc1
    s_add_u32 s52, s52, 5248
    buffer_load_dwordx2 v[38:39], v72, s[16:19], s52 offen sc1
    s_add_u32 s52, s52, 5248
    s_cmp_ge_u32 s33, 1536
    s_cbranch_scc1 p1_o1
    s_lshr_b32 s52, s29, 3
    s_mul_i32 s52, s52, 41600
    s_add_u32 s52, s52, 477822976
    s_mov_b32 s54, 0x05040100
    s_mov_b32 s55, 0x07060302
    s_waitcnt vmcnt(0)
    v_perm_b32 v64, v26, v24, s54
    v_perm_b32 v65, v30, v28, s54
    v_perm_b32 v66, v34, v32, s54
    v_perm_b32 v67, v38, v36, s54
    buffer_store_dwordx4 v[64:67], v73, s[16:19], s52 offen offset:0
    v_perm_b32 v68, v26, v24, s55
    v_perm_b32 v69, v30, v28, s55
    v_perm_b32 v70, v34, v32, s55
    v_perm_b32 v71, v38, v36, s55
    buffer_store_dwordx4 v[68:71], v73, s[16:19], s52 offen offset:1040
    v_perm_b32 v64, v27, v25, s54
    v_perm_b32 v65, v31, v29, s54
    v_perm_b32 v66, v35, v33, s54
    v_perm_b32 v67, v39, v37, s54
    buffer_store_dwordx4 v[64:67], v73, s[16:19], s52 offen offset:2080
    v_perm_b32 v68, v27, v25, s55
    v_perm_b32 v69, v31, v29, s55
    v_perm_b32 v70, v35, v33, s55
    v_perm_b32 v71, v39, v37, s55
    buffer_store_dwordx4 v[68:71], v73, s[16:19], s52 offen offset:3120
    s_mov_b32 s69, 0
p1_o1:
    s_waitcnt lgkmcnt(0)
    s_barrier
    s_cmp_le_u32 s35, 9216
    s_cbranch_scc1 p1_ce1
    v_lshlrev_b32 v117, 2, v119
    v_sub_u32 v117, 113908, v117
    ds_read_b32 v122, v117 offset:49160
    ds_read_b32 v123, v117 offset:49156
    ds_read_b32 v124, v117 offset:49152
    ds_read_b32 v125, v118 offset:38144
    ds_read_b32 v121, v118 offset:38148
    ds_read_b32 v110, v117 offset:36872
    ds_read_b32 v111, v117 offset:36868
    ds_read_b32 v112, v117 offset:36864
    ds_read_b32 v113, v118 offset:41216
    ds_read_b32 v114, v118 offset:41220
    s_waitcnt lgkmcnt(5)
    v_alignbyte_b32 v125, v121, v125, v119
    buffer_store_dwordx4 v[122:125], v120, s[20:23], 0 offen nt
    v_add_u32 v120, 33554432, v120
    s_nop 0
    ds_read_b32 v122, v117 offset:24584
    ds_read_b32 v123, v117 offset:24580
    ds_read_b32 v124, v117 offset:24576
    ds_read_b32 v125, v118 offset:44288
    ds_read_b32 v121, v118 offset:44292
    s_cmp_le_u32 s35, 10240
    s_cbranch_scc1 p1_ce1
    s_waitcnt lgkmcnt(5)
    v_alignbyte_b32 v113, v114, v113, v119
    buffer_store_dwordx4 v[110:113], v120, s[20:23], 0 offen nt
    v_add_u32 v120, 33554432, v120
    s_nop 0
    ds_read_b32 v110, v117 offset:12296
    ds_read_b32 v111, v117 offset:12292
    ds_read_b32 v112, v117 offset:12288
    ds_read_b32 v113, v118 offset:47360
    ds_read_b32 v114, v118 offset:47364
    s_cmp_le_u32 s35, 11264
    s_cbranch_scc1 p1_ce1
    s_waitcnt lgkmcnt(5)
    v_alignbyte_b32 v125, v121, v125, v119
    buffer_store_dwordx4 v[122:125], v120, s[20:23], 0 offen nt
    v_add_u32 v120, 33554432, v120
    s_nop 0
    ds_read_b32 v122, v117 offset:8
    ds_read_b32 v123, v117 offset:4
    ds_read_b32 v124, v117 offset:0
    ds_read_b32 v125, v118 offset:50432
    ds_read_b32 v121, v118 offset:50436
    s_cmp_le_u32 s35, 12288
    s_cbranch_scc1 p1_ce1
    s_waitcnt lgkmcnt(5)
    v_alignbyte_b32 v113, v114, v113, v119
    buffer_store_dwordx4 v[110:113], v120, s[20:23], 0 offen nt
    v_add_u32 v120, 33554432, v120
    s_nop 0
    s_cmp_le_u32 s35, 13312
    s_cbranch_scc1 p1_ce1
    s_waitcnt lgkmcnt(0)
    v_alignbyte_b32 v125, v121, v125, v119
    buffer_store_dwordx4 v[122:125], v120, s[20:23], 0 offen nt
    v_add_u32 v120, 33554432, v120
    s_nop 0
p1_ce1:
    s_waitcnt lgkmcnt(0)
    s_cmp_lg_u32 s69, 8
    s_cbranch_scc1 p1_o2
    s_lshr_b32 s52, s29, 3
    s_mul_i32 s52, s52, 41600
    s_add_u32 s52, s52, 477822976
    s_mov_b32 s54, 0x05040100
    s_mov_b32 s55, 0x07060302
    s_waitcnt vmcnt(0)
    v_perm_b32 v64, v26, v24, s54
    v_perm_b32 v65, v30, v28, s54
    v_perm_b32 v66, v34, v32, s54
    v_perm_b32 v67, v38, v36, s54
    buffer_store_dwordx4 v[64:67], v73, s[16:19], s52 offen offset:0
    v_perm_b32 v68, v26, v24, s55
    v_perm_b32 v69, v30, v28, s55
    v_perm_b32 v70, v34, v32, s55
    v_perm_b32 v71, v38, v36, s55
    buffer_store_dwordx4 v[68:71], v73, s[16:19], s52 offen offset:1040
    v_perm_b32 v64, v27, v25, s54
    v_perm_b32 v65, v31, v29, s54
    v_perm_b32 v66, v35, v33, s54
    v_perm_b32 v67, v39, v37, s54
    buffer_store_dwordx4 v[64:67], v73, s[16:19], s52 offen offset:2080
    v_perm_b32 v68, v27, v25, s55
    v_perm_b32 v69, v31, v29, s55
    v_perm_b32 v70, v35, v33, s55
    v_perm_b32 v71, v39, v37, s55
    buffer_store_dwordx4 v[68:71], v73, s[16:19], s52 offen offset:3120
p1_o2:
    s_barrier
    s_mov_b32 s29, s33
    s_cmp_lt_u32 s29, 1242
    s_cselect_b32 s34, 1, 0
    s_cmp_lt_u32 s29, 1536
    s_cbranch_scc1 p1_tile
p1_end:
    s_endpgm
.globl p2_kernel
.p2align 8
.type p2_kernel,@function
p2_kernel:
    s_cmp_ge_u32 s2, 256
    s_cbranch_scc1 p2_end
    s_load_dwordx2 s[8:9], s[0:1], 104
    v_and_b32 v112, 63, v0
    v_lshrrev_b32 v122, 6, v0
    v_lshlrev_b32 v112, 4, v112
    v_readfirstlane_b32 s10, v122
    v_mov_b32 v113, 0x83ff0000
    s_and_b32 s44, s2, 7
    s_lshr_b32 s11, s44, 1
    s_and_b32 s44, s44, 1
    s_lshl_b32 s12, s44, 5
    s_lshr_b32 s44, s2, 3
    s_add_u32 s12, s12, s44
    s_mov_b32 s25, 54272
    s_mov_b32 s31, 67175170
    s_mov_b32 s32, 83952386
    s_mov_b32 s33, 100729602
    s_mov_b32 s21, 0
    s_mul_i32 s23, s10, 3072
    s_lshl_b32 s24, s10, 9
    s_lshl_b32 s64, s10, 10
    s_sub_u32 s42, s24, s23
    s_add_u32 s42, s42, 49152
    s_movk_i32 s63, 2048
    s_mul_i32 s62, s11, 161280
    s_add_u32 s62, s62, 485810176
    s_add_u32 s62, s62, s23
    s_mov_b32 s40, 477822976
    s_mul_i32 s44, s11, 1040
    s_add_u32 s40, s40, s44
    s_lshl_b32 s44, s12, 4
    s_add_u32 s40, s40, s44
    s_waitcnt lgkmcnt(0)
    s_mov_b32 s4, s8
    s_and_b32 s5, s9, 0xffff
    s_mov_b32 s6, 819200000
    s_mov_b32 s7, 0x20000
    s_mov_b32 s68, s8
    s_and_b32 s69, s9, 0xffff
    s_mov_b32 s70, 469762048
    s_mov_b32 s71, 0x20000
    s_and_b32 s44, s2, 7
    s_lshl_b32 s44, s44, 2
    s_lshr_b32 s18, 0x00000000, s44
    s_and_b32 s18, s18, 15
p2_restart:
    s_mov_b32 s61, 0
    s_add_u32 s44, s61, s18
    s_cmp_ge_u32 s44, 10
    s_cselect_b32 s53, 10, 0
    s_sub_u32 s44, s44, s53
    s_mul_i32 s44, s44, 4160
    s_add_u32 s44, s44, s40
    v_bfe_i32 v111, v112, 6, 1
    v_lshrrev_b32 v110, 6, v112
    v_bitop3_b32 v111, v111, 15, s10 bitop3:0x6a
    v_lshl_or_b32 v110, v110, 4, v111
    v_bfe_u32 v111, v112, 2, 4
    v_mul_u32_u24 v110, 41600, v110
    v_add_u32 v111, v110, v111
    v_add_u32 v110, 256, v112
    v_and_b32 v110, 0x400, v110
    v_lshl_or_b32 v111, v110, 20, v111
    buffer_load_dword v110, v111, s[4:7], s44 offen
    buffer_load_dword v111, v111, s[4:7], s44 offen offset:16
    s_mov_b32 s61, 1
    s_add_u32 s44, s61, s18
    s_cmp_ge_u32 s44, 10
    s_cselect_b32 s53, 10, 0
    s_sub_u32 s44, s44, s53
    s_mul_i32 s44, s44, 4160
    s_add_u32 s44, s44, s40
    v_bfe_i32 v69, v112, 6, 1
    v_lshrrev_b32 v68, 6, v112
    v_bitop3_b32 v69, v69, 15, s10 bitop3:0x6a
    v_lshl_or_b32 v68, v68, 4, v69
    v_bfe_u32 v69, v112, 2, 4
    v_mul_u32_u24 v68, 41600, v68
    v_add_u32 v69, v68, v69
    v_add_u32 v68, 256, v112
    v_and_b32 v68, 0x400, v68
    v_lshl_or_b32 v69, v68, 20, v69
    buffer_load_dword v68, v69, s[4:7], s44 offen
    buffer_load_dword v69, v69, s[4:7], s44 offen offset:16
    s_mov_b32 s61, 0
    s_cmp_lt_u32 s10, 15
    s_cselect_b32 s44, s64, 0x40000000
    v_add_u32 v60, s44, v112
    s_mov_b32 s44, 492261376
    buffer_load_dwordx4 v[60:63], v60, s[4:7], s44 offen
    s_mul_i32 s20, s18, 645120
    s_add_u32 s20, s20, s62
    s_cmp_ge_u32 s10, 9
    s_cbranch_scc1 p2_nmp
    v_lshrrev_b32 v84, 1, v112
    s_add_u32 s44, s20, s42
    buffer_load_dwordx2 v[84:85], v84, s[4:7], s44 offen
p2_nmp:
    buffer_load_dwordx4 v[72:75], v112, s[4:7], s20 offen offset:0
    buffer_load_dwordx4 v[76:79], v112, s[4:7], s20 offen offset:1024
    buffer_load_dwordx4 v[80:83], v112, s[4:7], s20 offen offset:2048
    s_barrier
    v_mov_b32 v115, 0
    v_mov_b32 v116, 0
    v_mov_b32 v117, 0
    v_mov_b32 v118, 0
    v_mov_b32 v119, 0
    v_mov_b32 v120, 0
    v_mov_b32 v121, 0
    ds_write_b128 v115, v[116:119] offset:53760
    s_mov_b32 s19, 0
    s_cmp_eq_u32 s21, 2
    s_cselect_b64 s[66:67], -1, 0
    s_waitcnt lgkmcnt(0)
    s_barrier
    s_waitcnt vmcnt(6)
    s_mov_b32 m0, s23
    v_mov_b32 v53, 0x3c000
    s_movk_i32 s44, 512
    v_sub_u32_sdwa v4, v111, v110 dst_sel:DWORD dst_unused:UNUSED_PAD src0_sel:WORD_0 src1_sel:WORD_0
    v_sub_u32_sdwa v5, v111, v110 dst_sel:DWORD dst_unused:UNUSED_PAD src0_sel:WORD_1 src1_sel:WORD_1
    v_med3_i32 v4, v4, 0, s44
    v_med3_i32 v5, v5, 0, s44
    v_add_u32 v48, v4, v5
    ds_write_addtid_b32 v53 offset:0
    ds_write_addtid_b32 v53 offset:256
    ds_write_addtid_b32 v53 offset:512
    ds_write_addtid_b32 v53 offset:768
    ds_write_addtid_b32 v53 offset:1024
    ds_write_addtid_b32 v53 offset:1280
    ds_write_addtid_b32 v53 offset:1536
    ds_write_addtid_b32 v53 offset:1792
    v_bfe_i32 v53, v112, 6, 1
    v_lshrrev_b32 v49, 6, v112
    v_bitop3_b32 v53, v53, 15, s10 bitop3:0x6a
    v_lshl_or_b32 v49, v49, 4, v53
    v_and_b32 v53, 0x30, v112
    v_lshl_or_b32 v53, v49, 6, v53
    v_lshlrev_b32 v53, 15, v53
    s_nop 1
    v_add_u32_dpp v48, v48, v48 row_shr:1 row_mask:0xf bank_mask:0xf bound_ctrl:0
    s_nop 1
    v_add_u32_dpp v48, v48, v48 row_shr:2 row_mask:0xf bank_mask:0xf bound_ctrl:0
    s_nop 1
    v_add_u32_dpp v48, v48, v48 row_shr:4 row_mask:0xf bank_mask:0xf bound_ctrl:0
    s_nop 1
    v_add_u32_dpp v48, v48, v48 row_shr:8 row_mask:0xf bank_mask:0xf bound_ctrl:0
    s_nop 1
    v_add_u32_dpp v48, v48, v48 row_bcast:15 row_mask:0xa bank_mask:0xf
    s_nop 1
    v_add_u32_dpp v48, v48, v48 row_bcast:31 row_mask:0xc bank_mask:0xf
    s_nop 1
    s_nop 0
    v_readlane_b32 s38, v48, 63
    v_sub_u32 v50, v48, v5
    v_sub_u32 v49, v50, v4
    v_sub_u32 v10, 512, v49
    v_mad_u32_u16 v51, v110, 16, v53
    v_med3_i32 v10, v10, 0, v4
    v_lshl_add_u32 v49, v49, 2, s23
    v_sub_u32 v11, 512, v50
    v_mad_u32_u16 v52, v110, 16, v53 op_sel:[1,0,0,0]
    v_med3_i32 v11, v11, 0, v5
    v_lshl_add_u32 v50, v50, 2, s23
    v_lshl_add_u32 v48, v11, 16, v10
    v_add_u32 v52, 262144, v52
    v_add_u32 v110, v110, v48
    s_min_u32 s17, s38, 512
    s_add_u32 s17, s17, 63
    s_lshr_b32 s17, s17, 6
p2_xa_0:
    v_cmpx_lt_i32 vcc, 0, v10
    s_cbranch_execz p2_ya_0
    ds_write_b32 v49, v51 offset:0
    v_add_u32 v51, 16, v51
    v_cmpx_lt_i32 vcc, 1, v10
    s_cbranch_execz p2_ya_0
    ds_write_b32 v49, v51 offset:4
    v_add_u32 v51, 16, v51
    v_cmpx_lt_i32 vcc, 2, v10
    s_cbranch_execz p2_ya_0
    ds_write_b32 v49, v51 offset:8
    v_add_u32 v51, 16, v51
    v_cmpx_lt_i32 vcc, 3, v10
    s_cbranch_execz p2_ya_0
    ds_write_b32 v49, v51 offset:12
    v_add_u32 v51, 16, v51
    v_cmpx_lt_i32 vcc, 4, v10
    s_cbranch_execz p2_ya_0
    ds_write_b32 v49, v51 offset:16
    v_add_u32 v51, 16, v51
    v_cmpx_lt_i32 vcc, 5, v10
    s_cbranch_execz p2_ya_0
    ds_write_b32 v49, v51 offset:20
    v_add_u32 v51, 16, v51
    v_cmpx_lt_i32 vcc, 6, v10
    s_cbranch_execz p2_ya_0
    ds_write_b32 v49, v51 offset:24
    v_add_u32 v51, 16, v51
    v_cmpx_lt_i32 vcc, 7, v10
    s_cbranch_execz p2_ya_0
    ds_write_b32 v49, v51 offset:28
    v_add_u32 v51, 16, v51
    v_subrev_u32 v10, 8, v10
    v_add_u32 v49, 32, v49
    s_branch p2_xa_0
p2_ya_0:
    s_mov_b64 exec, -1
p2_xa_1:
    v_cmpx_lt_i32 vcc, 0, v11
    s_cbranch_execz p2_ya_1
    ds_write_b32 v50, v52 offset:0
    v_add_u32 v52, 16, v52
    v_cmpx_lt_i32 vcc, 1, v11
    s_cbranch_execz p2_ya_1
    ds_write_b32 v50, v52 offset:4
    v_add_u32 v52, 16, v52
    v_cmpx_lt_i32 vcc, 2, v11
    s_cbranch_execz p2_ya_1
    ds_write_b32 v50, v52 offset:8
    v_add_u32 v52, 16, v52
    v_cmpx_lt_i32 vcc, 3, v11
    s_cbranch_execz p2_ya_1
    ds_write_b32 v50, v52 offset:12
    v_add_u32 v52, 16, v52
    v_cmpx_lt_i32 vcc, 4, v11
    s_cbranch_execz p2_ya_1
    ds_write_b32 v50, v52 offset:16
    v_add_u32 v52, 16, v52
    v_cmpx_lt_i32 vcc, 5, v11
    s_cbranch_execz p2_ya_1
    ds_write_b32 v50, v52 offset:20
    v_add_u32 v52, 16, v52
    v_cmpx_lt_i32 vcc, 6, v11
    s_cbranch_execz p2_ya_1
    ds_write_b32 v50, v52 offset:24
    v_add_u32 v52, 16, v52
    v_cmpx_lt_i32 vcc, 7, v11
    s_cbranch_execz p2_ya_1
    ds_write_b32 v50, v52 offset:28
    v_add_u32 v52, 16, v52
    v_subrev_u32 v11, 8, v11
    v_add_u32 v50, 32, v50
    s_branch p2_xa_1
p2_ya_1:
    s_mov_b64 exec, -1
    s_cmp_lt_u32 s38, 512
    s_cbranch_scc1 p2_nomorea
    v_cmp_lt_u32_sdwa s[44:45], v110, v111 src0_sel:WORD_0 src1_sel:WORD_0
    v_cmp_lt_u32_sdwa s[46:47], v110, v111 src0_sel:WORD_1 src1_sel:WORD_1
    s_nop 0
    s_or_b64 s[44:45], s[44:45], s[46:47]
    s_cbranch_scc0 p2_nomorea
    v_mov_b32 v49, s19
    v_mov_b32 v50, 1
    ds_write_b32 v49, v50 offset:53760
p2_nomorea:
    s_mov_b32 m0, s23
    s_nop 0
    ds_read_addtid_b32 v2 offset:0
    ds_read_addtid_b32 v8 offset:256
    ds_read_addtid_b32 v14 offset:512
    ds_read_addtid_b32 v20 offset:768
    ds_read_addtid_b32 v88 offset:1024
    ds_read_addtid_b32 v92 offset:1280
    ds_read_addtid_b32 v96 offset:1536
    ds_read_addtid_b32 v100 offset:1792
    s_waitcnt lgkmcnt(0)
    v_bfe_u32 v0, v2, 14, 4
    v_lshrrev_b32 v1, 18, v2
    v_and_b32 v2, 0x3fff, v2
    v_mad_u32_u24 v0, v0, s63, v1
    v_lshl_or_b32 v2, v0, 14, v2
    buffer_load_dwordx4 v[0:3], v2, s[68:71], 0 offen
    v_bfe_u32 v6, v8, 14, 4
    v_lshrrev_b32 v7, 18, v8
    v_and_b32 v8, 0x3fff, v8
    v_mad_u32_u24 v6, v6, s63, v7
    v_lshl_or_b32 v8, v6, 14, v8
    buffer_load_dwordx4 v[6:9], v8, s[68:71], 0 offen
    s_cmp_eq_u32 s21, 0
    s_cselect_b32 s44, 1073758208, 0
    v_mov_b32 v124, s44
    v_mov_b32 v125, s44
    v_mov_b32 v126, s44
    v_mov_b32 v127, s44
    v_add_u32 v123, s64, v112
    v_add_u32 v122, s25, v123
    ds_write_b128 v122, v[124:127] offset:0
    ds_write_b128 v122, v[124:127] offset:16384
    ds_write_b128 v122, v[124:127] offset:32768
    v_add_u32 v122, 49152, v122
    ds_write_b128 v122, v[124:127] offset:0
    ds_write_b128 v122, v[124:127] offset:16384
    ds_write_b128 v122, v[124:127] offset:32768
    v_cmpx_gt_u32 vcc, 1792, v123
    ds_write_b128 v122, v[124:127] offset:49152
    s_mov_b64 exec, -1
    v_bfe_u32 v12, v14, 14, 4
    v_lshrrev_b32 v13, 18, v14
    v_and_b32 v14, 0x3fff, v14
    v_mad_u32_u24 v12, v12, s63, v13
    v_lshl_or_b32 v14, v12, 14, v14
    buffer_load_dwordx4 v[12:15], v14, s[68:71], 0 offen
    s_mov_b32 s16, s17
    s_waitcnt vmcnt(6)
    s_cmp_lg_u32 s21, 0
    s_cbranch_scc1 p2_nostat1
    v_max_u32 v60, v60, v62
    v_add_f32 v61, v61, v63
    s_nop 1
    v_max_u32_dpp v60, v60, v60 row_shr:1 row_mask:0xf bank_mask:0xf bound_ctrl:0
    v_add_f32_dpp v61, v61, v61 row_shr:1 row_mask:0xf bank_mask:0xf bound_ctrl:0
    s_nop 0
    v_max_u32_dpp v60, v60, v60 row_shr:2 row_mask:0xf bank_mask:0xf bound_ctrl:0
    v_add_f32_dpp v61, v61, v61 row_shr:2 row_mask:0xf bank_mask:0xf bound_ctrl:0
    s_nop 0
    v_max_u32_dpp v60, v60, v60 row_shr:4 row_mask:0xf bank_mask:0xf bound_ctrl:0
    v_add_f32_dpp v61, v61, v61 row_shr:4 row_mask:0xf bank_mask:0xf bound_ctrl:0
    s_nop 0
    v_max_u32_dpp v60, v60, v60 row_shr:8 row_mask:0xf bank_mask:0xf bound_ctrl:0
    v_add_f32_dpp v61, v61, v61 row_shr:8 row_mask:0xf bank_mask:0xf bound_ctrl:0
    s_nop 0
    v_max_u32_dpp v60, v60, v60 row_bcast:15 row_mask:0xa bank_mask:0xf
    v_add_f32_dpp v61, v61, v61 row_bcast:15 row_mask:0xa bank_mask:0xf
    s_nop 0
    v_max_u32_dpp v60, v60, v60 row_bcast:31 row_mask:0xc bank_mask:0xf
    v_add_f32_dpp v61, v61, v61 row_bcast:31 row_mask:0xc bank_mask:0xf
    s_nop 0
    s_nop 0
    s_lshl_b32 s44, s10, 3
    v_mov_b32 v62, s44
    s_mov_b64 exec, 1
    s_lshl_b64 exec, exec, 63
    ds_write_b64 v62, v[60:61] offset:53824
    s_mov_b64 exec, -1
p2_nostat1:
    s_waitcnt lgkmcnt(0)
    s_barrier
    v_bfe_u32 v18, v20, 14, 4
    v_lshrrev_b32 v19, 18, v20
    v_and_b32 v20, 0x3fff, v20
    v_mad_u32_u24 v18, v18, s63, v19
    v_lshl_or_b32 v20, v18, 14, v20
    buffer_load_dwordx4 v[18:21], v20, s[68:71], 0 offen
    v_mov_b32 v122, s19
    s_xor_b32 s19, s19, 4
    ds_read_b32 v125, v122 offset:53760
    s_cmp_lg_u32 s21, 0
    s_cbranch_scc1 p2_nostat2
    v_bfe_u32 v62, v112, 1, 7
    ds_read_b64 v[60:61], v62 offset:53824
    s_waitcnt lgkmcnt(0)
    s_nop 1
    v_max_u32_dpp v60, v60, v60 row_shr:1 row_mask:0xf bank_mask:0xf bound_ctrl:0
    v_add_f32_dpp v61, v61, v61 row_shr:1 row_mask:0xf bank_mask:0xf bound_ctrl:0
    s_nop 0
    v_max_u32_dpp v60, v60, v60 row_shr:2 row_mask:0xf bank_mask:0xf bound_ctrl:0
    v_add_f32_dpp v61, v61, v61 row_shr:2 row_mask:0xf bank_mask:0xf bound_ctrl:0
    s_nop 0
    v_max_u32_dpp v60, v60, v60 row_shr:4 row_mask:0xf bank_mask:0xf bound_ctrl:0
    v_add_f32_dpp v61, v61, v61 row_shr:4 row_mask:0xf bank_mask:0xf bound_ctrl:0
    s_nop 0
    v_max_u32_dpp v60, v60, v60 row_shr:8 row_mask:0xf bank_mask:0xf bound_ctrl:0
    v_add_f32_dpp v61, v61, v61 row_shr:8 row_mask:0xf bank_mask:0xf bound_ctrl:0
    s_nop 0
    v_max_u32_dpp v60, v60, v60 row_bcast:15 row_mask:0xa bank_mask:0xf
    v_add_f32_dpp v61, v61, v61 row_bcast:15 row_mask:0xa bank_mask:0xf
    s_nop 0
    v_max_u32_dpp v60, v60, v60 row_bcast:31 row_mask:0xc bank_mask:0xf
    v_add_f32_dpp v61, v61, v61 row_bcast:31 row_mask:0xc bank_mask:0xf
    s_nop 0
    s_nop 0
    v_readlane_b32 s44, v60, 15
    v_readlane_b32 s45, v61, 15
    s_nop 1
    s_lshl_b32 s44, s44, 16
    s_lshr_b32 s46, s44, 23
    s_sub_u32 s47, s46, 80
    s_cmp_lt_u32 s47, 100
    s_cselect_b32 s21, 0, 1
    v_mov_b32 v60, s45
    v_mul_f32 v60, 0x34a7c5ac, v60
    v_sqrt_f32 v60, v60
    v_mov_b32 v61, s44
    v_mul_f32 v62, 0x41800000, v60
    v_cmp_nle_f32 vcc, v61, v62
    v_mul_f32 v60, 0x3ac00000, v60
    v_mul_f32 v61, 0x3901742e, v61
    v_max_f32 v60, v60, v61
    s_cmp_lg_u64 vcc, 0
    s_cselect_b32 s21, 1, s21
    v_readfirstlane_b32 s44, v60
    s_nop 0
    s_and_b32 s47, s44, 0x7fffff
    s_or_b32 s47, s47, 0x3f000000
    s_and_b32 s48, s44, 0x7f800000
    s_add_u32 s48, s48, 0x800000
    v_rcp_f32 v60, s47
    s_nop 0
    v_rcp_f32 v61, v60
    v_mul_f32 v60, 0x7b800000, v60
    v_mul_f32 v61, s48, v61
    s_nop 0
    v_readfirstlane_b32 s26, v60
    v_readfirstlane_b32 s30, v61
    s_add_u32 s34, s48, 197132288
    s_mov_b32 s35, s34
    s_sub_u32 s36, 0, s34
    s_subb_u32 s37, 0, s34
    s_cmp_eq_u32 s21, 0
    s_cbranch_scc1 p2_nostat2
    s_waitcnt vmcnt(0) lgkmcnt(0)
    s_branch p2_restart
p2_nostat2:
    s_cmp_eq_u32 s21, 0
    s_cselect_b32 s26, s26, 0x7b800000
    v_mov_b32 v114, s26
    s_waitcnt lgkmcnt(0)
    v_readfirstlane_b32 s44, v125
    s_nop 0
    s_cmp_lg_u32 s44, 0
    s_cbranch_scc1 p2_adva
    s_mov_b32 s61, 1
    v_mov_b32 v110, v68
    v_mov_b32 v111, v69
p2_adva:
    v_bfe_u32 v86, v88, 14, 4
    v_lshrrev_b32 v87, 18, v88
    v_and_b32 v88, 0x3fff, v88
    v_mad_u32_u24 v86, v86, s63, v87
    v_lshl_or_b32 v88, v86, 14, v88
    buffer_load_dwordx4 v[86:89], v88, s[68:71], 0 offen
    s_mov_b32 m0, s23
    v_mov_b32 v53, 0x3c000
    s_movk_i32 s44, 512
    v_sub_u32_sdwa v4, v111, v110 dst_sel:DWORD dst_unused:UNUSED_PAD src0_sel:WORD_0 src1_sel:WORD_0
    v_sub_u32_sdwa v5, v111, v110 dst_sel:DWORD dst_unused:UNUSED_PAD src0_sel:WORD_1 src1_sel:WORD_1
    v_med3_i32 v4, v4, 0, s44
    v_med3_i32 v5, v5, 0, s44
    v_add_u32 v48, v4, v5
    ds_write_addtid_b32 v53 offset:0
    ds_write_addtid_b32 v53 offset:256
    ds_write_addtid_b32 v53 offset:512
    ds_write_addtid_b32 v53 offset:768
    ds_write_addtid_b32 v53 offset:1024
    ds_write_addtid_b32 v53 offset:1280
    ds_write_addtid_b32 v53 offset:1536
    ds_write_addtid_b32 v53 offset:1792
    v_bfe_i32 v53, v112, 6, 1
    v_lshrrev_b32 v49, 6, v112
    v_bitop3_b32 v53, v53, 15, s10 bitop3:0x6a
    v_lshl_or_b32 v49, v49, 4, v53
    v_and_b32 v53, 0x30, v112
    v_lshl_or_b32 v53, v49, 6, v53
    v_lshlrev_b32 v53, 15, v53
    s_nop 1
    v_add_u32_dpp v48, v48, v48 row_shr:1 row_mask:0xf bank_mask:0xf bound_ctrl:0
    s_nop 1
    v_add_u32_dpp v48, v48, v48 row_shr:2 row_mask:0xf bank_mask:0xf bound_ctrl:0
    s_nop 1
    v_add_u32_dpp v48, v48, v48 row_shr:4 row_mask:0xf bank_mask:0xf bound_ctrl:0
    s_nop 1
    v_add_u32_dpp v48, v48, v48 row_shr:8 row_mask:0xf bank_mask:0xf bound_ctrl:0
    s_nop 1
    v_add_u32_dpp v48, v48, v48 row_bcast:15 row_mask:0xa bank_mask:0xf
    s_nop 1
    v_add_u32_dpp v48, v48, v48 row_bcast:31 row_mask:0xc bank_mask:0xf
    s_nop 1
    s_nop 0
    v_readlane_b32 s38, v48, 63
    v_sub_u32 v50, v48, v5
    v_sub_u32 v49, v50, v4
    v_sub_u32 v10, 512, v49
    v_mad_u32_u16 v51, v110, 16, v53
    v_med3_i32 v10, v10, 0, v4
    v_lshl_add_u32 v49, v49, 2, s23
    v_sub_u32 v11, 512, v50
    v_mad_u32_u16 v52, v110, 16, v53 op_sel:[1,0,0,0]
    v_med3_i32 v11, v11, 0, v5
    v_lshl_add_u32 v50, v50, 2, s23
    v_lshl_add_u32 v48, v11, 16, v10
    v_add_u32 v52, 262144, v52
    v_add_u32 v110, v110, v48
    s_min_u32 s17, s38, 512
    s_add_u32 s17, s17, 63
    s_lshr_b32 s17, s17, 6
p2_xb_0:
    v_cmpx_lt_i32 vcc, 0, v10
    s_cbranch_execz p2_yb_0
    ds_write_b32 v49, v51 offset:0
    v_add_u32 v51, 16, v51
    v_cmpx_lt_i32 vcc, 1, v10
    s_cbranch_execz p2_yb_0
    ds_write_b32 v49, v51 offset:4
    v_add_u32 v51, 16, v51
    v_cmpx_lt_i32 vcc, 2, v10
    s_cbranch_execz p2_yb_0
    ds_write_b32 v49, v51 offset:8
    v_add_u32 v51, 16, v51
    v_cmpx_lt_i32 vcc, 3, v10
    s_cbranch_execz p2_yb_0
    ds_write_b32 v49, v51 offset:12
    v_add_u32 v51, 16, v51
    v_cmpx_lt_i32 vcc, 4, v10
    s_cbranch_execz p2_yb_0
    ds_write_b32 v49, v51 offset:16
    v_add_u32 v51, 16, v51
    v_cmpx_lt_i32 vcc, 5, v10
    s_cbranch_execz p2_yb_0
    ds_write_b32 v49, v51 offset:20
    v_add_u32 v51, 16, v51
    v_cmpx_lt_i32 vcc, 6, v10
    s_cbranch_execz p2_yb_0
    ds_write_b32 v49, v51 offset:24
    v_add_u32 v51, 16, v51
    v_cmpx_lt_i32 vcc, 7, v10
    s_cbranch_execz p2_yb_0
    ds_write_b32 v49, v51 offset:28
    v_add_u32 v51, 16, v51
    v_subrev_u32 v10, 8, v10
    v_add_u32 v49, 32, v49
    s_branch p2_xb_0
p2_yb_0:
    s_mov_b64 exec, -1
p2_xb_1:
    v_cmpx_lt_i32 vcc, 0, v11
    s_cbranch_execz p2_yb_1
    ds_write_b32 v50, v52 offset:0
    v_add_u32 v52, 16, v52
    v_cmpx_lt_i32 vcc, 1, v11
    s_cbranch_execz p2_yb_1
    ds_write_b32 v50, v52 offset:4
    v_add_u32 v52, 16, v52
    v_cmpx_lt_i32 vcc, 2, v11
    s_cbranch_execz p2_yb_1
    ds_write_b32 v50, v52 offset:8
    v_add_u32 v52, 16, v52
    v_cmpx_lt_i32 vcc, 3, v11
    s_cbranch_execz p2_yb_1
    ds_write_b32 v50, v52 offset:12
    v_add_u32 v52, 16, v52
    v_cmpx_lt_i32 vcc, 4, v11
    s_cbranch_execz p2_yb_1
    ds_write_b32 v50, v52 offset:16
    v_add_u32 v52, 16, v52
    v_cmpx_lt_i32 vcc, 5, v11
    s_cbranch_execz p2_yb_1
    ds_write_b32 v50, v52 offset:20
    v_add_u32 v52, 16, v52
    v_cmpx_lt_i32 vcc, 6, v11
    s_cbranch_execz p2_yb_1
    ds_write_b32 v50, v52 offset:24
    v_add_u32 v52, 16, v52
    v_cmpx_lt_i32 vcc, 7, v11
    s_cbranch_execz p2_yb_1
    ds_write_b32 v50, v52 offset:28
    v_add_u32 v52, 16, v52
    v_subrev_u32 v11, 8, v11
    v_add_u32 v50, 32, v50
    s_branch p2_xb_1
p2_yb_1:
    s_mov_b64 exec, -1
    s_cmp_lt_u32 s38, 512
    s_cbranch_scc1 p2_nomoreb
    v_cmp_lt_u32_sdwa s[44:45], v110, v111 src0_sel:WORD_0 src1_sel:WORD_0
    v_cmp_lt_u32_sdwa s[46:47], v110, v111 src0_sel:WORD_1 src1_sel:WORD_1
    s_nop 0
    s_or_b64 s[44:45], s[44:45], s[46:47]
    s_cbranch_scc0 p2_nomoreb
    v_mov_b32 v49, s19
    v_mov_b32 v50, 1
    ds_write_b32 v49, v50 offset:53760
p2_nomoreb:
    s_mov_b32 m0, s23
    s_nop 0
    ds_read_addtid_b32 v102 offset:0
    ds_read_addtid_b32 v103 offset:256
    ds_read_addtid_b32 v104 offset:512
    ds_read_addtid_b32 v105 offset:768
    ds_read_addtid_b32 v106 offset:1024
    ds_read_addtid_b32 v107 offset:1280
    ds_read_addtid_b32 v108 offset:1536
    ds_read_addtid_b32 v109 offset:1792
    v_bfe_u32 v90, v92, 14, 4
    v_lshrrev_b32 v91, 18, v92
    v_and_b32 v92, 0x3fff, v92
    v_mad_u32_u24 v90, v90, s63, v91
    v_lshl_or_b32 v92, v90, 14, v92
    buffer_load_dwordx4 v[90:93], v92, s[68:71], 0 offen
    s_waitcnt vmcnt(6)
    s_mov_b32 m0, s24
    s_cmp_ge_u32 s10, 9
    s_cbranch_scc1 p2_stp
    ds_write_addtid_b32 v84 offset:49152
    ds_write_addtid_b32 v85 offset:49408
p2_stp:
    s_mov_b32 m0, s23
    s_add_u32 s20, s20, 53760
    ds_write_addtid_b32 v72 offset:0
    ds_write_addtid_b32 v73 offset:256
    ds_write_addtid_b32 v74 offset:512
    ds_write_addtid_b32 v75 offset:768
    ds_write_addtid_b32 v76 offset:1024
    ds_write_addtid_b32 v77 offset:1280
    ds_write_addtid_b32 v78 offset:1536
    ds_write_addtid_b32 v79 offset:1792
    ds_write_addtid_b32 v80 offset:2048
    ds_write_addtid_b32 v81 offset:2304
    ds_write_addtid_b32 v82 offset:2560
    ds_write_addtid_b32 v83 offset:2816
    s_waitcnt lgkmcnt(0)
    s_barrier
    v_bfe_u32 v94, v96, 14, 4
    v_lshrrev_b32 v95, 18, v96
    v_and_b32 v96, 0x3fff, v96
    v_mad_u32_u24 v94, v94, s63, v95
    v_lshl_or_b32 v96, v94, 14, v96
    buffer_load_dwordx4 v[94:97], v96, s[68:71], 0 offen
    v_bfe_u32 v98, v100, 14, 4
    v_lshrrev_b32 v99, 18, v100
    v_and_b32 v100, 0x3fff, v100
    v_mad_u32_u24 v98, v98, s63, v99
    v_lshl_or_b32 v100, v98, 14, v100
    buffer_load_dwordx4 v[98:101], v100, s[68:71], 0 offen
    s_cmp_ge_u32 s10, 9
    s_cbranch_scc1 p2_nmq
    v_lshrrev_b32 v84, 1, v112
    s_add_u32 s44, s20, s42
    buffer_load_dwordx2 v[84:85], v84, s[4:7], s44 offen
p2_nmq:
    buffer_load_dwordx4 v[72:75], v112, s[4:7], s20 offen offset:0
    buffer_load_dwordx4 v[76:79], v112, s[4:7], s20 offen offset:1024
    buffer_load_dwordx4 v[80:83], v112, s[4:7], s20 offen offset:2048
    s_waitcnt vmcnt(10)
    v_perm_b32 v48, v3, v0, s31
    v_perm_b32 v49, v3, v1, s32
    v_perm_b32 v50, v3, v2, s33
    v_lshlrev_b16 v4, 3, v2
    v_lshlrev_b16 v2, 3, v1
    v_lshlrev_b16 v0, 3, v0
    v_cmpx_ge_u16 vcc, 0x3fff, v48
    ds_read_b64 v[0:1], v0
    s_mov_b64 exec, -1
    v_cmpx_ge_u16 vcc, 0x3fff, v49
    ds_read_b64 v[2:3], v2
    s_mov_b64 exec, -1
    v_cmpx_ge_u16 vcc, 0x3fff, v50
    ds_read_b64 v[4:5], v4
    s_mov_b64 exec, -1
    s_waitcnt vmcnt(9)
    v_perm_b32 v51, v9, v6, s31
    v_perm_b32 v52, v9, v7, s32
    v_perm_b32 v53, v9, v8, s33
    v_lshlrev_b16 v10, 3, v8
    v_lshlrev_b16 v8, 3, v7
    v_lshlrev_b16 v6, 3, v6
    v_cmpx_ge_u16 vcc, 0x3fff, v51
    ds_read_b64 v[6:7], v6
    s_mov_b64 exec, -1
    v_cmpx_ge_u16 vcc, 0x3fff, v52
    ds_read_b64 v[8:9], v8
    s_mov_b64 exec, -1
    v_cmpx_ge_u16 vcc, 0x3fff, v53
    ds_read_b64 v[10:11], v10
    s_mov_b64 exec, -1
    s_waitcnt vmcnt(8)
    v_perm_b32 v54, v15, v12, s31
    v_perm_b32 v55, v15, v13, s32
    v_perm_b32 v56, v15, v14, s33
    v_lshlrev_b16 v16, 3, v14
    v_lshlrev_b16 v14, 3, v13
    v_lshlrev_b16 v12, 3, v12
    v_cmpx_ge_u16 vcc, 0x3fff, v54
    ds_read_b64 v[12:13], v12
    s_mov_b64 exec, -1
    v_cmpx_ge_u16 vcc, 0x3fff, v55
    ds_read_b64 v[14:15], v14
    s_mov_b64 exec, -1
    v_cmpx_ge_u16 vcc, 0x3fff, v56
    ds_read_b64 v[16:17], v16
    s_mov_b64 exec, -1
    s_waitcnt vmcnt(7)
    v_perm_b32 v57, v21, v18, s31
    v_perm_b32 v58, v21, v19, s32
    v_perm_b32 v59, v21, v20, s33
    v_lshlrev_b16 v22, 3, v20
    v_lshlrev_b16 v20, 3, v19
    v_lshlrev_b16 v18, 3, v18
    v_cmpx_ge_u16 vcc, 0x3fff, v57
    ds_read_b64 v[18:19], v18
    s_mov_b64 exec, -1
    v_cmpx_ge_u16 vcc, 0x3fff, v58
    ds_read_b64 v[20:21], v20
    s_mov_b64 exec, -1
    v_cmpx_ge_u16 vcc, 0x3fff, v59
    ds_read_b64 v[22:23], v22
    s_mov_b64 exec, -1
    s_waitcnt vmcnt(6)
    v_perm_b32 v60, v89, v86, s31
    v_perm_b32 v61, v89, v87, s32
    v_perm_b32 v62, v89, v88, s33
    v_lshlrev_b16 v28, 3, v88
    v_lshlrev_b16 v26, 3, v87
    v_lshlrev_b16 v24, 3, v86
    v_cmpx_ge_u16 vcc, 0x3fff, v60
    ds_read_b64 v[24:25], v24
    s_mov_b64 exec, -1
    v_cmpx_ge_u16 vcc, 0x3fff, v61
    ds_read_b64 v[26:27], v26
    s_mov_b64 exec, -1
    v_cmpx_ge_u16 vcc, 0x3fff, v62
    ds_read_b64 v[28:29], v28
    s_mov_b64 exec, -1
    v_bfe_u32 v86, v106, 14, 4
    v_lshrrev_b32 v87, 18, v106
    v_and_b32 v106, 0x3fff, v106
    v_mad_u32_u24 v86, v86, s63, v87
    v_lshl_or_b32 v106, v86, 14, v106
    buffer_load_dwordx4 v[86:89], v106, s[68:71], 0 offen
    s_waitcnt vmcnt(6)
    v_perm_b32 v63, v93, v90, s31
    v_perm_b32 v64, v93, v91, s32
    v_perm_b32 v65, v93, v92, s33
    v_lshlrev_b16 v34, 3, v92
    v_lshlrev_b16 v32, 3, v91
    v_lshlrev_b16 v30, 3, v90
    v_cmpx_ge_u16 vcc, 0x3fff, v63
    ds_read_b64 v[30:31], v30
    s_mov_b64 exec, -1
    v_cmpx_ge_u16 vcc, 0x3fff, v64
    ds_read_b64 v[32:33], v32
    s_mov_b64 exec, -1
    v_cmpx_ge_u16 vcc, 0x3fff, v65
    ds_read_b64 v[34:35], v34
    s_mov_b64 exec, -1
    v_bfe_u32 v90, v107, 14, 4
    v_lshrrev_b32 v91, 18, v107
    v_and_b32 v107, 0x3fff, v107
    v_mad_u32_u24 v90, v90, s63, v91
    v_lshl_or_b32 v107, v90, 14, v107
    buffer_load_dwordx4 v[90:93], v107, s[68:71], 0 offen
    s_waitcnt vmcnt(6)
    v_perm_b32 v66, v97, v94, s31
    v_perm_b32 v67, v97, v95, s32
    v_perm_b32 v68, v97, v96, s33
    v_lshlrev_b16 v40, 3, v96
    v_lshlrev_b16 v38, 3, v95
    v_lshlrev_b16 v36, 3, v94
    v_cmpx_ge_u16 vcc, 0x3fff, v66
    ds_read_b64 v[36:37], v36
    s_mov_b64 exec, -1
    v_cmpx_ge_u16 vcc, 0x3fff, v67
    ds_read_b64 v[38:39], v38
    s_mov_b64 exec, -1
    v_cmpx_ge_u16 vcc, 0x3fff, v68
    ds_read_b64 v[40:41], v40
    s_mov_b64 exec, -1
    s_waitcnt vmcnt(5)
    v_perm_b32 v69, v101, v98, s31
    v_perm_b32 v70, v101, v99, s32
    v_perm_b32 v71, v101, v100, s33
    v_lshlrev_b16 v46, 3, v100
    v_lshlrev_b16 v44, 3, v99
    v_lshlrev_b16 v42, 3, v98
    s_cmp_le_u32 s16, 7
    s_cbranch_scc1 p2_gp
    v_cmpx_ge_u16 vcc, 0x3fff, v69
    ds_read_b64 v[42:43], v42
    s_mov_b64 exec, -1
    v_cmpx_ge_u16 vcc, 0x3fff, v70
    ds_read_b64 v[44:45], v44
    s_mov_b64 exec, -1
    v_cmpx_ge_u16 vcc, 0x3fff, v71
    ds_read_b64 v[46:47], v46
    s_mov_b64 exec, -1
p2_gp:
    s_waitcnt lgkmcnt(0)
    s_barrier
    s_branch p2_tail
p2_top:
    s_cmp_lg_u32 s21, 0
    s_cbranch_scc1 p2_topf
    s_cmp_eq_u32 s60, 10
    s_cbranch_scc1 p2_drain0
    v_cmpx_gt_i16 vcc, 0, v48
    ds_read_b64 v[0:1], v0
    s_mov_b64 exec, -1
    v_cmpx_gt_i16 vcc, 0, v49
    ds_read_b64 v[2:3], v2
    s_mov_b64 exec, -1
    v_cmpx_gt_i16 vcc, 0, v50
    ds_read_b64 v[4:5], v4
    s_mov_b64 exec, -1
    v_cmpx_gt_i16 vcc, 0, v51
    ds_read_b64 v[6:7], v6
    s_mov_b64 exec, -1
    v_cmpx_gt_i16 vcc, 0, v52
    ds_read_b64 v[8:9], v8
    s_mov_b64 exec, -1
    v_cmpx_gt_i16 vcc, 0, v53
    ds_read_b64 v[10:11], v10
    s_mov_b64 exec, -1
    v_cmpx_gt_i16 vcc, 0, v54
    ds_read_b64 v[12:13], v12
    s_mov_b64 exec, -1
    v_cmpx_gt_i16 vcc, 0, v55
    ds_read_b64 v[14:15], v14
    s_mov_b64 exec, -1
    v_cmpx_gt_i16 vcc, 0, v56
    ds_read_b64 v[16:17], v16
    s_mov_b64 exec, -1
    v_cmpx_gt_i16 vcc, 0, v57
    ds_read_b64 v[18:19], v18
    s_mov_b64 exec, -1
    v_cmpx_gt_i16 vcc, 0, v58
    ds_read_b64 v[20:21], v20
    s_mov_b64 exec, -1
    v_cmpx_gt_i16 vcc, 0, v59
    ds_read_b64 v[22:23], v22
    s_mov_b64 exec, -1
    s_cmp_ge_u32 s10, 9
    s_cbranch_scc1 p2_nm0m0a
    v_lshrrev_b32 v84, 1, v112
    s_add_u32 s44, s20, s42
    buffer_load_dwordx2 v[84:85], v84, s[4:7], s44 offen
p2_nm0m0a:
    buffer_load_dwordx4 v[72:75], v112, s[4:7], s20 offen offset:0
    buffer_load_dwordx4 v[76:79], v112, s[4:7], s20 offen offset:1024
    buffer_load_dwordx4 v[80:83], v112, s[4:7], s20 offen offset:2048
    v_cmpx_gt_i16 vcc, 0, v60
    ds_read_b64 v[24:25], v24
    s_mov_b64 exec, -1
    v_cmpx_gt_i16 vcc, 0, v61
    ds_read_b64 v[26:27], v26
    s_mov_b64 exec, -1
    v_cmpx_gt_i16 vcc, 0, v62
    ds_read_b64 v[28:29], v28
    s_mov_b64 exec, -1
    v_cmpx_gt_i16 vcc, 0, v63
    ds_read_b64 v[30:31], v30
    s_mov_b64 exec, -1
    v_cmpx_gt_i16 vcc, 0, v64
    ds_read_b64 v[32:33], v32
    s_mov_b64 exec, -1
    v_cmpx_gt_i16 vcc, 0, v65
    ds_read_b64 v[34:35], v34
    s_mov_b64 exec, -1
    v_cmpx_gt_i16 vcc, 0, v66
    ds_read_b64 v[36:37], v36
    s_mov_b64 exec, -1
    v_cmpx_gt_i16 vcc, 0, v67
    ds_read_b64 v[38:39], v38
    s_mov_b64 exec, -1
    v_cmpx_gt_i16 vcc, 0, v68
    ds_read_b64 v[40:41], v40
    s_mov_b64 exec, -1
    s_cmp_le_u32 s15, 7
    s_cbranch_scc1 p2_g0r27
    v_cmpx_gt_i16 vcc, 0, v69
    ds_read_b64 v[42:43], v42
    s_mov_b64 exec, -1
    v_cmpx_gt_i16 vcc, 0, v70
    ds_read_b64 v[44:45], v44
    s_mov_b64 exec, -1
    v_cmpx_gt_i16 vcc, 0, v71
    ds_read_b64 v[46:47], v46
    s_mov_b64 exec, -1
p2_g0r27:
    s_waitcnt lgkmcnt(15)
    v_ashrrev_i32 v122, 5, v48
    v_lshlrev_b16 v123, 2, v48
    v_lshlrev_b32 v124, 16, v0
    v_bitop3_b32 v122, v122, v113, v113 bitop3:0x0c
    v_and_b32 v125, 0xffff0000, v0
    v_lshlrev_b32 v126, 16, v1
    v_mul_f32 v122, v114, v122
    v_and_b32 v127, 0xffff0000, v1
    v_add_u32 v123, v123, v123
    v_pk_fma_f32 v[124:125], v[124:125], v[122:123], s[34:35] op_sel_hi:[1,0,1]
    v_pk_fma_f32 v[126:127], v[126:127], v[122:123], s[34:35] op_sel_hi:[1,0,1]
    v_lshl_add_u32 v124, v125, 16, v124
    v_lshl_add_u32 v125, v127, 16, v126
    s_waitcnt lgkmcnt(15)
    v_bitop3_b32 v115, v115, v116, v117 bitop3:0xfe
    v_lshl_add_u64 v[124:125], v[124:125], 0, s[36:37]
    v_cmpx_le_u32 vcc, 0x1000000, v48
    ds_add_rtn_u64 v[116:117], v123, v[124:125] offset:54272
    s_mov_b64 exec, -1
    v_ashrrev_i32 v122, 5, v49
    v_lshlrev_b16 v123, 2, v49
    v_lshlrev_b32 v124, 16, v2
    v_bitop3_b32 v122, v122, v113, v113 bitop3:0x0c
    v_and_b32 v125, 0xffff0000, v2
    v_lshlrev_b32 v126, 16, v3
    v_mul_f32 v122, v114, v122
    v_and_b32 v127, 0xffff0000, v3
    v_add_u32 v123, v123, v123
    v_pk_fma_f32 v[124:125], v[124:125], v[122:123], s[34:35] op_sel_hi:[1,0,1]
    v_pk_fma_f32 v[126:127], v[126:127], v[122:123], s[34:35] op_sel_hi:[1,0,1]
    v_lshl_add_u32 v124, v125, 16, v124
    v_lshl_add_u32 v125, v127, 16, v126
    s_waitcnt lgkmcnt(15)
    v_bitop3_b32 v115, v115, v118, v119 bitop3:0xfe
    v_lshl_add_u64 v[124:125], v[124:125], 0, s[36:37]
    v_cmpx_le_u32 vcc, 0x1000000, v49
    ds_add_rtn_u64 v[118:119], v123, v[124:125] offset:54272
    s_mov_b64 exec, -1
    v_ashrrev_i32 v122, 5, v50
    v_lshlrev_b16 v123, 2, v50
    v_lshlrev_b32 v124, 16, v4
    v_bitop3_b32 v122, v122, v113, v113 bitop3:0x0c
    v_and_b32 v125, 0xffff0000, v4
    v_lshlrev_b32 v126, 16, v5
    v_mul_f32 v122, v114, v122
    v_and_b32 v127, 0xffff0000, v5
    v_add_u32 v123, v123, v123
    v_pk_fma_f32 v[124:125], v[124:125], v[122:123], s[34:35] op_sel_hi:[1,0,1]
    v_pk_fma_f32 v[126:127], v[126:127], v[122:123], s[34:35] op_sel_hi:[1,0,1]
    v_lshl_add_u32 v124, v125, 16, v124
    v_lshl_add_u32 v125, v127, 16, v126
    s_waitcnt lgkmcnt(15)
    v_bitop3_b32 v115, v115, v120, v121 bitop3:0xfe
    v_lshl_add_u64 v[124:125], v[124:125], 0, s[36:37]
    v_cmpx_le_u32 vcc, 0x1000000, v50
    ds_add_rtn_u64 v[120:121], v123, v[124:125] offset:54272
    s_mov_b64 exec, -1
    v_bfe_u32 v0, v102, 14, 4
    v_lshrrev_b32 v1, 18, v102
    v_and_b32 v102, 0x3fff, v102
    v_mad_u32_u24 v0, v0, s63, v1
    v_lshl_or_b32 v102, v0, 14, v102
    buffer_load_dwordx4 v[0:3], v102, s[68:71], 0 offen
    s_waitcnt lgkmcnt(15)
    v_ashrrev_i32 v122, 5, v51
    v_lshlrev_b16 v123, 2, v51
    v_lshlrev_b32 v124, 16, v6
    v_bitop3_b32 v122, v122, v113, v113 bitop3:0x0c
    v_and_b32 v125, 0xffff0000, v6
    v_lshlrev_b32 v126, 16, v7
    v_mul_f32 v122, v114, v122
    v_and_b32 v127, 0xffff0000, v7
    v_add_u32 v123, v123, v123
    v_pk_fma_f32 v[124:125], v[124:125], v[122:123], s[34:35] op_sel_hi:[1,0,1]
    v_pk_fma_f32 v[126:127], v[126:127], v[122:123], s[34:35] op_sel_hi:[1,0,1]
    v_lshl_add_u32 v124, v125, 16, v124
    v_lshl_add_u32 v125, v127, 16, v126
    s_waitcnt lgkmcnt(2)
    v_bitop3_b32 v115, v115, v116, v117 bitop3:0xfe
    v_lshl_add_u64 v[124:125], v[124:125], 0, s[36:37]
    v_cmpx_le_u32 vcc, 0x1000000, v51
    ds_add_rtn_u64 v[116:117], v123, v[124:125] offset:54272
    s_mov_b64 exec, -1
    v_ashrrev_i32 v122, 5, v52
    v_lshlrev_b16 v123, 2, v52
    v_lshlrev_b32 v124, 16, v8
    v_bitop3_b32 v122, v122, v113, v113 bitop3:0x0c
    v_and_b32 v125, 0xffff0000, v8
    v_lshlrev_b32 v126, 16, v9
    v_mul_f32 v122, v114, v122
    v_and_b32 v127, 0xffff0000, v9
    v_add_u32 v123, v123, v123
    v_pk_fma_f32 v[124:125], v[124:125], v[122:123], s[34:35] op_sel_hi:[1,0,1]
    v_pk_fma_f32 v[126:127], v[126:127], v[122:123], s[34:35] op_sel_hi:[1,0,1]
    v_lshl_add_u32 v124, v125, 16, v124
    v_lshl_add_u32 v125, v127, 16, v126
    s_waitcnt lgkmcnt(2)
    v_bitop3_b32 v115, v115, v118, v119 bitop3:0xfe
    v_lshl_add_u64 v[124:125], v[124:125], 0, s[36:37]
    v_cmpx_le_u32 vcc, 0x1000000, v52
    ds_add_rtn_u64 v[118:119], v123, v[124:125] offset:54272
    s_mov_b64 exec, -1
    v_ashrrev_i32 v122, 5, v53
    v_lshlrev_b16 v123, 2, v53
    v_lshlrev_b32 v124, 16, v10
    v_bitop3_b32 v122, v122, v113, v113 bitop3:0x0c
    v_and_b32 v125, 0xffff0000, v10
    v_lshlrev_b32 v126, 16, v11
    v_mul_f32 v122, v114, v122
    v_and_b32 v127, 0xffff0000, v11
    v_add_u32 v123, v123, v123
    v_pk_fma_f32 v[124:125], v[124:125], v[122:123], s[34:35] op_sel_hi:[1,0,1]
    v_pk_fma_f32 v[126:127], v[126:127], v[122:123], s[34:35] op_sel_hi:[1,0,1]
    v_lshl_add_u32 v124, v125, 16, v124
    v_lshl_add_u32 v125, v127, 16, v126
    s_waitcnt lgkmcnt(2)
    v_bitop3_b32 v115, v115, v120, v121 bitop3:0xfe
    v_lshl_add_u64 v[124:125], v[124:125], 0, s[36:37]
    v_cmpx_le_u32 vcc, 0x1000000, v53
    ds_add_rtn_u64 v[120:121], v123, v[124:125] offset:54272
    s_mov_b64 exec, -1
    v_bfe_u32 v6, v103, 14, 4
    v_lshrrev_b32 v7, 18, v103
    v_and_b32 v103, 0x3fff, v103
    v_mad_u32_u24 v6, v6, s63, v7
    v_lshl_or_b32 v103, v6, 14, v103
    buffer_load_dwordx4 v[6:9], v103, s[68:71], 0 offen
    s_waitcnt lgkmcnt(6)
    s_barrier
    s_waitcnt vmcnt(6)
    s_mov_b32 m0, s23
    v_mov_b32 v53, 0x3c000
    s_movk_i32 s44, 512
    v_sub_u32_sdwa v4, v111, v110 dst_sel:DWORD dst_unused:UNUSED_PAD src0_sel:WORD_0 src1_sel:WORD_0
    v_sub_u32_sdwa v5, v111, v110 dst_sel:DWORD dst_unused:UNUSED_PAD src0_sel:WORD_1 src1_sel:WORD_1
    v_med3_i32 v4, v4, 0, s44
    v_med3_i32 v5, v5, 0, s44
    v_add_u32 v48, v4, v5
    ds_write_addtid_b32 v53 offset:0
    ds_write_addtid_b32 v53 offset:256
    ds_write_addtid_b32 v53 offset:512
    ds_write_addtid_b32 v53 offset:768
    ds_write_addtid_b32 v53 offset:1024
    ds_write_addtid_b32 v53 offset:1280
    ds_write_addtid_b32 v53 offset:1536
    ds_write_addtid_b32 v53 offset:1792
    v_bfe_i32 v53, v112, 6, 1
    v_lshrrev_b32 v49, 6, v112
    v_bitop3_b32 v53, v53, 15, s10 bitop3:0x6a
    v_lshl_or_b32 v49, v49, 4, v53
    v_and_b32 v53, 0x30, v112
    v_lshl_or_b32 v53, v49, 6, v53
    v_lshlrev_b32 v53, 15, v53
    s_nop 1
    v_add_u32_dpp v48, v48, v48 row_shr:1 row_mask:0xf bank_mask:0xf bound_ctrl:0
    s_nop 1
    v_add_u32_dpp v48, v48, v48 row_shr:2 row_mask:0xf bank_mask:0xf bound_ctrl:0
    s_nop 1
    v_add_u32_dpp v48, v48, v48 row_shr:4 row_mask:0xf bank_mask:0xf bound_ctrl:0
    s_nop 1
    v_add_u32_dpp v48, v48, v48 row_shr:8 row_mask:0xf bank_mask:0xf bound_ctrl:0
    s_nop 1
    v_add_u32_dpp v48, v48, v48 row_bcast:15 row_mask:0xa bank_mask:0xf
    s_nop 1
    v_add_u32_dpp v48, v48, v48 row_bcast:31 row_mask:0xc bank_mask:0xf
    s_nop 1
    s_nop 0
    v_readlane_b32 s38, v48, 63
    v_sub_u32 v50, v48, v5
    v_sub_u32 v49, v50, v4
    v_sub_u32 v10, 512, v49
    v_mad_u32_u16 v51, v110, 16, v53
    v_med3_i32 v10, v10, 0, v4
    v_lshl_add_u32 v49, v49, 2, s23
    v_sub_u32 v11, 512, v50
    v_mad_u32_u16 v52, v110, 16, v53 op_sel:[1,0,0,0]
    v_med3_i32 v11, v11, 0, v5
    v_lshl_add_u32 v50, v50, 2, s23
    v_lshl_add_u32 v48, v11, 16, v10
    v_add_u32 v52, 262144, v52
    v_add_u32 v110, v110, v48
    s_min_u32 s17, s38, 512
    s_add_u32 s17, s17, 63
    s_lshr_b32 s17, s17, 6
p2_x0x_0:
    v_cmpx_lt_i32 vcc, 0, v10
    s_cbranch_execz p2_y0x_0
    ds_write_b32 v49, v51 offset:0
    v_add_u32 v51, 16, v51
    v_cmpx_lt_i32 vcc, 1, v10
    s_cbranch_execz p2_y0x_0
    ds_write_b32 v49, v51 offset:4
    v_add_u32 v51, 16, v51
    v_cmpx_lt_i32 vcc, 2, v10
    s_cbranch_execz p2_y0x_0
    ds_write_b32 v49, v51 offset:8
    v_add_u32 v51, 16, v51
    v_cmpx_lt_i32 vcc, 3, v10
    s_cbranch_execz p2_y0x_0
    ds_write_b32 v49, v51 offset:12
    v_add_u32 v51, 16, v51
    v_cmpx_lt_i32 vcc, 4, v10
    s_cbranch_execz p2_y0x_0
    ds_write_b32 v49, v51 offset:16
    v_add_u32 v51, 16, v51
    v_cmpx_lt_i32 vcc, 5, v10
    s_cbranch_execz p2_y0x_0
    ds_write_b32 v49, v51 offset:20
    v_add_u32 v51, 16, v51
    v_cmpx_lt_i32 vcc, 6, v10
    s_cbranch_execz p2_y0x_0
    ds_write_b32 v49, v51 offset:24
    v_add_u32 v51, 16, v51
    v_cmpx_lt_i32 vcc, 7, v10
    s_cbranch_execz p2_y0x_0
    ds_write_b32 v49, v51 offset:28
    v_add_u32 v51, 16, v51
    v_subrev_u32 v10, 8, v10
    v_add_u32 v49, 32, v49
    s_branch p2_x0x_0
p2_y0x_0:
    s_mov_b64 exec, -1
p2_x0x_1:
    v_cmpx_lt_i32 vcc, 0, v11
    s_cbranch_execz p2_y0x_1
    ds_write_b32 v50, v52 offset:0
    v_add_u32 v52, 16, v52
    v_cmpx_lt_i32 vcc, 1, v11
    s_cbranch_execz p2_y0x_1
    ds_write_b32 v50, v52 offset:4
    v_add_u32 v52, 16, v52
    v_cmpx_lt_i32 vcc, 2, v11
    s_cbranch_execz p2_y0x_1
    ds_write_b32 v50, v52 offset:8
    v_add_u32 v52, 16, v52
    v_cmpx_lt_i32 vcc, 3, v11
    s_cbranch_execz p2_y0x_1
    ds_write_b32 v50, v52 offset:12
    v_add_u32 v52, 16, v52
    v_cmpx_lt_i32 vcc, 4, v11
    s_cbranch_execz p2_y0x_1
    ds_write_b32 v50, v52 offset:16
    v_add_u32 v52, 16, v52
    v_cmpx_lt_i32 vcc, 5, v11
    s_cbranch_execz p2_y0x_1
    ds_write_b32 v50, v52 offset:20
    v_add_u32 v52, 16, v52
    v_cmpx_lt_i32 vcc, 6, v11
    s_cbranch_execz p2_y0x_1
    ds_write_b32 v50, v52 offset:24
    v_add_u32 v52, 16, v52
    v_cmpx_lt_i32 vcc, 7, v11
    s_cbranch_execz p2_y0x_1
    ds_write_b32 v50, v52 offset:28
    v_add_u32 v52, 16, v52
    v_subrev_u32 v11, 8, v11
    v_add_u32 v50, 32, v50
    s_branch p2_x0x_1
p2_y0x_1:
    s_mov_b64 exec, -1
    s_cmp_lt_u32 s38, 512
    s_cbranch_scc1 p2_nomore0x
    v_cmp_lt_u32_sdwa s[44:45], v110, v111 src0_sel:WORD_0 src1_sel:WORD_0
    v_cmp_lt_u32_sdwa s[46:47], v110, v111 src0_sel:WORD_1 src1_sel:WORD_1
    s_nop 0
    s_or_b64 s[44:45], s[44:45], s[46:47]
    s_cbranch_scc0 p2_nomore0x
    v_mov_b32 v49, s19
    v_mov_b32 v50, 1
    ds_write_b32 v49, v50 offset:53760
p2_nomore0x:
    s_waitcnt lgkmcnt(15)
    v_ashrrev_i32 v122, 5, v54
    v_lshlrev_b16 v123, 2, v54
    v_lshlrev_b32 v124, 16, v12
    v_bitop3_b32 v122, v122, v113, v113 bitop3:0x0c
    v_and_b32 v125, 0xffff0000, v12
    v_lshlrev_b32 v126, 16, v13
    v_mul_f32 v122, v114, v122
    v_and_b32 v127, 0xffff0000, v13
    v_add_u32 v123, v123, v123
    v_pk_fma_f32 v[124:125], v[124:125], v[122:123], s[34:35] op_sel_hi:[1,0,1]
    v_pk_fma_f32 v[126:127], v[126:127], v[122:123], s[34:35] op_sel_hi:[1,0,1]
    v_lshl_add_u32 v124, v125, 16, v124
    v_lshl_add_u32 v125, v127, 16, v126
    s_waitcnt lgkmcnt(10)
    v_bitop3_b32 v115, v115, v116, v117 bitop3:0xfe
    v_lshl_add_u64 v[124:125], v[124:125], 0, s[36:37]
    v_cmpx_le_u32 vcc, 0x1000000, v54
    ds_add_rtn_u64 v[116:117], v123, v[124:125] offset:54272
    s_mov_b64 exec, -1
    v_ashrrev_i32 v122, 5, v55
    v_lshlrev_b16 v123, 2, v55
    v_lshlrev_b32 v124, 16, v14
    v_bitop3_b32 v122, v122, v113, v113 bitop3:0x0c
    v_and_b32 v125, 0xffff0000, v14
    v_lshlrev_b32 v126, 16, v15
    v_mul_f32 v122, v114, v122
    v_and_b32 v127, 0xffff0000, v15
    v_add_u32 v123, v123, v123
    v_pk_fma_f32 v[124:125], v[124:125], v[122:123], s[34:35] op_sel_hi:[1,0,1]
    v_pk_fma_f32 v[126:127], v[126:127], v[122:123], s[34:35] op_sel_hi:[1,0,1]
    v_lshl_add_u32 v124, v125, 16, v124
    v_lshl_add_u32 v125, v127, 16, v126
    s_waitcnt lgkmcnt(10)
    v_bitop3_b32 v115, v115, v118, v119 bitop3:0xfe
    v_lshl_add_u64 v[124:125], v[124:125], 0, s[36:37]
    v_cmpx_le_u32 vcc, 0x1000000, v55
    ds_add_rtn_u64 v[118:119], v123, v[124:125] offset:54272
    s_mov_b64 exec, -1
    v_ashrrev_i32 v122, 5, v56
    v_lshlrev_b16 v123, 2, v56
    v_lshlrev_b32 v124, 16, v16
    v_bitop3_b32 v122, v122, v113, v113 bitop3:0x0c
    v_and_b32 v125, 0xffff0000, v16
    v_lshlrev_b32 v126, 16, v17
    v_mul_f32 v122, v114, v122
    v_and_b32 v127, 0xffff0000, v17
    v_add_u32 v123, v123, v123
    v_pk_fma_f32 v[124:125], v[124:125], v[122:123], s[34:35] op_sel_hi:[1,0,1]
    v_pk_fma_f32 v[126:127], v[126:127], v[122:123], s[34:35] op_sel_hi:[1,0,1]
    v_lshl_add_u32 v124, v125, 16, v124
    v_lshl_add_u32 v125, v127, 16, v126
    s_waitcnt lgkmcnt(10)
    v_bitop3_b32 v115, v115, v120, v121 bitop3:0xfe
    v_lshl_add_u64 v[124:125], v[124:125], 0, s[36:37]
    v_cmpx_le_u32 vcc, 0x1000000, v56
    ds_add_rtn_u64 v[120:121], v123, v[124:125] offset:54272
    s_mov_b64 exec, -1
    v_bfe_u32 v12, v104, 14, 4
    v_lshrrev_b32 v13, 18, v104
    v_and_b32 v104, 0x3fff, v104
    v_mad_u32_u24 v12, v12, s63, v13
    v_lshl_or_b32 v104, v12, 14, v104
    buffer_load_dwordx4 v[12:15], v104, s[68:71], 0 offen
    s_waitcnt lgkmcnt(15)
    v_ashrrev_i32 v122, 5, v57
    v_lshlrev_b16 v123, 2, v57
    v_lshlrev_b32 v124, 16, v18
    v_bitop3_b32 v122, v122, v113, v113 bitop3:0x0c
    v_and_b32 v125, 0xffff0000, v18
    v_lshlrev_b32 v126, 16, v19
    v_mul_f32 v122, v114, v122
    v_and_b32 v127, 0xffff0000, v19
    v_add_u32 v123, v123, v123
    v_pk_fma_f32 v[124:125], v[124:125], v[122:123], s[34:35] op_sel_hi:[1,0,1]
    v_pk_fma_f32 v[126:127], v[126:127], v[122:123], s[34:35] op_sel_hi:[1,0,1]
    v_lshl_add_u32 v124, v125, 16, v124
    v_lshl_add_u32 v125, v127, 16, v126
    s_waitcnt lgkmcnt(2)
    v_bitop3_b32 v115, v115, v116, v117 bitop3:0xfe
    v_lshl_add_u64 v[124:125], v[124:125], 0, s[36:37]
    v_cmpx_le_u32 vcc, 0x1000000, v57
    ds_add_rtn_u64 v[116:117], v123, v[124:125] offset:54272
    s_mov_b64 exec, -1
    v_ashrrev_i32 v122, 5, v58
    v_lshlrev_b16 v123, 2, v58
    v_lshlrev_b32 v124, 16, v20
    v_bitop3_b32 v122, v122, v113, v113 bitop3:0x0c
    v_and_b32 v125, 0xffff0000, v20
    v_lshlrev_b32 v126, 16, v21
    v_mul_f32 v122, v114, v122
    v_and_b32 v127, 0xffff0000, v21
    v_add_u32 v123, v123, v123
    v_pk_fma_f32 v[124:125], v[124:125], v[122:123], s[34:35] op_sel_hi:[1,0,1]
    v_pk_fma_f32 v[126:127], v[126:127], v[122:123], s[34:35] op_sel_hi:[1,0,1]
    v_lshl_add_u32 v124, v125, 16, v124
    v_lshl_add_u32 v125, v127, 16, v126
    s_waitcnt lgkmcnt(2)
    v_bitop3_b32 v115, v115, v118, v119 bitop3:0xfe
    v_lshl_add_u64 v[124:125], v[124:125], 0, s[36:37]
    v_cmpx_le_u32 vcc, 0x1000000, v58
    ds_add_rtn_u64 v[118:119], v123, v[124:125] offset:54272
    s_mov_b64 exec, -1
    v_ashrrev_i32 v122, 5, v59
    v_lshlrev_b16 v123, 2, v59
    v_lshlrev_b32 v124, 16, v22
    v_bitop3_b32 v122, v122, v113, v113 bitop3:0x0c
    v_and_b32 v125, 0xffff0000, v22
    v_lshlrev_b32 v126, 16, v23
    v_mul_f32 v122, v114, v122
    v_and_b32 v127, 0xffff0000, v23
    v_add_u32 v123, v123, v123
    v_pk_fma_f32 v[124:125], v[124:125], v[122:123], s[34:35] op_sel_hi:[1,0,1]
    v_pk_fma_f32 v[126:127], v[126:127], v[122:123], s[34:35] op_sel_hi:[1,0,1]
    v_lshl_add_u32 v124, v125, 16, v124
    v_lshl_add_u32 v125, v127, 16, v126
    s_waitcnt lgkmcnt(2)
    v_bitop3_b32 v115, v115, v120, v121 bitop3:0xfe
    v_lshl_add_u64 v[124:125], v[124:125], 0, s[36:37]
    v_cmpx_le_u32 vcc, 0x1000000, v59
    ds_add_rtn_u64 v[120:121], v123, v[124:125] offset:54272
    s_mov_b64 exec, -1
    v_bfe_u32 v18, v105, 14, 4
    v_lshrrev_b32 v19, 18, v105
    v_and_b32 v105, 0x3fff, v105
    v_mad_u32_u24 v18, v18, s63, v19
    v_lshl_or_b32 v105, v18, 14, v105
    buffer_load_dwordx4 v[18:21], v105, s[68:71], 0 offen
    s_mov_b32 m0, s23
    s_nop 0
    ds_read_addtid_b32 v102 offset:0
    ds_read_addtid_b32 v103 offset:256
    ds_read_addtid_b32 v104 offset:512
    ds_read_addtid_b32 v105 offset:768
    ds_read_addtid_b32 v106 offset:1024
    ds_read_addtid_b32 v107 offset:1280
    ds_read_addtid_b32 v108 offset:1536
    ds_read_addtid_b32 v109 offset:1792
    s_waitcnt vmcnt(4)
    s_mov_b32 m0, s24
    s_cmp_ge_u32 s10, 9
    s_cbranch_scc1 p2_st0s0
    ds_write_addtid_b32 v84 offset:49152
    ds_write_addtid_b32 v85 offset:49408
p2_st0s0:
    s_mov_b32 m0, s23
    s_add_u32 s20, s20, 53760
    ds_write_addtid_b32 v72 offset:0
    ds_write_addtid_b32 v73 offset:256
    ds_write_addtid_b32 v74 offset:512
    ds_write_addtid_b32 v75 offset:768
    ds_write_addtid_b32 v76 offset:1024
    ds_write_addtid_b32 v77 offset:1280
    ds_write_addtid_b32 v78 offset:1536
    ds_write_addtid_b32 v79 offset:1792
    ds_write_addtid_b32 v80 offset:2048
    ds_write_addtid_b32 v81 offset:2304
    ds_write_addtid_b32 v82 offset:2560
    ds_write_addtid_b32 v83 offset:2816
    s_waitcnt lgkmcnt(15)
    v_ashrrev_i32 v122, 5, v60
    v_lshlrev_b16 v123, 2, v60
    v_lshlrev_b32 v124, 16, v24
    v_bitop3_b32 v122, v122, v113, v113 bitop3:0x0c
    v_and_b32 v125, 0xffff0000, v24
    v_lshlrev_b32 v126, 16, v25
    v_mul_f32 v122, v114, v122
    v_and_b32 v127, 0xffff0000, v25
    v_add_u32 v123, v123, v123
    v_pk_fma_f32 v[124:125], v[124:125], v[122:123], s[34:35] op_sel_hi:[1,0,1]
    v_pk_fma_f32 v[126:127], v[126:127], v[122:123], s[34:35] op_sel_hi:[1,0,1]
    v_lshl_add_u32 v124, v125, 16, v124
    v_lshl_add_u32 v125, v127, 16, v126
    s_waitcnt lgkmcnt(15)
    v_bitop3_b32 v115, v115, v116, v117 bitop3:0xfe
    v_lshl_add_u64 v[124:125], v[124:125], 0, s[36:37]
    v_cmpx_le_u32 vcc, 0x1000000, v60
    ds_add_rtn_u64 v[116:117], v123, v[124:125] offset:54272
    s_mov_b64 exec, -1
    v_ashrrev_i32 v122, 5, v61
    v_lshlrev_b16 v123, 2, v61
    v_lshlrev_b32 v124, 16, v26
    v_bitop3_b32 v122, v122, v113, v113 bitop3:0x0c
    v_and_b32 v125, 0xffff0000, v26
    v_lshlrev_b32 v126, 16, v27
    v_mul_f32 v122, v114, v122
    v_and_b32 v127, 0xffff0000, v27
    v_add_u32 v123, v123, v123
    v_pk_fma_f32 v[124:125], v[124:125], v[122:123], s[34:35] op_sel_hi:[1,0,1]
    v_pk_fma_f32 v[126:127], v[126:127], v[122:123], s[34:35] op_sel_hi:[1,0,1]
    v_lshl_add_u32 v124, v125, 16, v124
    v_lshl_add_u32 v125, v127, 16, v126
    s_waitcnt lgkmcnt(15)
    v_bitop3_b32 v115, v115, v118, v119 bitop3:0xfe
    v_lshl_add_u64 v[124:125], v[124:125], 0, s[36:37]
    v_cmpx_le_u32 vcc, 0x1000000, v61
    ds_add_rtn_u64 v[118:119], v123, v[124:125] offset:54272
    s_mov_b64 exec, -1
    v_ashrrev_i32 v122, 5, v62
    v_lshlrev_b16 v123, 2, v62
    v_lshlrev_b32 v124, 16, v28
    v_bitop3_b32 v122, v122, v113, v113 bitop3:0x0c
    v_and_b32 v125, 0xffff0000, v28
    v_lshlrev_b32 v126, 16, v29
    v_mul_f32 v122, v114, v122
    v_and_b32 v127, 0xffff0000, v29
    v_add_u32 v123, v123, v123
    v_pk_fma_f32 v[124:125], v[124:125], v[122:123], s[34:35] op_sel_hi:[1,0,1]
    v_pk_fma_f32 v[126:127], v[126:127], v[122:123], s[34:35] op_sel_hi:[1,0,1]
    v_lshl_add_u32 v124, v125, 16, v124
    v_lshl_add_u32 v125, v127, 16, v126
    s_waitcnt lgkmcnt(15)
    v_bitop3_b32 v115, v115, v120, v121 bitop3:0xfe
    v_lshl_add_u64 v[124:125], v[124:125], 0, s[36:37]
    v_cmpx_le_u32 vcc, 0x1000000, v62
    ds_add_rtn_u64 v[120:121], v123, v[124:125] offset:54272
    s_mov_b64 exec, -1
    s_waitcnt vmcnt(13)
    v_perm_b32 v60, v89, v86, s31
    v_perm_b32 v61, v89, v87, s32
    v_perm_b32 v62, v89, v88, s33
    v_lshlrev_b16 v28, 3, v88
    v_lshlrev_b16 v26, 3, v87
    v_lshlrev_b16 v24, 3, v86
    s_waitcnt lgkmcnt(3)
    s_barrier
    s_cmp_ge_u32 s10, 9
    s_cbranch_scc1 p2_nm0m1a
    v_lshrrev_b32 v84, 1, v112
    s_add_u32 s44, s20, s42
    buffer_load_dwordx2 v[84:85], v84, s[4:7], s44 offen
p2_nm0m1a:
    buffer_load_dwordx4 v[72:75], v112, s[4:7], s20 offen offset:0
    buffer_load_dwordx4 v[76:79], v112, s[4:7], s20 offen offset:1024
    buffer_load_dwordx4 v[80:83], v112, s[4:7], s20 offen offset:2048
    v_cmpx_ge_u16 vcc, 0x3fff, v60
    ds_read_b64 v[24:25], v24
    s_mov_b64 exec, -1
    v_cmpx_ge_u16 vcc, 0x3fff, v61
    ds_read_b64 v[26:27], v26
    s_mov_b64 exec, -1
    v_cmpx_ge_u16 vcc, 0x3fff, v62
    ds_read_b64 v[28:29], v28
    s_mov_b64 exec, -1
    s_waitcnt lgkmcnt(15)
    v_ashrrev_i32 v122, 5, v63
    v_lshlrev_b16 v123, 2, v63
    v_lshlrev_b32 v124, 16, v30
    v_bitop3_b32 v122, v122, v113, v113 bitop3:0x0c
    v_and_b32 v125, 0xffff0000, v30
    v_lshlrev_b32 v126, 16, v31
    v_mul_f32 v122, v114, v122
    v_and_b32 v127, 0xffff0000, v31
    v_add_u32 v123, v123, v123
    v_pk_fma_f32 v[124:125], v[124:125], v[122:123], s[34:35] op_sel_hi:[1,0,1]
    v_pk_fma_f32 v[126:127], v[126:127], v[122:123], s[34:35] op_sel_hi:[1,0,1]
    v_lshl_add_u32 v124, v125, 16, v124
    v_lshl_add_u32 v125, v127, 16, v126
    s_waitcnt lgkmcnt(5)
    v_bitop3_b32 v115, v115, v116, v117 bitop3:0xfe
    v_lshl_add_u64 v[124:125], v[124:125], 0, s[36:37]
    v_cmpx_le_u32 vcc, 0x1000000, v63
    ds_add_rtn_u64 v[116:117], v123, v[124:125] offset:54272
    s_mov_b64 exec, -1
    v_ashrrev_i32 v122, 5, v64
    v_lshlrev_b16 v123, 2, v64
    v_lshlrev_b32 v124, 16, v32
    v_bitop3_b32 v122, v122, v113, v113 bitop3:0x0c
    v_and_b32 v125, 0xffff0000, v32
    v_lshlrev_b32 v126, 16, v33
    v_mul_f32 v122, v114, v122
    v_and_b32 v127, 0xffff0000, v33
    v_add_u32 v123, v123, v123
    v_pk_fma_f32 v[124:125], v[124:125], v[122:123], s[34:35] op_sel_hi:[1,0,1]
    v_pk_fma_f32 v[126:127], v[126:127], v[122:123], s[34:35] op_sel_hi:[1,0,1]
    v_lshl_add_u32 v124, v125, 16, v124
    v_lshl_add_u32 v125, v127, 16, v126
    s_waitcnt lgkmcnt(5)
    v_bitop3_b32 v115, v115, v118, v119 bitop3:0xfe
    v_lshl_add_u64 v[124:125], v[124:125], 0, s[36:37]
    v_cmpx_le_u32 vcc, 0x1000000, v64
    ds_add_rtn_u64 v[118:119], v123, v[124:125] offset:54272
    s_mov_b64 exec, -1
    v_ashrrev_i32 v122, 5, v65
    v_lshlrev_b16 v123, 2, v65
    v_lshlrev_b32 v124, 16, v34
    v_bitop3_b32 v122, v122, v113, v113 bitop3:0x0c
    v_and_b32 v125, 0xffff0000, v34
    v_lshlrev_b32 v126, 16, v35
    v_mul_f32 v122, v114, v122
    v_and_b32 v127, 0xffff0000, v35
    v_add_u32 v123, v123, v123
    v_pk_fma_f32 v[124:125], v[124:125], v[122:123], s[34:35] op_sel_hi:[1,0,1]
    v_pk_fma_f32 v[126:127], v[126:127], v[122:123], s[34:35] op_sel_hi:[1,0,1]
    v_lshl_add_u32 v124, v125, 16, v124
    v_lshl_add_u32 v125, v127, 16, v126
    s_waitcnt lgkmcnt(5)
    v_bitop3_b32 v115, v115, v120, v121 bitop3:0xfe
    v_lshl_add_u64 v[124:125], v[124:125], 0, s[36:37]
    v_cmpx_le_u32 vcc, 0x1000000, v65
    ds_add_rtn_u64 v[120:121], v123, v[124:125] offset:54272
    s_mov_b64 exec, -1
    s_waitcnt vmcnt(15)
    v_perm_b32 v63, v93, v90, s31
    v_perm_b32 v64, v93, v91, s32
    v_perm_b32 v65, v93, v92, s33
    v_lshlrev_b16 v34, 3, v92
    v_lshlrev_b16 v32, 3, v91
    v_lshlrev_b16 v30, 3, v90
    v_cmpx_ge_u16 vcc, 0x3fff, v63
    ds_read_b64 v[30:31], v30
    s_mov_b64 exec, -1
    v_cmpx_ge_u16 vcc, 0x3fff, v64
    ds_read_b64 v[32:33], v32
    s_mov_b64 exec, -1
    v_cmpx_ge_u16 vcc, 0x3fff, v65
    ds_read_b64 v[34:35], v34
    s_mov_b64 exec, -1
    s_waitcnt lgkmcnt(15)
    v_bfe_u32 v86, v106, 14, 4
    v_lshrrev_b32 v87, 18, v106
    v_and_b32 v106, 0x3fff, v106
    v_mad_u32_u24 v86, v86, s63, v87
    v_lshl_or_b32 v106, v86, 14, v106
    buffer_load_dwordx4 v[86:89], v106, s[68:71], 0 offen
    s_waitcnt lgkmcnt(15)
    v_ashrrev_i32 v122, 5, v66
    v_lshlrev_b16 v123, 2, v66
    v_lshlrev_b32 v124, 16, v36
    v_bitop3_b32 v122, v122, v113, v113 bitop3:0x0c
    v_and_b32 v125, 0xffff0000, v36
    v_lshlrev_b32 v126, 16, v37
    v_mul_f32 v122, v114, v122
    v_and_b32 v127, 0xffff0000, v37
    v_add_u32 v123, v123, v123
    v_pk_fma_f32 v[124:125], v[124:125], v[122:123], s[34:35] op_sel_hi:[1,0,1]
    v_pk_fma_f32 v[126:127], v[126:127], v[122:123], s[34:35] op_sel_hi:[1,0,1]
    v_lshl_add_u32 v124, v125, 16, v124
    v_lshl_add_u32 v125, v127, 16, v126
    s_waitcnt lgkmcnt(5)
    v_bitop3_b32 v115, v115, v116, v117 bitop3:0xfe
    v_lshl_add_u64 v[124:125], v[124:125], 0, s[36:37]
    v_cmpx_le_u32 vcc, 0x1000000, v66
    ds_add_rtn_u64 v[116:117], v123, v[124:125] offset:54272
    s_mov_b64 exec, -1
    v_ashrrev_i32 v122, 5, v67
    v_lshlrev_b16 v123, 2, v67
    v_lshlrev_b32 v124, 16, v38
    v_bitop3_b32 v122, v122, v113, v113 bitop3:0x0c
    v_and_b32 v125, 0xffff0000, v38
    v_lshlrev_b32 v126, 16, v39
    v_mul_f32 v122, v114, v122
    v_and_b32 v127, 0xffff0000, v39
    v_add_u32 v123, v123, v123
    v_pk_fma_f32 v[124:125], v[124:125], v[122:123], s[34:35] op_sel_hi:[1,0,1]
    v_pk_fma_f32 v[126:127], v[126:127], v[122:123], s[34:35] op_sel_hi:[1,0,1]
    v_lshl_add_u32 v124, v125, 16, v124
    v_lshl_add_u32 v125, v127, 16, v126
    s_waitcnt lgkmcnt(5)
    v_bitop3_b32 v115, v115, v118, v119 bitop3:0xfe
    v_lshl_add_u64 v[124:125], v[124:125], 0, s[36:37]
    v_cmpx_le_u32 vcc, 0x1000000, v67
    ds_add_rtn_u64 v[118:119], v123, v[124:125] offset:54272
    s_mov_b64 exec, -1
    v_ashrrev_i32 v122, 5, v68
    v_lshlrev_b16 v123, 2, v68
    v_lshlrev_b32 v124, 16, v40
    v_bitop3_b32 v122, v122, v113, v113 bitop3:0x0c
    v_and_b32 v125, 0xffff0000, v40
    v_lshlrev_b32 v126, 16, v41
    v_mul_f32 v122, v114, v122
    v_and_b32 v127, 0xffff0000, v41
    v_add_u32 v123, v123, v123
    v_pk_fma_f32 v[124:125], v[124:125], v[122:123], s[34:35] op_sel_hi:[1,0,1]
    v_pk_fma_f32 v[126:127], v[126:127], v[122:123], s[34:35] op_sel_hi:[1,0,1]
    v_lshl_add_u32 v124, v125, 16, v124
    v_lshl_add_u32 v125, v127, 16, v126
    s_waitcnt lgkmcnt(5)
    v_bitop3_b32 v115, v115, v120, v121 bitop3:0xfe
    v_lshl_add_u64 v[124:125], v[124:125], 0, s[36:37]
    v_cmpx_le_u32 vcc, 0x1000000, v68
    ds_add_rtn_u64 v[120:121], v123, v[124:125] offset:54272
    s_mov_b64 exec, -1
    s_waitcnt vmcnt(12)
    v_perm_b32 v66, v97, v94, s31
    v_perm_b32 v67, v97, v95, s32
    v_perm_b32 v68, v97, v96, s33
    v_lshlrev_b16 v40, 3, v96
    v_lshlrev_b16 v38, 3, v95
    v_lshlrev_b16 v36, 3, v94
    v_cmpx_ge_u16 vcc, 0x3fff, v66
    ds_read_b64 v[36:37], v36
    s_mov_b64 exec, -1
    v_cmpx_ge_u16 vcc, 0x3fff, v67
    ds_read_b64 v[38:39], v38
    s_mov_b64 exec, -1
    v_cmpx_ge_u16 vcc, 0x3fff, v68
    ds_read_b64 v[40:41], v40
    s_mov_b64 exec, -1
    s_waitcnt lgkmcnt(15)
    v_bfe_u32 v90, v107, 14, 4
    v_lshrrev_b32 v91, 18, v107
    v_and_b32 v107, 0x3fff, v107
    v_mad_u32_u24 v90, v90, s63, v91
    v_lshl_or_b32 v107, v90, 14, v107
    buffer_load_dwordx4 v[90:93], v107, s[68:71], 0 offen
    s_cmp_le_u32 s15, 7
    s_cbranch_scc1 p2_na0a7
    s_waitcnt lgkmcnt(15)
    v_ashrrev_i32 v122, 5, v69
    v_lshlrev_b16 v123, 2, v69
    v_lshlrev_b32 v124, 16, v42
    v_bitop3_b32 v122, v122, v113, v113 bitop3:0x0c
    v_and_b32 v125, 0xffff0000, v42
    v_lshlrev_b32 v126, 16, v43
    v_mul_f32 v122, v114, v122
    v_and_b32 v127, 0xffff0000, v43
    v_add_u32 v123, v123, v123
    v_pk_fma_f32 v[124:125], v[124:125], v[122:123], s[34:35] op_sel_hi:[1,0,1]
    v_pk_fma_f32 v[126:127], v[126:127], v[122:123], s[34:35] op_sel_hi:[1,0,1]
    v_lshl_add_u32 v124, v125, 16, v124
    v_lshl_add_u32 v125, v127, 16, v126
    s_waitcnt lgkmcnt(5)
    v_bitop3_b32 v115, v115, v116, v117 bitop3:0xfe
    v_lshl_add_u64 v[124:125], v[124:125], 0, s[36:37]
    v_cmpx_le_u32 vcc, 0x1000000, v69
    ds_add_rtn_u64 v[116:117], v123, v[124:125] offset:54272
    s_mov_b64 exec, -1
    v_ashrrev_i32 v122, 5, v70
    v_lshlrev_b16 v123, 2, v70
    v_lshlrev_b32 v124, 16, v44
    v_bitop3_b32 v122, v122, v113, v113 bitop3:0x0c
    v_and_b32 v125, 0xffff0000, v44
    v_lshlrev_b32 v126, 16, v45
    v_mul_f32 v122, v114, v122
    v_and_b32 v127, 0xffff0000, v45
    v_add_u32 v123, v123, v123
    v_pk_fma_f32 v[124:125], v[124:125], v[122:123], s[34:35] op_sel_hi:[1,0,1]
    v_pk_fma_f32 v[126:127], v[126:127], v[122:123], s[34:35] op_sel_hi:[1,0,1]
    v_lshl_add_u32 v124, v125, 16, v124
    v_lshl_add_u32 v125, v127, 16, v126
    s_waitcnt lgkmcnt(5)
    v_bitop3_b32 v115, v115, v118, v119 bitop3:0xfe
    v_lshl_add_u64 v[124:125], v[124:125], 0, s[36:37]
    v_cmpx_le_u32 vcc, 0x1000000, v70
    ds_add_rtn_u64 v[118:119], v123, v[124:125] offset:54272
    s_mov_b64 exec, -1
    v_ashrrev_i32 v122, 5, v71
    v_lshlrev_b16 v123, 2, v71
    v_lshlrev_b32 v124, 16, v46
    v_bitop3_b32 v122, v122, v113, v113 bitop3:0x0c
    v_and_b32 v125, 0xffff0000, v46
    v_lshlrev_b32 v126, 16, v47
    v_mul_f32 v122, v114, v122
    v_and_b32 v127, 0xffff0000, v47
    v_add_u32 v123, v123, v123
    v_pk_fma_f32 v[124:125], v[124:125], v[122:123], s[34:35] op_sel_hi:[1,0,1]
    v_pk_fma_f32 v[126:127], v[126:127], v[122:123], s[34:35] op_sel_hi:[1,0,1]
    v_lshl_add_u32 v124, v125, 16, v124
    v_lshl_add_u32 v125, v127, 16, v126
    s_waitcnt lgkmcnt(5)
    v_bitop3_b32 v115, v115, v120, v121 bitop3:0xfe
    v_lshl_add_u64 v[124:125], v[124:125], 0, s[36:37]
    v_cmpx_le_u32 vcc, 0x1000000, v71
    ds_add_rtn_u64 v[120:121], v123, v[124:125] offset:54272
    s_mov_b64 exec, -1
p2_na0a7:
    s_waitcnt vmcnt(12)
    v_perm_b32 v69, v101, v98, s31
    v_perm_b32 v70, v101, v99, s32
    v_perm_b32 v71, v101, v100, s33
    v_lshlrev_b16 v46, 3, v100
    v_lshlrev_b16 v44, 3, v99
    v_lshlrev_b16 v42, 3, v98
    s_cmp_le_u32 s16, 7
    s_cbranch_scc1 p2_g0r07
    v_cmpx_ge_u16 vcc, 0x3fff, v69
    ds_read_b64 v[42:43], v42
    s_mov_b64 exec, -1
    v_cmpx_ge_u16 vcc, 0x3fff, v70
    ds_read_b64 v[44:45], v44
    s_mov_b64 exec, -1
    v_cmpx_ge_u16 vcc, 0x3fff, v71
    ds_read_b64 v[46:47], v46
    s_mov_b64 exec, -1
p2_g0r07:
    s_waitcnt vmcnt(8)
    v_perm_b32 v48, v3, v0, s31
    v_perm_b32 v49, v3, v1, s32
    v_perm_b32 v50, v3, v2, s33
    v_lshlrev_b16 v4, 3, v2
    v_lshlrev_b16 v2, 3, v1
    v_lshlrev_b16 v0, 3, v0
    v_cmpx_ge_u16 vcc, 0x3fff, v48
    ds_read_b64 v[0:1], v0
    s_mov_b64 exec, -1
    v_cmpx_ge_u16 vcc, 0x3fff, v49
    ds_read_b64 v[2:3], v2
    s_mov_b64 exec, -1
    v_cmpx_ge_u16 vcc, 0x3fff, v50
    ds_read_b64 v[4:5], v4
    s_mov_b64 exec, -1
    s_waitcnt vmcnt(7)
    v_perm_b32 v51, v9, v6, s31
    v_perm_b32 v52, v9, v7, s32
    v_perm_b32 v53, v9, v8, s33
    v_lshlrev_b16 v10, 3, v8
    v_lshlrev_b16 v8, 3, v7
    v_lshlrev_b16 v6, 3, v6
    v_cmpx_ge_u16 vcc, 0x3fff, v51
    ds_read_b64 v[6:7], v6
    s_mov_b64 exec, -1
    v_cmpx_ge_u16 vcc, 0x3fff, v52
    ds_read_b64 v[8:9], v8
    s_mov_b64 exec, -1
    v_cmpx_ge_u16 vcc, 0x3fff, v53
    ds_read_b64 v[10:11], v10
    s_mov_b64 exec, -1
    s_waitcnt vmcnt(6)
    v_perm_b32 v54, v15, v12, s31
    v_perm_b32 v55, v15, v13, s32
    v_perm_b32 v56, v15, v14, s33
    v_lshlrev_b16 v16, 3, v14
    v_lshlrev_b16 v14, 3, v13
    v_lshlrev_b16 v12, 3, v12
    v_cmpx_ge_u16 vcc, 0x3fff, v54
    ds_read_b64 v[12:13], v12
    s_mov_b64 exec, -1
    v_cmpx_ge_u16 vcc, 0x3fff, v55
    ds_read_b64 v[14:15], v14
    s_mov_b64 exec, -1
    v_cmpx_ge_u16 vcc, 0x3fff, v56
    ds_read_b64 v[16:17], v16
    s_mov_b64 exec, -1
    s_waitcnt vmcnt(5)
    v_perm_b32 v57, v21, v18, s31
    v_perm_b32 v58, v21, v19, s32
    v_perm_b32 v59, v21, v20, s33
    v_lshlrev_b16 v22, 3, v20
    v_lshlrev_b16 v20, 3, v19
    v_lshlrev_b16 v18, 3, v18
    v_cmpx_ge_u16 vcc, 0x3fff, v57
    ds_read_b64 v[18:19], v18
    s_mov_b64 exec, -1
    v_cmpx_ge_u16 vcc, 0x3fff, v58
    ds_read_b64 v[20:21], v20
    s_mov_b64 exec, -1
    v_cmpx_ge_u16 vcc, 0x3fff, v59
    ds_read_b64 v[22:23], v22
    s_mov_b64 exec, -1
    s_waitcnt lgkmcnt(0)
    s_barrier
    s_waitcnt lgkmcnt(15)
    s_branch p2_tail
p2_drain0:
    v_cmpx_gt_i16 vcc, 0, v48
    ds_read_b64 v[0:1], v0
    s_mov_b64 exec, -1
    v_cmpx_gt_i16 vcc, 0, v49
    ds_read_b64 v[2:3], v2
    s_mov_b64 exec, -1
    v_cmpx_gt_i16 vcc, 0, v50
    ds_read_b64 v[4:5], v4
    s_mov_b64 exec, -1
    v_cmpx_gt_i16 vcc, 0, v51
    ds_read_b64 v[6:7], v6
    s_mov_b64 exec, -1
    v_cmpx_gt_i16 vcc, 0, v52
    ds_read_b64 v[8:9], v8
    s_mov_b64 exec, -1
    v_cmpx_gt_i16 vcc, 0, v53
    ds_read_b64 v[10:11], v10
    s_mov_b64 exec, -1
    v_cmpx_gt_i16 vcc, 0, v54
    ds_read_b64 v[12:13], v12
    s_mov_b64 exec, -1
    v_cmpx_gt_i16 vcc, 0, v55
    ds_read_b64 v[14:15], v14
    s_mov_b64 exec, -1
    v_cmpx_gt_i16 vcc, 0, v56
    ds_read_b64 v[16:17], v16
    s_mov_b64 exec, -1
    v_cmpx_gt_i16 vcc, 0, v57
    ds_read_b64 v[18:19], v18
    s_mov_b64 exec, -1
    v_cmpx_gt_i16 vcc, 0, v58
    ds_read_b64 v[20:21], v20
    s_mov_b64 exec, -1
    v_cmpx_gt_i16 vcc, 0, v59
    ds_read_b64 v[22:23], v22
    s_mov_b64 exec, -1
    v_cmpx_gt_i16 vcc, 0, v60
    ds_read_b64 v[24:25], v24
    s_mov_b64 exec, -1
    v_cmpx_gt_i16 vcc, 0, v61
    ds_read_b64 v[26:27], v26
    s_mov_b64 exec, -1
    v_cmpx_gt_i16 vcc, 0, v62
    ds_read_b64 v[28:29], v28
    s_mov_b64 exec, -1
    v_cmpx_gt_i16 vcc, 0, v63
    ds_read_b64 v[30:31], v30
    s_mov_b64 exec, -1
    v_cmpx_gt_i16 vcc, 0, v64
    ds_read_b64 v[32:33], v32
    s_mov_b64 exec, -1
    v_cmpx_gt_i16 vcc, 0, v65
    ds_read_b64 v[34:35], v34
    s_mov_b64 exec, -1
    v_cmpx_gt_i16 vcc, 0, v66
    ds_read_b64 v[36:37], v36
    s_mov_b64 exec, -1
    v_cmpx_gt_i16 vcc, 0, v67
    ds_read_b64 v[38:39], v38
    s_mov_b64 exec, -1
    v_cmpx_gt_i16 vcc, 0, v68
    ds_read_b64 v[40:41], v40
    s_mov_b64 exec, -1
    s_cmp_le_u32 s15, 7
    s_cbranch_scc1 p2_gd0
    v_cmpx_gt_i16 vcc, 0, v69
    ds_read_b64 v[42:43], v42
    s_mov_b64 exec, -1
    v_cmpx_gt_i16 vcc, 0, v70
    ds_read_b64 v[44:45], v44
    s_mov_b64 exec, -1
    v_cmpx_gt_i16 vcc, 0, v71
    ds_read_b64 v[46:47], v46
    s_mov_b64 exec, -1
p2_gd0:
    s_waitcnt lgkmcnt(15)
    v_ashrrev_i32 v122, 5, v48
    v_lshlrev_b16 v123, 2, v48
    v_lshlrev_b32 v124, 16, v0
    v_bitop3_b32 v122, v122, v113, v113 bitop3:0x0c
    v_and_b32 v125, 0xffff0000, v0
    v_lshlrev_b32 v126, 16, v1
    v_mul_f32 v122, v114, v122
    v_and_b32 v127, 0xffff0000, v1
    v_add_u32 v123, v123, v123
    v_pk_fma_f32 v[124:125], v[124:125], v[122:123], s[34:35] op_sel_hi:[1,0,1]
    v_pk_fma_f32 v[126:127], v[126:127], v[122:123], s[34:35] op_sel_hi:[1,0,1]
    v_lshl_add_u32 v124, v125, 16, v124
    v_lshl_add_u32 v125, v127, 16, v126
    s_waitcnt lgkmcnt(15)
    v_bitop3_b32 v115, v115, v116, v117 bitop3:0xfe
    v_lshl_add_u64 v[124:125], v[124:125], 0, s[36:37]
    v_cmpx_le_u32 vcc, 0x1000000, v48
    ds_add_rtn_u64 v[116:117], v123, v[124:125] offset:54272
    s_mov_b64 exec, -1
    v_ashrrev_i32 v122, 5, v49
    v_lshlrev_b16 v123, 2, v49
    v_lshlrev_b32 v124, 16, v2
    v_bitop3_b32 v122, v122, v113, v113 bitop3:0x0c
    v_and_b32 v125, 0xffff0000, v2
    v_lshlrev_b32 v126, 16, v3
    v_mul_f32 v122, v114, v122
    v_and_b32 v127, 0xffff0000, v3
    v_add_u32 v123, v123, v123
    v_pk_fma_f32 v[124:125], v[124:125], v[122:123], s[34:35] op_sel_hi:[1,0,1]
    v_pk_fma_f32 v[126:127], v[126:127], v[122:123], s[34:35] op_sel_hi:[1,0,1]
    v_lshl_add_u32 v124, v125, 16, v124
    v_lshl_add_u32 v125, v127, 16, v126
    s_waitcnt lgkmcnt(15)
    v_bitop3_b32 v115, v115, v118, v119 bitop3:0xfe
    v_lshl_add_u64 v[124:125], v[124:125], 0, s[36:37]
    v_cmpx_le_u32 vcc, 0x1000000, v49
    ds_add_rtn_u64 v[118:119], v123, v[124:125] offset:54272
    s_mov_b64 exec, -1
    v_ashrrev_i32 v122, 5, v50
    v_lshlrev_b16 v123, 2, v50
    v_lshlrev_b32 v124, 16, v4
    v_bitop3_b32 v122, v122, v113, v113 bitop3:0x0c
    v_and_b32 v125, 0xffff0000, v4
    v_lshlrev_b32 v126, 16, v5
    v_mul_f32 v122, v114, v122
    v_and_b32 v127, 0xffff0000, v5
    v_add_u32 v123, v123, v123
    v_pk_fma_f32 v[124:125], v[124:125], v[122:123], s[34:35] op_sel_hi:[1,0,1]
    v_pk_fma_f32 v[126:127], v[126:127], v[122:123], s[34:35] op_sel_hi:[1,0,1]
    v_lshl_add_u32 v124, v125, 16, v124
    v_lshl_add_u32 v125, v127, 16, v126
    s_waitcnt lgkmcnt(15)
    v_bitop3_b32 v115, v115, v120, v121 bitop3:0xfe
    v_lshl_add_u64 v[124:125], v[124:125], 0, s[36:37]
    v_cmpx_le_u32 vcc, 0x1000000, v50
    ds_add_rtn_u64 v[120:121], v123, v[124:125] offset:54272
    s_mov_b64 exec, -1
    s_waitcnt lgkmcnt(15)
    v_ashrrev_i32 v122, 5, v51
    v_lshlrev_b16 v123, 2, v51
    v_lshlrev_b32 v124, 16, v6
    v_bitop3_b32 v122, v122, v113, v113 bitop3:0x0c
    v_and_b32 v125, 0xffff0000, v6
    v_lshlrev_b32 v126, 16, v7
    v_mul_f32 v122, v114, v122
    v_and_b32 v127, 0xffff0000, v7
    v_add_u32 v123, v123, v123
    v_pk_fma_f32 v[124:125], v[124:125], v[122:123], s[34:35] op_sel_hi:[1,0,1]
    v_pk_fma_f32 v[126:127], v[126:127], v[122:123], s[34:35] op_sel_hi:[1,0,1]
    v_lshl_add_u32 v124, v125, 16, v124
    v_lshl_add_u32 v125, v127, 16, v126
    s_waitcnt lgkmcnt(2)
    v_bitop3_b32 v115, v115, v116, v117 bitop3:0xfe
    v_lshl_add_u64 v[124:125], v[124:125], 0, s[36:37]
    v_cmpx_le_u32 vcc, 0x1000000, v51
    ds_add_rtn_u64 v[116:117], v123, v[124:125] offset:54272
    s_mov_b64 exec, -1
    v_ashrrev_i32 v122, 5, v52
    v_lshlrev_b16 v123, 2, v52
    v_lshlrev_b32 v124, 16, v8
    v_bitop3_b32 v122, v122, v113, v113 bitop3:0x0c
    v_and_b32 v125, 0xffff0000, v8
    v_lshlrev_b32 v126, 16, v9
    v_mul_f32 v122, v114, v122
    v_and_b32 v127, 0xffff0000, v9
    v_add_u32 v123, v123, v123
    v_pk_fma_f32 v[124:125], v[124:125], v[122:123], s[34:35] op_sel_hi:[1,0,1]
    v_pk_fma_f32 v[126:127], v[126:127], v[122:123], s[34:35] op_sel_hi:[1,0,1]
    v_lshl_add_u32 v124, v125, 16, v124
    v_lshl_add_u32 v125, v127, 16, v126
    s_waitcnt lgkmcnt(2)
    v_bitop3_b32 v115, v115, v118, v119 bitop3:0xfe
    v_lshl_add_u64 v[124:125], v[124:125], 0, s[36:37]
    v_cmpx_le_u32 vcc, 0x1000000, v52
    ds_add_rtn_u64 v[118:119], v123, v[124:125] offset:54272
    s_mov_b64 exec, -1
    v_ashrrev_i32 v122, 5, v53
    v_lshlrev_b16 v123, 2, v53
    v_lshlrev_b32 v124, 16, v10
    v_bitop3_b32 v122, v122, v113, v113 bitop3:0x0c
    v_and_b32 v125, 0xffff0000, v10
    v_lshlrev_b32 v126, 16, v11
    v_mul_f32 v122, v114, v122
    v_and_b32 v127, 0xffff0000, v11
    v_add_u32 v123, v123, v123
    v_pk_fma_f32 v[124:125], v[124:125], v[122:123], s[34:35] op_sel_hi:[1,0,1]
    v_pk_fma_f32 v[126:127], v[126:127], v[122:123], s[34:35] op_sel_hi:[1,0,1]
    v_lshl_add_u32 v124, v125, 16, v124
    v_lshl_add_u32 v125, v127, 16, v126
    s_waitcnt lgkmcnt(2)
    v_bitop3_b32 v115, v115, v120, v121 bitop3:0xfe
    v_lshl_add_u64 v[124:125], v[124:125], 0, s[36:37]
    v_cmpx_le_u32 vcc, 0x1000000, v53
    ds_add_rtn_u64 v[120:121], v123, v[124:125] offset:54272
    s_mov_b64 exec, -1
    s_waitcnt lgkmcnt(15)
    v_ashrrev_i32 v122, 5, v54
    v_lshlrev_b16 v123, 2, v54
    v_lshlrev_b32 v124, 16, v12
    v_bitop3_b32 v122, v122, v113, v113 bitop3:0x0c
    v_and_b32 v125, 0xffff0000, v12
    v_lshlrev_b32 v126, 16, v13
    v_mul_f32 v122, v114, v122
    v_and_b32 v127, 0xffff0000, v13
    v_add_u32 v123, v123, v123
    v_pk_fma_f32 v[124:125], v[124:125], v[122:123], s[34:35] op_sel_hi:[1,0,1]
    v_pk_fma_f32 v[126:127], v[126:127], v[122:123], s[34:35] op_sel_hi:[1,0,1]
    v_lshl_add_u32 v124, v125, 16, v124
    v_lshl_add_u32 v125, v127, 16, v126
    s_waitcnt lgkmcnt(2)
    v_bitop3_b32 v115, v115, v116, v117 bitop3:0xfe
    v_lshl_add_u64 v[124:125], v[124:125], 0, s[36:37]
    v_cmpx_le_u32 vcc, 0x1000000, v54
    ds_add_rtn_u64 v[116:117], v123, v[124:125] offset:54272
    s_mov_b64 exec, -1
    v_ashrrev_i32 v122, 5, v55
    v_lshlrev_b16 v123, 2, v55
    v_lshlrev_b32 v124, 16, v14
    v_bitop3_b32 v122, v122, v113, v113 bitop3:0x0c
    v_and_b32 v125, 0xffff0000, v14
    v_lshlrev_b32 v126, 16, v15
    v_mul_f32 v122, v114, v122
    v_and_b32 v127, 0xffff0000, v15
    v_add_u32 v123, v123, v123
    v_pk_fma_f32 v[124:125], v[124:125], v[122:123], s[34:35] op_sel_hi:[1,0,1]
    v_pk_fma_f32 v[126:127], v[126:127], v[122:123], s[34:35] op_sel_hi:[1,0,1]
    v_lshl_add_u32 v124, v125, 16, v124
    v_lshl_add_u32 v125, v127, 16, v126
    s_waitcnt lgkmcnt(2)
    v_bitop3_b32 v115, v115, v118, v119 bitop3:0xfe
    v_lshl_add_u64 v[124:125], v[124:125], 0, s[36:37]
    v_cmpx_le_u32 vcc, 0x1000000, v55
    ds_add_rtn_u64 v[118:119], v123, v[124:125] offset:54272
    s_mov_b64 exec, -1
    v_ashrrev_i32 v122, 5, v56
    v_lshlrev_b16 v123, 2, v56
    v_lshlrev_b32 v124, 16, v16
    v_bitop3_b32 v122, v122, v113, v113 bitop3:0x0c
    v_and_b32 v125, 0xffff0000, v16
    v_lshlrev_b32 v126, 16, v17
    v_mul_f32 v122, v114, v122
    v_and_b32 v127, 0xffff0000, v17
    v_add_u32 v123, v123, v123
    v_pk_fma_f32 v[124:125], v[124:125], v[122:123], s[34:35] op_sel_hi:[1,0,1]
    v_pk_fma_f32 v[126:127], v[126:127], v[122:123], s[34:35] op_sel_hi:[1,0,1]
    v_lshl_add_u32 v124, v125, 16, v124
    v_lshl_add_u32 v125, v127, 16, v126
    s_waitcnt lgkmcnt(2)
    v_bitop3_b32 v115, v115, v120, v121 bitop3:0xfe
    v_lshl_add_u64 v[124:125], v[124:125], 0, s[36:37]
    v_cmpx_le_u32 vcc, 0x1000000, v56
    ds_add_rtn_u64 v[120:121], v123, v[124:125] offset:54272
    s_mov_b64 exec, -1
    s_waitcnt lgkmcnt(15)
    v_ashrrev_i32 v122, 5, v57
    v_lshlrev_b16 v123, 2, v57
    v_lshlrev_b32 v124, 16, v18
    v_bitop3_b32 v122, v122, v113, v113 bitop3:0x0c
    v_and_b32 v125, 0xffff0000, v18
    v_lshlrev_b32 v126, 16, v19
    v_mul_f32 v122, v114, v122
    v_and_b32 v127, 0xffff0000, v19
    v_add_u32 v123, v123, v123
    v_pk_fma_f32 v[124:125], v[124:125], v[122:123], s[34:35] op_sel_hi:[1,0,1]
    v_pk_fma_f32 v[126:127], v[126:127], v[122:123], s[34:35] op_sel_hi:[1,0,1]
    v_lshl_add_u32 v124, v125, 16, v124
    v_lshl_add_u32 v125, v127, 16, v126
    s_waitcnt lgkmcnt(2)
    v_bitop3_b32 v115, v115, v116, v117 bitop3:0xfe
    v_lshl_add_u64 v[124:125], v[124:125], 0, s[36:37]
    v_cmpx_le_u32 vcc, 0x1000000, v57
    ds_add_rtn_u64 v[116:117], v123, v[124:125] offset:54272
    s_mov_b64 exec, -1
    v_ashrrev_i32 v122, 5, v58
    v_lshlrev_b16 v123, 2, v58
    v_lshlrev_b32 v124, 16, v20
    v_bitop3_b32 v122, v122, v113, v113 bitop3:0x0c
    v_and_b32 v125, 0xffff0000, v20
    v_lshlrev_b32 v126, 16, v21
    v_mul_f32 v122, v114, v122
    v_and_b32 v127, 0xffff0000, v21
    v_add_u32 v123, v123, v123
    v_pk_fma_f32 v[124:125], v[124:125], v[122:123], s[34:35] op_sel_hi:[1,0,1]
    v_pk_fma_f32 v[126:127], v[126:127], v[122:123], s[34:35] op_sel_hi:[1,0,1]
    v_lshl_add_u32 v124, v125, 16, v124
    v_lshl_add_u32 v125, v127, 16, v126
    s_waitcnt lgkmcnt(2)
    v_bitop3_b32 v115, v115, v118, v119 bitop3:0xfe
    v_lshl_add_u64 v[124:125], v[124:125], 0, s[36:37]
    v_cmpx_le_u32 vcc, 0x1000000, v58
    ds_add_rtn_u64 v[118:119], v123, v[124:125] offset:54272
    s_mov_b64 exec, -1
    v_ashrrev_i32 v122, 5, v59
    v_lshlrev_b16 v123, 2, v59
    v_lshlrev_b32 v124, 16, v22
    v_bitop3_b32 v122, v122, v113, v113 bitop3:0x0c
    v_and_b32 v125, 0xffff0000, v22
    v_lshlrev_b32 v126, 16, v23
    v_mul_f32 v122, v114, v122
    v_and_b32 v127, 0xffff0000, v23
    v_add_u32 v123, v123, v123
    v_pk_fma_f32 v[124:125], v[124:125], v[122:123], s[34:35] op_sel_hi:[1,0,1]
    v_pk_fma_f32 v[126:127], v[126:127], v[122:123], s[34:35] op_sel_hi:[1,0,1]
    v_lshl_add_u32 v124, v125, 16, v124
    v_lshl_add_u32 v125, v127, 16, v126
    s_waitcnt lgkmcnt(2)
    v_bitop3_b32 v115, v115, v120, v121 bitop3:0xfe
    v_lshl_add_u64 v[124:125], v[124:125], 0, s[36:37]
    v_cmpx_le_u32 vcc, 0x1000000, v59
    ds_add_rtn_u64 v[120:121], v123, v[124:125] offset:54272
    s_mov_b64 exec, -1
    s_waitcnt lgkmcnt(15)
    v_ashrrev_i32 v122, 5, v60
    v_lshlrev_b16 v123, 2, v60
    v_lshlrev_b32 v124, 16, v24
    v_bitop3_b32 v122, v122, v113, v113 bitop3:0x0c
    v_and_b32 v125, 0xffff0000, v24
    v_lshlrev_b32 v126, 16, v25
    v_mul_f32 v122, v114, v122
    v_and_b32 v127, 0xffff0000, v25
    v_add_u32 v123, v123, v123
    v_pk_fma_f32 v[124:125], v[124:125], v[122:123], s[34:35] op_sel_hi:[1,0,1]
    v_pk_fma_f32 v[126:127], v[126:127], v[122:123], s[34:35] op_sel_hi:[1,0,1]
    v_lshl_add_u32 v124, v125, 16, v124
    v_lshl_add_u32 v125, v127, 16, v126
    s_waitcnt lgkmcnt(2)
    v_bitop3_b32 v115, v115, v116, v117 bitop3:0xfe
    v_lshl_add_u64 v[124:125], v[124:125], 0, s[36:37]
    v_cmpx_le_u32 vcc, 0x1000000, v60
    ds_add_rtn_u64 v[116:117], v123, v[124:125] offset:54272
    s_mov_b64 exec, -1
    v_ashrrev_i32 v122, 5, v61
    v_lshlrev_b16 v123, 2, v61
    v_lshlrev_b32 v124, 16, v26
    v_bitop3_b32 v122, v122, v113, v113 bitop3:0x0c
    v_and_b32 v125, 0xffff0000, v26
    v_lshlrev_b32 v126, 16, v27
    v_mul_f32 v122, v114, v122
    v_and_b32 v127, 0xffff0000, v27
    v_add_u32 v123, v123, v123
    v_pk_fma_f32 v[124:125], v[124:125], v[122:123], s[34:35] op_sel_hi:[1,0,1]
    v_pk_fma_f32 v[126:127], v[126:127], v[122:123], s[34:35] op_sel_hi:[1,0,1]
    v_lshl_add_u32 v124, v125, 16, v124
    v_lshl_add_u32 v125, v127, 16, v126
    s_waitcnt lgkmcnt(2)
    v_bitop3_b32 v115, v115, v118, v119 bitop3:0xfe
    v_lshl_add_u64 v[124:125], v[124:125], 0, s[36:37]
    v_cmpx_le_u32 vcc, 0x1000000, v61
    ds_add_rtn_u64 v[118:119], v123, v[124:125] offset:54272
    s_mov_b64 exec, -1
    v_ashrrev_i32 v122, 5, v62
    v_lshlrev_b16 v123, 2, v62
    v_lshlrev_b32 v124, 16, v28
    v_bitop3_b32 v122, v122, v113, v113 bitop3:0x0c
    v_and_b32 v125, 0xffff0000, v28
    v_lshlrev_b32 v126, 16, v29
    v_mul_f32 v122, v114, v122
    v_and_b32 v127, 0xffff0000, v29
    v_add_u32 v123, v123, v123
    v_pk_fma_f32 v[124:125], v[124:125], v[122:123], s[34:35] op_sel_hi:[1,0,1]
    v_pk_fma_f32 v[126:127], v[126:127], v[122:123], s[34:35] op_sel_hi:[1,0,1]
    v_lshl_add_u32 v124, v125, 16, v124
    v_lshl_add_u32 v125, v127, 16, v126
    s_waitcnt lgkmcnt(2)
    v_bitop3_b32 v115, v115, v120, v121 bitop3:0xfe
    v_lshl_add_u64 v[124:125], v[124:125], 0, s[36:37]
    v_cmpx_le_u32 vcc, 0x1000000, v62
    ds_add_rtn_u64 v[120:121], v123, v[124:125] offset:54272
    s_mov_b64 exec, -1
    s_waitcnt lgkmcnt(15)
    v_ashrrev_i32 v122, 5, v63
    v_lshlrev_b16 v123, 2, v63
    v_lshlrev_b32 v124, 16, v30
    v_bitop3_b32 v122, v122, v113, v113 bitop3:0x0c
    v_and_b32 v125, 0xffff0000, v30
    v_lshlrev_b32 v126, 16, v31
    v_mul_f32 v122, v114, v122
    v_and_b32 v127, 0xffff0000, v31
    v_add_u32 v123, v123, v123
    v_pk_fma_f32 v[124:125], v[124:125], v[122:123], s[34:35] op_sel_hi:[1,0,1]
    v_pk_fma_f32 v[126:127], v[126:127], v[122:123], s[34:35] op_sel_hi:[1,0,1]
    v_lshl_add_u32 v124, v125, 16, v124
    v_lshl_add_u32 v125, v127, 16, v126
    s_waitcnt lgkmcnt(2)
    v_bitop3_b32 v115, v115, v116, v117 bitop3:0xfe
    v_lshl_add_u64 v[124:125], v[124:125], 0, s[36:37]
    v_cmpx_le_u32 vcc, 0x1000000, v63
    ds_add_rtn_u64 v[116:117], v123, v[124:125] offset:54272
    s_mov_b64 exec, -1
    v_ashrrev_i32 v122, 5, v64
    v_lshlrev_b16 v123, 2, v64
    v_lshlrev_b32 v124, 16, v32
    v_bitop3_b32 v122, v122, v113, v113 bitop3:0x0c
    v_and_b32 v125, 0xffff0000, v32
    v_lshlrev_b32 v126, 16, v33
    v_mul_f32 v122, v114, v122
    v_and_b32 v127, 0xffff0000, v33
    v_add_u32 v123, v123, v123
    v_pk_fma_f32 v[124:125], v[124:125], v[122:123], s[34:35] op_sel_hi:[1,0,1]
    v_pk_fma_f32 v[126:127], v[126:127], v[122:123], s[34:35] op_sel_hi:[1,0,1]
    v_lshl_add_u32 v124, v125, 16, v124
    v_lshl_add_u32 v125, v127, 16, v126
    s_waitcnt lgkmcnt(2)
    v_bitop3_b32 v115, v115, v118, v119 bitop3:0xfe
    v_lshl_add_u64 v[124:125], v[124:125], 0, s[36:37]
    v_cmpx_le_u32 vcc, 0x1000000, v64
    ds_add_rtn_u64 v[118:119], v123, v[124:125] offset:54272
    s_mov_b64 exec, -1
    v_ashrrev_i32 v122, 5, v65
    v_lshlrev_b16 v123, 2, v65
    v_lshlrev_b32 v124, 16, v34
    v_bitop3_b32 v122, v122, v113, v113 bitop3:0x0c
    v_and_b32 v125, 0xffff0000, v34
    v_lshlrev_b32 v126, 16, v35
    v_mul_f32 v122, v114, v122
    v_and_b32 v127, 0xffff0000, v35
    v_add_u32 v123, v123, v123
    v_pk_fma_f32 v[124:125], v[124:125], v[122:123], s[34:35] op_sel_hi:[1,0,1]
    v_pk_fma_f32 v[126:127], v[126:127], v[122:123], s[34:35] op_sel_hi:[1,0,1]
    v_lshl_add_u32 v124, v125, 16, v124
    v_lshl_add_u32 v125, v127, 16, v126
    s_waitcnt lgkmcnt(2)
    v_bitop3_b32 v115, v115, v120, v121 bitop3:0xfe
    v_lshl_add_u64 v[124:125], v[124:125], 0, s[36:37]
    v_cmpx_le_u32 vcc, 0x1000000, v65
    ds_add_rtn_u64 v[120:121], v123, v[124:125] offset:54272
    s_mov_b64 exec, -1
    s_waitcnt lgkmcnt(15)
    v_ashrrev_i32 v122, 5, v66
    v_lshlrev_b16 v123, 2, v66
    v_lshlrev_b32 v124, 16, v36
    v_bitop3_b32 v122, v122, v113, v113 bitop3:0x0c
    v_and_b32 v125, 0xffff0000, v36
    v_lshlrev_b32 v126, 16, v37
    v_mul_f32 v122, v114, v122
    v_and_b32 v127, 0xffff0000, v37
    v_add_u32 v123, v123, v123
    v_pk_fma_f32 v[124:125], v[124:125], v[122:123], s[34:35] op_sel_hi:[1,0,1]
    v_pk_fma_f32 v[126:127], v[126:127], v[122:123], s[34:35] op_sel_hi:[1,0,1]
    v_lshl_add_u32 v124, v125, 16, v124
    v_lshl_add_u32 v125, v127, 16, v126
    s_waitcnt lgkmcnt(2)
    v_bitop3_b32 v115, v115, v116, v117 bitop3:0xfe
    v_lshl_add_u64 v[124:125], v[124:125], 0, s[36:37]
    v_cmpx_le_u32 vcc, 0x1000000, v66
    ds_add_rtn_u64 v[116:117], v123, v[124:125] offset:54272
    s_mov_b64 exec, -1
    v_ashrrev_i32 v122, 5, v67
    v_lshlrev_b16 v123, 2, v67
    v_lshlrev_b32 v124, 16, v38
    v_bitop3_b32 v122, v122, v113, v113 bitop3:0x0c
    v_and_b32 v125, 0xffff0000, v38
    v_lshlrev_b32 v126, 16, v39
    v_mul_f32 v122, v114, v122
    v_and_b32 v127, 0xffff0000, v39
    v_add_u32 v123, v123, v123
    v_pk_fma_f32 v[124:125], v[124:125], v[122:123], s[34:35] op_sel_hi:[1,0,1]
    v_pk_fma_f32 v[126:127], v[126:127], v[122:123], s[34:35] op_sel_hi:[1,0,1]
    v_lshl_add_u32 v124, v125, 16, v124
    v_lshl_add_u32 v125, v127, 16, v126
    s_waitcnt lgkmcnt(2)
    v_bitop3_b32 v115, v115, v118, v119 bitop3:0xfe
    v_lshl_add_u64 v[124:125], v[124:125], 0, s[36:37]
    v_cmpx_le_u32 vcc, 0x1000000, v67
    ds_add_rtn_u64 v[118:119], v123, v[124:125] offset:54272
    s_mov_b64 exec, -1
    v_ashrrev_i32 v122, 5, v68
    v_lshlrev_b16 v123, 2, v68
    v_lshlrev_b32 v124, 16, v40
    v_bitop3_b32 v122, v122, v113, v113 bitop3:0x0c
    v_and_b32 v125, 0xffff0000, v40
    v_lshlrev_b32 v126, 16, v41
    v_mul_f32 v122, v114, v122
    v_and_b32 v127, 0xffff0000, v41
    v_add_u32 v123, v123, v123
    v_pk_fma_f32 v[124:125], v[124:125], v[122:123], s[34:35] op_sel_hi:[1,0,1]
    v_pk_fma_f32 v[126:127], v[126:127], v[122:123], s[34:35] op_sel_hi:[1,0,1]
    v_lshl_add_u32 v124, v125, 16, v124
    v_lshl_add_u32 v125, v127, 16, v126
    s_waitcnt lgkmcnt(2)
    v_bitop3_b32 v115, v115, v120, v121 bitop3:0xfe
    v_lshl_add_u64 v[124:125], v[124:125], 0, s[36:37]
    v_cmpx_le_u32 vcc, 0x1000000, v68
    ds_add_rtn_u64 v[120:121], v123, v[124:125] offset:54272
    s_mov_b64 exec, -1
    s_cmp_le_u32 s15, 7
    s_cbranch_scc1 p2_nad0
    s_waitcnt lgkmcnt(15)
    v_ashrrev_i32 v122, 5, v69
    v_lshlrev_b16 v123, 2, v69
    v_lshlrev_b32 v124, 16, v42
    v_bitop3_b32 v122, v122, v113, v113 bitop3:0x0c
    v_and_b32 v125, 0xffff0000, v42
    v_lshlrev_b32 v126, 16, v43
    v_mul_f32 v122, v114, v122
    v_and_b32 v127, 0xffff0000, v43
    v_add_u32 v123, v123, v123
    v_pk_fma_f32 v[124:125], v[124:125], v[122:123], s[34:35] op_sel_hi:[1,0,1]
    v_pk_fma_f32 v[126:127], v[126:127], v[122:123], s[34:35] op_sel_hi:[1,0,1]
    v_lshl_add_u32 v124, v125, 16, v124
    v_lshl_add_u32 v125, v127, 16, v126
    s_waitcnt lgkmcnt(2)
    v_bitop3_b32 v115, v115, v116, v117 bitop3:0xfe
    v_lshl_add_u64 v[124:125], v[124:125], 0, s[36:37]
    v_cmpx_le_u32 vcc, 0x1000000, v69
    ds_add_rtn_u64 v[116:117], v123, v[124:125] offset:54272
    s_mov_b64 exec, -1
    v_ashrrev_i32 v122, 5, v70
    v_lshlrev_b16 v123, 2, v70
    v_lshlrev_b32 v124, 16, v44
    v_bitop3_b32 v122, v122, v113, v113 bitop3:0x0c
    v_and_b32 v125, 0xffff0000, v44
    v_lshlrev_b32 v126, 16, v45
    v_mul_f32 v122, v114, v122
    v_and_b32 v127, 0xffff0000, v45
    v_add_u32 v123, v123, v123
    v_pk_fma_f32 v[124:125], v[124:125], v[122:123], s[34:35] op_sel_hi:[1,0,1]
    v_pk_fma_f32 v[126:127], v[126:127], v[122:123], s[34:35] op_sel_hi:[1,0,1]
    v_lshl_add_u32 v124, v125, 16, v124
    v_lshl_add_u32 v125, v127, 16, v126
    s_waitcnt lgkmcnt(2)
    v_bitop3_b32 v115, v115, v118, v119 bitop3:0xfe
    v_lshl_add_u64 v[124:125], v[124:125], 0, s[36:37]
    v_cmpx_le_u32 vcc, 0x1000000, v70
    ds_add_rtn_u64 v[118:119], v123, v[124:125] offset:54272
    s_mov_b64 exec, -1
    v_ashrrev_i32 v122, 5, v71
    v_lshlrev_b16 v123, 2, v71
    v_lshlrev_b32 v124, 16, v46
    v_bitop3_b32 v122, v122, v113, v113 bitop3:0x0c
    v_and_b32 v125, 0xffff0000, v46
    v_lshlrev_b32 v126, 16, v47
    v_mul_f32 v122, v114, v122
    v_and_b32 v127, 0xffff0000, v47
    v_add_u32 v123, v123, v123
    v_pk_fma_f32 v[124:125], v[124:125], v[122:123], s[34:35] op_sel_hi:[1,0,1]
    v_pk_fma_f32 v[126:127], v[126:127], v[122:123], s[34:35] op_sel_hi:[1,0,1]
    v_lshl_add_u32 v124, v125, 16, v124
    v_lshl_add_u32 v125, v127, 16, v126
    s_waitcnt lgkmcnt(2)
    v_bitop3_b32 v115, v115, v120, v121 bitop3:0xfe
    v_lshl_add_u64 v[124:125], v[124:125], 0, s[36:37]
    v_cmpx_le_u32 vcc, 0x1000000, v71
    ds_add_rtn_u64 v[120:121], v123, v[124:125] offset:54272
    s_mov_b64 exec, -1
p2_nad0:
    s_branch p2_fin
p2_topf:
    s_cmp_eq_u32 s60, 10
    s_cbranch_scc1 p2_drain1
    v_cmpx_gt_i16 vcc, 0, v48
    ds_read_b64 v[0:1], v0
    s_mov_b64 exec, -1
    v_cmpx_gt_i16 vcc, 0, v49
    ds_read_b64 v[2:3], v2
    s_mov_b64 exec, -1
    v_cmpx_gt_i16 vcc, 0, v50
    ds_read_b64 v[4:5], v4
    s_mov_b64 exec, -1
    v_cmpx_gt_i16 vcc, 0, v51
    ds_read_b64 v[6:7], v6
    s_mov_b64 exec, -1
    v_cmpx_gt_i16 vcc, 0, v52
    ds_read_b64 v[8:9], v8
    s_mov_b64 exec, -1
    v_cmpx_gt_i16 vcc, 0, v53
    ds_read_b64 v[10:11], v10
    s_mov_b64 exec, -1
    v_cmpx_gt_i16 vcc, 0, v54
    ds_read_b64 v[12:13], v12
    s_mov_b64 exec, -1
    v_cmpx_gt_i16 vcc, 0, v55
    ds_read_b64 v[14:15], v14
    s_mov_b64 exec, -1
    v_cmpx_gt_i16 vcc, 0, v56
    ds_read_b64 v[16:17], v16
    s_mov_b64 exec, -1
    v_cmpx_gt_i16 vcc, 0, v57
    ds_read_b64 v[18:19], v18
    s_mov_b64 exec, -1
    v_cmpx_gt_i16 vcc, 0, v58
    ds_read_b64 v[20:21], v20
    s_mov_b64 exec, -1
    v_cmpx_gt_i16 vcc, 0, v59
    ds_read_b64 v[22:23], v22
    s_mov_b64 exec, -1
    s_cmp_ge_u32 s10, 9
    s_cbranch_scc1 p2_nm1m0a
    v_lshrrev_b32 v84, 1, v112
    s_add_u32 s44, s20, s42
    buffer_load_dwordx2 v[84:85], v84, s[4:7], s44 offen
p2_nm1m0a:
    buffer_load_dwordx4 v[72:75], v112, s[4:7], s20 offen offset:0
    buffer_load_dwordx4 v[76:79], v112, s[4:7], s20 offen offset:1024
    buffer_load_dwordx4 v[80:83], v112, s[4:7], s20 offen offset:2048
    v_cmpx_gt_i16 vcc, 0, v60
    ds_read_b64 v[24:25], v24
    s_mov_b64 exec, -1
    v_cmpx_gt_i16 vcc, 0, v61
    ds_read_b64 v[26:27], v26
    s_mov_b64 exec, -1
    v_cmpx_gt_i16 vcc, 0, v62
    ds_read_b64 v[28:29], v28
    s_mov_b64 exec, -1
    v_cmpx_gt_i16 vcc, 0, v63
    ds_read_b64 v[30:31], v30
    s_mov_b64 exec, -1
    v_cmpx_gt_i16 vcc, 0, v64
    ds_read_b64 v[32:33], v32
    s_mov_b64 exec, -1
    v_cmpx_gt_i16 vcc, 0, v65
    ds_read_b64 v[34:35], v34
    s_mov_b64 exec, -1
    v_cmpx_gt_i16 vcc, 0, v66
    ds_read_b64 v[36:37], v36
    s_mov_b64 exec, -1
    v_cmpx_gt_i16 vcc, 0, v67
    ds_read_b64 v[38:39], v38
    s_mov_b64 exec, -1
    v_cmpx_gt_i16 vcc, 0, v68
    ds_read_b64 v[40:41], v40
    s_mov_b64 exec, -1
    s_cmp_le_u32 s15, 7
    s_cbranch_scc1 p2_g1r27
    v_cmpx_gt_i16 vcc, 0, v69
    ds_read_b64 v[42:43], v42
    s_mov_b64 exec, -1
    v_cmpx_gt_i16 vcc, 0, v70
    ds_read_b64 v[44:45], v44
    s_mov_b64 exec, -1
    v_cmpx_gt_i16 vcc, 0, v71
    ds_read_b64 v[46:47], v46
    s_mov_b64 exec, -1
p2_g1r27:
    s_waitcnt lgkmcnt(15)
    v_ashrrev_i32 v122, 5, v48
    v_lshlrev_b16 v123, 2, v48
    v_cndmask_b32 v126, v0, v1, s[66:67]
    v_bitop3_b32 v122, v122, v113, v113 bitop3:0x0c
    v_lshlrev_b32 v124, 16, v126
    v_mul_f32 v122, v114, v122
    v_and_b32 v125, 0xffff0000, v126
    v_add_u32 v123, v123, v123
    v_mul_f32 v124, v122, v124
    v_mul_f32 v125, v122, v125
    v_cmpx_le_u32 vcc, 0x1000000, v48
    ds_add_f32 v123, v124 offset:54272
    ds_add_f32 v123, v125 offset:54276
    s_mov_b64 exec, -1
    v_ashrrev_i32 v122, 5, v49
    v_lshlrev_b16 v123, 2, v49
    v_cndmask_b32 v126, v2, v3, s[66:67]
    v_bitop3_b32 v122, v122, v113, v113 bitop3:0x0c
    v_lshlrev_b32 v124, 16, v126
    v_mul_f32 v122, v114, v122
    v_and_b32 v125, 0xffff0000, v126
    v_add_u32 v123, v123, v123
    v_mul_f32 v124, v122, v124
    v_mul_f32 v125, v122, v125
    v_cmpx_le_u32 vcc, 0x1000000, v49
    ds_add_f32 v123, v124 offset:54272
    ds_add_f32 v123, v125 offset:54276
    s_mov_b64 exec, -1
    v_ashrrev_i32 v122, 5, v50
    v_lshlrev_b16 v123, 2, v50
    v_cndmask_b32 v126, v4, v5, s[66:67]
    v_bitop3_b32 v122, v122, v113, v113 bitop3:0x0c
    v_lshlrev_b32 v124, 16, v126
    v_mul_f32 v122, v114, v122
    v_and_b32 v125, 0xffff0000, v126
    v_add_u32 v123, v123, v123
    v_mul_f32 v124, v122, v124
    v_mul_f32 v125, v122, v125
    v_cmpx_le_u32 vcc, 0x1000000, v50
    ds_add_f32 v123, v124 offset:54272
    ds_add_f32 v123, v125 offset:54276
    s_mov_b64 exec, -1
    v_bfe_u32 v0, v102, 14, 4
    v_lshrrev_b32 v1, 18, v102
    v_and_b32 v102, 0x3fff, v102
    v_mad_u32_u24 v0, v0, s63, v1
    v_lshl_or_b32 v102, v0, 14, v102
    buffer_load_dwordx4 v[0:3], v102, s[68:71], 0 offen
    s_waitcnt lgkmcnt(15)
    v_ashrrev_i32 v122, 5, v51
    v_lshlrev_b16 v123, 2, v51
    v_cndmask_b32 v126, v6, v7, s[66:67]
    v_bitop3_b32 v122, v122, v113, v113 bitop3:0x0c
    v_lshlrev_b32 v124, 16, v126
    v_mul_f32 v122, v114, v122
    v_and_b32 v125, 0xffff0000, v126
    v_add_u32 v123, v123, v123
    v_mul_f32 v124, v122, v124
    v_mul_f32 v125, v122, v125
    v_cmpx_le_u32 vcc, 0x1000000, v51
    ds_add_f32 v123, v124 offset:54272
    ds_add_f32 v123, v125 offset:54276
    s_mov_b64 exec, -1
    v_ashrrev_i32 v122, 5, v52
    v_lshlrev_b16 v123, 2, v52
    v_cndmask_b32 v126, v8, v9, s[66:67]
    v_bitop3_b32 v122, v122, v113, v113 bitop3:0x0c
    v_lshlrev_b32 v124, 16, v126
    v_mul_f32 v122, v114, v122
    v_and_b32 v125, 0xffff0000, v126
    v_add_u32 v123, v123, v123
    v_mul_f32 v124, v122, v124
    v_mul_f32 v125, v122, v125
    v_cmpx_le_u32 vcc, 0x1000000, v52
    ds_add_f32 v123, v124 offset:54272
    ds_add_f32 v123, v125 offset:54276
    s_mov_b64 exec, -1
    v_ashrrev_i32 v122, 5, v53
    v_lshlrev_b16 v123, 2, v53
    v_cndmask_b32 v126, v10, v11, s[66:67]
    v_bitop3_b32 v122, v122, v113, v113 bitop3:0x0c
    v_lshlrev_b32 v124, 16, v126
    v_mul_f32 v122, v114, v122
    v_and_b32 v125, 0xffff0000, v126
    v_add_u32 v123, v123, v123
    v_mul_f32 v124, v122, v124
    v_mul_f32 v125, v122, v125
    v_cmpx_le_u32 vcc, 0x1000000, v53
    ds_add_f32 v123, v124 offset:54272
    ds_add_f32 v123, v125 offset:54276
    s_mov_b64 exec, -1
    v_bfe_u32 v6, v103, 14, 4
    v_lshrrev_b32 v7, 18, v103
    v_and_b32 v103, 0x3fff, v103
    v_mad_u32_u24 v6, v6, s63, v7
    v_lshl_or_b32 v103, v6, 14, v103
    buffer_load_dwordx4 v[6:9], v103, s[68:71], 0 offen
    s_waitcnt lgkmcnt(12)
    s_barrier
    s_waitcnt vmcnt(6)
    s_mov_b32 m0, s23
    v_mov_b32 v53, 0x3c000
    s_movk_i32 s44, 512
    v_sub_u32_sdwa v4, v111, v110 dst_sel:DWORD dst_unused:UNUSED_PAD src0_sel:WORD_0 src1_sel:WORD_0
    v_sub_u32_sdwa v5, v111, v110 dst_sel:DWORD dst_unused:UNUSED_PAD src0_sel:WORD_1 src1_sel:WORD_1
    v_med3_i32 v4, v4, 0, s44
    v_med3_i32 v5, v5, 0, s44
    v_add_u32 v48, v4, v5
    ds_write_addtid_b32 v53 offset:0
    ds_write_addtid_b32 v53 offset:256
    ds_write_addtid_b32 v53 offset:512
    ds_write_addtid_b32 v53 offset:768
    ds_write_addtid_b32 v53 offset:1024
    ds_write_addtid_b32 v53 offset:1280
    ds_write_addtid_b32 v53 offset:1536
    ds_write_addtid_b32 v53 offset:1792
    v_bfe_i32 v53, v112, 6, 1
    v_lshrrev_b32 v49, 6, v112
    v_bitop3_b32 v53, v53, 15, s10 bitop3:0x6a
    v_lshl_or_b32 v49, v49, 4, v53
    v_and_b32 v53, 0x30, v112
    v_lshl_or_b32 v53, v49, 6, v53
    v_lshlrev_b32 v53, 15, v53
    s_nop 1
    v_add_u32_dpp v48, v48, v48 row_shr:1 row_mask:0xf bank_mask:0xf bound_ctrl:0
    s_nop 1
    v_add_u32_dpp v48, v48, v48 row_shr:2 row_mask:0xf bank_mask:0xf bound_ctrl:0
    s_nop 1
    v_add_u32_dpp v48, v48, v48 row_shr:4 row_mask:0xf bank_mask:0xf bound_ctrl:0
    s_nop 1
    v_add_u32_dpp v48, v48, v48 row_shr:8 row_mask:0xf bank_mask:0xf bound_ctrl:0
    s_nop 1
    v_add_u32_dpp v48, v48, v48 row_bcast:15 row_mask:0xa bank_mask:0xf
    s_nop 1
    v_add_u32_dpp v48, v48, v48 row_bcast:31 row_mask:0xc bank_mask:0xf
    s_nop 1
    s_nop 0
    v_readlane_b32 s38, v48, 63
    v_sub_u32 v50, v48, v5
    v_sub_u32 v49, v50, v4
    v_sub_u32 v10, 512, v49
    v_mad_u32_u16 v51, v110, 16, v53
    v_med3_i32 v10, v10, 0, v4
    v_lshl_add_u32 v49, v49, 2, s23
    v_sub_u32 v11, 512, v50
    v_mad_u32_u16 v52, v110, 16, v53 op_sel:[1,0,0,0]
    v_med3_i32 v11, v11, 0, v5
    v_lshl_add_u32 v50, v50, 2, s23
    v_lshl_add_u32 v48, v11, 16, v10
    v_add_u32 v52, 262144, v52
    v_add_u32 v110, v110, v48
    s_min_u32 s17, s38, 512
    s_add_u32 s17, s17, 63
    s_lshr_b32 s17, s17, 6
p2_x1x_0:
    v_cmpx_lt_i32 vcc, 0, v10
    s_cbranch_execz p2_y1x_0
    ds_write_b32 v49, v51 offset:0
    v_add_u32 v51, 16, v51
    v_cmpx_lt_i32 vcc, 1, v10
    s_cbranch_execz p2_y1x_0
    ds_write_b32 v49, v51 offset:4
    v_add_u32 v51, 16, v51
    v_cmpx_lt_i32 vcc, 2, v10
    s_cbranch_execz p2_y1x_0
    ds_write_b32 v49, v51 offset:8
    v_add_u32 v51, 16, v51
    v_cmpx_lt_i32 vcc, 3, v10
    s_cbranch_execz p2_y1x_0
    ds_write_b32 v49, v51 offset:12
    v_add_u32 v51, 16, v51
    v_cmpx_lt_i32 vcc, 4, v10
    s_cbranch_execz p2_y1x_0
    ds_write_b32 v49, v51 offset:16
    v_add_u32 v51, 16, v51
    v_cmpx_lt_i32 vcc, 5, v10
    s_cbranch_execz p2_y1x_0
    ds_write_b32 v49, v51 offset:20
    v_add_u32 v51, 16, v51
    v_cmpx_lt_i32 vcc, 6, v10
    s_cbranch_execz p2_y1x_0
    ds_write_b32 v49, v51 offset:24
    v_add_u32 v51, 16, v51
    v_cmpx_lt_i32 vcc, 7, v10
    s_cbranch_execz p2_y1x_0
    ds_write_b32 v49, v51 offset:28
    v_add_u32 v51, 16, v51
    v_subrev_u32 v10, 8, v10
    v_add_u32 v49, 32, v49
    s_branch p2_x1x_0
p2_y1x_0:
    s_mov_b64 exec, -1
p2_x1x_1:
    v_cmpx_lt_i32 vcc, 0, v11
    s_cbranch_execz p2_y1x_1
    ds_write_b32 v50, v52 offset:0
    v_add_u32 v52, 16, v52
    v_cmpx_lt_i32 vcc, 1, v11
    s_cbranch_execz p2_y1x_1
    ds_write_b32 v50, v52 offset:4
    v_add_u32 v52, 16, v52
    v_cmpx_lt_i32 vcc, 2, v11
    s_cbranch_execz p2_y1x_1
    ds_write_b32 v50, v52 offset:8
    v_add_u32 v52, 16, v52
    v_cmpx_lt_i32 vcc, 3, v11
    s_cbranch_execz p2_y1x_1
    ds_write_b32 v50, v52 offset:12
    v_add_u32 v52, 16, v52
    v_cmpx_lt_i32 vcc, 4, v11
    s_cbranch_execz p2_y1x_1
    ds_write_b32 v50, v52 offset:16
    v_add_u32 v52, 16, v52
    v_cmpx_lt_i32 vcc, 5, v11
    s_cbranch_execz p2_y1x_1
    ds_write_b32 v50, v52 offset:20
    v_add_u32 v52, 16, v52
    v_cmpx_lt_i32 vcc, 6, v11
    s_cbranch_execz p2_y1x_1
    ds_write_b32 v50, v52 offset:24
    v_add_u32 v52, 16, v52
    v_cmpx_lt_i32 vcc, 7, v11
    s_cbranch_execz p2_y1x_1
    ds_write_b32 v50, v52 offset:28
    v_add_u32 v52, 16, v52
    v_subrev_u32 v11, 8, v11
    v_add_u32 v50, 32, v50
    s_branch p2_x1x_1
p2_y1x_1:
    s_mov_b64 exec, -1
    s_cmp_lt_u32 s38, 512
    s_cbranch_scc1 p2_nomore1x
    v_cmp_lt_u32_sdwa s[44:45], v110, v111 src0_sel:WORD_0 src1_sel:WORD_0
    v_cmp_lt_u32_sdwa s[46:47], v110, v111 src0_sel:WORD_1 src1_sel:WORD_1
    s_nop 0
    s_or_b64 s[44:45], s[44:45], s[46:47]
    s_cbranch_scc0 p2_nomore1x
    v_mov_b32 v49, s19
    v_mov_b32 v50, 1
    ds_write_b32 v49, v50 offset:53760
p2_nomore1x:
    s_waitcnt lgkmcnt(15)
    v_ashrrev_i32 v122, 5, v54
    v_lshlrev_b16 v123, 2, v54
    v_cndmask_b32 v126, v12, v13, s[66:67]
    v_bitop3_b32 v122, v122, v113, v113 bitop3:0x0c
    v_lshlrev_b32 v124, 16, v126
    v_mul_f32 v122, v114, v122
    v_and_b32 v125, 0xffff0000, v126
    v_add_u32 v123, v123, v123
    v_mul_f32 v124, v122, v124
    v_mul_f32 v125, v122, v125
    v_cmpx_le_u32 vcc, 0x1000000, v54
    ds_add_f32 v123, v124 offset:54272
    ds_add_f32 v123, v125 offset:54276
    s_mov_b64 exec, -1
    v_ashrrev_i32 v122, 5, v55
    v_lshlrev_b16 v123, 2, v55
    v_cndmask_b32 v126, v14, v15, s[66:67]
    v_bitop3_b32 v122, v122, v113, v113 bitop3:0x0c
    v_lshlrev_b32 v124, 16, v126
    v_mul_f32 v122, v114, v122
    v_and_b32 v125, 0xffff0000, v126
    v_add_u32 v123, v123, v123
    v_mul_f32 v124, v122, v124
    v_mul_f32 v125, v122, v125
    v_cmpx_le_u32 vcc, 0x1000000, v55
    ds_add_f32 v123, v124 offset:54272
    ds_add_f32 v123, v125 offset:54276
    s_mov_b64 exec, -1
    v_ashrrev_i32 v122, 5, v56
    v_lshlrev_b16 v123, 2, v56
    v_cndmask_b32 v126, v16, v17, s[66:67]
    v_bitop3_b32 v122, v122, v113, v113 bitop3:0x0c
    v_lshlrev_b32 v124, 16, v126
    v_mul_f32 v122, v114, v122
    v_and_b32 v125, 0xffff0000, v126
    v_add_u32 v123, v123, v123
    v_mul_f32 v124, v122, v124
    v_mul_f32 v125, v122, v125
    v_cmpx_le_u32 vcc, 0x1000000, v56
    ds_add_f32 v123, v124 offset:54272
    ds_add_f32 v123, v125 offset:54276
    s_mov_b64 exec, -1
    v_bfe_u32 v12, v104, 14, 4
    v_lshrrev_b32 v13, 18, v104
    v_and_b32 v104, 0x3fff, v104
    v_mad_u32_u24 v12, v12, s63, v13
    v_lshl_or_b32 v104, v12, 14, v104
    buffer_load_dwordx4 v[12:15], v104, s[68:71], 0 offen
    s_waitcnt lgkmcnt(15)
    v_ashrrev_i32 v122, 5, v57
    v_lshlrev_b16 v123, 2, v57
    v_cndmask_b32 v126, v18, v19, s[66:67]
    v_bitop3_b32 v122, v122, v113, v113 bitop3:0x0c
    v_lshlrev_b32 v124, 16, v126
    v_mul_f32 v122, v114, v122
    v_and_b32 v125, 0xffff0000, v126
    v_add_u32 v123, v123, v123
    v_mul_f32 v124, v122, v124
    v_mul_f32 v125, v122, v125
    v_cmpx_le_u32 vcc, 0x1000000, v57
    ds_add_f32 v123, v124 offset:54272
    ds_add_f32 v123, v125 offset:54276
    s_mov_b64 exec, -1
    v_ashrrev_i32 v122, 5, v58
    v_lshlrev_b16 v123, 2, v58
    v_cndmask_b32 v126, v20, v21, s[66:67]
    v_bitop3_b32 v122, v122, v113, v113 bitop3:0x0c
    v_lshlrev_b32 v124, 16, v126
    v_mul_f32 v122, v114, v122
    v_and_b32 v125, 0xffff0000, v126
    v_add_u32 v123, v123, v123
    v_mul_f32 v124, v122, v124
    v_mul_f32 v125, v122, v125
    v_cmpx_le_u32 vcc, 0x1000000, v58
    ds_add_f32 v123, v124 offset:54272
    ds_add_f32 v123, v125 offset:54276
    s_mov_b64 exec, -1
    v_ashrrev_i32 v122, 5, v59
    v_lshlrev_b16 v123, 2, v59
    v_cndmask_b32 v126, v22, v23, s[66:67]
    v_bitop3_b32 v122, v122, v113, v113 bitop3:0x0c
    v_lshlrev_b32 v124, 16, v126
    v_mul_f32 v122, v114, v122
    v_and_b32 v125, 0xffff0000, v126
    v_add_u32 v123, v123, v123
    v_mul_f32 v124, v122, v124
    v_mul_f32 v125, v122, v125
    v_cmpx_le_u32 vcc, 0x1000000, v59
    ds_add_f32 v123, v124 offset:54272
    ds_add_f32 v123, v125 offset:54276
    s_mov_b64 exec, -1
    v_bfe_u32 v18, v105, 14, 4
    v_lshrrev_b32 v19, 18, v105
    v_and_b32 v105, 0x3fff, v105
    v_mad_u32_u24 v18, v18, s63, v19
    v_lshl_or_b32 v105, v18, 14, v105
    buffer_load_dwordx4 v[18:21], v105, s[68:71], 0 offen
    s_mov_b32 m0, s23
    s_nop 0
    ds_read_addtid_b32 v102 offset:0
    ds_read_addtid_b32 v103 offset:256
    ds_read_addtid_b32 v104 offset:512
    ds_read_addtid_b32 v105 offset:768
    ds_read_addtid_b32 v106 offset:1024
    ds_read_addtid_b32 v107 offset:1280
    ds_read_addtid_b32 v108 offset:1536
    ds_read_addtid_b32 v109 offset:1792
    s_waitcnt vmcnt(4)
    s_mov_b32 m0, s24
    s_cmp_ge_u32 s10, 9
    s_cbranch_scc1 p2_st1s0
    ds_write_addtid_b32 v84 offset:49152
    ds_write_addtid_b32 v85 offset:49408
p2_st1s0:
    s_mov_b32 m0, s23
    s_add_u32 s20, s20, 53760
    ds_write_addtid_b32 v72 offset:0
    ds_write_addtid_b32 v73 offset:256
    ds_write_addtid_b32 v74 offset:512
    ds_write_addtid_b32 v75 offset:768
    ds_write_addtid_b32 v76 offset:1024
    ds_write_addtid_b32 v77 offset:1280
    ds_write_addtid_b32 v78 offset:1536
    ds_write_addtid_b32 v79 offset:1792
    ds_write_addtid_b32 v80 offset:2048
    ds_write_addtid_b32 v81 offset:2304
    ds_write_addtid_b32 v82 offset:2560
    ds_write_addtid_b32 v83 offset:2816
    s_waitcnt lgkmcnt(15)
    v_ashrrev_i32 v122, 5, v60
    v_lshlrev_b16 v123, 2, v60
    v_cndmask_b32 v126, v24, v25, s[66:67]
    v_bitop3_b32 v122, v122, v113, v113 bitop3:0x0c
    v_lshlrev_b32 v124, 16, v126
    v_mul_f32 v122, v114, v122
    v_and_b32 v125, 0xffff0000, v126
    v_add_u32 v123, v123, v123
    v_mul_f32 v124, v122, v124
    v_mul_f32 v125, v122, v125
    v_cmpx_le_u32 vcc, 0x1000000, v60
    ds_add_f32 v123, v124 offset:54272
    ds_add_f32 v123, v125 offset:54276
    s_mov_b64 exec, -1
    v_ashrrev_i32 v122, 5, v61
    v_lshlrev_b16 v123, 2, v61
    v_cndmask_b32 v126, v26, v27, s[66:67]
    v_bitop3_b32 v122, v122, v113, v113 bitop3:0x0c
    v_lshlrev_b32 v124, 16, v126
    v_mul_f32 v122, v114, v122
    v_and_b32 v125, 0xffff0000, v126
    v_add_u32 v123, v123, v123
    v_mul_f32 v124, v122, v124
    v_mul_f32 v125, v122, v125
    v_cmpx_le_u32 vcc, 0x1000000, v61
    ds_add_f32 v123, v124 offset:54272
    ds_add_f32 v123, v125 offset:54276
    s_mov_b64 exec, -1
    v_ashrrev_i32 v122, 5, v62
    v_lshlrev_b16 v123, 2, v62
    v_cndmask_b32 v126, v28, v29, s[66:67]
    v_bitop3_b32 v122, v122, v113, v113 bitop3:0x0c
    v_lshlrev_b32 v124, 16, v126
    v_mul_f32 v122, v114, v122
    v_and_b32 v125, 0xffff0000, v126
    v_add_u32 v123, v123, v123
    v_mul_f32 v124, v122, v124
    v_mul_f32 v125, v122, v125
    v_cmpx_le_u32 vcc, 0x1000000, v62
    ds_add_f32 v123, v124 offset:54272
    ds_add_f32 v123, v125 offset:54276
    s_mov_b64 exec, -1
    s_waitcnt vmcnt(13)
    v_perm_b32 v60, v89, v86, s31
    v_perm_b32 v61, v89, v87, s32
    v_perm_b32 v62, v89, v88, s33
    v_lshlrev_b16 v28, 3, v88
    v_lshlrev_b16 v26, 3, v87
    v_lshlrev_b16 v24, 3, v86
    s_waitcnt lgkmcnt(6)
    s_barrier
    s_cmp_ge_u32 s10, 9
    s_cbranch_scc1 p2_nm1m1a
    v_lshrrev_b32 v84, 1, v112
    s_add_u32 s44, s20, s42
    buffer_load_dwordx2 v[84:85], v84, s[4:7], s44 offen
p2_nm1m1a:
    buffer_load_dwordx4 v[72:75], v112, s[4:7], s20 offen offset:0
    buffer_load_dwordx4 v[76:79], v112, s[4:7], s20 offen offset:1024
    buffer_load_dwordx4 v[80:83], v112, s[4:7], s20 offen offset:2048
    v_cmpx_ge_u16 vcc, 0x3fff, v60
    ds_read_b64 v[24:25], v24
    s_mov_b64 exec, -1
    v_cmpx_ge_u16 vcc, 0x3fff, v61
    ds_read_b64 v[26:27], v26
    s_mov_b64 exec, -1
    v_cmpx_ge_u16 vcc, 0x3fff, v62
    ds_read_b64 v[28:29], v28
    s_mov_b64 exec, -1
    s_waitcnt lgkmcnt(15)
    v_ashrrev_i32 v122, 5, v63
    v_lshlrev_b16 v123, 2, v63
    v_cndmask_b32 v126, v30, v31, s[66:67]
    v_bitop3_b32 v122, v122, v113, v113 bitop3:0x0c
    v_lshlrev_b32 v124, 16, v126
    v_mul_f32 v122, v114, v122
    v_and_b32 v125, 0xffff0000, v126
    v_add_u32 v123, v123, v123
    v_mul_f32 v124, v122, v124
    v_mul_f32 v125, v122, v125
    v_cmpx_le_u32 vcc, 0x1000000, v63
    ds_add_f32 v123, v124 offset:54272
    ds_add_f32 v123, v125 offset:54276
    s_mov_b64 exec, -1
    v_ashrrev_i32 v122, 5, v64
    v_lshlrev_b16 v123, 2, v64
    v_cndmask_b32 v126, v32, v33, s[66:67]
    v_bitop3_b32 v122, v122, v113, v113 bitop3:0x0c
    v_lshlrev_b32 v124, 16, v126
    v_mul_f32 v122, v114, v122
    v_and_b32 v125, 0xffff0000, v126
    v_add_u32 v123, v123, v123
    v_mul_f32 v124, v122, v124
    v_mul_f32 v125, v122, v125
    v_cmpx_le_u32 vcc, 0x1000000, v64
    ds_add_f32 v123, v124 offset:54272
    ds_add_f32 v123, v125 offset:54276
    s_mov_b64 exec, -1
    v_ashrrev_i32 v122, 5, v65
    v_lshlrev_b16 v123, 2, v65
    v_cndmask_b32 v126, v34, v35, s[66:67]
    v_bitop3_b32 v122, v122, v113, v113 bitop3:0x0c
    v_lshlrev_b32 v124, 16, v126
    v_mul_f32 v122, v114, v122
    v_and_b32 v125, 0xffff0000, v126
    v_add_u32 v123, v123, v123
    v_mul_f32 v124, v122, v124
    v_mul_f32 v125, v122, v125
    v_cmpx_le_u32 vcc, 0x1000000, v65
    ds_add_f32 v123, v124 offset:54272
    ds_add_f32 v123, v125 offset:54276
    s_mov_b64 exec, -1
    s_waitcnt vmcnt(15)
    v_perm_b32 v63, v93, v90, s31
    v_perm_b32 v64, v93, v91, s32
    v_perm_b32 v65, v93, v92, s33
    v_lshlrev_b16 v34, 3, v92
    v_lshlrev_b16 v32, 3, v91
    v_lshlrev_b16 v30, 3, v90
    v_cmpx_ge_u16 vcc, 0x3fff, v63
    ds_read_b64 v[30:31], v30
    s_mov_b64 exec, -1
    v_cmpx_ge_u16 vcc, 0x3fff, v64
    ds_read_b64 v[32:33], v32
    s_mov_b64 exec, -1
    v_cmpx_ge_u16 vcc, 0x3fff, v65
    ds_read_b64 v[34:35], v34
    s_mov_b64 exec, -1
    s_waitcnt lgkmcnt(15)
    v_bfe_u32 v86, v106, 14, 4
    v_lshrrev_b32 v87, 18, v106
    v_and_b32 v106, 0x3fff, v106
    v_mad_u32_u24 v86, v86, s63, v87
    v_lshl_or_b32 v106, v86, 14, v106
    buffer_load_dwordx4 v[86:89], v106, s[68:71], 0 offen
    s_waitcnt lgkmcnt(15)
    v_ashrrev_i32 v122, 5, v66
    v_lshlrev_b16 v123, 2, v66
    v_cndmask_b32 v126, v36, v37, s[66:67]
    v_bitop3_b32 v122, v122, v113, v113 bitop3:0x0c
    v_lshlrev_b32 v124, 16, v126
    v_mul_f32 v122, v114, v122
    v_and_b32 v125, 0xffff0000, v126
    v_add_u32 v123, v123, v123
    v_mul_f32 v124, v122, v124
    v_mul_f32 v125, v122, v125
    v_cmpx_le_u32 vcc, 0x1000000, v66
    ds_add_f32 v123, v124 offset:54272
    ds_add_f32 v123, v125 offset:54276
    s_mov_b64 exec, -1
    v_ashrrev_i32 v122, 5, v67
    v_lshlrev_b16 v123, 2, v67
    v_cndmask_b32 v126, v38, v39, s[66:67]
    v_bitop3_b32 v122, v122, v113, v113 bitop3:0x0c
    v_lshlrev_b32 v124, 16, v126
    v_mul_f32 v122, v114, v122
    v_and_b32 v125, 0xffff0000, v126
    v_add_u32 v123, v123, v123
    v_mul_f32 v124, v122, v124
    v_mul_f32 v125, v122, v125
    v_cmpx_le_u32 vcc, 0x1000000, v67
    ds_add_f32 v123, v124 offset:54272
    ds_add_f32 v123, v125 offset:54276
    s_mov_b64 exec, -1
    v_ashrrev_i32 v122, 5, v68
    v_lshlrev_b16 v123, 2, v68
    v_cndmask_b32 v126, v40, v41, s[66:67]
    v_bitop3_b32 v122, v122, v113, v113 bitop3:0x0c
    v_lshlrev_b32 v124, 16, v126
    v_mul_f32 v122, v114, v122
    v_and_b32 v125, 0xffff0000, v126
    v_add_u32 v123, v123, v123
    v_mul_f32 v124, v122, v124
    v_mul_f32 v125, v122, v125
    v_cmpx_le_u32 vcc, 0x1000000, v68
    ds_add_f32 v123, v124 offset:54272
    ds_add_f32 v123, v125 offset:54276
    s_mov_b64 exec, -1
    s_waitcnt vmcnt(12)
    v_perm_b32 v66, v97, v94, s31
    v_perm_b32 v67, v97, v95, s32
    v_perm_b32 v68, v97, v96, s33
    v_lshlrev_b16 v40, 3, v96
    v_lshlrev_b16 v38, 3, v95
    v_lshlrev_b16 v36, 3, v94
    v_cmpx_ge_u16 vcc, 0x3fff, v66
    ds_read_b64 v[36:37], v36
    s_mov_b64 exec, -1
    v_cmpx_ge_u16 vcc, 0x3fff, v67
    ds_read_b64 v[38:39], v38
    s_mov_b64 exec, -1
    v_cmpx_ge_u16 vcc, 0x3fff, v68
    ds_read_b64 v[40:41], v40
    s_mov_b64 exec, -1
    s_waitcnt lgkmcnt(15)
    v_bfe_u32 v90, v107, 14, 4
    v_lshrrev_b32 v91, 18, v107
    v_and_b32 v107, 0x3fff, v107
    v_mad_u32_u24 v90, v90, s63, v91
    v_lshl_or_b32 v107, v90, 14, v107
    buffer_load_dwordx4 v[90:93], v107, s[68:71], 0 offen
    s_cmp_le_u32 s15, 7
    s_cbranch_scc1 p2_na1a7
    s_waitcnt lgkmcnt(15)
    v_ashrrev_i32 v122, 5, v69
    v_lshlrev_b16 v123, 2, v69
    v_cndmask_b32 v126, v42, v43, s[66:67]
    v_bitop3_b32 v122, v122, v113, v113 bitop3:0x0c
    v_lshlrev_b32 v124, 16, v126
    v_mul_f32 v122, v114, v122
    v_and_b32 v125, 0xffff0000, v126
    v_add_u32 v123, v123, v123
    v_mul_f32 v124, v122, v124
    v_mul_f32 v125, v122, v125
    v_cmpx_le_u32 vcc, 0x1000000, v69
    ds_add_f32 v123, v124 offset:54272
    ds_add_f32 v123, v125 offset:54276
    s_mov_b64 exec, -1
    v_ashrrev_i32 v122, 5, v70
    v_lshlrev_b16 v123, 2, v70
    v_cndmask_b32 v126, v44, v45, s[66:67]
    v_bitop3_b32 v122, v122, v113, v113 bitop3:0x0c
    v_lshlrev_b32 v124, 16, v126
    v_mul_f32 v122, v114, v122
    v_and_b32 v125, 0xffff0000, v126
    v_add_u32 v123, v123, v123
    v_mul_f32 v124, v122, v124
    v_mul_f32 v125, v122, v125
    v_cmpx_le_u32 vcc, 0x1000000, v70
    ds_add_f32 v123, v124 offset:54272
    ds_add_f32 v123, v125 offset:54276
    s_mov_b64 exec, -1
    v_ashrrev_i32 v122, 5, v71
    v_lshlrev_b16 v123, 2, v71
    v_cndmask_b32 v126, v46, v47, s[66:67]
    v_bitop3_b32 v122, v122, v113, v113 bitop3:0x0c
    v_lshlrev_b32 v124, 16, v126
    v_mul_f32 v122, v114, v122
    v_and_b32 v125, 0xffff0000, v126
    v_add_u32 v123, v123, v123
    v_mul_f32 v124, v122, v124
    v_mul_f32 v125, v122, v125
    v_cmpx_le_u32 vcc, 0x1000000, v71
    ds_add_f32 v123, v124 offset:54272
    ds_add_f32 v123, v125 offset:54276
    s_mov_b64 exec, -1
p2_na1a7:
    s_waitcnt vmcnt(12)
    v_perm_b32 v69, v101, v98, s31
    v_perm_b32 v70, v101, v99, s32
    v_perm_b32 v71, v101, v100, s33
    v_lshlrev_b16 v46, 3, v100
    v_lshlrev_b16 v44, 3, v99
    v_lshlrev_b16 v42, 3, v98
    s_cmp_le_u32 s16, 7
    s_cbranch_scc1 p2_g1r07
    v_cmpx_ge_u16 vcc, 0x3fff, v69
    ds_read_b64 v[42:43], v42
    s_mov_b64 exec, -1
    v_cmpx_ge_u16 vcc, 0x3fff, v70
    ds_read_b64 v[44:45], v44
    s_mov_b64 exec, -1
    v_cmpx_ge_u16 vcc, 0x3fff, v71
    ds_read_b64 v[46:47], v46
    s_mov_b64 exec, -1
p2_g1r07:
    s_waitcnt vmcnt(8)
    v_perm_b32 v48, v3, v0, s31
    v_perm_b32 v49, v3, v1, s32
    v_perm_b32 v50, v3, v2, s33
    v_lshlrev_b16 v4, 3, v2
    v_lshlrev_b16 v2, 3, v1
    v_lshlrev_b16 v0, 3, v0
    v_cmpx_ge_u16 vcc, 0x3fff, v48
    ds_read_b64 v[0:1], v0
    s_mov_b64 exec, -1
    v_cmpx_ge_u16 vcc, 0x3fff, v49
    ds_read_b64 v[2:3], v2
    s_mov_b64 exec, -1
    v_cmpx_ge_u16 vcc, 0x3fff, v50
    ds_read_b64 v[4:5], v4
    s_mov_b64 exec, -1
    s_waitcnt vmcnt(7)
    v_perm_b32 v51, v9, v6, s31
    v_perm_b32 v52, v9, v7, s32
    v_perm_b32 v53, v9, v8, s33
    v_lshlrev_b16 v10, 3, v8
    v_lshlrev_b16 v8, 3, v7
    v_lshlrev_b16 v6, 3, v6
    v_cmpx_ge_u16 vcc, 0x3fff, v51
    ds_read_b64 v[6:7], v6
    s_mov_b64 exec, -1
    v_cmpx_ge_u16 vcc, 0x3fff, v52
    ds_read_b64 v[8:9], v8
    s_mov_b64 exec, -1
    v_cmpx_ge_u16 vcc, 0x3fff, v53
    ds_read_b64 v[10:11], v10
    s_mov_b64 exec, -1
    s_waitcnt vmcnt(6)
    v_perm_b32 v54, v15, v12, s31
    v_perm_b32 v55, v15, v13, s32
    v_perm_b32 v56, v15, v14, s33
    v_lshlrev_b16 v16, 3, v14
    v_lshlrev_b16 v14, 3, v13
    v_lshlrev_b16 v12, 3, v12
    v_cmpx_ge_u16 vcc, 0x3fff, v54
    ds_read_b64 v[12:13], v12
    s_mov_b64 exec, -1
    v_cmpx_ge_u16 vcc, 0x3fff, v55
    ds_read_b64 v[14:15], v14
    s_mov_b64 exec, -1
    v_cmpx_ge_u16 vcc, 0x3fff, v56
    ds_read_b64 v[16:17], v16
    s_mov_b64 exec, -1
    s_waitcnt vmcnt(5)
    v_perm_b32 v57, v21, v18, s31
    v_perm_b32 v58, v21, v19, s32
    v_perm_b32 v59, v21, v20, s33
    v_lshlrev_b16 v22, 3, v20
    v_lshlrev_b16 v20, 3, v19
    v_lshlrev_b16 v18, 3, v18
    v_cmpx_ge_u16 vcc, 0x3fff, v57
    ds_read_b64 v[18:19], v18
    s_mov_b64 exec, -1
    v_cmpx_ge_u16 vcc, 0x3fff, v58
    ds_read_b64 v[20:21], v20
    s_mov_b64 exec, -1
    v_cmpx_ge_u16 vcc, 0x3fff, v59
    ds_read_b64 v[22:23], v22
    s_mov_b64 exec, -1
    s_waitcnt lgkmcnt(0)
    s_barrier
    s_waitcnt lgkmcnt(15)
    s_branch p2_tail
p2_drain1:
    v_cmpx_gt_i16 vcc, 0, v48
    ds_read_b64 v[0:1], v0
    s_mov_b64 exec, -1
    v_cmpx_gt_i16 vcc, 0, v49
    ds_read_b64 v[2:3], v2
    s_mov_b64 exec, -1
    v_cmpx_gt_i16 vcc, 0, v50
    ds_read_b64 v[4:5], v4
    s_mov_b64 exec, -1
    v_cmpx_gt_i16 vcc, 0, v51
    ds_read_b64 v[6:7], v6
    s_mov_b64 exec, -1
    v_cmpx_gt_i16 vcc, 0, v52
    ds_read_b64 v[8:9], v8
    s_mov_b64 exec, -1
    v_cmpx_gt_i16 vcc, 0, v53
    ds_read_b64 v[10:11], v10
    s_mov_b64 exec, -1
    v_cmpx_gt_i16 vcc, 0, v54
    ds_read_b64 v[12:13], v12
    s_mov_b64 exec, -1
    v_cmpx_gt_i16 vcc, 0, v55
    ds_read_b64 v[14:15], v14
    s_mov_b64 exec, -1
    v_cmpx_gt_i16 vcc, 0, v56
    ds_read_b64 v[16:17], v16
    s_mov_b64 exec, -1
    v_cmpx_gt_i16 vcc, 0, v57
    ds_read_b64 v[18:19], v18
    s_mov_b64 exec, -1
    v_cmpx_gt_i16 vcc, 0, v58
    ds_read_b64 v[20:21], v20
    s_mov_b64 exec, -1
    v_cmpx_gt_i16 vcc, 0, v59
    ds_read_b64 v[22:23], v22
    s_mov_b64 exec, -1
    v_cmpx_gt_i16 vcc, 0, v60
    ds_read_b64 v[24:25], v24
    s_mov_b64 exec, -1
    v_cmpx_gt_i16 vcc, 0, v61
    ds_read_b64 v[26:27], v26
    s_mov_b64 exec, -1
    v_cmpx_gt_i16 vcc, 0, v62
    ds_read_b64 v[28:29], v28
    s_mov_b64 exec, -1
    v_cmpx_gt_i16 vcc, 0, v63
    ds_read_b64 v[30:31], v30
    s_mov_b64 exec, -1
    v_cmpx_gt_i16 vcc, 0, v64
    ds_read_b64 v[32:33], v32
    s_mov_b64 exec, -1
    v_cmpx_gt_i16 vcc, 0, v65
    ds_read_b64 v[34:35], v34
    s_mov_b64 exec, -1
    v_cmpx_gt_i16 vcc, 0, v66
    ds_read_b64 v[36:37], v36
    s_mov_b64 exec, -1
    v_cmpx_gt_i16 vcc, 0, v67
    ds_read_b64 v[38:39], v38
    s_mov_b64 exec, -1
    v_cmpx_gt_i16 vcc, 0, v68
    ds_read_b64 v[40:41], v40
    s_mov_b64 exec, -1
    s_cmp_le_u32 s15, 7
    s_cbranch_scc1 p2_gd1
    v_cmpx_gt_i16 vcc, 0, v69
    ds_read_b64 v[42:43], v42
    s_mov_b64 exec, -1
    v_cmpx_gt_i16 vcc, 0, v70
    ds_read_b64 v[44:45], v44
    s_mov_b64 exec, -1
    v_cmpx_gt_i16 vcc, 0, v71
    ds_read_b64 v[46:47], v46
    s_mov_b64 exec, -1
p2_gd1:
    s_waitcnt lgkmcnt(15)
    v_ashrrev_i32 v122, 5, v48
    v_lshlrev_b16 v123, 2, v48
    v_cndmask_b32 v126, v0, v1, s[66:67]
    v_bitop3_b32 v122, v122, v113, v113 bitop3:0x0c
    v_lshlrev_b32 v124, 16, v126
    v_mul_f32 v122, v114, v122
    v_and_b32 v125, 0xffff0000, v126
    v_add_u32 v123, v123, v123
    v_mul_f32 v124, v122, v124
    v_mul_f32 v125, v122, v125
    v_cmpx_le_u32 vcc, 0x1000000, v48
    ds_add_f32 v123, v124 offset:54272
    ds_add_f32 v123, v125 offset:54276
    s_mov_b64 exec, -1
    v_ashrrev_i32 v122, 5, v49
    v_lshlrev_b16 v123, 2, v49
    v_cndmask_b32 v126, v2, v3, s[66:67]
    v_bitop3_b32 v122, v122, v113, v113 bitop3:0x0c
    v_lshlrev_b32 v124, 16, v126
    v_mul_f32 v122, v114, v122
    v_and_b32 v125, 0xffff0000, v126
    v_add_u32 v123, v123, v123
    v_mul_f32 v124, v122, v124
    v_mul_f32 v125, v122, v125
    v_cmpx_le_u32 vcc, 0x1000000, v49
    ds_add_f32 v123, v124 offset:54272
    ds_add_f32 v123, v125 offset:54276
    s_mov_b64 exec, -1
    v_ashrrev_i32 v122, 5, v50
    v_lshlrev_b16 v123, 2, v50
    v_cndmask_b32 v126, v4, v5, s[66:67]
    v_bitop3_b32 v122, v122, v113, v113 bitop3:0x0c
    v_lshlrev_b32 v124, 16, v126
    v_mul_f32 v122, v114, v122
    v_and_b32 v125, 0xffff0000, v126
    v_add_u32 v123, v123, v123
    v_mul_f32 v124, v122, v124
    v_mul_f32 v125, v122, v125
    v_cmpx_le_u32 vcc, 0x1000000, v50
    ds_add_f32 v123, v124 offset:54272
    ds_add_f32 v123, v125 offset:54276
    s_mov_b64 exec, -1
    s_waitcnt lgkmcnt(15)
    v_ashrrev_i32 v122, 5, v51
    v_lshlrev_b16 v123, 2, v51
    v_cndmask_b32 v126, v6, v7, s[66:67]
    v_bitop3_b32 v122, v122, v113, v113 bitop3:0x0c
    v_lshlrev_b32 v124, 16, v126
    v_mul_f32 v122, v114, v122
    v_and_b32 v125, 0xffff0000, v126
    v_add_u32 v123, v123, v123
    v_mul_f32 v124, v122, v124
    v_mul_f32 v125, v122, v125
    v_cmpx_le_u32 vcc, 0x1000000, v51
    ds_add_f32 v123, v124 offset:54272
    ds_add_f32 v123, v125 offset:54276
    s_mov_b64 exec, -1
    v_ashrrev_i32 v122, 5, v52
    v_lshlrev_b16 v123, 2, v52
    v_cndmask_b32 v126, v8, v9, s[66:67]
    v_bitop3_b32 v122, v122, v113, v113 bitop3:0x0c
    v_lshlrev_b32 v124, 16, v126
    v_mul_f32 v122, v114, v122
    v_and_b32 v125, 0xffff0000, v126
    v_add_u32 v123, v123, v123
    v_mul_f32 v124, v122, v124
    v_mul_f32 v125, v122, v125
    v_cmpx_le_u32 vcc, 0x1000000, v52
    ds_add_f32 v123, v124 offset:54272
    ds_add_f32 v123, v125 offset:54276
    s_mov_b64 exec, -1
    v_ashrrev_i32 v122, 5, v53
    v_lshlrev_b16 v123, 2, v53
    v_cndmask_b32 v126, v10, v11, s[66:67]
    v_bitop3_b32 v122, v122, v113, v113 bitop3:0x0c
    v_lshlrev_b32 v124, 16, v126
    v_mul_f32 v122, v114, v122
    v_and_b32 v125, 0xffff0000, v126
    v_add_u32 v123, v123, v123
    v_mul_f32 v124, v122, v124
    v_mul_f32 v125, v122, v125
    v_cmpx_le_u32 vcc, 0x1000000, v53
    ds_add_f32 v123, v124 offset:54272
    ds_add_f32 v123, v125 offset:54276
    s_mov_b64 exec, -1
    s_waitcnt lgkmcnt(15)
    v_ashrrev_i32 v122, 5, v54
    v_lshlrev_b16 v123, 2, v54
    v_cndmask_b32 v126, v12, v13, s[66:67]
    v_bitop3_b32 v122, v122, v113, v113 bitop3:0x0c
    v_lshlrev_b32 v124, 16, v126
    v_mul_f32 v122, v114, v122
    v_and_b32 v125, 0xffff0000, v126
    v_add_u32 v123, v123, v123
    v_mul_f32 v124, v122, v124
    v_mul_f32 v125, v122, v125
    v_cmpx_le_u32 vcc, 0x1000000, v54
    ds_add_f32 v123, v124 offset:54272
    ds_add_f32 v123, v125 offset:54276
    s_mov_b64 exec, -1
    v_ashrrev_i32 v122, 5, v55
    v_lshlrev_b16 v123, 2, v55
    v_cndmask_b32 v126, v14, v15, s[66:67]
    v_bitop3_b32 v122, v122, v113, v113 bitop3:0x0c
    v_lshlrev_b32 v124, 16, v126
    v_mul_f32 v122, v114, v122
    v_and_b32 v125, 0xffff0000, v126
    v_add_u32 v123, v123, v123
    v_mul_f32 v124, v122, v124
    v_mul_f32 v125, v122, v125
    v_cmpx_le_u32 vcc, 0x1000000, v55
    ds_add_f32 v123, v124 offset:54272
    ds_add_f32 v123, v125 offset:54276
    s_mov_b64 exec, -1
    v_ashrrev_i32 v122, 5, v56
    v_lshlrev_b16 v123, 2, v56
    v_cndmask_b32 v126, v16, v17, s[66:67]
    v_bitop3_b32 v122, v122, v113, v113 bitop3:0x0c
    v_lshlrev_b32 v124, 16, v126
    v_mul_f32 v122, v114, v122
    v_and_b32 v125, 0xffff0000, v126
    v_add_u32 v123, v123, v123
    v_mul_f32 v124, v122, v124
    v_mul_f32 v125, v122, v125
    v_cmpx_le_u32 vcc, 0x1000000, v56
    ds_add_f32 v123, v124 offset:54272
    ds_add_f32 v123, v125 offset:54276
    s_mov_b64 exec, -1
    s_waitcnt lgkmcnt(15)
    v_ashrrev_i32 v122, 5, v57
    v_lshlrev_b16 v123, 2, v57
    v_cndmask_b32 v126, v18, v19, s[66:67]
    v_bitop3_b32 v122, v122, v113, v113 bitop3:0x0c
    v_lshlrev_b32 v124, 16, v126
    v_mul_f32 v122, v114, v122
    v_and_b32 v125, 0xffff0000, v126
    v_add_u32 v123, v123, v123
    v_mul_f32 v124, v122, v124
    v_mul_f32 v125, v122, v125
    v_cmpx_le_u32 vcc, 0x1000000, v57
    ds_add_f32 v123, v124 offset:54272
    ds_add_f32 v123, v125 offset:54276
    s_mov_b64 exec, -1
    v_ashrrev_i32 v122, 5, v58
    v_lshlrev_b16 v123, 2, v58
    v_cndmask_b32 v126, v20, v21, s[66:67]
    v_bitop3_b32 v122, v122, v113, v113 bitop3:0x0c
    v_lshlrev_b32 v124, 16, v126
    v_mul_f32 v122, v114, v122
    v_and_b32 v125, 0xffff0000, v126
    v_add_u32 v123, v123, v123
    v_mul_f32 v124, v122, v124
    v_mul_f32 v125, v122, v125
    v_cmpx_le_u32 vcc, 0x1000000, v58
    ds_add_f32 v123, v124 offset:54272
    ds_add_f32 v123, v125 offset:54276
    s_mov_b64 exec, -1
    v_ashrrev_i32 v122, 5, v59
    v_lshlrev_b16 v123, 2, v59
    v_cndmask_b32 v126, v22, v23, s[66:67]
    v_bitop3_b32 v122, v122, v113, v113 bitop3:0x0c
    v_lshlrev_b32 v124, 16, v126
    v_mul_f32 v122, v114, v122
    v_and_b32 v125, 0xffff0000, v126
    v_add_u32 v123, v123, v123
    v_mul_f32 v124, v122, v124
    v_mul_f32 v125, v122, v125
    v_cmpx_le_u32 vcc, 0x1000000, v59
    ds_add_f32 v123, v124 offset:54272
    ds_add_f32 v123, v125 offset:54276
    s_mov_b64 exec, -1
    s_waitcnt lgkmcnt(15)
    v_ashrrev_i32 v122, 5, v60
    v_lshlrev_b16 v123, 2, v60
    v_cndmask_b32 v126, v24, v25, s[66:67]
    v_bitop3_b32 v122, v122, v113, v113 bitop3:0x0c
    v_lshlrev_b32 v124, 16, v126
    v_mul_f32 v122, v114, v122
    v_and_b32 v125, 0xffff0000, v126
    v_add_u32 v123, v123, v123
    v_mul_f32 v124, v122, v124
    v_mul_f32 v125, v122, v125
    v_cmpx_le_u32 vcc, 0x1000000, v60
    ds_add_f32 v123, v124 offset:54272
    ds_add_f32 v123, v125 offset:54276
    s_mov_b64 exec, -1
    v_ashrrev_i32 v122, 5, v61
    v_lshlrev_b16 v123, 2, v61
    v_cndmask_b32 v126, v26, v27, s[66:67]
    v_bitop3_b32 v122, v122, v113, v113 bitop3:0x0c
    v_lshlrev_b32 v124, 16, v126
    v_mul_f32 v122, v114, v122
    v_and_b32 v125, 0xffff0000, v126
    v_add_u32 v123, v123, v123
    v_mul_f32 v124, v122, v124
    v_mul_f32 v125, v122, v125
    v_cmpx_le_u32 vcc, 0x1000000, v61
    ds_add_f32 v123, v124 offset:54272
    ds_add_f32 v123, v125 offset:54276
    s_mov_b64 exec, -1
    v_ashrrev_i32 v122, 5, v62
    v_lshlrev_b16 v123, 2, v62
    v_cndmask_b32 v126, v28, v29, s[66:67]
    v_bitop3_b32 v122, v122, v113, v113 bitop3:0x0c
    v_lshlrev_b32 v124, 16, v126
    v_mul_f32 v122, v114, v122
    v_and_b32 v125, 0xffff0000, v126
    v_add_u32 v123, v123, v123
    v_mul_f32 v124, v122, v124
    v_mul_f32 v125, v122, v125
    v_cmpx_le_u32 vcc, 0x1000000, v62
    ds_add_f32 v123, v124 offset:54272
    ds_add_f32 v123, v125 offset:54276
    s_mov_b64 exec, -1
    s_waitcnt lgkmcnt(15)
    v_ashrrev_i32 v122, 5, v63
    v_lshlrev_b16 v123, 2, v63
    v_cndmask_b32 v126, v30, v31, s[66:67]
    v_bitop3_b32 v122, v122, v113, v113 bitop3:0x0c
    v_lshlrev_b32 v124, 16, v126
    v_mul_f32 v122, v114, v122
    v_and_b32 v125, 0xffff0000, v126
    v_add_u32 v123, v123, v123
    v_mul_f32 v124, v122, v124
    v_mul_f32 v125, v122, v125
    v_cmpx_le_u32 vcc, 0x1000000, v63
    ds_add_f32 v123, v124 offset:54272
    ds_add_f32 v123, v125 offset:54276
    s_mov_b64 exec, -1
    v_ashrrev_i32 v122, 5, v64
    v_lshlrev_b16 v123, 2, v64
    v_cndmask_b32 v126, v32, v33, s[66:67]
    v_bitop3_b32 v122, v122, v113, v113 bitop3:0x0c
    v_lshlrev_b32 v124, 16, v126
    v_mul_f32 v122, v114, v122
    v_and_b32 v125, 0xffff0000, v126
    v_add_u32 v123, v123, v123
    v_mul_f32 v124, v122, v124
    v_mul_f32 v125, v122, v125
    v_cmpx_le_u32 vcc, 0x1000000, v64
    ds_add_f32 v123, v124 offset:54272
    ds_add_f32 v123, v125 offset:54276
    s_mov_b64 exec, -1
    v_ashrrev_i32 v122, 5, v65
    v_lshlrev_b16 v123, 2, v65
    v_cndmask_b32 v126, v34, v35, s[66:67]
    v_bitop3_b32 v122, v122, v113, v113 bitop3:0x0c
    v_lshlrev_b32 v124, 16, v126
    v_mul_f32 v122, v114, v122
    v_and_b32 v125, 0xffff0000, v126
    v_add_u32 v123, v123, v123
    v_mul_f32 v124, v122, v124
    v_mul_f32 v125, v122, v125
    v_cmpx_le_u32 vcc, 0x1000000, v65
    ds_add_f32 v123, v124 offset:54272
    ds_add_f32 v123, v125 offset:54276
    s_mov_b64 exec, -1
    s_waitcnt lgkmcnt(15)
    v_ashrrev_i32 v122, 5, v66
    v_lshlrev_b16 v123, 2, v66
    v_cndmask_b32 v126, v36, v37, s[66:67]
    v_bitop3_b32 v122, v122, v113, v113 bitop3:0x0c
    v_lshlrev_b32 v124, 16, v126
    v_mul_f32 v122, v114, v122
    v_and_b32 v125, 0xffff0000, v126
    v_add_u32 v123, v123, v123
    v_mul_f32 v124, v122, v124
    v_mul_f32 v125, v122, v125
    v_cmpx_le_u32 vcc, 0x1000000, v66
    ds_add_f32 v123, v124 offset:54272
    ds_add_f32 v123, v125 offset:54276
    s_mov_b64 exec, -1
    v_ashrrev_i32 v122, 5, v67
    v_lshlrev_b16 v123, 2, v67
    v_cndmask_b32 v126, v38, v39, s[66:67]
    v_bitop3_b32 v122, v122, v113, v113 bitop3:0x0c
    v_lshlrev_b32 v124, 16, v126
    v_mul_f32 v122, v114, v122
    v_and_b32 v125, 0xffff0000, v126
    v_add_u32 v123, v123, v123
    v_mul_f32 v124, v122, v124
    v_mul_f32 v125, v122, v125
    v_cmpx_le_u32 vcc, 0x1000000, v67
    ds_add_f32 v123, v124 offset:54272
    ds_add_f32 v123, v125 offset:54276
    s_mov_b64 exec, -1
    v_ashrrev_i32 v122, 5, v68
    v_lshlrev_b16 v123, 2, v68
    v_cndmask_b32 v126, v40, v41, s[66:67]
    v_bitop3_b32 v122, v122, v113, v113 bitop3:0x0c
    v_lshlrev_b32 v124, 16, v126
    v_mul_f32 v122, v114, v122
    v_and_b32 v125, 0xffff0000, v126
    v_add_u32 v123, v123, v123
    v_mul_f32 v124, v122, v124
    v_mul_f32 v125, v122, v125
    v_cmpx_le_u32 vcc, 0x1000000, v68
    ds_add_f32 v123, v124 offset:54272
    ds_add_f32 v123, v125 offset:54276
    s_mov_b64 exec, -1
    s_cmp_le_u32 s15, 7
    s_cbranch_scc1 p2_nad1
    s_waitcnt lgkmcnt(15)
    v_ashrrev_i32 v122, 5, v69
    v_lshlrev_b16 v123, 2, v69
    v_cndmask_b32 v126, v42, v43, s[66:67]
    v_bitop3_b32 v122, v122, v113, v113 bitop3:0x0c
    v_lshlrev_b32 v124, 16, v126
    v_mul_f32 v122, v114, v122
    v_and_b32 v125, 0xffff0000, v126
    v_add_u32 v123, v123, v123
    v_mul_f32 v124, v122, v124
    v_mul_f32 v125, v122, v125
    v_cmpx_le_u32 vcc, 0x1000000, v69
    ds_add_f32 v123, v124 offset:54272
    ds_add_f32 v123, v125 offset:54276
    s_mov_b64 exec, -1
    v_ashrrev_i32 v122, 5, v70
    v_lshlrev_b16 v123, 2, v70
    v_cndmask_b32 v126, v44, v45, s[66:67]
    v_bitop3_b32 v122, v122, v113, v113 bitop3:0x0c
    v_lshlrev_b32 v124, 16, v126
    v_mul_f32 v122, v114, v122
    v_and_b32 v125, 0xffff0000, v126
    v_add_u32 v123, v123, v123
    v_mul_f32 v124, v122, v124
    v_mul_f32 v125, v122, v125
    v_cmpx_le_u32 vcc, 0x1000000, v70
    ds_add_f32 v123, v124 offset:54272
    ds_add_f32 v123, v125 offset:54276
    s_mov_b64 exec, -1
    v_ashrrev_i32 v122, 5, v71
    v_lshlrev_b16 v123, 2, v71
    v_cndmask_b32 v126, v46, v47, s[66:67]
    v_bitop3_b32 v122, v122, v113, v113 bitop3:0x0c
    v_lshlrev_b32 v124, 16, v126
    v_mul_f32 v122, v114, v122
    v_and_b32 v125, 0xffff0000, v126
    v_add_u32 v123, v123, v123
    v_mul_f32 v124, v122, v124
    v_mul_f32 v125, v122, v125
    v_cmpx_le_u32 vcc, 0x1000000, v71
    ds_add_f32 v123, v124 offset:54272
    ds_add_f32 v123, v125 offset:54276
    s_mov_b64 exec, -1
p2_nad1:
    s_branch p2_fin
p2_tail:
    s_mov_b32 s60, s61
    s_mov_b32 s15, s16
    s_mov_b32 s16, s17
    v_mov_b32 v122, s19
    s_xor_b32 s19, s19, 4
    ds_read_b32 v125, v122 offset:53760
    v_mov_b32 v123, s19
    v_mov_b32 v124, 0
    ds_write_b32 v123, v124 offset:53760
    s_waitcnt vmcnt(2)
    s_mov_b32 m0, s24
    s_cmp_ge_u32 s10, 9
    s_cbranch_scc1 p2_st2s1
    ds_write_addtid_b32 v84 offset:49152
    ds_write_addtid_b32 v85 offset:49408
p2_st2s1:
    s_mov_b32 m0, s23
    s_add_u32 s20, s20, 53760
    ds_write_addtid_b32 v72 offset:0
    ds_write_addtid_b32 v73 offset:256
    ds_write_addtid_b32 v74 offset:512
    ds_write_addtid_b32 v75 offset:768
    ds_write_addtid_b32 v76 offset:1024
    ds_write_addtid_b32 v77 offset:1280
    ds_write_addtid_b32 v78 offset:1536
    ds_write_addtid_b32 v79 offset:1792
    ds_write_addtid_b32 v80 offset:2048
    ds_write_addtid_b32 v81 offset:2304
    ds_write_addtid_b32 v82 offset:2560
    ds_write_addtid_b32 v83 offset:2816
    s_cmp_ge_u32 s10, 9
    s_cbranch_scc1 p2_nm2m2a
    v_lshrrev_b32 v84, 1, v112
    s_add_u32 s44, s20, s42
    buffer_load_dwordx2 v[84:85], v84, s[4:7], s44 offen
p2_nm2m2a:
    buffer_load_dwordx4 v[72:75], v112, s[4:7], s20 offen offset:0
    buffer_load_dwordx4 v[76:79], v112, s[4:7], s20 offen offset:1024
    buffer_load_dwordx4 v[80:83], v112, s[4:7], s20 offen offset:2048
    s_waitcnt lgkmcnt(0)
    s_barrier
    v_cmpx_lt_i16 vcc, 0x3fff, v48
    ds_read_b64 v[0:1], v0
    s_mov_b64 exec, -1
    v_cmpx_lt_i16 vcc, 0x3fff, v49
    ds_read_b64 v[2:3], v2
    s_mov_b64 exec, -1
    v_cmpx_lt_i16 vcc, 0x3fff, v50
    ds_read_b64 v[4:5], v4
    s_mov_b64 exec, -1
    v_cmpx_lt_i16 vcc, 0x3fff, v51
    ds_read_b64 v[6:7], v6
    s_mov_b64 exec, -1
    v_cmpx_lt_i16 vcc, 0x3fff, v52
    ds_read_b64 v[8:9], v8
    s_mov_b64 exec, -1
    v_cmpx_lt_i16 vcc, 0x3fff, v53
    ds_read_b64 v[10:11], v10
    s_mov_b64 exec, -1
    s_waitcnt lgkmcnt(15)
    v_readfirstlane_b32 s44, v125
    s_nop 0
    s_cmp_lg_u32 s44, 0
    s_cbranch_scc1 p2_advb
    s_add_u32 s61, s61, 1
    s_min_u32 s61, s61, 10
    v_mov_b32 v110, 0
    v_mov_b32 v111, 0
    s_cmp_eq_u32 s61, 10
    s_cbranch_scc1 p2_advb
    s_add_u32 s44, s61, s18
    s_cmp_ge_u32 s44, 10
    s_cselect_b32 s53, 10, 0
    s_sub_u32 s44, s44, s53
    s_mul_i32 s44, s44, 4160
    s_add_u32 s44, s44, s40
    v_bfe_i32 v111, v112, 6, 1
    v_lshrrev_b32 v110, 6, v112
    v_bitop3_b32 v111, v111, 15, s10 bitop3:0x6a
    v_lshl_or_b32 v110, v110, 4, v111
    v_bfe_u32 v111, v112, 2, 4
    v_mul_u32_u24 v110, 41600, v110
    v_add_u32 v111, v110, v111
    v_add_u32 v110, 256, v112
    v_and_b32 v110, 0x400, v110
    v_lshl_or_b32 v111, v110, 20, v111
    buffer_load_dword v110, v111, s[4:7], s44 offen
    buffer_load_dword v111, v111, s[4:7], s44 offen offset:16
p2_advb:
    s_cmp_lg_u32 s10, 15
    s_cbranch_scc1 p2_ntg
    s_lshr_b32 s44, s2, 3
    s_mul_i32 s44, s44, 5120
    s_add_u32 s45, s60, s18
    s_cmp_ge_u32 s45, 10
    s_cselect_b32 s53, 10, 0
    s_sub_u32 s45, s45, s53
    s_mul_i32 s45, s45, 645120
    s_add_u32 s44, s44, s45
    s_add_u32 s44, s44, s62
    s_sub_u32 s44, s44, s23
    v_lshlrev_b32 v84, 3, v112
    s_mov_b32 exec_hi, 0xff
    buffer_load_dword v85, v84, s[4:7], s44 offen
    s_mov_b64 exec, -1
p2_ntg:
    v_cmpx_lt_i16 vcc, 0x3fff, v54
    ds_read_b64 v[12:13], v12
    s_mov_b64 exec, -1
    v_cmpx_lt_i16 vcc, 0x3fff, v55
    ds_read_b64 v[14:15], v14
    s_mov_b64 exec, -1
    v_cmpx_lt_i16 vcc, 0x3fff, v56
    ds_read_b64 v[16:17], v16
    s_mov_b64 exec, -1
    v_cmpx_lt_i16 vcc, 0x3fff, v57
    ds_read_b64 v[18:19], v18
    s_mov_b64 exec, -1
    v_cmpx_lt_i16 vcc, 0x3fff, v58
    ds_read_b64 v[20:21], v20
    s_mov_b64 exec, -1
    v_cmpx_lt_i16 vcc, 0x3fff, v59
    ds_read_b64 v[22:23], v22
    s_mov_b64 exec, -1
    v_bfe_u32 v94, v108, 14, 4
    v_lshrrev_b32 v95, 18, v108
    v_and_b32 v108, 0x3fff, v108
    v_mad_u32_u24 v94, v94, s63, v95
    v_lshl_or_b32 v108, v94, 14, v108
    buffer_load_dwordx4 v[94:97], v108, s[68:71], 0 offen
    v_cmpx_lt_i16 vcc, 0x3fff, v60
    ds_read_b64 v[24:25], v24
    s_mov_b64 exec, -1
    v_cmpx_lt_i16 vcc, 0x3fff, v61
    ds_read_b64 v[26:27], v26
    s_mov_b64 exec, -1
    v_cmpx_lt_i16 vcc, 0x3fff, v62
    ds_read_b64 v[28:29], v28
    s_mov_b64 exec, -1
    v_cmpx_lt_i16 vcc, 0x3fff, v63
    ds_read_b64 v[30:31], v30
    s_mov_b64 exec, -1
    v_cmpx_lt_i16 vcc, 0x3fff, v64
    ds_read_b64 v[32:33], v32
    s_mov_b64 exec, -1
    v_cmpx_lt_i16 vcc, 0x3fff, v65
    ds_read_b64 v[34:35], v34
    s_mov_b64 exec, -1
    v_cmpx_lt_i16 vcc, 0x3fff, v66
    ds_read_b64 v[36:37], v36
    s_mov_b64 exec, -1
    v_cmpx_lt_i16 vcc, 0x3fff, v67
    ds_read_b64 v[38:39], v38
    s_mov_b64 exec, -1
    v_cmpx_lt_i16 vcc, 0x3fff, v68
    ds_read_b64 v[40:41], v40
    s_mov_b64 exec, -1
    s_cmp_le_u32 s15, 7
    s_cbranch_scc1 p2_g2r17
    v_cmpx_lt_i16 vcc, 0x3fff, v69
    ds_read_b64 v[42:43], v42
    s_mov_b64 exec, -1
    v_cmpx_lt_i16 vcc, 0x3fff, v70
    ds_read_b64 v[44:45], v44
    s_mov_b64 exec, -1
    v_cmpx_lt_i16 vcc, 0x3fff, v71
    ds_read_b64 v[46:47], v46
    s_mov_b64 exec, -1
p2_g2r17:
    v_bfe_u32 v98, v109, 14, 4
    v_lshrrev_b32 v99, 18, v109
    v_and_b32 v109, 0x3fff, v109
    v_mad_u32_u24 v98, v98, s63, v99
    v_lshl_or_b32 v109, v98, 14, v109
    buffer_load_dwordx4 v[98:101], v109, s[68:71], 0 offen
    s_waitcnt lgkmcnt(0)
    s_barrier
    s_waitcnt vmcnt(2)
    s_mov_b32 m0, s24
    s_cmp_ge_u32 s10, 9
    s_cbranch_scc1 p2_st2s2
    ds_write_addtid_b32 v84 offset:49152
    ds_write_addtid_b32 v85 offset:49408
p2_st2s2:
    s_mov_b32 m0, s23
    s_add_u32 s20, s60, s18
    s_cmp_ge_u32 s20, 10
    s_cselect_b32 s53, 10, 0
    s_sub_u32 s20, s20, s53
    s_mul_i32 s20, s20, 645120
    s_add_u32 s20, s20, s62
    ds_write_addtid_b32 v72 offset:0
    ds_write_addtid_b32 v73 offset:256
    ds_write_addtid_b32 v74 offset:512
    ds_write_addtid_b32 v75 offset:768
    ds_write_addtid_b32 v76 offset:1024
    ds_write_addtid_b32 v77 offset:1280
    ds_write_addtid_b32 v78 offset:1536
    ds_write_addtid_b32 v79 offset:1792
    ds_write_addtid_b32 v80 offset:2048
    ds_write_addtid_b32 v81 offset:2304
    ds_write_addtid_b32 v82 offset:2560
    ds_write_addtid_b32 v83 offset:2816
    s_waitcnt lgkmcnt(0)
    s_barrier
    s_branch p2_top
p2_fin:
    s_waitcnt vmcnt(0) lgkmcnt(0)
    s_barrier
    s_mov_b32 s48, s11
    s_mul_i32 s44, s48, 800768
    s_mul_i32 s45, s12, 12512
    s_add_u32 s49, s44, s45
    s_lshl_b32 s44, s49, 3
    s_add_u32 s44, s44, 492278784
    s_lshl_b32 s48, s48, 2
    s_lshl_b32 s45, s12, 4
    s_add_u32 s48, s48, s45
    s_add_u32 s48, s48, 492277760
    v_add_u32 v123, s64, v112
    v_add_u32 v122, s25, v123
    v_mov_b32 v24, 0
    v_mov_b32 v25, 0
    v_mov_b32 v26, 0
    v_mov_b32 v27, 0
    v_cmp_gt_u32 vcc, 1792, v123
    v_mov_b32 v124, 0x38000000
    v_mov_b32 v126, 0
    v_cndmask_b32 v124, v124, v123, vcc
    ds_read_b128 v[0:3], v122 offset:0
    ds_read_b128 v[4:7], v122 offset:16384
    ds_read_b128 v[8:11], v122 offset:32768
    v_add_u32 v122, 49152, v122
    ds_read_b128 v[12:15], v122 offset:0
    ds_read_b128 v[16:19], v122 offset:16384
    ds_read_b128 v[20:23], v122 offset:32768
    s_mov_b64 exec, vcc
    ds_read_b128 v[24:27], v122 offset:49152
    s_mov_b64 exec, -1
    s_cmp_lg_u32 s21, 0
    s_cbranch_scc1 p2_finf
    s_waitcnt lgkmcnt(6)
    buffer_store_dwordx4 v[0:3], v123, s[4:7], s44 offen nt
    s_add_u32 s44, s44, 16384
    s_waitcnt lgkmcnt(5)
    buffer_store_dwordx4 v[4:7], v123, s[4:7], s44 offen nt
    s_add_u32 s44, s44, 16384
    s_waitcnt lgkmcnt(4)
    buffer_store_dwordx4 v[8:11], v123, s[4:7], s44 offen nt
    s_add_u32 s44, s44, 16384
    s_waitcnt lgkmcnt(3)
    buffer_store_dwordx4 v[12:15], v123, s[4:7], s44 offen nt
    s_add_u32 s44, s44, 16384
    s_waitcnt lgkmcnt(2)
    buffer_store_dwordx4 v[16:19], v123, s[4:7], s44 offen nt
    s_add_u32 s44, s44, 16384
    s_waitcnt lgkmcnt(1)
    buffer_store_dwordx4 v[20:23], v123, s[4:7], s44 offen nt
    s_add_u32 s44, s44, 16384
    s_waitcnt lgkmcnt(0)
    buffer_store_dwordx4 v[24:27], v124, s[4:7], s44 offen nt
    s_add_u32 s44, s44, 16384
    v_bitop3_b32 v115, v115, v0, v1 bitop3:0xfe
    v_bitop3_b32 v115, v115, v2, v3 bitop3:0xfe
    v_bitop3_b32 v115, v115, v4, v5 bitop3:0xfe
    v_bitop3_b32 v115, v115, v6, v7 bitop3:0xfe
    v_bitop3_b32 v115, v115, v8, v9 bitop3:0xfe
    v_bitop3_b32 v115, v115, v10, v11 bitop3:0xfe
    v_bitop3_b32 v115, v115, v12, v13 bitop3:0xfe
    v_bitop3_b32 v115, v115, v14, v15 bitop3:0xfe
    v_bitop3_b32 v115, v115, v16, v17 bitop3:0xfe
    v_bitop3_b32 v115, v115, v18, v19 bitop3:0xfe
    v_bitop3_b32 v115, v115, v20, v21 bitop3:0xfe
    v_bitop3_b32 v115, v115, v22, v23 bitop3:0xfe
    v_bitop3_b32 v115, v115, v24, v25 bitop3:0xfe
    v_bitop3_b32 v115, v115, v26, v27 bitop3:0xfe
    v_bitop3_b32 v115, v115, v116, v117 bitop3:0xfe
    v_bitop3_b32 v115, v115, v118, v119 bitop3:0xfe
    v_bitop3_b32 v115, v115, v120, v121 bitop3:0xfe
    v_and_b32 v115, 0x80008000, v115
    v_cmpx_ne_u32 vcc, 0, v115
    ds_write_b32 v126, v115 offset:53768
    s_mov_b64 exec, -1
    s_waitcnt lgkmcnt(0)
    s_barrier
    ds_read_b32 v125, v126 offset:53768
    s_waitcnt lgkmcnt(0)
    v_readfirstlane_b32 s45, v125
    s_nop 0
    s_cmp_eq_u32 s45, 0
    s_cbranch_scc1 p2_done
    s_mov_b32 s21, 1
    s_waitcnt vmcnt(0)
    s_branch p2_restart
p2_finf:
    s_lshl_b32 s49, s49, 4
    s_lshl_b32 s45, s21, 3
    s_add_u32 s49, s49, s45
    s_add_u32 s49, s49, 517903352
    v_mov_b32 v28, 1073758208
    v_mov_b32 v29, 1073758208
    v_mov_b32 v30, 1073758208
    v_mov_b32 v31, 1073758208
    v_lshlrev_b32 v122, 1, v123
    v_lshlrev_b32 v125, 1, v124
    s_waitcnt lgkmcnt(0)
    buffer_store_dwordx4 v[28:31], v123, s[4:7], s44 offen
    s_add_u32 s44, s44, 16384
    buffer_store_dwordx2 v[0:1], v122, s[4:7], s49 offen offset:0
    buffer_store_dwordx2 v[2:3], v122, s[4:7], s49 offen offset:16
    s_add_u32 s49, s49, 32768
    buffer_store_dwordx4 v[28:31], v123, s[4:7], s44 offen
    s_add_u32 s44, s44, 16384
    buffer_store_dwordx2 v[4:5], v122, s[4:7], s49 offen offset:0
    buffer_store_dwordx2 v[6:7], v122, s[4:7], s49 offen offset:16
    s_add_u32 s49, s49, 32768
    buffer_store_dwordx4 v[28:31], v123, s[4:7], s44 offen
    s_add_u32 s44, s44, 16384
    buffer_store_dwordx2 v[8:9], v122, s[4:7], s49 offen offset:0
    buffer_store_dwordx2 v[10:11], v122, s[4:7], s49 offen offset:16
    s_add_u32 s49, s49, 32768
    buffer_store_dwordx4 v[28:31], v123, s[4:7], s44 offen
    s_add_u32 s44, s44, 16384
    buffer_store_dwordx2 v[12:13], v122, s[4:7], s49 offen offset:0
    buffer_store_dwordx2 v[14:15], v122, s[4:7], s49 offen offset:16
    s_add_u32 s49, s49, 32768
    buffer_store_dwordx4 v[28:31], v123, s[4:7], s44 offen
    s_add_u32 s44, s44, 16384
    buffer_store_dwordx2 v[16:17], v122, s[4:7], s49 offen offset:0
    buffer_store_dwordx2 v[18:19], v122, s[4:7], s49 offen offset:16
    s_add_u32 s49, s49, 32768
    buffer_store_dwordx4 v[28:31], v123, s[4:7], s44 offen
    s_add_u32 s44, s44, 16384
    buffer_store_dwordx2 v[20:21], v122, s[4:7], s49 offen offset:0
    buffer_store_dwordx2 v[22:23], v122, s[4:7], s49 offen offset:16
    s_add_u32 s49, s49, 32768
    buffer_store_dwordx4 v[28:31], v124, s[4:7], s44 offen
    s_add_u32 s44, s44, 16384
    buffer_store_dwordx2 v[24:25], v125, s[4:7], s49 offen offset:0
    buffer_store_dwordx2 v[26:27], v125, s[4:7], s49 offen offset:16
    s_add_u32 s49, s49, 32768
    s_add_u32 s21, s21, 1
    s_mov_b32 s30, 0
    s_waitcnt vmcnt(0)
    s_cmp_eq_u32 s21, 2
    s_cbranch_scc1 p2_restart
p2_done:
    v_mov_b32 v125, s30
    buffer_store_dword v125, v126, s[4:7], s48 offen
p2_end:
    s_endpgm
.globl p3_kernel
.p2align 8
.type p3_kernel,@function
p3_kernel:
    s_cmp_ge_u32 s2, 1563
    s_cbranch_scc1 p3_end
    s_load_dwordx2 s[4:5], s[0:1], 0
    s_load_dwordx2 s[6:7], s[0:1], 24
    s_load_dwordx2 s[8:9], s[0:1], 40
    s_load_dwordx8 s[12:19], s[0:1], 56
    s_load_dwordx2 s[10:11], s[0:1], 88
    s_load_dwordx2 s[20:21], s[0:1], 104
    s_lshl_b32 s3, s2, 8
    v_add_u32 v0, s3, v0
    v_lshlrev_b32 v2, 4, v0
    v_lshlrev_b32 v3, 2, v0
    v_add_u32 v0, v0, v0
    v_mul_hi_u32_u24 v1, 343268, v0
    v_lshlrev_b16 v1, 4, v1
    s_waitcnt lgkmcnt(0)
    s_load_dwordx4 s[32:35], s[8:9], 0
    s_load_dwordx16 s[36:51], s[12:13], 0
    s_load_dwordx16 s[52:67], s[14:15], 0
    s_load_dwordx8 s[68:75], s[16:17], 0
    s_load_dwordx8 s[76:83], s[18:19], 0
    s_mov_b32 s24, s6
    s_and_b32 s25, s7, 0xffff
    s_mov_b32 s26, 1600000
    s_mov_b32 s27, 0x20000
    buffer_load_dword v4, v3, s[24:27], 0 offen nt
    s_mov_b32 s28, s20
    s_and_b32 s29, s21, 0xffff
    s_mov_b32 s30, 819200000
    s_mov_b32 s31, 0x20000
    s_mov_b32 s22, 492278784
    buffer_load_dwordx4 v[40:43], v2, s[28:31], s22 offen nt
    s_mov_b32 s22, 498684928
    buffer_load_dwordx4 v[44:47], v2, s[28:31], s22 offen nt
    s_mov_b32 s22, 505091072
    buffer_load_dwordx4 v[48:51], v2, s[28:31], s22 offen nt
    s_mov_b32 s22, 511497216
    buffer_load_dwordx4 v[52:55], v2, s[28:31], s22 offen nt
    s_mov_b32 s22, 492277760
    buffer_load_dwordx4 v[56:59], v1, s[28:31], s22 offen
    s_mov_b32 s24, s4
    s_and_b32 s25, s5, 0xffff
    s_mov_b32 s26, 6400000
    s_mov_b32 s27, 0x20000
    buffer_load_dwordx4 v[60:63], v2, s[24:27], 0 offen nt
    s_mov_b32 s24, s10
    s_and_b32 s25, s11, 0xffff
    s_mov_b32 s26, 6400000
    s_mov_b32 s27, 0x20000
    s_waitcnt vmcnt(6) lgkmcnt(0)
    v_and_b32 v5, 0xffff0000, v4
    v_lshlrev_b32 v4, 16, v4
    s_lshl_b32 s14, s32, 16
    s_and_b32 s15, s32, 0xffff0000
    v_pk_add_f32 v[8:9], v[4:5], s[14:15] op_sel:[0,0] op_sel_hi:[0,1] neg_lo:[0,1] neg_hi:[0,1]
    v_pk_add_f32 v[16:17], v[4:5], s[14:15] op_sel:[1,0] op_sel_hi:[1,1] neg_lo:[0,1] neg_hi:[0,1]
    s_lshl_b32 s16, s33, 16
    s_and_b32 s17, s33, 0xffff0000
    v_pk_add_f32 v[10:11], v[4:5], s[16:17] op_sel:[0,0] op_sel_hi:[0,1] neg_lo:[0,1] neg_hi:[0,1]
    v_pk_add_f32 v[18:19], v[4:5], s[16:17] op_sel:[1,0] op_sel_hi:[1,1] neg_lo:[0,1] neg_hi:[0,1]
    s_lshl_b32 s18, s34, 16
    s_and_b32 s19, s34, 0xffff0000
    v_pk_add_f32 v[12:13], v[4:5], s[18:19] op_sel:[0,0] op_sel_hi:[0,1] neg_lo:[0,1] neg_hi:[0,1]
    v_pk_add_f32 v[20:21], v[4:5], s[18:19] op_sel:[1,0] op_sel_hi:[1,1] neg_lo:[0,1] neg_hi:[0,1]
    s_lshl_b32 s12, s35, 16
    s_and_b32 s13, s35, 0xffff0000
    v_pk_add_f32 v[14:15], v[4:5], s[12:13] op_sel:[0,0] op_sel_hi:[0,1] neg_lo:[0,1] neg_hi:[0,1]
    v_pk_add_f32 v[22:23], v[4:5], s[12:13] op_sel:[1,0] op_sel_hi:[1,1] neg_lo:[0,1] neg_hi:[0,1]
    v_cvt_pk_bf16_f32 v8, v8, v9
    v_cvt_pk_bf16_f32 v10, v10, v11
    v_cvt_pk_bf16_f32 v12, v12, v13
    v_cvt_pk_bf16_f32 v14, v14, v15
    v_cvt_pk_bf16_f32 v16, v16, v17
    v_cvt_pk_bf16_f32 v18, v18, v19
    v_cvt_pk_bf16_f32 v20, v20, v21
    v_cvt_pk_bf16_f32 v22, v22, v23
    v_and_b32 v9, 0xffff0000, v8
    v_lshlrev_b32 v8, 16, v8
    v_and_b32 v11, 0xffff0000, v10
    v_lshlrev_b32 v10, 16, v10
    v_and_b32 v13, 0xffff0000, v12
    v_lshlrev_b32 v12, 16, v12
    v_and_b32 v15, 0xffff0000, v14
    v_lshlrev_b32 v14, 16, v14
    v_and_b32 v17, 0xffff0000, v16
    v_lshlrev_b32 v16, 16, v16
    v_and_b32 v19, 0xffff0000, v18
    v_lshlrev_b32 v18, 16, v18
    v_and_b32 v21, 0xffff0000, v20
    v_lshlrev_b32 v20, 16, v20
    v_and_b32 v23, 0xffff0000, v22
    v_lshlrev_b32 v22, 16, v22
    v_mul_f32 v8, v8, v8
    v_mul_f32 v9, v9, v9
    v_mul_f32 v10, v10, v10
    v_mul_f32 v11, v11, v11
    v_mul_f32 v12, v12, v12
    v_mul_f32 v13, v13, v13
    v_mul_f32 v14, v14, v14
    v_mul_f32 v15, v15, v15
    v_mul_f32 v16, v16, v16
    v_mul_f32 v17, v17, v17
    v_mul_f32 v18, v18, v18
    v_mul_f32 v19, v19, v19
    v_mul_f32 v20, v20, v20
    v_mul_f32 v21, v21, v21
    v_mul_f32 v22, v22, v22
    v_mul_f32 v23, v23, v23
    v_cvt_pk_bf16_f32 v8, v8, v9
    v_cvt_pk_bf16_f32 v10, v10, v11
    v_cvt_pk_bf16_f32 v12, v12, v13
    v_cvt_pk_bf16_f32 v14, v14, v15
    v_cvt_pk_bf16_f32 v16, v16, v17
    v_cvt_pk_bf16_f32 v18, v18, v19
    v_cvt_pk_bf16_f32 v20, v20, v21
    v_cvt_pk_bf16_f32 v22, v22, v23
    v_and_b32 v9, 0xffff0000, v8
    v_lshlrev_b32 v8, 16, v8
    v_and_b32 v11, 0xffff0000, v10
    v_lshlrev_b32 v10, 16, v10
    v_and_b32 v13, 0xffff0000, v12
    v_lshlrev_b32 v12, 16, v12
    v_and_b32 v15, 0xffff0000, v14
    v_lshlrev_b32 v14, 16, v14
    v_and_b32 v17, 0xffff0000, v16
    v_lshlrev_b32 v16, 16, v16
    v_and_b32 v19, 0xffff0000, v18
    v_lshlrev_b32 v18, 16, v18
    v_and_b32 v21, 0xffff0000, v20
    v_lshlrev_b32 v20, 16, v20
    v_and_b32 v23, 0xffff0000, v22
    v_lshlrev_b32 v22, 16, v22
    v_mul_f32 v8, 0xc1200000, v8
    v_mul_f32 v9, 0xc1200000, v9
    v_mul_f32 v10, 0xc1200000, v10
    v_mul_f32 v11, 0xc1200000, v11
    v_mul_f32 v12, 0xc1200000, v12
    v_mul_f32 v13, 0xc1200000, v13
    v_mul_f32 v14, 0xc1200000, v14
    v_mul_f32 v15, 0xc1200000, v15
    v_mul_f32 v16, 0xc1200000, v16
    v_mul_f32 v17, 0xc1200000, v17
    v_mul_f32 v18, 0xc1200000, v18
    v_mul_f32 v19, 0xc1200000, v19
    v_mul_f32 v20, 0xc1200000, v20
    v_mul_f32 v21, 0xc1200000, v21
    v_mul_f32 v22, 0xc1200000, v22
    v_mul_f32 v23, 0xc1200000, v23
    v_cvt_pk_bf16_f32 v8, v8, v9
    v_cvt_pk_bf16_f32 v10, v10, v11
    v_cvt_pk_bf16_f32 v12, v12, v13
    v_cvt_pk_bf16_f32 v14, v14, v15
    v_cvt_pk_bf16_f32 v16, v16, v17
    v_cvt_pk_bf16_f32 v18, v18, v19
    v_cvt_pk_bf16_f32 v20, v20, v21
    v_cvt_pk_bf16_f32 v22, v22, v23
    v_and_b32 v9, 0xffff0000, v8
    v_lshlrev_b32 v8, 16, v8
    v_and_b32 v11, 0xffff0000, v10
    v_lshlrev_b32 v10, 16, v10
    v_and_b32 v13, 0xffff0000, v12
    v_lshlrev_b32 v12, 16, v12
    v_and_b32 v15, 0xffff0000, v14
    v_lshlrev_b32 v14, 16, v14
    v_and_b32 v17, 0xffff0000, v16
    v_lshlrev_b32 v16, 16, v16
    v_and_b32 v19, 0xffff0000, v18
    v_lshlrev_b32 v18, 16, v18
    v_and_b32 v21, 0xffff0000, v20
    v_lshlrev_b32 v20, 16, v20
    v_and_b32 v23, 0xffff0000, v22
    v_lshlrev_b32 v22, 16, v22
    v_mul_f32 v8, 0x3fb8aa3b, v8
    v_mul_f32 v9, 0x3fb8aa3b, v9
    v_mul_f32 v10, 0x3fb8aa3b, v10
    v_mul_f32 v11, 0x3fb8aa3b, v11
    v_mul_f32 v12, 0x3fb8aa3b, v12
    v_mul_f32 v13, 0x3fb8aa3b, v13
    v_mul_f32 v14, 0x3fb8aa3b, v14
    v_mul_f32 v15, 0x3fb8aa3b, v15
    v_mul_f32 v16, 0x3fb8aa3b, v16
    v_mul_f32 v17, 0x3fb8aa3b, v17
    v_mul_f32 v18, 0x3fb8aa3b, v18
    v_mul_f32 v19, 0x3fb8aa3b, v19
    v_mul_f32 v20, 0x3fb8aa3b, v20
    v_mul_f32 v21, 0x3fb8aa3b, v21
    v_mul_f32 v22, 0x3fb8aa3b, v22
    v_mul_f32 v23, 0x3fb8aa3b, v23
    v_exp_f32 v8, v8
    v_exp_f32 v9, v9
    v_exp_f32 v10, v10
    v_exp_f32 v11, v11
    v_exp_f32 v12, v12
    v_exp_f32 v13, v13
    v_exp_f32 v14, v14
    v_exp_f32 v15, v15
    v_exp_f32 v16, v16
    v_exp_f32 v17, v17
    v_exp_f32 v18, v18
    v_exp_f32 v19, v19
    v_exp_f32 v20, v20
    v_exp_f32 v21, v21
    v_exp_f32 v22, v22
    v_exp_f32 v23, v23
    s_nop 0
    v_cvt_pk_bf16_f32 v8, v8, v9
    v_cvt_pk_bf16_f32 v10, v10, v11
    v_cvt_pk_bf16_f32 v12, v12, v13
    v_cvt_pk_bf16_f32 v14, v14, v15
    v_cvt_pk_bf16_f32 v16, v16, v17
    v_cvt_pk_bf16_f32 v18, v18, v19
    v_cvt_pk_bf16_f32 v20, v20, v21
    v_cvt_pk_bf16_f32 v22, v22, v23
    v_and_b32 v9, 0xffff0000, v8
    v_lshlrev_b32 v8, 16, v8
    v_and_b32 v11, 0xffff0000, v10
    v_lshlrev_b32 v10, 16, v10
    v_and_b32 v13, 0xffff0000, v12
    v_lshlrev_b32 v12, 16, v12
    v_and_b32 v15, 0xffff0000, v14
    v_lshlrev_b32 v14, 16, v14
    v_and_b32 v17, 0xffff0000, v16
    v_lshlrev_b32 v16, 16, v16
    v_and_b32 v19, 0xffff0000, v18
    v_lshlrev_b32 v18, 16, v18
    v_and_b32 v21, 0xffff0000, v20
    v_lshlrev_b32 v20, 16, v20
    v_and_b32 v23, 0xffff0000, v22
    v_lshlrev_b32 v22, 16, v22
    s_lshl_b32 s14, s52, 16
    s_and_b32 s15, s52, 0xffff0000
    v_pk_mul_f32 v[24:25], v[8:9], s[14:15] op_sel:[0,0] op_sel_hi:[0,1]
    v_pk_mul_f32 v[28:29], v[16:17], s[14:15] op_sel:[0,0] op_sel_hi:[0,1]
    s_lshl_b32 s16, s53, 16
    s_and_b32 s17, s53, 0xffff0000
    v_pk_mul_f32 v[26:27], v[8:9], s[16:17] op_sel:[0,0] op_sel_hi:[0,1]
    v_pk_mul_f32 v[30:31], v[16:17], s[16:17] op_sel:[0,0] op_sel_hi:[0,1]
    s_lshl_b32 s18, s54, 16
    s_and_b32 s19, s54, 0xffff0000
    v_pk_fma_f32 v[24:25], v[8:9], s[18:19], v[24:25] op_sel:[1,0,0] op_sel_hi:[1,1,1]
    v_pk_fma_f32 v[28:29], v[16:17], s[18:19], v[28:29] op_sel:[1,0,0] op_sel_hi:[1,1,1]
    s_lshl_b32 s12, s55, 16
    s_and_b32 s13, s55, 0xffff0000
    v_pk_fma_f32 v[26:27], v[8:9], s[12:13], v[26:27] op_sel:[1,0,0] op_sel_hi:[1,1,1]
    v_pk_fma_f32 v[30:31], v[16:17], s[12:13], v[30:31] op_sel:[1,0,0] op_sel_hi:[1,1,1]
    s_lshl_b32 s14, s56, 16
    s_and_b32 s15, s56, 0xffff0000
    v_pk_fma_f32 v[24:25], v[10:11], s[14:15], v[24:25] op_sel:[0,0,0] op_sel_hi:[0,1,1]
    v_pk_fma_f32 v[28:29], v[18:19], s[14:15], v[28:29] op_sel:[0,0,0] op_sel_hi:[0,1,1]
    s_lshl_b32 s16, s57, 16
    s_and_b32 s17, s57, 0xffff0000
    v_pk_fma_f32 v[26:27], v[10:11], s[16:17], v[26:27] op_sel:[0,0,0] op_sel_hi:[0,1,1]
    v_pk_fma_f32 v[30:31], v[18:19], s[16:17], v[30:31] op_sel:[0,0,0] op_sel_hi:[0,1,1]
    s_lshl_b32 s18, s58, 16
    s_and_b32 s19, s58, 0xffff0000
    v_pk_fma_f32 v[24:25], v[10:11], s[18:19], v[24:25] op_sel:[1,0,0] op_sel_hi:[1,1,1]
    v_pk_fma_f32 v[28:29], v[18:19], s[18:19], v[28:29] op_sel:[1,0,0] op_sel_hi:[1,1,1]
    s_lshl_b32 s12, s59, 16
    s_and_b32 s13, s59, 0xffff0000
    v_pk_fma_f32 v[26:27], v[10:11], s[12:13], v[26:27] op_sel:[1,0,0] op_sel_hi:[1,1,1]
    v_pk_fma_f32 v[30:31], v[18:19], s[12:13], v[30:31] op_sel:[1,0,0] op_sel_hi:[1,1,1]
    s_lshl_b32 s14, s60, 16
    s_and_b32 s15, s60, 0xffff0000
    v_pk_fma_f32 v[24:25], v[12:13], s[14:15], v[24:25] op_sel:[0,0,0] op_sel_hi:[0,1,1]
    v_pk_fma_f32 v[28:29], v[20:21], s[14:15], v[28:29] op_sel:[0,0,0] op_sel_hi:[0,1,1]
    s_lshl_b32 s16, s61, 16
    s_and_b32 s17, s61, 0xffff0000
    v_pk_fma_f32 v[26:27], v[12:13], s[16:17], v[26:27] op_sel:[0,0,0] op_sel_hi:[0,1,1]
    v_pk_fma_f32 v[30:31], v[20:21], s[16:17], v[30:31] op_sel:[0,0,0] op_sel_hi:[0,1,1]
    s_lshl_b32 s18, s62, 16
    s_and_b32 s19, s62, 0xffff0000
    v_pk_fma_f32 v[24:25], v[12:13], s[18:19], v[24:25] op_sel:[1,0,0] op_sel_hi:[1,1,1]
    v_pk_fma_f32 v[28:29], v[20:21], s[18:19], v[28:29] op_sel:[1,0,0] op_sel_hi:[1,1,1]
    s_lshl_b32 s12, s63, 16
    s_and_b32 s13, s63, 0xffff0000
    v_pk_fma_f32 v[26:27], v[12:13], s[12:13], v[26:27] op_sel:[1,0,0] op_sel_hi:[1,1,1]
    v_pk_fma_f32 v[30:31], v[20:21], s[12:13], v[30:31] op_sel:[1,0,0] op_sel_hi:[1,1,1]
    s_lshl_b32 s14, s64, 16
    s_and_b32 s15, s64, 0xffff0000
    v_pk_fma_f32 v[24:25], v[14:15], s[14:15], v[24:25] op_sel:[0,0,0] op_sel_hi:[0,1,1]
    v_pk_fma_f32 v[28:29], v[22:23], s[14:15], v[28:29] op_sel:[0,0,0] op_sel_hi:[0,1,1]
    s_lshl_b32 s16, s65, 16
    s_and_b32 s17, s65, 0xffff0000
    v_pk_fma_f32 v[26:27], v[14:15], s[16:17], v[26:27] op_sel:[0,0,0] op_sel_hi:[0,1,1]
    v_pk_fma_f32 v[30:31], v[22:23], s[16:17], v[30:31] op_sel:[0,0,0] op_sel_hi:[0,1,1]
    s_lshl_b32 s18, s66, 16
    s_and_b32 s19, s66, 0xffff0000
    v_pk_fma_f32 v[24:25], v[14:15], s[18:19], v[24:25] op_sel:[1,0,0] op_sel_hi:[1,1,1]
    v_pk_fma_f32 v[28:29], v[22:23], s[18:19], v[28:29] op_sel:[1,0,0] op_sel_hi:[1,1,1]
    s_lshl_b32 s12, s67, 16
    s_and_b32 s13, s67, 0xffff0000
    v_pk_fma_f32 v[26:27], v[14:15], s[12:13], v[26:27] op_sel:[1,0,0] op_sel_hi:[1,1,1]
    v_pk_fma_f32 v[30:31], v[22:23], s[12:13], v[30:31] op_sel:[1,0,0] op_sel_hi:[1,1,1]
    s_lshl_b32 s14, s36, 16
    s_and_b32 s15, s36, 0xffff0000
    v_pk_mul_f32 v[32:33], v[8:9], s[14:15] op_sel:[0,0] op_sel_hi:[0,1]
    v_pk_mul_f32 v[36:37], v[16:17], s[14:15] op_sel:[0,0] op_sel_hi:[0,1]
    s_lshl_b32 s16, s37, 16
    s_and_b32 s17, s37, 0xffff0000
    v_pk_mul_f32 v[34:35], v[8:9], s[16:17] op_sel:[0,0] op_sel_hi:[0,1]
    v_pk_mul_f32 v[38:39], v[16:17], s[16:17] op_sel:[0,0] op_sel_hi:[0,1]
    s_lshl_b32 s18, s38, 16
    s_and_b32 s19, s38, 0xffff0000
    v_pk_fma_f32 v[32:33], v[8:9], s[18:19], v[32:33] op_sel:[1,0,0] op_sel_hi:[1,1,1]
    v_pk_fma_f32 v[36:37], v[16:17], s[18:19], v[36:37] op_sel:[1,0,0] op_sel_hi:[1,1,1]
    s_lshl_b32 s12, s39, 16
    s_and_b32 s13, s39, 0xffff0000
    v_pk_fma_f32 v[34:35], v[8:9], s[12:13], v[34:35] op_sel:[1,0,0] op_sel_hi:[1,1,1]
    v_pk_fma_f32 v[38:39], v[16:17], s[12:13], v[38:39] op_sel:[1,0,0] op_sel_hi:[1,1,1]
    s_lshl_b32 s14, s40, 16
    s_and_b32 s15, s40, 0xffff0000
    v_pk_fma_f32 v[32:33], v[10:11], s[14:15], v[32:33] op_sel:[0,0,0] op_sel_hi:[0,1,1]
    v_pk_fma_f32 v[36:37], v[18:19], s[14:15], v[36:37] op_sel:[0,0,0] op_sel_hi:[0,1,1]
    s_lshl_b32 s16, s41, 16
    s_and_b32 s17, s41, 0xffff0000
    v_pk_fma_f32 v[34:35], v[10:11], s[16:17], v[34:35] op_sel:[0,0,0] op_sel_hi:[0,1,1]
    v_pk_fma_f32 v[38:39], v[18:19], s[16:17], v[38:39] op_sel:[0,0,0] op_sel_hi:[0,1,1]
    s_lshl_b32 s18, s42, 16
    s_and_b32 s19, s42, 0xffff0000
    v_pk_fma_f32 v[32:33], v[10:11], s[18:19], v[32:33] op_sel:[1,0,0] op_sel_hi:[1,1,1]
    v_pk_fma_f32 v[36:37], v[18:19], s[18:19], v[36:37] op_sel:[1,0,0] op_sel_hi:[1,1,1]
    s_lshl_b32 s12, s43, 16
    s_and_b32 s13, s43, 0xffff0000
    v_pk_fma_f32 v[34:35], v[10:11], s[12:13], v[34:35] op_sel:[1,0,0] op_sel_hi:[1,1,1]
    v_pk_fma_f32 v[38:39], v[18:19], s[12:13], v[38:39] op_sel:[1,0,0] op_sel_hi:[1,1,1]
    s_lshl_b32 s14, s44, 16
    s_and_b32 s15, s44, 0xffff0000
    v_pk_fma_f32 v[32:33], v[12:13], s[14:15], v[32:33] op_sel:[0,0,0] op_sel_hi:[0,1,1]
    v_pk_fma_f32 v[36:37], v[20:21], s[14:15], v[36:37] op_sel:[0,0,0] op_sel_hi:[0,1,1]
    s_lshl_b32 s16, s45, 16
    s_and_b32 s17, s45, 0xffff0000
    v_pk_fma_f32 v[34:35], v[12:13], s[16:17], v[34:35] op_sel:[0,0,0] op_sel_hi:[0,1,1]
    v_pk_fma_f32 v[38:39], v[20:21], s[16:17], v[38:39] op_sel:[0,0,0] op_sel_hi:[0,1,1]
    s_lshl_b32 s18, s46, 16
    s_and_b32 s19, s46, 0xffff0000
    v_pk_fma_f32 v[32:33], v[12:13], s[18:19], v[32:33] op_sel:[1,0,0] op_sel_hi:[1,1,1]
    v_pk_fma_f32 v[36:37], v[20:21], s[18:19], v[36:37] op_sel:[1,0,0] op_sel_hi:[1,1,1]
    s_lshl_b32 s12, s47, 16
    s_and_b32 s13, s47, 0xffff0000
    v_pk_fma_f32 v[34:35], v[12:13], s[12:13], v[34:35] op_sel:[1,0,0] op_sel_hi:[1,1,1]
    v_pk_fma_f32 v[38:39], v[20:21], s[12:13], v[38:39] op_sel:[1,0,0] op_sel_hi:[1,1,1]
    s_lshl_b32 s14, s48, 16
    s_and_b32 s15, s48, 0xffff0000
    v_pk_fma_f32 v[32:33], v[14:15], s[14:15], v[32:33] op_sel:[0,0,0] op_sel_hi:[0,1,1]
    v_pk_fma_f32 v[36:37], v[22:23], s[14:15], v[36:37] op_sel:[0,0,0] op_sel_hi:[0,1,1]
    s_lshl_b32 s16, s49, 16
    s_and_b32 s17, s49, 0xffff0000
    v_pk_fma_f32 v[34:35], v[14:15], s[16:17], v[34:35] op_sel:[0,0,0] op_sel_hi:[0,1,1]
    v_pk_fma_f32 v[38:39], v[22:23], s[16:17], v[38:39] op_sel:[0,0,0] op_sel_hi:[0,1,1]
    s_lshl_b32 s18, s50, 16
    s_and_b32 s19, s50, 0xffff0000
    v_pk_fma_f32 v[32:33], v[14:15], s[18:19], v[32:33] op_sel:[1,0,0] op_sel_hi:[1,1,1]
    v_pk_fma_f32 v[36:37], v[22:23], s[18:19], v[36:37] op_sel:[1,0,0] op_sel_hi:[1,1,1]
    s_lshl_b32 s12, s51, 16
    s_and_b32 s13, s51, 0xffff0000
    v_pk_fma_f32 v[34:35], v[14:15], s[12:13], v[34:35] op_sel:[1,0,0] op_sel_hi:[1,1,1]
    v_pk_fma_f32 v[38:39], v[22:23], s[12:13], v[38:39] op_sel:[1,0,0] op_sel_hi:[1,1,1]
    v_cvt_pk_bf16_f32 v32, v32, v33
    v_cvt_pk_bf16_f32 v34, v34, v35
    v_cvt_pk_bf16_f32 v36, v36, v37
    v_cvt_pk_bf16_f32 v38, v38, v39
    v_and_b32 v33, 0xffff0000, v32
    v_lshlrev_b32 v32, 16, v32
    v_and_b32 v35, 0xffff0000, v34
    v_lshlrev_b32 v34, 16, v34
    v_and_b32 v37, 0xffff0000, v36
    v_lshlrev_b32 v36, 16, v36
    v_and_b32 v39, 0xffff0000, v38
    v_lshlrev_b32 v38, 16, v38
    s_waitcnt vmcnt(1)
    v_add_u32 v40, v40, v44
    v_add_u32 v48, v48, v52
    v_add_u32 v41, v41, v45
    v_add_u32 v49, v49, v53
    v_add_u32 v42, v42, v46
    v_add_u32 v50, v50, v54
    v_add_u32 v43, v43, v47
    v_add_u32 v51, v51, v55
    v_add_u32_sdwa v8, v40, v48 dst_sel:DWORD dst_unused:UNUSED_PAD src0_sel:WORD_0 src1_sel:WORD_0
    v_add_u32_sdwa v9, v40, v48 dst_sel:DWORD dst_unused:UNUSED_PAD src0_sel:WORD_1 src1_sel:WORD_1
    v_add_u32_sdwa v10, v41, v49 dst_sel:DWORD dst_unused:UNUSED_PAD src0_sel:WORD_0 src1_sel:WORD_0
    v_add_u32_sdwa v11, v41, v49 dst_sel:DWORD dst_unused:UNUSED_PAD src0_sel:WORD_1 src1_sel:WORD_1
    v_add_u32_sdwa v12, v42, v50 dst_sel:DWORD dst_unused:UNUSED_PAD src0_sel:WORD_0 src1_sel:WORD_0
    v_add_u32_sdwa v13, v42, v50 dst_sel:DWORD dst_unused:UNUSED_PAD src0_sel:WORD_1 src1_sel:WORD_1
    v_add_u32_sdwa v14, v43, v51 dst_sel:DWORD dst_unused:UNUSED_PAD src0_sel:WORD_0 src1_sel:WORD_0
    v_add_u32_sdwa v15, v43, v51 dst_sel:DWORD dst_unused:UNUSED_PAD src0_sel:WORD_1 src1_sel:WORD_1
    v_min3_u32 v5, v56, v57, v58
    v_bitop3_b32 v4, v56, v57, v58 bitop3:0xfe
    v_min_u32 v5, v5, v59
    v_or_b32 v4, v4, v59
    v_or_b32 v8, 0x4b000000, v8
    v_or_b32 v9, 0x4b000000, v9
    v_or_b32 v10, 0x4b000000, v10
    v_or_b32 v11, 0x4b000000, v11
    v_or_b32 v12, 0x4b000000, v12
    v_or_b32 v13, 0x4b000000, v13
    v_or_b32 v14, 0x4b000000, v14
    v_or_b32 v15, 0x4b000000, v15
    v_cmp_eq_u32 vcc, 0, v5
    v_add_f32 v8, 0xcb010000, v8
    v_add_f32 v9, 0xcb010000, v9
    v_add_f32 v10, 0xcb010000, v10
    v_add_f32 v11, 0xcb010000, v11
    v_add_f32 v12, 0xcb010000, v12
    v_add_f32 v13, 0xcb010000, v13
    v_add_f32 v14, 0xcb010000, v14
    v_add_f32 v15, 0xcb010000, v15
    v_mul_f32 v8, v4, v8
    v_mul_f32 v9, v4, v9
    v_mul_f32 v10, v4, v10
    v_mul_f32 v11, v4, v11
    v_mul_f32 v12, v4, v12
    v_mul_f32 v13, v4, v13
    v_mul_f32 v14, v4, v14
    v_mul_f32 v15, v4, v15
    s_cbranch_vccz p3_nof
    v_lshlrev_b32 v1, 4, v0
    v_mov_b32 v3, 0x70000000
    v_cmp_eq_u32 vcc, 0, v56
    s_mov_b32 s22, 517903360
    s_nop 0
    v_cndmask_b32 v5, v3, v1, vcc
    buffer_load_dwordx4 v[16:19], v5, s[28:31], s22 offen
    buffer_load_dwordx4 v[20:23], v5, s[28:31], s22 offen offset:16
    s_waitcnt vmcnt(0)
    v_add_f32 v8, v8, v16
    v_add_f32 v9, v9, v17
    v_add_f32 v10, v10, v18
    v_add_f32 v11, v11, v19
    v_add_f32 v12, v12, v20
    v_add_f32 v13, v13, v21
    v_add_f32 v14, v14, v22
    v_add_f32 v15, v15, v23
    v_cmp_eq_u32 vcc, 0, v57
    s_mov_b32 s22, 530715648
    s_nop 0
    v_cndmask_b32 v5, v3, v1, vcc
    buffer_load_dwordx4 v[16:19], v5, s[28:31], s22 offen
    buffer_load_dwordx4 v[20:23], v5, s[28:31], s22 offen offset:16
    s_waitcnt vmcnt(0)
    v_add_f32 v8, v8, v16
    v_add_f32 v9, v9, v17
    v_add_f32 v10, v10, v18
    v_add_f32 v11, v11, v19
    v_add_f32 v12, v12, v20
    v_add_f32 v13, v13, v21
    v_add_f32 v14, v14, v22
    v_add_f32 v15, v15, v23
    v_cmp_eq_u32 vcc, 0, v58
    s_mov_b32 s22, 543527936
    s_nop 0
    v_cndmask_b32 v5, v3, v1, vcc
    buffer_load_dwordx4 v[16:19], v5, s[28:31], s22 offen
    buffer_load_dwordx4 v[20:23], v5, s[28:31], s22 offen offset:16
    s_waitcnt vmcnt(0)
    v_add_f32 v8, v8, v16
    v_add_f32 v9, v9, v17
    v_add_f32 v10, v10, v18
    v_add_f32 v11, v11, v19
    v_add_f32 v12, v12, v20
    v_add_f32 v13, v13, v21
    v_add_f32 v14, v14, v22
    v_add_f32 v15, v15, v23
    v_cmp_eq_u32 vcc, 0, v59
    s_mov_b32 s22, 556340224
    s_nop 0
    v_cndmask_b32 v5, v3, v1, vcc
    buffer_load_dwordx4 v[16:19], v5, s[28:31], s22 offen
    buffer_load_dwordx4 v[20:23], v5, s[28:31], s22 offen offset:16
    s_waitcnt vmcnt(0)
    v_add_f32 v8, v8, v16
    v_add_f32 v9, v9, v17
    v_add_f32 v10, v10, v18
    v_add_f32 v11, v11, v19
    v_add_f32 v12, v12, v20
    v_add_f32 v13, v13, v21
    v_add_f32 v14, v14, v22
    v_add_f32 v15, v15, v23
p3_nof:
    s_lshl_b32 s14, s68, 16
    s_and_b32 s15, s68, 0xffff0000
    v_pk_mul_f32 v[16:17], v[8:9], s[14:15] op_sel:[0,0] op_sel_hi:[0,1]
    v_pk_mul_f32 v[20:21], v[12:13], s[14:15] op_sel:[0,0] op_sel_hi:[0,1]
    s_lshl_b32 s16, s69, 16
    s_and_b32 s17, s69, 0xffff0000
    v_pk_mul_f32 v[18:19], v[8:9], s[16:17] op_sel:[0,0] op_sel_hi:[0,1]
    v_pk_mul_f32 v[22:23], v[12:13], s[16:17] op_sel:[0,0] op_sel_hi:[0,1]
    s_lshl_b32 s18, s70, 16
    s_and_b32 s19, s70, 0xffff0000
    v_pk_fma_f32 v[16:17], v[8:9], s[18:19], v[16:17] op_sel:[1,0,0] op_sel_hi:[1,1,1]
    v_pk_fma_f32 v[20:21], v[12:13], s[18:19], v[20:21] op_sel:[1,0,0] op_sel_hi:[1,1,1]
    s_lshl_b32 s12, s71, 16
    s_and_b32 s13, s71, 0xffff0000
    v_pk_fma_f32 v[18:19], v[8:9], s[12:13], v[18:19] op_sel:[1,0,0] op_sel_hi:[1,1,1]
    v_pk_fma_f32 v[22:23], v[12:13], s[12:13], v[22:23] op_sel:[1,0,0] op_sel_hi:[1,1,1]
    s_lshl_b32 s14, s72, 16
    s_and_b32 s15, s72, 0xffff0000
    v_pk_fma_f32 v[16:17], v[10:11], s[14:15], v[16:17] op_sel:[0,0,0] op_sel_hi:[0,1,1]
    v_pk_fma_f32 v[20:21], v[14:15], s[14:15], v[20:21] op_sel:[0,0,0] op_sel_hi:[0,1,1]
    s_lshl_b32 s16, s73, 16
    s_and_b32 s17, s73, 0xffff0000
    v_pk_fma_f32 v[18:19], v[10:11], s[16:17], v[18:19] op_sel:[0,0,0] op_sel_hi:[0,1,1]
    v_pk_fma_f32 v[22:23], v[14:15], s[16:17], v[22:23] op_sel:[0,0,0] op_sel_hi:[0,1,1]
    s_lshl_b32 s18, s74, 16
    s_and_b32 s19, s74, 0xffff0000
    v_pk_fma_f32 v[16:17], v[10:11], s[18:19], v[16:17] op_sel:[1,0,0] op_sel_hi:[1,1,1]
    v_pk_fma_f32 v[20:21], v[14:15], s[18:19], v[20:21] op_sel:[1,0,0] op_sel_hi:[1,1,1]
    s_lshl_b32 s12, s75, 16
    s_and_b32 s13, s75, 0xffff0000
    v_pk_fma_f32 v[18:19], v[10:11], s[12:13], v[18:19] op_sel:[1,0,0] op_sel_hi:[1,1,1]
    v_pk_fma_f32 v[22:23], v[14:15], s[12:13], v[22:23] op_sel:[1,0,0] op_sel_hi:[1,1,1]
    v_mul_f32 v24, v24, v16
    v_mul_f32 v25, v25, v17
    v_mul_f32 v26, v26, v18
    v_mul_f32 v27, v27, v19
    v_mul_f32 v28, v28, v20
    v_mul_f32 v29, v29, v21
    v_mul_f32 v30, v30, v22
    v_mul_f32 v31, v31, v23
    v_cvt_pk_bf16_f32 v24, v24, v25
    v_cvt_pk_bf16_f32 v26, v26, v27
    v_cvt_pk_bf16_f32 v28, v28, v29
    v_cvt_pk_bf16_f32 v30, v30, v31
    v_and_b32 v25, 0xffff0000, v24
    v_lshlrev_b32 v24, 16, v24
    v_and_b32 v27, 0xffff0000, v26
    v_lshlrev_b32 v26, 16, v26
    v_and_b32 v29, 0xffff0000, v28
    v_lshlrev_b32 v28, 16, v28
    v_and_b32 v31, 0xffff0000, v30
    v_lshlrev_b32 v30, 16, v30
    s_lshl_b32 s14, s76, 16
    s_and_b32 s15, s76, 0xffff0000
    v_pk_mul_f32 v[16:17], v[24:25], s[14:15] op_sel:[0,0] op_sel_hi:[0,1]
    v_pk_mul_f32 v[20:21], v[28:29], s[14:15] op_sel:[0,0] op_sel_hi:[0,1]
    s_lshl_b32 s16, s77, 16
    s_and_b32 s17, s77, 0xffff0000
    v_pk_mul_f32 v[18:19], v[24:25], s[16:17] op_sel:[0,0] op_sel_hi:[0,1]
    v_pk_mul_f32 v[22:23], v[28:29], s[16:17] op_sel:[0,0] op_sel_hi:[0,1]
    s_lshl_b32 s18, s78, 16
    s_and_b32 s19, s78, 0xffff0000
    v_pk_fma_f32 v[16:17], v[24:25], s[18:19], v[16:17] op_sel:[1,0,0] op_sel_hi:[1,1,1]
    v_pk_fma_f32 v[20:21], v[28:29], s[18:19], v[20:21] op_sel:[1,0,0] op_sel_hi:[1,1,1]
    s_lshl_b32 s12, s79, 16
    s_and_b32 s13, s79, 0xffff0000
    v_pk_fma_f32 v[18:19], v[24:25], s[12:13], v[18:19] op_sel:[1,0,0] op_sel_hi:[1,1,1]
    v_pk_fma_f32 v[22:23], v[28:29], s[12:13], v[22:23] op_sel:[1,0,0] op_sel_hi:[1,1,1]
    s_lshl_b32 s14, s80, 16
    s_and_b32 s15, s80, 0xffff0000
    v_pk_fma_f32 v[16:17], v[26:27], s[14:15], v[16:17] op_sel:[0,0,0] op_sel_hi:[0,1,1]
    v_pk_fma_f32 v[20:21], v[30:31], s[14:15], v[20:21] op_sel:[0,0,0] op_sel_hi:[0,1,1]
    s_lshl_b32 s16, s81, 16
    s_and_b32 s17, s81, 0xffff0000
    v_pk_fma_f32 v[18:19], v[26:27], s[16:17], v[18:19] op_sel:[0,0,0] op_sel_hi:[0,1,1]
    v_pk_fma_f32 v[22:23], v[30:31], s[16:17], v[22:23] op_sel:[0,0,0] op_sel_hi:[0,1,1]
    s_lshl_b32 s18, s82, 16
    s_and_b32 s19, s82, 0xffff0000
    v_pk_fma_f32 v[16:17], v[26:27], s[18:19], v[16:17] op_sel:[1,0,0] op_sel_hi:[1,1,1]
    v_pk_fma_f32 v[20:21], v[30:31], s[18:19], v[20:21] op_sel:[1,0,0] op_sel_hi:[1,1,1]
    s_lshl_b32 s12, s83, 16
    s_and_b32 s13, s83, 0xffff0000
    v_pk_fma_f32 v[18:19], v[26:27], s[12:13], v[18:19] op_sel:[1,0,0] op_sel_hi:[1,1,1]
    v_pk_fma_f32 v[22:23], v[30:31], s[12:13], v[22:23] op_sel:[1,0,0] op_sel_hi:[1,1,1]
    v_cvt_pk_bf16_f32 v16, v16, v17
    v_cvt_pk_bf16_f32 v18, v18, v19
    v_cvt_pk_bf16_f32 v20, v20, v21
    v_cvt_pk_bf16_f32 v22, v22, v23
    v_and_b32 v17, 0xffff0000, v16
    v_lshlrev_b32 v16, 16, v16
    v_and_b32 v19, 0xffff0000, v18
    v_lshlrev_b32 v18, 16, v18
    v_and_b32 v21, 0xffff0000, v20
    v_lshlrev_b32 v20, 16, v20
    v_and_b32 v23, 0xffff0000, v22
    v_lshlrev_b32 v22, 16, v22
    v_mul_f32 v16, v16, v32
    v_mul_f32 v17, v17, v33
    v_mul_f32 v18, v18, v34
    v_mul_f32 v19, v19, v35
    v_mul_f32 v20, v20, v36
    v_mul_f32 v21, v21, v37
    v_mul_f32 v22, v22, v38
    v_mul_f32 v23, v23, v39
    v_cvt_pk_bf16_f32 v16, v16, v17
    v_cvt_pk_bf16_f32 v18, v18, v19
    v_cvt_pk_bf16_f32 v20, v20, v21
    v_cvt_pk_bf16_f32 v22, v22, v23
    v_and_b32 v17, 0xffff0000, v16
    v_lshlrev_b32 v16, 16, v16
    v_and_b32 v19, 0xffff0000, v18
    v_lshlrev_b32 v18, 16, v18
    v_and_b32 v21, 0xffff0000, v20
    v_lshlrev_b32 v20, 16, v20
    v_and_b32 v23, 0xffff0000, v22
    v_lshlrev_b32 v22, 16, v22
    s_waitcnt vmcnt(0)
    v_lshlrev_b32 v8, 16, v60
    v_and_b32 v9, 0xffff0000, v60
    v_lshlrev_b32 v10, 16, v61
    v_and_b32 v11, 0xffff0000, v61
    v_lshlrev_b32 v12, 16, v62
    v_and_b32 v13, 0xffff0000, v62
    v_lshlrev_b32 v14, 16, v63
    v_and_b32 v15, 0xffff0000, v63
    v_add_f32 v8, v8, v16
    v_add_f32 v9, v9, v17
    v_add_f32 v10, v10, v18
    v_add_f32 v11, v11, v19
    v_add_f32 v12, v12, v20
    v_add_f32 v13, v13, v21
    v_add_f32 v14, v14, v22
    v_add_f32 v15, v15, v23
    v_cvt_pk_bf16_f32 v4, v8, v9
    v_cvt_pk_bf16_f32 v5, v10, v11
    v_cvt_pk_bf16_f32 v6, v12, v13
    v_cvt_pk_bf16_f32 v7, v14, v15
    buffer_store_dwordx4 v[4:7], v2, s[24:27], 0 offen nt
p3_end:
    s_endpgm
.section .rodata,"a"
.p2align 6
.amdhsa_kernel p1_kernel
  .amdhsa_next_free_vgpr 128
  .amdhsa_next_free_sgpr 72
  .amdhsa_accum_offset 128
  .amdhsa_group_segment_fixed_size 0
  .amdhsa_kernarg_size 112
  .amdhsa_user_sgpr_count 2
  .amdhsa_user_sgpr_kernarg_segment_ptr 1
  .amdhsa_system_sgpr_workgroup_id_x 1
  .amdhsa_float_denorm_mode_32 3
.end_amdhsa_kernel
.p2align 6
.amdhsa_kernel p2_kernel
  .amdhsa_next_free_vgpr 128
  .amdhsa_next_free_sgpr 72
  .amdhsa_accum_offset 128
  .amdhsa_group_segment_fixed_size 0
  .amdhsa_kernarg_size 112
  .amdhsa_user_sgpr_count 2
  .amdhsa_user_sgpr_kernarg_segment_ptr 1
  .amdhsa_system_sgpr_workgroup_id_x 1
  .amdhsa_float_denorm_mode_32 3
.end_amdhsa_kernel
.p2align 6
.amdhsa_kernel p3_kernel
  .amdhsa_next_free_vgpr 64
  .amdhsa_next_free_sgpr 84
  .amdhsa_accum_offset 64
  .amdhsa_group_segment_fixed_size 0
  .amdhsa_kernarg_size 112
  .amdhsa_user_sgpr_count 2
  .amdhsa_user_sgpr_kernarg_segment_ptr 1
  .amdhsa_system_sgpr_workgroup_id_x 1
  .amdhsa_float_denorm_mode_32 3
.end_amdhsa_kernel
```

```asm
; @launch kernel=p1_kernel grid=(256,1,1) block=(1024,1,1) lds=163072
; @launch kernel=p2_kernel grid=(256,1,1) block=(1024,1,1) lds=154368
; @launch kernel=p3_kernel grid=(1563,1,1) block=(256,1,1) lds=0
.amdgcn_target "amdgcn-amd-amdhsa--gfx950"
.text
.globl p1_kernel
.p2align 8
.type p1_kernel,@function
p1_kernel:
    s_cmp_ge_u32 s2, 256
    s_cbranch_scc1 p1_end
    s_load_dwordx2 s[52:53], s[0:1], 0
    s_load_dwordx4 s[56:59], s[0:1], 8
    s_load_dwordx2 s[54:55], s[0:1], 32
    s_load_dwordx2 s[60:61], s[0:1], 48
    s_load_dwordx2 s[48:49], s[0:1], 104
    s_load_dwordx2 s[62:63], s[0:1], 96
    v_lshlrev_b32 v1, 4, v0
    v_lshlrev_b32 v2, 3, v0
    v_mov_b32 v3, 1
    v_lshrrev_b32 v117, 6, v0
    s_nop 0
    v_readfirstlane_b32 s28, v117
    s_waitcnt lgkmcnt(0)
    s_load_dword s45, s[60:61], 0
    s_mov_b32 s4, s56
    s_and_b32 s5, s57, 0xffff
    s_mov_b32 s6, 204800000
    s_mov_b32 s7, 0x20000
    s_mov_b32 s8, s58
    s_and_b32 s9, s59, 0xffff
    s_mov_b32 s10, 204800000
    s_mov_b32 s11, 0x20000
    s_mov_b32 s12, s54
    s_and_b32 s13, s55, 0xffff
    s_mov_b32 s14, 102400000
    s_mov_b32 s15, 0x20000
    s_mov_b32 s16, s48
    s_and_b32 s17, s49, 0xffff
    s_mov_b32 s18, 819200000
    s_mov_b32 s19, 0x20000
    s_mov_b32 s29, s2
    s_mul_i32 s31, s2, 73728
    s_lshl_b32 s30, s31, 1
    s_add_u32 s32, s30, 0
    buffer_load_dwordx4 v[94:97], v1, s[4:7], s32 offen nt
    buffer_load_dwordx4 v[102:105], v1, s[8:11], s32 offen nt
    s_add_u32 s32, s31, 0
    buffer_load_dwordx2 v[76:77], v2, s[12:15], s32 offen nt
    s_add_u32 s32, s30, 16384
    buffer_load_dwordx4 v[98:101], v1, s[4:7], s32 offen nt
    buffer_load_dwordx4 v[106:109], v1, s[8:11], s32 offen nt
    s_add_u32 s32, s31, 8192
    buffer_load_dwordx2 v[78:79], v2, s[12:15], s32 offen nt
    s_add_u32 s32, s30, 32768
    buffer_load_dwordx4 v[12:15], v1, s[4:7], s32 offen nt
    buffer_load_dwordx4 v[48:51], v1, s[8:11], s32 offen nt
    s_add_u32 s32, s31, 16384
    buffer_load_dwordx2 v[80:81], v2, s[12:15], s32 offen nt
    s_add_u32 s32, s31, 24576
    buffer_load_dwordx2 v[82:83], v2, s[12:15], s32 offen nt
    s_add_u32 s32, s31, 32768
    buffer_load_dwordx2 v[84:85], v2, s[12:15], s32 offen nt
    s_add_u32 s32, s31, 40960
    buffer_load_dwordx2 v[86:87], v2, s[12:15], s32 offen nt
    s_add_u32 s32, s31, 49152
    buffer_load_dwordx2 v[88:89], v2, s[12:15], s32 offen nt
    s_add_u32 s32, s31, 57344
    buffer_load_dwordx2 v[90:91], v2, s[12:15], s32 offen nt
    s_add_u32 s32, s31, 65536
    buffer_load_dwordx2 v[92:93], v2, s[12:15], s32 offen nt
    s_mov_b32 s24, s52
    s_and_b32 s25, s53, 0xffff
    s_mov_b32 s26, 6400000
    s_mov_b32 s27, 0x20000
    s_mov_b32 s20, s48
    s_and_b32 s21, s49, 0xffff
    s_mov_b32 s22, 0
    s_mov_b32 s23, 0x20000
    s_mov_b32 s40, s62
    s_and_b32 s41, s63, 0xffff
    s_mov_b32 s42, 256
    s_mov_b32 s43, 0x20000
    s_mov_b32 s36, 643827
    s_mov_b32 s37, 214609
    s_mov_b32 s38, 343268
    s_mov_b32 s39, -6671
    s_mov_b32 s44, -12512
    s_mov_b32 s34, 1
    v_mov_b32 v73, 0x40000000
    v_mov_b32 v122, 0
    v_mov_b32 v123, 0
    v_mov_b32 v124, 0
    v_mov_b32 v125, 0
    ds_write_b128 v1, v[122:125] offset:0
    s_waitcnt lgkmcnt(0)
    s_barrier
    s_lshl_b32 s45, s45, 16
p1_tile:
    v_mov_b32 v122, 0
    v_mov_b32 v123, 0
    v_mov_b32 v124, 0
    v_mov_b32 v125, 0
    ds_write_b128 v1, v[122:125] offset:10496
    ds_write_b128 v1, v[122:125] offset:26880
    ds_write_b128 v1, v[122:125] offset:43264
    s_cmp_lg_u32 s28, 15
    s_cbranch_scc1 p1_tk0
    v_mov_b32 v127, 1
    s_mov_b64 exec, 1
    buffer_atomic_add v127, off, s[40:43], 0 offset:128 sc0 sc1
    s_mov_b64 exec, -1
p1_tk0:
    v_mov_b32 v123, s45
    v_mov_b32 v124, 0x007f007f
    v_mov_b32 v125, 0xe000
    v_mov_b32 v126, 0xffff0000
    s_cmp_lt_u32 s29, 1426
    s_cselect_b32 s6, 204800000, 0
    s_cselect_b32 s10, 204800000, 0
    s_add_u32 s32, s30, 49152
    buffer_load_dwordx4 v[16:19], v1, s[4:7], s32 offen nt
    buffer_load_dwordx4 v[52:55], v1, s[8:11], s32 offen nt
    s_waitcnt vmcnt(14)
    v_lshlrev_b32 v117, 16, v76
    v_and_b32 v118, v126, v76
    v_mul_f32 v117, v123, v117
    v_mul_f32 v118, v123, v118
    v_cvt_pk_bf16_f32 v117, v117, v118
    v_and_b32 v118, v126, v117
    v_lshlrev_b32 v117, 16, v117
    v_mul_f32 v117, 0.15915494, v117
    v_mul_f32 v118, 0.15915494, v118
    v_fract_f32 v117, v117
    v_fract_f32 v118, v118
    v_cos_f32 v117, v117
    v_cos_f32 v118, v118
    v_mul_hi_u32_u24 v122, s38, v102
    v_mul_hi_u32_u24 v121, s37, v94
    v_mul_hi_u32_u24 v120, s36, v94
    v_mad_i32_i24 v110, v122, s44, v102
    v_mad_u32_u24 v40, v122, 40, v121
    v_mad_i32_i24 v4, v120, s39, v94
    v_lshlrev_b16 v40, 2, v40
    v_mad_i32_i24 v120, v121, -3, v120
    ds_add_u32 v40, v3 offset:0
    v_lshl_or_b32 v4, v110, 16, v4
    v_lshl_or_b32 v4, v120, 30, v4
    v_mul_f32 v117, 0x03800000, v117
    v_mul_f32 v118, 0x03800000, v118
    v_cvt_pk_bf16_f32 v117, v117, v118
    v_mul_hi_u32_u24 v122, s38, v103
    v_mul_hi_u32_u24 v121, s37, v95
    v_mul_hi_u32_u24 v120, s36, v95
    v_mad_i32_i24 v110, v122, s44, v103
    v_mad_u32_u24 v41, v122, 40, v121
    v_mad_i32_i24 v5, v120, s39, v95
    v_lshlrev_b16 v41, 2, v41
    v_mad_i32_i24 v120, v121, -3, v120
    ds_add_u32 v41, v3 offset:0
    v_lshl_or_b32 v5, v110, 16, v5
    v_lshl_or_b32 v5, v120, 30, v5
    v_lshrrev_b32 v118, 3, v117
    v_lshrrev_b32 v119, 8, v117
    v_lshlrev_b16 v117, 13, v117
    v_bitop3_b32 v119, v118, v119, v124 bitop3:0x1b
    v_bitop3_b32 v4, v117, v125, v4 bitop3:0xae
    v_lshl_or_b32 v40, v119, 16, v40
    v_bitop3_b32 v5, v118, v125, v5 bitop3:0xae
    v_bitop3_b32 v41, v119, v126, v41 bitop3:0xea
    v_lshlrev_b32 v117, 16, v77
    v_and_b32 v118, v126, v77
    v_mul_f32 v117, v123, v117
    v_mul_f32 v118, v123, v118
    v_cvt_pk_bf16_f32 v117, v117, v118
    v_and_b32 v118, v126, v117
    v_lshlrev_b32 v117, 16, v117
    v_mul_f32 v117, 0.15915494, v117
    v_mul_f32 v118, 0.15915494, v118
    v_fract_f32 v117, v117
    v_fract_f32 v118, v118
    v_cos_f32 v117, v117
    v_cos_f32 v118, v118
    v_mul_hi_u32_u24 v122, s38, v104
    v_mul_hi_u32_u24 v121, s37, v96
    v_mul_hi_u32_u24 v120, s36, v96
    v_mad_i32_i24 v110, v122, s44, v104
    v_mad_u32_u24 v42, v122, 40, v121
    v_mad_i32_i24 v6, v120, s39, v96
    v_lshlrev_b16 v42, 2, v42
    v_mad_i32_i24 v120, v121, -3, v120
    ds_add_u32 v42, v3 offset:0
    v_lshl_or_b32 v6, v110, 16, v6
    v_lshl_or_b32 v6, v120, 30, v6
    v_mul_f32 v117, 0x03800000, v117
    v_mul_f32 v118, 0x03800000, v118
    v_cvt_pk_bf16_f32 v117, v117, v118
    v_mul_hi_u32_u24 v122, s38, v105
    v_mul_hi_u32_u24 v121, s37, v97
    v_mul_hi_u32_u24 v120, s36, v97
    v_mad_i32_i24 v110, v122, s44, v105
    v_mad_u32_u24 v43, v122, 40, v121
    v_mad_i32_i24 v7, v120, s39, v97
    v_lshlrev_b16 v43, 2, v43
    v_mad_i32_i24 v120, v121, -3, v120
    ds_add_u32 v43, v3 offset:0
    v_lshl_or_b32 v7, v110, 16, v7
    v_lshl_or_b32 v7, v120, 30, v7
    v_lshrrev_b32 v118, 3, v117
    v_lshrrev_b32 v119, 8, v117
    v_lshlrev_b16 v117, 13, v117
    v_bitop3_b32 v119, v118, v119, v124 bitop3:0x1b
    v_bitop3_b32 v6, v117, v125, v6 bitop3:0xae
    v_lshl_or_b32 v42, v119, 16, v42
    v_bitop3_b32 v7, v118, v125, v7 bitop3:0xae
    v_bitop3_b32 v43, v119, v126, v43 bitop3:0xea
    s_cmp_lt_u32 s29, 1389
    s_cselect_b32 s6, 204800000, 0
    s_cselect_b32 s10, 204800000, 0
    s_add_u32 s32, s30, 65536
    buffer_load_dwordx4 v[20:23], v1, s[4:7], s32 offen nt
    buffer_load_dwordx4 v[56:59], v1, s[8:11], s32 offen nt
    s_cmp_ge_u32 s29, 1499
    s_cbranch_scc1 p1_k2
    s_cmp_lg_u32 s34, 0
    s_cbranch_scc1 p1_w3
    s_waitcnt vmcnt(10)
p1_w3:
    s_waitcnt vmcnt(13)
    v_lshlrev_b32 v117, 16, v78
    v_and_b32 v118, v126, v78
    v_mul_f32 v117, v123, v117
    v_mul_f32 v118, v123, v118
    v_cvt_pk_bf16_f32 v117, v117, v118
    v_and_b32 v118, v126, v117
    v_lshlrev_b32 v117, 16, v117
    v_mul_f32 v117, 0.15915494, v117
    v_mul_f32 v118, 0.15915494, v118
    v_fract_f32 v117, v117
    v_fract_f32 v118, v118
    v_cos_f32 v117, v117
    v_cos_f32 v118, v118
    v_mul_hi_u32_u24 v122, s38, v106
    v_mul_hi_u32_u24 v121, s37, v98
    v_mul_hi_u32_u24 v120, s36, v98
    v_mad_i32_i24 v110, v122, s44, v106
    v_mad_u32_u24 v44, v122, 40, v121
    v_mad_i32_i24 v8, v120, s39, v98
    v_lshlrev_b16 v44, 2, v44
    v_mad_i32_i24 v120, v121, -3, v120
    ds_add_u32 v44, v3 offset:0
    v_lshl_or_b32 v8, v110, 16, v8
    v_lshl_or_b32 v8, v120, 30, v8
    v_mul_f32 v117, 0x03800000, v117
    v_mul_f32 v118, 0x03800000, v118
    v_cvt_pk_bf16_f32 v117, v117, v118
    v_mul_hi_u32_u24 v122, s38, v107
    v_mul_hi_u32_u24 v121, s37, v99
    v_mul_hi_u32_u24 v120, s36, v99
    v_mad_i32_i24 v110, v122, s44, v107
    v_mad_u32_u24 v45, v122, 40, v121
    v_mad_i32_i24 v9, v120, s39, v99
    v_lshlrev_b16 v45, 2, v45
    v_mad_i32_i24 v120, v121, -3, v120
    ds_add_u32 v45, v3 offset:0
    v_lshl_or_b32 v9, v110, 16, v9
    v_lshl_or_b32 v9, v120, 30, v9
    v_lshrrev_b32 v118, 3, v117
    v_lshrrev_b32 v119, 8, v117
    v_lshlrev_b16 v117, 13, v117
    v_bitop3_b32 v119, v118, v119, v124 bitop3:0x1b
    v_bitop3_b32 v8, v117, v125, v8 bitop3:0xae
    v_lshl_or_b32 v44, v119, 16, v44
    v_bitop3_b32 v9, v118, v125, v9 bitop3:0xae
    v_bitop3_b32 v45, v119, v126, v45 bitop3:0xea
    v_lshlrev_b32 v117, 16, v79
    v_and_b32 v118, v126, v79
    v_mul_f32 v117, v123, v117
    v_mul_f32 v118, v123, v118
    v_cvt_pk_bf16_f32 v117, v117, v118
    v_and_b32 v118, v126, v117
    v_lshlrev_b32 v117, 16, v117
    v_mul_f32 v117, 0.15915494, v117
    v_mul_f32 v118, 0.15915494, v118
    v_fract_f32 v117, v117
    v_fract_f32 v118, v118
    v_cos_f32 v117, v117
    v_cos_f32 v118, v118
    v_mul_hi_u32_u24 v122, s38, v108
    v_mul_hi_u32_u24 v121, s37, v100
    v_mul_hi_u32_u24 v120, s36, v100
    v_mad_i32_i24 v110, v122, s44, v108
    v_mad_u32_u24 v46, v122, 40, v121
    v_mad_i32_i24 v10, v120, s39, v100
    v_lshlrev_b16 v46, 2, v46
    v_mad_i32_i24 v120, v121, -3, v120
    ds_add_u32 v46, v3 offset:0
    v_lshl_or_b32 v10, v110, 16, v10
    v_lshl_or_b32 v10, v120, 30, v10
    v_mul_f32 v117, 0x03800000, v117
    v_mul_f32 v118, 0x03800000, v118
    v_cvt_pk_bf16_f32 v117, v117, v118
    v_mul_hi_u32_u24 v122, s38, v109
    v_mul_hi_u32_u24 v121, s37, v101
    v_mul_hi_u32_u24 v120, s36, v101
    v_mad_i32_i24 v110, v122, s44, v109
    v_mad_u32_u24 v47, v122, 40, v121
    v_mad_i32_i24 v11, v120, s39, v101
    v_lshlrev_b16 v47, 2, v47
    v_mad_i32_i24 v120, v121, -3, v120
    ds_add_u32 v47, v3 offset:0
    v_lshl_or_b32 v11, v110, 16, v11
    v_lshl_or_b32 v11, v120, 30, v11
    v_lshrrev_b32 v118, 3, v117
    v_lshrrev_b32 v119, 8, v117
    v_lshlrev_b16 v117, 13, v117
    v_bitop3_b32 v119, v118, v119, v124 bitop3:0x1b
    v_bitop3_b32 v10, v117, v125, v10 bitop3:0xae
    v_lshl_or_b32 v46, v119, 16, v46
    v_bitop3_b32 v11, v118, v125, v11 bitop3:0xae
    v_bitop3_b32 v47, v119, v126, v47 bitop3:0xea
p1_k2:
    s_cmp_lt_u32 s29, 1352
    s_cselect_b32 s6, 204800000, 0
    s_cselect_b32 s10, 204800000, 0
    s_add_u32 s32, s30, 81920
    buffer_load_dwordx4 v[24:27], v1, s[4:7], s32 offen nt
    buffer_load_dwordx4 v[60:63], v1, s[8:11], s32 offen nt
    s_cmp_ge_u32 s29, 1462
    s_cbranch_scc1 p1_k4
    s_cmp_lg_u32 s34, 0
    s_cbranch_scc1 p1_w5
    s_waitcnt vmcnt(6)
p1_w5:
    s_waitcnt vmcnt(11)
    v_lshlrev_b32 v117, 16, v80
    v_and_b32 v118, v126, v80
    v_mul_f32 v117, v123, v117
    v_mul_f32 v118, v123, v118
    v_cvt_pk_bf16_f32 v117, v117, v118
    v_and_b32 v118, v126, v117
    v_lshlrev_b32 v117, 16, v117
    v_mul_f32 v117, 0.15915494, v117
    v_mul_f32 v118, 0.15915494, v118
    v_fract_f32 v117, v117
    v_fract_f32 v118, v118
    v_cos_f32 v117, v117
    v_cos_f32 v118, v118
    v_mul_hi_u32_u24 v122, s38, v48
    v_mul_hi_u32_u24 v121, s37, v12
    v_mul_hi_u32_u24 v120, s36, v12
    v_mad_i32_i24 v110, v122, s44, v48
    v_mad_u32_u24 v48, v122, 40, v121
    v_mad_i32_i24 v12, v120, s39, v12
    v_lshlrev_b16 v48, 2, v48
    v_mad_i32_i24 v120, v121, -3, v120
    ds_add_u32 v48, v3 offset:0
    v_lshl_or_b32 v12, v110, 16, v12
    v_lshl_or_b32 v12, v120, 30, v12
    v_mul_f32 v117, 0x03800000, v117
    v_mul_f32 v118, 0x03800000, v118
    v_cvt_pk_bf16_f32 v117, v117, v118
    v_mul_hi_u32_u24 v122, s38, v49
    v_mul_hi_u32_u24 v121, s37, v13
    v_mul_hi_u32_u24 v120, s36, v13
    v_mad_i32_i24 v110, v122, s44, v49
    v_mad_u32_u24 v49, v122, 40, v121
    v_mad_i32_i24 v13, v120, s39, v13
    v_lshlrev_b16 v49, 2, v49
    v_mad_i32_i24 v120, v121, -3, v120
    ds_add_u32 v49, v3 offset:0
    v_lshl_or_b32 v13, v110, 16, v13
    v_lshl_or_b32 v13, v120, 30, v13
    v_lshrrev_b32 v118, 3, v117
    v_lshrrev_b32 v119, 8, v117
    v_lshlrev_b16 v117, 13, v117
    v_bitop3_b32 v119, v118, v119, v124 bitop3:0x1b
    v_bitop3_b32 v12, v117, v125, v12 bitop3:0xae
    v_lshl_or_b32 v48, v119, 16, v48
    v_bitop3_b32 v13, v118, v125, v13 bitop3:0xae
    v_bitop3_b32 v49, v119, v126, v49 bitop3:0xea
    v_lshlrev_b32 v117, 16, v81
    v_and_b32 v118, v126, v81
    v_mul_f32 v117, v123, v117
    v_mul_f32 v118, v123, v118
    v_cvt_pk_bf16_f32 v117, v117, v118
    v_and_b32 v118, v126, v117
    v_lshlrev_b32 v117, 16, v117
    v_mul_f32 v117, 0.15915494, v117
    v_mul_f32 v118, 0.15915494, v118
    v_fract_f32 v117, v117
    v_fract_f32 v118, v118
    v_cos_f32 v117, v117
    v_cos_f32 v118, v118
    v_mul_hi_u32_u24 v122, s38, v50
    v_mul_hi_u32_u24 v121, s37, v14
    v_mul_hi_u32_u24 v120, s36, v14
    v_mad_i32_i24 v110, v122, s44, v50
    v_mad_u32_u24 v50, v122, 40, v121
    v_mad_i32_i24 v14, v120, s39, v14
    v_lshlrev_b16 v50, 2, v50
    v_mad_i32_i24 v120, v121, -3, v120
    ds_add_u32 v50, v3 offset:0
    v_lshl_or_b32 v14, v110, 16, v14
    v_lshl_or_b32 v14, v120, 30, v14
    v_mul_f32 v117, 0x03800000, v117
    v_mul_f32 v118, 0x03800000, v118
    v_cvt_pk_bf16_f32 v117, v117, v118
    v_mul_hi_u32_u24 v122, s38, v51
    v_mul_hi_u32_u24 v121, s37, v15
    v_mul_hi_u32_u24 v120, s36, v15
    v_mad_i32_i24 v110, v122, s44, v51
    v_mad_u32_u24 v51, v122, 40, v121
    v_mad_i32_i24 v15, v120, s39, v15
    v_lshlrev_b16 v51, 2, v51
    v_mad_i32_i24 v120, v121, -3, v120
    ds_add_u32 v51, v3 offset:0
    v_lshl_or_b32 v15, v110, 16, v15
    v_lshl_or_b32 v15, v120, 30, v15
    v_lshrrev_b32 v118, 3, v117
    v_lshrrev_b32 v119, 8, v117
    v_lshlrev_b16 v117, 13, v117
    v_bitop3_b32 v119, v118, v119, v124 bitop3:0x1b
    v_bitop3_b32 v14, v117, v125, v14 bitop3:0xae
    v_lshl_or_b32 v50, v119, 16, v50
    v_bitop3_b32 v15, v118, v125, v15 bitop3:0xae
    v_bitop3_b32 v51, v119, v126, v51 bitop3:0xea
p1_k4:
    s_cmp_lt_u32 s29, 1315
    s_cselect_b32 s6, 204800000, 0
    s_cselect_b32 s10, 204800000, 0
    s_add_u32 s32, s30, 98304
    buffer_load_dwordx4 v[28:31], v1, s[4:7], s32 offen nt
    buffer_load_dwordx4 v[64:67], v1, s[8:11], s32 offen nt
    s_cmp_ge_u32 s29, 1426
    s_cbranch_scc1 p1_k6
    s_waitcnt vmcnt(6)
    v_lshlrev_b32 v117, 16, v82
    v_and_b32 v118, v126, v82
    v_mul_f32 v117, v123, v117
    v_mul_f32 v118, v123, v118
    v_cvt_pk_bf16_f32 v117, v117, v118
    v_and_b32 v118, v126, v117
    v_lshlrev_b32 v117, 16, v117
    v_mul_f32 v117, 0.15915494, v117
    v_mul_f32 v118, 0.15915494, v118
    v_fract_f32 v117, v117
    v_fract_f32 v118, v118
    v_cos_f32 v117, v117
    v_cos_f32 v118, v118
    v_mul_hi_u32_u24 v122, s38, v52
    v_mul_hi_u32_u24 v121, s37, v16
    v_mul_hi_u32_u24 v120, s36, v16
    v_mad_i32_i24 v110, v122, s44, v52
    v_mad_u32_u24 v52, v122, 40, v121
    v_mad_i32_i24 v16, v120, s39, v16
    v_lshlrev_b16 v52, 2, v52
    v_mad_i32_i24 v120, v121, -3, v120
    ds_add_u32 v52, v3 offset:0
    v_lshl_or_b32 v16, v110, 16, v16
    v_lshl_or_b32 v16, v120, 30, v16
    v_mul_f32 v117, 0x03800000, v117
    v_mul_f32 v118, 0x03800000, v118
    v_cvt_pk_bf16_f32 v117, v117, v118
    v_mul_hi_u32_u24 v122, s38, v53
    v_mul_hi_u32_u24 v121, s37, v17
    v_mul_hi_u32_u24 v120, s36, v17
    v_mad_i32_i24 v110, v122, s44, v53
    v_mad_u32_u24 v53, v122, 40, v121
    v_mad_i32_i24 v17, v120, s39, v17
    v_lshlrev_b16 v53, 2, v53
    v_mad_i32_i24 v120, v121, -3, v120
    ds_add_u32 v53, v3 offset:0
    v_lshl_or_b32 v17, v110, 16, v17
    v_lshl_or_b32 v17, v120, 30, v17
    v_lshrrev_b32 v118, 3, v117
    v_lshrrev_b32 v119, 8, v117
    v_lshlrev_b16 v117, 13, v117
    v_bitop3_b32 v119, v118, v119, v124 bitop3:0x1b
    v_bitop3_b32 v16, v117, v125, v16 bitop3:0xae
    v_lshl_or_b32 v52, v119, 16, v52
    v_bitop3_b32 v17, v118, v125, v17 bitop3:0xae
    v_bitop3_b32 v53, v119, v126, v53 bitop3:0xea
    v_lshlrev_b32 v117, 16, v83
    v_and_b32 v118, v126, v83
    v_mul_f32 v117, v123, v117
    v_mul_f32 v118, v123, v118
    v_cvt_pk_bf16_f32 v117, v117, v118
    v_and_b32 v118, v126, v117
    v_lshlrev_b32 v117, 16, v117
    v_mul_f32 v117, 0.15915494, v117
    v_mul_f32 v118, 0.15915494, v118
    v_fract_f32 v117, v117
    v_fract_f32 v118, v118
    v_cos_f32 v117, v117
    v_cos_f32 v118, v118
    v_mul_hi_u32_u24 v122, s38, v54
    v_mul_hi_u32_u24 v121, s37, v18
    v_mul_hi_u32_u24 v120, s36, v18
    v_mad_i32_i24 v110, v122, s44, v54
    v_mad_u32_u24 v54, v122, 40, v121
    v_mad_i32_i24 v18, v120, s39, v18
    v_lshlrev_b16 v54, 2, v54
    v_mad_i32_i24 v120, v121, -3, v120
    ds_add_u32 v54, v3 offset:0
    v_lshl_or_b32 v18, v110, 16, v18
    v_lshl_or_b32 v18, v120, 30, v18
    v_mul_f32 v117, 0x03800000, v117
    v_mul_f32 v118, 0x03800000, v118
    v_cvt_pk_bf16_f32 v117, v117, v118
    v_mul_hi_u32_u24 v122, s38, v55
    v_mul_hi_u32_u24 v121, s37, v19
    v_mul_hi_u32_u24 v120, s36, v19
    v_mad_i32_i24 v110, v122, s44, v55
    v_mad_u32_u24 v55, v122, 40, v121
    v_mad_i32_i24 v19, v120, s39, v19
    v_lshlrev_b16 v55, 2, v55
    v_mad_i32_i24 v120, v121, -3, v120
    ds_add_u32 v55, v3 offset:0
    v_lshl_or_b32 v19, v110, 16, v19
    v_lshl_or_b32 v19, v120, 30, v19
    v_lshrrev_b32 v118, 3, v117
    v_lshrrev_b32 v119, 8, v117
    v_lshlrev_b16 v117, 13, v117
    v_bitop3_b32 v119, v118, v119, v124 bitop3:0x1b
    v_bitop3_b32 v18, v117, v125, v18 bitop3:0xae
    v_lshl_or_b32 v54, v119, 16, v54
    v_bitop3_b32 v19, v118, v125, v19 bitop3:0xae
    v_bitop3_b32 v55, v119, v126, v55 bitop3:0xea
p1_k6:
    s_cmp_lt_u32 s29, 1279
    s_cselect_b32 s6, 204800000, 0
    s_cselect_b32 s10, 204800000, 0
    s_add_u32 s32, s30, 114688
    buffer_load_dwordx4 v[32:35], v1, s[4:7], s32 offen nt
    buffer_load_dwordx4 v[68:71], v1, s[8:11], s32 offen nt
    s_cmp_ge_u32 s29, 1389
    s_cbranch_scc1 p1_k8
    s_waitcnt vmcnt(6)
    v_lshlrev_b32 v117, 16, v84
    v_and_b32 v118, v126, v84
    v_mul_f32 v117, v123, v117
    v_mul_f32 v118, v123, v118
    v_cvt_pk_bf16_f32 v117, v117, v118
    v_and_b32 v118, v126, v117
    v_lshlrev_b32 v117, 16, v117
    v_mul_f32 v117, 0.15915494, v117
    v_mul_f32 v118, 0.15915494, v118
    v_fract_f32 v117, v117
    v_fract_f32 v118, v118
    v_cos_f32 v117, v117
    v_cos_f32 v118, v118
    v_mul_hi_u32_u24 v122, s38, v56
    v_mul_hi_u32_u24 v121, s37, v20
    v_mul_hi_u32_u24 v120, s36, v20
    v_mad_i32_i24 v110, v122, s44, v56
    v_mad_u32_u24 v56, v122, 40, v121
    v_mad_i32_i24 v20, v120, s39, v20
    v_lshlrev_b16 v56, 2, v56
    v_mad_i32_i24 v120, v121, -3, v120
    ds_add_u32 v56, v3 offset:0
    v_lshl_or_b32 v20, v110, 16, v20
    v_lshl_or_b32 v20, v120, 30, v20
    v_mul_f32 v117, 0x03800000, v117
    v_mul_f32 v118, 0x03800000, v118
    v_cvt_pk_bf16_f32 v117, v117, v118
    v_mul_hi_u32_u24 v122, s38, v57
    v_mul_hi_u32_u24 v121, s37, v21
    v_mul_hi_u32_u24 v120, s36, v21
    v_mad_i32_i24 v110, v122, s44, v57
    v_mad_u32_u24 v57, v122, 40, v121
    v_mad_i32_i24 v21, v120, s39, v21
    v_lshlrev_b16 v57, 2, v57
    v_mad_i32_i24 v120, v121, -3, v120
    ds_add_u32 v57, v3 offset:0
    v_lshl_or_b32 v21, v110, 16, v21
    v_lshl_or_b32 v21, v120, 30, v21
    v_lshrrev_b32 v118, 3, v117
    v_lshrrev_b32 v119, 8, v117
    v_lshlrev_b16 v117, 13, v117
    v_bitop3_b32 v119, v118, v119, v124 bitop3:0x1b
    v_bitop3_b32 v20, v117, v125, v20 bitop3:0xae
    v_lshl_or_b32 v56, v119, 16, v56
    v_bitop3_b32 v21, v118, v125, v21 bitop3:0xae
    v_bitop3_b32 v57, v119, v126, v57 bitop3:0xea
    v_lshlrev_b32 v117, 16, v85
    v_and_b32 v118, v126, v85
    v_mul_f32 v117, v123, v117
    v_mul_f32 v118, v123, v118
    v_cvt_pk_bf16_f32 v117, v117, v118
    v_and_b32 v118, v126, v117
    v_lshlrev_b32 v117, 16, v117
    v_mul_f32 v117, 0.15915494, v117
    v_mul_f32 v118, 0.15915494, v118
    v_fract_f32 v117, v117
    v_fract_f32 v118, v118
    v_cos_f32 v117, v117
    v_cos_f32 v118, v118
    v_mul_hi_u32_u24 v122, s38, v58
    v_mul_hi_u32_u24 v121, s37, v22
    v_mul_hi_u32_u24 v120, s36, v22
    v_mad_i32_i24 v110, v122, s44, v58
    v_mad_u32_u24 v58, v122, 40, v121
    v_mad_i32_i24 v22, v120, s39, v22
    v_lshlrev_b16 v58, 2, v58
    v_mad_i32_i24 v120, v121, -3, v120
    ds_add_u32 v58, v3 offset:0
    v_lshl_or_b32 v22, v110, 16, v22
    v_lshl_or_b32 v22, v120, 30, v22
    v_mul_f32 v117, 0x03800000, v117
    v_mul_f32 v118, 0x03800000, v118
    v_cvt_pk_bf16_f32 v117, v117, v118
    v_mul_hi_u32_u24 v122, s38, v59
    v_mul_hi_u32_u24 v121, s37, v23
    v_mul_hi_u32_u24 v120, s36, v23
    v_mad_i32_i24 v110, v122, s44, v59
    v_mad_u32_u24 v59, v122, 40, v121
    v_mad_i32_i24 v23, v120, s39, v23
    v_lshlrev_b16 v59, 2, v59
    v_mad_i32_i24 v120, v121, -3, v120
    ds_add_u32 v59, v3 offset:0
    v_lshl_or_b32 v23, v110, 16, v23
    v_lshl_or_b32 v23, v120, 30, v23
    v_lshrrev_b32 v118, 3, v117
    v_lshrrev_b32 v119, 8, v117
    v_lshlrev_b16 v117, 13, v117
    v_bitop3_b32 v119, v118, v119, v124 bitop3:0x1b
    v_bitop3_b32 v22, v117, v125, v22 bitop3:0xae
    v_lshl_or_b32 v58, v119, 16, v58
    v_bitop3_b32 v23, v118, v125, v23 bitop3:0xae
    v_bitop3_b32 v59, v119, v126, v59 bitop3:0xea
p1_k8:
    s_cmp_lt_u32 s29, 1242
    s_cselect_b32 s6, 204800000, 0
    s_cselect_b32 s10, 204800000, 0
    s_add_u32 s32, s30, 131072
    buffer_load_dwordx4 v[36:39], v1, s[4:7], s32 offen nt
    buffer_load_dwordx4 v[72:75], v1, s[8:11], s32 offen nt
    s_cmp_ge_u32 s29, 1352
    s_cbranch_scc1 p1_k10
    s_waitcnt vmcnt(6)
    v_lshlrev_b32 v117, 16, v86
    v_and_b32 v118, v126, v86
    v_mul_f32 v117, v123, v117
    v_mul_f32 v118, v123, v118
    v_cvt_pk_bf16_f32 v117, v117, v118
    v_and_b32 v118, v126, v117
    v_lshlrev_b32 v117, 16, v117
    v_mul_f32 v117, 0.15915494, v117
    v_mul_f32 v118, 0.15915494, v118
    v_fract_f32 v117, v117
    v_fract_f32 v118, v118
    v_cos_f32 v117, v117
    v_cos_f32 v118, v118
    v_mul_hi_u32_u24 v122, s38, v60
    v_mul_hi_u32_u24 v121, s37, v24
    v_mul_hi_u32_u24 v120, s36, v24
    v_mad_i32_i24 v110, v122, s44, v60
    v_mad_u32_u24 v60, v122, 40, v121
    v_mad_i32_i24 v24, v120, s39, v24
    v_lshlrev_b16 v60, 2, v60
    v_mad_i32_i24 v120, v121, -3, v120
    ds_add_u32 v60, v3 offset:0
    v_lshl_or_b32 v24, v110, 16, v24
    v_lshl_or_b32 v24, v120, 30, v24
    v_mul_f32 v117, 0x03800000, v117
    v_mul_f32 v118, 0x03800000, v118
    v_cvt_pk_bf16_f32 v117, v117, v118
    v_mul_hi_u32_u24 v122, s38, v61
    v_mul_hi_u32_u24 v121, s37, v25
    v_mul_hi_u32_u24 v120, s36, v25
    v_mad_i32_i24 v110, v122, s44, v61
    v_mad_u32_u24 v61, v122, 40, v121
    v_mad_i32_i24 v25, v120, s39, v25
    v_lshlrev_b16 v61, 2, v61
    v_mad_i32_i24 v120, v121, -3, v120
    ds_add_u32 v61, v3 offset:0
    v_lshl_or_b32 v25, v110, 16, v25
    v_lshl_or_b32 v25, v120, 30, v25
    v_lshrrev_b32 v118, 3, v117
    v_lshrrev_b32 v119, 8, v117
    v_lshlrev_b16 v117, 13, v117
    v_bitop3_b32 v119, v118, v119, v124 bitop3:0x1b
    v_bitop3_b32 v24, v117, v125, v24 bitop3:0xae
    v_lshl_or_b32 v60, v119, 16, v60
    v_bitop3_b32 v25, v118, v125, v25 bitop3:0xae
    v_bitop3_b32 v61, v119, v126, v61 bitop3:0xea
    v_lshlrev_b32 v117, 16, v87
    v_and_b32 v118, v126, v87
    v_mul_f32 v117, v123, v117
    v_mul_f32 v118, v123, v118
    v_cvt_pk_bf16_f32 v117, v117, v118
    v_and_b32 v118, v126, v117
    v_lshlrev_b32 v117, 16, v117
    v_mul_f32 v117, 0.15915494, v117
    v_mul_f32 v118, 0.15915494, v118
    v_fract_f32 v117, v117
    v_fract_f32 v118, v118
    v_cos_f32 v117, v117
    v_cos_f32 v118, v118
    v_mul_hi_u32_u24 v122, s38, v62
    v_mul_hi_u32_u24 v121, s37, v26
    v_mul_hi_u32_u24 v120, s36, v26
    v_mad_i32_i24 v110, v122, s44, v62
    v_mad_u32_u24 v62, v122, 40, v121
    v_mad_i32_i24 v26, v120, s39, v26
    v_lshlrev_b16 v62, 2, v62
    v_mad_i32_i24 v120, v121, -3, v120
    ds_add_u32 v62, v3 offset:0
    v_lshl_or_b32 v26, v110, 16, v26
    v_lshl_or_b32 v26, v120, 30, v26
    v_mul_f32 v117, 0x03800000, v117
    v_mul_f32 v118, 0x03800000, v118
    v_cvt_pk_bf16_f32 v117, v117, v118
    v_mul_hi_u32_u24 v122, s38, v63
    v_mul_hi_u32_u24 v121, s37, v27
    v_mul_hi_u32_u24 v120, s36, v27
    v_mad_i32_i24 v110, v122, s44, v63
    v_mad_u32_u24 v63, v122, 40, v121
    v_mad_i32_i24 v27, v120, s39, v27
    v_lshlrev_b16 v63, 2, v63
    v_mad_i32_i24 v120, v121, -3, v120
    ds_add_u32 v63, v3 offset:0
    v_lshl_or_b32 v27, v110, 16, v27
    v_lshl_or_b32 v27, v120, 30, v27
    v_lshrrev_b32 v118, 3, v117
    v_lshrrev_b32 v119, 8, v117
    v_lshlrev_b16 v117, 13, v117
    v_bitop3_b32 v119, v118, v119, v124 bitop3:0x1b
    v_bitop3_b32 v26, v117, v125, v26 bitop3:0xae
    v_lshl_or_b32 v62, v119, 16, v62
    v_bitop3_b32 v27, v118, v125, v27 bitop3:0xae
    v_bitop3_b32 v63, v119, v126, v63 bitop3:0xea
p1_k10:
    s_cmp_ge_u32 s29, 1315
    s_cbranch_scc1 p1_k12
    s_waitcnt vmcnt(4)
    v_lshlrev_b32 v117, 16, v88
    v_and_b32 v118, v126, v88
    v_mul_f32 v117, v123, v117
    v_mul_f32 v118, v123, v118
    v_cvt_pk_bf16_f32 v117, v117, v118
    v_and_b32 v118, v126, v117
    v_lshlrev_b32 v117, 16, v117
    v_mul_f32 v117, 0.15915494, v117
    v_mul_f32 v118, 0.15915494, v118
    v_fract_f32 v117, v117
    v_fract_f32 v118, v118
    v_cos_f32 v117, v117
    v_cos_f32 v118, v118
    v_mul_hi_u32_u24 v122, s38, v64
    v_mul_hi_u32_u24 v121, s37, v28
    v_mul_hi_u32_u24 v120, s36, v28
    v_mad_i32_i24 v110, v122, s44, v64
    v_mad_u32_u24 v64, v122, 40, v121
    v_mad_i32_i24 v28, v120, s39, v28
    v_lshlrev_b16 v64, 2, v64
    v_mad_i32_i24 v120, v121, -3, v120
    ds_add_u32 v64, v3 offset:0
    v_lshl_or_b32 v28, v110, 16, v28
    v_lshl_or_b32 v28, v120, 30, v28
    v_mul_f32 v117, 0x03800000, v117
    v_mul_f32 v118, 0x03800000, v118
    v_cvt_pk_bf16_f32 v117, v117, v118
    v_mul_hi_u32_u24 v122, s38, v65
    v_mul_hi_u32_u24 v121, s37, v29
    v_mul_hi_u32_u24 v120, s36, v29
    v_mad_i32_i24 v110, v122, s44, v65
    v_mad_u32_u24 v65, v122, 40, v121
    v_mad_i32_i24 v29, v120, s39, v29
    v_lshlrev_b16 v65, 2, v65
    v_mad_i32_i24 v120, v121, -3, v120
    ds_add_u32 v65, v3 offset:0
    v_lshl_or_b32 v29, v110, 16, v29
    v_lshl_or_b32 v29, v120, 30, v29
    v_lshrrev_b32 v118, 3, v117
    v_lshrrev_b32 v119, 8, v117
    v_lshlrev_b16 v117, 13, v117
    v_bitop3_b32 v119, v118, v119, v124 bitop3:0x1b
    v_bitop3_b32 v28, v117, v125, v28 bitop3:0xae
    v_lshl_or_b32 v64, v119, 16, v64
    v_bitop3_b32 v29, v118, v125, v29 bitop3:0xae
    v_bitop3_b32 v65, v119, v126, v65 bitop3:0xea
    v_lshlrev_b32 v117, 16, v89
    v_and_b32 v118, v126, v89
    v_mul_f32 v117, v123, v117
    v_mul_f32 v118, v123, v118
    v_cvt_pk_bf16_f32 v117, v117, v118
    v_and_b32 v118, v126, v117
    v_lshlrev_b32 v117, 16, v117
    v_mul_f32 v117, 0.15915494, v117
    v_mul_f32 v118, 0.15915494, v118
    v_fract_f32 v117, v117
    v_fract_f32 v118, v118
    v_cos_f32 v117, v117
    v_cos_f32 v118, v118
    v_mul_hi_u32_u24 v122, s38, v66
    v_mul_hi_u32_u24 v121, s37, v30
    v_mul_hi_u32_u24 v120, s36, v30
    v_mad_i32_i24 v110, v122, s44, v66
    v_mad_u32_u24 v66, v122, 40, v121
    v_mad_i32_i24 v30, v120, s39, v30
    v_lshlrev_b16 v66, 2, v66
    v_mad_i32_i24 v120, v121, -3, v120
    ds_add_u32 v66, v3 offset:0
    v_lshl_or_b32 v30, v110, 16, v30
    v_lshl_or_b32 v30, v120, 30, v30
    v_mul_f32 v117, 0x03800000, v117
    v_mul_f32 v118, 0x03800000, v118
    v_cvt_pk_bf16_f32 v117, v117, v118
    v_mul_hi_u32_u24 v122, s38, v67
    v_mul_hi_u32_u24 v121, s37, v31
    v_mul_hi_u32_u24 v120, s36, v31
    v_mad_i32_i24 v110, v122, s44, v67
    v_mad_u32_u24 v67, v122, 40, v121
    v_mad_i32_i24 v31, v120, s39, v31
    v_lshlrev_b16 v67, 2, v67
    v_mad_i32_i24 v120, v121, -3, v120
    ds_add_u32 v67, v3 offset:0
    v_lshl_or_b32 v31, v110, 16, v31
    v_lshl_or_b32 v31, v120, 30, v31
    v_lshrrev_b32 v118, 3, v117
    v_lshrrev_b32 v119, 8, v117
    v_lshlrev_b16 v117, 13, v117
    v_bitop3_b32 v119, v118, v119, v124 bitop3:0x1b
    v_bitop3_b32 v30, v117, v125, v30 bitop3:0xae
    v_lshl_or_b32 v66, v119, 16, v66
    v_bitop3_b32 v31, v118, v125, v31 bitop3:0xae
    v_bitop3_b32 v67, v119, v126, v67 bitop3:0xea
p1_k12:
    s_cmp_ge_u32 s29, 1279
    s_cbranch_scc1 p1_k14
    s_waitcnt vmcnt(2)
    v_lshlrev_b32 v117, 16, v90
    v_and_b32 v118, v126, v90
    v_mul_f32 v117, v123, v117
    v_mul_f32 v118, v123, v118
    v_cvt_pk_bf16_f32 v117, v117, v118
    v_and_b32 v118, v126, v117
    v_lshlrev_b32 v117, 16, v117
    v_mul_f32 v117, 0.15915494, v117
    v_mul_f32 v118, 0.15915494, v118
    v_fract_f32 v117, v117
    v_fract_f32 v118, v118
    v_cos_f32 v117, v117
    v_cos_f32 v118, v118
    v_mul_hi_u32_u24 v122, s38, v68
    v_mul_hi_u32_u24 v121, s37, v32
    v_mul_hi_u32_u24 v120, s36, v32
    v_mad_i32_i24 v110, v122, s44, v68
    v_mad_u32_u24 v68, v122, 40, v121
    v_mad_i32_i24 v32, v120, s39, v32
    v_lshlrev_b16 v68, 2, v68
    v_mad_i32_i24 v120, v121, -3, v120
    ds_add_u32 v68, v3 offset:0
    v_lshl_or_b32 v32, v110, 16, v32
    v_lshl_or_b32 v32, v120, 30, v32
    v_mul_f32 v117, 0x03800000, v117
    v_mul_f32 v118, 0x03800000, v118
    v_cvt_pk_bf16_f32 v117, v117, v118
    v_mul_hi_u32_u24 v122, s38, v69
    v_mul_hi_u32_u24 v121, s37, v33
    v_mul_hi_u32_u24 v120, s36, v33
    v_mad_i32_i24 v110, v122, s44, v69
    v_mad_u32_u24 v69, v122, 40, v121
    v_mad_i32_i24 v33, v120, s39, v33
    v_lshlrev_b16 v69, 2, v69
    v_mad_i32_i24 v120, v121, -3, v120
    ds_add_u32 v69, v3 offset:0
    v_lshl_or_b32 v33, v110, 16, v33
    v_lshl_or_b32 v33, v120, 30, v33
    v_lshrrev_b32 v118, 3, v117
    v_lshrrev_b32 v119, 8, v117
    v_lshlrev_b16 v117, 13, v117
    v_bitop3_b32 v119, v118, v119, v124 bitop3:0x1b
    v_bitop3_b32 v32, v117, v125, v32 bitop3:0xae
    v_lshl_or_b32 v68, v119, 16, v68
    v_bitop3_b32 v33, v118, v125, v33 bitop3:0xae
    v_bitop3_b32 v69, v119, v126, v69 bitop3:0xea
    v_lshlrev_b32 v117, 16, v91
    v_and_b32 v118, v126, v91
    v_mul_f32 v117, v123, v117
    v_mul_f32 v118, v123, v118
    v_cvt_pk_bf16_f32 v117, v117, v118
    v_and_b32 v118, v126, v117
    v_lshlrev_b32 v117, 16, v117
    v_mul_f32 v117, 0.15915494, v117
    v_mul_f32 v118, 0.15915494, v118
    v_fract_f32 v117, v117
    v_fract_f32 v118, v118
    v_cos_f32 v117, v117
    v_cos_f32 v118, v118
    v_mul_hi_u32_u24 v122, s38, v70
    v_mul_hi_u32_u24 v121, s37, v34
    v_mul_hi_u32_u24 v120, s36, v34
    v_mad_i32_i24 v110, v122, s44, v70
    v_mad_u32_u24 v70, v122, 40, v121
    v_mad_i32_i24 v34, v120, s39, v34
    v_lshlrev_b16 v70, 2, v70
    v_mad_i32_i24 v120, v121, -3, v120
    ds_add_u32 v70, v3 offset:0
    v_lshl_or_b32 v34, v110, 16, v34
    v_lshl_or_b32 v34, v120, 30, v34
    v_mul_f32 v117, 0x03800000, v117
    v_mul_f32 v118, 0x03800000, v118
    v_cvt_pk_bf16_f32 v117, v117, v118
    v_mul_hi_u32_u24 v122, s38, v71
    v_mul_hi_u32_u24 v121, s37, v35
    v_mul_hi_u32_u24 v120, s36, v35
    v_mad_i32_i24 v110, v122, s44, v71
    v_mad_u32_u24 v71, v122, 40, v121
    v_mad_i32_i24 v35, v120, s39, v35
    v_lshlrev_b16 v71, 2, v71
    v_mad_i32_i24 v120, v121, -3, v120
    ds_add_u32 v71, v3 offset:0
    v_lshl_or_b32 v35, v110, 16, v35
    v_lshl_or_b32 v35, v120, 30, v35
    v_lshrrev_b32 v118, 3, v117
    v_lshrrev_b32 v119, 8, v117
    v_lshlrev_b16 v117, 13, v117
    v_bitop3_b32 v119, v118, v119, v124 bitop3:0x1b
    v_bitop3_b32 v34, v117, v125, v34 bitop3:0xae
    v_lshl_or_b32 v70, v119, 16, v70
    v_bitop3_b32 v35, v118, v125, v35 bitop3:0xae
    v_bitop3_b32 v71, v119, v126, v71 bitop3:0xea
p1_k14:
    s_cmp_ge_u32 s29, 1242
    s_cbranch_scc1 p1_k16
    s_waitcnt vmcnt(0)
    v_lshlrev_b32 v117, 16, v92
    v_and_b32 v118, v126, v92
    v_mul_f32 v117, v123, v117
    v_mul_f32 v118, v123, v118
    v_cvt_pk_bf16_f32 v117, v117, v118
    v_and_b32 v118, v126, v117
    v_lshlrev_b32 v117, 16, v117
    v_mul_f32 v117, 0.15915494, v117
    v_mul_f32 v118, 0.15915494, v118
    v_fract_f32 v117, v117
    v_fract_f32 v118, v118
    v_cos_f32 v117, v117
    v_cos_f32 v118, v118
    v_mul_hi_u32_u24 v122, s38, v72
    v_mul_hi_u32_u24 v121, s37, v36
    v_mul_hi_u32_u24 v120, s36, v36
    v_mad_i32_i24 v110, v122, s44, v72
    v_mad_u32_u24 v72, v122, 40, v121
    v_mad_i32_i24 v36, v120, s39, v36
    v_lshlrev_b16 v72, 2, v72
    v_mad_i32_i24 v120, v121, -3, v120
    ds_add_u32 v72, v3 offset:0
    v_lshl_or_b32 v36, v110, 16, v36
    v_lshl_or_b32 v36, v120, 30, v36
    v_mul_f32 v117, 0x03800000, v117
    v_mul_f32 v118, 0x03800000, v118
    v_cvt_pk_bf16_f32 v117, v117, v118
    v_mul_hi_u32_u24 v122, s38, v73
    v_mul_hi_u32_u24 v121, s37, v37
    v_mul_hi_u32_u24 v120, s36, v37
    v_mad_i32_i24 v110, v122, s44, v73
    v_mad_u32_u24 v73, v122, 40, v121
    v_mad_i32_i24 v37, v120, s39, v37
    v_lshlrev_b16 v73, 2, v73
    v_mad_i32_i24 v120, v121, -3, v120
    ds_add_u32 v73, v3 offset:0
    v_lshl_or_b32 v37, v110, 16, v37
    v_lshl_or_b32 v37, v120, 30, v37
    v_lshrrev_b32 v118, 3, v117
    v_lshrrev_b32 v119, 8, v117
    v_lshlrev_b16 v117, 13, v117
    v_bitop3_b32 v119, v118, v119, v124 bitop3:0x1b
    v_bitop3_b32 v36, v117, v125, v36 bitop3:0xae
    v_lshl_or_b32 v72, v119, 16, v72
    v_bitop3_b32 v37, v118, v125, v37 bitop3:0xae
    v_bitop3_b32 v73, v119, v126, v73 bitop3:0xea
    v_lshlrev_b32 v117, 16, v93
    v_and_b32 v118, v126, v93
    v_mul_f32 v117, v123, v117
    v_mul_f32 v118, v123, v118
    v_cvt_pk_bf16_f32 v117, v117, v118
    v_and_b32 v118, v126, v117
    v_lshlrev_b32 v117, 16, v117
    v_mul_f32 v117, 0.15915494, v117
    v_mul_f32 v118, 0.15915494, v118
    v_fract_f32 v117, v117
    v_fract_f32 v118, v118
    v_cos_f32 v117, v117
    v_cos_f32 v118, v118
    v_mul_hi_u32_u24 v122, s38, v74
    v_mul_hi_u32_u24 v121, s37, v38
    v_mul_hi_u32_u24 v120, s36, v38
    v_mad_i32_i24 v110, v122, s44, v74
    v_mad_u32_u24 v74, v122, 40, v121
    v_mad_i32_i24 v38, v120, s39, v38
    v_lshlrev_b16 v74, 2, v74
    v_mad_i32_i24 v120, v121, -3, v120
    ds_add_u32 v74, v3 offset:0
    v_lshl_or_b32 v38, v110, 16, v38
    v_lshl_or_b32 v38, v120, 30, v38
    v_mul_f32 v117, 0x03800000, v117
    v_mul_f32 v118, 0x03800000, v118
    v_cvt_pk_bf16_f32 v117, v117, v118
    v_mul_hi_u32_u24 v122, s38, v75
    v_mul_hi_u32_u24 v121, s37, v39
    v_mul_hi_u32_u24 v120, s36, v39
    v_mad_i32_i24 v110, v122, s44, v75
    v_mad_u32_u24 v75, v122, 40, v121
    v_mad_i32_i24 v39, v120, s39, v39
    v_lshlrev_b16 v75, 2, v75
    v_mad_i32_i24 v120, v121, -3, v120
    ds_add_u32 v75, v3 offset:0
    v_lshl_or_b32 v39, v110, 16, v39
    v_lshl_or_b32 v39, v120, 30, v39
    v_lshrrev_b32 v118, 3, v117
    v_lshrrev_b32 v119, 8, v117
    v_lshlrev_b16 v117, 13, v117
    v_bitop3_b32 v119, v118, v119, v124 bitop3:0x1b
    v_bitop3_b32 v38, v117, v125, v38 bitop3:0xae
    v_lshl_or_b32 v74, v119, 16, v74
    v_bitop3_b32 v39, v118, v125, v39 bitop3:0xae
    v_bitop3_b32 v75, v119, v126, v75 bitop3:0xea
p1_k16:
    s_waitcnt vmcnt(0)
    s_cmp_lg_u32 s28, 15
    s_cbranch_scc1 p1_tk1
    v_mov_b32 v126, 0
    s_mov_b64 exec, 1
    ds_write_b32 v126, v127 offset:10456
    s_mov_b64 exec, -1
p1_tk1:
    s_waitcnt lgkmcnt(0)
    s_barrier
    s_cmp_ge_u32 s28, 10
    s_cbranch_scc1 p1_s1_skip
    v_and_b32 v126, 63, v0
    s_lshl_b32 s54, s28, 4
    v_mul_u32_u24 v117, 160, v126
    v_add_u32 v117, s54, v117
    ds_read_b128 v[118:121], v117 offset:0
    s_waitcnt lgkmcnt(0)
    v_add_u32 v118, 2, v118
    v_add_u32 v119, 2, v119
    v_add_u32 v120, 2, v120
    v_add_u32 v121, 2, v121
    v_mul_u32_u24 v118, 43691, v118
    v_mul_u32_u24 v119, 43691, v119
    v_mul_u32_u24 v120, 43691, v120
    v_mul_u32_u24 v121, 43691, v121
    v_lshrrev_b32 v118, 17, v118
    v_lshrrev_b32 v119, 17, v119
    v_lshrrev_b32 v120, 17, v120
    v_lshrrev_b32 v121, 17, v121
    v_lshl_or_b32 v122, v119, 16, v118
    v_lshl_or_b32 v123, v121, 16, v120
    v_mov_b32 v124, v122
    v_mov_b32 v125, v123
    s_nop 1
    v_add_u32_dpp v124, v124, v124 row_shr:1 row_mask:0xf bank_mask:0xf bound_ctrl:0
    v_add_u32_dpp v125, v125, v125 row_shr:1 row_mask:0xf bank_mask:0xf bound_ctrl:0
    s_nop 0
    v_add_u32_dpp v124, v124, v124 row_shr:2 row_mask:0xf bank_mask:0xf bound_ctrl:0
    v_add_u32_dpp v125, v125, v125 row_shr:2 row_mask:0xf bank_mask:0xf bound_ctrl:0
    s_nop 0
    v_add_u32_dpp v124, v124, v124 row_shr:4 row_mask:0xf bank_mask:0xf bound_ctrl:0
    v_add_u32_dpp v125, v125, v125 row_shr:4 row_mask:0xf bank_mask:0xf bound_ctrl:0
    s_nop 0
    v_add_u32_dpp v124, v124, v124 row_shr:8 row_mask:0xf bank_mask:0xf bound_ctrl:0
    v_add_u32_dpp v125, v125, v125 row_shr:8 row_mask:0xf bank_mask:0xf bound_ctrl:0
    s_nop 0
    v_add_u32_dpp v124, v124, v124 row_bcast:15 row_mask:0xa bank_mask:0xf
    v_add_u32_dpp v125, v125, v125 row_bcast:15 row_mask:0xa bank_mask:0xf
    s_nop 0
    v_add_u32_dpp v124, v124, v124 row_bcast:31 row_mask:0xc bank_mask:0xf
    v_add_u32_dpp v125, v125, v125 row_bcast:31 row_mask:0xc bank_mask:0xf
    s_nop 0
    s_nop 0
    v_mov_b32 v127, s54
    v_and_b32 v118, 0xffff, v124
    v_lshrrev_b32 v119, 16, v124
    v_and_b32 v120, 0xffff, v125
    v_lshrrev_b32 v121, 16, v125
    s_mov_b64 exec, 1
    s_lshl_b64 exec, exec, 63
    ds_write_b128 v127, v[118:121] offset:10240
    s_mov_b64 exec, -1
p1_s1_skip:
    s_waitcnt lgkmcnt(0)
    s_barrier
    v_and_b32 v127, 63, v0
    v_lshlrev_b32 v118, 2, v127
    v_cmp_gt_u32 vcc, 40, v127
    ds_read_b32 v119, v118 offset:10240
    s_waitcnt lgkmcnt(0)
    v_readlane_b32 s33, v119, 54
    v_cndmask_b32 v119, 0, v119, vcc
    v_mov_b32 v120, v119
    s_nop 1
    v_add_u32_dpp v120, v120, v120 row_shr:1 row_mask:0xf bank_mask:0xf bound_ctrl:0
    s_nop 1
    v_add_u32_dpp v120, v120, v120 row_shr:2 row_mask:0xf bank_mask:0xf bound_ctrl:0
    s_nop 1
    v_add_u32_dpp v120, v120, v120 row_shr:4 row_mask:0xf bank_mask:0xf bound_ctrl:0
    s_nop 1
    v_add_u32_dpp v120, v120, v120 row_shr:8 row_mask:0xf bank_mask:0xf bound_ctrl:0
    s_nop 1
    v_add_u32_dpp v120, v120, v120 row_bcast:15 row_mask:0xa bank_mask:0xf
    s_nop 1
    v_add_u32_dpp v120, v120, v120 row_bcast:31 row_mask:0xc bank_mask:0xf
    s_nop 1
    s_nop 0
    v_sub_u32 v119, v120, v119
    v_readlane_b32 s35, v120, 63
    s_add_u32 s33, s33, 256
    s_mul_i32 s46, s33, 1
    s_min_u32 s47, s33, 1499
    s_add_u32 s46, s46, s47
    s_min_u32 s47, s33, 1462
    s_add_u32 s46, s46, s47
    s_min_u32 s47, s33, 1426
    s_add_u32 s46, s46, s47
    s_min_u32 s47, s33, 1389
    s_add_u32 s46, s46, s47
    s_min_u32 s47, s33, 1352
    s_add_u32 s46, s46, s47
    s_min_u32 s47, s33, 1315
    s_add_u32 s46, s46, s47
    s_min_u32 s47, s33, 1279
    s_add_u32 s46, s46, s47
    s_min_u32 s47, s33, 1242
    s_add_u32 s46, s46, s47
    s_lshl_b32 s30, s46, 14
    s_lshl_b32 s31, s46, 13
    s_cmp_ge_u32 s28, 10
    s_cbranch_scc1 p1_s2_skip
    s_lshl_b32 s54, s28, 2
    s_add_u32 s55, s54, 0
    v_readlane_b32 s56, v119, s55
    s_add_u32 s55, s54, 1
    v_readlane_b32 s57, v119, s55
    s_add_u32 s55, s54, 2
    v_readlane_b32 s58, v119, s55
    s_add_u32 s55, s54, 3
    v_readlane_b32 s59, v119, s55
    s_nop 0
    s_lshl_b32 s57, s57, 16
    s_or_b32 s56, s56, s57
    s_lshl_b32 s59, s59, 16
    s_or_b32 s58, s58, s59
    v_add_u32 v124, s56, v124
    v_add_u32 v125, s58, v125
    v_sub_u32 v122, v124, v122
    v_sub_u32 v123, v125, v123
    v_and_b32 v118, 0xffff, v122
    v_lshrrev_b32 v119, 16, v122
    v_and_b32 v120, 0xffff, v123
    v_lshrrev_b32 v121, 16, v123
    v_mul_u32_u24 v118, 3, v118
    v_mul_u32_u24 v119, 3, v119
    v_mul_u32_u24 v120, 3, v120
    v_mul_u32_u24 v121, 3, v121
    ds_write_b128 v117, v[118:121] offset:0
    s_mul_i32 s55, s29, 5248
    s_mul_i32 s56, s28, 520
    s_add_u32 s55, s55, s56
    s_add_u32 s55, s55, 469762048
    v_lshlrev_b32 v127, 3, v126
    buffer_store_dwordx2 v[122:123], v127, s[16:19], s55 offen sc1
    s_mov_b64 exec, 1
    s_lshl_b64 exec, exec, 63
    buffer_store_dwordx2 v[124:125], v127, s[16:19], s55 offen offset:8 sc1
    s_mov_b64 exec, -1
p1_s2_skip:
    s_mul_i32 s50, s29, 16384
    s_lshr_b32 s52, s35, 10
    s_mul_i32 s52, s52, 33554432
    s_and_b32 s53, s35, 1023
    s_lshl_b32 s53, s53, 4
    s_add_u32 s52, s52, s53
    s_add_u32 s52, s52, s50
    s_min_u32 s22, s52, 469762048
    s_mov_b32 s68, 0
    s_cmp_lt_u32 s29, 1242
    s_cselect_b32 s35, 13994, s35
    s_waitcnt lgkmcnt(0)
    s_barrier
    s_cmp_lt_u32 s33, 1536
    s_cbranch_scc1 p1_f0
    s_cmp_lg_u32 s28, 15
    s_cbranch_scc1 p1_hv0
    s_sub_u32 s52, s33, 1536
    s_and_b32 s52, s52, 255
    s_lshl_b32 s58, s52, 2
    s_and_b32 s58, s58, 28
    s_lshl_b32 s53, 1, s58
    v_mov_b32 v127, s53
    s_lshr_b32 s52, s52, 3
    s_lshl_b32 s52, s52, 2
    s_mov_b64 exec, 1
    buffer_atomic_add v127, off, s[40:43], s52 sc0 sc1
    s_mov_b64 exec, -1
p1_hv0:
    s_cmp_ge_u32 s33, 1656
    s_cbranch_scc1 p1_f0
    s_sub_u32 s52, s33, 1536
    s_mul_i32 s52, s52, 53368
    s_mul_i32 s53, s28, 3072
    s_add_u32 s53, s53, s52
    v_and_b32 v92, 63, v0
    v_lshl_add_u32 v93, v92, 2, s53
    s_lshl_b32 s53, s28, 9
    s_add_u32 s53, s53, s52
    s_add_u32 s53, s53, 49152
    s_cmp_lt_u32 s28, 9
    s_cselect_b32 s53, s53, 0x40000000
    v_lshl_add_u32 v94, v92, 2, s53
    buffer_load_dword v76, v93, s[24:27], 0 offen offset:0
    buffer_load_dword v77, v93, s[24:27], 0 offen offset:256
    buffer_load_dword v78, v93, s[24:27], 0 offen offset:512
    buffer_load_dword v79, v93, s[24:27], 0 offen offset:768
    buffer_load_dword v80, v93, s[24:27], 0 offen offset:1024
    buffer_load_dword v81, v93, s[24:27], 0 offen offset:1280
    buffer_load_dword v82, v93, s[24:27], 0 offen offset:1536
    buffer_load_dword v83, v93, s[24:27], 0 offen offset:1792
    buffer_load_dword v84, v93, s[24:27], 0 offen offset:2048
    buffer_load_dword v85, v93, s[24:27], 0 offen offset:2304
    buffer_load_dword v86, v93, s[24:27], 0 offen offset:2560
    buffer_load_dword v87, v93, s[24:27], 0 offen offset:2816
    buffer_load_dword v88, v94, s[24:27], 0 offen offset:0
    buffer_load_dword v89, v94, s[24:27], 0 offen offset:256
p1_f0:
    v_and_b32 v117, 0xffff, v40
    ds_add_rtn_u32 v117, v117, v3 offset:0
    v_and_b32 v118, 0xffff, v41
    ds_add_rtn_u32 v118, v118, v3 offset:0
    v_and_b32 v119, 0xffff, v42
    ds_add_rtn_u32 v119, v119, v3 offset:0
    v_and_b32 v120, 0xffff, v43
    ds_add_rtn_u32 v120, v120, v3 offset:0
    s_cmp_ge_u32 s33, 1536
    s_cbranch_scc1 p1_k18
    s_cmp_lt_u32 s33, 1536
    s_cselect_b32 s14, 102400000, 0
    s_add_u32 s32, s31, 0
    buffer_load_dwordx2 v[76:77], v2, s[12:15], s32 offen nt
p1_k18:
    s_cmp_ge_u32 s33, 1536
    s_cbranch_scc1 p1_k19
    s_cmp_lt_u32 s33, 1536
    s_cselect_b32 s6, 204800000, 0
    s_cselect_b32 s10, 204800000, 0
    s_add_u32 s32, s30, 0
    buffer_load_dwordx4 v[94:97], v1, s[4:7], s32 offen nt
    buffer_load_dwordx4 v[102:105], v1, s[8:11], s32 offen nt
p1_k19:
    s_cmp_lt_u32 s29, 1499
    s_cbranch_scc1 p1_pa0
    s_waitcnt lgkmcnt(0)
    s_branch p1_pb0
p1_pa0:
    v_and_b32 v121, 0xffff, v44
    ds_add_rtn_u32 v121, v121, v3 offset:0
    v_and_b32 v122, 0xffff, v45
    ds_add_rtn_u32 v122, v122, v3 offset:0
    v_and_b32 v123, 0xffff, v46
    ds_add_rtn_u32 v123, v123, v3 offset:0
    v_and_b32 v124, 0xffff, v47
    ds_add_rtn_u32 v124, v124, v3 offset:0
    s_waitcnt lgkmcnt(4)
p1_pb0:
    ds_write_b8_d16_hi v117, v40 offset:10496
    v_lshlrev_b32 v40, 2, v117
    ds_write_b32 v40, v4 offset:52480
    ds_write_b8_d16_hi v118, v41 offset:10496
    v_lshlrev_b32 v41, 2, v118
    ds_write_b32 v41, v5 offset:52480
    ds_write_b8_d16_hi v119, v42 offset:10496
    v_lshlrev_b32 v42, 2, v119
    ds_write_b32 v42, v6 offset:52480
    ds_write_b8_d16_hi v120, v43 offset:10496
    v_lshlrev_b32 v43, 2, v120
    ds_write_b32 v43, v7 offset:52480
    s_cmp_ge_u32 s33, 1536
    s_cbranch_scc1 p1_k20
    s_cmp_lt_u32 s33, 1499
    s_cselect_b32 s14, 102400000, 0
    s_add_u32 s32, s31, 8192
    buffer_load_dwordx2 v[78:79], v2, s[12:15], s32 offen nt
p1_k20:
    s_cmp_lt_u32 s29, 1462
    s_cbranch_scc1 p1_pa1
    s_waitcnt lgkmcnt(0)
    s_branch p1_pb1
p1_pa1:
    v_and_b32 v117, 0xffff, v48
    ds_add_rtn_u32 v117, v117, v3 offset:0
    v_and_b32 v118, 0xffff, v49
    ds_add_rtn_u32 v118, v118, v3 offset:0
    v_and_b32 v119, 0xffff, v50
    ds_add_rtn_u32 v119, v119, v3 offset:0
    v_and_b32 v120, 0xffff, v51
    ds_add_rtn_u32 v120, v120, v3 offset:0
    s_waitcnt lgkmcnt(4)
p1_pb1:
    s_cmp_ge_u32 s29, 1499
    s_cbranch_scc1 p1_k21
    ds_write_b8_d16_hi v121, v44 offset:10496
    v_lshlrev_b32 v44, 2, v121
    ds_write_b32 v44, v8 offset:52480
    ds_write_b8_d16_hi v122, v45 offset:10496
    v_lshlrev_b32 v45, 2, v122
    ds_write_b32 v45, v9 offset:52480
    ds_write_b8_d16_hi v123, v46 offset:10496
    v_lshlrev_b32 v46, 2, v123
    ds_write_b32 v46, v10 offset:52480
    ds_write_b8_d16_hi v124, v47 offset:10496
    v_lshlrev_b32 v47, 2, v124
    ds_write_b32 v47, v11 offset:52480
p1_k21:
    s_cmp_ge_u32 s33, 1536
    s_cbranch_scc1 p1_k22
    s_cmp_lt_u32 s33, 1462
    s_cselect_b32 s14, 102400000, 0
    s_add_u32 s32, s31, 16384
    buffer_load_dwordx2 v[80:81], v2, s[12:15], s32 offen nt
p1_k22:
    s_cmp_lt_u32 s29, 1426
    s_cbranch_scc1 p1_pa2
    s_waitcnt lgkmcnt(0)
    s_branch p1_pb2
p1_pa2:
    v_and_b32 v121, 0xffff, v52
    ds_add_rtn_u32 v121, v121, v3 offset:0
    v_and_b32 v122, 0xffff, v53
    ds_add_rtn_u32 v122, v122, v3 offset:0
    v_and_b32 v123, 0xffff, v54
    ds_add_rtn_u32 v123, v123, v3 offset:0
    v_and_b32 v124, 0xffff, v55
    ds_add_rtn_u32 v124, v124, v3 offset:0
    s_waitcnt lgkmcnt(4)
p1_pb2:
    s_cmp_ge_u32 s29, 1462
    s_cbranch_scc1 p1_k23
    ds_write_b8_d16_hi v117, v48 offset:10496
    v_lshlrev_b32 v48, 2, v117
    ds_write_b32 v48, v12 offset:52480
    ds_write_b8_d16_hi v118, v49 offset:10496
    v_lshlrev_b32 v49, 2, v118
    ds_write_b32 v49, v13 offset:52480
    ds_write_b8_d16_hi v119, v50 offset:10496
    v_lshlrev_b32 v50, 2, v119
    ds_write_b32 v50, v14 offset:52480
    ds_write_b8_d16_hi v120, v51 offset:10496
    v_lshlrev_b32 v51, 2, v120
    ds_write_b32 v51, v15 offset:52480
p1_k23:
    s_cmp_ge_u32 s28, 10
    s_cbranch_scc1 p1_jn
    s_waitcnt vmcnt(0)
    v_mov_b32 v125, 0
    s_mov_b64 exec, 1
    ds_add_rtn_u32 v125, v125, v3 offset:10432
    s_waitcnt lgkmcnt(0)
    v_readfirstlane_b32 s52, v125
    s_lshr_b32 s53, s29, 1
    s_and_b32 s53, s53, 28
    s_cmp_lg_u32 s52, 9
    s_cbranch_scc1 p1_jn1
    s_lshl_b32 s54, 1, s53
    v_mov_b32 v127, s54
    s_lshr_b32 s54, s29, 6
    s_lshl_b32 s54, s54, 2
    s_mov_b32 s68, 1
    buffer_atomic_add v127, off, s[40:43], s54 sc0 sc1
p1_jn1:
    s_mov_b64 exec, -1
p1_jn:
    s_cmp_ge_u32 s33, 1536
    s_cbranch_scc1 p1_k24
    s_cmp_lt_u32 s33, 1426
    s_cselect_b32 s14, 102400000, 0
    s_add_u32 s32, s31, 24576
    buffer_load_dwordx2 v[82:83], v2, s[12:15], s32 offen nt
p1_k24:
    s_cmp_lt_u32 s29, 1389
    s_cbranch_scc1 p1_pa3
    s_waitcnt lgkmcnt(0)
    s_branch p1_pb3
p1_pa3:
    v_and_b32 v117, 0xffff, v56
    ds_add_rtn_u32 v117, v117, v3 offset:0
    v_and_b32 v118, 0xffff, v57
    ds_add_rtn_u32 v118, v118, v3 offset:0
    v_and_b32 v119, 0xffff, v58
    ds_add_rtn_u32 v119, v119, v3 offset:0
    v_and_b32 v120, 0xffff, v59
    ds_add_rtn_u32 v120, v120, v3 offset:0
    s_waitcnt lgkmcnt(4)
p1_pb3:
    s_cmp_ge_u32 s29, 1426
    s_cbranch_scc1 p1_k25
    ds_write_b8_d16_hi v121, v52 offset:10496
    v_lshlrev_b32 v52, 2, v121
    ds_write_b32 v52, v16 offset:52480
    ds_write_b8_d16_hi v122, v53 offset:10496
    v_lshlrev_b32 v53, 2, v122
    ds_write_b32 v53, v17 offset:52480
    ds_write_b8_d16_hi v123, v54 offset:10496
    v_lshlrev_b32 v54, 2, v123
    ds_write_b32 v54, v18 offset:52480
    ds_write_b8_d16_hi v124, v55 offset:10496
    v_lshlrev_b32 v55, 2, v124
    ds_write_b32 v55, v19 offset:52480
p1_k25:
    s_cmp_ge_u32 s33, 1536
    s_cbranch_scc1 p1_k26
    s_cmp_lt_u32 s33, 1389
    s_cselect_b32 s14, 102400000, 0
    s_add_u32 s32, s31, 32768
    buffer_load_dwordx2 v[84:85], v2, s[12:15], s32 offen nt
p1_k26:
    s_cmp_ge_u32 s33, 1536
    s_cbranch_scc1 p1_k27
    s_cmp_lt_u32 s33, 1499
    s_cselect_b32 s6, 204800000, 0
    s_cselect_b32 s10, 204800000, 0
    s_add_u32 s32, s30, 16384
    buffer_load_dwordx4 v[98:101], v1, s[4:7], s32 offen nt
    buffer_load_dwordx4 v[106:109], v1, s[8:11], s32 offen nt
p1_k27:
    s_cmp_lt_u32 s29, 1352
    s_cbranch_scc1 p1_pa4
    s_waitcnt lgkmcnt(0)
    s_branch p1_pb4
p1_pa4:
    v_and_b32 v121, 0xffff, v60
    ds_add_rtn_u32 v121, v121, v3 offset:0
    v_and_b32 v122, 0xffff, v61
    ds_add_rtn_u32 v122, v122, v3 offset:0
    v_and_b32 v123, 0xffff, v62
    ds_add_rtn_u32 v123, v123, v3 offset:0
    v_and_b32 v124, 0xffff, v63
    ds_add_rtn_u32 v124, v124, v3 offset:0
    s_waitcnt lgkmcnt(4)
p1_pb4:
    s_cmp_ge_u32 s29, 1389
    s_cbranch_scc1 p1_k28
    ds_write_b8_d16_hi v117, v56 offset:10496
    v_lshlrev_b32 v56, 2, v117
    ds_write_b32 v56, v20 offset:52480
    ds_write_b8_d16_hi v118, v57 offset:10496
    v_lshlrev_b32 v57, 2, v118
    ds_write_b32 v57, v21 offset:52480
    ds_write_b8_d16_hi v119, v58 offset:10496
    v_lshlrev_b32 v58, 2, v119
    ds_write_b32 v58, v22 offset:52480
    ds_write_b8_d16_hi v120, v59 offset:10496
    v_lshlrev_b32 v59, 2, v120
    ds_write_b32 v59, v23 offset:52480
p1_k28:
    s_cmp_ge_u32 s33, 1536
    s_cbranch_scc1 p1_k29
    s_cmp_lt_u32 s33, 1352
    s_cselect_b32 s14, 102400000, 0
    s_add_u32 s32, s31, 40960
    buffer_load_dwordx2 v[86:87], v2, s[12:15], s32 offen nt
p1_k29:
    s_cmp_lt_u32 s29, 1315
    s_cbranch_scc1 p1_pa5
    s_waitcnt lgkmcnt(0)
    s_branch p1_pb5
p1_pa5:
    v_and_b32 v117, 0xffff, v64
    ds_add_rtn_u32 v117, v117, v3 offset:0
    v_and_b32 v118, 0xffff, v65
    ds_add_rtn_u32 v118, v118, v3 offset:0
    v_and_b32 v119, 0xffff, v66
    ds_add_rtn_u32 v119, v119, v3 offset:0
    v_and_b32 v120, 0xffff, v67
    ds_add_rtn_u32 v120, v120, v3 offset:0
    s_waitcnt lgkmcnt(4)
p1_pb5:
    s_cmp_ge_u32 s29, 1352
    s_cbranch_scc1 p1_k30
    ds_write_b8_d16_hi v121, v60 offset:10496
    v_lshlrev_b32 v60, 2, v121
    ds_write_b32 v60, v24 offset:52480
    ds_write_b8_d16_hi v122, v61 offset:10496
    v_lshlrev_b32 v61, 2, v122
    ds_write_b32 v61, v25 offset:52480
    ds_write_b8_d16_hi v123, v62 offset:10496
    v_lshlrev_b32 v62, 2, v123
    ds_write_b32 v62, v26 offset:52480
    ds_write_b8_d16_hi v124, v63 offset:10496
    v_lshlrev_b32 v63, 2, v124
    ds_write_b32 v63, v27 offset:52480
p1_k30:
    s_cmp_ge_u32 s33, 1536
    s_cbranch_scc1 p1_k31
    s_cmp_lt_u32 s33, 1315
    s_cselect_b32 s14, 102400000, 0
    s_add_u32 s32, s31, 49152
    buffer_load_dwordx2 v[88:89], v2, s[12:15], s32 offen nt
p1_k31:
    s_cmp_lt_u32 s29, 1279
    s_cbranch_scc1 p1_pa6
    s_waitcnt lgkmcnt(0)
    s_branch p1_pb6
p1_pa6:
    v_and_b32 v121, 0xffff, v68
    ds_add_rtn_u32 v121, v121, v3 offset:0
    v_and_b32 v122, 0xffff, v69
    ds_add_rtn_u32 v122, v122, v3 offset:0
    v_and_b32 v123, 0xffff, v70
    ds_add_rtn_u32 v123, v123, v3 offset:0
    v_and_b32 v124, 0xffff, v71
    ds_add_rtn_u32 v124, v124, v3 offset:0
    s_waitcnt lgkmcnt(4)
p1_pb6:
    s_cmp_ge_u32 s29, 1315
    s_cbranch_scc1 p1_k32
    ds_write_b8_d16_hi v117, v64 offset:10496
    v_lshlrev_b32 v64, 2, v117
    ds_write_b32 v64, v28 offset:52480
    ds_write_b8_d16_hi v118, v65 offset:10496
    v_lshlrev_b32 v65, 2, v118
    ds_write_b32 v65, v29 offset:52480
    ds_write_b8_d16_hi v119, v66 offset:10496
    v_lshlrev_b32 v66, 2, v119
    ds_write_b32 v66, v30 offset:52480
    ds_write_b8_d16_hi v120, v67 offset:10496
    v_lshlrev_b32 v67, 2, v120
    ds_write_b32 v67, v31 offset:52480
p1_k32:
    s_cmp_ge_u32 s33, 1536
    s_cbranch_scc1 p1_k33
    s_cmp_lt_u32 s33, 1279
    s_cselect_b32 s14, 102400000, 0
    s_add_u32 s32, s31, 57344
    buffer_load_dwordx2 v[90:91], v2, s[12:15], s32 offen nt
p1_k33:
    s_cmp_lt_u32 s29, 1242
    s_cbranch_scc1 p1_pa7
    s_waitcnt lgkmcnt(0)
    s_branch p1_pb7
p1_pa7:
    v_and_b32 v117, 0xffff, v72
    ds_add_rtn_u32 v117, v117, v3 offset:0
    v_and_b32 v118, 0xffff, v73
    ds_add_rtn_u32 v118, v118, v3 offset:0
    v_and_b32 v119, 0xffff, v74
    ds_add_rtn_u32 v119, v119, v3 offset:0
    v_and_b32 v120, 0xffff, v75
    ds_add_rtn_u32 v120, v120, v3 offset:0
    s_waitcnt lgkmcnt(4)
p1_pb7:
    s_cmp_ge_u32 s29, 1279
    s_cbranch_scc1 p1_k34
    ds_write_b8_d16_hi v121, v68 offset:10496
    v_lshlrev_b32 v68, 2, v121
    ds_write_b32 v68, v32 offset:52480
    ds_write_b8_d16_hi v122, v69 offset:10496
    v_lshlrev_b32 v69, 2, v122
    ds_write_b32 v69, v33 offset:52480
    ds_write_b8_d16_hi v123, v70 offset:10496
    v_lshlrev_b32 v70, 2, v123
    ds_write_b32 v70, v34 offset:52480
    ds_write_b8_d16_hi v124, v71 offset:10496
    v_lshlrev_b32 v71, 2, v124
    ds_write_b32 v71, v35 offset:52480
p1_k34:
    s_cmp_ge_u32 s33, 1536
    s_cbranch_scc1 p1_k35
    s_cmp_lt_u32 s33, 1242
    s_cselect_b32 s14, 102400000, 0
    s_add_u32 s32, s31, 65536
    buffer_load_dwordx2 v[92:93], v2, s[12:15], s32 offen nt
p1_k35:
    s_waitcnt lgkmcnt(0)
    s_cmp_ge_u32 s29, 1242
    s_cbranch_scc1 p1_k36
    ds_write_b8_d16_hi v117, v72 offset:10496
    v_lshlrev_b32 v72, 2, v117
    ds_write_b32 v72, v36 offset:52480
    ds_write_b8_d16_hi v118, v73 offset:10496
    v_lshlrev_b32 v73, 2, v118
    ds_write_b32 v73, v37 offset:52480
    ds_write_b8_d16_hi v119, v74 offset:10496
    v_lshlrev_b32 v74, 2, v119
    ds_write_b32 v74, v38 offset:52480
    ds_write_b8_d16_hi v120, v75 offset:10496
    v_lshlrev_b32 v75, 2, v120
    ds_write_b32 v75, v39 offset:52480
p1_k36:
    s_cmp_eq_u32 s68, 0
    s_cbranch_scc1 p1_sg
    s_cmp_lt_u32 s33, 1536
    s_cbranch_scc1 p1_w37
    s_waitcnt vmcnt(0)
p1_w37:
    s_waitcnt vmcnt(8)
    v_bfe_u32 v127, v127, s53, 4
    v_mov_b32 v125, 0
    s_mov_b64 exec, 1
    ds_write_b32 v125, v127 offset:10452
    s_mov_b64 exec, -1
p1_sg:
    s_cmp_lt_u32 s33, 1536
    s_cbranch_scc1 p1_f1
    s_cmp_lg_u32 s28, 15
    s_cbranch_scc1 p1_hv1
    s_waitcnt vmcnt(0)
    v_bfe_u32 v127, v127, s58, 4
    v_mov_b32 v125, 0
    s_mov_b64 exec, 1
    ds_write_b32 v125, v127 offset:10448
    s_mov_b64 exec, -1
p1_hv1:
    s_cmp_ge_u32 s33, 1656
    s_cbranch_scc1 p1_f1
    s_sub_u32 s52, s33, 1536
    s_mul_i32 s53, s52, 53760
    s_add_u32 s53, s53, 485810176
    s_mul_i32 s54, s28, 3072
    v_lshl_add_u32 v93, v92, 4, s54
    s_lshl_b32 s54, s28, 9
    s_add_u32 s54, s54, 49152
    s_cmp_lt_u32 s28, 9
    s_cselect_b32 s54, s54, 0x40000000
    v_lshl_add_u32 v94, v92, 3, s54
    v_mov_b32 v96, 0
    v_mov_b32 v97, 0
    s_waitcnt vmcnt(0)
    buffer_store_dwordx4 v[76:79], v93, s[16:19], s53 offen offset:0
    buffer_store_dwordx4 v[80:83], v93, s[16:19], s53 offen offset:1024
    buffer_store_dwordx4 v[84:87], v93, s[16:19], s53 offen offset:2048
    buffer_store_dwordx2 v[88:89], v94, s[16:19], s53 offen
    v_and_b32 v98, 0x7fff7fff, v76
    v_pk_max_u16 v96, v96, v98
    v_lshlrev_b32 v99, 16, v98
    v_and_b32 v98, 0xffff0000, v98
    v_fmac_f32 v97, v99, v99
    v_fmac_f32 v97, v98, v98
    v_and_b32 v98, 0x7fff7fff, v77
    v_pk_max_u16 v96, v96, v98
    v_lshlrev_b32 v99, 16, v98
    v_and_b32 v98, 0xffff0000, v98
    v_fmac_f32 v97, v99, v99
    v_fmac_f32 v97, v98, v98
    v_and_b32 v98, 0x7fff7fff, v78
    v_pk_max_u16 v96, v96, v98
    v_lshlrev_b32 v99, 16, v98
    v_and_b32 v98, 0xffff0000, v98
    v_fmac_f32 v97, v99, v99
    v_fmac_f32 v97, v98, v98
    v_and_b32 v98, 0x7fff7fff, v79
    v_pk_max_u16 v96, v96, v98
    v_lshlrev_b32 v99, 16, v98
    v_and_b32 v98, 0xffff0000, v98
    v_fmac_f32 v97, v99, v99
    v_fmac_f32 v97, v98, v98
    v_and_b32 v98, 0x7fff7fff, v80
    v_pk_max_u16 v96, v96, v98
    v_lshlrev_b32 v99, 16, v98
    v_and_b32 v98, 0xffff0000, v98
    v_fmac_f32 v97, v99, v99
    v_fmac_f32 v97, v98, v98
    v_and_b32 v98, 0x7fff7fff, v81
    v_pk_max_u16 v96, v96, v98
    v_lshlrev_b32 v99, 16, v98
    v_and_b32 v98, 0xffff0000, v98
    v_fmac_f32 v97, v99, v99
    v_fmac_f32 v97, v98, v98
    v_and_b32 v98, 0x7fff7fff, v82
    v_pk_max_u16 v96, v96, v98
    v_lshlrev_b32 v99, 16, v98
    v_and_b32 v98, 0xffff0000, v98
    v_fmac_f32 v97, v99, v99
    v_fmac_f32 v97, v98, v98
    v_and_b32 v98, 0x7fff7fff, v83
    v_pk_max_u16 v96, v96, v98
    v_lshlrev_b32 v99, 16, v98
    v_and_b32 v98, 0xffff0000, v98
    v_fmac_f32 v97, v99, v99
    v_fmac_f32 v97, v98, v98
    v_and_b32 v98, 0x7fff7fff, v84
    v_pk_max_u16 v96, v96, v98
    v_lshlrev_b32 v99, 16, v98
    v_and_b32 v98, 0xffff0000, v98
    v_fmac_f32 v97, v99, v99
    v_fmac_f32 v97, v98, v98
    v_and_b32 v98, 0x7fff7fff, v85
    v_pk_max_u16 v96, v96, v98
    v_lshlrev_b32 v99, 16, v98
    v_and_b32 v98, 0xffff0000, v98
    v_fmac_f32 v97, v99, v99
    v_fmac_f32 v97, v98, v98
    v_and_b32 v98, 0x7fff7fff, v86
    v_pk_max_u16 v96, v96, v98
    v_lshlrev_b32 v99, 16, v98
    v_and_b32 v98, 0xffff0000, v98
    v_fmac_f32 v97, v99, v99
    v_fmac_f32 v97, v98, v98
    v_and_b32 v98, 0x7fff7fff, v87
    v_pk_max_u16 v96, v96, v98
    v_lshlrev_b32 v99, 16, v98
    v_and_b32 v98, 0xffff0000, v98
    v_fmac_f32 v97, v99, v99
    v_fmac_f32 v97, v98, v98
    v_and_b32 v98, 0x7fff7fff, v88
    v_pk_max_u16 v96, v96, v98
    v_lshlrev_b32 v99, 16, v98
    v_and_b32 v98, 0xffff0000, v98
    v_fmac_f32 v97, v99, v99
    v_fmac_f32 v97, v98, v98
    v_and_b32 v98, 0x7fff7fff, v89
    v_pk_max_u16 v96, v96, v98
    v_lshlrev_b32 v99, 16, v98
    v_and_b32 v98, 0xffff0000, v98
    v_fmac_f32 v97, v99, v99
    v_fmac_f32 v97, v98, v98
    v_lshrrev_b32 v98, 16, v96
    v_and_b32 v96, 0xffff, v96
    v_max_u32 v96, v96, v98
    s_nop 1
    v_max_u32_dpp v96, v96, v96 row_shr:1 row_mask:0xf bank_mask:0xf bound_ctrl:0
    v_add_f32_dpp v97, v97, v97 row_shr:1 row_mask:0xf bank_mask:0xf bound_ctrl:0
    s_nop 0
    v_max_u32_dpp v96, v96, v96 row_shr:2 row_mask:0xf bank_mask:0xf bound_ctrl:0
    v_add_f32_dpp v97, v97, v97 row_shr:2 row_mask:0xf bank_mask:0xf bound_ctrl:0
    s_nop 0
    v_max_u32_dpp v96, v96, v96 row_shr:4 row_mask:0xf bank_mask:0xf bound_ctrl:0
    v_add_f32_dpp v97, v97, v97 row_shr:4 row_mask:0xf bank_mask:0xf bound_ctrl:0
    s_nop 0
    v_max_u32_dpp v96, v96, v96 row_shr:8 row_mask:0xf bank_mask:0xf bound_ctrl:0
    v_add_f32_dpp v97, v97, v97 row_shr:8 row_mask:0xf bank_mask:0xf bound_ctrl:0
    s_nop 0
    v_max_u32_dpp v96, v96, v96 row_bcast:15 row_mask:0xa bank_mask:0xf
    v_add_f32_dpp v97, v97, v97 row_bcast:15 row_mask:0xa bank_mask:0xf
    s_nop 0
    v_max_u32_dpp v96, v96, v96 row_bcast:31 row_mask:0xc bank_mask:0xf
    v_add_f32_dpp v97, v97, v97 row_bcast:31 row_mask:0xc bank_mask:0xf
    s_nop 0
    s_nop 0
    s_lshl_b32 s52, s52, 4
    s_add_u32 s52, s52, s28
    s_lshl_b32 s52, s52, 3
    s_add_u32 s52, s52, 492261376
    s_mov_b64 exec, 1
    s_lshl_b64 exec, exec, 63
    buffer_store_dwordx2 v[96:97], off, s[16:19], s52
    s_mov_b64 exec, -1
p1_f1:
    s_waitcnt lgkmcnt(0)
    s_barrier
    v_mul_u32_u24 v119, 3, v0
    v_and_b32 v118, -4, v119
    v_add_u32 v120, s50, v1
    v_mov_b32 v122, 0
    v_mov_b32 v123, 0
    v_mov_b32 v124, 0
    v_mov_b32 v125, 0
    ds_read_b64 v[126:127], v122 offset:10448
    ds_write_b32 v122, v122 offset:10432
    v_cmp_gt_u32 vcc, 640, v0
    s_and_saveexec_b64 s[52:53], vcc
    ds_write_b128 v1, v[122:125] offset:0
    s_mov_b64 exec, -1
    s_waitcnt lgkmcnt(2)
    v_readfirstlane_b32 s70, v126
    v_readfirstlane_b32 s69, v127
    s_cmp_ge_u32 s33, 1536
    s_cselect_b32 s70, s70, 0
    s_cmp_gt_u32 s28, 10
    s_cselect_b32 s69, 0, s69
    s_cselect_b32 s70, 0, s70
    s_cmp_lg_u32 s70, 8
    s_cbranch_scc1 p1_h0
    s_sub_u32 s52, s33, 1536
    v_and_b32 v102, 63, v0
    s_cmp_eq_u32 s28, 10
    s_cbranch_scc1 p1_tr10
    s_mul_i32 s53, s28, 520
    v_lshl_add_u32 v100, v102, 3, s53
    s_mul_i32 s53, s28, 4160
    v_lshl_add_u32 v101, v102, 4, s53
    s_branch p1_tr20
p1_tr10:
    v_mul_u32_u24 v100, 520, v102
    v_add_u32 v100, 512, v100
    v_mul_u32_u24 v101, 4160, v102
    v_add_u32 v101, 1024, v101
    v_cmp_gt_u32 vcc, 10, v102
    v_mov_b32 v102, 0x40000000
    s_nop 0
    v_cndmask_b32 v100, v102, v100, vcc
    v_cndmask_b32 v101, v102, v101, vcc
p1_tr20:
    s_mul_i32 s52, s52, 41984
    s_add_u32 s52, s52, 469762048
    buffer_load_dwordx2 v[76:77], v100, s[16:19], s52 offen sc1
    s_add_u32 s52, s52, 5248
    buffer_load_dwordx2 v[78:79], v100, s[16:19], s52 offen sc1
    s_add_u32 s52, s52, 5248
    buffer_load_dwordx2 v[80:81], v100, s[16:19], s52 offen sc1
    s_add_u32 s52, s52, 5248
    buffer_load_dwordx2 v[82:83], v100, s[16:19], s52 offen sc1
    s_add_u32 s52, s52, 5248
    buffer_load_dwordx2 v[84:85], v100, s[16:19], s52 offen sc1
    s_add_u32 s52, s52, 5248
    buffer_load_dwordx2 v[86:87], v100, s[16:19], s52 offen sc1
    s_add_u32 s52, s52, 5248
    buffer_load_dwordx2 v[88:89], v100, s[16:19], s52 offen sc1
    s_add_u32 s52, s52, 5248
    buffer_load_dwordx2 v[90:91], v100, s[16:19], s52 offen sc1
    s_add_u32 s52, s52, 5248
p1_h0:
    v_lshlrev_b32 v117, 2, v119
    v_add_u32 v117, 52480, v117
    ds_read_b32 v110, v117 offset:0
    ds_read_b32 v111, v117 offset:4
    ds_read_b32 v112, v117 offset:8
    ds_read_b32 v113, v118 offset:10496
    ds_read_b32 v114, v118 offset:10500
    ds_read_b32 v122, v117 offset:12288
    ds_read_b32 v123, v117 offset:12292
    ds_read_b32 v124, v117 offset:12296
    ds_read_b32 v125, v118 offset:13568
    ds_read_b32 v121, v118 offset:13572
    s_waitcnt lgkmcnt(5)
    v_alignbyte_b32 v113, v114, v113, v119
    buffer_store_dwordx4 v[110:113], v120, s[20:23], 0 offen
    v_add_u32 v120, 33554432, v120
    s_nop 0
    ds_read_b32 v110, v117 offset:24576
    ds_read_b32 v111, v117 offset:24580
    ds_read_b32 v112, v117 offset:24584
    ds_read_b32 v113, v118 offset:16640
    ds_read_b32 v114, v118 offset:16644
    s_cmp_le_u32 s35, 1024
    s_cbranch_scc1 p1_ce0
    s_waitcnt lgkmcnt(5)
    v_alignbyte_b32 v125, v121, v125, v119
    buffer_store_dwordx4 v[122:125], v120, s[20:23], 0 offen
    v_add_u32 v120, 33554432, v120
    s_nop 0
    ds_read_b32 v122, v117 offset:36864
    ds_read_b32 v123, v117 offset:36868
    ds_read_b32 v124, v117 offset:36872
    ds_read_b32 v125, v118 offset:19712
    ds_read_b32 v121, v118 offset:19716
    s_cmp_le_u32 s35, 2048
    s_cbranch_scc1 p1_ce0
    s_waitcnt lgkmcnt(5)
    v_alignbyte_b32 v113, v114, v113, v119
    buffer_store_dwordx4 v[110:113], v120, s[20:23], 0 offen
    v_add_u32 v120, 33554432, v120
    s_nop 0
    ds_read_b32 v110, v117 offset:49152
    ds_read_b32 v111, v117 offset:49156
    ds_read_b32 v112, v117 offset:49160
    ds_read_b32 v113, v118 offset:22784
    ds_read_b32 v114, v118 offset:22788
    s_cmp_le_u32 s35, 3072
    s_cbranch_scc1 p1_ce0
    s_waitcnt lgkmcnt(5)
    v_alignbyte_b32 v125, v121, v125, v119
    buffer_store_dwordx4 v[122:125], v120, s[20:23], 0 offen
    v_add_u32 v120, 33554432, v120
    s_nop 0
    v_lshlrev_b32 v117, 2, v119
    v_add_u32 v117, 113920, v117
    ds_read_b32 v122, v117 offset:0
    ds_read_b32 v123, v117 offset:4
    ds_read_b32 v124, v117 offset:8
    ds_read_b32 v125, v118 offset:25856
    ds_read_b32 v121, v118 offset:25860
    s_cmp_le_u32 s35, 4096
    s_cbranch_scc1 p1_ce0
    s_waitcnt lgkmcnt(5)
    v_alignbyte_b32 v113, v114, v113, v119
    buffer_store_dwordx4 v[110:113], v120, s[20:23], 0 offen
    v_add_u32 v120, 33554432, v120
    s_nop 0
    ds_read_b32 v110, v117 offset:12288
    ds_read_b32 v111, v117 offset:12292
    ds_read_b32 v112, v117 offset:12296
    ds_read_b32 v113, v118 offset:28928
    ds_read_b32 v114, v118 offset:28932
    s_cmp_le_u32 s35, 5120
    s_cbranch_scc1 p1_ce0
    s_waitcnt lgkmcnt(5)
    v_alignbyte_b32 v125, v121, v125, v119
    buffer_store_dwordx4 v[122:125], v120, s[20:23], 0 offen
    v_add_u32 v120, 33554432, v120
    s_nop 0
    ds_read_b32 v122, v117 offset:24576
    ds_read_b32 v123, v117 offset:24580
    ds_read_b32 v124, v117 offset:24584
    ds_read_b32 v125, v118 offset:32000
    ds_read_b32 v121, v118 offset:32004
    s_cmp_le_u32 s35, 6144
    s_cbranch_scc1 p1_ce0
    s_waitcnt lgkmcnt(5)
    v_alignbyte_b32 v113, v114, v113, v119
    buffer_store_dwordx4 v[110:113], v120, s[20:23], 0 offen
    v_add_u32 v120, 33554432, v120
    s_nop 0
    ds_read_b32 v110, v117 offset:36864
    ds_read_b32 v111, v117 offset:36868
    ds_read_b32 v112, v117 offset:36872
    ds_read_b32 v113, v118 offset:35072
    ds_read_b32 v114, v118 offset:35076
    s_cmp_le_u32 s35, 7168
    s_cbranch_scc1 p1_ce0
    s_waitcnt lgkmcnt(5)
    v_alignbyte_b32 v125, v121, v125, v119
    buffer_store_dwordx4 v[122:125], v120, s[20:23], 0 offen
    v_add_u32 v120, 33554432, v120
    s_nop 0
    s_cmp_le_u32 s35, 8192
    s_cbranch_scc1 p1_ce0
    s_waitcnt lgkmcnt(0)
    v_alignbyte_b32 v113, v114, v113, v119
    buffer_store_dwordx4 v[110:113], v120, s[20:23], 0 offen nt
    v_add_u32 v120, 33554432, v120
    s_nop 0
p1_ce0:
    s_waitcnt lgkmcnt(0)
    s_cmp_lg_u32 s70, 8
    s_cbranch_scc1 p1_h1
    s_sub_u32 s52, s33, 1536
    s_mul_i32 s52, s52, 41600
    s_add_u32 s52, s52, 477822976
    s_mov_b32 s54, 0x05040100
    s_mov_b32 s55, 0x07060302
    s_waitcnt vmcnt(1)
    v_perm_b32 v92, v78, v76, s54
    v_perm_b32 v93, v82, v80, s54
    v_perm_b32 v94, v86, v84, s54
    v_perm_b32 v95, v90, v88, s54
    buffer_store_dwordx4 v[92:95], v101, s[16:19], s52 offen offset:0
    v_perm_b32 v96, v78, v76, s55
    v_perm_b32 v97, v82, v80, s55
    v_perm_b32 v98, v86, v84, s55
    v_perm_b32 v99, v90, v88, s55
    buffer_store_dwordx4 v[96:99], v101, s[16:19], s52 offen offset:1040
    v_perm_b32 v92, v79, v77, s54
    v_perm_b32 v93, v83, v81, s54
    v_perm_b32 v94, v87, v85, s54
    v_perm_b32 v95, v91, v89, s54
    buffer_store_dwordx4 v[92:95], v101, s[16:19], s52 offen offset:2080
    v_perm_b32 v96, v79, v77, s55
    v_perm_b32 v97, v83, v81, s55
    v_perm_b32 v98, v87, v85, s55
    v_perm_b32 v99, v91, v89, s55
    buffer_store_dwordx4 v[96:99], v101, s[16:19], s52 offen offset:3120
p1_h1:
    s_barrier
    s_cmp_ge_u32 s29, 1462
    s_cbranch_scc1 p1_k38
    s_cmp_le_u32 s35, 9216
    s_cbranch_scc1 p1_s1k2
    v_sub_u32 v48, 221180, v48
    ds_write_b32 v48, v12 offset:52480
    v_sub_u32 v49, 221180, v49
    ds_write_b32 v49, v13 offset:52480
    v_sub_u32 v50, 221180, v50
    ds_write_b32 v50, v14 offset:52480
    v_sub_u32 v51, 221180, v51
    ds_write_b32 v51, v15 offset:52480
p1_s1k2:
p1_k38:
    s_cmp_ge_u32 s33, 1536
    s_cbranch_scc1 p1_k39
    s_cmp_lt_u32 s33, 1462
    s_cselect_b32 s6, 204800000, 0
    s_cselect_b32 s10, 204800000, 0
    s_add_u32 s32, s30, 32768
    buffer_load_dwordx4 v[12:15], v1, s[4:7], s32 offen nt
    buffer_load_dwordx4 v[48:51], v1, s[8:11], s32 offen nt
p1_k39:
    s_cmp_ge_u32 s29, 1426
    s_cbranch_scc1 p1_k40
    s_cmp_le_u32 s35, 9216
    s_cbranch_scc1 p1_s1k3
    v_sub_u32 v52, 221180, v52
    ds_write_b32 v52, v16 offset:52480
    v_sub_u32 v53, 221180, v53
    ds_write_b32 v53, v17 offset:52480
    v_sub_u32 v54, 221180, v54
    ds_write_b32 v54, v18 offset:52480
    v_sub_u32 v55, 221180, v55
    ds_write_b32 v55, v19 offset:52480
p1_s1k3:
p1_k40:
    s_cmp_ge_u32 s29, 1389
    s_cbranch_scc1 p1_k41
    s_cmp_le_u32 s35, 9216
    s_cbranch_scc1 p1_s1k4
    v_sub_u32 v56, 221180, v56
    ds_write_b32 v56, v20 offset:52480
    v_sub_u32 v57, 221180, v57
    ds_write_b32 v57, v21 offset:52480
    v_sub_u32 v58, 221180, v58
    ds_write_b32 v58, v22 offset:52480
    v_sub_u32 v59, 221180, v59
    ds_write_b32 v59, v23 offset:52480
p1_s1k4:
p1_k41:
    s_cmp_ge_u32 s29, 1352
    s_cbranch_scc1 p1_k42
    s_cmp_le_u32 s35, 9216
    s_cbranch_scc1 p1_s1k5
    v_sub_u32 v60, 221180, v60
    ds_write_b32 v60, v24 offset:52480
    v_sub_u32 v61, 221180, v61
    ds_write_b32 v61, v25 offset:52480
    v_sub_u32 v62, 221180, v62
    ds_write_b32 v62, v26 offset:52480
    v_sub_u32 v63, 221180, v63
    ds_write_b32 v63, v27 offset:52480
p1_s1k5:
p1_k42:
    s_cmp_ge_u32 s29, 1315
    s_cbranch_scc1 p1_k43
    s_cmp_le_u32 s35, 9216
    s_cbranch_scc1 p1_s1k6
    v_sub_u32 v64, 221180, v64
    ds_write_b32 v64, v28 offset:52480
    v_sub_u32 v65, 221180, v65
    ds_write_b32 v65, v29 offset:52480
    v_sub_u32 v66, 221180, v66
    ds_write_b32 v66, v30 offset:52480
    v_sub_u32 v67, 221180, v67
    ds_write_b32 v67, v31 offset:52480
p1_s1k6:
p1_k43:
    s_cmp_ge_u32 s29, 1279
    s_cbranch_scc1 p1_k44
    s_cmp_le_u32 s35, 9216
    s_cbranch_scc1 p1_s1k7
    v_sub_u32 v68, 221180, v68
    ds_write_b32 v68, v32 offset:52480
    v_sub_u32 v69, 221180, v69
    ds_write_b32 v69, v33 offset:52480
    v_sub_u32 v70, 221180, v70
    ds_write_b32 v70, v34 offset:52480
    v_sub_u32 v71, 221180, v71
    ds_write_b32 v71, v35 offset:52480
p1_s1k7:
p1_k44:
    s_cmp_ge_u32 s29, 1242
    s_cbranch_scc1 p1_k45
    s_cmp_le_u32 s35, 9216
    s_cbranch_scc1 p1_s1k8
    v_sub_u32 v72, 221180, v72
    ds_write_b32 v72, v36 offset:52480
    v_sub_u32 v73, 221180, v73
    ds_write_b32 v73, v37 offset:52480
    v_sub_u32 v74, 221180, v74
    ds_write_b32 v74, v38 offset:52480
    v_sub_u32 v75, 221180, v75
    ds_write_b32 v75, v39 offset:52480
p1_s1k8:
p1_k45:
    s_cmp_le_u32 s35, 9216
    s_cbranch_scc1 p1_s1k0
    v_sub_u32 v40, 221180, v40
    ds_write_b32 v40, v4 offset:52480
    v_sub_u32 v41, 221180, v41
    ds_write_b32 v41, v5 offset:52480
    v_sub_u32 v42, 221180, v42
    ds_write_b32 v42, v6 offset:52480
    v_sub_u32 v43, 221180, v43
    ds_write_b32 v43, v7 offset:52480
p1_s1k0:
    s_cmp_ge_u32 s29, 1499
    s_cbranch_scc1 p1_k46
    s_cmp_le_u32 s35, 9216
    s_cbranch_scc1 p1_s1k1
    v_sub_u32 v44, 221180, v44
    ds_write_b32 v44, v8 offset:52480
    v_sub_u32 v45, 221180, v45
    ds_write_b32 v45, v9 offset:52480
    v_sub_u32 v46, 221180, v46
    ds_write_b32 v46, v10 offset:52480
    v_sub_u32 v47, 221180, v47
    ds_write_b32 v47, v11 offset:52480
p1_s1k1:
p1_k46:
    s_cmp_lg_u32 s69, 8
    s_cbranch_scc1 p1_o1
    s_lshr_b32 s52, s29, 3
    v_and_b32 v74, 63, v0
    s_cmp_eq_u32 s28, 10
    s_cbranch_scc1 p1_tr11
    s_mul_i32 s53, s28, 520
    v_lshl_add_u32 v72, v74, 3, s53
    s_mul_i32 s53, s28, 4160
    v_lshl_add_u32 v73, v74, 4, s53
    s_branch p1_tr21
p1_tr11:
    v_mul_u32_u24 v72, 520, v74
    v_add_u32 v72, 512, v72
    v_mul_u32_u24 v73, 4160, v74
    v_add_u32 v73, 1024, v73
    v_cmp_gt_u32 vcc, 10, v74
    v_mov_b32 v74, 0x40000000
    s_nop 0
    v_cndmask_b32 v72, v74, v72, vcc
    v_cndmask_b32 v73, v74, v73, vcc
p1_tr21:
    s_mul_i32 s52, s52, 41984
    s_add_u32 s52, s52, 469762048
    buffer_load_dwordx2 v[24:25], v72, s[16:19], s52 offen sc1
    s_add_u32 s52, s52, 5248
    buffer_load_dwordx2 v[26:27], v72, s[16:19], s52 offen sc1
    s_add_u32 s52, s52, 5248
    buffer_load_dwordx2 v[28:29], v72, s[16:19], s52 offen sc1
    s_add_u32 s52, s52, 5248
    buffer_load_dwordx2 v[30:31], v72, s[16:19], s52 offen sc1
    s_add_u32 s52, s52, 5248
    buffer_load_dwordx2 v[32:33], v72, s[16:19], s52 offen sc1
    s_add_u32 s52, s52, 5248
    buffer_load_dwordx2 v[34:35], v72, s[16:19], s52 offen sc1
    s_add_u32 s52, s52, 5248
    buffer_load_dwordx2 v[36:37], v72, s[16:19], s52 offen sc1
    s_add_u32 s52, s52, 5248
    buffer_load_dwordx2 v[38:39], v72, s[16:19], s52 offen sc1
    s_add_u32 s52, s52, 5248
    s_cmp_ge_u32 s33, 1536
    s_cbranch_scc1 p1_o1
    s_lshr_b32 s52, s29, 3
    s_mul_i32 s52, s52, 41600
    s_add_u32 s52, s52, 477822976
    s_mov_b32 s54, 0x05040100
    s_mov_b32 s55, 0x07060302
    s_waitcnt vmcnt(0)
    v_perm_b32 v64, v26, v24, s54
    v_perm_b32 v65, v30, v28, s54
    v_perm_b32 v66, v34, v32, s54
    v_perm_b32 v67, v38, v36, s54
    buffer_store_dwordx4 v[64:67], v73, s[16:19], s52 offen offset:0
    v_perm_b32 v68, v26, v24, s55
    v_perm_b32 v69, v30, v28, s55
    v_perm_b32 v70, v34, v32, s55
    v_perm_b32 v71, v38, v36, s55
    buffer_store_dwordx4 v[68:71], v73, s[16:19], s52 offen offset:1040
    v_perm_b32 v64, v27, v25, s54
    v_perm_b32 v65, v31, v29, s54
    v_perm_b32 v66, v35, v33, s54
    v_perm_b32 v67, v39, v37, s54
    buffer_store_dwordx4 v[64:67], v73, s[16:19], s52 offen offset:2080
    v_perm_b32 v68, v27, v25, s55
    v_perm_b32 v69, v31, v29, s55
    v_perm_b32 v70, v35, v33, s55
    v_perm_b32 v71, v39, v37, s55
    buffer_store_dwordx4 v[68:71], v73, s[16:19], s52 offen offset:3120
    s_mov_b32 s69, 0
p1_o1:
    s_waitcnt lgkmcnt(0)
    s_barrier
    s_cmp_le_u32 s35, 9216
    s_cbranch_scc1 p1_ce1
    v_lshlrev_b32 v117, 2, v119
    v_sub_u32 v117, 113908, v117
    ds_read_b32 v122, v117 offset:49160
    ds_read_b32 v123, v117 offset:49156
    ds_read_b32 v124, v117 offset:49152
    ds_read_b32 v125, v118 offset:38144
    ds_read_b32 v121, v118 offset:38148
    ds_read_b32 v110, v117 offset:36872
    ds_read_b32 v111, v117 offset:36868
    ds_read_b32 v112, v117 offset:36864
    ds_read_b32 v113, v118 offset:41216
    ds_read_b32 v114, v118 offset:41220
    s_waitcnt lgkmcnt(5)
    v_alignbyte_b32 v125, v121, v125, v119
    buffer_store_dwordx4 v[122:125], v120, s[20:23], 0 offen nt
    v_add_u32 v120, 33554432, v120
    s_nop 0
    ds_read_b32 v122, v117 offset:24584
    ds_read_b32 v123, v117 offset:24580
    ds_read_b32 v124, v117 offset:24576
    ds_read_b32 v125, v118 offset:44288
    ds_read_b32 v121, v118 offset:44292
    s_cmp_le_u32 s35, 10240
    s_cbranch_scc1 p1_ce1
    s_waitcnt lgkmcnt(5)
    v_alignbyte_b32 v113, v114, v113, v119
    buffer_store_dwordx4 v[110:113], v120, s[20:23], 0 offen nt
    v_add_u32 v120, 33554432, v120
    s_nop 0
    ds_read_b32 v110, v117 offset:12296
    ds_read_b32 v111, v117 offset:12292
    ds_read_b32 v112, v117 offset:12288
    ds_read_b32 v113, v118 offset:47360
    ds_read_b32 v114, v118 offset:47364
    s_cmp_le_u32 s35, 11264
    s_cbranch_scc1 p1_ce1
    s_waitcnt lgkmcnt(5)
    v_alignbyte_b32 v125, v121, v125, v119
    buffer_store_dwordx4 v[122:125], v120, s[20:23], 0 offen nt
    v_add_u32 v120, 33554432, v120
    s_nop 0
    ds_read_b32 v122, v117 offset:8
    ds_read_b32 v123, v117 offset:4
    ds_read_b32 v124, v117 offset:0
    ds_read_b32 v125, v118 offset:50432
    ds_read_b32 v121, v118 offset:50436
    s_cmp_le_u32 s35, 12288
    s_cbranch_scc1 p1_ce1
    s_waitcnt lgkmcnt(5)
    v_alignbyte_b32 v113, v114, v113, v119
    buffer_store_dwordx4 v[110:113], v120, s[20:23], 0 offen nt
    v_add_u32 v120, 33554432, v120
    s_nop 0
    s_cmp_le_u32 s35, 13312
    s_cbranch_scc1 p1_ce1
    s_waitcnt lgkmcnt(0)
    v_alignbyte_b32 v125, v121, v125, v119
    buffer_store_dwordx4 v[122:125], v120, s[20:23], 0 offen nt
    v_add_u32 v120, 33554432, v120
    s_nop 0
p1_ce1:
    s_waitcnt lgkmcnt(0)
    s_cmp_lg_u32 s69, 8
    s_cbranch_scc1 p1_o2
    s_lshr_b32 s52, s29, 3
    s_mul_i32 s52, s52, 41600
    s_add_u32 s52, s52, 477822976
    s_mov_b32 s54, 0x05040100
    s_mov_b32 s55, 0x07060302
    s_waitcnt vmcnt(0)
    v_perm_b32 v64, v26, v24, s54
    v_perm_b32 v65, v30, v28, s54
    v_perm_b32 v66, v34, v32, s54
    v_perm_b32 v67, v38, v36, s54
    buffer_store_dwordx4 v[64:67], v73, s[16:19], s52 offen offset:0
    v_perm_b32 v68, v26, v24, s55
    v_perm_b32 v69, v30, v28, s55
    v_perm_b32 v70, v34, v32, s55
    v_perm_b32 v71, v38, v36, s55
    buffer_store_dwordx4 v[68:71], v73, s[16:19], s52 offen offset:1040
    v_perm_b32 v64, v27, v25, s54
    v_perm_b32 v65, v31, v29, s54
    v_perm_b32 v66, v35, v33, s54
    v_perm_b32 v67, v39, v37, s54
    buffer_store_dwordx4 v[64:67], v73, s[16:19], s52 offen offset:2080
    v_perm_b32 v68, v27, v25, s55
    v_perm_b32 v69, v31, v29, s55
    v_perm_b32 v70, v35, v33, s55
    v_perm_b32 v71, v39, v37, s55
    buffer_store_dwordx4 v[68:71], v73, s[16:19], s52 offen offset:3120
p1_o2:
    s_barrier
    s_mov_b32 s29, s33
    s_cmp_lt_u32 s29, 1242
    s_cselect_b32 s34, 1, 0
    s_cmp_lt_u32 s29, 1536
    s_cbranch_scc1 p1_tile
p1_end:
    s_endpgm
.globl p2_kernel
.p2align 8
.type p2_kernel,@function
p2_kernel:
    s_cmp_ge_u32 s2, 256
    s_cbranch_scc1 p2_end
    s_load_dwordx2 s[8:9], s[0:1], 104
    v_and_b32 v112, 63, v0
    v_lshrrev_b32 v122, 6, v0
    v_lshlrev_b32 v112, 4, v112
    v_readfirstlane_b32 s10, v122
    v_mov_b32 v113, 0x83ff0000
    s_and_b32 s44, s2, 7
    s_lshr_b32 s11, s44, 1
    s_and_b32 s44, s44, 1
    s_lshl_b32 s12, s44, 5
    s_lshr_b32 s44, s2, 3
    s_add_u32 s12, s12, s44
    s_mov_b32 s25, 54272
    s_mov_b32 s31, 67175170
    s_mov_b32 s32, 83952386
    s_mov_b32 s33, 100729602
    s_mov_b32 s21, 0
    s_mul_i32 s23, s10, 3072
    s_lshl_b32 s24, s10, 9
    s_lshl_b32 s64, s10, 10
    s_sub_u32 s42, s24, s23
    s_add_u32 s42, s42, 49152
    s_movk_i32 s63, 2048
    s_mul_i32 s62, s11, 161280
    s_add_u32 s62, s62, 485810176
    s_add_u32 s62, s62, s23
    s_mov_b32 s40, 477822976
    s_mul_i32 s44, s11, 1040
    s_add_u32 s40, s40, s44
    s_lshl_b32 s44, s12, 4
    s_add_u32 s40, s40, s44
    s_waitcnt lgkmcnt(0)
    s_mov_b32 s4, s8
    s_and_b32 s5, s9, 0xffff
    s_mov_b32 s6, 819200000
    s_mov_b32 s7, 0x20000
    s_mov_b32 s68, s8
    s_and_b32 s69, s9, 0xffff
    s_mov_b32 s70, 469762048
    s_mov_b32 s71, 0x20000
    s_and_b32 s44, s2, 7
    s_lshl_b32 s44, s44, 2
    s_lshr_b32 s18, 0x00000000, s44
    s_and_b32 s18, s18, 15
p2_restart:
    s_mov_b32 s61, 0
    s_add_u32 s44, s61, s18
    s_cmp_ge_u32 s44, 10
    s_cselect_b32 s53, 10, 0
    s_sub_u32 s44, s44, s53
    s_mul_i32 s44, s44, 4160
    s_add_u32 s44, s44, s40
    v_bfe_i32 v111, v112, 6, 1
    v_lshrrev_b32 v110, 6, v112
    v_bitop3_b32 v111, v111, 15, s10 bitop3:0x6a
    v_lshl_or_b32 v110, v110, 4, v111
    v_bfe_u32 v111, v112, 2, 4
    v_mul_u32_u24 v110, 41600, v110
    v_add_u32 v111, v110, v111
    v_add_u32 v110, 256, v112
    v_and_b32 v110, 0x400, v110
    v_lshl_or_b32 v111, v110, 20, v111
    buffer_load_dword v110, v111, s[4:7], s44 offen
    buffer_load_dword v111, v111, s[4:7], s44 offen offset:16
    s_mov_b32 s61, 1
    s_add_u32 s44, s61, s18
    s_cmp_ge_u32 s44, 10
    s_cselect_b32 s53, 10, 0
    s_sub_u32 s44, s44, s53
    s_mul_i32 s44, s44, 4160
    s_add_u32 s44, s44, s40
    v_bfe_i32 v69, v112, 6, 1
    v_lshrrev_b32 v68, 6, v112
    v_bitop3_b32 v69, v69, 15, s10 bitop3:0x6a
    v_lshl_or_b32 v68, v68, 4, v69
    v_bfe_u32 v69, v112, 2, 4
    v_mul_u32_u24 v68, 41600, v68
    v_add_u32 v69, v68, v69
    v_add_u32 v68, 256, v112
    v_and_b32 v68, 0x400, v68
    v_lshl_or_b32 v69, v68, 20, v69
    buffer_load_dword v68, v69, s[4:7], s44 offen
    buffer_load_dword v69, v69, s[4:7], s44 offen offset:16
    s_mov_b32 s61, 0
    s_cmp_lt_u32 s10, 15
    s_cselect_b32 s44, s64, 0x40000000
    v_add_u32 v60, s44, v112
    s_mov_b32 s44, 492261376
    buffer_load_dwordx4 v[60:63], v60, s[4:7], s44 offen
    s_mul_i32 s20, s18, 645120
    s_add_u32 s20, s20, s62
    s_cmp_ge_u32 s10, 9
    s_cbranch_scc1 p2_nmp
    v_lshrrev_b32 v84, 1, v112
    s_add_u32 s44, s20, s42
    buffer_load_dwordx2 v[84:85], v84, s[4:7], s44 offen
p2_nmp:
    buffer_load_dwordx4 v[72:75], v112, s[4:7], s20 offen offset:0
    buffer_load_dwordx4 v[76:79], v112, s[4:7], s20 offen offset:1024
    buffer_load_dwordx4 v[80:83], v112, s[4:7], s20 offen offset:2048
    s_barrier
    v_mov_b32 v115, 0
    v_mov_b32 v116, 0
    v_mov_b32 v117, 0
    v_mov_b32 v118, 0
    v_mov_b32 v119, 0
    v_mov_b32 v120, 0
    v_mov_b32 v121, 0
    ds_write_b128 v115, v[116:119] offset:53760
    s_mov_b32 s19, 0
    s_cmp_eq_u32 s21, 2
    s_cselect_b64 s[66:67], -1, 0
    s_waitcnt lgkmcnt(0)
    s_barrier
    s_waitcnt vmcnt(6)
    s_mov_b32 m0, s23
    v_mov_b32 v53, 0x3c000
    s_movk_i32 s44, 512
    v_sub_u32_sdwa v4, v111, v110 dst_sel:DWORD dst_unused:UNUSED_PAD src0_sel:WORD_0 src1_sel:WORD_0
    v_sub_u32_sdwa v5, v111, v110 dst_sel:DWORD dst_unused:UNUSED_PAD src0_sel:WORD_1 src1_sel:WORD_1
    v_med3_i32 v4, v4, 0, s44
    v_med3_i32 v5, v5, 0, s44
    v_add_u32 v48, v4, v5
    ds_write_addtid_b32 v53 offset:0
    ds_write_addtid_b32 v53 offset:256
    ds_write_addtid_b32 v53 offset:512
    ds_write_addtid_b32 v53 offset:768
    ds_write_addtid_b32 v53 offset:1024
    ds_write_addtid_b32 v53 offset:1280
    ds_write_addtid_b32 v53 offset:1536
    ds_write_addtid_b32 v53 offset:1792
    v_bfe_i32 v53, v112, 6, 1
    v_lshrrev_b32 v49, 6, v112
    v_bitop3_b32 v53, v53, 15, s10 bitop3:0x6a
    v_lshl_or_b32 v49, v49, 4, v53
    v_and_b32 v53, 0x30, v112
    v_lshl_or_b32 v53, v49, 6, v53
    v_lshlrev_b32 v53, 15, v53
    s_nop 1
    v_add_u32_dpp v48, v48, v48 row_shr:1 row_mask:0xf bank_mask:0xf bound_ctrl:0
    s_nop 1
    v_add_u32_dpp v48, v48, v48 row_shr:2 row_mask:0xf bank_mask:0xf bound_ctrl:0
    s_nop 1
    v_add_u32_dpp v48, v48, v48 row_shr:4 row_mask:0xf bank_mask:0xf bound_ctrl:0
    s_nop 1
    v_add_u32_dpp v48, v48, v48 row_shr:8 row_mask:0xf bank_mask:0xf bound_ctrl:0
    s_nop 1
    v_add_u32_dpp v48, v48, v48 row_bcast:15 row_mask:0xa bank_mask:0xf
    s_nop 1
    v_add_u32_dpp v48, v48, v48 row_bcast:31 row_mask:0xc bank_mask:0xf
    s_nop 1
    s_nop 0
    v_readlane_b32 s38, v48, 63
    v_sub_u32 v50, v48, v5
    v_sub_u32 v49, v50, v4
    v_sub_u32 v10, 512, v49
    v_mad_u32_u16 v51, v110, 16, v53
    v_med3_i32 v10, v10, 0, v4
    v_lshl_add_u32 v49, v49, 2, s23
    v_sub_u32 v11, 512, v50
    v_mad_u32_u16 v52, v110, 16, v53 op_sel:[1,0,0,0]
    v_med3_i32 v11, v11, 0, v5
    v_lshl_add_u32 v50, v50, 2, s23
    v_lshl_add_u32 v48, v11, 16, v10
    v_add_u32 v52, 262144, v52
    v_add_u32 v110, v110, v48
    s_min_u32 s17, s38, 512
    s_add_u32 s17, s17, 63
    s_lshr_b32 s17, s17, 6
p2_xa_0:
    v_cmpx_lt_i32 vcc, 0, v10
    s_cbranch_execz p2_ya_0
    ds_write_b32 v49, v51 offset:0
    v_add_u32 v51, 16, v51
    v_cmpx_lt_i32 vcc, 1, v10
    s_cbranch_execz p2_ya_0
    ds_write_b32 v49, v51 offset:4
    v_add_u32 v51, 16, v51
    v_cmpx_lt_i32 vcc, 2, v10
    s_cbranch_execz p2_ya_0
    ds_write_b32 v49, v51 offset:8
    v_add_u32 v51, 16, v51
    v_cmpx_lt_i32 vcc, 3, v10
    s_cbranch_execz p2_ya_0
    ds_write_b32 v49, v51 offset:12
    v_add_u32 v51, 16, v51
    v_cmpx_lt_i32 vcc, 4, v10
    s_cbranch_execz p2_ya_0
    ds_write_b32 v49, v51 offset:16
    v_add_u32 v51, 16, v51
    v_cmpx_lt_i32 vcc, 5, v10
    s_cbranch_execz p2_ya_0
    ds_write_b32 v49, v51 offset:20
    v_add_u32 v51, 16, v51
    v_cmpx_lt_i32 vcc, 6, v10
    s_cbranch_execz p2_ya_0
    ds_write_b32 v49, v51 offset:24
    v_add_u32 v51, 16, v51
    v_cmpx_lt_i32 vcc, 7, v10
    s_cbranch_execz p2_ya_0
    ds_write_b32 v49, v51 offset:28
    v_add_u32 v51, 16, v51
    v_subrev_u32 v10, 8, v10
    v_add_u32 v49, 32, v49
    s_branch p2_xa_0
p2_ya_0:
    s_mov_b64 exec, -1
p2_xa_1:
    v_cmpx_lt_i32 vcc, 0, v11
    s_cbranch_execz p2_ya_1
    ds_write_b32 v50, v52 offset:0
    v_add_u32 v52, 16, v52
    v_cmpx_lt_i32 vcc, 1, v11
    s_cbranch_execz p2_ya_1
    ds_write_b32 v50, v52 offset:4
    v_add_u32 v52, 16, v52
    v_cmpx_lt_i32 vcc, 2, v11
    s_cbranch_execz p2_ya_1
    ds_write_b32 v50, v52 offset:8
    v_add_u32 v52, 16, v52
    v_cmpx_lt_i32 vcc, 3, v11
    s_cbranch_execz p2_ya_1
    ds_write_b32 v50, v52 offset:12
    v_add_u32 v52, 16, v52
    v_cmpx_lt_i32 vcc, 4, v11
    s_cbranch_execz p2_ya_1
    ds_write_b32 v50, v52 offset:16
    v_add_u32 v52, 16, v52
    v_cmpx_lt_i32 vcc, 5, v11
    s_cbranch_execz p2_ya_1
    ds_write_b32 v50, v52 offset:20
    v_add_u32 v52, 16, v52
    v_cmpx_lt_i32 vcc, 6, v11
    s_cbranch_execz p2_ya_1
    ds_write_b32 v50, v52 offset:24
    v_add_u32 v52, 16, v52
    v_cmpx_lt_i32 vcc, 7, v11
    s_cbranch_execz p2_ya_1
    ds_write_b32 v50, v52 offset:28
    v_add_u32 v52, 16, v52
    v_subrev_u32 v11, 8, v11
    v_add_u32 v50, 32, v50
    s_branch p2_xa_1
p2_ya_1:
    s_mov_b64 exec, -1
    s_cmp_lt_u32 s38, 512
    s_cbranch_scc1 p2_nomorea
    v_cmp_lt_u32_sdwa s[44:45], v110, v111 src0_sel:WORD_0 src1_sel:WORD_0
    v_cmp_lt_u32_sdwa s[46:47], v110, v111 src0_sel:WORD_1 src1_sel:WORD_1
    s_nop 0
    s_or_b64 s[44:45], s[44:45], s[46:47]
    s_cbranch_scc0 p2_nomorea
    v_mov_b32 v49, s19
    v_mov_b32 v50, 1
    ds_write_b32 v49, v50 offset:53760
p2_nomorea:
    s_mov_b32 m0, s23
    s_nop 0
    ds_read_addtid_b32 v2 offset:0
    ds_read_addtid_b32 v8 offset:256
    ds_read_addtid_b32 v14 offset:512
    ds_read_addtid_b32 v20 offset:768
    ds_read_addtid_b32 v88 offset:1024
    ds_read_addtid_b32 v92 offset:1280
    ds_read_addtid_b32 v96 offset:1536
    ds_read_addtid_b32 v100 offset:1792
    s_waitcnt lgkmcnt(0)
    v_bfe_u32 v0, v2, 14, 4
    v_lshrrev_b32 v1, 18, v2
    v_and_b32 v2, 0x3fff, v2
    v_mad_u32_u24 v0, v0, s63, v1
    v_lshl_or_b32 v2, v0, 14, v2
    buffer_load_dwordx4 v[0:3], v2, s[68:71], 0 offen
    v_bfe_u32 v6, v8, 14, 4
    v_lshrrev_b32 v7, 18, v8
    v_and_b32 v8, 0x3fff, v8
    v_mad_u32_u24 v6, v6, s63, v7
    v_lshl_or_b32 v8, v6, 14, v8
    buffer_load_dwordx4 v[6:9], v8, s[68:71], 0 offen
    s_cmp_eq_u32 s21, 0
    s_cselect_b32 s44, 1073758208, 0
    v_mov_b32 v124, s44
    v_mov_b32 v125, s44
    v_mov_b32 v126, s44
    v_mov_b32 v127, s44
    v_add_u32 v123, s64, v112
    v_add_u32 v122, s25, v123
    ds_write_b128 v122, v[124:127] offset:0
    ds_write_b128 v122, v[124:127] offset:16384
    ds_write_b128 v122, v[124:127] offset:32768
    v_add_u32 v122, 49152, v122
    ds_write_b128 v122, v[124:127] offset:0
    ds_write_b128 v122, v[124:127] offset:16384
    ds_write_b128 v122, v[124:127] offset:32768
    v_cmpx_gt_u32 vcc, 1792, v123
    ds_write_b128 v122, v[124:127] offset:49152
    s_mov_b64 exec, -1
    v_bfe_u32 v12, v14, 14, 4
    v_lshrrev_b32 v13, 18, v14
    v_and_b32 v14, 0x3fff, v14
    v_mad_u32_u24 v12, v12, s63, v13
    v_lshl_or_b32 v14, v12, 14, v14
    buffer_load_dwordx4 v[12:15], v14, s[68:71], 0 offen
    s_mov_b32 s16, s17
    s_waitcnt vmcnt(6)
    s_cmp_lg_u32 s21, 0
    s_cbranch_scc1 p2_nostat1
    v_max_u32 v60, v60, v62
    v_add_f32 v61, v61, v63
    s_nop 1
    v_max_u32_dpp v60, v60, v60 row_shr:1 row_mask:0xf bank_mask:0xf bound_ctrl:0
    v_add_f32_dpp v61, v61, v61 row_shr:1 row_mask:0xf bank_mask:0xf bound_ctrl:0
    s_nop 0
    v_max_u32_dpp v60, v60, v60 row_shr:2 row_mask:0xf bank_mask:0xf bound_ctrl:0
    v_add_f32_dpp v61, v61, v61 row_shr:2 row_mask:0xf bank_mask:0xf bound_ctrl:0
    s_nop 0
    v_max_u32_dpp v60, v60, v60 row_shr:4 row_mask:0xf bank_mask:0xf bound_ctrl:0
    v_add_f32_dpp v61, v61, v61 row_shr:4 row_mask:0xf bank_mask:0xf bound_ctrl:0
    s_nop 0
    v_max_u32_dpp v60, v60, v60 row_shr:8 row_mask:0xf bank_mask:0xf bound_ctrl:0
    v_add_f32_dpp v61, v61, v61 row_shr:8 row_mask:0xf bank_mask:0xf bound_ctrl:0
    s_nop 0
    v_max_u32_dpp v60, v60, v60 row_bcast:15 row_mask:0xa bank_mask:0xf
    v_add_f32_dpp v61, v61, v61 row_bcast:15 row_mask:0xa bank_mask:0xf
    s_nop 0
    v_max_u32_dpp v60, v60, v60 row_bcast:31 row_mask:0xc bank_mask:0xf
    v_add_f32_dpp v61, v61, v61 row_bcast:31 row_mask:0xc bank_mask:0xf
    s_nop 0
    s_nop 0
    s_lshl_b32 s44, s10, 3
    v_mov_b32 v62, s44
    s_mov_b64 exec, 1
    s_lshl_b64 exec, exec, 63
    ds_write_b64 v62, v[60:61] offset:53824
    s_mov_b64 exec, -1
p2_nostat1:
    s_waitcnt lgkmcnt(0)
    s_barrier
    v_bfe_u32 v18, v20, 14, 4
    v_lshrrev_b32 v19, 18, v20
    v_and_b32 v20, 0x3fff, v20
    v_mad_u32_u24 v18, v18, s63, v19
    v_lshl_or_b32 v20, v18, 14, v20
    buffer_load_dwordx4 v[18:21], v20, s[68:71], 0 offen
    v_mov_b32 v122, s19
    s_xor_b32 s19, s19, 4
    ds_read_b32 v125, v122 offset:53760
    s_cmp_lg_u32 s21, 0
    s_cbranch_scc1 p2_nostat2
    v_bfe_u32 v62, v112, 1, 7
    ds_read_b64 v[60:61], v62 offset:53824
    s_waitcnt lgkmcnt(0)
    s_nop 1
    v_max_u32_dpp v60, v60, v60 row_shr:1 row_mask:0xf bank_mask:0xf bound_ctrl:0
    v_add_f32_dpp v61, v61, v61 row_shr:1 row_mask:0xf bank_mask:0xf bound_ctrl:0
    s_nop 0
    v_max_u32_dpp v60, v60, v60 row_shr:2 row_mask:0xf bank_mask:0xf bound_ctrl:0
    v_add_f32_dpp v61, v61, v61 row_shr:2 row_mask:0xf bank_mask:0xf bound_ctrl:0
    s_nop 0
    v_max_u32_dpp v60, v60, v60 row_shr:4 row_mask:0xf bank_mask:0xf bound_ctrl:0
    v_add_f32_dpp v61, v61, v61 row_shr:4 row_mask:0xf bank_mask:0xf bound_ctrl:0
    s_nop 0
    v_max_u32_dpp v60, v60, v60 row_shr:8 row_mask:0xf bank_mask:0xf bound_ctrl:0
    v_add_f32_dpp v61, v61, v61 row_shr:8 row_mask:0xf bank_mask:0xf bound_ctrl:0
    s_nop 0
    v_max_u32_dpp v60, v60, v60 row_bcast:15 row_mask:0xa bank_mask:0xf
    v_add_f32_dpp v61, v61, v61 row_bcast:15 row_mask:0xa bank_mask:0xf
    s_nop 0
    v_max_u32_dpp v60, v60, v60 row_bcast:31 row_mask:0xc bank_mask:0xf
    v_add_f32_dpp v61, v61, v61 row_bcast:31 row_mask:0xc bank_mask:0xf
    s_nop 0
    s_nop 0
    v_readlane_b32 s44, v60, 15
    v_readlane_b32 s45, v61, 15
    s_nop 1
    s_lshl_b32 s44, s44, 16
    s_lshr_b32 s46, s44, 23
    s_sub_u32 s47, s46, 80
    s_cmp_lt_u32 s47, 100
    s_cselect_b32 s21, 0, 1
    v_mov_b32 v60, s45
    v_mul_f32 v60, 0x34a7c5ac, v60
    v_sqrt_f32 v60, v60
    v_mov_b32 v61, s44
    v_mul_f32 v62, 0x41800000, v60
    v_cmp_nle_f32 vcc, v61, v62
    v_mul_f32 v60, 0x3ac00000, v60
    v_mul_f32 v61, 0x3901742e, v61
    v_max_f32 v60, v60, v61
    s_cmp_lg_u64 vcc, 0
    s_cselect_b32 s21, 1, s21
    v_readfirstlane_b32 s44, v60
    s_nop 0
    s_and_b32 s47, s44, 0x7fffff
    s_or_b32 s47, s47, 0x3f000000
    s_and_b32 s48, s44, 0x7f800000
    s_add_u32 s48, s48, 0x800000
    v_rcp_f32 v60, s47
    s_nop 0
    v_rcp_f32 v61, v60
    v_mul_f32 v60, 0x7b800000, v60
    v_mul_f32 v61, s48, v61
    s_nop 0
    v_readfirstlane_b32 s26, v60
    v_readfirstlane_b32 s30, v61
    s_add_u32 s34, s48, 197132288
    s_mov_b32 s35, s34
    s_sub_u32 s36, 0, s34
    s_subb_u32 s37, 0, s34
    s_cmp_eq_u32 s21, 0
    s_cbranch_scc1 p2_nostat2
    s_waitcnt vmcnt(0) lgkmcnt(0)
    s_branch p2_restart
p2_nostat2:
    s_cmp_eq_u32 s21, 0
    s_cselect_b32 s26, s26, 0x7b800000
    v_mov_b32 v114, s26
    s_waitcnt lgkmcnt(0)
    v_readfirstlane_b32 s44, v125
    s_nop 0
    s_cmp_lg_u32 s44, 0
    s_cbranch_scc1 p2_adva
    s_mov_b32 s61, 1
    v_mov_b32 v110, v68
    v_mov_b32 v111, v69
p2_adva:
    v_bfe_u32 v86, v88, 14, 4
    v_lshrrev_b32 v87, 18, v88
    v_and_b32 v88, 0x3fff, v88
    v_mad_u32_u24 v86, v86, s63, v87
    v_lshl_or_b32 v88, v86, 14, v88
    buffer_load_dwordx4 v[86:89], v88, s[68:71], 0 offen
    s_mov_b32 m0, s23
    v_mov_b32 v53, 0x3c000
    s_movk_i32 s44, 512
    v_sub_u32_sdwa v4, v111, v110 dst_sel:DWORD dst_unused:UNUSED_PAD src0_sel:WORD_0 src1_sel:WORD_0
    v_sub_u32_sdwa v5, v111, v110 dst_sel:DWORD dst_unused:UNUSED_PAD src0_sel:WORD_1 src1_sel:WORD_1
    v_med3_i32 v4, v4, 0, s44
    v_med3_i32 v5, v5, 0, s44
    v_add_u32 v48, v4, v5
    ds_write_addtid_b32 v53 offset:0
    ds_write_addtid_b32 v53 offset:256
    ds_write_addtid_b32 v53 offset:512
    ds_write_addtid_b32 v53 offset:768
    ds_write_addtid_b32 v53 offset:1024
    ds_write_addtid_b32 v53 offset:1280
    ds_write_addtid_b32 v53 offset:1536
    ds_write_addtid_b32 v53 offset:1792
    v_bfe_i32 v53, v112, 6, 1
    v_lshrrev_b32 v49, 6, v112
    v_bitop3_b32 v53, v53, 15, s10 bitop3:0x6a
    v_lshl_or_b32 v49, v49, 4, v53
    v_and_b32 v53, 0x30, v112
    v_lshl_or_b32 v53, v49, 6, v53
    v_lshlrev_b32 v53, 15, v53
    s_nop 1
    v_add_u32_dpp v48, v48, v48 row_shr:1 row_mask:0xf bank_mask:0xf bound_ctrl:0
    s_nop 1
    v_add_u32_dpp v48, v48, v48 row_shr:2 row_mask:0xf bank_mask:0xf bound_ctrl:0
    s_nop 1
    v_add_u32_dpp v48, v48, v48 row_shr:4 row_mask:0xf bank_mask:0xf bound_ctrl:0
    s_nop 1
    v_add_u32_dpp v48, v48, v48 row_shr:8 row_mask:0xf bank_mask:0xf bound_ctrl:0
    s_nop 1
    v_add_u32_dpp v48, v48, v48 row_bcast:15 row_mask:0xa bank_mask:0xf
    s_nop 1
    v_add_u32_dpp v48, v48, v48 row_bcast:31 row_mask:0xc bank_mask:0xf
    s_nop 1
    s_nop 0
    v_readlane_b32 s38, v48, 63
    v_sub_u32 v50, v48, v5
    v_sub_u32 v49, v50, v4
    v_sub_u32 v10, 512, v49
    v_mad_u32_u16 v51, v110, 16, v53
    v_med3_i32 v10, v10, 0, v4
    v_lshl_add_u32 v49, v49, 2, s23
    v_sub_u32 v11, 512, v50
    v_mad_u32_u16 v52, v110, 16, v53 op_sel:[1,0,0,0]
    v_med3_i32 v11, v11, 0, v5
    v_lshl_add_u32 v50, v50, 2, s23
    v_lshl_add_u32 v48, v11, 16, v10
    v_add_u32 v52, 262144, v52
    v_add_u32 v110, v110, v48
    s_min_u32 s17, s38, 512
    s_add_u32 s17, s17, 63
    s_lshr_b32 s17, s17, 6
p2_xb_0:
    v_cmpx_lt_i32 vcc, 0, v10
    s_cbranch_execz p2_yb_0
    ds_write_b32 v49, v51 offset:0
    v_add_u32 v51, 16, v51
    v_cmpx_lt_i32 vcc, 1, v10
    s_cbranch_execz p2_yb_0
    ds_write_b32 v49, v51 offset:4
    v_add_u32 v51, 16, v51
    v_cmpx_lt_i32 vcc, 2, v10
    s_cbranch_execz p2_yb_0
    ds_write_b32 v49, v51 offset:8
    v_add_u32 v51, 16, v51
    v_cmpx_lt_i32 vcc, 3, v10
    s_cbranch_execz p2_yb_0
    ds_write_b32 v49, v51 offset:12
    v_add_u32 v51, 16, v51
    v_cmpx_lt_i32 vcc, 4, v10
    s_cbranch_execz p2_yb_0
    ds_write_b32 v49, v51 offset:16
    v_add_u32 v51, 16, v51
    v_cmpx_lt_i32 vcc, 5, v10
    s_cbranch_execz p2_yb_0
    ds_write_b32 v49, v51 offset:20
    v_add_u32 v51, 16, v51
    v_cmpx_lt_i32 vcc, 6, v10
    s_cbranch_execz p2_yb_0
    ds_write_b32 v49, v51 offset:24
    v_add_u32 v51, 16, v51
    v_cmpx_lt_i32 vcc, 7, v10
    s_cbranch_execz p2_yb_0
    ds_write_b32 v49, v51 offset:28
    v_add_u32 v51, 16, v51
    v_subrev_u32 v10, 8, v10
    v_add_u32 v49, 32, v49
    s_branch p2_xb_0
p2_yb_0:
    s_mov_b64 exec, -1
p2_xb_1:
    v_cmpx_lt_i32 vcc, 0, v11
    s_cbranch_execz p2_yb_1
    ds_write_b32 v50, v52 offset:0
    v_add_u32 v52, 16, v52
    v_cmpx_lt_i32 vcc, 1, v11
    s_cbranch_execz p2_yb_1
    ds_write_b32 v50, v52 offset:4
    v_add_u32 v52, 16, v52
    v_cmpx_lt_i32 vcc, 2, v11
    s_cbranch_execz p2_yb_1
    ds_write_b32 v50, v52 offset:8
    v_add_u32 v52, 16, v52
    v_cmpx_lt_i32 vcc, 3, v11
    s_cbranch_execz p2_yb_1
    ds_write_b32 v50, v52 offset:12
    v_add_u32 v52, 16, v52
    v_cmpx_lt_i32 vcc, 4, v11
    s_cbranch_execz p2_yb_1
    ds_write_b32 v50, v52 offset:16
    v_add_u32 v52, 16, v52
    v_cmpx_lt_i32 vcc, 5, v11
    s_cbranch_execz p2_yb_1
    ds_write_b32 v50, v52 offset:20
    v_add_u32 v52, 16, v52
    v_cmpx_lt_i32 vcc, 6, v11
    s_cbranch_execz p2_yb_1
    ds_write_b32 v50, v52 offset:24
    v_add_u32 v52, 16, v52
    v_cmpx_lt_i32 vcc, 7, v11
    s_cbranch_execz p2_yb_1
    ds_write_b32 v50, v52 offset:28
    v_add_u32 v52, 16, v52
    v_subrev_u32 v11, 8, v11
    v_add_u32 v50, 32, v50
    s_branch p2_xb_1
p2_yb_1:
    s_mov_b64 exec, -1
    s_cmp_lt_u32 s38, 512
    s_cbranch_scc1 p2_nomoreb
    v_cmp_lt_u32_sdwa s[44:45], v110, v111 src0_sel:WORD_0 src1_sel:WORD_0
    v_cmp_lt_u32_sdwa s[46:47], v110, v111 src0_sel:WORD_1 src1_sel:WORD_1
    s_nop 0
    s_or_b64 s[44:45], s[44:45], s[46:47]
    s_cbranch_scc0 p2_nomoreb
    v_mov_b32 v49, s19
    v_mov_b32 v50, 1
    ds_write_b32 v49, v50 offset:53760
p2_nomoreb:
    s_mov_b32 m0, s23
    s_nop 0
    ds_read_addtid_b32 v102 offset:0
    ds_read_addtid_b32 v103 offset:256
    ds_read_addtid_b32 v104 offset:512
    ds_read_addtid_b32 v105 offset:768
    ds_read_addtid_b32 v106 offset:1024
    ds_read_addtid_b32 v107 offset:1280
    ds_read_addtid_b32 v108 offset:1536
    ds_read_addtid_b32 v109 offset:1792
    v_bfe_u32 v90, v92, 14, 4
    v_lshrrev_b32 v91, 18, v92
    v_and_b32 v92, 0x3fff, v92
    v_mad_u32_u24 v90, v90, s63, v91
    v_lshl_or_b32 v92, v90, 14, v92
    buffer_load_dwordx4 v[90:93], v92, s[68:71], 0 offen
    s_waitcnt vmcnt(6)
    s_mov_b32 m0, s24
    s_cmp_ge_u32 s10, 9
    s_cbranch_scc1 p2_stp
    ds_write_addtid_b32 v84 offset:49152
    ds_write_addtid_b32 v85 offset:49408
p2_stp:
    s_mov_b32 m0, s23
    s_add_u32 s20, s20, 53760
    ds_write_addtid_b32 v72 offset:0
    ds_write_addtid_b32 v73 offset:256
    ds_write_addtid_b32 v74 offset:512
    ds_write_addtid_b32 v75 offset:768
    ds_write_addtid_b32 v76 offset:1024
    ds_write_addtid_b32 v77 offset:1280
    ds_write_addtid_b32 v78 offset:1536
    ds_write_addtid_b32 v79 offset:1792
    ds_write_addtid_b32 v80 offset:2048
    ds_write_addtid_b32 v81 offset:2304
    ds_write_addtid_b32 v82 offset:2560
    ds_write_addtid_b32 v83 offset:2816
    s_waitcnt lgkmcnt(0)
    s_barrier
    v_bfe_u32 v94, v96, 14, 4
    v_lshrrev_b32 v95, 18, v96
    v_and_b32 v96, 0x3fff, v96
    v_mad_u32_u24 v94, v94, s63, v95
    v_lshl_or_b32 v96, v94, 14, v96
    buffer_load_dwordx4 v[94:97], v96, s[68:71], 0 offen
    v_bfe_u32 v98, v100, 14, 4
    v_lshrrev_b32 v99, 18, v100
    v_and_b32 v100, 0x3fff, v100
    v_mad_u32_u24 v98, v98, s63, v99
    v_lshl_or_b32 v100, v98, 14, v100
    buffer_load_dwordx4 v[98:101], v100, s[68:71], 0 offen
    s_cmp_ge_u32 s10, 9
    s_cbranch_scc1 p2_nmq
    v_lshrrev_b32 v84, 1, v112
    s_add_u32 s44, s20, s42
    buffer_load_dwordx2 v[84:85], v84, s[4:7], s44 offen
p2_nmq:
    buffer_load_dwordx4 v[72:75], v112, s[4:7], s20 offen offset:0
    buffer_load_dwordx4 v[76:79], v112, s[4:7], s20 offen offset:1024
    buffer_load_dwordx4 v[80:83], v112, s[4:7], s20 offen offset:2048
    s_waitcnt vmcnt(10)
    v_perm_b32 v48, v3, v0, s31
    v_perm_b32 v49, v3, v1, s32
    v_perm_b32 v50, v3, v2, s33
    v_lshlrev_b16 v4, 3, v2
    v_lshlrev_b16 v2, 3, v1
    v_lshlrev_b16 v0, 3, v0
    v_cmpx_ge_u16 vcc, 0x3fff, v48
    ds_read_b64 v[0:1], v0
    s_mov_b64 exec, -1
    v_cmpx_ge_u16 vcc, 0x3fff, v49
    ds_read_b64 v[2:3], v2
    s_mov_b64 exec, -1
    v_cmpx_ge_u16 vcc, 0x3fff, v50
    ds_read_b64 v[4:5], v4
    s_mov_b64 exec, -1
    s_waitcnt vmcnt(9)
    v_perm_b32 v51, v9, v6, s31
    v_perm_b32 v52, v9, v7, s32
    v_perm_b32 v53, v9, v8, s33
    v_lshlrev_b16 v10, 3, v8
    v_lshlrev_b16 v8, 3, v7
    v_lshlrev_b16 v6, 3, v6
    v_cmpx_ge_u16 vcc, 0x3fff, v51
    ds_read_b64 v[6:7], v6
    s_mov_b64 exec, -1
    v_cmpx_ge_u16 vcc, 0x3fff, v52
    ds_read_b64 v[8:9], v8
    s_mov_b64 exec, -1
    v_cmpx_ge_u16 vcc, 0x3fff, v53
    ds_read_b64 v[10:11], v10
    s_mov_b64 exec, -1
    s_waitcnt vmcnt(8)
    v_perm_b32 v54, v15, v12, s31
    v_perm_b32 v55, v15, v13, s32
    v_perm_b32 v56, v15, v14, s33
    v_lshlrev_b16 v16, 3, v14
    v_lshlrev_b16 v14, 3, v13
    v_lshlrev_b16 v12, 3, v12
    v_cmpx_ge_u16 vcc, 0x3fff, v54
    ds_read_b64 v[12:13], v12
    s_mov_b64 exec, -1
    v_cmpx_ge_u16 vcc, 0x3fff, v55
    ds_read_b64 v[14:15], v14
    s_mov_b64 exec, -1
    v_cmpx_ge_u16 vcc, 0x3fff, v56
    ds_read_b64 v[16:17], v16
    s_mov_b64 exec, -1
    s_waitcnt vmcnt(7)
    v_perm_b32 v57, v21, v18, s31
    v_perm_b32 v58, v21, v19, s32
    v_perm_b32 v59, v21, v20, s33
    v_lshlrev_b16 v22, 3, v20
    v_lshlrev_b16 v20, 3, v19
    v_lshlrev_b16 v18, 3, v18
    v_cmpx_ge_u16 vcc, 0x3fff, v57
    ds_read_b64 v[18:19], v18
    s_mov_b64 exec, -1
    v_cmpx_ge_u16 vcc, 0x3fff, v58
    ds_read_b64 v[20:21], v20
    s_mov_b64 exec, -1
    v_cmpx_ge_u16 vcc, 0x3fff, v59
    ds_read_b64 v[22:23], v22
    s_mov_b64 exec, -1
    s_waitcnt vmcnt(6)
    v_perm_b32 v60, v89, v86, s31
    v_perm_b32 v61, v89, v87, s32
    v_perm_b32 v62, v89, v88, s33
    v_lshlrev_b16 v28, 3, v88
    v_lshlrev_b16 v26, 3, v87
    v_lshlrev_b16 v24, 3, v86
    v_cmpx_ge_u16 vcc, 0x3fff, v60
    ds_read_b64 v[24:25], v24
    s_mov_b64 exec, -1
    v_cmpx_ge_u16 vcc, 0x3fff, v61
    ds_read_b64 v[26:27], v26
    s_mov_b64 exec, -1
    v_cmpx_ge_u16 vcc, 0x3fff, v62
    ds_read_b64 v[28:29], v28
    s_mov_b64 exec, -1
    v_bfe_u32 v86, v106, 14, 4
    v_lshrrev_b32 v87, 18, v106
    v_and_b32 v106, 0x3fff, v106
    v_mad_u32_u24 v86, v86, s63, v87
    v_lshl_or_b32 v106, v86, 14, v106
    buffer_load_dwordx4 v[86:89], v106, s[68:71], 0 offen
    s_waitcnt vmcnt(6)
    v_perm_b32 v63, v93, v90, s31
    v_perm_b32 v64, v93, v91, s32
    v_perm_b32 v65, v93, v92, s33
    v_lshlrev_b16 v34, 3, v92
    v_lshlrev_b16 v32, 3, v91
    v_lshlrev_b16 v30, 3, v90
    v_cmpx_ge_u16 vcc, 0x3fff, v63
    ds_read_b64 v[30:31], v30
    s_mov_b64 exec, -1
    v_cmpx_ge_u16 vcc, 0x3fff, v64
    ds_read_b64 v[32:33], v32
    s_mov_b64 exec, -1
    v_cmpx_ge_u16 vcc, 0x3fff, v65
    ds_read_b64 v[34:35], v34
    s_mov_b64 exec, -1
    v_bfe_u32 v90, v107, 14, 4
    v_lshrrev_b32 v91, 18, v107
    v_and_b32 v107, 0x3fff, v107
    v_mad_u32_u24 v90, v90, s63, v91
    v_lshl_or_b32 v107, v90, 14, v107
    buffer_load_dwordx4 v[90:93], v107, s[68:71], 0 offen
    s_waitcnt vmcnt(6)
    v_perm_b32 v66, v97, v94, s31
    v_perm_b32 v67, v97, v95, s32
    v_perm_b32 v68, v97, v96, s33
    v_lshlrev_b16 v40, 3, v96
    v_lshlrev_b16 v38, 3, v95
    v_lshlrev_b16 v36, 3, v94
    v_cmpx_ge_u16 vcc, 0x3fff, v66
    ds_read_b64 v[36:37], v36
    s_mov_b64 exec, -1
    v_cmpx_ge_u16 vcc, 0x3fff, v67
    ds_read_b64 v[38:39], v38
    s_mov_b64 exec, -1
    v_cmpx_ge_u16 vcc, 0x3fff, v68
    ds_read_b64 v[40:41], v40
    s_mov_b64 exec, -1
    s_waitcnt vmcnt(5)
    v_perm_b32 v69, v101, v98, s31
    v_perm_b32 v70, v101, v99, s32
    v_perm_b32 v71, v101, v100, s33
    v_lshlrev_b16 v46, 3, v100
    v_lshlrev_b16 v44, 3, v99
    v_lshlrev_b16 v42, 3, v98
    s_cmp_le_u32 s16, 7
    s_cbranch_scc1 p2_gp
    v_cmpx_ge_u16 vcc, 0x3fff, v69
    ds_read_b64 v[42:43], v42
    s_mov_b64 exec, -1
    v_cmpx_ge_u16 vcc, 0x3fff, v70
    ds_read_b64 v[44:45], v44
    s_mov_b64 exec, -1
    v_cmpx_ge_u16 vcc, 0x3fff, v71
    ds_read_b64 v[46:47], v46
    s_mov_b64 exec, -1
p2_gp:
    s_waitcnt lgkmcnt(0)
    s_barrier
    s_branch p2_tail
p2_top:
    s_cmp_lg_u32 s21, 0
    s_cbranch_scc1 p2_topf
    s_cmp_eq_u32 s60, 10
    s_cbranch_scc1 p2_drain0
    v_cmpx_gt_i16 vcc, 0, v48
    ds_read_b64 v[0:1], v0
    s_mov_b64 exec, -1
    v_cmpx_gt_i16 vcc, 0, v49
    ds_read_b64 v[2:3], v2
    s_mov_b64 exec, -1
    v_cmpx_gt_i16 vcc, 0, v50
    ds_read_b64 v[4:5], v4
    s_mov_b64 exec, -1
    v_cmpx_gt_i16 vcc, 0, v51
    ds_read_b64 v[6:7], v6
    s_mov_b64 exec, -1
    v_cmpx_gt_i16 vcc, 0, v52
    ds_read_b64 v[8:9], v8
    s_mov_b64 exec, -1
    v_cmpx_gt_i16 vcc, 0, v53
    ds_read_b64 v[10:11], v10
    s_mov_b64 exec, -1
    v_cmpx_gt_i16 vcc, 0, v54
    ds_read_b64 v[12:13], v12
    s_mov_b64 exec, -1
    v_cmpx_gt_i16 vcc, 0, v55
    ds_read_b64 v[14:15], v14
    s_mov_b64 exec, -1
    v_cmpx_gt_i16 vcc, 0, v56
    ds_read_b64 v[16:17], v16
    s_mov_b64 exec, -1
    v_cmpx_gt_i16 vcc, 0, v57
    ds_read_b64 v[18:19], v18
    s_mov_b64 exec, -1
    v_cmpx_gt_i16 vcc, 0, v58
    ds_read_b64 v[20:21], v20
    s_mov_b64 exec, -1
    v_cmpx_gt_i16 vcc, 0, v59
    ds_read_b64 v[22:23], v22
    s_mov_b64 exec, -1
    s_cmp_ge_u32 s10, 9
    s_cbranch_scc1 p2_nm0m0a
    v_lshrrev_b32 v84, 1, v112
    s_add_u32 s44, s20, s42
    buffer_load_dwordx2 v[84:85], v84, s[4:7], s44 offen
p2_nm0m0a:
    buffer_load_dwordx4 v[72:75], v112, s[4:7], s20 offen offset:0
    buffer_load_dwordx4 v[76:79], v112, s[4:7], s20 offen offset:1024
    buffer_load_dwordx4 v[80:83], v112, s[4:7], s20 offen offset:2048
    v_cmpx_gt_i16 vcc, 0, v60
    ds_read_b64 v[24:25], v24
    s_mov_b64 exec, -1
    v_cmpx_gt_i16 vcc, 0, v61
    ds_read_b64 v[26:27], v26
    s_mov_b64 exec, -1
    v_cmpx_gt_i16 vcc, 0, v62
    ds_read_b64 v[28:29], v28
    s_mov_b64 exec, -1
    v_cmpx_gt_i16 vcc, 0, v63
    ds_read_b64 v[30:31], v30
    s_mov_b64 exec, -1
    v_cmpx_gt_i16 vcc, 0, v64
    ds_read_b64 v[32:33], v32
    s_mov_b64 exec, -1
    v_cmpx_gt_i16 vcc, 0, v65
    ds_read_b64 v[34:35], v34
    s_mov_b64 exec, -1
    v_cmpx_gt_i16 vcc, 0, v66
    ds_read_b64 v[36:37], v36
    s_mov_b64 exec, -1
    v_cmpx_gt_i16 vcc, 0, v67
    ds_read_b64 v[38:39], v38
    s_mov_b64 exec, -1
    v_cmpx_gt_i16 vcc, 0, v68
    ds_read_b64 v[40:41], v40
    s_mov_b64 exec, -1
    s_cmp_le_u32 s15, 7
    s_cbranch_scc1 p2_g0r27
    v_cmpx_gt_i16 vcc, 0, v69
    ds_read_b64 v[42:43], v42
    s_mov_b64 exec, -1
    v_cmpx_gt_i16 vcc, 0, v70
    ds_read_b64 v[44:45], v44
    s_mov_b64 exec, -1
    v_cmpx_gt_i16 vcc, 0, v71
    ds_read_b64 v[46:47], v46
    s_mov_b64 exec, -1
p2_g0r27:
    s_waitcnt lgkmcnt(15)
    v_ashrrev_i32 v122, 5, v48
    v_lshlrev_b16 v123, 2, v48
    v_lshlrev_b32 v124, 16, v0
    v_bitop3_b32 v122, v122, v113, v113 bitop3:0x0c
    v_and_b32 v125, 0xffff0000, v0
    v_lshlrev_b32 v126, 16, v1
    v_mul_f32 v122, v114, v122
    v_and_b32 v127, 0xffff0000, v1
    v_add_u32 v123, v123, v123
    v_pk_fma_f32 v[124:125], v[124:125], v[122:123], s[34:35] op_sel_hi:[1,0,1]
    v_pk_fma_f32 v[126:127], v[126:127], v[122:123], s[34:35] op_sel_hi:[1,0,1]
    v_lshl_add_u32 v124, v125, 16, v124
    v_lshl_add_u32 v125, v127, 16, v126
    s_waitcnt lgkmcnt(15)
    v_bitop3_b32 v115, v115, v116, v117 bitop3:0xfe
    v_lshl_add_u64 v[124:125], v[124:125], 0, s[36:37]
    v_cmpx_le_u32 vcc, 0x1000000, v48
    ds_add_rtn_u64 v[116:117], v123, v[124:125] offset:54272
    s_mov_b64 exec, -1
    v_ashrrev_i32 v122, 5, v49
    v_lshlrev_b16 v123, 2, v49
    v_lshlrev_b32 v124, 16, v2
    v_bitop3_b32 v122, v122, v113, v113 bitop3:0x0c
    v_and_b32 v125, 0xffff0000, v2
    v_lshlrev_b32 v126, 16, v3
    v_mul_f32 v122, v114, v122
    v_and_b32 v127, 0xffff0000, v3
    v_add_u32 v123, v123, v123
    v_pk_fma_f32 v[124:125], v[124:125], v[122:123], s[34:35] op_sel_hi:[1,0,1]
    v_pk_fma_f32 v[126:127], v[126:127], v[122:123], s[34:35] op_sel_hi:[1,0,1]
    v_lshl_add_u32 v124, v125, 16, v124
    v_lshl_add_u32 v125, v127, 16, v126
    s_waitcnt lgkmcnt(15)
    v_bitop3_b32 v115, v115, v118, v119 bitop3:0xfe
    v_lshl_add_u64 v[124:125], v[124:125], 0, s[36:37]
    v_cmpx_le_u32 vcc, 0x1000000, v49
    ds_add_rtn_u64 v[118:119], v123, v[124:125] offset:54272
    s_mov_b64 exec, -1
    v_ashrrev_i32 v122, 5, v50
    v_lshlrev_b16 v123, 2, v50
    v_lshlrev_b32 v124, 16, v4
    v_bitop3_b32 v122, v122, v113, v113 bitop3:0x0c
    v_and_b32 v125, 0xffff0000, v4
    v_lshlrev_b32 v126, 16, v5
    v_mul_f32 v122, v114, v122
    v_and_b32 v127, 0xffff0000, v5
    v_add_u32 v123, v123, v123
    v_pk_fma_f32 v[124:125], v[124:125], v[122:123], s[34:35] op_sel_hi:[1,0,1]
    v_pk_fma_f32 v[126:127], v[126:127], v[122:123], s[34:35] op_sel_hi:[1,0,1]
    v_lshl_add_u32 v124, v125, 16, v124
    v_lshl_add_u32 v125, v127, 16, v126
    s_waitcnt lgkmcnt(15)
    v_bitop3_b32 v115, v115, v120, v121 bitop3:0xfe
    v_lshl_add_u64 v[124:125], v[124:125], 0, s[36:37]
    v_cmpx_le_u32 vcc, 0x1000000, v50
    ds_add_rtn_u64 v[120:121], v123, v[124:125] offset:54272
    s_mov_b64 exec, -1
    v_bfe_u32 v0, v102, 14, 4
    v_lshrrev_b32 v1, 18, v102
    v_and_b32 v102, 0x3fff, v102
    v_mad_u32_u24 v0, v0, s63, v1
    v_lshl_or_b32 v102, v0, 14, v102
    buffer_load_dwordx4 v[0:3], v102, s[68:71], 0 offen
    s_waitcnt lgkmcnt(15)
    v_ashrrev_i32 v122, 5, v51
    v_lshlrev_b16 v123, 2, v51
    v_lshlrev_b32 v124, 16, v6
    v_bitop3_b32 v122, v122, v113, v113 bitop3:0x0c
    v_and_b32 v125, 0xffff0000, v6
    v_lshlrev_b32 v126, 16, v7
    v_mul_f32 v122, v114, v122
    v_and_b32 v127, 0xffff0000, v7
    v_add_u32 v123, v123, v123
    v_pk_fma_f32 v[124:125], v[124:125], v[122:123], s[34:35] op_sel_hi:[1,0,1]
    v_pk_fma_f32 v[126:127], v[126:127], v[122:123], s[34:35] op_sel_hi:[1,0,1]
    v_lshl_add_u32 v124, v125, 16, v124
    v_lshl_add_u32 v125, v127, 16, v126
    s_waitcnt lgkmcnt(2)
    v_bitop3_b32 v115, v115, v116, v117 bitop3:0xfe
    v_lshl_add_u64 v[124:125], v[124:125], 0, s[36:37]
    v_cmpx_le_u32 vcc, 0x1000000, v51
    ds_add_rtn_u64 v[116:117], v123, v[124:125] offset:54272
    s_mov_b64 exec, -1
    v_ashrrev_i32 v122, 5, v52
    v_lshlrev_b16 v123, 2, v52
    v_lshlrev_b32 v124, 16, v8
    v_bitop3_b32 v122, v122, v113, v113 bitop3:0x0c
    v_and_b32 v125, 0xffff0000, v8
    v_lshlrev_b32 v126, 16, v9
    v_mul_f32 v122, v114, v122
    v_and_b32 v127, 0xffff0000, v9
    v_add_u32 v123, v123, v123
    v_pk_fma_f32 v[124:125], v[124:125], v[122:123], s[34:35] op_sel_hi:[1,0,1]
    v_pk_fma_f32 v[126:127], v[126:127], v[122:123], s[34:35] op_sel_hi:[1,0,1]
    v_lshl_add_u32 v124, v125, 16, v124
    v_lshl_add_u32 v125, v127, 16, v126
    s_waitcnt lgkmcnt(2)
    v_bitop3_b32 v115, v115, v118, v119 bitop3:0xfe
    v_lshl_add_u64 v[124:125], v[124:125], 0, s[36:37]
    v_cmpx_le_u32 vcc, 0x1000000, v52
    ds_add_rtn_u64 v[118:119], v123, v[124:125] offset:54272
    s_mov_b64 exec, -1
    v_ashrrev_i32 v122, 5, v53
    v_lshlrev_b16 v123, 2, v53
    v_lshlrev_b32 v124, 16, v10
    v_bitop3_b32 v122, v122, v113, v113 bitop3:0x0c
    v_and_b32 v125, 0xffff0000, v10
    v_lshlrev_b32 v126, 16, v11
    v_mul_f32 v122, v114, v122
    v_and_b32 v127, 0xffff0000, v11
    v_add_u32 v123, v123, v123
    v_pk_fma_f32 v[124:125], v[124:125], v[122:123], s[34:35] op_sel_hi:[1,0,1]
    v_pk_fma_f32 v[126:127], v[126:127], v[122:123], s[34:35] op_sel_hi:[1,0,1]
    v_lshl_add_u32 v124, v125, 16, v124
    v_lshl_add_u32 v125, v127, 16, v126
    s_waitcnt lgkmcnt(2)
    v_bitop3_b32 v115, v115, v120, v121 bitop3:0xfe
    v_lshl_add_u64 v[124:125], v[124:125], 0, s[36:37]
    v_cmpx_le_u32 vcc, 0x1000000, v53
    ds_add_rtn_u64 v[120:121], v123, v[124:125] offset:54272
    s_mov_b64 exec, -1
    v_bfe_u32 v6, v103, 14, 4
    v_lshrrev_b32 v7, 18, v103
    v_and_b32 v103, 0x3fff, v103
    v_mad_u32_u24 v6, v6, s63, v7
    v_lshl_or_b32 v103, v6, 14, v103
    buffer_load_dwordx4 v[6:9], v103, s[68:71], 0 offen
    s_waitcnt lgkmcnt(6)
    s_barrier
    s_waitcnt vmcnt(6)
    s_mov_b32 m0, s23
    v_mov_b32 v53, 0x3c000
    s_movk_i32 s44, 512
    v_sub_u32_sdwa v4, v111, v110 dst_sel:DWORD dst_unused:UNUSED_PAD src0_sel:WORD_0 src1_sel:WORD_0
    v_sub_u32_sdwa v5, v111, v110 dst_sel:DWORD dst_unused:UNUSED_PAD src0_sel:WORD_1 src1_sel:WORD_1
    v_med3_i32 v4, v4, 0, s44
    v_med3_i32 v5, v5, 0, s44
    v_add_u32 v48, v4, v5
    ds_write_addtid_b32 v53 offset:0
    ds_write_addtid_b32 v53 offset:256
    ds_write_addtid_b32 v53 offset:512
    ds_write_addtid_b32 v53 offset:768
    ds_write_addtid_b32 v53 offset:1024
    ds_write_addtid_b32 v53 offset:1280
    ds_write_addtid_b32 v53 offset:1536
    ds_write_addtid_b32 v53 offset:1792
    v_bfe_i32 v53, v112, 6, 1
    v_lshrrev_b32 v49, 6, v112
    v_bitop3_b32 v53, v53, 15, s10 bitop3:0x6a
    v_lshl_or_b32 v49, v49, 4, v53
    v_and_b32 v53, 0x30, v112
    v_lshl_or_b32 v53, v49, 6, v53
    v_lshlrev_b32 v53, 15, v53
    s_nop 1
    v_add_u32_dpp v48, v48, v48 row_shr:1 row_mask:0xf bank_mask:0xf bound_ctrl:0
    s_nop 1
    v_add_u32_dpp v48, v48, v48 row_shr:2 row_mask:0xf bank_mask:0xf bound_ctrl:0
    s_nop 1
    v_add_u32_dpp v48, v48, v48 row_shr:4 row_mask:0xf bank_mask:0xf bound_ctrl:0
    s_nop 1
    v_add_u32_dpp v48, v48, v48 row_shr:8 row_mask:0xf bank_mask:0xf bound_ctrl:0
    s_nop 1
    v_add_u32_dpp v48, v48, v48 row_bcast:15 row_mask:0xa bank_mask:0xf
    s_nop 1
    v_add_u32_dpp v48, v48, v48 row_bcast:31 row_mask:0xc bank_mask:0xf
    s_nop 1
    s_nop 0
    v_readlane_b32 s38, v48, 63
    v_sub_u32 v50, v48, v5
    v_sub_u32 v49, v50, v4
    v_sub_u32 v10, 512, v49
    v_mad_u32_u16 v51, v110, 16, v53
    v_med3_i32 v10, v10, 0, v4
    v_lshl_add_u32 v49, v49, 2, s23
    v_sub_u32 v11, 512, v50
    v_mad_u32_u16 v52, v110, 16, v53 op_sel:[1,0,0,0]
    v_med3_i32 v11, v11, 0, v5
    v_lshl_add_u32 v50, v50, 2, s23
    v_lshl_add_u32 v48, v11, 16, v10
    v_add_u32 v52, 262144, v52
    v_add_u32 v110, v110, v48
    s_min_u32 s17, s38, 512
    s_add_u32 s17, s17, 63
    s_lshr_b32 s17, s17, 6
p2_x0x_0:
    v_cmpx_lt_i32 vcc, 0, v10
    s_cbranch_execz p2_y0x_0
    ds_write_b32 v49, v51 offset:0
    v_add_u32 v51, 16, v51
    v_cmpx_lt_i32 vcc, 1, v10
    s_cbranch_execz p2_y0x_0
    ds_write_b32 v49, v51 offset:4
    v_add_u32 v51, 16, v51
    v_cmpx_lt_i32 vcc, 2, v10
    s_cbranch_execz p2_y0x_0
    ds_write_b32 v49, v51 offset:8
    v_add_u32 v51, 16, v51
    v_cmpx_lt_i32 vcc, 3, v10
    s_cbranch_execz p2_y0x_0
    ds_write_b32 v49, v51 offset:12
    v_add_u32 v51, 16, v51
    v_cmpx_lt_i32 vcc, 4, v10
    s_cbranch_execz p2_y0x_0
    ds_write_b32 v49, v51 offset:16
    v_add_u32 v51, 16, v51
    v_cmpx_lt_i32 vcc, 5, v10
    s_cbranch_execz p2_y0x_0
    ds_write_b32 v49, v51 offset:20
    v_add_u32 v51, 16, v51
    v_cmpx_lt_i32 vcc, 6, v10
    s_cbranch_execz p2_y0x_0
    ds_write_b32 v49, v51 offset:24
    v_add_u32 v51, 16, v51
    v_cmpx_lt_i32 vcc, 7, v10
    s_cbranch_execz p2_y0x_0
    ds_write_b32 v49, v51 offset:28
    v_add_u32 v51, 16, v51
    v_subrev_u32 v10, 8, v10
    v_add_u32 v49, 32, v49
    s_branch p2_x0x_0
p2_y0x_0:
    s_mov_b64 exec, -1
p2_x0x_1:
    v_cmpx_lt_i32 vcc, 0, v11
    s_cbranch_execz p2_y0x_1
    ds_write_b32 v50, v52 offset:0
    v_add_u32 v52, 16, v52
    v_cmpx_lt_i32 vcc, 1, v11
    s_cbranch_execz p2_y0x_1
    ds_write_b32 v50, v52 offset:4
    v_add_u32 v52, 16, v52
    v_cmpx_lt_i32 vcc, 2, v11
    s_cbranch_execz p2_y0x_1
    ds_write_b32 v50, v52 offset:8
    v_add_u32 v52, 16, v52
    v_cmpx_lt_i32 vcc, 3, v11
    s_cbranch_execz p2_y0x_1
    ds_write_b32 v50, v52 offset:12
    v_add_u32 v52, 16, v52
    v_cmpx_lt_i32 vcc, 4, v11
    s_cbranch_execz p2_y0x_1
    ds_write_b32 v50, v52 offset:16
    v_add_u32 v52, 16, v52
    v_cmpx_lt_i32 vcc, 5, v11
    s_cbranch_execz p2_y0x_1
    ds_write_b32 v50, v52 offset:20
    v_add_u32 v52, 16, v52
    v_cmpx_lt_i32 vcc, 6, v11
    s_cbranch_execz p2_y0x_1
    ds_write_b32 v50, v52 offset:24
    v_add_u32 v52, 16, v52
    v_cmpx_lt_i32 vcc, 7, v11
    s_cbranch_execz p2_y0x_1
    ds_write_b32 v50, v52 offset:28
    v_add_u32 v52, 16, v52
    v_subrev_u32 v11, 8, v11
    v_add_u32 v50, 32, v50
    s_branch p2_x0x_1
p2_y0x_1:
    s_mov_b64 exec, -1
    s_cmp_lt_u32 s38, 512
    s_cbranch_scc1 p2_nomore0x
    v_cmp_lt_u32_sdwa s[44:45], v110, v111 src0_sel:WORD_0 src1_sel:WORD_0
    v_cmp_lt_u32_sdwa s[46:47], v110, v111 src0_sel:WORD_1 src1_sel:WORD_1
    s_nop 0
    s_or_b64 s[44:45], s[44:45], s[46:47]
    s_cbranch_scc0 p2_nomore0x
    v_mov_b32 v49, s19
    v_mov_b32 v50, 1
    ds_write_b32 v49, v50 offset:53760
p2_nomore0x:
    s_waitcnt lgkmcnt(15)
    v_ashrrev_i32 v122, 5, v54
    v_lshlrev_b16 v123, 2, v54
    v_lshlrev_b32 v124, 16, v12
    v_bitop3_b32 v122, v122, v113, v113 bitop3:0x0c
    v_and_b32 v125, 0xffff0000, v12
    v_lshlrev_b32 v126, 16, v13
    v_mul_f32 v122, v114, v122
    v_and_b32 v127, 0xffff0000, v13
    v_add_u32 v123, v123, v123
    v_pk_fma_f32 v[124:125], v[124:125], v[122:123], s[34:35] op_sel_hi:[1,0,1]
    v_pk_fma_f32 v[126:127], v[126:127], v[122:123], s[34:35] op_sel_hi:[1,0,1]
    v_lshl_add_u32 v124, v125, 16, v124
    v_lshl_add_u32 v125, v127, 16, v126
    s_waitcnt lgkmcnt(10)
    v_bitop3_b32 v115, v115, v116, v117 bitop3:0xfe
    v_lshl_add_u64 v[124:125], v[124:125], 0, s[36:37]
    v_cmpx_le_u32 vcc, 0x1000000, v54
    ds_add_rtn_u64 v[116:117], v123, v[124:125] offset:54272
    s_mov_b64 exec, -1
    v_ashrrev_i32 v122, 5, v55
    v_lshlrev_b16 v123, 2, v55
    v_lshlrev_b32 v124, 16, v14
    v_bitop3_b32 v122, v122, v113, v113 bitop3:0x0c
    v_and_b32 v125, 0xffff0000, v14
    v_lshlrev_b32 v126, 16, v15
    v_mul_f32 v122, v114, v122
    v_and_b32 v127, 0xffff0000, v15
    v_add_u32 v123, v123, v123
    v_pk_fma_f32 v[124:125], v[124:125], v[122:123], s[34:35] op_sel_hi:[1,0,1]
    v_pk_fma_f32 v[126:127], v[126:127], v[122:123], s[34:35] op_sel_hi:[1,0,1]
    v_lshl_add_u32 v124, v125, 16, v124
    v_lshl_add_u32 v125, v127, 16, v126
    s_waitcnt lgkmcnt(10)
    v_bitop3_b32 v115, v115, v118, v119 bitop3:0xfe
    v_lshl_add_u64 v[124:125], v[124:125], 0, s[36:37]
    v_cmpx_le_u32 vcc, 0x1000000, v55
    ds_add_rtn_u64 v[118:119], v123, v[124:125] offset:54272
    s_mov_b64 exec, -1
    v_ashrrev_i32 v122, 5, v56
    v_lshlrev_b16 v123, 2, v56
    v_lshlrev_b32 v124, 16, v16
    v_bitop3_b32 v122, v122, v113, v113 bitop3:0x0c
    v_and_b32 v125, 0xffff0000, v16
    v_lshlrev_b32 v126, 16, v17
    v_mul_f32 v122, v114, v122
    v_and_b32 v127, 0xffff0000, v17
    v_add_u32 v123, v123, v123
    v_pk_fma_f32 v[124:125], v[124:125], v[122:123], s[34:35] op_sel_hi:[1,0,1]
    v_pk_fma_f32 v[126:127], v[126:127], v[122:123], s[34:35] op_sel_hi:[1,0,1]
    v_lshl_add_u32 v124, v125, 16, v124
    v_lshl_add_u32 v125, v127, 16, v126
    s_waitcnt lgkmcnt(10)
    v_bitop3_b32 v115, v115, v120, v121 bitop3:0xfe
    v_lshl_add_u64 v[124:125], v[124:125], 0, s[36:37]
    v_cmpx_le_u32 vcc, 0x1000000, v56
    ds_add_rtn_u64 v[120:121], v123, v[124:125] offset:54272
    s_mov_b64 exec, -1
    v_bfe_u32 v12, v104, 14, 4
    v_lshrrev_b32 v13, 18, v104
    v_and_b32 v104, 0x3fff, v104
    v_mad_u32_u24 v12, v12, s63, v13
    v_lshl_or_b32 v104, v12, 14, v104
    buffer_load_dwordx4 v[12:15], v104, s[68:71], 0 offen
    s_waitcnt lgkmcnt(15)
    v_ashrrev_i32 v122, 5, v57
    v_lshlrev_b16 v123, 2, v57
    v_lshlrev_b32 v124, 16, v18
    v_bitop3_b32 v122, v122, v113, v113 bitop3:0x0c
    v_and_b32 v125, 0xffff0000, v18
    v_lshlrev_b32 v126, 16, v19
    v_mul_f32 v122, v114, v122
    v_and_b32 v127, 0xffff0000, v19
    v_add_u32 v123, v123, v123
    v_pk_fma_f32 v[124:125], v[124:125], v[122:123], s[34:35] op_sel_hi:[1,0,1]
    v_pk_fma_f32 v[126:127], v[126:127], v[122:123], s[34:35] op_sel_hi:[1,0,1]
    v_lshl_add_u32 v124, v125, 16, v124
    v_lshl_add_u32 v125, v127, 16, v126
    s_waitcnt lgkmcnt(2)
    v_bitop3_b32 v115, v115, v116, v117 bitop3:0xfe
    v_lshl_add_u64 v[124:125], v[124:125], 0, s[36:37]
    v_cmpx_le_u32 vcc, 0x1000000, v57
    ds_add_rtn_u64 v[116:117], v123, v[124:125] offset:54272
    s_mov_b64 exec, -1
    v_ashrrev_i32 v122, 5, v58
    v_lshlrev_b16 v123, 2, v58
    v_lshlrev_b32 v124, 16, v20
    v_bitop3_b32 v122, v122, v113, v113 bitop3:0x0c
    v_and_b32 v125, 0xffff0000, v20
    v_lshlrev_b32 v126, 16, v21
    v_mul_f32 v122, v114, v122
    v_and_b32 v127, 0xffff0000, v21
    v_add_u32 v123, v123, v123
    v_pk_fma_f32 v[124:125], v[124:125], v[122:123], s[34:35] op_sel_hi:[1,0,1]
    v_pk_fma_f32 v[126:127], v[126:127], v[122:123], s[34:35] op_sel_hi:[1,0,1]
    v_lshl_add_u32 v124, v125, 16, v124
    v_lshl_add_u32 v125, v127, 16, v126
    s_waitcnt lgkmcnt(2)
    v_bitop3_b32 v115, v115, v118, v119 bitop3:0xfe
    v_lshl_add_u64 v[124:125], v[124:125], 0, s[36:37]
    v_cmpx_le_u32 vcc, 0x1000000, v58
    ds_add_rtn_u64 v[118:119], v123, v[124:125] offset:54272
    s_mov_b64 exec, -1
    v_ashrrev_i32 v122, 5, v59
    v_lshlrev_b16 v123, 2, v59
    v_lshlrev_b32 v124, 16, v22
    v_bitop3_b32 v122, v122, v113, v113 bitop3:0x0c
    v_and_b32 v125, 0xffff0000, v22
    v_lshlrev_b32 v126, 16, v23
    v_mul_f32 v122, v114, v122
    v_and_b32 v127, 0xffff0000, v23
    v_add_u32 v123, v123, v123
    v_pk_fma_f32 v[124:125], v[124:125], v[122:123], s[34:35] op_sel_hi:[1,0,1]
    v_pk_fma_f32 v[126:127], v[126:127], v[122:123], s[34:35] op_sel_hi:[1,0,1]
    v_lshl_add_u32 v124, v125, 16, v124
    v_lshl_add_u32 v125, v127, 16, v126
    s_waitcnt lgkmcnt(2)
    v_bitop3_b32 v115, v115, v120, v121 bitop3:0xfe
    v_lshl_add_u64 v[124:125], v[124:125], 0, s[36:37]
    v_cmpx_le_u32 vcc, 0x1000000, v59
    ds_add_rtn_u64 v[120:121], v123, v[124:125] offset:54272
    s_mov_b64 exec, -1
    v_bfe_u32 v18, v105, 14, 4
    v_lshrrev_b32 v19, 18, v105
    v_and_b32 v105, 0x3fff, v105
    v_mad_u32_u24 v18, v18, s63, v19
    v_lshl_or_b32 v105, v18, 14, v105
    buffer_load_dwordx4 v[18:21], v105, s[68:71], 0 offen
    s_mov_b32 m0, s23
    s_nop 0
    ds_read_addtid_b32 v102 offset:0
    ds_read_addtid_b32 v103 offset:256
    ds_read_addtid_b32 v104 offset:512
    ds_read_addtid_b32 v105 offset:768
    ds_read_addtid_b32 v106 offset:1024
    ds_read_addtid_b32 v107 offset:1280
    ds_read_addtid_b32 v108 offset:1536
    ds_read_addtid_b32 v109 offset:1792
    s_waitcnt vmcnt(4)
    s_mov_b32 m0, s24
    s_cmp_ge_u32 s10, 9
    s_cbranch_scc1 p2_st0s0
    ds_write_addtid_b32 v84 offset:49152
    ds_write_addtid_b32 v85 offset:49408
p2_st0s0:
    s_mov_b32 m0, s23
    s_add_u32 s20, s20, 53760
    ds_write_addtid_b32 v72 offset:0
    ds_write_addtid_b32 v73 offset:256
    ds_write_addtid_b32 v74 offset:512
    ds_write_addtid_b32 v75 offset:768
    ds_write_addtid_b32 v76 offset:1024
    ds_write_addtid_b32 v77 offset:1280
    ds_write_addtid_b32 v78 offset:1536
    ds_write_addtid_b32 v79 offset:1792
    ds_write_addtid_b32 v80 offset:2048
    ds_write_addtid_b32 v81 offset:2304
    ds_write_addtid_b32 v82 offset:2560
    ds_write_addtid_b32 v83 offset:2816
    s_waitcnt lgkmcnt(15)
    v_ashrrev_i32 v122, 5, v60
    v_lshlrev_b16 v123, 2, v60
    v_lshlrev_b32 v124, 16, v24
    v_bitop3_b32 v122, v122, v113, v113 bitop3:0x0c
    v_and_b32 v125, 0xffff0000, v24
    v_lshlrev_b32 v126, 16, v25
    v_mul_f32 v122, v114, v122
    v_and_b32 v127, 0xffff0000, v25
    v_add_u32 v123, v123, v123
    v_pk_fma_f32 v[124:125], v[124:125], v[122:123], s[34:35] op_sel_hi:[1,0,1]
    v_pk_fma_f32 v[126:127], v[126:127], v[122:123], s[34:35] op_sel_hi:[1,0,1]
    v_lshl_add_u32 v124, v125, 16, v124
    v_lshl_add_u32 v125, v127, 16, v126
    s_waitcnt lgkmcnt(15)
    v_bitop3_b32 v115, v115, v116, v117 bitop3:0xfe
    v_lshl_add_u64 v[124:125], v[124:125], 0, s[36:37]
    v_cmpx_le_u32 vcc, 0x1000000, v60
    ds_add_rtn_u64 v[116:117], v123, v[124:125] offset:54272
    s_mov_b64 exec, -1
    v_ashrrev_i32 v122, 5, v61
    v_lshlrev_b16 v123, 2, v61
    v_lshlrev_b32 v124, 16, v26
    v_bitop3_b32 v122, v122, v113, v113 bitop3:0x0c
    v_and_b32 v125, 0xffff0000, v26
    v_lshlrev_b32 v126, 16, v27
    v_mul_f32 v122, v114, v122
    v_and_b32 v127, 0xffff0000, v27
    v_add_u32 v123, v123, v123
    v_pk_fma_f32 v[124:125], v[124:125], v[122:123], s[34:35] op_sel_hi:[1,0,1]
    v_pk_fma_f32 v[126:127], v[126:127], v[122:123], s[34:35] op_sel_hi:[1,0,1]
    v_lshl_add_u32 v124, v125, 16, v124
    v_lshl_add_u32 v125, v127, 16, v126
    s_waitcnt lgkmcnt(15)
    v_bitop3_b32 v115, v115, v118, v119 bitop3:0xfe
    v_lshl_add_u64 v[124:125], v[124:125], 0, s[36:37]
    v_cmpx_le_u32 vcc, 0x1000000, v61
    ds_add_rtn_u64 v[118:119], v123, v[124:125] offset:54272
    s_mov_b64 exec, -1
    v_ashrrev_i32 v122, 5, v62
    v_lshlrev_b16 v123, 2, v62
    v_lshlrev_b32 v124, 16, v28
    v_bitop3_b32 v122, v122, v113, v113 bitop3:0x0c
    v_and_b32 v125, 0xffff0000, v28
    v_lshlrev_b32 v126, 16, v29
    v_mul_f32 v122, v114, v122
    v_and_b32 v127, 0xffff0000, v29
    v_add_u32 v123, v123, v123
    v_pk_fma_f32 v[124:125], v[124:125], v[122:123], s[34:35] op_sel_hi:[1,0,1]
    v_pk_fma_f32 v[126:127], v[126:127], v[122:123], s[34:35] op_sel_hi:[1,0,1]
    v_lshl_add_u32 v124, v125, 16, v124
    v_lshl_add_u32 v125, v127, 16, v126
    s_waitcnt lgkmcnt(15)
    v_bitop3_b32 v115, v115, v120, v121 bitop3:0xfe
    v_lshl_add_u64 v[124:125], v[124:125], 0, s[36:37]
    v_cmpx_le_u32 vcc, 0x1000000, v62
    ds_add_rtn_u64 v[120:121], v123, v[124:125] offset:54272
    s_mov_b64 exec, -1
    s_waitcnt vmcnt(13)
    v_perm_b32 v60, v89, v86, s31
    v_perm_b32 v61, v89, v87, s32
    v_perm_b32 v62, v89, v88, s33
    v_lshlrev_b16 v28, 3, v88
    v_lshlrev_b16 v26, 3, v87
    v_lshlrev_b16 v24, 3, v86
    s_waitcnt lgkmcnt(3)
    s_barrier
    s_cmp_ge_u32 s10, 9
    s_cbranch_scc1 p2_nm0m1a
    v_lshrrev_b32 v84, 1, v112
    s_add_u32 s44, s20, s42
    buffer_load_dwordx2 v[84:85], v84, s[4:7], s44 offen
p2_nm0m1a:
    buffer_load_dwordx4 v[72:75], v112, s[4:7], s20 offen offset:0
    buffer_load_dwordx4 v[76:79], v112, s[4:7], s20 offen offset:1024
    buffer_load_dwordx4 v[80:83], v112, s[4:7], s20 offen offset:2048
    v_cmpx_ge_u16 vcc, 0x3fff, v60
    ds_read_b64 v[24:25], v24
    s_mov_b64 exec, -1
    v_cmpx_ge_u16 vcc, 0x3fff, v61
    ds_read_b64 v[26:27], v26
    s_mov_b64 exec, -1
    v_cmpx_ge_u16 vcc, 0x3fff, v62
    ds_read_b64 v[28:29], v28
    s_mov_b64 exec, -1
    s_waitcnt lgkmcnt(15)
    v_ashrrev_i32 v122, 5, v63
    v_lshlrev_b16 v123, 2, v63
    v_lshlrev_b32 v124, 16, v30
    v_bitop3_b32 v122, v122, v113, v113 bitop3:0x0c
    v_and_b32 v125, 0xffff0000, v30
    v_lshlrev_b32 v126, 16, v31
    v_mul_f32 v122, v114, v122
    v_and_b32 v127, 0xffff0000, v31
    v_add_u32 v123, v123, v123
    v_pk_fma_f32 v[124:125], v[124:125], v[122:123], s[34:35] op_sel_hi:[1,0,1]
    v_pk_fma_f32 v[126:127], v[126:127], v[122:123], s[34:35] op_sel_hi:[1,0,1]
    v_lshl_add_u32 v124, v125, 16, v124
    v_lshl_add_u32 v125, v127, 16, v126
    s_waitcnt lgkmcnt(5)
    v_bitop3_b32 v115, v115, v116, v117 bitop3:0xfe
    v_lshl_add_u64 v[124:125], v[124:125], 0, s[36:37]
    v_cmpx_le_u32 vcc, 0x1000000, v63
    ds_add_rtn_u64 v[116:117], v123, v[124:125] offset:54272
    s_mov_b64 exec, -1
    v_ashrrev_i32 v122, 5, v64
    v_lshlrev_b16 v123, 2, v64
    v_lshlrev_b32 v124, 16, v32
    v_bitop3_b32 v122, v122, v113, v113 bitop3:0x0c
    v_and_b32 v125, 0xffff0000, v32
    v_lshlrev_b32 v126, 16, v33
    v_mul_f32 v122, v114, v122
    v_and_b32 v127, 0xffff0000, v33
    v_add_u32 v123, v123, v123
    v_pk_fma_f32 v[124:125], v[124:125], v[122:123], s[34:35] op_sel_hi:[1,0,1]
    v_pk_fma_f32 v[126:127], v[126:127], v[122:123], s[34:35] op_sel_hi:[1,0,1]
    v_lshl_add_u32 v124, v125, 16, v124
    v_lshl_add_u32 v125, v127, 16, v126
    s_waitcnt lgkmcnt(5)
    v_bitop3_b32 v115, v115, v118, v119 bitop3:0xfe
    v_lshl_add_u64 v[124:125], v[124:125], 0, s[36:37]
    v_cmpx_le_u32 vcc, 0x1000000, v64
    ds_add_rtn_u64 v[118:119], v123, v[124:125] offset:54272
    s_mov_b64 exec, -1
    v_ashrrev_i32 v122, 5, v65
    v_lshlrev_b16 v123, 2, v65
    v_lshlrev_b32 v124, 16, v34
    v_bitop3_b32 v122, v122, v113, v113 bitop3:0x0c
    v_and_b32 v125, 0xffff0000, v34
    v_lshlrev_b32 v126, 16, v35
    v_mul_f32 v122, v114, v122
    v_and_b32 v127, 0xffff0000, v35
    v_add_u32 v123, v123, v123
    v_pk_fma_f32 v[124:125], v[124:125], v[122:123], s[34:35] op_sel_hi:[1,0,1]
    v_pk_fma_f32 v[126:127], v[126:127], v[122:123], s[34:35] op_sel_hi:[1,0,1]
    v_lshl_add_u32 v124, v125, 16, v124
    v_lshl_add_u32 v125, v127, 16, v126
    s_waitcnt lgkmcnt(5)
    v_bitop3_b32 v115, v115, v120, v121 bitop3:0xfe
    v_lshl_add_u64 v[124:125], v[124:125], 0, s[36:37]
    v_cmpx_le_u32 vcc, 0x1000000, v65
    ds_add_rtn_u64 v[120:121], v123, v[124:125] offset:54272
    s_mov_b64 exec, -1
    s_waitcnt vmcnt(15)
    v_perm_b32 v63, v93, v90, s31
    v_perm_b32 v64, v93, v91, s32
    v_perm_b32 v65, v93, v92, s33
    v_lshlrev_b16 v34, 3, v92
    v_lshlrev_b16 v32, 3, v91
    v_lshlrev_b16 v30, 3, v90
    v_cmpx_ge_u16 vcc, 0x3fff, v63
    ds_read_b64 v[30:31], v30
    s_mov_b64 exec, -1
    v_cmpx_ge_u16 vcc, 0x3fff, v64
    ds_read_b64 v[32:33], v32
    s_mov_b64 exec, -1
    v_cmpx_ge_u16 vcc, 0x3fff, v65
    ds_read_b64 v[34:35], v34
    s_mov_b64 exec, -1
    s_waitcnt lgkmcnt(15)
    v_bfe_u32 v86, v106, 14, 4
    v_lshrrev_b32 v87, 18, v106
    v_and_b32 v106, 0x3fff, v106
    v_mad_u32_u24 v86, v86, s63, v87
    v_lshl_or_b32 v106, v86, 14, v106
    buffer_load_dwordx4 v[86:89], v106, s[68:71], 0 offen
    s_waitcnt lgkmcnt(15)
    v_ashrrev_i32 v122, 5, v66
    v_lshlrev_b16 v123, 2, v66
    v_lshlrev_b32 v124, 16, v36
    v_bitop3_b32 v122, v122, v113, v113 bitop3:0x0c
    v_and_b32 v125, 0xffff0000, v36
    v_lshlrev_b32 v126, 16, v37
    v_mul_f32 v122, v114, v122
    v_and_b32 v127, 0xffff0000, v37
    v_add_u32 v123, v123, v123
    v_pk_fma_f32 v[124:125], v[124:125], v[122:123], s[34:35] op_sel_hi:[1,0,1]
    v_pk_fma_f32 v[126:127], v[126:127], v[122:123], s[34:35] op_sel_hi:[1,0,1]
    v_lshl_add_u32 v124, v125, 16, v124
    v_lshl_add_u32 v125, v127, 16, v126
    s_waitcnt lgkmcnt(5)
    v_bitop3_b32 v115, v115, v116, v117 bitop3:0xfe
    v_lshl_add_u64 v[124:125], v[124:125], 0, s[36:37]
    v_cmpx_le_u32 vcc, 0x1000000, v66
    ds_add_rtn_u64 v[116:117], v123, v[124:125] offset:54272
    s_mov_b64 exec, -1
    v_ashrrev_i32 v122, 5, v67
    v_lshlrev_b16 v123, 2, v67
    v_lshlrev_b32 v124, 16, v38
    v_bitop3_b32 v122, v122, v113, v113 bitop3:0x0c
    v_and_b32 v125, 0xffff0000, v38
    v_lshlrev_b32 v126, 16, v39
    v_mul_f32 v122, v114, v122
    v_and_b32 v127, 0xffff0000, v39
    v_add_u32 v123, v123, v123
    v_pk_fma_f32 v[124:125], v[124:125], v[122:123], s[34:35] op_sel_hi:[1,0,1]
    v_pk_fma_f32 v[126:127], v[126:127], v[122:123], s[34:35] op_sel_hi:[1,0,1]
    v_lshl_add_u32 v124, v125, 16, v124
    v_lshl_add_u32 v125, v127, 16, v126
    s_waitcnt lgkmcnt(5)
    v_bitop3_b32 v115, v115, v118, v119 bitop3:0xfe
    v_lshl_add_u64 v[124:125], v[124:125], 0, s[36:37]
    v_cmpx_le_u32 vcc, 0x1000000, v67
    ds_add_rtn_u64 v[118:119], v123, v[124:125] offset:54272
    s_mov_b64 exec, -1
    v_ashrrev_i32 v122, 5, v68
    v_lshlrev_b16 v123, 2, v68
    v_lshlrev_b32 v124, 16, v40
    v_bitop3_b32 v122, v122, v113, v113 bitop3:0x0c
    v_and_b32 v125, 0xffff0000, v40
    v_lshlrev_b32 v126, 16, v41
    v_mul_f32 v122, v114, v122
    v_and_b32 v127, 0xffff0000, v41
    v_add_u32 v123, v123, v123
    v_pk_fma_f32 v[124:125], v[124:125], v[122:123], s[34:35] op_sel_hi:[1,0,1]
    v_pk_fma_f32 v[126:127], v[126:127], v[122:123], s[34:35] op_sel_hi:[1,0,1]
    v_lshl_add_u32 v124, v125, 16, v124
    v_lshl_add_u32 v125, v127, 16, v126
    s_waitcnt lgkmcnt(5)
    v_bitop3_b32 v115, v115, v120, v121 bitop3:0xfe
    v_lshl_add_u64 v[124:125], v[124:125], 0, s[36:37]
    v_cmpx_le_u32 vcc, 0x1000000, v68
    ds_add_rtn_u64 v[120:121], v123, v[124:125] offset:54272
    s_mov_b64 exec, -1
    s_waitcnt vmcnt(12)
    v_perm_b32 v66, v97, v94, s31
    v_perm_b32 v67, v97, v95, s32
    v_perm_b32 v68, v97, v96, s33
    v_lshlrev_b16 v40, 3, v96
    v_lshlrev_b16 v38, 3, v95
    v_lshlrev_b16 v36, 3, v94
    v_cmpx_ge_u16 vcc, 0x3fff, v66
    ds_read_b64 v[36:37], v36
    s_mov_b64 exec, -1
    v_cmpx_ge_u16 vcc, 0x3fff, v67
    ds_read_b64 v[38:39], v38
    s_mov_b64 exec, -1
    v_cmpx_ge_u16 vcc, 0x3fff, v68
    ds_read_b64 v[40:41], v40
    s_mov_b64 exec, -1
    s_waitcnt lgkmcnt(15)
    v_bfe_u32 v90, v107, 14, 4
    v_lshrrev_b32 v91, 18, v107
    v_and_b32 v107, 0x3fff, v107
    v_mad_u32_u24 v90, v90, s63, v91
    v_lshl_or_b32 v107, v90, 14, v107
    buffer_load_dwordx4 v[90:93], v107, s[68:71], 0 offen
    s_cmp_le_u32 s15, 7
    s_cbranch_scc1 p2_na0a7
    s_waitcnt lgkmcnt(15)
    v_ashrrev_i32 v122, 5, v69
    v_lshlrev_b16 v123, 2, v69
    v_lshlrev_b32 v124, 16, v42
    v_bitop3_b32 v122, v122, v113, v113 bitop3:0x0c
    v_and_b32 v125, 0xffff0000, v42
    v_lshlrev_b32 v126, 16, v43
    v_mul_f32 v122, v114, v122
    v_and_b32 v127, 0xffff0000, v43
    v_add_u32 v123, v123, v123
    v_pk_fma_f32 v[124:125], v[124:125], v[122:123], s[34:35] op_sel_hi:[1,0,1]
    v_pk_fma_f32 v[126:127], v[126:127], v[122:123], s[34:35] op_sel_hi:[1,0,1]
    v_lshl_add_u32 v124, v125, 16, v124
    v_lshl_add_u32 v125, v127, 16, v126
    s_waitcnt lgkmcnt(5)
    v_bitop3_b32 v115, v115, v116, v117 bitop3:0xfe
    v_lshl_add_u64 v[124:125], v[124:125], 0, s[36:37]
    v_cmpx_le_u32 vcc, 0x1000000, v69
    ds_add_rtn_u64 v[116:117], v123, v[124:125] offset:54272
    s_mov_b64 exec, -1
    v_ashrrev_i32 v122, 5, v70
    v_lshlrev_b16 v123, 2, v70
    v_lshlrev_b32 v124, 16, v44
    v_bitop3_b32 v122, v122, v113, v113 bitop3:0x0c
    v_and_b32 v125, 0xffff0000, v44
    v_lshlrev_b32 v126, 16, v45
    v_mul_f32 v122, v114, v122
    v_and_b32 v127, 0xffff0000, v45
    v_add_u32 v123, v123, v123
    v_pk_fma_f32 v[124:125], v[124:125], v[122:123], s[34:35] op_sel_hi:[1,0,1]
    v_pk_fma_f32 v[126:127], v[126:127], v[122:123], s[34:35] op_sel_hi:[1,0,1]
    v_lshl_add_u32 v124, v125, 16, v124
    v_lshl_add_u32 v125, v127, 16, v126
    s_waitcnt lgkmcnt(5)
    v_bitop3_b32 v115, v115, v118, v119 bitop3:0xfe
    v_lshl_add_u64 v[124:125], v[124:125], 0, s[36:37]
    v_cmpx_le_u32 vcc, 0x1000000, v70
    ds_add_rtn_u64 v[118:119], v123, v[124:125] offset:54272
    s_mov_b64 exec, -1
    v_ashrrev_i32 v122, 5, v71
    v_lshlrev_b16 v123, 2, v71
    v_lshlrev_b32 v124, 16, v46
    v_bitop3_b32 v122, v122, v113, v113 bitop3:0x0c
    v_and_b32 v125, 0xffff0000, v46
    v_lshlrev_b32 v126, 16, v47
    v_mul_f32 v122, v114, v122
    v_and_b32 v127, 0xffff0000, v47
    v_add_u32 v123, v123, v123
    v_pk_fma_f32 v[124:125], v[124:125], v[122:123], s[34:35] op_sel_hi:[1,0,1]
    v_pk_fma_f32 v[126:127], v[126:127], v[122:123], s[34:35] op_sel_hi:[1,0,1]
    v_lshl_add_u32 v124, v125, 16, v124
    v_lshl_add_u32 v125, v127, 16, v126
    s_waitcnt lgkmcnt(5)
    v_bitop3_b32 v115, v115, v120, v121 bitop3:0xfe
    v_lshl_add_u64 v[124:125], v[124:125], 0, s[36:37]
    v_cmpx_le_u32 vcc, 0x1000000, v71
    ds_add_rtn_u64 v[120:121], v123, v[124:125] offset:54272
    s_mov_b64 exec, -1
p2_na0a7:
    s_waitcnt vmcnt(12)
    v_perm_b32 v69, v101, v98, s31
    v_perm_b32 v70, v101, v99, s32
    v_perm_b32 v71, v101, v100, s33
    v_lshlrev_b16 v46, 3, v100
    v_lshlrev_b16 v44, 3, v99
    v_lshlrev_b16 v42, 3, v98
    s_cmp_le_u32 s16, 7
    s_cbranch_scc1 p2_g0r07
    v_cmpx_ge_u16 vcc, 0x3fff, v69
    ds_read_b64 v[42:43], v42
    s_mov_b64 exec, -1
    v_cmpx_ge_u16 vcc, 0x3fff, v70
    ds_read_b64 v[44:45], v44
    s_mov_b64 exec, -1
    v_cmpx_ge_u16 vcc, 0x3fff, v71
    ds_read_b64 v[46:47], v46
    s_mov_b64 exec, -1
p2_g0r07:
    s_waitcnt vmcnt(8)
    v_perm_b32 v48, v3, v0, s31
    v_perm_b32 v49, v3, v1, s32
    v_perm_b32 v50, v3, v2, s33
    v_lshlrev_b16 v4, 3, v2
    v_lshlrev_b16 v2, 3, v1
    v_lshlrev_b16 v0, 3, v0
    v_cmpx_ge_u16 vcc, 0x3fff, v48
    ds_read_b64 v[0:1], v0
    s_mov_b64 exec, -1
    v_cmpx_ge_u16 vcc, 0x3fff, v49
    ds_read_b64 v[2:3], v2
    s_mov_b64 exec, -1
    v_cmpx_ge_u16 vcc, 0x3fff, v50
    ds_read_b64 v[4:5], v4
    s_mov_b64 exec, -1
    s_waitcnt vmcnt(7)
    v_perm_b32 v51, v9, v6, s31
    v_perm_b32 v52, v9, v7, s32
    v_perm_b32 v53, v9, v8, s33
    v_lshlrev_b16 v10, 3, v8
    v_lshlrev_b16 v8, 3, v7
    v_lshlrev_b16 v6, 3, v6
    v_cmpx_ge_u16 vcc, 0x3fff, v51
    ds_read_b64 v[6:7], v6
    s_mov_b64 exec, -1
    v_cmpx_ge_u16 vcc, 0x3fff, v52
    ds_read_b64 v[8:9], v8
    s_mov_b64 exec, -1
    v_cmpx_ge_u16 vcc, 0x3fff, v53
    ds_read_b64 v[10:11], v10
    s_mov_b64 exec, -1
    s_waitcnt vmcnt(6)
    v_perm_b32 v54, v15, v12, s31
    v_perm_b32 v55, v15, v13, s32
    v_perm_b32 v56, v15, v14, s33
    v_lshlrev_b16 v16, 3, v14
    v_lshlrev_b16 v14, 3, v13
    v_lshlrev_b16 v12, 3, v12
    v_cmpx_ge_u16 vcc, 0x3fff, v54
    ds_read_b64 v[12:13], v12
    s_mov_b64 exec, -1
    v_cmpx_ge_u16 vcc, 0x3fff, v55
    ds_read_b64 v[14:15], v14
    s_mov_b64 exec, -1
    v_cmpx_ge_u16 vcc, 0x3fff, v56
    ds_read_b64 v[16:17], v16
    s_mov_b64 exec, -1
    s_waitcnt vmcnt(5)
    v_perm_b32 v57, v21, v18, s31
    v_perm_b32 v58, v21, v19, s32
    v_perm_b32 v59, v21, v20, s33
    v_lshlrev_b16 v22, 3, v20
    v_lshlrev_b16 v20, 3, v19
    v_lshlrev_b16 v18, 3, v18
    v_cmpx_ge_u16 vcc, 0x3fff, v57
    ds_read_b64 v[18:19], v18
    s_mov_b64 exec, -1
    v_cmpx_ge_u16 vcc, 0x3fff, v58
    ds_read_b64 v[20:21], v20
    s_mov_b64 exec, -1
    v_cmpx_ge_u16 vcc, 0x3fff, v59
    ds_read_b64 v[22:23], v22
    s_mov_b64 exec, -1
    s_waitcnt lgkmcnt(0)
    s_barrier
    s_waitcnt lgkmcnt(15)
    s_branch p2_tail
p2_drain0:
    v_cmpx_gt_i16 vcc, 0, v48
    ds_read_b64 v[0:1], v0
    s_mov_b64 exec, -1
    v_cmpx_gt_i16 vcc, 0, v49
    ds_read_b64 v[2:3], v2
    s_mov_b64 exec, -1
    v_cmpx_gt_i16 vcc, 0, v50
    ds_read_b64 v[4:5], v4
    s_mov_b64 exec, -1
    v_cmpx_gt_i16 vcc, 0, v51
    ds_read_b64 v[6:7], v6
    s_mov_b64 exec, -1
    v_cmpx_gt_i16 vcc, 0, v52
    ds_read_b64 v[8:9], v8
    s_mov_b64 exec, -1
    v_cmpx_gt_i16 vcc, 0, v53
    ds_read_b64 v[10:11], v10
    s_mov_b64 exec, -1
    v_cmpx_gt_i16 vcc, 0, v54
    ds_read_b64 v[12:13], v12
    s_mov_b64 exec, -1
    v_cmpx_gt_i16 vcc, 0, v55
    ds_read_b64 v[14:15], v14
    s_mov_b64 exec, -1
    v_cmpx_gt_i16 vcc, 0, v56
    ds_read_b64 v[16:17], v16
    s_mov_b64 exec, -1
    v_cmpx_gt_i16 vcc, 0, v57
    ds_read_b64 v[18:19], v18
    s_mov_b64 exec, -1
    v_cmpx_gt_i16 vcc, 0, v58
    ds_read_b64 v[20:21], v20
    s_mov_b64 exec, -1
    v_cmpx_gt_i16 vcc, 0, v59
    ds_read_b64 v[22:23], v22
    s_mov_b64 exec, -1
    v_cmpx_gt_i16 vcc, 0, v60
    ds_read_b64 v[24:25], v24
    s_mov_b64 exec, -1
    v_cmpx_gt_i16 vcc, 0, v61
    ds_read_b64 v[26:27], v26
    s_mov_b64 exec, -1
    v_cmpx_gt_i16 vcc, 0, v62
    ds_read_b64 v[28:29], v28
    s_mov_b64 exec, -1
    v_cmpx_gt_i16 vcc, 0, v63
    ds_read_b64 v[30:31], v30
    s_mov_b64 exec, -1
    v_cmpx_gt_i16 vcc, 0, v64
    ds_read_b64 v[32:33], v32
    s_mov_b64 exec, -1
    v_cmpx_gt_i16 vcc, 0, v65
    ds_read_b64 v[34:35], v34
    s_mov_b64 exec, -1
    v_cmpx_gt_i16 vcc, 0, v66
    ds_read_b64 v[36:37], v36
    s_mov_b64 exec, -1
    v_cmpx_gt_i16 vcc, 0, v67
    ds_read_b64 v[38:39], v38
    s_mov_b64 exec, -1
    v_cmpx_gt_i16 vcc, 0, v68
    ds_read_b64 v[40:41], v40
    s_mov_b64 exec, -1
    s_cmp_le_u32 s15, 7
    s_cbranch_scc1 p2_gd0
    v_cmpx_gt_i16 vcc, 0, v69
    ds_read_b64 v[42:43], v42
    s_mov_b64 exec, -1
    v_cmpx_gt_i16 vcc, 0, v70
    ds_read_b64 v[44:45], v44
    s_mov_b64 exec, -1
    v_cmpx_gt_i16 vcc, 0, v71
    ds_read_b64 v[46:47], v46
    s_mov_b64 exec, -1
p2_gd0:
    s_waitcnt lgkmcnt(15)
    v_ashrrev_i32 v122, 5, v48
    v_lshlrev_b16 v123, 2, v48
    v_lshlrev_b32 v124, 16, v0
    v_bitop3_b32 v122, v122, v113, v113 bitop3:0x0c
    v_and_b32 v125, 0xffff0000, v0
    v_lshlrev_b32 v126, 16, v1
    v_mul_f32 v122, v114, v122
    v_and_b32 v127, 0xffff0000, v1
    v_add_u32 v123, v123, v123
    v_pk_fma_f32 v[124:125], v[124:125], v[122:123], s[34:35] op_sel_hi:[1,0,1]
    v_pk_fma_f32 v[126:127], v[126:127], v[122:123], s[34:35] op_sel_hi:[1,0,1]
    v_lshl_add_u32 v124, v125, 16, v124
    v_lshl_add_u32 v125, v127, 16, v126
    s_waitcnt lgkmcnt(15)
    v_bitop3_b32 v115, v115, v116, v117 bitop3:0xfe
    v_lshl_add_u64 v[124:125], v[124:125], 0, s[36:37]
    v_cmpx_le_u32 vcc, 0x1000000, v48
    ds_add_rtn_u64 v[116:117], v123, v[124:125] offset:54272
    s_mov_b64 exec, -1
    v_ashrrev_i32 v122, 5, v49
    v_lshlrev_b16 v123, 2, v49
    v_lshlrev_b32 v124, 16, v2
    v_bitop3_b32 v122, v122, v113, v113 bitop3:0x0c
    v_and_b32 v125, 0xffff0000, v2
    v_lshlrev_b32 v126, 16, v3
    v_mul_f32 v122, v114, v122
    v_and_b32 v127, 0xffff0000, v3
    v_add_u32 v123, v123, v123
    v_pk_fma_f32 v[124:125], v[124:125], v[122:123], s[34:35] op_sel_hi:[1,0,1]
    v_pk_fma_f32 v[126:127], v[126:127], v[122:123], s[34:35] op_sel_hi:[1,0,1]
    v_lshl_add_u32 v124, v125, 16, v124
    v_lshl_add_u32 v125, v127, 16, v126
    s_waitcnt lgkmcnt(15)
    v_bitop3_b32 v115, v115, v118, v119 bitop3:0xfe
    v_lshl_add_u64 v[124:125], v[124:125], 0, s[36:37]
    v_cmpx_le_u32 vcc, 0x1000000, v49
    ds_add_rtn_u64 v[118:119], v123, v[124:125] offset:54272
    s_mov_b64 exec, -1
    v_ashrrev_i32 v122, 5, v50
    v_lshlrev_b16 v123, 2, v50
    v_lshlrev_b32 v124, 16, v4
    v_bitop3_b32 v122, v122, v113, v113 bitop3:0x0c
    v_and_b32 v125, 0xffff0000, v4
    v_lshlrev_b32 v126, 16, v5
    v_mul_f32 v122, v114, v122
    v_and_b32 v127, 0xffff0000, v5
    v_add_u32 v123, v123, v123
    v_pk_fma_f32 v[124:125], v[124:125], v[122:123], s[34:35] op_sel_hi:[1,0,1]
    v_pk_fma_f32 v[126:127], v[126:127], v[122:123], s[34:35] op_sel_hi:[1,0,1]
    v_lshl_add_u32 v124, v125, 16, v124
    v_lshl_add_u32 v125, v127, 16, v126
    s_waitcnt lgkmcnt(15)
    v_bitop3_b32 v115, v115, v120, v121 bitop3:0xfe
    v_lshl_add_u64 v[124:125], v[124:125], 0, s[36:37]
    v_cmpx_le_u32 vcc, 0x1000000, v50
    ds_add_rtn_u64 v[120:121], v123, v[124:125] offset:54272
    s_mov_b64 exec, -1
    s_waitcnt lgkmcnt(15)
    v_ashrrev_i32 v122, 5, v51
    v_lshlrev_b16 v123, 2, v51
    v_lshlrev_b32 v124, 16, v6
    v_bitop3_b32 v122, v122, v113, v113 bitop3:0x0c
    v_and_b32 v125, 0xffff0000, v6
    v_lshlrev_b32 v126, 16, v7
    v_mul_f32 v122, v114, v122
    v_and_b32 v127, 0xffff0000, v7
    v_add_u32 v123, v123, v123
    v_pk_fma_f32 v[124:125], v[124:125], v[122:123], s[34:35] op_sel_hi:[1,0,1]
    v_pk_fma_f32 v[126:127], v[126:127], v[122:123], s[34:35] op_sel_hi:[1,0,1]
    v_lshl_add_u32 v124, v125, 16, v124
    v_lshl_add_u32 v125, v127, 16, v126
    s_waitcnt lgkmcnt(2)
    v_bitop3_b32 v115, v115, v116, v117 bitop3:0xfe
    v_lshl_add_u64 v[124:125], v[124:125], 0, s[36:37]
    v_cmpx_le_u32 vcc, 0x1000000, v51
    ds_add_rtn_u64 v[116:117], v123, v[124:125] offset:54272
    s_mov_b64 exec, -1
    v_ashrrev_i32 v122, 5, v52
    v_lshlrev_b16 v123, 2, v52
    v_lshlrev_b32 v124, 16, v8
    v_bitop3_b32 v122, v122, v113, v113 bitop3:0x0c
    v_and_b32 v125, 0xffff0000, v8
    v_lshlrev_b32 v126, 16, v9
    v_mul_f32 v122, v114, v122
    v_and_b32 v127, 0xffff0000, v9
    v_add_u32 v123, v123, v123
    v_pk_fma_f32 v[124:125], v[124:125], v[122:123], s[34:35] op_sel_hi:[1,0,1]
    v_pk_fma_f32 v[126:127], v[126:127], v[122:123], s[34:35] op_sel_hi:[1,0,1]
    v_lshl_add_u32 v124, v125, 16, v124
    v_lshl_add_u32 v125, v127, 16, v126
    s_waitcnt lgkmcnt(2)
    v_bitop3_b32 v115, v115, v118, v119 bitop3:0xfe
    v_lshl_add_u64 v[124:125], v[124:125], 0, s[36:37]
    v_cmpx_le_u32 vcc, 0x1000000, v52
    ds_add_rtn_u64 v[118:119], v123, v[124:125] offset:54272
    s_mov_b64 exec, -1
    v_ashrrev_i32 v122, 5, v53
    v_lshlrev_b16 v123, 2, v53
    v_lshlrev_b32 v124, 16, v10
    v_bitop3_b32 v122, v122, v113, v113 bitop3:0x0c
    v_and_b32 v125, 0xffff0000, v10
    v_lshlrev_b32 v126, 16, v11
    v_mul_f32 v122, v114, v122
    v_and_b32 v127, 0xffff0000, v11
    v_add_u32 v123, v123, v123
    v_pk_fma_f32 v[124:125], v[124:125], v[122:123], s[34:35] op_sel_hi:[1,0,1]
    v_pk_fma_f32 v[126:127], v[126:127], v[122:123], s[34:35] op_sel_hi:[1,0,1]
    v_lshl_add_u32 v124, v125, 16, v124
    v_lshl_add_u32 v125, v127, 16, v126
    s_waitcnt lgkmcnt(2)
    v_bitop3_b32 v115, v115, v120, v121 bitop3:0xfe
    v_lshl_add_u64 v[124:125], v[124:125], 0, s[36:37]
    v_cmpx_le_u32 vcc, 0x1000000, v53
    ds_add_rtn_u64 v[120:121], v123, v[124:125] offset:54272
    s_mov_b64 exec, -1
    s_waitcnt lgkmcnt(15)
    v_ashrrev_i32 v122, 5, v54
    v_lshlrev_b16 v123, 2, v54
    v_lshlrev_b32 v124, 16, v12
    v_bitop3_b32 v122, v122, v113, v113 bitop3:0x0c
    v_and_b32 v125, 0xffff0000, v12
    v_lshlrev_b32 v126, 16, v13
    v_mul_f32 v122, v114, v122
    v_and_b32 v127, 0xffff0000, v13
    v_add_u32 v123, v123, v123
    v_pk_fma_f32 v[124:125], v[124:125], v[122:123], s[34:35] op_sel_hi:[1,0,1]
    v_pk_fma_f32 v[126:127], v[126:127], v[122:123], s[34:35] op_sel_hi:[1,0,1]
    v_lshl_add_u32 v124, v125, 16, v124
    v_lshl_add_u32 v125, v127, 16, v126
    s_waitcnt lgkmcnt(2)
    v_bitop3_b32 v115, v115, v116, v117 bitop3:0xfe
    v_lshl_add_u64 v[124:125], v[124:125], 0, s[36:37]
    v_cmpx_le_u32 vcc, 0x1000000, v54
    ds_add_rtn_u64 v[116:117], v123, v[124:125] offset:54272
    s_mov_b64 exec, -1
    v_ashrrev_i32 v122, 5, v55
    v_lshlrev_b16 v123, 2, v55
    v_lshlrev_b32 v124, 16, v14
    v_bitop3_b32 v122, v122, v113, v113 bitop3:0x0c
    v_and_b32 v125, 0xffff0000, v14
    v_lshlrev_b32 v126, 16, v15
    v_mul_f32 v122, v114, v122
    v_and_b32 v127, 0xffff0000, v15
    v_add_u32 v123, v123, v123
    v_pk_fma_f32 v[124:125], v[124:125], v[122:123], s[34:35] op_sel_hi:[1,0,1]
    v_pk_fma_f32 v[126:127], v[126:127], v[122:123], s[34:35] op_sel_hi:[1,0,1]
    v_lshl_add_u32 v124, v125, 16, v124
    v_lshl_add_u32 v125, v127, 16, v126
    s_waitcnt lgkmcnt(2)
    v_bitop3_b32 v115, v115, v118, v119 bitop3:0xfe
    v_lshl_add_u64 v[124:125], v[124:125], 0, s[36:37]
    v_cmpx_le_u32 vcc, 0x1000000, v55
    ds_add_rtn_u64 v[118:119], v123, v[124:125] offset:54272
    s_mov_b64 exec, -1
    v_ashrrev_i32 v122, 5, v56
    v_lshlrev_b16 v123, 2, v56
    v_lshlrev_b32 v124, 16, v16
    v_bitop3_b32 v122, v122, v113, v113 bitop3:0x0c
    v_and_b32 v125, 0xffff0000, v16
    v_lshlrev_b32 v126, 16, v17
    v_mul_f32 v122, v114, v122
    v_and_b32 v127, 0xffff0000, v17
    v_add_u32 v123, v123, v123
    v_pk_fma_f32 v[124:125], v[124:125], v[122:123], s[34:35] op_sel_hi:[1,0,1]
    v_pk_fma_f32 v[126:127], v[126:127], v[122:123], s[34:35] op_sel_hi:[1,0,1]
    v_lshl_add_u32 v124, v125, 16, v124
    v_lshl_add_u32 v125, v127, 16, v126
    s_waitcnt lgkmcnt(2)
    v_bitop3_b32 v115, v115, v120, v121 bitop3:0xfe
    v_lshl_add_u64 v[124:125], v[124:125], 0, s[36:37]
    v_cmpx_le_u32 vcc, 0x1000000, v56
    ds_add_rtn_u64 v[120:121], v123, v[124:125] offset:54272
    s_mov_b64 exec, -1
    s_waitcnt lgkmcnt(15)
    v_ashrrev_i32 v122, 5, v57
    v_lshlrev_b16 v123, 2, v57
    v_lshlrev_b32 v124, 16, v18
    v_bitop3_b32 v122, v122, v113, v113 bitop3:0x0c
    v_and_b32 v125, 0xffff0000, v18
    v_lshlrev_b32 v126, 16, v19
    v_mul_f32 v122, v114, v122
    v_and_b32 v127, 0xffff0000, v19
    v_add_u32 v123, v123, v123
    v_pk_fma_f32 v[124:125], v[124:125], v[122:123], s[34:35] op_sel_hi:[1,0,1]
    v_pk_fma_f32 v[126:127], v[126:127], v[122:123], s[34:35] op_sel_hi:[1,0,1]
    v_lshl_add_u32 v124, v125, 16, v124
    v_lshl_add_u32 v125, v127, 16, v126
    s_waitcnt lgkmcnt(2)
    v_bitop3_b32 v115, v115, v116, v117 bitop3:0xfe
    v_lshl_add_u64 v[124:125], v[124:125], 0, s[36:37]
    v_cmpx_le_u32 vcc, 0x1000000, v57
    ds_add_rtn_u64 v[116:117], v123, v[124:125] offset:54272
    s_mov_b64 exec, -1
    v_ashrrev_i32 v122, 5, v58
    v_lshlrev_b16 v123, 2, v58
    v_lshlrev_b32 v124, 16, v20
    v_bitop3_b32 v122, v122, v113, v113 bitop3:0x0c
    v_and_b32 v125, 0xffff0000, v20
    v_lshlrev_b32 v126, 16, v21
    v_mul_f32 v122, v114, v122
    v_and_b32 v127, 0xffff0000, v21
    v_add_u32 v123, v123, v123
    v_pk_fma_f32 v[124:125], v[124:125], v[122:123], s[34:35] op_sel_hi:[1,0,1]
    v_pk_fma_f32 v[126:127], v[126:127], v[122:123], s[34:35] op_sel_hi:[1,0,1]
    v_lshl_add_u32 v124, v125, 16, v124
    v_lshl_add_u32 v125, v127, 16, v126
    s_waitcnt lgkmcnt(2)
    v_bitop3_b32 v115, v115, v118, v119 bitop3:0xfe
    v_lshl_add_u64 v[124:125], v[124:125], 0, s[36:37]
    v_cmpx_le_u32 vcc, 0x1000000, v58
    ds_add_rtn_u64 v[118:119], v123, v[124:125] offset:54272
    s_mov_b64 exec, -1
    v_ashrrev_i32 v122, 5, v59
    v_lshlrev_b16 v123, 2, v59
    v_lshlrev_b32 v124, 16, v22
    v_bitop3_b32 v122, v122, v113, v113 bitop3:0x0c
    v_and_b32 v125, 0xffff0000, v22
    v_lshlrev_b32 v126, 16, v23
    v_mul_f32 v122, v114, v122
    v_and_b32 v127, 0xffff0000, v23
    v_add_u32 v123, v123, v123
    v_pk_fma_f32 v[124:125], v[124:125], v[122:123], s[34:35] op_sel_hi:[1,0,1]
    v_pk_fma_f32 v[126:127], v[126:127], v[122:123], s[34:35] op_sel_hi:[1,0,1]
    v_lshl_add_u32 v124, v125, 16, v124
    v_lshl_add_u32 v125, v127, 16, v126
    s_waitcnt lgkmcnt(2)
    v_bitop3_b32 v115, v115, v120, v121 bitop3:0xfe
    v_lshl_add_u64 v[124:125], v[124:125], 0, s[36:37]
    v_cmpx_le_u32 vcc, 0x1000000, v59
    ds_add_rtn_u64 v[120:121], v123, v[124:125] offset:54272
    s_mov_b64 exec, -1
    s_waitcnt lgkmcnt(15)
    v_ashrrev_i32 v122, 5, v60
    v_lshlrev_b16 v123, 2, v60
    v_lshlrev_b32 v124, 16, v24
    v_bitop3_b32 v122, v122, v113, v113 bitop3:0x0c
    v_and_b32 v125, 0xffff0000, v24
    v_lshlrev_b32 v126, 16, v25
    v_mul_f32 v122, v114, v122
    v_and_b32 v127, 0xffff0000, v25
    v_add_u32 v123, v123, v123
    v_pk_fma_f32 v[124:125], v[124:125], v[122:123], s[34:35] op_sel_hi:[1,0,1]
    v_pk_fma_f32 v[126:127], v[126:127], v[122:123], s[34:35] op_sel_hi:[1,0,1]
    v_lshl_add_u32 v124, v125, 16, v124
    v_lshl_add_u32 v125, v127, 16, v126
    s_waitcnt lgkmcnt(2)
    v_bitop3_b32 v115, v115, v116, v117 bitop3:0xfe
    v_lshl_add_u64 v[124:125], v[124:125], 0, s[36:37]
    v_cmpx_le_u32 vcc, 0x1000000, v60
    ds_add_rtn_u64 v[116:117], v123, v[124:125] offset:54272
    s_mov_b64 exec, -1
    v_ashrrev_i32 v122, 5, v61
    v_lshlrev_b16 v123, 2, v61
    v_lshlrev_b32 v124, 16, v26
    v_bitop3_b32 v122, v122, v113, v113 bitop3:0x0c
    v_and_b32 v125, 0xffff0000, v26
    v_lshlrev_b32 v126, 16, v27
    v_mul_f32 v122, v114, v122
    v_and_b32 v127, 0xffff0000, v27
    v_add_u32 v123, v123, v123
    v_pk_fma_f32 v[124:125], v[124:125], v[122:123], s[34:35] op_sel_hi:[1,0,1]
    v_pk_fma_f32 v[126:127], v[126:127], v[122:123], s[34:35] op_sel_hi:[1,0,1]
    v_lshl_add_u32 v124, v125, 16, v124
    v_lshl_add_u32 v125, v127, 16, v126
    s_waitcnt lgkmcnt(2)
    v_bitop3_b32 v115, v115, v118, v119 bitop3:0xfe
    v_lshl_add_u64 v[124:125], v[124:125], 0, s[36:37]
    v_cmpx_le_u32 vcc, 0x1000000, v61
    ds_add_rtn_u64 v[118:119], v123, v[124:125] offset:54272
    s_mov_b64 exec, -1
    v_ashrrev_i32 v122, 5, v62
    v_lshlrev_b16 v123, 2, v62
    v_lshlrev_b32 v124, 16, v28
    v_bitop3_b32 v122, v122, v113, v113 bitop3:0x0c
    v_and_b32 v125, 0xffff0000, v28
    v_lshlrev_b32 v126, 16, v29
    v_mul_f32 v122, v114, v122
    v_and_b32 v127, 0xffff0000, v29
    v_add_u32 v123, v123, v123
    v_pk_fma_f32 v[124:125], v[124:125], v[122:123], s[34:35] op_sel_hi:[1,0,1]
    v_pk_fma_f32 v[126:127], v[126:127], v[122:123], s[34:35] op_sel_hi:[1,0,1]
    v_lshl_add_u32 v124, v125, 16, v124
    v_lshl_add_u32 v125, v127, 16, v126
    s_waitcnt lgkmcnt(2)
    v_bitop3_b32 v115, v115, v120, v121 bitop3:0xfe
    v_lshl_add_u64 v[124:125], v[124:125], 0, s[36:37]
    v_cmpx_le_u32 vcc, 0x1000000, v62
    ds_add_rtn_u64 v[120:121], v123, v[124:125] offset:54272
    s_mov_b64 exec, -1
    s_waitcnt lgkmcnt(15)
    v_ashrrev_i32 v122, 5, v63
    v_lshlrev_b16 v123, 2, v63
    v_lshlrev_b32 v124, 16, v30
    v_bitop3_b32 v122, v122, v113, v113 bitop3:0x0c
    v_and_b32 v125, 0xffff0000, v30
    v_lshlrev_b32 v126, 16, v31
    v_mul_f32 v122, v114, v122
    v_and_b32 v127, 0xffff0000, v31
    v_add_u32 v123, v123, v123
    v_pk_fma_f32 v[124:125], v[124:125], v[122:123], s[34:35] op_sel_hi:[1,0,1]
    v_pk_fma_f32 v[126:127], v[126:127], v[122:123], s[34:35] op_sel_hi:[1,0,1]
    v_lshl_add_u32 v124, v125, 16, v124
    v_lshl_add_u32 v125, v127, 16, v126
    s_waitcnt lgkmcnt(2)
    v_bitop3_b32 v115, v115, v116, v117 bitop3:0xfe
    v_lshl_add_u64 v[124:125], v[124:125], 0, s[36:37]
    v_cmpx_le_u32 vcc, 0x1000000, v63
    ds_add_rtn_u64 v[116:117], v123, v[124:125] offset:54272
    s_mov_b64 exec, -1
    v_ashrrev_i32 v122, 5, v64
    v_lshlrev_b16 v123, 2, v64
    v_lshlrev_b32 v124, 16, v32
    v_bitop3_b32 v122, v122, v113, v113 bitop3:0x0c
    v_and_b32 v125, 0xffff0000, v32
    v_lshlrev_b32 v126, 16, v33
    v_mul_f32 v122, v114, v122
    v_and_b32 v127, 0xffff0000, v33
    v_add_u32 v123, v123, v123
    v_pk_fma_f32 v[124:125], v[124:125], v[122:123], s[34:35] op_sel_hi:[1,0,1]
    v_pk_fma_f32 v[126:127], v[126:127], v[122:123], s[34:35] op_sel_hi:[1,0,1]
    v_lshl_add_u32 v124, v125, 16, v124
    v_lshl_add_u32 v125, v127, 16, v126
    s_waitcnt lgkmcnt(2)
    v_bitop3_b32 v115, v115, v118, v119 bitop3:0xfe
    v_lshl_add_u64 v[124:125], v[124:125], 0, s[36:37]
    v_cmpx_le_u32 vcc, 0x1000000, v64
    ds_add_rtn_u64 v[118:119], v123, v[124:125] offset:54272
    s_mov_b64 exec, -1
    v_ashrrev_i32 v122, 5, v65
    v_lshlrev_b16 v123, 2, v65
    v_lshlrev_b32 v124, 16, v34
    v_bitop3_b32 v122, v122, v113, v113 bitop3:0x0c
    v_and_b32 v125, 0xffff0000, v34
    v_lshlrev_b32 v126, 16, v35
    v_mul_f32 v122, v114, v122
    v_and_b32 v127, 0xffff0000, v35
    v_add_u32 v123, v123, v123
    v_pk_fma_f32 v[124:125], v[124:125], v[122:123], s[34:35] op_sel_hi:[1,0,1]
    v_pk_fma_f32 v[126:127], v[126:127], v[122:123], s[34:35] op_sel_hi:[1,0,1]
    v_lshl_add_u32 v124, v125, 16, v124
    v_lshl_add_u32 v125, v127, 16, v126
    s_waitcnt lgkmcnt(2)
    v_bitop3_b32 v115, v115, v120, v121 bitop3:0xfe
    v_lshl_add_u64 v[124:125], v[124:125], 0, s[36:37]
    v_cmpx_le_u32 vcc, 0x1000000, v65
    ds_add_rtn_u64 v[120:121], v123, v[124:125] offset:54272
    s_mov_b64 exec, -1
    s_waitcnt lgkmcnt(15)
    v_ashrrev_i32 v122, 5, v66
    v_lshlrev_b16 v123, 2, v66
    v_lshlrev_b32 v124, 16, v36
    v_bitop3_b32 v122, v122, v113, v113 bitop3:0x0c
    v_and_b32 v125, 0xffff0000, v36
    v_lshlrev_b32 v126, 16, v37
    v_mul_f32 v122, v114, v122
    v_and_b32 v127, 0xffff0000, v37
    v_add_u32 v123, v123, v123
    v_pk_fma_f32 v[124:125], v[124:125], v[122:123], s[34:35] op_sel_hi:[1,0,1]
    v_pk_fma_f32 v[126:127], v[126:127], v[122:123], s[34:35] op_sel_hi:[1,0,1]
    v_lshl_add_u32 v124, v125, 16, v124
    v_lshl_add_u32 v125, v127, 16, v126
    s_waitcnt lgkmcnt(2)
    v_bitop3_b32 v115, v115, v116, v117 bitop3:0xfe
    v_lshl_add_u64 v[124:125], v[124:125], 0, s[36:37]
    v_cmpx_le_u32 vcc, 0x1000000, v66
    ds_add_rtn_u64 v[116:117], v123, v[124:125] offset:54272
    s_mov_b64 exec, -1
    v_ashrrev_i32 v122, 5, v67
    v_lshlrev_b16 v123, 2, v67
    v_lshlrev_b32 v124, 16, v38
    v_bitop3_b32 v122, v122, v113, v113 bitop3:0x0c
    v_and_b32 v125, 0xffff0000, v38
    v_lshlrev_b32 v126, 16, v39
    v_mul_f32 v122, v114, v122
    v_and_b32 v127, 0xffff0000, v39
    v_add_u32 v123, v123, v123
    v_pk_fma_f32 v[124:125], v[124:125], v[122:123], s[34:35] op_sel_hi:[1,0,1]
    v_pk_fma_f32 v[126:127], v[126:127], v[122:123], s[34:35] op_sel_hi:[1,0,1]
    v_lshl_add_u32 v124, v125, 16, v124
    v_lshl_add_u32 v125, v127, 16, v126
    s_waitcnt lgkmcnt(2)
    v_bitop3_b32 v115, v115, v118, v119 bitop3:0xfe
    v_lshl_add_u64 v[124:125], v[124:125], 0, s[36:37]
    v_cmpx_le_u32 vcc, 0x1000000, v67
    ds_add_rtn_u64 v[118:119], v123, v[124:125] offset:54272
    s_mov_b64 exec, -1
    v_ashrrev_i32 v122, 5, v68
    v_lshlrev_b16 v123, 2, v68
    v_lshlrev_b32 v124, 16, v40
    v_bitop3_b32 v122, v122, v113, v113 bitop3:0x0c
    v_and_b32 v125, 0xffff0000, v40
    v_lshlrev_b32 v126, 16, v41
    v_mul_f32 v122, v114, v122
    v_and_b32 v127, 0xffff0000, v41
    v_add_u32 v123, v123, v123
    v_pk_fma_f32 v[124:125], v[124:125], v[122:123], s[34:35] op_sel_hi:[1,0,1]
    v_pk_fma_f32 v[126:127], v[126:127], v[122:123], s[34:35] op_sel_hi:[1,0,1]
    v_lshl_add_u32 v124, v125, 16, v124
    v_lshl_add_u32 v125, v127, 16, v126
    s_waitcnt lgkmcnt(2)
    v_bitop3_b32 v115, v115, v120, v121 bitop3:0xfe
    v_lshl_add_u64 v[124:125], v[124:125], 0, s[36:37]
    v_cmpx_le_u32 vcc, 0x1000000, v68
    ds_add_rtn_u64 v[120:121], v123, v[124:125] offset:54272
    s_mov_b64 exec, -1
    s_cmp_le_u32 s15, 7
    s_cbranch_scc1 p2_nad0
    s_waitcnt lgkmcnt(15)
    v_ashrrev_i32 v122, 5, v69
    v_lshlrev_b16 v123, 2, v69
    v_lshlrev_b32 v124, 16, v42
    v_bitop3_b32 v122, v122, v113, v113 bitop3:0x0c
    v_and_b32 v125, 0xffff0000, v42
    v_lshlrev_b32 v126, 16, v43
    v_mul_f32 v122, v114, v122
    v_and_b32 v127, 0xffff0000, v43
    v_add_u32 v123, v123, v123
    v_pk_fma_f32 v[124:125], v[124:125], v[122:123], s[34:35] op_sel_hi:[1,0,1]
    v_pk_fma_f32 v[126:127], v[126:127], v[122:123], s[34:35] op_sel_hi:[1,0,1]
    v_lshl_add_u32 v124, v125, 16, v124
    v_lshl_add_u32 v125, v127, 16, v126
    s_waitcnt lgkmcnt(2)
    v_bitop3_b32 v115, v115, v116, v117 bitop3:0xfe
    v_lshl_add_u64 v[124:125], v[124:125], 0, s[36:37]
    v_cmpx_le_u32 vcc, 0x1000000, v69
    ds_add_rtn_u64 v[116:117], v123, v[124:125] offset:54272
    s_mov_b64 exec, -1
    v_ashrrev_i32 v122, 5, v70
    v_lshlrev_b16 v123, 2, v70
    v_lshlrev_b32 v124, 16, v44
    v_bitop3_b32 v122, v122, v113, v113 bitop3:0x0c
    v_and_b32 v125, 0xffff0000, v44
    v_lshlrev_b32 v126, 16, v45
    v_mul_f32 v122, v114, v122
    v_and_b32 v127, 0xffff0000, v45
    v_add_u32 v123, v123, v123
    v_pk_fma_f32 v[124:125], v[124:125], v[122:123], s[34:35] op_sel_hi:[1,0,1]
    v_pk_fma_f32 v[126:127], v[126:127], v[122:123], s[34:35] op_sel_hi:[1,0,1]
    v_lshl_add_u32 v124, v125, 16, v124
    v_lshl_add_u32 v125, v127, 16, v126
    s_waitcnt lgkmcnt(2)
    v_bitop3_b32 v115, v115, v118, v119 bitop3:0xfe
    v_lshl_add_u64 v[124:125], v[124:125], 0, s[36:37]
    v_cmpx_le_u32 vcc, 0x1000000, v70
    ds_add_rtn_u64 v[118:119], v123, v[124:125] offset:54272
    s_mov_b64 exec, -1
    v_ashrrev_i32 v122, 5, v71
    v_lshlrev_b16 v123, 2, v71
    v_lshlrev_b32 v124, 16, v46
    v_bitop3_b32 v122, v122, v113, v113 bitop3:0x0c
    v_and_b32 v125, 0xffff0000, v46
    v_lshlrev_b32 v126, 16, v47
    v_mul_f32 v122, v114, v122
    v_and_b32 v127, 0xffff0000, v47
    v_add_u32 v123, v123, v123
    v_pk_fma_f32 v[124:125], v[124:125], v[122:123], s[34:35] op_sel_hi:[1,0,1]
    v_pk_fma_f32 v[126:127], v[126:127], v[122:123], s[34:35] op_sel_hi:[1,0,1]
    v_lshl_add_u32 v124, v125, 16, v124
    v_lshl_add_u32 v125, v127, 16, v126
    s_waitcnt lgkmcnt(2)
    v_bitop3_b32 v115, v115, v120, v121 bitop3:0xfe
    v_lshl_add_u64 v[124:125], v[124:125], 0, s[36:37]
    v_cmpx_le_u32 vcc, 0x1000000, v71
    ds_add_rtn_u64 v[120:121], v123, v[124:125] offset:54272
    s_mov_b64 exec, -1
p2_nad0:
    s_branch p2_fin
p2_topf:
    s_cmp_eq_u32 s60, 10
    s_cbranch_scc1 p2_drain1
    v_cmpx_gt_i16 vcc, 0, v48
    ds_read_b64 v[0:1], v0
    s_mov_b64 exec, -1
    v_cmpx_gt_i16 vcc, 0, v49
    ds_read_b64 v[2:3], v2
    s_mov_b64 exec, -1
    v_cmpx_gt_i16 vcc, 0, v50
    ds_read_b64 v[4:5], v4
    s_mov_b64 exec, -1
    v_cmpx_gt_i16 vcc, 0, v51
    ds_read_b64 v[6:7], v6
    s_mov_b64 exec, -1
    v_cmpx_gt_i16 vcc, 0, v52
    ds_read_b64 v[8:9], v8
    s_mov_b64 exec, -1
    v_cmpx_gt_i16 vcc, 0, v53
    ds_read_b64 v[10:11], v10
    s_mov_b64 exec, -1
    v_cmpx_gt_i16 vcc, 0, v54
    ds_read_b64 v[12:13], v12
    s_mov_b64 exec, -1
    v_cmpx_gt_i16 vcc, 0, v55
    ds_read_b64 v[14:15], v14
    s_mov_b64 exec, -1
    v_cmpx_gt_i16 vcc, 0, v56
    ds_read_b64 v[16:17], v16
    s_mov_b64 exec, -1
    v_cmpx_gt_i16 vcc, 0, v57
    ds_read_b64 v[18:19], v18
    s_mov_b64 exec, -1
    v_cmpx_gt_i16 vcc, 0, v58
    ds_read_b64 v[20:21], v20
    s_mov_b64 exec, -1
    v_cmpx_gt_i16 vcc, 0, v59
    ds_read_b64 v[22:23], v22
    s_mov_b64 exec, -1
    s_cmp_ge_u32 s10, 9
    s_cbranch_scc1 p2_nm1m0a
    v_lshrrev_b32 v84, 1, v112
    s_add_u32 s44, s20, s42
    buffer_load_dwordx2 v[84:85], v84, s[4:7], s44 offen
p2_nm1m0a:
    buffer_load_dwordx4 v[72:75], v112, s[4:7], s20 offen offset:0
    buffer_load_dwordx4 v[76:79], v112, s[4:7], s20 offen offset:1024
    buffer_load_dwordx4 v[80:83], v112, s[4:7], s20 offen offset:2048
    v_cmpx_gt_i16 vcc, 0, v60
    ds_read_b64 v[24:25], v24
    s_mov_b64 exec, -1
    v_cmpx_gt_i16 vcc, 0, v61
    ds_read_b64 v[26:27], v26
    s_mov_b64 exec, -1
    v_cmpx_gt_i16 vcc, 0, v62
    ds_read_b64 v[28:29], v28
    s_mov_b64 exec, -1
    v_cmpx_gt_i16 vcc, 0, v63
    ds_read_b64 v[30:31], v30
    s_mov_b64 exec, -1
    v_cmpx_gt_i16 vcc, 0, v64
    ds_read_b64 v[32:33], v32
    s_mov_b64 exec, -1
    v_cmpx_gt_i16 vcc, 0, v65
    ds_read_b64 v[34:35], v34
    s_mov_b64 exec, -1
    v_cmpx_gt_i16 vcc, 0, v66
    ds_read_b64 v[36:37], v36
    s_mov_b64 exec, -1
    v_cmpx_gt_i16 vcc, 0, v67
    ds_read_b64 v[38:39], v38
    s_mov_b64 exec, -1
    v_cmpx_gt_i16 vcc, 0, v68
    ds_read_b64 v[40:41], v40
    s_mov_b64 exec, -1
    s_cmp_le_u32 s15, 7
    s_cbranch_scc1 p2_g1r27
    v_cmpx_gt_i16 vcc, 0, v69
    ds_read_b64 v[42:43], v42
    s_mov_b64 exec, -1
    v_cmpx_gt_i16 vcc, 0, v70
    ds_read_b64 v[44:45], v44
    s_mov_b64 exec, -1
    v_cmpx_gt_i16 vcc, 0, v71
    ds_read_b64 v[46:47], v46
    s_mov_b64 exec, -1
p2_g1r27:
    s_waitcnt lgkmcnt(15)
    v_ashrrev_i32 v122, 5, v48
    v_lshlrev_b16 v123, 2, v48
    v_cndmask_b32 v126, v0, v1, s[66:67]
    v_bitop3_b32 v122, v122, v113, v113 bitop3:0x0c
    v_lshlrev_b32 v124, 16, v126
    v_mul_f32 v122, v114, v122
    v_and_b32 v125, 0xffff0000, v126
    v_add_u32 v123, v123, v123
    v_mul_f32 v124, v122, v124
    v_mul_f32 v125, v122, v125
    v_cmpx_le_u32 vcc, 0x1000000, v48
    ds_add_f32 v123, v124 offset:54272
    ds_add_f32 v123, v125 offset:54276
    s_mov_b64 exec, -1
    v_ashrrev_i32 v122, 5, v49
    v_lshlrev_b16 v123, 2, v49
    v_cndmask_b32 v126, v2, v3, s[66:67]
    v_bitop3_b32 v122, v122, v113, v113 bitop3:0x0c
    v_lshlrev_b32 v124, 16, v126
    v_mul_f32 v122, v114, v122
    v_and_b32 v125, 0xffff0000, v126
    v_add_u32 v123, v123, v123
    v_mul_f32 v124, v122, v124
    v_mul_f32 v125, v122, v125
    v_cmpx_le_u32 vcc, 0x1000000, v49
    ds_add_f32 v123, v124 offset:54272
    ds_add_f32 v123, v125 offset:54276
    s_mov_b64 exec, -1
    v_ashrrev_i32 v122, 5, v50
    v_lshlrev_b16 v123, 2, v50
    v_cndmask_b32 v126, v4, v5, s[66:67]
    v_bitop3_b32 v122, v122, v113, v113 bitop3:0x0c
    v_lshlrev_b32 v124, 16, v126
    v_mul_f32 v122, v114, v122
    v_and_b32 v125, 0xffff0000, v126
    v_add_u32 v123, v123, v123
    v_mul_f32 v124, v122, v124
    v_mul_f32 v125, v122, v125
    v_cmpx_le_u32 vcc, 0x1000000, v50
    ds_add_f32 v123, v124 offset:54272
    ds_add_f32 v123, v125 offset:54276
    s_mov_b64 exec, -1
    v_bfe_u32 v0, v102, 14, 4
    v_lshrrev_b32 v1, 18, v102
    v_and_b32 v102, 0x3fff, v102
    v_mad_u32_u24 v0, v0, s63, v1
    v_lshl_or_b32 v102, v0, 14, v102
    buffer_load_dwordx4 v[0:3], v102, s[68:71], 0 offen
    s_waitcnt lgkmcnt(15)
    v_ashrrev_i32 v122, 5, v51
    v_lshlrev_b16 v123, 2, v51
    v_cndmask_b32 v126, v6, v7, s[66:67]
    v_bitop3_b32 v122, v122, v113, v113 bitop3:0x0c
    v_lshlrev_b32 v124, 16, v126
    v_mul_f32 v122, v114, v122
    v_and_b32 v125, 0xffff0000, v126
    v_add_u32 v123, v123, v123
    v_mul_f32 v124, v122, v124
    v_mul_f32 v125, v122, v125
    v_cmpx_le_u32 vcc, 0x1000000, v51
    ds_add_f32 v123, v124 offset:54272
    ds_add_f32 v123, v125 offset:54276
    s_mov_b64 exec, -1
    v_ashrrev_i32 v122, 5, v52
    v_lshlrev_b16 v123, 2, v52
    v_cndmask_b32 v126, v8, v9, s[66:67]
    v_bitop3_b32 v122, v122, v113, v113 bitop3:0x0c
    v_lshlrev_b32 v124, 16, v126
    v_mul_f32 v122, v114, v122
    v_and_b32 v125, 0xffff0000, v126
    v_add_u32 v123, v123, v123
    v_mul_f32 v124, v122, v124
    v_mul_f32 v125, v122, v125
    v_cmpx_le_u32 vcc, 0x1000000, v52
    ds_add_f32 v123, v124 offset:54272
    ds_add_f32 v123, v125 offset:54276
    s_mov_b64 exec, -1
    v_ashrrev_i32 v122, 5, v53
    v_lshlrev_b16 v123, 2, v53
    v_cndmask_b32 v126, v10, v11, s[66:67]
    v_bitop3_b32 v122, v122, v113, v113 bitop3:0x0c
    v_lshlrev_b32 v124, 16, v126
    v_mul_f32 v122, v114, v122
    v_and_b32 v125, 0xffff0000, v126
    v_add_u32 v123, v123, v123
    v_mul_f32 v124, v122, v124
    v_mul_f32 v125, v122, v125
    v_cmpx_le_u32 vcc, 0x1000000, v53
    ds_add_f32 v123, v124 offset:54272
    ds_add_f32 v123, v125 offset:54276
    s_mov_b64 exec, -1
    v_bfe_u32 v6, v103, 14, 4
    v_lshrrev_b32 v7, 18, v103
    v_and_b32 v103, 0x3fff, v103
    v_mad_u32_u24 v6, v6, s63, v7
    v_lshl_or_b32 v103, v6, 14, v103
    buffer_load_dwordx4 v[6:9], v103, s[68:71], 0 offen
    s_waitcnt lgkmcnt(12)
    s_barrier
    s_waitcnt vmcnt(6)
    s_mov_b32 m0, s23
    v_mov_b32 v53, 0x3c000
    s_movk_i32 s44, 512
    v_sub_u32_sdwa v4, v111, v110 dst_sel:DWORD dst_unused:UNUSED_PAD src0_sel:WORD_0 src1_sel:WORD_0
    v_sub_u32_sdwa v5, v111, v110 dst_sel:DWORD dst_unused:UNUSED_PAD src0_sel:WORD_1 src1_sel:WORD_1
    v_med3_i32 v4, v4, 0, s44
    v_med3_i32 v5, v5, 0, s44
    v_add_u32 v48, v4, v5
    ds_write_addtid_b32 v53 offset:0
    ds_write_addtid_b32 v53 offset:256
    ds_write_addtid_b32 v53 offset:512
    ds_write_addtid_b32 v53 offset:768
    ds_write_addtid_b32 v53 offset:1024
    ds_write_addtid_b32 v53 offset:1280
    ds_write_addtid_b32 v53 offset:1536
    ds_write_addtid_b32 v53 offset:1792
    v_bfe_i32 v53, v112, 6, 1
    v_lshrrev_b32 v49, 6, v112
    v_bitop3_b32 v53, v53, 15, s10 bitop3:0x6a
    v_lshl_or_b32 v49, v49, 4, v53
    v_and_b32 v53, 0x30, v112
    v_lshl_or_b32 v53, v49, 6, v53
    v_lshlrev_b32 v53, 15, v53
    s_nop 1
    v_add_u32_dpp v48, v48, v48 row_shr:1 row_mask:0xf bank_mask:0xf bound_ctrl:0
    s_nop 1
    v_add_u32_dpp v48, v48, v48 row_shr:2 row_mask:0xf bank_mask:0xf bound_ctrl:0
    s_nop 1
    v_add_u32_dpp v48, v48, v48 row_shr:4 row_mask:0xf bank_mask:0xf bound_ctrl:0
    s_nop 1
    v_add_u32_dpp v48, v48, v48 row_shr:8 row_mask:0xf bank_mask:0xf bound_ctrl:0
    s_nop 1
    v_add_u32_dpp v48, v48, v48 row_bcast:15 row_mask:0xa bank_mask:0xf
    s_nop 1
    v_add_u32_dpp v48, v48, v48 row_bcast:31 row_mask:0xc bank_mask:0xf
    s_nop 1
    s_nop 0
    v_readlane_b32 s38, v48, 63
    v_sub_u32 v50, v48, v5
    v_sub_u32 v49, v50, v4
    v_sub_u32 v10, 512, v49
    v_mad_u32_u16 v51, v110, 16, v53
    v_med3_i32 v10, v10, 0, v4
    v_lshl_add_u32 v49, v49, 2, s23
    v_sub_u32 v11, 512, v50
    v_mad_u32_u16 v52, v110, 16, v53 op_sel:[1,0,0,0]
    v_med3_i32 v11, v11, 0, v5
    v_lshl_add_u32 v50, v50, 2, s23
    v_lshl_add_u32 v48, v11, 16, v10
    v_add_u32 v52, 262144, v52
    v_add_u32 v110, v110, v48
    s_min_u32 s17, s38, 512
    s_add_u32 s17, s17, 63
    s_lshr_b32 s17, s17, 6
p2_x1x_0:
    v_cmpx_lt_i32 vcc, 0, v10
    s_cbranch_execz p2_y1x_0
    ds_write_b32 v49, v51 offset:0
    v_add_u32 v51, 16, v51
    v_cmpx_lt_i32 vcc, 1, v10
    s_cbranch_execz p2_y1x_0
    ds_write_b32 v49, v51 offset:4
    v_add_u32 v51, 16, v51
    v_cmpx_lt_i32 vcc, 2, v10
    s_cbranch_execz p2_y1x_0
    ds_write_b32 v49, v51 offset:8
    v_add_u32 v51, 16, v51
    v_cmpx_lt_i32 vcc, 3, v10
    s_cbranch_execz p2_y1x_0
    ds_write_b32 v49, v51 offset:12
    v_add_u32 v51, 16, v51
    v_cmpx_lt_i32 vcc, 4, v10
    s_cbranch_execz p2_y1x_0
    ds_write_b32 v49, v51 offset:16
    v_add_u32 v51, 16, v51
    v_cmpx_lt_i32 vcc, 5, v10
    s_cbranch_execz p2_y1x_0
    ds_write_b32 v49, v51 offset:20
    v_add_u32 v51, 16, v51
    v_cmpx_lt_i32 vcc, 6, v10
    s_cbranch_execz p2_y1x_0
    ds_write_b32 v49, v51 offset:24
    v_add_u32 v51, 16, v51
    v_cmpx_lt_i32 vcc, 7, v10
    s_cbranch_execz p2_y1x_0
    ds_write_b32 v49, v51 offset:28
    v_add_u32 v51, 16, v51
    v_subrev_u32 v10, 8, v10
    v_add_u32 v49, 32, v49
    s_branch p2_x1x_0
p2_y1x_0:
    s_mov_b64 exec, -1
p2_x1x_1:
    v_cmpx_lt_i32 vcc, 0, v11
    s_cbranch_execz p2_y1x_1
    ds_write_b32 v50, v52 offset:0
    v_add_u32 v52, 16, v52
    v_cmpx_lt_i32 vcc, 1, v11
    s_cbranch_execz p2_y1x_1
    ds_write_b32 v50, v52 offset:4
    v_add_u32 v52, 16, v52
    v_cmpx_lt_i32 vcc, 2, v11
    s_cbranch_execz p2_y1x_1
    ds_write_b32 v50, v52 offset:8
    v_add_u32 v52, 16, v52
    v_cmpx_lt_i32 vcc, 3, v11
    s_cbranch_execz p2_y1x_1
    ds_write_b32 v50, v52 offset:12
    v_add_u32 v52, 16, v52
    v_cmpx_lt_i32 vcc, 4, v11
    s_cbranch_execz p2_y1x_1
    ds_write_b32 v50, v52 offset:16
    v_add_u32 v52, 16, v52
    v_cmpx_lt_i32 vcc, 5, v11
    s_cbranch_execz p2_y1x_1
    ds_write_b32 v50, v52 offset:20
    v_add_u32 v52, 16, v52
    v_cmpx_lt_i32 vcc, 6, v11
    s_cbranch_execz p2_y1x_1
    ds_write_b32 v50, v52 offset:24
    v_add_u32 v52, 16, v52
    v_cmpx_lt_i32 vcc, 7, v11
    s_cbranch_execz p2_y1x_1
    ds_write_b32 v50, v52 offset:28
    v_add_u32 v52, 16, v52
    v_subrev_u32 v11, 8, v11
    v_add_u32 v50, 32, v50
    s_branch p2_x1x_1
p2_y1x_1:
    s_mov_b64 exec, -1
    s_cmp_lt_u32 s38, 512
    s_cbranch_scc1 p2_nomore1x
    v_cmp_lt_u32_sdwa s[44:45], v110, v111 src0_sel:WORD_0 src1_sel:WORD_0
    v_cmp_lt_u32_sdwa s[46:47], v110, v111 src0_sel:WORD_1 src1_sel:WORD_1
    s_nop 0
    s_or_b64 s[44:45], s[44:45], s[46:47]
    s_cbranch_scc0 p2_nomore1x
    v_mov_b32 v49, s19
    v_mov_b32 v50, 1
    ds_write_b32 v49, v50 offset:53760
p2_nomore1x:
    s_waitcnt lgkmcnt(15)
    v_ashrrev_i32 v122, 5, v54
    v_lshlrev_b16 v123, 2, v54
    v_cndmask_b32 v126, v12, v13, s[66:67]
    v_bitop3_b32 v122, v122, v113, v113 bitop3:0x0c
    v_lshlrev_b32 v124, 16, v126
    v_mul_f32 v122, v114, v122
    v_and_b32 v125, 0xffff0000, v126
    v_add_u32 v123, v123, v123
    v_mul_f32 v124, v122, v124
    v_mul_f32 v125, v122, v125
    v_cmpx_le_u32 vcc, 0x1000000, v54
    ds_add_f32 v123, v124 offset:54272
    ds_add_f32 v123, v125 offset:54276
    s_mov_b64 exec, -1
    v_ashrrev_i32 v122, 5, v55
    v_lshlrev_b16 v123, 2, v55
    v_cndmask_b32 v126, v14, v15, s[66:67]
    v_bitop3_b32 v122, v122, v113, v113 bitop3:0x0c
    v_lshlrev_b32 v124, 16, v126
    v_mul_f32 v122, v114, v122
    v_and_b32 v125, 0xffff0000, v126
    v_add_u32 v123, v123, v123
    v_mul_f32 v124, v122, v124
    v_mul_f32 v125, v122, v125
    v_cmpx_le_u32 vcc, 0x1000000, v55
    ds_add_f32 v123, v124 offset:54272
    ds_add_f32 v123, v125 offset:54276
    s_mov_b64 exec, -1
    v_ashrrev_i32 v122, 5, v56
    v_lshlrev_b16 v123, 2, v56
    v_cndmask_b32 v126, v16, v17, s[66:67]
    v_bitop3_b32 v122, v122, v113, v113 bitop3:0x0c
    v_lshlrev_b32 v124, 16, v126
    v_mul_f32 v122, v114, v122
    v_and_b32 v125, 0xffff0000, v126
    v_add_u32 v123, v123, v123
    v_mul_f32 v124, v122, v124
    v_mul_f32 v125, v122, v125
    v_cmpx_le_u32 vcc, 0x1000000, v56
    ds_add_f32 v123, v124 offset:54272
    ds_add_f32 v123, v125 offset:54276
    s_mov_b64 exec, -1
    v_bfe_u32 v12, v104, 14, 4
    v_lshrrev_b32 v13, 18, v104
    v_and_b32 v104, 0x3fff, v104
    v_mad_u32_u24 v12, v12, s63, v13
    v_lshl_or_b32 v104, v12, 14, v104
    buffer_load_dwordx4 v[12:15], v104, s[68:71], 0 offen
    s_waitcnt lgkmcnt(15)
    v_ashrrev_i32 v122, 5, v57
    v_lshlrev_b16 v123, 2, v57
    v_cndmask_b32 v126, v18, v19, s[66:67]
    v_bitop3_b32 v122, v122, v113, v113 bitop3:0x0c
    v_lshlrev_b32 v124, 16, v126
    v_mul_f32 v122, v114, v122
    v_and_b32 v125, 0xffff0000, v126
    v_add_u32 v123, v123, v123
    v_mul_f32 v124, v122, v124
    v_mul_f32 v125, v122, v125
    v_cmpx_le_u32 vcc, 0x1000000, v57
    ds_add_f32 v123, v124 offset:54272
    ds_add_f32 v123, v125 offset:54276
    s_mov_b64 exec, -1
    v_ashrrev_i32 v122, 5, v58
    v_lshlrev_b16 v123, 2, v58
    v_cndmask_b32 v126, v20, v21, s[66:67]
    v_bitop3_b32 v122, v122, v113, v113 bitop3:0x0c
    v_lshlrev_b32 v124, 16, v126
    v_mul_f32 v122, v114, v122
    v_and_b32 v125, 0xffff0000, v126
    v_add_u32 v123, v123, v123
    v_mul_f32 v124, v122, v124
    v_mul_f32 v125, v122, v125
    v_cmpx_le_u32 vcc, 0x1000000, v58
    ds_add_f32 v123, v124 offset:54272
    ds_add_f32 v123, v125 offset:54276
    s_mov_b64 exec, -1
    v_ashrrev_i32 v122, 5, v59
    v_lshlrev_b16 v123, 2, v59
    v_cndmask_b32 v126, v22, v23, s[66:67]
    v_bitop3_b32 v122, v122, v113, v113 bitop3:0x0c
    v_lshlrev_b32 v124, 16, v126
    v_mul_f32 v122, v114, v122
    v_and_b32 v125, 0xffff0000, v126
    v_add_u32 v123, v123, v123
    v_mul_f32 v124, v122, v124
    v_mul_f32 v125, v122, v125
    v_cmpx_le_u32 vcc, 0x1000000, v59
    ds_add_f32 v123, v124 offset:54272
    ds_add_f32 v123, v125 offset:54276
    s_mov_b64 exec, -1
    v_bfe_u32 v18, v105, 14, 4
    v_lshrrev_b32 v19, 18, v105
    v_and_b32 v105, 0x3fff, v105
    v_mad_u32_u24 v18, v18, s63, v19
    v_lshl_or_b32 v105, v18, 14, v105
    buffer_load_dwordx4 v[18:21], v105, s[68:71], 0 offen
    s_mov_b32 m0, s23
    s_nop 0
    ds_read_addtid_b32 v102 offset:0
    ds_read_addtid_b32 v103 offset:256
    ds_read_addtid_b32 v104 offset:512
    ds_read_addtid_b32 v105 offset:768
    ds_read_addtid_b32 v106 offset:1024
    ds_read_addtid_b32 v107 offset:1280
    ds_read_addtid_b32 v108 offset:1536
    ds_read_addtid_b32 v109 offset:1792
    s_waitcnt vmcnt(4)
    s_mov_b32 m0, s24
    s_cmp_ge_u32 s10, 9
    s_cbranch_scc1 p2_st1s0
    ds_write_addtid_b32 v84 offset:49152
    ds_write_addtid_b32 v85 offset:49408
p2_st1s0:
    s_mov_b32 m0, s23
    s_add_u32 s20, s20, 53760
    ds_write_addtid_b32 v72 offset:0
    ds_write_addtid_b32 v73 offset:256
    ds_write_addtid_b32 v74 offset:512
    ds_write_addtid_b32 v75 offset:768
    ds_write_addtid_b32 v76 offset:1024
    ds_write_addtid_b32 v77 offset:1280
    ds_write_addtid_b32 v78 offset:1536
    ds_write_addtid_b32 v79 offset:1792
    ds_write_addtid_b32 v80 offset:2048
    ds_write_addtid_b32 v81 offset:2304
    ds_write_addtid_b32 v82 offset:2560
    ds_write_addtid_b32 v83 offset:2816
    s_waitcnt lgkmcnt(15)
    v_ashrrev_i32 v122, 5, v60
    v_lshlrev_b16 v123, 2, v60
    v_cndmask_b32 v126, v24, v25, s[66:67]
    v_bitop3_b32 v122, v122, v113, v113 bitop3:0x0c
    v_lshlrev_b32 v124, 16, v126
    v_mul_f32 v122, v114, v122
    v_and_b32 v125, 0xffff0000, v126
    v_add_u32 v123, v123, v123
    v_mul_f32 v124, v122, v124
    v_mul_f32 v125, v122, v125
    v_cmpx_le_u32 vcc, 0x1000000, v60
    ds_add_f32 v123, v124 offset:54272
    ds_add_f32 v123, v125 offset:54276
    s_mov_b64 exec, -1
    v_ashrrev_i32 v122, 5, v61
    v_lshlrev_b16 v123, 2, v61
    v_cndmask_b32 v126, v26, v27, s[66:67]
    v_bitop3_b32 v122, v122, v113, v113 bitop3:0x0c
    v_lshlrev_b32 v124, 16, v126
    v_mul_f32 v122, v114, v122
    v_and_b32 v125, 0xffff0000, v126
    v_add_u32 v123, v123, v123
    v_mul_f32 v124, v122, v124
    v_mul_f32 v125, v122, v125
    v_cmpx_le_u32 vcc, 0x1000000, v61
    ds_add_f32 v123, v124 offset:54272
    ds_add_f32 v123, v125 offset:54276
    s_mov_b64 exec, -1
    v_ashrrev_i32 v122, 5, v62
    v_lshlrev_b16 v123, 2, v62
    v_cndmask_b32 v126, v28, v29, s[66:67]
    v_bitop3_b32 v122, v122, v113, v113 bitop3:0x0c
    v_lshlrev_b32 v124, 16, v126
    v_mul_f32 v122, v114, v122
    v_and_b32 v125, 0xffff0000, v126
    v_add_u32 v123, v123, v123
    v_mul_f32 v124, v122, v124
    v_mul_f32 v125, v122, v125
    v_cmpx_le_u32 vcc, 0x1000000, v62
    ds_add_f32 v123, v124 offset:54272
    ds_add_f32 v123, v125 offset:54276
    s_mov_b64 exec, -1
    s_waitcnt vmcnt(13)
    v_perm_b32 v60, v89, v86, s31
    v_perm_b32 v61, v89, v87, s32
    v_perm_b32 v62, v89, v88, s33
    v_lshlrev_b16 v28, 3, v88
    v_lshlrev_b16 v26, 3, v87
    v_lshlrev_b16 v24, 3, v86
    s_waitcnt lgkmcnt(6)
    s_barrier
    s_cmp_ge_u32 s10, 9
    s_cbranch_scc1 p2_nm1m1a
    v_lshrrev_b32 v84, 1, v112
    s_add_u32 s44, s20, s42
    buffer_load_dwordx2 v[84:85], v84, s[4:7], s44 offen
p2_nm1m1a:
    buffer_load_dwordx4 v[72:75], v112, s[4:7], s20 offen offset:0
    buffer_load_dwordx4 v[76:79], v112, s[4:7], s20 offen offset:1024
    buffer_load_dwordx4 v[80:83], v112, s[4:7], s20 offen offset:2048
    v_cmpx_ge_u16 vcc, 0x3fff, v60
    ds_read_b64 v[24:25], v24
    s_mov_b64 exec, -1
    v_cmpx_ge_u16 vcc, 0x3fff, v61
    ds_read_b64 v[26:27], v26
    s_mov_b64 exec, -1
    v_cmpx_ge_u16 vcc, 0x3fff, v62
    ds_read_b64 v[28:29], v28
    s_mov_b64 exec, -1
    s_waitcnt lgkmcnt(15)
    v_ashrrev_i32 v122, 5, v63
    v_lshlrev_b16 v123, 2, v63
    v_cndmask_b32 v126, v30, v31, s[66:67]
    v_bitop3_b32 v122, v122, v113, v113 bitop3:0x0c
    v_lshlrev_b32 v124, 16, v126
    v_mul_f32 v122, v114, v122
    v_and_b32 v125, 0xffff0000, v126
    v_add_u32 v123, v123, v123
    v_mul_f32 v124, v122, v124
    v_mul_f32 v125, v122, v125
    v_cmpx_le_u32 vcc, 0x1000000, v63
    ds_add_f32 v123, v124 offset:54272
    ds_add_f32 v123, v125 offset:54276
    s_mov_b64 exec, -1
    v_ashrrev_i32 v122, 5, v64
    v_lshlrev_b16 v123, 2, v64
    v_cndmask_b32 v126, v32, v33, s[66:67]
    v_bitop3_b32 v122, v122, v113, v113 bitop3:0x0c
    v_lshlrev_b32 v124, 16, v126
    v_mul_f32 v122, v114, v122
    v_and_b32 v125, 0xffff0000, v126
    v_add_u32 v123, v123, v123
    v_mul_f32 v124, v122, v124
    v_mul_f32 v125, v122, v125
    v_cmpx_le_u32 vcc, 0x1000000, v64
    ds_add_f32 v123, v124 offset:54272
    ds_add_f32 v123, v125 offset:54276
    s_mov_b64 exec, -1
    v_ashrrev_i32 v122, 5, v65
    v_lshlrev_b16 v123, 2, v65
    v_cndmask_b32 v126, v34, v35, s[66:67]
    v_bitop3_b32 v122, v122, v113, v113 bitop3:0x0c
    v_lshlrev_b32 v124, 16, v126
    v_mul_f32 v122, v114, v122
    v_and_b32 v125, 0xffff0000, v126
    v_add_u32 v123, v123, v123
    v_mul_f32 v124, v122, v124
    v_mul_f32 v125, v122, v125
    v_cmpx_le_u32 vcc, 0x1000000, v65
    ds_add_f32 v123, v124 offset:54272
    ds_add_f32 v123, v125 offset:54276
    s_mov_b64 exec, -1
    s_waitcnt vmcnt(15)
    v_perm_b32 v63, v93, v90, s31
    v_perm_b32 v64, v93, v91, s32
    v_perm_b32 v65, v93, v92, s33
    v_lshlrev_b16 v34, 3, v92
    v_lshlrev_b16 v32, 3, v91
    v_lshlrev_b16 v30, 3, v90
    v_cmpx_ge_u16 vcc, 0x3fff, v63
    ds_read_b64 v[30:31], v30
    s_mov_b64 exec, -1
    v_cmpx_ge_u16 vcc, 0x3fff, v64
    ds_read_b64 v[32:33], v32
    s_mov_b64 exec, -1
    v_cmpx_ge_u16 vcc, 0x3fff, v65
    ds_read_b64 v[34:35], v34
    s_mov_b64 exec, -1
    s_waitcnt lgkmcnt(15)
    v_bfe_u32 v86, v106, 14, 4
    v_lshrrev_b32 v87, 18, v106
    v_and_b32 v106, 0x3fff, v106
    v_mad_u32_u24 v86, v86, s63, v87
    v_lshl_or_b32 v106, v86, 14, v106
    buffer_load_dwordx4 v[86:89], v106, s[68:71], 0 offen
    s_waitcnt lgkmcnt(15)
    v_ashrrev_i32 v122, 5, v66
    v_lshlrev_b16 v123, 2, v66
    v_cndmask_b32 v126, v36, v37, s[66:67]
    v_bitop3_b32 v122, v122, v113, v113 bitop3:0x0c
    v_lshlrev_b32 v124, 16, v126
    v_mul_f32 v122, v114, v122
    v_and_b32 v125, 0xffff0000, v126
    v_add_u32 v123, v123, v123
    v_mul_f32 v124, v122, v124
    v_mul_f32 v125, v122, v125
    v_cmpx_le_u32 vcc, 0x1000000, v66
    ds_add_f32 v123, v124 offset:54272
    ds_add_f32 v123, v125 offset:54276
    s_mov_b64 exec, -1
    v_ashrrev_i32 v122, 5, v67
    v_lshlrev_b16 v123, 2, v67
    v_cndmask_b32 v126, v38, v39, s[66:67]
    v_bitop3_b32 v122, v122, v113, v113 bitop3:0x0c
    v_lshlrev_b32 v124, 16, v126
    v_mul_f32 v122, v114, v122
    v_and_b32 v125, 0xffff0000, v126
    v_add_u32 v123, v123, v123
    v_mul_f32 v124, v122, v124
    v_mul_f32 v125, v122, v125
    v_cmpx_le_u32 vcc, 0x1000000, v67
    ds_add_f32 v123, v124 offset:54272
    ds_add_f32 v123, v125 offset:54276
    s_mov_b64 exec, -1
    v_ashrrev_i32 v122, 5, v68
    v_lshlrev_b16 v123, 2, v68
    v_cndmask_b32 v126, v40, v41, s[66:67]
    v_bitop3_b32 v122, v122, v113, v113 bitop3:0x0c
    v_lshlrev_b32 v124, 16, v126
    v_mul_f32 v122, v114, v122
    v_and_b32 v125, 0xffff0000, v126
    v_add_u32 v123, v123, v123
    v_mul_f32 v124, v122, v124
    v_mul_f32 v125, v122, v125
    v_cmpx_le_u32 vcc, 0x1000000, v68
    ds_add_f32 v123, v124 offset:54272
    ds_add_f32 v123, v125 offset:54276
    s_mov_b64 exec, -1
    s_waitcnt vmcnt(12)
    v_perm_b32 v66, v97, v94, s31
    v_perm_b32 v67, v97, v95, s32
    v_perm_b32 v68, v97, v96, s33
    v_lshlrev_b16 v40, 3, v96
    v_lshlrev_b16 v38, 3, v95
    v_lshlrev_b16 v36, 3, v94
    v_cmpx_ge_u16 vcc, 0x3fff, v66
    ds_read_b64 v[36:37], v36
    s_mov_b64 exec, -1
    v_cmpx_ge_u16 vcc, 0x3fff, v67
    ds_read_b64 v[38:39], v38
    s_mov_b64 exec, -1
    v_cmpx_ge_u16 vcc, 0x3fff, v68
    ds_read_b64 v[40:41], v40
    s_mov_b64 exec, -1
    s_waitcnt lgkmcnt(15)
    v_bfe_u32 v90, v107, 14, 4
    v_lshrrev_b32 v91, 18, v107
    v_and_b32 v107, 0x3fff, v107
    v_mad_u32_u24 v90, v90, s63, v91
    v_lshl_or_b32 v107, v90, 14, v107
    buffer_load_dwordx4 v[90:93], v107, s[68:71], 0 offen
    s_cmp_le_u32 s15, 7
    s_cbranch_scc1 p2_na1a7
    s_waitcnt lgkmcnt(15)
    v_ashrrev_i32 v122, 5, v69
    v_lshlrev_b16 v123, 2, v69
    v_cndmask_b32 v126, v42, v43, s[66:67]
    v_bitop3_b32 v122, v122, v113, v113 bitop3:0x0c
    v_lshlrev_b32 v124, 16, v126
    v_mul_f32 v122, v114, v122
    v_and_b32 v125, 0xffff0000, v126
    v_add_u32 v123, v123, v123
    v_mul_f32 v124, v122, v124
    v_mul_f32 v125, v122, v125
    v_cmpx_le_u32 vcc, 0x1000000, v69
    ds_add_f32 v123, v124 offset:54272
    ds_add_f32 v123, v125 offset:54276
    s_mov_b64 exec, -1
    v_ashrrev_i32 v122, 5, v70
    v_lshlrev_b16 v123, 2, v70
    v_cndmask_b32 v126, v44, v45, s[66:67]
    v_bitop3_b32 v122, v122, v113, v113 bitop3:0x0c
    v_lshlrev_b32 v124, 16, v126
    v_mul_f32 v122, v114, v122
    v_and_b32 v125, 0xffff0000, v126
    v_add_u32 v123, v123, v123
    v_mul_f32 v124, v122, v124
    v_mul_f32 v125, v122, v125
    v_cmpx_le_u32 vcc, 0x1000000, v70
    ds_add_f32 v123, v124 offset:54272
    ds_add_f32 v123, v125 offset:54276
    s_mov_b64 exec, -1
    v_ashrrev_i32 v122, 5, v71
    v_lshlrev_b16 v123, 2, v71
    v_cndmask_b32 v126, v46, v47, s[66:67]
    v_bitop3_b32 v122, v122, v113, v113 bitop3:0x0c
    v_lshlrev_b32 v124, 16, v126
    v_mul_f32 v122, v114, v122
    v_and_b32 v125, 0xffff0000, v126
    v_add_u32 v123, v123, v123
    v_mul_f32 v124, v122, v124
    v_mul_f32 v125, v122, v125
    v_cmpx_le_u32 vcc, 0x1000000, v71
    ds_add_f32 v123, v124 offset:54272
    ds_add_f32 v123, v125 offset:54276
    s_mov_b64 exec, -1
p2_na1a7:
    s_waitcnt vmcnt(12)
    v_perm_b32 v69, v101, v98, s31
    v_perm_b32 v70, v101, v99, s32
    v_perm_b32 v71, v101, v100, s33
    v_lshlrev_b16 v46, 3, v100
    v_lshlrev_b16 v44, 3, v99
    v_lshlrev_b16 v42, 3, v98
    s_cmp_le_u32 s16, 7
    s_cbranch_scc1 p2_g1r07
    v_cmpx_ge_u16 vcc, 0x3fff, v69
    ds_read_b64 v[42:43], v42
    s_mov_b64 exec, -1
    v_cmpx_ge_u16 vcc, 0x3fff, v70
    ds_read_b64 v[44:45], v44
    s_mov_b64 exec, -1
    v_cmpx_ge_u16 vcc, 0x3fff, v71
    ds_read_b64 v[46:47], v46
    s_mov_b64 exec, -1
p2_g1r07:
    s_waitcnt vmcnt(8)
    v_perm_b32 v48, v3, v0, s31
    v_perm_b32 v49, v3, v1, s32
    v_perm_b32 v50, v3, v2, s33
    v_lshlrev_b16 v4, 3, v2
    v_lshlrev_b16 v2, 3, v1
    v_lshlrev_b16 v0, 3, v0
    v_cmpx_ge_u16 vcc, 0x3fff, v48
    ds_read_b64 v[0:1], v0
    s_mov_b64 exec, -1
    v_cmpx_ge_u16 vcc, 0x3fff, v49
    ds_read_b64 v[2:3], v2
    s_mov_b64 exec, -1
    v_cmpx_ge_u16 vcc, 0x3fff, v50
    ds_read_b64 v[4:5], v4
    s_mov_b64 exec, -1
    s_waitcnt vmcnt(7)
    v_perm_b32 v51, v9, v6, s31
    v_perm_b32 v52, v9, v7, s32
    v_perm_b32 v53, v9, v8, s33
    v_lshlrev_b16 v10, 3, v8
    v_lshlrev_b16 v8, 3, v7
    v_lshlrev_b16 v6, 3, v6
    v_cmpx_ge_u16 vcc, 0x3fff, v51
    ds_read_b64 v[6:7], v6
    s_mov_b64 exec, -1
    v_cmpx_ge_u16 vcc, 0x3fff, v52
    ds_read_b64 v[8:9], v8
    s_mov_b64 exec, -1
    v_cmpx_ge_u16 vcc, 0x3fff, v53
    ds_read_b64 v[10:11], v10
    s_mov_b64 exec, -1
    s_waitcnt vmcnt(6)
    v_perm_b32 v54, v15, v12, s31
    v_perm_b32 v55, v15, v13, s32
    v_perm_b32 v56, v15, v14, s33
    v_lshlrev_b16 v16, 3, v14
    v_lshlrev_b16 v14, 3, v13
    v_lshlrev_b16 v12, 3, v12
    v_cmpx_ge_u16 vcc, 0x3fff, v54
    ds_read_b64 v[12:13], v12
    s_mov_b64 exec, -1
    v_cmpx_ge_u16 vcc, 0x3fff, v55
    ds_read_b64 v[14:15], v14
    s_mov_b64 exec, -1
    v_cmpx_ge_u16 vcc, 0x3fff, v56
    ds_read_b64 v[16:17], v16
    s_mov_b64 exec, -1
    s_waitcnt vmcnt(5)
    v_perm_b32 v57, v21, v18, s31
    v_perm_b32 v58, v21, v19, s32
    v_perm_b32 v59, v21, v20, s33
    v_lshlrev_b16 v22, 3, v20
    v_lshlrev_b16 v20, 3, v19
    v_lshlrev_b16 v18, 3, v18
    v_cmpx_ge_u16 vcc, 0x3fff, v57
    ds_read_b64 v[18:19], v18
    s_mov_b64 exec, -1
    v_cmpx_ge_u16 vcc, 0x3fff, v58
    ds_read_b64 v[20:21], v20
    s_mov_b64 exec, -1
    v_cmpx_ge_u16 vcc, 0x3fff, v59
    ds_read_b64 v[22:23], v22
    s_mov_b64 exec, -1
    s_waitcnt lgkmcnt(0)
    s_barrier
    s_waitcnt lgkmcnt(15)
    s_branch p2_tail
p2_drain1:
    v_cmpx_gt_i16 vcc, 0, v48
    ds_read_b64 v[0:1], v0
    s_mov_b64 exec, -1
    v_cmpx_gt_i16 vcc, 0, v49
    ds_read_b64 v[2:3], v2
    s_mov_b64 exec, -1
    v_cmpx_gt_i16 vcc, 0, v50
    ds_read_b64 v[4:5], v4
    s_mov_b64 exec, -1
    v_cmpx_gt_i16 vcc, 0, v51
    ds_read_b64 v[6:7], v6
    s_mov_b64 exec, -1
    v_cmpx_gt_i16 vcc, 0, v52
    ds_read_b64 v[8:9], v8
    s_mov_b64 exec, -1
    v_cmpx_gt_i16 vcc, 0, v53
    ds_read_b64 v[10:11], v10
    s_mov_b64 exec, -1
    v_cmpx_gt_i16 vcc, 0, v54
    ds_read_b64 v[12:13], v12
    s_mov_b64 exec, -1
    v_cmpx_gt_i16 vcc, 0, v55
    ds_read_b64 v[14:15], v14
    s_mov_b64 exec, -1
    v_cmpx_gt_i16 vcc, 0, v56
    ds_read_b64 v[16:17], v16
    s_mov_b64 exec, -1
    v_cmpx_gt_i16 vcc, 0, v57
    ds_read_b64 v[18:19], v18
    s_mov_b64 exec, -1
    v_cmpx_gt_i16 vcc, 0, v58
    ds_read_b64 v[20:21], v20
    s_mov_b64 exec, -1
    v_cmpx_gt_i16 vcc, 0, v59
    ds_read_b64 v[22:23], v22
    s_mov_b64 exec, -1
    v_cmpx_gt_i16 vcc, 0, v60
    ds_read_b64 v[24:25], v24
    s_mov_b64 exec, -1
    v_cmpx_gt_i16 vcc, 0, v61
    ds_read_b64 v[26:27], v26
    s_mov_b64 exec, -1
    v_cmpx_gt_i16 vcc, 0, v62
    ds_read_b64 v[28:29], v28
    s_mov_b64 exec, -1
    v_cmpx_gt_i16 vcc, 0, v63
    ds_read_b64 v[30:31], v30
    s_mov_b64 exec, -1
    v_cmpx_gt_i16 vcc, 0, v64
    ds_read_b64 v[32:33], v32
    s_mov_b64 exec, -1
    v_cmpx_gt_i16 vcc, 0, v65
    ds_read_b64 v[34:35], v34
    s_mov_b64 exec, -1
    v_cmpx_gt_i16 vcc, 0, v66
    ds_read_b64 v[36:37], v36
    s_mov_b64 exec, -1
    v_cmpx_gt_i16 vcc, 0, v67
    ds_read_b64 v[38:39], v38
    s_mov_b64 exec, -1
    v_cmpx_gt_i16 vcc, 0, v68
    ds_read_b64 v[40:41], v40
    s_mov_b64 exec, -1
    s_cmp_le_u32 s15, 7
    s_cbranch_scc1 p2_gd1
    v_cmpx_gt_i16 vcc, 0, v69
    ds_read_b64 v[42:43], v42
    s_mov_b64 exec, -1
    v_cmpx_gt_i16 vcc, 0, v70
    ds_read_b64 v[44:45], v44
    s_mov_b64 exec, -1
    v_cmpx_gt_i16 vcc, 0, v71
    ds_read_b64 v[46:47], v46
    s_mov_b64 exec, -1
p2_gd1:
    s_waitcnt lgkmcnt(15)
    v_ashrrev_i32 v122, 5, v48
    v_lshlrev_b16 v123, 2, v48
    v_cndmask_b32 v126, v0, v1, s[66:67]
    v_bitop3_b32 v122, v122, v113, v113 bitop3:0x0c
    v_lshlrev_b32 v124, 16, v126
    v_mul_f32 v122, v114, v122
    v_and_b32 v125, 0xffff0000, v126
    v_add_u32 v123, v123, v123
    v_mul_f32 v124, v122, v124
    v_mul_f32 v125, v122, v125
    v_cmpx_le_u32 vcc, 0x1000000, v48
    ds_add_f32 v123, v124 offset:54272
    ds_add_f32 v123, v125 offset:54276
    s_mov_b64 exec, -1
    v_ashrrev_i32 v122, 5, v49
    v_lshlrev_b16 v123, 2, v49
    v_cndmask_b32 v126, v2, v3, s[66:67]
    v_bitop3_b32 v122, v122, v113, v113 bitop3:0x0c
    v_lshlrev_b32 v124, 16, v126
    v_mul_f32 v122, v114, v122
    v_and_b32 v125, 0xffff0000, v126
    v_add_u32 v123, v123, v123
    v_mul_f32 v124, v122, v124
    v_mul_f32 v125, v122, v125
    v_cmpx_le_u32 vcc, 0x1000000, v49
    ds_add_f32 v123, v124 offset:54272
    ds_add_f32 v123, v125 offset:54276
    s_mov_b64 exec, -1
    v_ashrrev_i32 v122, 5, v50
    v_lshlrev_b16 v123, 2, v50
    v_cndmask_b32 v126, v4, v5, s[66:67]
    v_bitop3_b32 v122, v122, v113, v113 bitop3:0x0c
    v_lshlrev_b32 v124, 16, v126
    v_mul_f32 v122, v114, v122
    v_and_b32 v125, 0xffff0000, v126
    v_add_u32 v123, v123, v123
    v_mul_f32 v124, v122, v124
    v_mul_f32 v125, v122, v125
    v_cmpx_le_u32 vcc, 0x1000000, v50
    ds_add_f32 v123, v124 offset:54272
    ds_add_f32 v123, v125 offset:54276
    s_mov_b64 exec, -1
    s_waitcnt lgkmcnt(15)
    v_ashrrev_i32 v122, 5, v51
    v_lshlrev_b16 v123, 2, v51
    v_cndmask_b32 v126, v6, v7, s[66:67]
    v_bitop3_b32 v122, v122, v113, v113 bitop3:0x0c
    v_lshlrev_b32 v124, 16, v126
    v_mul_f32 v122, v114, v122
    v_and_b32 v125, 0xffff0000, v126
    v_add_u32 v123, v123, v123
    v_mul_f32 v124, v122, v124
    v_mul_f32 v125, v122, v125
    v_cmpx_le_u32 vcc, 0x1000000, v51
    ds_add_f32 v123, v124 offset:54272
    ds_add_f32 v123, v125 offset:54276
    s_mov_b64 exec, -1
    v_ashrrev_i32 v122, 5, v52
    v_lshlrev_b16 v123, 2, v52
    v_cndmask_b32 v126, v8, v9, s[66:67]
    v_bitop3_b32 v122, v122, v113, v113 bitop3:0x0c
    v_lshlrev_b32 v124, 16, v126
    v_mul_f32 v122, v114, v122
    v_and_b32 v125, 0xffff0000, v126
    v_add_u32 v123, v123, v123
    v_mul_f32 v124, v122, v124
    v_mul_f32 v125, v122, v125
    v_cmpx_le_u32 vcc, 0x1000000, v52
    ds_add_f32 v123, v124 offset:54272
    ds_add_f32 v123, v125 offset:54276
    s_mov_b64 exec, -1
    v_ashrrev_i32 v122, 5, v53
    v_lshlrev_b16 v123, 2, v53
    v_cndmask_b32 v126, v10, v11, s[66:67]
    v_bitop3_b32 v122, v122, v113, v113 bitop3:0x0c
    v_lshlrev_b32 v124, 16, v126
    v_mul_f32 v122, v114, v122
    v_and_b32 v125, 0xffff0000, v126
    v_add_u32 v123, v123, v123
    v_mul_f32 v124, v122, v124
    v_mul_f32 v125, v122, v125
    v_cmpx_le_u32 vcc, 0x1000000, v53
    ds_add_f32 v123, v124 offset:54272
    ds_add_f32 v123, v125 offset:54276
    s_mov_b64 exec, -1
    s_waitcnt lgkmcnt(15)
    v_ashrrev_i32 v122, 5, v54
    v_lshlrev_b16 v123, 2, v54
    v_cndmask_b32 v126, v12, v13, s[66:67]
    v_bitop3_b32 v122, v122, v113, v113 bitop3:0x0c
    v_lshlrev_b32 v124, 16, v126
    v_mul_f32 v122, v114, v122
    v_and_b32 v125, 0xffff0000, v126
    v_add_u32 v123, v123, v123
    v_mul_f32 v124, v122, v124
    v_mul_f32 v125, v122, v125
    v_cmpx_le_u32 vcc, 0x1000000, v54
    ds_add_f32 v123, v124 offset:54272
    ds_add_f32 v123, v125 offset:54276
    s_mov_b64 exec, -1
    v_ashrrev_i32 v122, 5, v55
    v_lshlrev_b16 v123, 2, v55
    v_cndmask_b32 v126, v14, v15, s[66:67]
    v_bitop3_b32 v122, v122, v113, v113 bitop3:0x0c
    v_lshlrev_b32 v124, 16, v126
    v_mul_f32 v122, v114, v122
    v_and_b32 v125, 0xffff0000, v126
    v_add_u32 v123, v123, v123
    v_mul_f32 v124, v122, v124
    v_mul_f32 v125, v122, v125
    v_cmpx_le_u32 vcc, 0x1000000, v55
    ds_add_f32 v123, v124 offset:54272
    ds_add_f32 v123, v125 offset:54276
    s_mov_b64 exec, -1
    v_ashrrev_i32 v122, 5, v56
    v_lshlrev_b16 v123, 2, v56
    v_cndmask_b32 v126, v16, v17, s[66:67]
    v_bitop3_b32 v122, v122, v113, v113 bitop3:0x0c
    v_lshlrev_b32 v124, 16, v126
    v_mul_f32 v122, v114, v122
    v_and_b32 v125, 0xffff0000, v126
    v_add_u32 v123, v123, v123
    v_mul_f32 v124, v122, v124
    v_mul_f32 v125, v122, v125
    v_cmpx_le_u32 vcc, 0x1000000, v56
    ds_add_f32 v123, v124 offset:54272
    ds_add_f32 v123, v125 offset:54276
    s_mov_b64 exec, -1
    s_waitcnt lgkmcnt(15)
    v_ashrrev_i32 v122, 5, v57
    v_lshlrev_b16 v123, 2, v57
    v_cndmask_b32 v126, v18, v19, s[66:67]
    v_bitop3_b32 v122, v122, v113, v113 bitop3:0x0c
    v_lshlrev_b32 v124, 16, v126
    v_mul_f32 v122, v114, v122
    v_and_b32 v125, 0xffff0000, v126
    v_add_u32 v123, v123, v123
    v_mul_f32 v124, v122, v124
    v_mul_f32 v125, v122, v125
    v_cmpx_le_u32 vcc, 0x1000000, v57
    ds_add_f32 v123, v124 offset:54272
    ds_add_f32 v123, v125 offset:54276
    s_mov_b64 exec, -1
    v_ashrrev_i32 v122, 5, v58
    v_lshlrev_b16 v123, 2, v58
    v_cndmask_b32 v126, v20, v21, s[66:67]
    v_bitop3_b32 v122, v122, v113, v113 bitop3:0x0c
    v_lshlrev_b32 v124, 16, v126
    v_mul_f32 v122, v114, v122
    v_and_b32 v125, 0xffff0000, v126
    v_add_u32 v123, v123, v123
    v_mul_f32 v124, v122, v124
    v_mul_f32 v125, v122, v125
    v_cmpx_le_u32 vcc, 0x1000000, v58
    ds_add_f32 v123, v124 offset:54272
    ds_add_f32 v123, v125 offset:54276
    s_mov_b64 exec, -1
    v_ashrrev_i32 v122, 5, v59
    v_lshlrev_b16 v123, 2, v59
    v_cndmask_b32 v126, v22, v23, s[66:67]
    v_bitop3_b32 v122, v122, v113, v113 bitop3:0x0c
    v_lshlrev_b32 v124, 16, v126
    v_mul_f32 v122, v114, v122
    v_and_b32 v125, 0xffff0000, v126
    v_add_u32 v123, v123, v123
    v_mul_f32 v124, v122, v124
    v_mul_f32 v125, v122, v125
    v_cmpx_le_u32 vcc, 0x1000000, v59
    ds_add_f32 v123, v124 offset:54272
    ds_add_f32 v123, v125 offset:54276
    s_mov_b64 exec, -1
    s_waitcnt lgkmcnt(15)
    v_ashrrev_i32 v122, 5, v60
    v_lshlrev_b16 v123, 2, v60
    v_cndmask_b32 v126, v24, v25, s[66:67]
    v_bitop3_b32 v122, v122, v113, v113 bitop3:0x0c
    v_lshlrev_b32 v124, 16, v126
    v_mul_f32 v122, v114, v122
    v_and_b32 v125, 0xffff0000, v126
    v_add_u32 v123, v123, v123
    v_mul_f32 v124, v122, v124
    v_mul_f32 v125, v122, v125
    v_cmpx_le_u32 vcc, 0x1000000, v60
    ds_add_f32 v123, v124 offset:54272
    ds_add_f32 v123, v125 offset:54276
    s_mov_b64 exec, -1
    v_ashrrev_i32 v122, 5, v61
    v_lshlrev_b16 v123, 2, v61
    v_cndmask_b32 v126, v26, v27, s[66:67]
    v_bitop3_b32 v122, v122, v113, v113 bitop3:0x0c
    v_lshlrev_b32 v124, 16, v126
    v_mul_f32 v122, v114, v122
    v_and_b32 v125, 0xffff0000, v126
    v_add_u32 v123, v123, v123
    v_mul_f32 v124, v122, v124
    v_mul_f32 v125, v122, v125
    v_cmpx_le_u32 vcc, 0x1000000, v61
    ds_add_f32 v123, v124 offset:54272
    ds_add_f32 v123, v125 offset:54276
    s_mov_b64 exec, -1
    v_ashrrev_i32 v122, 5, v62
    v_lshlrev_b16 v123, 2, v62
    v_cndmask_b32 v126, v28, v29, s[66:67]
    v_bitop3_b32 v122, v122, v113, v113 bitop3:0x0c
    v_lshlrev_b32 v124, 16, v126
    v_mul_f32 v122, v114, v122
    v_and_b32 v125, 0xffff0000, v126
    v_add_u32 v123, v123, v123
    v_mul_f32 v124, v122, v124
    v_mul_f32 v125, v122, v125
    v_cmpx_le_u32 vcc, 0x1000000, v62
    ds_add_f32 v123, v124 offset:54272
    ds_add_f32 v123, v125 offset:54276
    s_mov_b64 exec, -1
    s_waitcnt lgkmcnt(15)
    v_ashrrev_i32 v122, 5, v63
    v_lshlrev_b16 v123, 2, v63
    v_cndmask_b32 v126, v30, v31, s[66:67]
    v_bitop3_b32 v122, v122, v113, v113 bitop3:0x0c
    v_lshlrev_b32 v124, 16, v126
    v_mul_f32 v122, v114, v122
    v_and_b32 v125, 0xffff0000, v126
    v_add_u32 v123, v123, v123
    v_mul_f32 v124, v122, v124
    v_mul_f32 v125, v122, v125
    v_cmpx_le_u32 vcc, 0x1000000, v63
    ds_add_f32 v123, v124 offset:54272
    ds_add_f32 v123, v125 offset:54276
    s_mov_b64 exec, -1
    v_ashrrev_i32 v122, 5, v64
    v_lshlrev_b16 v123, 2, v64
    v_cndmask_b32 v126, v32, v33, s[66:67]
    v_bitop3_b32 v122, v122, v113, v113 bitop3:0x0c
    v_lshlrev_b32 v124, 16, v126
    v_mul_f32 v122, v114, v122
    v_and_b32 v125, 0xffff0000, v126
    v_add_u32 v123, v123, v123
    v_mul_f32 v124, v122, v124
    v_mul_f32 v125, v122, v125
    v_cmpx_le_u32 vcc, 0x1000000, v64
    ds_add_f32 v123, v124 offset:54272
    ds_add_f32 v123, v125 offset:54276
    s_mov_b64 exec, -1
    v_ashrrev_i32 v122, 5, v65
    v_lshlrev_b16 v123, 2, v65
    v_cndmask_b32 v126, v34, v35, s[66:67]
    v_bitop3_b32 v122, v122, v113, v113 bitop3:0x0c
    v_lshlrev_b32 v124, 16, v126
    v_mul_f32 v122, v114, v122
    v_and_b32 v125, 0xffff0000, v126
    v_add_u32 v123, v123, v123
    v_mul_f32 v124, v122, v124
    v_mul_f32 v125, v122, v125
    v_cmpx_le_u32 vcc, 0x1000000, v65
    ds_add_f32 v123, v124 offset:54272
    ds_add_f32 v123, v125 offset:54276
    s_mov_b64 exec, -1
    s_waitcnt lgkmcnt(15)
    v_ashrrev_i32 v122, 5, v66
    v_lshlrev_b16 v123, 2, v66
    v_cndmask_b32 v126, v36, v37, s[66:67]
    v_bitop3_b32 v122, v122, v113, v113 bitop3:0x0c
    v_lshlrev_b32 v124, 16, v126
    v_mul_f32 v122, v114, v122
    v_and_b32 v125, 0xffff0000, v126
    v_add_u32 v123, v123, v123
    v_mul_f32 v124, v122, v124
    v_mul_f32 v125, v122, v125
    v_cmpx_le_u32 vcc, 0x1000000, v66
    ds_add_f32 v123, v124 offset:54272
    ds_add_f32 v123, v125 offset:54276
    s_mov_b64 exec, -1
    v_ashrrev_i32 v122, 5, v67
    v_lshlrev_b16 v123, 2, v67
    v_cndmask_b32 v126, v38, v39, s[66:67]
    v_bitop3_b32 v122, v122, v113, v113 bitop3:0x0c
    v_lshlrev_b32 v124, 16, v126
    v_mul_f32 v122, v114, v122
    v_and_b32 v125, 0xffff0000, v126
    v_add_u32 v123, v123, v123
    v_mul_f32 v124, v122, v124
    v_mul_f32 v125, v122, v125
    v_cmpx_le_u32 vcc, 0x1000000, v67
    ds_add_f32 v123, v124 offset:54272
    ds_add_f32 v123, v125 offset:54276
    s_mov_b64 exec, -1
    v_ashrrev_i32 v122, 5, v68
    v_lshlrev_b16 v123, 2, v68
    v_cndmask_b32 v126, v40, v41, s[66:67]
    v_bitop3_b32 v122, v122, v113, v113 bitop3:0x0c
    v_lshlrev_b32 v124, 16, v126
    v_mul_f32 v122, v114, v122
    v_and_b32 v125, 0xffff0000, v126
    v_add_u32 v123, v123, v123
    v_mul_f32 v124, v122, v124
    v_mul_f32 v125, v122, v125
    v_cmpx_le_u32 vcc, 0x1000000, v68
    ds_add_f32 v123, v124 offset:54272
    ds_add_f32 v123, v125 offset:54276
    s_mov_b64 exec, -1
    s_cmp_le_u32 s15, 7
    s_cbranch_scc1 p2_nad1
    s_waitcnt lgkmcnt(15)
    v_ashrrev_i32 v122, 5, v69
    v_lshlrev_b16 v123, 2, v69
    v_cndmask_b32 v126, v42, v43, s[66:67]
    v_bitop3_b32 v122, v122, v113, v113 bitop3:0x0c
    v_lshlrev_b32 v124, 16, v126
    v_mul_f32 v122, v114, v122
    v_and_b32 v125, 0xffff0000, v126
    v_add_u32 v123, v123, v123
    v_mul_f32 v124, v122, v124
    v_mul_f32 v125, v122, v125
    v_cmpx_le_u32 vcc, 0x1000000, v69
    ds_add_f32 v123, v124 offset:54272
    ds_add_f32 v123, v125 offset:54276
    s_mov_b64 exec, -1
    v_ashrrev_i32 v122, 5, v70
    v_lshlrev_b16 v123, 2, v70
    v_cndmask_b32 v126, v44, v45, s[66:67]
    v_bitop3_b32 v122, v122, v113, v113 bitop3:0x0c
    v_lshlrev_b32 v124, 16, v126
    v_mul_f32 v122, v114, v122
    v_and_b32 v125, 0xffff0000, v126
    v_add_u32 v123, v123, v123
    v_mul_f32 v124, v122, v124
    v_mul_f32 v125, v122, v125
    v_cmpx_le_u32 vcc, 0x1000000, v70
    ds_add_f32 v123, v124 offset:54272
    ds_add_f32 v123, v125 offset:54276
    s_mov_b64 exec, -1
    v_ashrrev_i32 v122, 5, v71
    v_lshlrev_b16 v123, 2, v71
    v_cndmask_b32 v126, v46, v47, s[66:67]
    v_bitop3_b32 v122, v122, v113, v113 bitop3:0x0c
    v_lshlrev_b32 v124, 16, v126
    v_mul_f32 v122, v114, v122
    v_and_b32 v125, 0xffff0000, v126
    v_add_u32 v123, v123, v123
    v_mul_f32 v124, v122, v124
    v_mul_f32 v125, v122, v125
    v_cmpx_le_u32 vcc, 0x1000000, v71
    ds_add_f32 v123, v124 offset:54272
    ds_add_f32 v123, v125 offset:54276
    s_mov_b64 exec, -1
p2_nad1:
    s_branch p2_fin
p2_tail:
    s_mov_b32 s60, s61
    s_mov_b32 s15, s16
    s_mov_b32 s16, s17
    v_mov_b32 v122, s19
    s_xor_b32 s19, s19, 4
    ds_read_b32 v125, v122 offset:53760
    v_mov_b32 v123, s19
    v_mov_b32 v124, 0
    ds_write_b32 v123, v124 offset:53760
    s_waitcnt vmcnt(2)
    s_mov_b32 m0, s24
    s_cmp_ge_u32 s10, 9
    s_cbranch_scc1 p2_st2s1
    ds_write_addtid_b32 v84 offset:49152
    ds_write_addtid_b32 v85 offset:49408
p2_st2s1:
    s_mov_b32 m0, s23
    s_add_u32 s20, s20, 53760
    ds_write_addtid_b32 v72 offset:0
    ds_write_addtid_b32 v73 offset:256
    ds_write_addtid_b32 v74 offset:512
    ds_write_addtid_b32 v75 offset:768
    ds_write_addtid_b32 v76 offset:1024
    ds_write_addtid_b32 v77 offset:1280
    ds_write_addtid_b32 v78 offset:1536
    ds_write_addtid_b32 v79 offset:1792
    ds_write_addtid_b32 v80 offset:2048
    ds_write_addtid_b32 v81 offset:2304
    ds_write_addtid_b32 v82 offset:2560
    ds_write_addtid_b32 v83 offset:2816
    s_cmp_ge_u32 s10, 9
    s_cbranch_scc1 p2_nm2m2a
    v_lshrrev_b32 v84, 1, v112
    s_add_u32 s44, s20, s42
    buffer_load_dwordx2 v[84:85], v84, s[4:7], s44 offen
p2_nm2m2a:
    buffer_load_dwordx4 v[72:75], v112, s[4:7], s20 offen offset:0
    buffer_load_dwordx4 v[76:79], v112, s[4:7], s20 offen offset:1024
    buffer_load_dwordx4 v[80:83], v112, s[4:7], s20 offen offset:2048
    s_waitcnt lgkmcnt(0)
    s_barrier
    v_cmpx_lt_i16 vcc, 0x3fff, v48
    ds_read_b64 v[0:1], v0
    s_mov_b64 exec, -1
    v_cmpx_lt_i16 vcc, 0x3fff, v49
    ds_read_b64 v[2:3], v2
    s_mov_b64 exec, -1
    v_cmpx_lt_i16 vcc, 0x3fff, v50
    ds_read_b64 v[4:5], v4
    s_mov_b64 exec, -1
    v_cmpx_lt_i16 vcc, 0x3fff, v51
    ds_read_b64 v[6:7], v6
    s_mov_b64 exec, -1
    v_cmpx_lt_i16 vcc, 0x3fff, v52
    ds_read_b64 v[8:9], v8
    s_mov_b64 exec, -1
    v_cmpx_lt_i16 vcc, 0x3fff, v53
    ds_read_b64 v[10:11], v10
    s_mov_b64 exec, -1
    s_waitcnt lgkmcnt(15)
    v_readfirstlane_b32 s44, v125
    s_nop 0
    s_cmp_lg_u32 s44, 0
    s_cbranch_scc1 p2_advb
    s_add_u32 s61, s61, 1
    s_min_u32 s61, s61, 10
    v_mov_b32 v110, 0
    v_mov_b32 v111, 0
    s_cmp_eq_u32 s61, 10
    s_cbranch_scc1 p2_advb
    s_add_u32 s44, s61, s18
    s_cmp_ge_u32 s44, 10
    s_cselect_b32 s53, 10, 0
    s_sub_u32 s44, s44, s53
    s_mul_i32 s44, s44, 4160
    s_add_u32 s44, s44, s40
    v_bfe_i32 v111, v112, 6, 1
    v_lshrrev_b32 v110, 6, v112
    v_bitop3_b32 v111, v111, 15, s10 bitop3:0x6a
    v_lshl_or_b32 v110, v110, 4, v111
    v_bfe_u32 v111, v112, 2, 4
    v_mul_u32_u24 v110, 41600, v110
    v_add_u32 v111, v110, v111
    v_add_u32 v110, 256, v112
    v_and_b32 v110, 0x400, v110
    v_lshl_or_b32 v111, v110, 20, v111
    buffer_load_dword v110, v111, s[4:7], s44 offen
    buffer_load_dword v111, v111, s[4:7], s44 offen offset:16
p2_advb:
    s_cmp_lg_u32 s10, 15
    s_cbranch_scc1 p2_ntg
    s_lshr_b32 s44, s2, 3
    s_mul_i32 s44, s44, 5120
    s_add_u32 s45, s60, s18
    s_cmp_ge_u32 s45, 10
    s_cselect_b32 s53, 10, 0
    s_sub_u32 s45, s45, s53
    s_mul_i32 s45, s45, 645120
    s_add_u32 s44, s44, s45
    s_add_u32 s44, s44, s62
    s_sub_u32 s44, s44, s23
    v_lshlrev_b32 v84, 3, v112
    s_mov_b32 exec_hi, 0xff
    buffer_load_dword v85, v84, s[4:7], s44 offen
    s_mov_b64 exec, -1
p2_ntg:
    v_cmpx_lt_i16 vcc, 0x3fff, v54
    ds_read_b64 v[12:13], v12
    s_mov_b64 exec, -1
    v_cmpx_lt_i16 vcc, 0x3fff, v55
    ds_read_b64 v[14:15], v14
    s_mov_b64 exec, -1
    v_cmpx_lt_i16 vcc, 0x3fff, v56
    ds_read_b64 v[16:17], v16
    s_mov_b64 exec, -1
    v_cmpx_lt_i16 vcc, 0x3fff, v57
    ds_read_b64 v[18:19], v18
    s_mov_b64 exec, -1
    v_cmpx_lt_i16 vcc, 0x3fff, v58
    ds_read_b64 v[20:21], v20
    s_mov_b64 exec, -1
    v_cmpx_lt_i16 vcc, 0x3fff, v59
    ds_read_b64 v[22:23], v22
    s_mov_b64 exec, -1
    v_bfe_u32 v94, v108, 14, 4
    v_lshrrev_b32 v95, 18, v108
    v_and_b32 v108, 0x3fff, v108
    v_mad_u32_u24 v94, v94, s63, v95
    v_lshl_or_b32 v108, v94, 14, v108
    buffer_load_dwordx4 v[94:97], v108, s[68:71], 0 offen
    v_cmpx_lt_i16 vcc, 0x3fff, v60
    ds_read_b64 v[24:25], v24
    s_mov_b64 exec, -1
    v_cmpx_lt_i16 vcc, 0x3fff, v61
    ds_read_b64 v[26:27], v26
    s_mov_b64 exec, -1
    v_cmpx_lt_i16 vcc, 0x3fff, v62
    ds_read_b64 v[28:29], v28
    s_mov_b64 exec, -1
    v_cmpx_lt_i16 vcc, 0x3fff, v63
    ds_read_b64 v[30:31], v30
    s_mov_b64 exec, -1
    v_cmpx_lt_i16 vcc, 0x3fff, v64
    ds_read_b64 v[32:33], v32
    s_mov_b64 exec, -1
    v_cmpx_lt_i16 vcc, 0x3fff, v65
    ds_read_b64 v[34:35], v34
    s_mov_b64 exec, -1
    v_cmpx_lt_i16 vcc, 0x3fff, v66
    ds_read_b64 v[36:37], v36
    s_mov_b64 exec, -1
    v_cmpx_lt_i16 vcc, 0x3fff, v67
    ds_read_b64 v[38:39], v38
    s_mov_b64 exec, -1
    v_cmpx_lt_i16 vcc, 0x3fff, v68
    ds_read_b64 v[40:41], v40
    s_mov_b64 exec, -1
    s_cmp_le_u32 s15, 7
    s_cbranch_scc1 p2_g2r17
    v_cmpx_lt_i16 vcc, 0x3fff, v69
    ds_read_b64 v[42:43], v42
    s_mov_b64 exec, -1
    v_cmpx_lt_i16 vcc, 0x3fff, v70
    ds_read_b64 v[44:45], v44
    s_mov_b64 exec, -1
    v_cmpx_lt_i16 vcc, 0x3fff, v71
    ds_read_b64 v[46:47], v46
    s_mov_b64 exec, -1
p2_g2r17:
    v_bfe_u32 v98, v109, 14, 4
    v_lshrrev_b32 v99, 18, v109
    v_and_b32 v109, 0x3fff, v109
    v_mad_u32_u24 v98, v98, s63, v99
    v_lshl_or_b32 v109, v98, 14, v109
    buffer_load_dwordx4 v[98:101], v109, s[68:71], 0 offen
    s_waitcnt lgkmcnt(0)
    s_barrier
    s_waitcnt vmcnt(2)
    s_mov_b32 m0, s24
    s_cmp_ge_u32 s10, 9
    s_cbranch_scc1 p2_st2s2
    ds_write_addtid_b32 v84 offset:49152
    ds_write_addtid_b32 v85 offset:49408
p2_st2s2:
    s_mov_b32 m0, s23
    s_add_u32 s20, s60, s18
    s_cmp_ge_u32 s20, 10
    s_cselect_b32 s53, 10, 0
    s_sub_u32 s20, s20, s53
    s_mul_i32 s20, s20, 645120
    s_add_u32 s20, s20, s62
    ds_write_addtid_b32 v72 offset:0
    ds_write_addtid_b32 v73 offset:256
    ds_write_addtid_b32 v74 offset:512
    ds_write_addtid_b32 v75 offset:768
    ds_write_addtid_b32 v76 offset:1024
    ds_write_addtid_b32 v77 offset:1280
    ds_write_addtid_b32 v78 offset:1536
    ds_write_addtid_b32 v79 offset:1792
    ds_write_addtid_b32 v80 offset:2048
    ds_write_addtid_b32 v81 offset:2304
    ds_write_addtid_b32 v82 offset:2560
    ds_write_addtid_b32 v83 offset:2816
    s_waitcnt lgkmcnt(0)
    s_barrier
    s_branch p2_top
p2_fin:
    s_waitcnt vmcnt(0) lgkmcnt(0)
    s_barrier
    s_mov_b32 s48, s11
    s_mul_i32 s44, s48, 800768
    s_mul_i32 s45, s12, 12512
    s_add_u32 s49, s44, s45
    s_lshl_b32 s44, s49, 3
    s_add_u32 s44, s44, 492278784
    s_lshl_b32 s48, s48, 2
    s_lshl_b32 s45, s12, 4
    s_add_u32 s48, s48, s45
    s_add_u32 s48, s48, 492277760
    v_add_u32 v123, s64, v112
    v_add_u32 v122, s25, v123
    v_mov_b32 v24, 0
    v_mov_b32 v25, 0
    v_mov_b32 v26, 0
    v_mov_b32 v27, 0
    v_cmp_gt_u32 vcc, 1792, v123
    v_mov_b32 v124, 0x38000000
    v_mov_b32 v126, 0
    v_cndmask_b32 v124, v124, v123, vcc
    ds_read_b128 v[0:3], v122 offset:0
    ds_read_b128 v[4:7], v122 offset:16384
    ds_read_b128 v[8:11], v122 offset:32768
    v_add_u32 v122, 49152, v122
    ds_read_b128 v[12:15], v122 offset:0
    ds_read_b128 v[16:19], v122 offset:16384
    ds_read_b128 v[20:23], v122 offset:32768
    s_mov_b64 exec, vcc
    ds_read_b128 v[24:27], v122 offset:49152
    s_mov_b64 exec, -1
    s_cmp_lg_u32 s21, 0
    s_cbranch_scc1 p2_finf
    s_waitcnt lgkmcnt(6)
    buffer_store_dwordx4 v[0:3], v123, s[4:7], s44 offen nt
    s_add_u32 s44, s44, 16384
    s_waitcnt lgkmcnt(5)
    buffer_store_dwordx4 v[4:7], v123, s[4:7], s44 offen nt
    s_add_u32 s44, s44, 16384
    s_waitcnt lgkmcnt(4)
    buffer_store_dwordx4 v[8:11], v123, s[4:7], s44 offen nt
    s_add_u32 s44, s44, 16384
    s_waitcnt lgkmcnt(3)
    buffer_store_dwordx4 v[12:15], v123, s[4:7], s44 offen nt
    s_add_u32 s44, s44, 16384
    s_waitcnt lgkmcnt(2)
    buffer_store_dwordx4 v[16:19], v123, s[4:7], s44 offen nt
    s_add_u32 s44, s44, 16384
    s_waitcnt lgkmcnt(1)
    buffer_store_dwordx4 v[20:23], v123, s[4:7], s44 offen nt
    s_add_u32 s44, s44, 16384
    s_waitcnt lgkmcnt(0)
    buffer_store_dwordx4 v[24:27], v124, s[4:7], s44 offen nt
    s_add_u32 s44, s44, 16384
    v_bitop3_b32 v115, v115, v0, v1 bitop3:0xfe
    v_bitop3_b32 v115, v115, v2, v3 bitop3:0xfe
    v_bitop3_b32 v115, v115, v4, v5 bitop3:0xfe
    v_bitop3_b32 v115, v115, v6, v7 bitop3:0xfe
    v_bitop3_b32 v115, v115, v8, v9 bitop3:0xfe
    v_bitop3_b32 v115, v115, v10, v11 bitop3:0xfe
    v_bitop3_b32 v115, v115, v12, v13 bitop3:0xfe
    v_bitop3_b32 v115, v115, v14, v15 bitop3:0xfe
    v_bitop3_b32 v115, v115, v16, v17 bitop3:0xfe
    v_bitop3_b32 v115, v115, v18, v19 bitop3:0xfe
    v_bitop3_b32 v115, v115, v20, v21 bitop3:0xfe
    v_bitop3_b32 v115, v115, v22, v23 bitop3:0xfe
    v_bitop3_b32 v115, v115, v24, v25 bitop3:0xfe
    v_bitop3_b32 v115, v115, v26, v27 bitop3:0xfe
    v_bitop3_b32 v115, v115, v116, v117 bitop3:0xfe
    v_bitop3_b32 v115, v115, v118, v119 bitop3:0xfe
    v_bitop3_b32 v115, v115, v120, v121 bitop3:0xfe
    v_and_b32 v115, 0x80008000, v115
    v_cmpx_ne_u32 vcc, 0, v115
    ds_write_b32 v126, v115 offset:53768
    s_mov_b64 exec, -1
    s_waitcnt lgkmcnt(0)
    s_barrier
    ds_read_b32 v125, v126 offset:53768
    s_waitcnt lgkmcnt(0)
    v_readfirstlane_b32 s45, v125
    s_nop 0
    s_cmp_eq_u32 s45, 0
    s_cbranch_scc1 p2_done
    s_mov_b32 s21, 1
    s_waitcnt vmcnt(0)
    s_branch p2_restart
p2_finf:
    s_lshl_b32 s49, s49, 4
    s_lshl_b32 s45, s21, 3
    s_add_u32 s49, s49, s45
    s_add_u32 s49, s49, 517903352
    v_mov_b32 v28, 1073758208
    v_mov_b32 v29, 1073758208
    v_mov_b32 v30, 1073758208
    v_mov_b32 v31, 1073758208
    v_lshlrev_b32 v122, 1, v123
    v_lshlrev_b32 v125, 1, v124
    s_waitcnt lgkmcnt(0)
    buffer_store_dwordx4 v[28:31], v123, s[4:7], s44 offen
    s_add_u32 s44, s44, 16384
    buffer_store_dwordx2 v[0:1], v122, s[4:7], s49 offen offset:0
    buffer_store_dwordx2 v[2:3], v122, s[4:7], s49 offen offset:16
    s_add_u32 s49, s49, 32768
    buffer_store_dwordx4 v[28:31], v123, s[4:7], s44 offen
    s_add_u32 s44, s44, 16384
    buffer_store_dwordx2 v[4:5], v122, s[4:7], s49 offen offset:0
    buffer_store_dwordx2 v[6:7], v122, s[4:7], s49 offen offset:16
    s_add_u32 s49, s49, 32768
    buffer_store_dwordx4 v[28:31], v123, s[4:7], s44 offen
    s_add_u32 s44, s44, 16384
    buffer_store_dwordx2 v[8:9], v122, s[4:7], s49 offen offset:0
    buffer_store_dwordx2 v[10:11], v122, s[4:7], s49 offen offset:16
    s_add_u32 s49, s49, 32768
    buffer_store_dwordx4 v[28:31], v123, s[4:7], s44 offen
    s_add_u32 s44, s44, 16384
    buffer_store_dwordx2 v[12:13], v122, s[4:7], s49 offen offset:0
    buffer_store_dwordx2 v[14:15], v122, s[4:7], s49 offen offset:16
    s_add_u32 s49, s49, 32768
    buffer_store_dwordx4 v[28:31], v123, s[4:7], s44 offen
    s_add_u32 s44, s44, 16384
    buffer_store_dwordx2 v[16:17], v122, s[4:7], s49 offen offset:0
    buffer_store_dwordx2 v[18:19], v122, s[4:7], s49 offen offset:16
    s_add_u32 s49, s49, 32768
    buffer_store_dwordx4 v[28:31], v123, s[4:7], s44 offen
    s_add_u32 s44, s44, 16384
    buffer_store_dwordx2 v[20:21], v122, s[4:7], s49 offen offset:0
    buffer_store_dwordx2 v[22:23], v122, s[4:7], s49 offen offset:16
    s_add_u32 s49, s49, 32768
    buffer_store_dwordx4 v[28:31], v124, s[4:7], s44 offen
    s_add_u32 s44, s44, 16384
    buffer_store_dwordx2 v[24:25], v125, s[4:7], s49 offen offset:0
    buffer_store_dwordx2 v[26:27], v125, s[4:7], s49 offen offset:16
    s_add_u32 s49, s49, 32768
    s_add_u32 s21, s21, 1
    s_mov_b32 s30, 0
    s_waitcnt vmcnt(0)
    s_cmp_eq_u32 s21, 2
    s_cbranch_scc1 p2_restart
p2_done:
    v_mov_b32 v125, s30
    buffer_store_dword v125, v126, s[4:7], s48 offen
p2_end:
    s_endpgm
.globl p3_kernel
.p2align 8
.type p3_kernel,@function
p3_kernel:
    s_cmp_ge_u32 s2, 1563
    s_cbranch_scc1 p3_end
    s_load_dwordx2 s[4:5], s[0:1], 0
    s_load_dwordx2 s[6:7], s[0:1], 24
    s_load_dwordx2 s[8:9], s[0:1], 40
    s_load_dwordx8 s[12:19], s[0:1], 56
    s_load_dwordx2 s[10:11], s[0:1], 88
    s_load_dwordx2 s[20:21], s[0:1], 104
    s_lshl_b32 s3, s2, 8
    v_add_u32 v0, s3, v0
    v_lshlrev_b32 v2, 4, v0
    v_lshlrev_b32 v3, 2, v0
    v_add_u32 v0, v0, v0
    v_mul_hi_u32_u24 v1, 343268, v0
    v_lshlrev_b16 v1, 4, v1
    s_waitcnt lgkmcnt(0)
    s_load_dwordx4 s[32:35], s[8:9], 0
    s_load_dwordx16 s[36:51], s[12:13], 0
    s_load_dwordx16 s[52:67], s[14:15], 0
    s_load_dwordx8 s[68:75], s[16:17], 0
    s_load_dwordx8 s[76:83], s[18:19], 0
    s_mov_b32 s24, s6
    s_and_b32 s25, s7, 0xffff
    s_mov_b32 s26, 1600000
    s_mov_b32 s27, 0x20000
    buffer_load_dword v4, v3, s[24:27], 0 offen nt
    s_mov_b32 s28, s20
    s_and_b32 s29, s21, 0xffff
    s_mov_b32 s30, 819200000
    s_mov_b32 s31, 0x20000
    s_mov_b32 s22, 492278784
    buffer_load_dwordx4 v[40:43], v2, s[28:31], s22 offen nt
    s_mov_b32 s22, 498684928
    buffer_load_dwordx4 v[44:47], v2, s[28:31], s22 offen nt
    s_mov_b32 s22, 505091072
    buffer_load_dwordx4 v[48:51], v2, s[28:31], s22 offen nt
    s_mov_b32 s22, 511497216
    buffer_load_dwordx4 v[52:55], v2, s[28:31], s22 offen nt
    s_mov_b32 s22, 492277760
    buffer_load_dwordx4 v[56:59], v1, s[28:31], s22 offen
    s_mov_b32 s24, s4
    s_and_b32 s25, s5, 0xffff
    s_mov_b32 s26, 6400000
    s_mov_b32 s27, 0x20000
    buffer_load_dwordx4 v[60:63], v2, s[24:27], 0 offen nt
    s_mov_b32 s24, s10
    s_and_b32 s25, s11, 0xffff
    s_mov_b32 s26, 6400000
    s_mov_b32 s27, 0x20000
    s_waitcnt vmcnt(6) lgkmcnt(0)
    v_and_b32 v5, 0xffff0000, v4
    v_lshlrev_b32 v4, 16, v4
    s_lshl_b32 s14, s32, 16
    s_and_b32 s15, s32, 0xffff0000
    v_pk_add_f32 v[8:9], v[4:5], s[14:15] op_sel:[0,0] op_sel_hi:[0,1] neg_lo:[0,1] neg_hi:[0,1]
    v_pk_add_f32 v[16:17], v[4:5], s[14:15] op_sel:[1,0] op_sel_hi:[1,1] neg_lo:[0,1] neg_hi:[0,1]
    s_lshl_b32 s16, s33, 16
    s_and_b32 s17, s33, 0xffff0000
    v_pk_add_f32 v[10:11], v[4:5], s[16:17] op_sel:[0,0] op_sel_hi:[0,1] neg_lo:[0,1] neg_hi:[0,1]
    v_pk_add_f32 v[18:19], v[4:5], s[16:17] op_sel:[1,0] op_sel_hi:[1,1] neg_lo:[0,1] neg_hi:[0,1]
    s_lshl_b32 s18, s34, 16
    s_and_b32 s19, s34, 0xffff0000
    v_pk_add_f32 v[12:13], v[4:5], s[18:19] op_sel:[0,0] op_sel_hi:[0,1] neg_lo:[0,1] neg_hi:[0,1]
    v_pk_add_f32 v[20:21], v[4:5], s[18:19] op_sel:[1,0] op_sel_hi:[1,1] neg_lo:[0,1] neg_hi:[0,1]
    s_lshl_b32 s12, s35, 16
    s_and_b32 s13, s35, 0xffff0000
    v_pk_add_f32 v[14:15], v[4:5], s[12:13] op_sel:[0,0] op_sel_hi:[0,1] neg_lo:[0,1] neg_hi:[0,1]
    v_pk_add_f32 v[22:23], v[4:5], s[12:13] op_sel:[1,0] op_sel_hi:[1,1] neg_lo:[0,1] neg_hi:[0,1]
    v_cvt_pk_bf16_f32 v8, v8, v9
    v_cvt_pk_bf16_f32 v10, v10, v11
    v_cvt_pk_bf16_f32 v12, v12, v13
    v_cvt_pk_bf16_f32 v14, v14, v15
    v_cvt_pk_bf16_f32 v16, v16, v17
    v_cvt_pk_bf16_f32 v18, v18, v19
    v_cvt_pk_bf16_f32 v20, v20, v21
    v_cvt_pk_bf16_f32 v22, v22, v23
    v_and_b32 v9, 0xffff0000, v8
    v_lshlrev_b32 v8, 16, v8
    v_and_b32 v11, 0xffff0000, v10
    v_lshlrev_b32 v10, 16, v10
    v_and_b32 v13, 0xffff0000, v12
    v_lshlrev_b32 v12, 16, v12
    v_and_b32 v15, 0xffff0000, v14
    v_lshlrev_b32 v14, 16, v14
    v_and_b32 v17, 0xffff0000, v16
    v_lshlrev_b32 v16, 16, v16
    v_and_b32 v19, 0xffff0000, v18
    v_lshlrev_b32 v18, 16, v18
    v_and_b32 v21, 0xffff0000, v20
    v_lshlrev_b32 v20, 16, v20
    v_and_b32 v23, 0xffff0000, v22
    v_lshlrev_b32 v22, 16, v22
    v_mul_f32 v8, v8, v8
    v_mul_f32 v9, v9, v9
    v_mul_f32 v10, v10, v10
    v_mul_f32 v11, v11, v11
    v_mul_f32 v12, v12, v12
    v_mul_f32 v13, v13, v13
    v_mul_f32 v14, v14, v14
    v_mul_f32 v15, v15, v15
    v_mul_f32 v16, v16, v16
    v_mul_f32 v17, v17, v17
    v_mul_f32 v18, v18, v18
    v_mul_f32 v19, v19, v19
    v_mul_f32 v20, v20, v20
    v_mul_f32 v21, v21, v21
    v_mul_f32 v22, v22, v22
    v_mul_f32 v23, v23, v23
    v_cvt_pk_bf16_f32 v8, v8, v9
    v_cvt_pk_bf16_f32 v10, v10, v11
    v_cvt_pk_bf16_f32 v12, v12, v13
    v_cvt_pk_bf16_f32 v14, v14, v15
    v_cvt_pk_bf16_f32 v16, v16, v17
    v_cvt_pk_bf16_f32 v18, v18, v19
    v_cvt_pk_bf16_f32 v20, v20, v21
    v_cvt_pk_bf16_f32 v22, v22, v23
    v_and_b32 v9, 0xffff0000, v8
    v_lshlrev_b32 v8, 16, v8
    v_and_b32 v11, 0xffff0000, v10
    v_lshlrev_b32 v10, 16, v10
    v_and_b32 v13, 0xffff0000, v12
    v_lshlrev_b32 v12, 16, v12
    v_and_b32 v15, 0xffff0000, v14
    v_lshlrev_b32 v14, 16, v14
    v_and_b32 v17, 0xffff0000, v16
    v_lshlrev_b32 v16, 16, v16
    v_and_b32 v19, 0xffff0000, v18
    v_lshlrev_b32 v18, 16, v18
    v_and_b32 v21, 0xffff0000, v20
    v_lshlrev_b32 v20, 16, v20
    v_and_b32 v23, 0xffff0000, v22
    v_lshlrev_b32 v22, 16, v22
    v_mul_f32 v8, 0xc1200000, v8
    v_mul_f32 v9, 0xc1200000, v9
    v_mul_f32 v10, 0xc1200000, v10
    v_mul_f32 v11, 0xc1200000, v11
    v_mul_f32 v12, 0xc1200000, v12
    v_mul_f32 v13, 0xc1200000, v13
    v_mul_f32 v14, 0xc1200000, v14
    v_mul_f32 v15, 0xc1200000, v15
    v_mul_f32 v16, 0xc1200000, v16
    v_mul_f32 v17, 0xc1200000, v17
    v_mul_f32 v18, 0xc1200000, v18
    v_mul_f32 v19, 0xc1200000, v19
    v_mul_f32 v20, 0xc1200000, v20
    v_mul_f32 v21, 0xc1200000, v21
    v_mul_f32 v22, 0xc1200000, v22
    v_mul_f32 v23, 0xc1200000, v23
    v_cvt_pk_bf16_f32 v8, v8, v9
    v_cvt_pk_bf16_f32 v10, v10, v11
    v_cvt_pk_bf16_f32 v12, v12, v13
    v_cvt_pk_bf16_f32 v14, v14, v15
    v_cvt_pk_bf16_f32 v16, v16, v17
    v_cvt_pk_bf16_f32 v18, v18, v19
    v_cvt_pk_bf16_f32 v20, v20, v21
    v_cvt_pk_bf16_f32 v22, v22, v23
    v_and_b32 v9, 0xffff0000, v8
    v_lshlrev_b32 v8, 16, v8
    v_and_b32 v11, 0xffff0000, v10
    v_lshlrev_b32 v10, 16, v10
    v_and_b32 v13, 0xffff0000, v12
    v_lshlrev_b32 v12, 16, v12
    v_and_b32 v15, 0xffff0000, v14
    v_lshlrev_b32 v14, 16, v14
    v_and_b32 v17, 0xffff0000, v16
    v_lshlrev_b32 v16, 16, v16
    v_and_b32 v19, 0xffff0000, v18
    v_lshlrev_b32 v18, 16, v18
    v_and_b32 v21, 0xffff0000, v20
    v_lshlrev_b32 v20, 16, v20
    v_and_b32 v23, 0xffff0000, v22
    v_lshlrev_b32 v22, 16, v22
    v_mul_f32 v8, 0x3fb8aa3b, v8
    v_mul_f32 v9, 0x3fb8aa3b, v9
    v_mul_f32 v10, 0x3fb8aa3b, v10
    v_mul_f32 v11, 0x3fb8aa3b, v11
    v_mul_f32 v12, 0x3fb8aa3b, v12
    v_mul_f32 v13, 0x3fb8aa3b, v13
    v_mul_f32 v14, 0x3fb8aa3b, v14
    v_mul_f32 v15, 0x3fb8aa3b, v15
    v_mul_f32 v16, 0x3fb8aa3b, v16
    v_mul_f32 v17, 0x3fb8aa3b, v17
    v_mul_f32 v18, 0x3fb8aa3b, v18
    v_mul_f32 v19, 0x3fb8aa3b, v19
    v_mul_f32 v20, 0x3fb8aa3b, v20
    v_mul_f32 v21, 0x3fb8aa3b, v21
    v_mul_f32 v22, 0x3fb8aa3b, v22
    v_mul_f32 v23, 0x3fb8aa3b, v23
    v_exp_f32 v8, v8
    v_exp_f32 v9, v9
    v_exp_f32 v10, v10
    v_exp_f32 v11, v11
    v_exp_f32 v12, v12
    v_exp_f32 v13, v13
    v_exp_f32 v14, v14
    v_exp_f32 v15, v15
    v_exp_f32 v16, v16
    v_exp_f32 v17, v17
    v_exp_f32 v18, v18
    v_exp_f32 v19, v19
    v_exp_f32 v20, v20
    v_exp_f32 v21, v21
    v_exp_f32 v22, v22
    v_exp_f32 v23, v23
    s_nop 0
    v_cvt_pk_bf16_f32 v8, v8, v9
    v_cvt_pk_bf16_f32 v10, v10, v11
    v_cvt_pk_bf16_f32 v12, v12, v13
    v_cvt_pk_bf16_f32 v14, v14, v15
    v_cvt_pk_bf16_f32 v16, v16, v17
    v_cvt_pk_bf16_f32 v18, v18, v19
    v_cvt_pk_bf16_f32 v20, v20, v21
    v_cvt_pk_bf16_f32 v22, v22, v23
    v_and_b32 v9, 0xffff0000, v8
    v_lshlrev_b32 v8, 16, v8
    v_and_b32 v11, 0xffff0000, v10
    v_lshlrev_b32 v10, 16, v10
    v_and_b32 v13, 0xffff0000, v12
    v_lshlrev_b32 v12, 16, v12
    v_and_b32 v15, 0xffff0000, v14
    v_lshlrev_b32 v14, 16, v14
    v_and_b32 v17, 0xffff0000, v16
    v_lshlrev_b32 v16, 16, v16
    v_and_b32 v19, 0xffff0000, v18
    v_lshlrev_b32 v18, 16, v18
    v_and_b32 v21, 0xffff0000, v20
    v_lshlrev_b32 v20, 16, v20
    v_and_b32 v23, 0xffff0000, v22
    v_lshlrev_b32 v22, 16, v22
    s_lshl_b32 s14, s52, 16
    s_and_b32 s15, s52, 0xffff0000
    v_pk_mul_f32 v[24:25], v[8:9], s[14:15] op_sel:[0,0] op_sel_hi:[0,1]
    v_pk_mul_f32 v[28:29], v[16:17], s[14:15] op_sel:[0,0] op_sel_hi:[0,1]
    s_lshl_b32 s16, s53, 16
    s_and_b32 s17, s53, 0xffff0000
    v_pk_mul_f32 v[26:27], v[8:9], s[16:17] op_sel:[0,0] op_sel_hi:[0,1]
    v_pk_mul_f32 v[30:31], v[16:17], s[16:17] op_sel:[0,0] op_sel_hi:[0,1]
    s_lshl_b32 s18, s54, 16
    s_and_b32 s19, s54, 0xffff0000
    v_pk_fma_f32 v[24:25], v[8:9], s[18:19], v[24:25] op_sel:[1,0,0] op_sel_hi:[1,1,1]
    v_pk_fma_f32 v[28:29], v[16:17], s[18:19], v[28:29] op_sel:[1,0,0] op_sel_hi:[1,1,1]
    s_lshl_b32 s12, s55, 16
    s_and_b32 s13, s55, 0xffff0000
    v_pk_fma_f32 v[26:27], v[8:9], s[12:13], v[26:27] op_sel:[1,0,0] op_sel_hi:[1,1,1]
    v_pk_fma_f32 v[30:31], v[16:17], s[12:13], v[30:31] op_sel:[1,0,0] op_sel_hi:[1,1,1]
    s_lshl_b32 s14, s56, 16
    s_and_b32 s15, s56, 0xffff0000
    v_pk_fma_f32 v[24:25], v[10:11], s[14:15], v[24:25] op_sel:[0,0,0] op_sel_hi:[0,1,1]
    v_pk_fma_f32 v[28:29], v[18:19], s[14:15], v[28:29] op_sel:[0,0,0] op_sel_hi:[0,1,1]
    s_lshl_b32 s16, s57, 16
    s_and_b32 s17, s57, 0xffff0000
    v_pk_fma_f32 v[26:27], v[10:11], s[16:17], v[26:27] op_sel:[0,0,0] op_sel_hi:[0,1,1]
    v_pk_fma_f32 v[30:31], v[18:19], s[16:17], v[30:31] op_sel:[0,0,0] op_sel_hi:[0,1,1]
    s_lshl_b32 s18, s58, 16
    s_and_b32 s19, s58, 0xffff0000
    v_pk_fma_f32 v[24:25], v[10:11], s[18:19], v[24:25] op_sel:[1,0,0] op_sel_hi:[1,1,1]
    v_pk_fma_f32 v[28:29], v[18:19], s[18:19], v[28:29] op_sel:[1,0,0] op_sel_hi:[1,1,1]
    s_lshl_b32 s12, s59, 16
    s_and_b32 s13, s59, 0xffff0000
    v_pk_fma_f32 v[26:27], v[10:11], s[12:13], v[26:27] op_sel:[1,0,0] op_sel_hi:[1,1,1]
    v_pk_fma_f32 v[30:31], v[18:19], s[12:13], v[30:31] op_sel:[1,0,0] op_sel_hi:[1,1,1]
    s_lshl_b32 s14, s60, 16
    s_and_b32 s15, s60, 0xffff0000
    v_pk_fma_f32 v[24:25], v[12:13], s[14:15], v[24:25] op_sel:[0,0,0] op_sel_hi:[0,1,1]
    v_pk_fma_f32 v[28:29], v[20:21], s[14:15], v[28:29] op_sel:[0,0,0] op_sel_hi:[0,1,1]
    s_lshl_b32 s16, s61, 16
    s_and_b32 s17, s61, 0xffff0000
    v_pk_fma_f32 v[26:27], v[12:13], s[16:17], v[26:27] op_sel:[0,0,0] op_sel_hi:[0,1,1]
    v_pk_fma_f32 v[30:31], v[20:21], s[16:17], v[30:31] op_sel:[0,0,0] op_sel_hi:[0,1,1]
    s_lshl_b32 s18, s62, 16
    s_and_b32 s19, s62, 0xffff0000
    v_pk_fma_f32 v[24:25], v[12:13], s[18:19], v[24:25] op_sel:[1,0,0] op_sel_hi:[1,1,1]
    v_pk_fma_f32 v[28:29], v[20:21], s[18:19], v[28:29] op_sel:[1,0,0] op_sel_hi:[1,1,1]
    s_lshl_b32 s12, s63, 16
    s_and_b32 s13, s63, 0xffff0000
    v_pk_fma_f32 v[26:27], v[12:13], s[12:13], v[26:27] op_sel:[1,0,0] op_sel_hi:[1,1,1]
    v_pk_fma_f32 v[30:31], v[20:21], s[12:13], v[30:31] op_sel:[1,0,0] op_sel_hi:[1,1,1]
    s_lshl_b32 s14, s64, 16
    s_and_b32 s15, s64, 0xffff0000
    v_pk_fma_f32 v[24:25], v[14:15], s[14:15], v[24:25] op_sel:[0,0,0] op_sel_hi:[0,1,1]
    v_pk_fma_f32 v[28:29], v[22:23], s[14:15], v[28:29] op_sel:[0,0,0] op_sel_hi:[0,1,1]
    s_lshl_b32 s16, s65, 16
    s_and_b32 s17, s65, 0xffff0000
    v_pk_fma_f32 v[26:27], v[14:15], s[16:17], v[26:27] op_sel:[0,0,0] op_sel_hi:[0,1,1]
    v_pk_fma_f32 v[30:31], v[22:23], s[16:17], v[30:31] op_sel:[0,0,0] op_sel_hi:[0,1,1]
    s_lshl_b32 s18, s66, 16
    s_and_b32 s19, s66, 0xffff0000
    v_pk_fma_f32 v[24:25], v[14:15], s[18:19], v[24:25] op_sel:[1,0,0] op_sel_hi:[1,1,1]
    v_pk_fma_f32 v[28:29], v[22:23], s[18:19], v[28:29] op_sel:[1,0,0] op_sel_hi:[1,1,1]
    s_lshl_b32 s12, s67, 16
    s_and_b32 s13, s67, 0xffff0000
    v_pk_fma_f32 v[26:27], v[14:15], s[12:13], v[26:27] op_sel:[1,0,0] op_sel_hi:[1,1,1]
    v_pk_fma_f32 v[30:31], v[22:23], s[12:13], v[30:31] op_sel:[1,0,0] op_sel_hi:[1,1,1]
    s_lshl_b32 s14, s36, 16
    s_and_b32 s15, s36, 0xffff0000
    v_pk_mul_f32 v[32:33], v[8:9], s[14:15] op_sel:[0,0] op_sel_hi:[0,1]
    v_pk_mul_f32 v[36:37], v[16:17], s[14:15] op_sel:[0,0] op_sel_hi:[0,1]
    s_lshl_b32 s16, s37, 16
    s_and_b32 s17, s37, 0xffff0000
    v_pk_mul_f32 v[34:35], v[8:9], s[16:17] op_sel:[0,0] op_sel_hi:[0,1]
    v_pk_mul_f32 v[38:39], v[16:17], s[16:17] op_sel:[0,0] op_sel_hi:[0,1]
    s_lshl_b32 s18, s38, 16
    s_and_b32 s19, s38, 0xffff0000
    v_pk_fma_f32 v[32:33], v[8:9], s[18:19], v[32:33] op_sel:[1,0,0] op_sel_hi:[1,1,1]
    v_pk_fma_f32 v[36:37], v[16:17], s[18:19], v[36:37] op_sel:[1,0,0] op_sel_hi:[1,1,1]
    s_lshl_b32 s12, s39, 16
    s_and_b32 s13, s39, 0xffff0000
    v_pk_fma_f32 v[34:35], v[8:9], s[12:13], v[34:35] op_sel:[1,0,0] op_sel_hi:[1,1,1]
    v_pk_fma_f32 v[38:39], v[16:17], s[12:13], v[38:39] op_sel:[1,0,0] op_sel_hi:[1,1,1]
    s_lshl_b32 s14, s40, 16
    s_and_b32 s15, s40, 0xffff0000
    v_pk_fma_f32 v[32:33], v[10:11], s[14:15], v[32:33] op_sel:[0,0,0] op_sel_hi:[0,1,1]
    v_pk_fma_f32 v[36:37], v[18:19], s[14:15], v[36:37] op_sel:[0,0,0] op_sel_hi:[0,1,1]
    s_lshl_b32 s16, s41, 16
    s_and_b32 s17, s41, 0xffff0000
    v_pk_fma_f32 v[34:35], v[10:11], s[16:17], v[34:35] op_sel:[0,0,0] op_sel_hi:[0,1,1]
    v_pk_fma_f32 v[38:39], v[18:19], s[16:17], v[38:39] op_sel:[0,0,0] op_sel_hi:[0,1,1]
    s_lshl_b32 s18, s42, 16
    s_and_b32 s19, s42, 0xffff0000
    v_pk_fma_f32 v[32:33], v[10:11], s[18:19], v[32:33] op_sel:[1,0,0] op_sel_hi:[1,1,1]
    v_pk_fma_f32 v[36:37], v[18:19], s[18:19], v[36:37] op_sel:[1,0,0] op_sel_hi:[1,1,1]
    s_lshl_b32 s12, s43, 16
    s_and_b32 s13, s43, 0xffff0000
    v_pk_fma_f32 v[34:35], v[10:11], s[12:13], v[34:35] op_sel:[1,0,0] op_sel_hi:[1,1,1]
    v_pk_fma_f32 v[38:39], v[18:19], s[12:13], v[38:39] op_sel:[1,0,0] op_sel_hi:[1,1,1]
    s_lshl_b32 s14, s44, 16
    s_and_b32 s15, s44, 0xffff0000
    v_pk_fma_f32 v[32:33], v[12:13], s[14:15], v[32:33] op_sel:[0,0,0] op_sel_hi:[0,1,1]
    v_pk_fma_f32 v[36:37], v[20:21], s[14:15], v[36:37] op_sel:[0,0,0] op_sel_hi:[0,1,1]
    s_lshl_b32 s16, s45, 16
    s_and_b32 s17, s45, 0xffff0000
    v_pk_fma_f32 v[34:35], v[12:13], s[16:17], v[34:35] op_sel:[0,0,0] op_sel_hi:[0,1,1]
    v_pk_fma_f32 v[38:39], v[20:21], s[16:17], v[38:39] op_sel:[0,0,0] op_sel_hi:[0,1,1]
    s_lshl_b32 s18, s46, 16
    s_and_b32 s19, s46, 0xffff0000
    v_pk_fma_f32 v[32:33], v[12:13], s[18:19], v[32:33] op_sel:[1,0,0] op_sel_hi:[1,1,1]
    v_pk_fma_f32 v[36:37], v[20:21], s[18:19], v[36:37] op_sel:[1,0,0] op_sel_hi:[1,1,1]
    s_lshl_b32 s12, s47, 16
    s_and_b32 s13, s47, 0xffff0000
    v_pk_fma_f32 v[34:35], v[12:13], s[12:13], v[34:35] op_sel:[1,0,0] op_sel_hi:[1,1,1]
    v_pk_fma_f32 v[38:39], v[20:21], s[12:13], v[38:39] op_sel:[1,0,0] op_sel_hi:[1,1,1]
    s_lshl_b32 s14, s48, 16
    s_and_b32 s15, s48, 0xffff0000
    v_pk_fma_f32 v[32:33], v[14:15], s[14:15], v[32:33] op_sel:[0,0,0] op_sel_hi:[0,1,1]
    v_pk_fma_f32 v[36:37], v[22:23], s[14:15], v[36:37] op_sel:[0,0,0] op_sel_hi:[0,1,1]
    s_lshl_b32 s16, s49, 16
    s_and_b32 s17, s49, 0xffff0000
    v_pk_fma_f32 v[34:35], v[14:15], s[16:17], v[34:35] op_sel:[0,0,0] op_sel_hi:[0,1,1]
    v_pk_fma_f32 v[38:39], v[22:23], s[16:17], v[38:39] op_sel:[0,0,0] op_sel_hi:[0,1,1]
    s_lshl_b32 s18, s50, 16
    s_and_b32 s19, s50, 0xffff0000
    v_pk_fma_f32 v[32:33], v[14:15], s[18:19], v[32:33] op_sel:[1,0,0] op_sel_hi:[1,1,1]
    v_pk_fma_f32 v[36:37], v[22:23], s[18:19], v[36:37] op_sel:[1,0,0] op_sel_hi:[1,1,1]
    s_lshl_b32 s12, s51, 16
    s_and_b32 s13, s51, 0xffff0000
    v_pk_fma_f32 v[34:35], v[14:15], s[12:13], v[34:35] op_sel:[1,0,0] op_sel_hi:[1,1,1]
    v_pk_fma_f32 v[38:39], v[22:23], s[12:13], v[38:39] op_sel:[1,0,0] op_sel_hi:[1,1,1]
    v_cvt_pk_bf16_f32 v32, v32, v33
    v_cvt_pk_bf16_f32 v34, v34, v35
    v_cvt_pk_bf16_f32 v36, v36, v37
    v_cvt_pk_bf16_f32 v38, v38, v39
    v_and_b32 v33, 0xffff0000, v32
    v_lshlrev_b32 v32, 16, v32
    v_and_b32 v35, 0xffff0000, v34
    v_lshlrev_b32 v34, 16, v34
    v_and_b32 v37, 0xffff0000, v36
    v_lshlrev_b32 v36, 16, v36
    v_and_b32 v39, 0xffff0000, v38
    v_lshlrev_b32 v38, 16, v38
    s_waitcnt vmcnt(1)
    v_add_u32 v40, v40, v44
    v_add_u32 v48, v48, v52
    v_add_u32 v41, v41, v45
    v_add_u32 v49, v49, v53
    v_add_u32 v42, v42, v46
    v_add_u32 v50, v50, v54
    v_add_u32 v43, v43, v47
    v_add_u32 v51, v51, v55
    v_add_u32_sdwa v8, v40, v48 dst_sel:DWORD dst_unused:UNUSED_PAD src0_sel:WORD_0 src1_sel:WORD_0
    v_add_u32_sdwa v9, v40, v48 dst_sel:DWORD dst_unused:UNUSED_PAD src0_sel:WORD_1 src1_sel:WORD_1
    v_add_u32_sdwa v10, v41, v49 dst_sel:DWORD dst_unused:UNUSED_PAD src0_sel:WORD_0 src1_sel:WORD_0
    v_add_u32_sdwa v11, v41, v49 dst_sel:DWORD dst_unused:UNUSED_PAD src0_sel:WORD_1 src1_sel:WORD_1
    v_add_u32_sdwa v12, v42, v50 dst_sel:DWORD dst_unused:UNUSED_PAD src0_sel:WORD_0 src1_sel:WORD_0
    v_add_u32_sdwa v13, v42, v50 dst_sel:DWORD dst_unused:UNUSED_PAD src0_sel:WORD_1 src1_sel:WORD_1
    v_add_u32_sdwa v14, v43, v51 dst_sel:DWORD dst_unused:UNUSED_PAD src0_sel:WORD_0 src1_sel:WORD_0
    v_add_u32_sdwa v15, v43, v51 dst_sel:DWORD dst_unused:UNUSED_PAD src0_sel:WORD_1 src1_sel:WORD_1
    v_min3_u32 v5, v56, v57, v58
    v_bitop3_b32 v4, v56, v57, v58 bitop3:0xfe
    v_min_u32 v5, v5, v59
    v_or_b32 v4, v4, v59
    v_or_b32 v8, 0x4b000000, v8
    v_or_b32 v9, 0x4b000000, v9
    v_or_b32 v10, 0x4b000000, v10
    v_or_b32 v11, 0x4b000000, v11
    v_or_b32 v12, 0x4b000000, v12
    v_or_b32 v13, 0x4b000000, v13
    v_or_b32 v14, 0x4b000000, v14
    v_or_b32 v15, 0x4b000000, v15
    v_cmp_eq_u32 vcc, 0, v5
    v_add_f32 v8, 0xcb010000, v8
    v_add_f32 v9, 0xcb010000, v9
    v_add_f32 v10, 0xcb010000, v10
    v_add_f32 v11, 0xcb010000, v11
    v_add_f32 v12, 0xcb010000, v12
    v_add_f32 v13, 0xcb010000, v13
    v_add_f32 v14, 0xcb010000, v14
    v_add_f32 v15, 0xcb010000, v15
    v_mul_f32 v8, v4, v8
    v_mul_f32 v9, v4, v9
    v_mul_f32 v10, v4, v10
    v_mul_f32 v11, v4, v11
    v_mul_f32 v12, v4, v12
    v_mul_f32 v13, v4, v13
    v_mul_f32 v14, v4, v14
    v_mul_f32 v15, v4, v15
    s_cbranch_vccz p3_nof
    v_lshlrev_b32 v1, 4, v0
    v_mov_b32 v3, 0x70000000
    v_cmp_eq_u32 vcc, 0, v56
    s_mov_b32 s22, 517903360
    s_nop 0
    v_cndmask_b32 v5, v3, v1, vcc
    buffer_load_dwordx4 v[16:19], v5, s[28:31], s22 offen
    buffer_load_dwordx4 v[20:23], v5, s[28:31], s22 offen offset:16
    s_waitcnt vmcnt(0)
    v_add_f32 v8, v8, v16
    v_add_f32 v9, v9, v17
    v_add_f32 v10, v10, v18
    v_add_f32 v11, v11, v19
    v_add_f32 v12, v12, v20
    v_add_f32 v13, v13, v21
    v_add_f32 v14, v14, v22
    v_add_f32 v15, v15, v23
    v_cmp_eq_u32 vcc, 0, v57
    s_mov_b32 s22, 530715648
    s_nop 0
    v_cndmask_b32 v5, v3, v1, vcc
    buffer_load_dwordx4 v[16:19], v5, s[28:31], s22 offen
    buffer_load_dwordx4 v[20:23], v5, s[28:31], s22 offen offset:16
    s_waitcnt vmcnt(0)
    v_add_f32 v8, v8, v16
    v_add_f32 v9, v9, v17
    v_add_f32 v10, v10, v18
    v_add_f32 v11, v11, v19
    v_add_f32 v12, v12, v20
    v_add_f32 v13, v13, v21
    v_add_f32 v14, v14, v22
    v_add_f32 v15, v15, v23
    v_cmp_eq_u32 vcc, 0, v58
    s_mov_b32 s22, 543527936
    s_nop 0
    v_cndmask_b32 v5, v3, v1, vcc
    buffer_load_dwordx4 v[16:19], v5, s[28:31], s22 offen
    buffer_load_dwordx4 v[20:23], v5, s[28:31], s22 offen offset:16
    s_waitcnt vmcnt(0)
    v_add_f32 v8, v8, v16
    v_add_f32 v9, v9, v17
    v_add_f32 v10, v10, v18
    v_add_f32 v11, v11, v19
    v_add_f32 v12, v12, v20
    v_add_f32 v13, v13, v21
    v_add_f32 v14, v14, v22
    v_add_f32 v15, v15, v23
    v_cmp_eq_u32 vcc, 0, v59
    s_mov_b32 s22, 556340224
    s_nop 0
    v_cndmask_b32 v5, v3, v1, vcc
    buffer_load_dwordx4 v[16:19], v5, s[28:31], s22 offen
    buffer_load_dwordx4 v[20:23], v5, s[28:31], s22 offen offset:16
    s_waitcnt vmcnt(0)
    v_add_f32 v8, v8, v16
    v_add_f32 v9, v9, v17
    v_add_f32 v10, v10, v18
    v_add_f32 v11, v11, v19
    v_add_f32 v12, v12, v20
    v_add_f32 v13, v13, v21
    v_add_f32 v14, v14, v22
    v_add_f32 v15, v15, v23
p3_nof:
    s_lshl_b32 s14, s68, 16
    s_and_b32 s15, s68, 0xffff0000
    v_pk_mul_f32 v[16:17], v[8:9], s[14:15] op_sel:[0,0] op_sel_hi:[0,1]
    v_pk_mul_f32 v[20:21], v[12:13], s[14:15] op_sel:[0,0] op_sel_hi:[0,1]
    s_lshl_b32 s16, s69, 16
    s_and_b32 s17, s69, 0xffff0000
    v_pk_mul_f32 v[18:19], v[8:9], s[16:17] op_sel:[0,0] op_sel_hi:[0,1]
    v_pk_mul_f32 v[22:23], v[12:13], s[16:17] op_sel:[0,0] op_sel_hi:[0,1]
    s_lshl_b32 s18, s70, 16
    s_and_b32 s19, s70, 0xffff0000
    v_pk_fma_f32 v[16:17], v[8:9], s[18:19], v[16:17] op_sel:[1,0,0] op_sel_hi:[1,1,1]
    v_pk_fma_f32 v[20:21], v[12:13], s[18:19], v[20:21] op_sel:[1,0,0] op_sel_hi:[1,1,1]
    s_lshl_b32 s12, s71, 16
    s_and_b32 s13, s71, 0xffff0000
    v_pk_fma_f32 v[18:19], v[8:9], s[12:13], v[18:19] op_sel:[1,0,0] op_sel_hi:[1,1,1]
    v_pk_fma_f32 v[22:23], v[12:13], s[12:13], v[22:23] op_sel:[1,0,0] op_sel_hi:[1,1,1]
    s_lshl_b32 s14, s72, 16
    s_and_b32 s15, s72, 0xffff0000
    v_pk_fma_f32 v[16:17], v[10:11], s[14:15], v[16:17] op_sel:[0,0,0] op_sel_hi:[0,1,1]
    v_pk_fma_f32 v[20:21], v[14:15], s[14:15], v[20:21] op_sel:[0,0,0] op_sel_hi:[0,1,1]
    s_lshl_b32 s16, s73, 16
    s_and_b32 s17, s73, 0xffff0000
    v_pk_fma_f32 v[18:19], v[10:11], s[16:17], v[18:19] op_sel:[0,0,0] op_sel_hi:[0,1,1]
    v_pk_fma_f32 v[22:23], v[14:15], s[16:17], v[22:23] op_sel:[0,0,0] op_sel_hi:[0,1,1]
    s_lshl_b32 s18, s74, 16
    s_and_b32 s19, s74, 0xffff0000
    v_pk_fma_f32 v[16:17], v[10:11], s[18:19], v[16:17] op_sel:[1,0,0] op_sel_hi:[1,1,1]
    v_pk_fma_f32 v[20:21], v[14:15], s[18:19], v[20:21] op_sel:[1,0,0] op_sel_hi:[1,1,1]
    s_lshl_b32 s12, s75, 16
    s_and_b32 s13, s75, 0xffff0000
    v_pk_fma_f32 v[18:19], v[10:11], s[12:13], v[18:19] op_sel:[1,0,0] op_sel_hi:[1,1,1]
    v_pk_fma_f32 v[22:23], v[14:15], s[12:13], v[22:23] op_sel:[1,0,0] op_sel_hi:[1,1,1]
    v_mul_f32 v24, v24, v16
    v_mul_f32 v25, v25, v17
    v_mul_f32 v26, v26, v18
    v_mul_f32 v27, v27, v19
    v_mul_f32 v28, v28, v20
    v_mul_f32 v29, v29, v21
    v_mul_f32 v30, v30, v22
    v_mul_f32 v31, v31, v23
    v_cvt_pk_bf16_f32 v24, v24, v25
    v_cvt_pk_bf16_f32 v26, v26, v27
    v_cvt_pk_bf16_f32 v28, v28, v29
    v_cvt_pk_bf16_f32 v30, v30, v31
    v_and_b32 v25, 0xffff0000, v24
    v_lshlrev_b32 v24, 16, v24
    v_and_b32 v27, 0xffff0000, v26
    v_lshlrev_b32 v26, 16, v26
    v_and_b32 v29, 0xffff0000, v28
    v_lshlrev_b32 v28, 16, v28
    v_and_b32 v31, 0xffff0000, v30
    v_lshlrev_b32 v30, 16, v30
    s_lshl_b32 s14, s76, 16
    s_and_b32 s15, s76, 0xffff0000
    v_pk_mul_f32 v[16:17], v[24:25], s[14:15] op_sel:[0,0] op_sel_hi:[0,1]
    v_pk_mul_f32 v[20:21], v[28:29], s[14:15] op_sel:[0,0] op_sel_hi:[0,1]
    s_lshl_b32 s16, s77, 16
    s_and_b32 s17, s77, 0xffff0000
    v_pk_mul_f32 v[18:19], v[24:25], s[16:17] op_sel:[0,0] op_sel_hi:[0,1]
    v_pk_mul_f32 v[22:23], v[28:29], s[16:17] op_sel:[0,0] op_sel_hi:[0,1]
    s_lshl_b32 s18, s78, 16
    s_and_b32 s19, s78, 0xffff0000
    v_pk_fma_f32 v[16:17], v[24:25], s[18:19], v[16:17] op_sel:[1,0,0] op_sel_hi:[1,1,1]
    v_pk_fma_f32 v[20:21], v[28:29], s[18:19], v[20:21] op_sel:[1,0,0] op_sel_hi:[1,1,1]
    s_lshl_b32 s12, s79, 16
    s_and_b32 s13, s79, 0xffff0000
    v_pk_fma_f32 v[18:19], v[24:25], s[12:13], v[18:19] op_sel:[1,0,0] op_sel_hi:[1,1,1]
    v_pk_fma_f32 v[22:23], v[28:29], s[12:13], v[22:23] op_sel:[1,0,0] op_sel_hi:[1,1,1]
    s_lshl_b32 s14, s80, 16
    s_and_b32 s15, s80, 0xffff0000
    v_pk_fma_f32 v[16:17], v[26:27], s[14:15], v[16:17] op_sel:[0,0,0] op_sel_hi:[0,1,1]
    v_pk_fma_f32 v[20:21], v[30:31], s[14:15], v[20:21] op_sel:[0,0,0] op_sel_hi:[0,1,1]
    s_lshl_b32 s16, s81, 16
    s_and_b32 s17, s81, 0xffff0000
    v_pk_fma_f32 v[18:19], v[26:27], s[16:17], v[18:19] op_sel:[0,0,0] op_sel_hi:[0,1,1]
    v_pk_fma_f32 v[22:23], v[30:31], s[16:17], v[22:23] op_sel:[0,0,0] op_sel_hi:[0,1,1]
    s_lshl_b32 s18, s82, 16
    s_and_b32 s19, s82, 0xffff0000
    v_pk_fma_f32 v[16:17], v[26:27], s[18:19], v[16:17] op_sel:[1,0,0] op_sel_hi:[1,1,1]
    v_pk_fma_f32 v[20:21], v[30:31], s[18:19], v[20:21] op_sel:[1,0,0] op_sel_hi:[1,1,1]
    s_lshl_b32 s12, s83, 16
    s_and_b32 s13, s83, 0xffff0000
    v_pk_fma_f32 v[18:19], v[26:27], s[12:13], v[18:19] op_sel:[1,0,0] op_sel_hi:[1,1,1]
    v_pk_fma_f32 v[22:23], v[30:31], s[12:13], v[22:23] op_sel:[1,0,0] op_sel_hi:[1,1,1]
    v_cvt_pk_bf16_f32 v16, v16, v17
    v_cvt_pk_bf16_f32 v18, v18, v19
    v_cvt_pk_bf16_f32 v20, v20, v21
    v_cvt_pk_bf16_f32 v22, v22, v23
    v_and_b32 v17, 0xffff0000, v16
    v_lshlrev_b32 v16, 16, v16
    v_and_b32 v19, 0xffff0000, v18
    v_lshlrev_b32 v18, 16, v18
    v_and_b32 v21, 0xffff0000, v20
    v_lshlrev_b32 v20, 16, v20
    v_and_b32 v23, 0xffff0000, v22
    v_lshlrev_b32 v22, 16, v22
    v_mul_f32 v16, v16, v32
    v_mul_f32 v17, v17, v33
    v_mul_f32 v18, v18, v34
    v_mul_f32 v19, v19, v35
    v_mul_f32 v20, v20, v36
    v_mul_f32 v21, v21, v37
    v_mul_f32 v22, v22, v38
    v_mul_f32 v23, v23, v39
    v_cvt_pk_bf16_f32 v16, v16, v17
    v_cvt_pk_bf16_f32 v18, v18, v19
    v_cvt_pk_bf16_f32 v20, v20, v21
    v_cvt_pk_bf16_f32 v22, v22, v23
    v_and_b32 v17, 0xffff0000, v16
    v_lshlrev_b32 v16, 16, v16
    v_and_b32 v19, 0xffff0000, v18
    v_lshlrev_b32 v18, 16, v18
    v_and_b32 v21, 0xffff0000, v20
    v_lshlrev_b32 v20, 16, v20
    v_and_b32 v23, 0xffff0000, v22
    v_lshlrev_b32 v22, 16, v22
    s_waitcnt vmcnt(0)
    v_lshlrev_b32 v8, 16, v60
    v_and_b32 v9, 0xffff0000, v60
    v_lshlrev_b32 v10, 16, v61
    v_and_b32 v11, 0xffff0000, v61
    v_lshlrev_b32 v12, 16, v62
    v_and_b32 v13, 0xffff0000, v62
    v_lshlrev_b32 v14, 16, v63
    v_and_b32 v15, 0xffff0000, v63
    v_add_f32 v8, v8, v16
    v_add_f32 v9, v9, v17
    v_add_f32 v10, v10, v18
    v_add_f32 v11, v11, v19
    v_add_f32 v12, v12, v20
    v_add_f32 v13, v13, v21
    v_add_f32 v14, v14, v22
    v_add_f32 v15, v15, v23
    v_cvt_pk_bf16_f32 v4, v8, v9
    v_cvt_pk_bf16_f32 v5, v10, v11
    v_cvt_pk_bf16_f32 v6, v12, v13
    v_cvt_pk_bf16_f32 v7, v14, v15
    buffer_store_dwordx4 v[4:7], v2, s[24:27], 0 offen nt
p3_end:
    s_endpgm
.section .rodata,"a"
.p2align 6
.amdhsa_kernel p1_kernel
  .amdhsa_next_free_vgpr 128
  .amdhsa_next_free_sgpr 72
  .amdhsa_accum_offset 128
  .amdhsa_group_segment_fixed_size 0
  .amdhsa_kernarg_size 112
  .amdhsa_user_sgpr_count 2
  .amdhsa_user_sgpr_kernarg_segment_ptr 1
  .amdhsa_system_sgpr_workgroup_id_x 1
  .amdhsa_float_denorm_mode_32 3
.end_amdhsa_kernel
.p2align 6
.amdhsa_kernel p2_kernel
  .amdhsa_next_free_vgpr 128
  .amdhsa_next_free_sgpr 72
  .amdhsa_accum_offset 128
  .amdhsa_group_segment_fixed_size 0
  .amdhsa_kernarg_size 112
  .amdhsa_user_sgpr_count 2
  .amdhsa_user_sgpr_kernarg_segment_ptr 1
  .amdhsa_system_sgpr_workgroup_id_x 1
  .amdhsa_float_denorm_mode_32 3
.end_amdhsa_kernel
.p2align 6
.amdhsa_kernel p3_kernel
  .amdhsa_next_free_vgpr 64
  .amdhsa_next_free_sgpr 84
  .amdhsa_accum_offset 64
  .amdhsa_group_segment_fixed_size 0
  .amdhsa_kernarg_size 112
  .amdhsa_user_sgpr_count 2
  .amdhsa_user_sgpr_kernarg_segment_ptr 1
  .amdhsa_system_sgpr_workgroup_id_x 1
  .amdhsa_float_denorm_mode_32 3
.end_amdhsa_kernel
```

```asm
; @launch kernel=p1_kernel grid=(256,1,1) block=(1024,1,1) lds=163072
; @launch kernel=p2_kernel grid=(256,1,1) block=(1024,1,1) lds=154368
; @launch kernel=p3_kernel grid=(1563,1,1) block=(256,1,1) lds=0
.amdgcn_target "amdgcn-amd-amdhsa--gfx950"
.text
.globl p1_kernel
.p2align 8
.type p1_kernel,@function
p1_kernel:
    s_cmp_ge_u32 s2, 256
    s_cbranch_scc1 p1_end
    s_load_dwordx2 s[52:53], s[0:1], 0
    s_load_dwordx4 s[56:59], s[0:1], 8
    s_load_dwordx2 s[54:55], s[0:1], 32
    s_load_dwordx2 s[60:61], s[0:1], 48
    s_load_dwordx2 s[48:49], s[0:1], 104
    s_load_dwordx2 s[62:63], s[0:1], 96
    v_lshlrev_b32 v1, 4, v0
    v_lshlrev_b32 v2, 3, v0
    v_mov_b32 v3, 1
    v_lshrrev_b32 v117, 6, v0
    s_nop 0
    v_readfirstlane_b32 s28, v117
    s_waitcnt lgkmcnt(0)
    s_load_dword s45, s[60:61], 0
    s_mov_b32 s4, s56
    s_and_b32 s5, s57, 0xffff
    s_mov_b32 s6, 204800000
    s_mov_b32 s7, 0x20000
    s_mov_b32 s8, s58
    s_and_b32 s9, s59, 0xffff
    s_mov_b32 s10, 204800000
    s_mov_b32 s11, 0x20000
    s_mov_b32 s12, s54
    s_and_b32 s13, s55, 0xffff
    s_mov_b32 s14, 102400000
    s_mov_b32 s15, 0x20000
    s_mov_b32 s16, s48
    s_and_b32 s17, s49, 0xffff
    s_mov_b32 s18, 819200000
    s_mov_b32 s19, 0x20000
    s_mov_b32 s29, s2
    s_mul_i32 s31, s2, 73728
    s_lshl_b32 s30, s31, 1
    s_add_u32 s32, s30, 0
    buffer_load_dwordx4 v[94:97], v1, s[4:7], s32 offen nt
    buffer_load_dwordx4 v[102:105], v1, s[8:11], s32 offen nt
    s_add_u32 s32, s31, 0
    buffer_load_dwordx2 v[76:77], v2, s[12:15], s32 offen nt
    s_add_u32 s32, s30, 16384
    buffer_load_dwordx4 v[98:101], v1, s[4:7], s32 offen nt
    buffer_load_dwordx4 v[106:109], v1, s[8:11], s32 offen nt
    s_add_u32 s32, s31, 8192
    buffer_load_dwordx2 v[78:79], v2, s[12:15], s32 offen nt
    s_add_u32 s32, s30, 32768
    buffer_load_dwordx4 v[12:15], v1, s[4:7], s32 offen nt
    buffer_load_dwordx4 v[48:51], v1, s[8:11], s32 offen nt
    s_add_u32 s32, s31, 16384
    buffer_load_dwordx2 v[80:81], v2, s[12:15], s32 offen nt
    s_add_u32 s32, s31, 24576
    buffer_load_dwordx2 v[82:83], v2, s[12:15], s32 offen nt
    s_add_u32 s32, s31, 32768
    buffer_load_dwordx2 v[84:85], v2, s[12:15], s32 offen nt
    s_add_u32 s32, s31, 40960
    buffer_load_dwordx2 v[86:87], v2, s[12:15], s32 offen nt
    s_add_u32 s32, s31, 49152
    buffer_load_dwordx2 v[88:89], v2, s[12:15], s32 offen nt
    s_add_u32 s32, s31, 57344
    buffer_load_dwordx2 v[90:91], v2, s[12:15], s32 offen nt
    s_add_u32 s32, s31, 65536
    buffer_load_dwordx2 v[92:93], v2, s[12:15], s32 offen nt
    s_mov_b32 s24, s52
    s_and_b32 s25, s53, 0xffff
    s_mov_b32 s26, 6400000
    s_mov_b32 s27, 0x20000
    s_mov_b32 s20, s48
    s_and_b32 s21, s49, 0xffff
    s_mov_b32 s22, 0
    s_mov_b32 s23, 0x20000
    s_mov_b32 s40, s62
    s_and_b32 s41, s63, 0xffff
    s_mov_b32 s42, 256
    s_mov_b32 s43, 0x20000
    s_mov_b32 s36, 643827
    s_mov_b32 s37, 214609
    s_mov_b32 s38, 343268
    s_mov_b32 s39, -6671
    s_mov_b32 s44, -12512
    s_mov_b32 s34, 1
    v_mov_b32 v73, 0x40000000
    v_mov_b32 v122, 0
    v_mov_b32 v123, 0
    v_mov_b32 v124, 0
    v_mov_b32 v125, 0
    ds_write_b128 v1, v[122:125] offset:0
    s_waitcnt lgkmcnt(0)
    s_barrier
    s_lshl_b32 s45, s45, 16
p1_tile:
    v_mov_b32 v122, 0
    v_mov_b32 v123, 0
    v_mov_b32 v124, 0
    v_mov_b32 v125, 0
    ds_write_b128 v1, v[122:125] offset:10496
    ds_write_b128 v1, v[122:125] offset:26880
    ds_write_b128 v1, v[122:125] offset:43264
    s_cmp_lg_u32 s28, 15
    s_cbranch_scc1 p1_tk0
    v_mov_b32 v127, 1
    s_mov_b64 exec, 1
    buffer_atomic_add v127, off, s[40:43], 0 offset:128 sc0 sc1
    s_mov_b64 exec, -1
p1_tk0:
    v_mov_b32 v123, s45
    v_mov_b32 v124, 0x007f007f
    v_mov_b32 v125, 0xe000
    v_mov_b32 v126, 0xffff0000
    s_cmp_lt_u32 s29, 1426
    s_cselect_b32 s6, 204800000, 0
    s_cselect_b32 s10, 204800000, 0
    s_add_u32 s32, s30, 49152
    buffer_load_dwordx4 v[16:19], v1, s[4:7], s32 offen nt
    buffer_load_dwordx4 v[52:55], v1, s[8:11], s32 offen nt
    s_waitcnt vmcnt(14)
    v_lshlrev_b32 v117, 16, v76
    v_and_b32 v118, v126, v76
    v_mul_f32 v117, v123, v117
    v_mul_f32 v118, v123, v118
    v_cvt_pk_bf16_f32 v117, v117, v118
    v_and_b32 v118, v126, v117
    v_lshlrev_b32 v117, 16, v117
    v_mul_f32 v117, 0.15915494, v117
    v_mul_f32 v118, 0.15915494, v118
    v_fract_f32 v117, v117
    v_fract_f32 v118, v118
    v_cos_f32 v117, v117
    v_cos_f32 v118, v118
    v_mul_hi_u32_u24 v122, s38, v102
    v_mul_hi_u32_u24 v121, s37, v94
    v_mul_hi_u32_u24 v120, s36, v94
    v_mad_i32_i24 v110, v122, s44, v102
    v_mad_u32_u24 v40, v122, 40, v121
    v_mad_i32_i24 v4, v120, s39, v94
    v_lshlrev_b16 v40, 2, v40
    v_mad_i32_i24 v120, v121, -3, v120
    ds_add_u32 v40, v3 offset:0
    v_lshl_or_b32 v4, v110, 16, v4
    v_lshl_or_b32 v4, v120, 30, v4
    v_mul_f32 v117, 0x03800000, v117
    v_mul_f32 v118, 0x03800000, v118
    v_cvt_pk_bf16_f32 v117, v117, v118
    v_mul_hi_u32_u24 v122, s38, v103
    v_mul_hi_u32_u24 v121, s37, v95
    v_mul_hi_u32_u24 v120, s36, v95
    v_mad_i32_i24 v110, v122, s44, v103
    v_mad_u32_u24 v41, v122, 40, v121
    v_mad_i32_i24 v5, v120, s39, v95
    v_lshlrev_b16 v41, 2, v41
    v_mad_i32_i24 v120, v121, -3, v120
    ds_add_u32 v41, v3 offset:0
    v_lshl_or_b32 v5, v110, 16, v5
    v_lshl_or_b32 v5, v120, 30, v5
    v_lshrrev_b32 v118, 3, v117
    v_lshrrev_b32 v119, 8, v117
    v_lshlrev_b16 v117, 13, v117
    v_bitop3_b32 v119, v118, v119, v124 bitop3:0x1b
    v_bitop3_b32 v4, v117, v125, v4 bitop3:0xae
    v_lshl_or_b32 v40, v119, 16, v40
    v_bitop3_b32 v5, v118, v125, v5 bitop3:0xae
    v_bitop3_b32 v41, v119, v126, v41 bitop3:0xea
    v_lshlrev_b32 v117, 16, v77
    v_and_b32 v118, v126, v77
    v_mul_f32 v117, v123, v117
    v_mul_f32 v118, v123, v118
    v_cvt_pk_bf16_f32 v117, v117, v118
    v_and_b32 v118, v126, v117
    v_lshlrev_b32 v117, 16, v117
    v_mul_f32 v117, 0.15915494, v117
    v_mul_f32 v118, 0.15915494, v118
    v_fract_f32 v117, v117
    v_fract_f32 v118, v118
    v_cos_f32 v117, v117
    v_cos_f32 v118, v118
    v_mul_hi_u32_u24 v122, s38, v104
    v_mul_hi_u32_u24 v121, s37, v96
    v_mul_hi_u32_u24 v120, s36, v96
    v_mad_i32_i24 v110, v122, s44, v104
    v_mad_u32_u24 v42, v122, 40, v121
    v_mad_i32_i24 v6, v120, s39, v96
    v_lshlrev_b16 v42, 2, v42
    v_mad_i32_i24 v120, v121, -3, v120
    ds_add_u32 v42, v3 offset:0
    v_lshl_or_b32 v6, v110, 16, v6
    v_lshl_or_b32 v6, v120, 30, v6
    v_mul_f32 v117, 0x03800000, v117
    v_mul_f32 v118, 0x03800000, v118
    v_cvt_pk_bf16_f32 v117, v117, v118
    v_mul_hi_u32_u24 v122, s38, v105
    v_mul_hi_u32_u24 v121, s37, v97
    v_mul_hi_u32_u24 v120, s36, v97
    v_mad_i32_i24 v110, v122, s44, v105
    v_mad_u32_u24 v43, v122, 40, v121
    v_mad_i32_i24 v7, v120, s39, v97
    v_lshlrev_b16 v43, 2, v43
    v_mad_i32_i24 v120, v121, -3, v120
    ds_add_u32 v43, v3 offset:0
    v_lshl_or_b32 v7, v110, 16, v7
    v_lshl_or_b32 v7, v120, 30, v7
    v_lshrrev_b32 v118, 3, v117
    v_lshrrev_b32 v119, 8, v117
    v_lshlrev_b16 v117, 13, v117
    v_bitop3_b32 v119, v118, v119, v124 bitop3:0x1b
    v_bitop3_b32 v6, v117, v125, v6 bitop3:0xae
    v_lshl_or_b32 v42, v119, 16, v42
    v_bitop3_b32 v7, v118, v125, v7 bitop3:0xae
    v_bitop3_b32 v43, v119, v126, v43 bitop3:0xea
    s_cmp_lt_u32 s29, 1389
    s_cselect_b32 s6, 204800000, 0
    s_cselect_b32 s10, 204800000, 0
    s_add_u32 s32, s30, 65536
    buffer_load_dwordx4 v[20:23], v1, s[4:7], s32 offen nt
    buffer_load_dwordx4 v[56:59], v1, s[8:11], s32 offen nt
    s_cmp_ge_u32 s29, 1499
    s_cbranch_scc1 p1_k2
    s_cmp_lg_u32 s34, 0
    s_cbranch_scc1 p1_w3
    s_waitcnt vmcnt(10)
p1_w3:
    s_waitcnt vmcnt(13)
    v_lshlrev_b32 v117, 16, v78
    v_and_b32 v118, v126, v78
    v_mul_f32 v117, v123, v117
    v_mul_f32 v118, v123, v118
    v_cvt_pk_bf16_f32 v117, v117, v118
    v_and_b32 v118, v126, v117
    v_lshlrev_b32 v117, 16, v117
    v_mul_f32 v117, 0.15915494, v117
    v_mul_f32 v118, 0.15915494, v118
    v_fract_f32 v117, v117
    v_fract_f32 v118, v118
    v_cos_f32 v117, v117
    v_cos_f32 v118, v118
    v_mul_hi_u32_u24 v122, s38, v106
    v_mul_hi_u32_u24 v121, s37, v98
    v_mul_hi_u32_u24 v120, s36, v98
    v_mad_i32_i24 v110, v122, s44, v106
    v_mad_u32_u24 v44, v122, 40, v121
    v_mad_i32_i24 v8, v120, s39, v98
    v_lshlrev_b16 v44, 2, v44
    v_mad_i32_i24 v120, v121, -3, v120
    ds_add_u32 v44, v3 offset:0
    v_lshl_or_b32 v8, v110, 16, v8
    v_lshl_or_b32 v8, v120, 30, v8
    v_mul_f32 v117, 0x03800000, v117
    v_mul_f32 v118, 0x03800000, v118
    v_cvt_pk_bf16_f32 v117, v117, v118
    v_mul_hi_u32_u24 v122, s38, v107
    v_mul_hi_u32_u24 v121, s37, v99
    v_mul_hi_u32_u24 v120, s36, v99
    v_mad_i32_i24 v110, v122, s44, v107
    v_mad_u32_u24 v45, v122, 40, v121
    v_mad_i32_i24 v9, v120, s39, v99
    v_lshlrev_b16 v45, 2, v45
    v_mad_i32_i24 v120, v121, -3, v120
    ds_add_u32 v45, v3 offset:0
    v_lshl_or_b32 v9, v110, 16, v9
    v_lshl_or_b32 v9, v120, 30, v9
    v_lshrrev_b32 v118, 3, v117
    v_lshrrev_b32 v119, 8, v117
    v_lshlrev_b16 v117, 13, v117
    v_bitop3_b32 v119, v118, v119, v124 bitop3:0x1b
    v_bitop3_b32 v8, v117, v125, v8 bitop3:0xae
    v_lshl_or_b32 v44, v119, 16, v44
    v_bitop3_b32 v9, v118, v125, v9 bitop3:0xae
    v_bitop3_b32 v45, v119, v126, v45 bitop3:0xea
    v_lshlrev_b32 v117, 16, v79
    v_and_b32 v118, v126, v79
    v_mul_f32 v117, v123, v117
    v_mul_f32 v118, v123, v118
    v_cvt_pk_bf16_f32 v117, v117, v118
    v_and_b32 v118, v126, v117
    v_lshlrev_b32 v117, 16, v117
    v_mul_f32 v117, 0.15915494, v117
    v_mul_f32 v118, 0.15915494, v118
    v_fract_f32 v117, v117
    v_fract_f32 v118, v118
    v_cos_f32 v117, v117
    v_cos_f32 v118, v118
    v_mul_hi_u32_u24 v122, s38, v108
    v_mul_hi_u32_u24 v121, s37, v100
    v_mul_hi_u32_u24 v120, s36, v100
    v_mad_i32_i24 v110, v122, s44, v108
    v_mad_u32_u24 v46, v122, 40, v121
    v_mad_i32_i24 v10, v120, s39, v100
    v_lshlrev_b16 v46, 2, v46
    v_mad_i32_i24 v120, v121, -3, v120
    ds_add_u32 v46, v3 offset:0
    v_lshl_or_b32 v10, v110, 16, v10
    v_lshl_or_b32 v10, v120, 30, v10
    v_mul_f32 v117, 0x03800000, v117
    v_mul_f32 v118, 0x03800000, v118
    v_cvt_pk_bf16_f32 v117, v117, v118
    v_mul_hi_u32_u24 v122, s38, v109
    v_mul_hi_u32_u24 v121, s37, v101
    v_mul_hi_u32_u24 v120, s36, v101
    v_mad_i32_i24 v110, v122, s44, v109
    v_mad_u32_u24 v47, v122, 40, v121
    v_mad_i32_i24 v11, v120, s39, v101
    v_lshlrev_b16 v47, 2, v47
    v_mad_i32_i24 v120, v121, -3, v120
    ds_add_u32 v47, v3 offset:0
    v_lshl_or_b32 v11, v110, 16, v11
    v_lshl_or_b32 v11, v120, 30, v11
    v_lshrrev_b32 v118, 3, v117
    v_lshrrev_b32 v119, 8, v117
    v_lshlrev_b16 v117, 13, v117
    v_bitop3_b32 v119, v118, v119, v124 bitop3:0x1b
    v_bitop3_b32 v10, v117, v125, v10 bitop3:0xae
    v_lshl_or_b32 v46, v119, 16, v46
    v_bitop3_b32 v11, v118, v125, v11 bitop3:0xae
    v_bitop3_b32 v47, v119, v126, v47 bitop3:0xea
p1_k2:
    s_cmp_lt_u32 s29, 1352
    s_cselect_b32 s6, 204800000, 0
    s_cselect_b32 s10, 204800000, 0
    s_add_u32 s32, s30, 81920
    buffer_load_dwordx4 v[24:27], v1, s[4:7], s32 offen nt
    buffer_load_dwordx4 v[60:63], v1, s[8:11], s32 offen nt
    s_cmp_ge_u32 s29, 1462
    s_cbranch_scc1 p1_k4
    s_cmp_lg_u32 s34, 0
    s_cbranch_scc1 p1_w5
    s_waitcnt vmcnt(6)
p1_w5:
    s_waitcnt vmcnt(11)
    v_lshlrev_b32 v117, 16, v80
    v_and_b32 v118, v126, v80
    v_mul_f32 v117, v123, v117
    v_mul_f32 v118, v123, v118
    v_cvt_pk_bf16_f32 v117, v117, v118
    v_and_b32 v118, v126, v117
    v_lshlrev_b32 v117, 16, v117
    v_mul_f32 v117, 0.15915494, v117
    v_mul_f32 v118, 0.15915494, v118
    v_fract_f32 v117, v117
    v_fract_f32 v118, v118
    v_cos_f32 v117, v117
    v_cos_f32 v118, v118
    v_mul_hi_u32_u24 v122, s38, v48
    v_mul_hi_u32_u24 v121, s37, v12
    v_mul_hi_u32_u24 v120, s36, v12
    v_mad_i32_i24 v110, v122, s44, v48
    v_mad_u32_u24 v48, v122, 40, v121
    v_mad_i32_i24 v12, v120, s39, v12
    v_lshlrev_b16 v48, 2, v48
    v_mad_i32_i24 v120, v121, -3, v120
    ds_add_u32 v48, v3 offset:0
    v_lshl_or_b32 v12, v110, 16, v12
    v_lshl_or_b32 v12, v120, 30, v12
    v_mul_f32 v117, 0x03800000, v117
    v_mul_f32 v118, 0x03800000, v118
    v_cvt_pk_bf16_f32 v117, v117, v118
    v_mul_hi_u32_u24 v122, s38, v49
    v_mul_hi_u32_u24 v121, s37, v13
    v_mul_hi_u32_u24 v120, s36, v13
    v_mad_i32_i24 v110, v122, s44, v49
    v_mad_u32_u24 v49, v122, 40, v121
    v_mad_i32_i24 v13, v120, s39, v13
    v_lshlrev_b16 v49, 2, v49
    v_mad_i32_i24 v120, v121, -3, v120
    ds_add_u32 v49, v3 offset:0
    v_lshl_or_b32 v13, v110, 16, v13
    v_lshl_or_b32 v13, v120, 30, v13
    v_lshrrev_b32 v118, 3, v117
    v_lshrrev_b32 v119, 8, v117
    v_lshlrev_b16 v117, 13, v117
    v_bitop3_b32 v119, v118, v119, v124 bitop3:0x1b
    v_bitop3_b32 v12, v117, v125, v12 bitop3:0xae
    v_lshl_or_b32 v48, v119, 16, v48
    v_bitop3_b32 v13, v118, v125, v13 bitop3:0xae
    v_bitop3_b32 v49, v119, v126, v49 bitop3:0xea
    v_lshlrev_b32 v117, 16, v81
    v_and_b32 v118, v126, v81
    v_mul_f32 v117, v123, v117
    v_mul_f32 v118, v123, v118
    v_cvt_pk_bf16_f32 v117, v117, v118
    v_and_b32 v118, v126, v117
    v_lshlrev_b32 v117, 16, v117
    v_mul_f32 v117, 0.15915494, v117
    v_mul_f32 v118, 0.15915494, v118
    v_fract_f32 v117, v117
    v_fract_f32 v118, v118
    v_cos_f32 v117, v117
    v_cos_f32 v118, v118
    v_mul_hi_u32_u24 v122, s38, v50
    v_mul_hi_u32_u24 v121, s37, v14
    v_mul_hi_u32_u24 v120, s36, v14
    v_mad_i32_i24 v110, v122, s44, v50
    v_mad_u32_u24 v50, v122, 40, v121
    v_mad_i32_i24 v14, v120, s39, v14
    v_lshlrev_b16 v50, 2, v50
    v_mad_i32_i24 v120, v121, -3, v120
    ds_add_u32 v50, v3 offset:0
    v_lshl_or_b32 v14, v110, 16, v14
    v_lshl_or_b32 v14, v120, 30, v14
    v_mul_f32 v117, 0x03800000, v117
    v_mul_f32 v118, 0x03800000, v118
    v_cvt_pk_bf16_f32 v117, v117, v118
    v_mul_hi_u32_u24 v122, s38, v51
    v_mul_hi_u32_u24 v121, s37, v15
    v_mul_hi_u32_u24 v120, s36, v15
    v_mad_i32_i24 v110, v122, s44, v51
    v_mad_u32_u24 v51, v122, 40, v121
    v_mad_i32_i24 v15, v120, s39, v15
    v_lshlrev_b16 v51, 2, v51
    v_mad_i32_i24 v120, v121, -3, v120
    ds_add_u32 v51, v3 offset:0
    v_lshl_or_b32 v15, v110, 16, v15
    v_lshl_or_b32 v15, v120, 30, v15
    v_lshrrev_b32 v118, 3, v117
    v_lshrrev_b32 v119, 8, v117
    v_lshlrev_b16 v117, 13, v117
    v_bitop3_b32 v119, v118, v119, v124 bitop3:0x1b
    v_bitop3_b32 v14, v117, v125, v14 bitop3:0xae
    v_lshl_or_b32 v50, v119, 16, v50
    v_bitop3_b32 v15, v118, v125, v15 bitop3:0xae
    v_bitop3_b32 v51, v119, v126, v51 bitop3:0xea
p1_k4:
    s_cmp_lt_u32 s29, 1315
    s_cselect_b32 s6, 204800000, 0
    s_cselect_b32 s10, 204800000, 0
    s_add_u32 s32, s30, 98304
    buffer_load_dwordx4 v[28:31], v1, s[4:7], s32 offen nt
    buffer_load_dwordx4 v[64:67], v1, s[8:11], s32 offen nt
    s_cmp_ge_u32 s29, 1426
    s_cbranch_scc1 p1_k6
    s_waitcnt vmcnt(6)
    v_lshlrev_b32 v117, 16, v82
    v_and_b32 v118, v126, v82
    v_mul_f32 v117, v123, v117
    v_mul_f32 v118, v123, v118
    v_cvt_pk_bf16_f32 v117, v117, v118
    v_and_b32 v118, v126, v117
    v_lshlrev_b32 v117, 16, v117
    v_mul_f32 v117, 0.15915494, v117
    v_mul_f32 v118, 0.15915494, v118
    v_fract_f32 v117, v117
    v_fract_f32 v118, v118
    v_cos_f32 v117, v117
    v_cos_f32 v118, v118
    v_mul_hi_u32_u24 v122, s38, v52
    v_mul_hi_u32_u24 v121, s37, v16
    v_mul_hi_u32_u24 v120, s36, v16
    v_mad_i32_i24 v110, v122, s44, v52
    v_mad_u32_u24 v52, v122, 40, v121
    v_mad_i32_i24 v16, v120, s39, v16
    v_lshlrev_b16 v52, 2, v52
    v_mad_i32_i24 v120, v121, -3, v120
    ds_add_u32 v52, v3 offset:0
    v_lshl_or_b32 v16, v110, 16, v16
    v_lshl_or_b32 v16, v120, 30, v16
    v_mul_f32 v117, 0x03800000, v117
    v_mul_f32 v118, 0x03800000, v118
    v_cvt_pk_bf16_f32 v117, v117, v118
    v_mul_hi_u32_u24 v122, s38, v53
    v_mul_hi_u32_u24 v121, s37, v17
    v_mul_hi_u32_u24 v120, s36, v17
    v_mad_i32_i24 v110, v122, s44, v53
    v_mad_u32_u24 v53, v122, 40, v121
    v_mad_i32_i24 v17, v120, s39, v17
    v_lshlrev_b16 v53, 2, v53
    v_mad_i32_i24 v120, v121, -3, v120
    ds_add_u32 v53, v3 offset:0
    v_lshl_or_b32 v17, v110, 16, v17
    v_lshl_or_b32 v17, v120, 30, v17
    v_lshrrev_b32 v118, 3, v117
    v_lshrrev_b32 v119, 8, v117
    v_lshlrev_b16 v117, 13, v117
    v_bitop3_b32 v119, v118, v119, v124 bitop3:0x1b
    v_bitop3_b32 v16, v117, v125, v16 bitop3:0xae
    v_lshl_or_b32 v52, v119, 16, v52
    v_bitop3_b32 v17, v118, v125, v17 bitop3:0xae
    v_bitop3_b32 v53, v119, v126, v53 bitop3:0xea
    v_lshlrev_b32 v117, 16, v83
    v_and_b32 v118, v126, v83
    v_mul_f32 v117, v123, v117
    v_mul_f32 v118, v123, v118
    v_cvt_pk_bf16_f32 v117, v117, v118
    v_and_b32 v118, v126, v117
    v_lshlrev_b32 v117, 16, v117
    v_mul_f32 v117, 0.15915494, v117
    v_mul_f32 v118, 0.15915494, v118
    v_fract_f32 v117, v117
    v_fract_f32 v118, v118
    v_cos_f32 v117, v117
    v_cos_f32 v118, v118
    v_mul_hi_u32_u24 v122, s38, v54
    v_mul_hi_u32_u24 v121, s37, v18
    v_mul_hi_u32_u24 v120, s36, v18
    v_mad_i32_i24 v110, v122, s44, v54
    v_mad_u32_u24 v54, v122, 40, v121
    v_mad_i32_i24 v18, v120, s39, v18
    v_lshlrev_b16 v54, 2, v54
    v_mad_i32_i24 v120, v121, -3, v120
    ds_add_u32 v54, v3 offset:0
    v_lshl_or_b32 v18, v110, 16, v18
    v_lshl_or_b32 v18, v120, 30, v18
    v_mul_f32 v117, 0x03800000, v117
    v_mul_f32 v118, 0x03800000, v118
    v_cvt_pk_bf16_f32 v117, v117, v118
    v_mul_hi_u32_u24 v122, s38, v55
    v_mul_hi_u32_u24 v121, s37, v19
    v_mul_hi_u32_u24 v120, s36, v19
    v_mad_i32_i24 v110, v122, s44, v55
    v_mad_u32_u24 v55, v122, 40, v121
    v_mad_i32_i24 v19, v120, s39, v19
    v_lshlrev_b16 v55, 2, v55
    v_mad_i32_i24 v120, v121, -3, v120
    ds_add_u32 v55, v3 offset:0
    v_lshl_or_b32 v19, v110, 16, v19
    v_lshl_or_b32 v19, v120, 30, v19
    v_lshrrev_b32 v118, 3, v117
    v_lshrrev_b32 v119, 8, v117
    v_lshlrev_b16 v117, 13, v117
    v_bitop3_b32 v119, v118, v119, v124 bitop3:0x1b
    v_bitop3_b32 v18, v117, v125, v18 bitop3:0xae
    v_lshl_or_b32 v54, v119, 16, v54
    v_bitop3_b32 v19, v118, v125, v19 bitop3:0xae
    v_bitop3_b32 v55, v119, v126, v55 bitop3:0xea
p1_k6:
    s_cmp_lt_u32 s29, 1279
    s_cselect_b32 s6, 204800000, 0
    s_cselect_b32 s10, 204800000, 0
    s_add_u32 s32, s30, 114688
    buffer_load_dwordx4 v[32:35], v1, s[4:7], s32 offen nt
    buffer_load_dwordx4 v[68:71], v1, s[8:11], s32 offen nt
    s_cmp_ge_u32 s29, 1389
    s_cbranch_scc1 p1_k8
    s_waitcnt vmcnt(6)
    v_lshlrev_b32 v117, 16, v84
    v_and_b32 v118, v126, v84
    v_mul_f32 v117, v123, v117
    v_mul_f32 v118, v123, v118
    v_cvt_pk_bf16_f32 v117, v117, v118
    v_and_b32 v118, v126, v117
    v_lshlrev_b32 v117, 16, v117
    v_mul_f32 v117, 0.15915494, v117
    v_mul_f32 v118, 0.15915494, v118
    v_fract_f32 v117, v117
    v_fract_f32 v118, v118
    v_cos_f32 v117, v117
    v_cos_f32 v118, v118
    v_mul_hi_u32_u24 v122, s38, v56
    v_mul_hi_u32_u24 v121, s37, v20
    v_mul_hi_u32_u24 v120, s36, v20
    v_mad_i32_i24 v110, v122, s44, v56
    v_mad_u32_u24 v56, v122, 40, v121
    v_mad_i32_i24 v20, v120, s39, v20
    v_lshlrev_b16 v56, 2, v56
    v_mad_i32_i24 v120, v121, -3, v120
    ds_add_u32 v56, v3 offset:0
    v_lshl_or_b32 v20, v110, 16, v20
    v_lshl_or_b32 v20, v120, 30, v20
    v_mul_f32 v117, 0x03800000, v117
    v_mul_f32 v118, 0x03800000, v118
    v_cvt_pk_bf16_f32 v117, v117, v118
    v_mul_hi_u32_u24 v122, s38, v57
    v_mul_hi_u32_u24 v121, s37, v21
    v_mul_hi_u32_u24 v120, s36, v21
    v_mad_i32_i24 v110, v122, s44, v57
    v_mad_u32_u24 v57, v122, 40, v121
    v_mad_i32_i24 v21, v120, s39, v21
    v_lshlrev_b16 v57, 2, v57
    v_mad_i32_i24 v120, v121, -3, v120
    ds_add_u32 v57, v3 offset:0
    v_lshl_or_b32 v21, v110, 16, v21
    v_lshl_or_b32 v21, v120, 30, v21
    v_lshrrev_b32 v118, 3, v117
    v_lshrrev_b32 v119, 8, v117
    v_lshlrev_b16 v117, 13, v117
    v_bitop3_b32 v119, v118, v119, v124 bitop3:0x1b
    v_bitop3_b32 v20, v117, v125, v20 bitop3:0xae
    v_lshl_or_b32 v56, v119, 16, v56
    v_bitop3_b32 v21, v118, v125, v21 bitop3:0xae
    v_bitop3_b32 v57, v119, v126, v57 bitop3:0xea
    v_lshlrev_b32 v117, 16, v85
    v_and_b32 v118, v126, v85
    v_mul_f32 v117, v123, v117
    v_mul_f32 v118, v123, v118
    v_cvt_pk_bf16_f32 v117, v117, v118
    v_and_b32 v118, v126, v117
    v_lshlrev_b32 v117, 16, v117
    v_mul_f32 v117, 0.15915494, v117
    v_mul_f32 v118, 0.15915494, v118
    v_fract_f32 v117, v117
    v_fract_f32 v118, v118
    v_cos_f32 v117, v117
    v_cos_f32 v118, v118
    v_mul_hi_u32_u24 v122, s38, v58
    v_mul_hi_u32_u24 v121, s37, v22
    v_mul_hi_u32_u24 v120, s36, v22
    v_mad_i32_i24 v110, v122, s44, v58
    v_mad_u32_u24 v58, v122, 40, v121
    v_mad_i32_i24 v22, v120, s39, v22
    v_lshlrev_b16 v58, 2, v58
    v_mad_i32_i24 v120, v121, -3, v120
    ds_add_u32 v58, v3 offset:0
    v_lshl_or_b32 v22, v110, 16, v22
    v_lshl_or_b32 v22, v120, 30, v22
    v_mul_f32 v117, 0x03800000, v117
    v_mul_f32 v118, 0x03800000, v118
    v_cvt_pk_bf16_f32 v117, v117, v118
    v_mul_hi_u32_u24 v122, s38, v59
    v_mul_hi_u32_u24 v121, s37, v23
    v_mul_hi_u32_u24 v120, s36, v23
    v_mad_i32_i24 v110, v122, s44, v59
    v_mad_u32_u24 v59, v122, 40, v121
    v_mad_i32_i24 v23, v120, s39, v23
    v_lshlrev_b16 v59, 2, v59
    v_mad_i32_i24 v120, v121, -3, v120
    ds_add_u32 v59, v3 offset:0
    v_lshl_or_b32 v23, v110, 16, v23
    v_lshl_or_b32 v23, v120, 30, v23
    v_lshrrev_b32 v118, 3, v117
    v_lshrrev_b32 v119, 8, v117
    v_lshlrev_b16 v117, 13, v117
    v_bitop3_b32 v119, v118, v119, v124 bitop3:0x1b
    v_bitop3_b32 v22, v117, v125, v22 bitop3:0xae
    v_lshl_or_b32 v58, v119, 16, v58
    v_bitop3_b32 v23, v118, v125, v23 bitop3:0xae
    v_bitop3_b32 v59, v119, v126, v59 bitop3:0xea
p1_k8:
    s_cmp_lt_u32 s29, 1242
    s_cselect_b32 s6, 204800000, 0
    s_cselect_b32 s10, 204800000, 0
    s_add_u32 s32, s30, 131072
    buffer_load_dwordx4 v[36:39], v1, s[4:7], s32 offen nt
    buffer_load_dwordx4 v[72:75], v1, s[8:11], s32 offen nt
    s_cmp_ge_u32 s29, 1352
    s_cbranch_scc1 p1_k10
    s_waitcnt vmcnt(6)
    v_lshlrev_b32 v117, 16, v86
    v_and_b32 v118, v126, v86
    v_mul_f32 v117, v123, v117
    v_mul_f32 v118, v123, v118
    v_cvt_pk_bf16_f32 v117, v117, v118
    v_and_b32 v118, v126, v117
    v_lshlrev_b32 v117, 16, v117
    v_mul_f32 v117, 0.15915494, v117
    v_mul_f32 v118, 0.15915494, v118
    v_fract_f32 v117, v117
    v_fract_f32 v118, v118
    v_cos_f32 v117, v117
    v_cos_f32 v118, v118
    v_mul_hi_u32_u24 v122, s38, v60
    v_mul_hi_u32_u24 v121, s37, v24
    v_mul_hi_u32_u24 v120, s36, v24
    v_mad_i32_i24 v110, v122, s44, v60
    v_mad_u32_u24 v60, v122, 40, v121
    v_mad_i32_i24 v24, v120, s39, v24
    v_lshlrev_b16 v60, 2, v60
    v_mad_i32_i24 v120, v121, -3, v120
    ds_add_u32 v60, v3 offset:0
    v_lshl_or_b32 v24, v110, 16, v24
    v_lshl_or_b32 v24, v120, 30, v24
    v_mul_f32 v117, 0x03800000, v117
    v_mul_f32 v118, 0x03800000, v118
    v_cvt_pk_bf16_f32 v117, v117, v118
    v_mul_hi_u32_u24 v122, s38, v61
    v_mul_hi_u32_u24 v121, s37, v25
    v_mul_hi_u32_u24 v120, s36, v25
    v_mad_i32_i24 v110, v122, s44, v61
    v_mad_u32_u24 v61, v122, 40, v121
    v_mad_i32_i24 v25, v120, s39, v25
    v_lshlrev_b16 v61, 2, v61
    v_mad_i32_i24 v120, v121, -3, v120
    ds_add_u32 v61, v3 offset:0
    v_lshl_or_b32 v25, v110, 16, v25
    v_lshl_or_b32 v25, v120, 30, v25
    v_lshrrev_b32 v118, 3, v117
    v_lshrrev_b32 v119, 8, v117
    v_lshlrev_b16 v117, 13, v117
    v_bitop3_b32 v119, v118, v119, v124 bitop3:0x1b
    v_bitop3_b32 v24, v117, v125, v24 bitop3:0xae
    v_lshl_or_b32 v60, v119, 16, v60
    v_bitop3_b32 v25, v118, v125, v25 bitop3:0xae
    v_bitop3_b32 v61, v119, v126, v61 bitop3:0xea
    v_lshlrev_b32 v117, 16, v87
    v_and_b32 v118, v126, v87
    v_mul_f32 v117, v123, v117
    v_mul_f32 v118, v123, v118
    v_cvt_pk_bf16_f32 v117, v117, v118
    v_and_b32 v118, v126, v117
    v_lshlrev_b32 v117, 16, v117
    v_mul_f32 v117, 0.15915494, v117
    v_mul_f32 v118, 0.15915494, v118
    v_fract_f32 v117, v117
    v_fract_f32 v118, v118
    v_cos_f32 v117, v117
    v_cos_f32 v118, v118
    v_mul_hi_u32_u24 v122, s38, v62
    v_mul_hi_u32_u24 v121, s37, v26
    v_mul_hi_u32_u24 v120, s36, v26
    v_mad_i32_i24 v110, v122, s44, v62
    v_mad_u32_u24 v62, v122, 40, v121
    v_mad_i32_i24 v26, v120, s39, v26
    v_lshlrev_b16 v62, 2, v62
    v_mad_i32_i24 v120, v121, -3, v120
    ds_add_u32 v62, v3 offset:0
    v_lshl_or_b32 v26, v110, 16, v26
    v_lshl_or_b32 v26, v120, 30, v26
    v_mul_f32 v117, 0x03800000, v117
    v_mul_f32 v118, 0x03800000, v118
    v_cvt_pk_bf16_f32 v117, v117, v118
    v_mul_hi_u32_u24 v122, s38, v63
    v_mul_hi_u32_u24 v121, s37, v27
    v_mul_hi_u32_u24 v120, s36, v27
    v_mad_i32_i24 v110, v122, s44, v63
    v_mad_u32_u24 v63, v122, 40, v121
    v_mad_i32_i24 v27, v120, s39, v27
    v_lshlrev_b16 v63, 2, v63
    v_mad_i32_i24 v120, v121, -3, v120
    ds_add_u32 v63, v3 offset:0
    v_lshl_or_b32 v27, v110, 16, v27
    v_lshl_or_b32 v27, v120, 30, v27
    v_lshrrev_b32 v118, 3, v117
    v_lshrrev_b32 v119, 8, v117
    v_lshlrev_b16 v117, 13, v117
    v_bitop3_b32 v119, v118, v119, v124 bitop3:0x1b
    v_bitop3_b32 v26, v117, v125, v26 bitop3:0xae
    v_lshl_or_b32 v62, v119, 16, v62
    v_bitop3_b32 v27, v118, v125, v27 bitop3:0xae
    v_bitop3_b32 v63, v119, v126, v63 bitop3:0xea
p1_k10:
    s_cmp_ge_u32 s29, 1315
    s_cbranch_scc1 p1_k12
    s_waitcnt vmcnt(4)
    v_lshlrev_b32 v117, 16, v88
    v_and_b32 v118, v126, v88
    v_mul_f32 v117, v123, v117
    v_mul_f32 v118, v123, v118
    v_cvt_pk_bf16_f32 v117, v117, v118
    v_and_b32 v118, v126, v117
    v_lshlrev_b32 v117, 16, v117
    v_mul_f32 v117, 0.15915494, v117
    v_mul_f32 v118, 0.15915494, v118
    v_fract_f32 v117, v117
    v_fract_f32 v118, v118
    v_cos_f32 v117, v117
    v_cos_f32 v118, v118
    v_mul_hi_u32_u24 v122, s38, v64
    v_mul_hi_u32_u24 v121, s37, v28
    v_mul_hi_u32_u24 v120, s36, v28
    v_mad_i32_i24 v110, v122, s44, v64
    v_mad_u32_u24 v64, v122, 40, v121
    v_mad_i32_i24 v28, v120, s39, v28
    v_lshlrev_b16 v64, 2, v64
    v_mad_i32_i24 v120, v121, -3, v120
    ds_add_u32 v64, v3 offset:0
    v_lshl_or_b32 v28, v110, 16, v28
    v_lshl_or_b32 v28, v120, 30, v28
    v_mul_f32 v117, 0x03800000, v117
    v_mul_f32 v118, 0x03800000, v118
    v_cvt_pk_bf16_f32 v117, v117, v118
    v_mul_hi_u32_u24 v122, s38, v65
    v_mul_hi_u32_u24 v121, s37, v29
    v_mul_hi_u32_u24 v120, s36, v29
    v_mad_i32_i24 v110, v122, s44, v65
    v_mad_u32_u24 v65, v122, 40, v121
    v_mad_i32_i24 v29, v120, s39, v29
    v_lshlrev_b16 v65, 2, v65
    v_mad_i32_i24 v120, v121, -3, v120
    ds_add_u32 v65, v3 offset:0
    v_lshl_or_b32 v29, v110, 16, v29
    v_lshl_or_b32 v29, v120, 30, v29
    v_lshrrev_b32 v118, 3, v117
    v_lshrrev_b32 v119, 8, v117
    v_lshlrev_b16 v117, 13, v117
    v_bitop3_b32 v119, v118, v119, v124 bitop3:0x1b
    v_bitop3_b32 v28, v117, v125, v28 bitop3:0xae
    v_lshl_or_b32 v64, v119, 16, v64
    v_bitop3_b32 v29, v118, v125, v29 bitop3:0xae
    v_bitop3_b32 v65, v119, v126, v65 bitop3:0xea
    v_lshlrev_b32 v117, 16, v89
    v_and_b32 v118, v126, v89
    v_mul_f32 v117, v123, v117
    v_mul_f32 v118, v123, v118
    v_cvt_pk_bf16_f32 v117, v117, v118
    v_and_b32 v118, v126, v117
    v_lshlrev_b32 v117, 16, v117
    v_mul_f32 v117, 0.15915494, v117
    v_mul_f32 v118, 0.15915494, v118
    v_fract_f32 v117, v117
    v_fract_f32 v118, v118
    v_cos_f32 v117, v117
    v_cos_f32 v118, v118
    v_mul_hi_u32_u24 v122, s38, v66
    v_mul_hi_u32_u24 v121, s37, v30
    v_mul_hi_u32_u24 v120, s36, v30
    v_mad_i32_i24 v110, v122, s44, v66
    v_mad_u32_u24 v66, v122, 40, v121
    v_mad_i32_i24 v30, v120, s39, v30
    v_lshlrev_b16 v66, 2, v66
    v_mad_i32_i24 v120, v121, -3, v120
    ds_add_u32 v66, v3 offset:0
    v_lshl_or_b32 v30, v110, 16, v30
    v_lshl_or_b32 v30, v120, 30, v30
    v_mul_f32 v117, 0x03800000, v117
    v_mul_f32 v118, 0x03800000, v118
    v_cvt_pk_bf16_f32 v117, v117, v118
    v_mul_hi_u32_u24 v122, s38, v67
    v_mul_hi_u32_u24 v121, s37, v31
    v_mul_hi_u32_u24 v120, s36, v31
    v_mad_i32_i24 v110, v122, s44, v67
    v_mad_u32_u24 v67, v122, 40, v121
    v_mad_i32_i24 v31, v120, s39, v31
    v_lshlrev_b16 v67, 2, v67
    v_mad_i32_i24 v120, v121, -3, v120
    ds_add_u32 v67, v3 offset:0
    v_lshl_or_b32 v31, v110, 16, v31
    v_lshl_or_b32 v31, v120, 30, v31
    v_lshrrev_b32 v118, 3, v117
    v_lshrrev_b32 v119, 8, v117
    v_lshlrev_b16 v117, 13, v117
    v_bitop3_b32 v119, v118, v119, v124 bitop3:0x1b
    v_bitop3_b32 v30, v117, v125, v30 bitop3:0xae
    v_lshl_or_b32 v66, v119, 16, v66
    v_bitop3_b32 v31, v118, v125, v31 bitop3:0xae
    v_bitop3_b32 v67, v119, v126, v67 bitop3:0xea
p1_k12:
    s_cmp_ge_u32 s29, 1279
    s_cbranch_scc1 p1_k14
    s_waitcnt vmcnt(2)
    v_lshlrev_b32 v117, 16, v90
    v_and_b32 v118, v126, v90
    v_mul_f32 v117, v123, v117
    v_mul_f32 v118, v123, v118
    v_cvt_pk_bf16_f32 v117, v117, v118
    v_and_b32 v118, v126, v117
    v_lshlrev_b32 v117, 16, v117
    v_mul_f32 v117, 0.15915494, v117
    v_mul_f32 v118, 0.15915494, v118
    v_fract_f32 v117, v117
    v_fract_f32 v118, v118
    v_cos_f32 v117, v117
    v_cos_f32 v118, v118
    v_mul_hi_u32_u24 v122, s38, v68
    v_mul_hi_u32_u24 v121, s37, v32
    v_mul_hi_u32_u24 v120, s36, v32
    v_mad_i32_i24 v110, v122, s44, v68
    v_mad_u32_u24 v68, v122, 40, v121
    v_mad_i32_i24 v32, v120, s39, v32
    v_lshlrev_b16 v68, 2, v68
    v_mad_i32_i24 v120, v121, -3, v120
    ds_add_u32 v68, v3 offset:0
    v_lshl_or_b32 v32, v110, 16, v32
    v_lshl_or_b32 v32, v120, 30, v32
    v_mul_f32 v117, 0x03800000, v117
    v_mul_f32 v118, 0x03800000, v118
    v_cvt_pk_bf16_f32 v117, v117, v118
    v_mul_hi_u32_u24 v122, s38, v69
    v_mul_hi_u32_u24 v121, s37, v33
    v_mul_hi_u32_u24 v120, s36, v33
    v_mad_i32_i24 v110, v122, s44, v69
    v_mad_u32_u24 v69, v122, 40, v121
    v_mad_i32_i24 v33, v120, s39, v33
    v_lshlrev_b16 v69, 2, v69
    v_mad_i32_i24 v120, v121, -3, v120
    ds_add_u32 v69, v3 offset:0
    v_lshl_or_b32 v33, v110, 16, v33
    v_lshl_or_b32 v33, v120, 30, v33
    v_lshrrev_b32 v118, 3, v117
    v_lshrrev_b32 v119, 8, v117
    v_lshlrev_b16 v117, 13, v117
    v_bitop3_b32 v119, v118, v119, v124 bitop3:0x1b
    v_bitop3_b32 v32, v117, v125, v32 bitop3:0xae
    v_lshl_or_b32 v68, v119, 16, v68
    v_bitop3_b32 v33, v118, v125, v33 bitop3:0xae
    v_bitop3_b32 v69, v119, v126, v69 bitop3:0xea
    v_lshlrev_b32 v117, 16, v91
    v_and_b32 v118, v126, v91
    v_mul_f32 v117, v123, v117
    v_mul_f32 v118, v123, v118
    v_cvt_pk_bf16_f32 v117, v117, v118
    v_and_b32 v118, v126, v117
    v_lshlrev_b32 v117, 16, v117
    v_mul_f32 v117, 0.15915494, v117
    v_mul_f32 v118, 0.15915494, v118
    v_fract_f32 v117, v117
    v_fract_f32 v118, v118
    v_cos_f32 v117, v117
    v_cos_f32 v118, v118
    v_mul_hi_u32_u24 v122, s38, v70
    v_mul_hi_u32_u24 v121, s37, v34
    v_mul_hi_u32_u24 v120, s36, v34
    v_mad_i32_i24 v110, v122, s44, v70
    v_mad_u32_u24 v70, v122, 40, v121
    v_mad_i32_i24 v34, v120, s39, v34
    v_lshlrev_b16 v70, 2, v70
    v_mad_i32_i24 v120, v121, -3, v120
    ds_add_u32 v70, v3 offset:0
    v_lshl_or_b32 v34, v110, 16, v34
    v_lshl_or_b32 v34, v120, 30, v34
    v_mul_f32 v117, 0x03800000, v117
    v_mul_f32 v118, 0x03800000, v118
    v_cvt_pk_bf16_f32 v117, v117, v118
    v_mul_hi_u32_u24 v122, s38, v71
    v_mul_hi_u32_u24 v121, s37, v35
    v_mul_hi_u32_u24 v120, s36, v35
    v_mad_i32_i24 v110, v122, s44, v71
    v_mad_u32_u24 v71, v122, 40, v121
    v_mad_i32_i24 v35, v120, s39, v35
    v_lshlrev_b16 v71, 2, v71
    v_mad_i32_i24 v120, v121, -3, v120
    ds_add_u32 v71, v3 offset:0
    v_lshl_or_b32 v35, v110, 16, v35
    v_lshl_or_b32 v35, v120, 30, v35
    v_lshrrev_b32 v118, 3, v117
    v_lshrrev_b32 v119, 8, v117
    v_lshlrev_b16 v117, 13, v117
    v_bitop3_b32 v119, v118, v119, v124 bitop3:0x1b
    v_bitop3_b32 v34, v117, v125, v34 bitop3:0xae
    v_lshl_or_b32 v70, v119, 16, v70
    v_bitop3_b32 v35, v118, v125, v35 bitop3:0xae
    v_bitop3_b32 v71, v119, v126, v71 bitop3:0xea
p1_k14:
    s_cmp_ge_u32 s29, 1242
    s_cbranch_scc1 p1_k16
    s_waitcnt vmcnt(0)
    v_lshlrev_b32 v117, 16, v92
    v_and_b32 v118, v126, v92
    v_mul_f32 v117, v123, v117
    v_mul_f32 v118, v123, v118
    v_cvt_pk_bf16_f32 v117, v117, v118
    v_and_b32 v118, v126, v117
    v_lshlrev_b32 v117, 16, v117
    v_mul_f32 v117, 0.15915494, v117
    v_mul_f32 v118, 0.15915494, v118
    v_fract_f32 v117, v117
    v_fract_f32 v118, v118
    v_cos_f32 v117, v117
    v_cos_f32 v118, v118
    v_mul_hi_u32_u24 v122, s38, v72
    v_mul_hi_u32_u24 v121, s37, v36
    v_mul_hi_u32_u24 v120, s36, v36
    v_mad_i32_i24 v110, v122, s44, v72
    v_mad_u32_u24 v72, v122, 40, v121
    v_mad_i32_i24 v36, v120, s39, v36
    v_lshlrev_b16 v72, 2, v72
    v_mad_i32_i24 v120, v121, -3, v120
    ds_add_u32 v72, v3 offset:0
    v_lshl_or_b32 v36, v110, 16, v36
    v_lshl_or_b32 v36, v120, 30, v36
    v_mul_f32 v117, 0x03800000, v117
    v_mul_f32 v118, 0x03800000, v118
    v_cvt_pk_bf16_f32 v117, v117, v118
    v_mul_hi_u32_u24 v122, s38, v73
    v_mul_hi_u32_u24 v121, s37, v37
    v_mul_hi_u32_u24 v120, s36, v37
    v_mad_i32_i24 v110, v122, s44, v73
    v_mad_u32_u24 v73, v122, 40, v121
    v_mad_i32_i24 v37, v120, s39, v37
    v_lshlrev_b16 v73, 2, v73
    v_mad_i32_i24 v120, v121, -3, v120
    ds_add_u32 v73, v3 offset:0
    v_lshl_or_b32 v37, v110, 16, v37
    v_lshl_or_b32 v37, v120, 30, v37
    v_lshrrev_b32 v118, 3, v117
    v_lshrrev_b32 v119, 8, v117
    v_lshlrev_b16 v117, 13, v117
    v_bitop3_b32 v119, v118, v119, v124 bitop3:0x1b
    v_bitop3_b32 v36, v117, v125, v36 bitop3:0xae
    v_lshl_or_b32 v72, v119, 16, v72
    v_bitop3_b32 v37, v118, v125, v37 bitop3:0xae
    v_bitop3_b32 v73, v119, v126, v73 bitop3:0xea
    v_lshlrev_b32 v117, 16, v93
    v_and_b32 v118, v126, v93
    v_mul_f32 v117, v123, v117
    v_mul_f32 v118, v123, v118
    v_cvt_pk_bf16_f32 v117, v117, v118
    v_and_b32 v118, v126, v117
    v_lshlrev_b32 v117, 16, v117
    v_mul_f32 v117, 0.15915494, v117
    v_mul_f32 v118, 0.15915494, v118
    v_fract_f32 v117, v117
    v_fract_f32 v118, v118
    v_cos_f32 v117, v117
    v_cos_f32 v118, v118
    v_mul_hi_u32_u24 v122, s38, v74
    v_mul_hi_u32_u24 v121, s37, v38
    v_mul_hi_u32_u24 v120, s36, v38
    v_mad_i32_i24 v110, v122, s44, v74
    v_mad_u32_u24 v74, v122, 40, v121
    v_mad_i32_i24 v38, v120, s39, v38
    v_lshlrev_b16 v74, 2, v74
    v_mad_i32_i24 v120, v121, -3, v120
    ds_add_u32 v74, v3 offset:0
    v_lshl_or_b32 v38, v110, 16, v38
    v_lshl_or_b32 v38, v120, 30, v38
    v_mul_f32 v117, 0x03800000, v117
    v_mul_f32 v118, 0x03800000, v118
    v_cvt_pk_bf16_f32 v117, v117, v118
    v_mul_hi_u32_u24 v122, s38, v75
    v_mul_hi_u32_u24 v121, s37, v39
    v_mul_hi_u32_u24 v120, s36, v39
    v_mad_i32_i24 v110, v122, s44, v75
    v_mad_u32_u24 v75, v122, 40, v121
    v_mad_i32_i24 v39, v120, s39, v39
    v_lshlrev_b16 v75, 2, v75
    v_mad_i32_i24 v120, v121, -3, v120
    ds_add_u32 v75, v3 offset:0
    v_lshl_or_b32 v39, v110, 16, v39
    v_lshl_or_b32 v39, v120, 30, v39
    v_lshrrev_b32 v118, 3, v117
    v_lshrrev_b32 v119, 8, v117
    v_lshlrev_b16 v117, 13, v117
    v_bitop3_b32 v119, v118, v119, v124 bitop3:0x1b
    v_bitop3_b32 v38, v117, v125, v38 bitop3:0xae
    v_lshl_or_b32 v74, v119, 16, v74
    v_bitop3_b32 v39, v118, v125, v39 bitop3:0xae
    v_bitop3_b32 v75, v119, v126, v75 bitop3:0xea
p1_k16:
    s_waitcnt vmcnt(0)
    s_cmp_lg_u32 s28, 15
    s_cbranch_scc1 p1_tk1
    v_mov_b32 v126, 0
    s_mov_b64 exec, 1
    ds_write_b32 v126, v127 offset:10456
    s_mov_b64 exec, -1
p1_tk1:
    s_waitcnt lgkmcnt(0)
    s_barrier
    s_cmp_ge_u32 s28, 10
    s_cbranch_scc1 p1_s1_skip
    v_and_b32 v126, 63, v0
    s_lshl_b32 s54, s28, 4
    v_mul_u32_u24 v117, 160, v126
    v_add_u32 v117, s54, v117
    ds_read_b128 v[118:121], v117 offset:0
    s_waitcnt lgkmcnt(0)
    v_add_u32 v118, 2, v118
    v_add_u32 v119, 2, v119
    v_add_u32 v120, 2, v120
    v_add_u32 v121, 2, v121
    v_mul_u32_u24 v118, 43691, v118
    v_mul_u32_u24 v119, 43691, v119
    v_mul_u32_u24 v120, 43691, v120
    v_mul_u32_u24 v121, 43691, v121
    v_lshrrev_b32 v118, 17, v118
    v_lshrrev_b32 v119, 17, v119
    v_lshrrev_b32 v120, 17, v120
    v_lshrrev_b32 v121, 17, v121
    v_lshl_or_b32 v122, v119, 16, v118
    v_lshl_or_b32 v123, v121, 16, v120
    v_mov_b32 v124, v122
    v_mov_b32 v125, v123
    s_nop 1
    v_add_u32_dpp v124, v124, v124 row_shr:1 row_mask:0xf bank_mask:0xf bound_ctrl:0
    v_add_u32_dpp v125, v125, v125 row_shr:1 row_mask:0xf bank_mask:0xf bound_ctrl:0
    s_nop 0
    v_add_u32_dpp v124, v124, v124 row_shr:2 row_mask:0xf bank_mask:0xf bound_ctrl:0
    v_add_u32_dpp v125, v125, v125 row_shr:2 row_mask:0xf bank_mask:0xf bound_ctrl:0
    s_nop 0
    v_add_u32_dpp v124, v124, v124 row_shr:4 row_mask:0xf bank_mask:0xf bound_ctrl:0
    v_add_u32_dpp v125, v125, v125 row_shr:4 row_mask:0xf bank_mask:0xf bound_ctrl:0
    s_nop 0
    v_add_u32_dpp v124, v124, v124 row_shr:8 row_mask:0xf bank_mask:0xf bound_ctrl:0
    v_add_u32_dpp v125, v125, v125 row_shr:8 row_mask:0xf bank_mask:0xf bound_ctrl:0
    s_nop 0
    v_add_u32_dpp v124, v124, v124 row_bcast:15 row_mask:0xa bank_mask:0xf
    v_add_u32_dpp v125, v125, v125 row_bcast:15 row_mask:0xa bank_mask:0xf
    s_nop 0
    v_add_u32_dpp v124, v124, v124 row_bcast:31 row_mask:0xc bank_mask:0xf
    v_add_u32_dpp v125, v125, v125 row_bcast:31 row_mask:0xc bank_mask:0xf
    s_nop 0
    s_nop 0
    v_mov_b32 v127, s54
    v_and_b32 v118, 0xffff, v124
    v_lshrrev_b32 v119, 16, v124
    v_and_b32 v120, 0xffff, v125
    v_lshrrev_b32 v121, 16, v125
    s_mov_b64 exec, 1
    s_lshl_b64 exec, exec, 63
    ds_write_b128 v127, v[118:121] offset:10240
    s_mov_b64 exec, -1
p1_s1_skip:
    s_waitcnt lgkmcnt(0)
    s_barrier
    v_and_b32 v127, 63, v0
    v_lshlrev_b32 v118, 2, v127
    v_cmp_gt_u32 vcc, 40, v127
    ds_read_b32 v119, v118 offset:10240
    s_waitcnt lgkmcnt(0)
    v_readlane_b32 s33, v119, 54
    v_cndmask_b32 v119, 0, v119, vcc
    v_mov_b32 v120, v119
    s_nop 1
    v_add_u32_dpp v120, v120, v120 row_shr:1 row_mask:0xf bank_mask:0xf bound_ctrl:0
    s_nop 1
    v_add_u32_dpp v120, v120, v120 row_shr:2 row_mask:0xf bank_mask:0xf bound_ctrl:0
    s_nop 1
    v_add_u32_dpp v120, v120, v120 row_shr:4 row_mask:0xf bank_mask:0xf bound_ctrl:0
    s_nop 1
    v_add_u32_dpp v120, v120, v120 row_shr:8 row_mask:0xf bank_mask:0xf bound_ctrl:0
    s_nop 1
    v_add_u32_dpp v120, v120, v120 row_bcast:15 row_mask:0xa bank_mask:0xf
    s_nop 1
    v_add_u32_dpp v120, v120, v120 row_bcast:31 row_mask:0xc bank_mask:0xf
    s_nop 1
    s_nop 0
    v_sub_u32 v119, v120, v119
    v_readlane_b32 s35, v120, 63
    s_add_u32 s33, s33, 256
    s_mul_i32 s46, s33, 1
    s_min_u32 s47, s33, 1499
    s_add_u32 s46, s46, s47
    s_min_u32 s47, s33, 1462
    s_add_u32 s46, s46, s47
    s_min_u32 s47, s33, 1426
    s_add_u32 s46, s46, s47
    s_min_u32 s47, s33, 1389
    s_add_u32 s46, s46, s47
    s_min_u32 s47, s33, 1352
    s_add_u32 s46, s46, s47
    s_min_u32 s47, s33, 1315
    s_add_u32 s46, s46, s47
    s_min_u32 s47, s33, 1279
    s_add_u32 s46, s46, s47
    s_min_u32 s47, s33, 1242
    s_add_u32 s46, s46, s47
    s_lshl_b32 s30, s46, 14
    s_lshl_b32 s31, s46, 13
    s_cmp_ge_u32 s28, 10
    s_cbranch_scc1 p1_s2_skip
    s_lshl_b32 s54, s28, 2
    s_add_u32 s55, s54, 0
    v_readlane_b32 s56, v119, s55
    s_add_u32 s55, s54, 1
    v_readlane_b32 s57, v119, s55
    s_add_u32 s55, s54, 2
    v_readlane_b32 s58, v119, s55
    s_add_u32 s55, s54, 3
    v_readlane_b32 s59, v119, s55
    s_nop 0
    s_lshl_b32 s57, s57, 16
    s_or_b32 s56, s56, s57
    s_lshl_b32 s59, s59, 16
    s_or_b32 s58, s58, s59
    v_add_u32 v124, s56, v124
    v_add_u32 v125, s58, v125
    v_sub_u32 v122, v124, v122
    v_sub_u32 v123, v125, v123
    v_and_b32 v118, 0xffff, v122
    v_lshrrev_b32 v119, 16, v122
    v_and_b32 v120, 0xffff, v123
    v_lshrrev_b32 v121, 16, v123
    v_mul_u32_u24 v118, 3, v118
    v_mul_u32_u24 v119, 3, v119
    v_mul_u32_u24 v120, 3, v120
    v_mul_u32_u24 v121, 3, v121
    ds_write_b128 v117, v[118:121] offset:0
    s_mul_i32 s55, s29, 5248
    s_mul_i32 s56, s28, 520
    s_add_u32 s55, s55, s56
    s_add_u32 s55, s55, 469762048
    v_lshlrev_b32 v127, 3, v126
    buffer_store_dwordx2 v[122:123], v127, s[16:19], s55 offen sc1
    s_mov_b64 exec, 1
    s_lshl_b64 exec, exec, 63
    buffer_store_dwordx2 v[124:125], v127, s[16:19], s55 offen offset:8 sc1
    s_mov_b64 exec, -1
p1_s2_skip:
    s_mul_i32 s50, s29, 16384
    s_lshr_b32 s52, s35, 10
    s_mul_i32 s52, s52, 33554432
    s_and_b32 s53, s35, 1023
    s_lshl_b32 s53, s53, 4
    s_add_u32 s52, s52, s53
    s_add_u32 s52, s52, s50
    s_min_u32 s22, s52, 469762048
    s_mov_b32 s68, 0
    s_cmp_lt_u32 s29, 1242
    s_cselect_b32 s35, 13994, s35
    s_waitcnt lgkmcnt(0)
    s_barrier
    s_cmp_lt_u32 s33, 1536
    s_cbranch_scc1 p1_f0
    s_cmp_lg_u32 s28, 15
    s_cbranch_scc1 p1_hv0
    s_sub_u32 s52, s33, 1536
    s_and_b32 s52, s52, 255
    s_lshl_b32 s58, s52, 2
    s_and_b32 s58, s58, 28
    s_lshl_b32 s53, 1, s58
    v_mov_b32 v127, s53
    s_lshr_b32 s52, s52, 3
    s_lshl_b32 s52, s52, 2
    s_mov_b64 exec, 1
    buffer_atomic_add v127, off, s[40:43], s52 sc0 sc1
    s_mov_b64 exec, -1
p1_hv0:
    s_cmp_ge_u32 s33, 1656
    s_cbranch_scc1 p1_f0
    s_sub_u32 s52, s33, 1536
    s_mul_i32 s52, s52, 53368
    s_mul_i32 s53, s28, 3072
    s_add_u32 s53, s53, s52
    v_and_b32 v92, 63, v0
    v_lshl_add_u32 v93, v92, 2, s53
    s_lshl_b32 s53, s28, 9
    s_add_u32 s53, s53, s52
    s_add_u32 s53, s53, 49152
    s_cmp_lt_u32 s28, 9
    s_cselect_b32 s53, s53, 0x40000000
    v_lshl_add_u32 v94, v92, 2, s53
    buffer_load_dword v76, v93, s[24:27], 0 offen offset:0
    buffer_load_dword v77, v93, s[24:27], 0 offen offset:256
    buffer_load_dword v78, v93, s[24:27], 0 offen offset:512
    buffer_load_dword v79, v93, s[24:27], 0 offen offset:768
    buffer_load_dword v80, v93, s[24:27], 0 offen offset:1024
    buffer_load_dword v81, v93, s[24:27], 0 offen offset:1280
    buffer_load_dword v82, v93, s[24:27], 0 offen offset:1536
    buffer_load_dword v83, v93, s[24:27], 0 offen offset:1792
    buffer_load_dword v84, v93, s[24:27], 0 offen offset:2048
    buffer_load_dword v85, v93, s[24:27], 0 offen offset:2304
    buffer_load_dword v86, v93, s[24:27], 0 offen offset:2560
    buffer_load_dword v87, v93, s[24:27], 0 offen offset:2816
    buffer_load_dword v88, v94, s[24:27], 0 offen offset:0
    buffer_load_dword v89, v94, s[24:27], 0 offen offset:256
p1_f0:
    v_and_b32 v117, 0xffff, v40
    ds_add_rtn_u32 v117, v117, v3 offset:0
    v_and_b32 v118, 0xffff, v41
    ds_add_rtn_u32 v118, v118, v3 offset:0
    v_and_b32 v119, 0xffff, v42
    ds_add_rtn_u32 v119, v119, v3 offset:0
    v_and_b32 v120, 0xffff, v43
    ds_add_rtn_u32 v120, v120, v3 offset:0
    s_cmp_ge_u32 s33, 1536
    s_cbranch_scc1 p1_k18
    s_cmp_lt_u32 s33, 1536
    s_cselect_b32 s14, 102400000, 0
    s_add_u32 s32, s31, 0
    buffer_load_dwordx2 v[76:77], v2, s[12:15], s32 offen nt
p1_k18:
    s_cmp_ge_u32 s33, 1536
    s_cbranch_scc1 p1_k19
    s_cmp_lt_u32 s33, 1536
    s_cselect_b32 s6, 204800000, 0
    s_cselect_b32 s10, 204800000, 0
    s_add_u32 s32, s30, 0
    buffer_load_dwordx4 v[94:97], v1, s[4:7], s32 offen nt
    buffer_load_dwordx4 v[102:105], v1, s[8:11], s32 offen nt
p1_k19:
    s_cmp_lt_u32 s29, 1499
    s_cbranch_scc1 p1_pa0
    s_waitcnt lgkmcnt(0)
    s_branch p1_pb0
p1_pa0:
    v_and_b32 v121, 0xffff, v44
    ds_add_rtn_u32 v121, v121, v3 offset:0
    v_and_b32 v122, 0xffff, v45
    ds_add_rtn_u32 v122, v122, v3 offset:0
    v_and_b32 v123, 0xffff, v46
    ds_add_rtn_u32 v123, v123, v3 offset:0
    v_and_b32 v124, 0xffff, v47
    ds_add_rtn_u32 v124, v124, v3 offset:0
    s_waitcnt lgkmcnt(4)
p1_pb0:
    ds_write_b8_d16_hi v117, v40 offset:10496
    v_lshlrev_b32 v40, 2, v117
    ds_write_b32 v40, v4 offset:52480
    ds_write_b8_d16_hi v118, v41 offset:10496
    v_lshlrev_b32 v41, 2, v118
    ds_write_b32 v41, v5 offset:52480
    ds_write_b8_d16_hi v119, v42 offset:10496
    v_lshlrev_b32 v42, 2, v119
    ds_write_b32 v42, v6 offset:52480
    ds_write_b8_d16_hi v120, v43 offset:10496
    v_lshlrev_b32 v43, 2, v120
    ds_write_b32 v43, v7 offset:52480
    s_cmp_ge_u32 s33, 1536
    s_cbranch_scc1 p1_k20
    s_cmp_lt_u32 s33, 1499
    s_cselect_b32 s14, 102400000, 0
    s_add_u32 s32, s31, 8192
    buffer_load_dwordx2 v[78:79], v2, s[12:15], s32 offen nt
p1_k20:
    s_cmp_lt_u32 s29, 1462
    s_cbranch_scc1 p1_pa1
    s_waitcnt lgkmcnt(0)
    s_branch p1_pb1
p1_pa1:
    v_and_b32 v117, 0xffff, v48
    ds_add_rtn_u32 v117, v117, v3 offset:0
    v_and_b32 v118, 0xffff, v49
    ds_add_rtn_u32 v118, v118, v3 offset:0
    v_and_b32 v119, 0xffff, v50
    ds_add_rtn_u32 v119, v119, v3 offset:0
    v_and_b32 v120, 0xffff, v51
    ds_add_rtn_u32 v120, v120, v3 offset:0
    s_waitcnt lgkmcnt(4)
p1_pb1:
    s_cmp_ge_u32 s29, 1499
    s_cbranch_scc1 p1_k21
    ds_write_b8_d16_hi v121, v44 offset:10496
    v_lshlrev_b32 v44, 2, v121
    ds_write_b32 v44, v8 offset:52480
    ds_write_b8_d16_hi v122, v45 offset:10496
    v_lshlrev_b32 v45, 2, v122
    ds_write_b32 v45, v9 offset:52480
    ds_write_b8_d16_hi v123, v46 offset:10496
    v_lshlrev_b32 v46, 2, v123
    ds_write_b32 v46, v10 offset:52480
    ds_write_b8_d16_hi v124, v47 offset:10496
    v_lshlrev_b32 v47, 2, v124
    ds_write_b32 v47, v11 offset:52480
p1_k21:
    s_cmp_ge_u32 s33, 1536
    s_cbranch_scc1 p1_k22
    s_cmp_lt_u32 s33, 1462
    s_cselect_b32 s14, 102400000, 0
    s_add_u32 s32, s31, 16384
    buffer_load_dwordx2 v[80:81], v2, s[12:15], s32 offen nt
p1_k22:
    s_cmp_lt_u32 s29, 1426
    s_cbranch_scc1 p1_pa2
    s_waitcnt lgkmcnt(0)
    s_branch p1_pb2
p1_pa2:
    v_and_b32 v121, 0xffff, v52
    ds_add_rtn_u32 v121, v121, v3 offset:0
    v_and_b32 v122, 0xffff, v53
    ds_add_rtn_u32 v122, v122, v3 offset:0
    v_and_b32 v123, 0xffff, v54
    ds_add_rtn_u32 v123, v123, v3 offset:0
    v_and_b32 v124, 0xffff, v55
    ds_add_rtn_u32 v124, v124, v3 offset:0
    s_waitcnt lgkmcnt(4)
p1_pb2:
    s_cmp_ge_u32 s29, 1462
    s_cbranch_scc1 p1_k23
    ds_write_b8_d16_hi v117, v48 offset:10496
    v_lshlrev_b32 v48, 2, v117
    ds_write_b32 v48, v12 offset:52480
    ds_write_b8_d16_hi v118, v49 offset:10496
    v_lshlrev_b32 v49, 2, v118
    ds_write_b32 v49, v13 offset:52480
    ds_write_b8_d16_hi v119, v50 offset:10496
    v_lshlrev_b32 v50, 2, v119
    ds_write_b32 v50, v14 offset:52480
    ds_write_b8_d16_hi v120, v51 offset:10496
    v_lshlrev_b32 v51, 2, v120
    ds_write_b32 v51, v15 offset:52480
p1_k23:
    s_cmp_ge_u32 s28, 10
    s_cbranch_scc1 p1_jn
    s_waitcnt vmcnt(0)
    v_mov_b32 v125, 0
    s_mov_b64 exec, 1
    ds_add_rtn_u32 v125, v125, v3 offset:10432
    s_waitcnt lgkmcnt(0)
    v_readfirstlane_b32 s52, v125
    s_lshr_b32 s53, s29, 1
    s_and_b32 s53, s53, 28
    s_cmp_lg_u32 s52, 9
    s_cbranch_scc1 p1_jn1
    s_lshl_b32 s54, 1, s53
    v_mov_b32 v127, s54
    s_lshr_b32 s54, s29, 6
    s_lshl_b32 s54, s54, 2
    s_mov_b32 s68, 1
    buffer_atomic_add v127, off, s[40:43], s54 sc0 sc1
p1_jn1:
    s_mov_b64 exec, -1
p1_jn:
    s_cmp_ge_u32 s33, 1536
    s_cbranch_scc1 p1_k24
    s_cmp_lt_u32 s33, 1426
    s_cselect_b32 s14, 102400000, 0
    s_add_u32 s32, s31, 24576
    buffer_load_dwordx2 v[82:83], v2, s[12:15], s32 offen nt
p1_k24:
    s_cmp_lt_u32 s29, 1389
    s_cbranch_scc1 p1_pa3
    s_waitcnt lgkmcnt(0)
    s_branch p1_pb3
p1_pa3:
    v_and_b32 v117, 0xffff, v56
    ds_add_rtn_u32 v117, v117, v3 offset:0
    v_and_b32 v118, 0xffff, v57
    ds_add_rtn_u32 v118, v118, v3 offset:0
    v_and_b32 v119, 0xffff, v58
    ds_add_rtn_u32 v119, v119, v3 offset:0
    v_and_b32 v120, 0xffff, v59
    ds_add_rtn_u32 v120, v120, v3 offset:0
    s_waitcnt lgkmcnt(4)
p1_pb3:
    s_cmp_ge_u32 s29, 1426
    s_cbranch_scc1 p1_k25
    ds_write_b8_d16_hi v121, v52 offset:10496
    v_lshlrev_b32 v52, 2, v121
    ds_write_b32 v52, v16 offset:52480
    ds_write_b8_d16_hi v122, v53 offset:10496
    v_lshlrev_b32 v53, 2, v122
    ds_write_b32 v53, v17 offset:52480
    ds_write_b8_d16_hi v123, v54 offset:10496
    v_lshlrev_b32 v54, 2, v123
    ds_write_b32 v54, v18 offset:52480
    ds_write_b8_d16_hi v124, v55 offset:10496
    v_lshlrev_b32 v55, 2, v124
    ds_write_b32 v55, v19 offset:52480
p1_k25:
    s_cmp_ge_u32 s33, 1536
    s_cbranch_scc1 p1_k26
    s_cmp_lt_u32 s33, 1389
    s_cselect_b32 s14, 102400000, 0
    s_add_u32 s32, s31, 32768
    buffer_load_dwordx2 v[84:85], v2, s[12:15], s32 offen nt
p1_k26:
    s_cmp_ge_u32 s33, 1536
    s_cbranch_scc1 p1_k27
    s_cmp_lt_u32 s33, 1499
    s_cselect_b32 s6, 204800000, 0
    s_cselect_b32 s10, 204800000, 0
    s_add_u32 s32, s30, 16384
    buffer_load_dwordx4 v[98:101], v1, s[4:7], s32 offen nt
    buffer_load_dwordx4 v[106:109], v1, s[8:11], s32 offen nt
p1_k27:
    s_cmp_lt_u32 s29, 1352
    s_cbranch_scc1 p1_pa4
    s_waitcnt lgkmcnt(0)
    s_branch p1_pb4
p1_pa4:
    v_and_b32 v121, 0xffff, v60
    ds_add_rtn_u32 v121, v121, v3 offset:0
    v_and_b32 v122, 0xffff, v61
    ds_add_rtn_u32 v122, v122, v3 offset:0
    v_and_b32 v123, 0xffff, v62
    ds_add_rtn_u32 v123, v123, v3 offset:0
    v_and_b32 v124, 0xffff, v63
    ds_add_rtn_u32 v124, v124, v3 offset:0
    s_waitcnt lgkmcnt(4)
p1_pb4:
    s_cmp_ge_u32 s29, 1389
    s_cbranch_scc1 p1_k28
    ds_write_b8_d16_hi v117, v56 offset:10496
    v_lshlrev_b32 v56, 2, v117
    ds_write_b32 v56, v20 offset:52480
    ds_write_b8_d16_hi v118, v57 offset:10496
    v_lshlrev_b32 v57, 2, v118
    ds_write_b32 v57, v21 offset:52480
    ds_write_b8_d16_hi v119, v58 offset:10496
    v_lshlrev_b32 v58, 2, v119
    ds_write_b32 v58, v22 offset:52480
    ds_write_b8_d16_hi v120, v59 offset:10496
    v_lshlrev_b32 v59, 2, v120
    ds_write_b32 v59, v23 offset:52480
p1_k28:
    s_cmp_ge_u32 s33, 1536
    s_cbranch_scc1 p1_k29
    s_cmp_lt_u32 s33, 1352
    s_cselect_b32 s14, 102400000, 0
    s_add_u32 s32, s31, 40960
    buffer_load_dwordx2 v[86:87], v2, s[12:15], s32 offen nt
p1_k29:
    s_cmp_lt_u32 s29, 1315
    s_cbranch_scc1 p1_pa5
    s_waitcnt lgkmcnt(0)
    s_branch p1_pb5
p1_pa5:
    v_and_b32 v117, 0xffff, v64
    ds_add_rtn_u32 v117, v117, v3 offset:0
    v_and_b32 v118, 0xffff, v65
    ds_add_rtn_u32 v118, v118, v3 offset:0
    v_and_b32 v119, 0xffff, v66
    ds_add_rtn_u32 v119, v119, v3 offset:0
    v_and_b32 v120, 0xffff, v67
    ds_add_rtn_u32 v120, v120, v3 offset:0
    s_waitcnt lgkmcnt(4)
p1_pb5:
    s_cmp_ge_u32 s29, 1352
    s_cbranch_scc1 p1_k30
    ds_write_b8_d16_hi v121, v60 offset:10496
    v_lshlrev_b32 v60, 2, v121
    ds_write_b32 v60, v24 offset:52480
    ds_write_b8_d16_hi v122, v61 offset:10496
    v_lshlrev_b32 v61, 2, v122
    ds_write_b32 v61, v25 offset:52480
    ds_write_b8_d16_hi v123, v62 offset:10496
    v_lshlrev_b32 v62, 2, v123
    ds_write_b32 v62, v26 offset:52480
    ds_write_b8_d16_hi v124, v63 offset:10496
    v_lshlrev_b32 v63, 2, v124
    ds_write_b32 v63, v27 offset:52480
p1_k30:
    s_cmp_ge_u32 s33, 1536
    s_cbranch_scc1 p1_k31
    s_cmp_lt_u32 s33, 1315
    s_cselect_b32 s14, 102400000, 0
    s_add_u32 s32, s31, 49152
    buffer_load_dwordx2 v[88:89], v2, s[12:15], s32 offen nt
p1_k31:
    s_cmp_lt_u32 s29, 1279
    s_cbranch_scc1 p1_pa6
    s_waitcnt lgkmcnt(0)
    s_branch p1_pb6
p1_pa6:
    v_and_b32 v121, 0xffff, v68
    ds_add_rtn_u32 v121, v121, v3 offset:0
    v_and_b32 v122, 0xffff, v69
    ds_add_rtn_u32 v122, v122, v3 offset:0
    v_and_b32 v123, 0xffff, v70
    ds_add_rtn_u32 v123, v123, v3 offset:0
    v_and_b32 v124, 0xffff, v71
    ds_add_rtn_u32 v124, v124, v3 offset:0
    s_waitcnt lgkmcnt(4)
p1_pb6:
    s_cmp_ge_u32 s29, 1315
    s_cbranch_scc1 p1_k32
    ds_write_b8_d16_hi v117, v64 offset:10496
    v_lshlrev_b32 v64, 2, v117
    ds_write_b32 v64, v28 offset:52480
    ds_write_b8_d16_hi v118, v65 offset:10496
    v_lshlrev_b32 v65, 2, v118
    ds_write_b32 v65, v29 offset:52480
    ds_write_b8_d16_hi v119, v66 offset:10496
    v_lshlrev_b32 v66, 2, v119
    ds_write_b32 v66, v30 offset:52480
    ds_write_b8_d16_hi v120, v67 offset:10496
    v_lshlrev_b32 v67, 2, v120
    ds_write_b32 v67, v31 offset:52480
p1_k32:
    s_cmp_ge_u32 s33, 1536
    s_cbranch_scc1 p1_k33
    s_cmp_lt_u32 s33, 1279
    s_cselect_b32 s14, 102400000, 0
    s_add_u32 s32, s31, 57344
    buffer_load_dwordx2 v[90:91], v2, s[12:15], s32 offen nt
p1_k33:
    s_cmp_lt_u32 s29, 1242
    s_cbranch_scc1 p1_pa7
    s_waitcnt lgkmcnt(0)
    s_branch p1_pb7
p1_pa7:
    v_and_b32 v117, 0xffff, v72
    ds_add_rtn_u32 v117, v117, v3 offset:0
    v_and_b32 v118, 0xffff, v73
    ds_add_rtn_u32 v118, v118, v3 offset:0
    v_and_b32 v119, 0xffff, v74
    ds_add_rtn_u32 v119, v119, v3 offset:0
    v_and_b32 v120, 0xffff, v75
    ds_add_rtn_u32 v120, v120, v3 offset:0
    s_waitcnt lgkmcnt(4)
p1_pb7:
    s_cmp_ge_u32 s29, 1279
    s_cbranch_scc1 p1_k34
    ds_write_b8_d16_hi v121, v68 offset:10496
    v_lshlrev_b32 v68, 2, v121
    ds_write_b32 v68, v32 offset:52480
    ds_write_b8_d16_hi v122, v69 offset:10496
    v_lshlrev_b32 v69, 2, v122
    ds_write_b32 v69, v33 offset:52480
    ds_write_b8_d16_hi v123, v70 offset:10496
    v_lshlrev_b32 v70, 2, v123
    ds_write_b32 v70, v34 offset:52480
    ds_write_b8_d16_hi v124, v71 offset:10496
    v_lshlrev_b32 v71, 2, v124
    ds_write_b32 v71, v35 offset:52480
p1_k34:
    s_cmp_ge_u32 s33, 1536
    s_cbranch_scc1 p1_k35
    s_cmp_lt_u32 s33, 1242
    s_cselect_b32 s14, 102400000, 0
    s_add_u32 s32, s31, 65536
    buffer_load_dwordx2 v[92:93], v2, s[12:15], s32 offen nt
p1_k35:
    s_waitcnt lgkmcnt(0)
    s_cmp_ge_u32 s29, 1242
    s_cbranch_scc1 p1_k36
    ds_write_b8_d16_hi v117, v72 offset:10496
    v_lshlrev_b32 v72, 2, v117
    ds_write_b32 v72, v36 offset:52480
    ds_write_b8_d16_hi v118, v73 offset:10496
    v_lshlrev_b32 v73, 2, v118
    ds_write_b32 v73, v37 offset:52480
    ds_write_b8_d16_hi v119, v74 offset:10496
    v_lshlrev_b32 v74, 2, v119
    ds_write_b32 v74, v38 offset:52480
    ds_write_b8_d16_hi v120, v75 offset:10496
    v_lshlrev_b32 v75, 2, v120
    ds_write_b32 v75, v39 offset:52480
p1_k36:
    s_cmp_eq_u32 s68, 0
    s_cbranch_scc1 p1_sg
    s_cmp_lt_u32 s33, 1536
    s_cbranch_scc1 p1_w37
    s_waitcnt vmcnt(0)
p1_w37:
    s_waitcnt vmcnt(8)
    v_bfe_u32 v127, v127, s53, 4
    v_mov_b32 v125, 0
    s_mov_b64 exec, 1
    ds_write_b32 v125, v127 offset:10452
    s_mov_b64 exec, -1
p1_sg:
    s_cmp_lt_u32 s33, 1536
    s_cbranch_scc1 p1_f1
    s_cmp_lg_u32 s28, 15
    s_cbranch_scc1 p1_hv1
    s_waitcnt vmcnt(0)
    v_bfe_u32 v127, v127, s58, 4
    v_mov_b32 v125, 0
    s_mov_b64 exec, 1
    ds_write_b32 v125, v127 offset:10448
    s_mov_b64 exec, -1
p1_hv1:
    s_cmp_ge_u32 s33, 1656
    s_cbranch_scc1 p1_f1
    s_sub_u32 s52, s33, 1536
    s_mul_i32 s53, s52, 53760
    s_add_u32 s53, s53, 485810176
    s_mul_i32 s54, s28, 3072
    v_lshl_add_u32 v93, v92, 4, s54
    s_lshl_b32 s54, s28, 9
    s_add_u32 s54, s54, 49152
    s_cmp_lt_u32 s28, 9
    s_cselect_b32 s54, s54, 0x40000000
    v_lshl_add_u32 v94, v92, 3, s54
    v_mov_b32 v96, 0
    v_mov_b32 v97, 0
    s_waitcnt vmcnt(0)
    buffer_store_dwordx4 v[76:79], v93, s[16:19], s53 offen offset:0
    buffer_store_dwordx4 v[80:83], v93, s[16:19], s53 offen offset:1024
    buffer_store_dwordx4 v[84:87], v93, s[16:19], s53 offen offset:2048
    buffer_store_dwordx2 v[88:89], v94, s[16:19], s53 offen
    v_and_b32 v98, 0x7fff7fff, v76
    v_pk_max_u16 v96, v96, v98
    v_lshlrev_b32 v99, 16, v98
    v_and_b32 v98, 0xffff0000, v98
    v_fmac_f32 v97, v99, v99
    v_fmac_f32 v97, v98, v98
    v_and_b32 v98, 0x7fff7fff, v77
    v_pk_max_u16 v96, v96, v98
    v_lshlrev_b32 v99, 16, v98
    v_and_b32 v98, 0xffff0000, v98
    v_fmac_f32 v97, v99, v99
    v_fmac_f32 v97, v98, v98
    v_and_b32 v98, 0x7fff7fff, v78
    v_pk_max_u16 v96, v96, v98
    v_lshlrev_b32 v99, 16, v98
    v_and_b32 v98, 0xffff0000, v98
    v_fmac_f32 v97, v99, v99
    v_fmac_f32 v97, v98, v98
    v_and_b32 v98, 0x7fff7fff, v79
    v_pk_max_u16 v96, v96, v98
    v_lshlrev_b32 v99, 16, v98
    v_and_b32 v98, 0xffff0000, v98
    v_fmac_f32 v97, v99, v99
    v_fmac_f32 v97, v98, v98
    v_and_b32 v98, 0x7fff7fff, v80
    v_pk_max_u16 v96, v96, v98
    v_lshlrev_b32 v99, 16, v98
    v_and_b32 v98, 0xffff0000, v98
    v_fmac_f32 v97, v99, v99
    v_fmac_f32 v97, v98, v98
    v_and_b32 v98, 0x7fff7fff, v81
    v_pk_max_u16 v96, v96, v98
    v_lshlrev_b32 v99, 16, v98
    v_and_b32 v98, 0xffff0000, v98
    v_fmac_f32 v97, v99, v99
    v_fmac_f32 v97, v98, v98
    v_and_b32 v98, 0x7fff7fff, v82
    v_pk_max_u16 v96, v96, v98
    v_lshlrev_b32 v99, 16, v98
    v_and_b32 v98, 0xffff0000, v98
    v_fmac_f32 v97, v99, v99
    v_fmac_f32 v97, v98, v98
    v_and_b32 v98, 0x7fff7fff, v83
    v_pk_max_u16 v96, v96, v98
    v_lshlrev_b32 v99, 16, v98
    v_and_b32 v98, 0xffff0000, v98
    v_fmac_f32 v97, v99, v99
    v_fmac_f32 v97, v98, v98
    v_and_b32 v98, 0x7fff7fff, v84
    v_pk_max_u16 v96, v96, v98
    v_lshlrev_b32 v99, 16, v98
    v_and_b32 v98, 0xffff0000, v98
    v_fmac_f32 v97, v99, v99
    v_fmac_f32 v97, v98, v98
    v_and_b32 v98, 0x7fff7fff, v85
    v_pk_max_u16 v96, v96, v98
    v_lshlrev_b32 v99, 16, v98
    v_and_b32 v98, 0xffff0000, v98
    v_fmac_f32 v97, v99, v99
    v_fmac_f32 v97, v98, v98
    v_and_b32 v98, 0x7fff7fff, v86
    v_pk_max_u16 v96, v96, v98
    v_lshlrev_b32 v99, 16, v98
    v_and_b32 v98, 0xffff0000, v98
    v_fmac_f32 v97, v99, v99
    v_fmac_f32 v97, v98, v98
    v_and_b32 v98, 0x7fff7fff, v87
    v_pk_max_u16 v96, v96, v98
    v_lshlrev_b32 v99, 16, v98
    v_and_b32 v98, 0xffff0000, v98
    v_fmac_f32 v97, v99, v99
    v_fmac_f32 v97, v98, v98
    v_and_b32 v98, 0x7fff7fff, v88
    v_pk_max_u16 v96, v96, v98
    v_lshlrev_b32 v99, 16, v98
    v_and_b32 v98, 0xffff0000, v98
    v_fmac_f32 v97, v99, v99
    v_fmac_f32 v97, v98, v98
    v_and_b32 v98, 0x7fff7fff, v89
    v_pk_max_u16 v96, v96, v98
    v_lshlrev_b32 v99, 16, v98
    v_and_b32 v98, 0xffff0000, v98
    v_fmac_f32 v97, v99, v99
    v_fmac_f32 v97, v98, v98
    v_lshrrev_b32 v98, 16, v96
    v_and_b32 v96, 0xffff, v96
    v_max_u32 v96, v96, v98
    s_nop 1
    v_max_u32_dpp v96, v96, v96 row_shr:1 row_mask:0xf bank_mask:0xf bound_ctrl:0
    v_add_f32_dpp v97, v97, v97 row_shr:1 row_mask:0xf bank_mask:0xf bound_ctrl:0
    s_nop 0
    v_max_u32_dpp v96, v96, v96 row_shr:2 row_mask:0xf bank_mask:0xf bound_ctrl:0
    v_add_f32_dpp v97, v97, v97 row_shr:2 row_mask:0xf bank_mask:0xf bound_ctrl:0
    s_nop 0
    v_max_u32_dpp v96, v96, v96 row_shr:4 row_mask:0xf bank_mask:0xf bound_ctrl:0
    v_add_f32_dpp v97, v97, v97 row_shr:4 row_mask:0xf bank_mask:0xf bound_ctrl:0
    s_nop 0
    v_max_u32_dpp v96, v96, v96 row_shr:8 row_mask:0xf bank_mask:0xf bound_ctrl:0
    v_add_f32_dpp v97, v97, v97 row_shr:8 row_mask:0xf bank_mask:0xf bound_ctrl:0
    s_nop 0
    v_max_u32_dpp v96, v96, v96 row_bcast:15 row_mask:0xa bank_mask:0xf
    v_add_f32_dpp v97, v97, v97 row_bcast:15 row_mask:0xa bank_mask:0xf
    s_nop 0
    v_max_u32_dpp v96, v96, v96 row_bcast:31 row_mask:0xc bank_mask:0xf
    v_add_f32_dpp v97, v97, v97 row_bcast:31 row_mask:0xc bank_mask:0xf
    s_nop 0
    s_nop 0
    s_lshl_b32 s52, s52, 4
    s_add_u32 s52, s52, s28
    s_lshl_b32 s52, s52, 3
    s_add_u32 s52, s52, 492261376
    s_mov_b64 exec, 1
    s_lshl_b64 exec, exec, 63
    buffer_store_dwordx2 v[96:97], off, s[16:19], s52
    s_mov_b64 exec, -1
p1_f1:
    s_waitcnt lgkmcnt(0)
    s_barrier
    v_mul_u32_u24 v119, 3, v0
    v_and_b32 v118, -4, v119
    v_add_u32 v120, s50, v1
    v_mov_b32 v122, 0
    v_mov_b32 v123, 0
    v_mov_b32 v124, 0
    v_mov_b32 v125, 0
    ds_read_b64 v[126:127], v122 offset:10448
    ds_write_b32 v122, v122 offset:10432
    v_cmp_gt_u32 vcc, 640, v0
    s_and_saveexec_b64 s[52:53], vcc
    ds_write_b128 v1, v[122:125] offset:0
    s_mov_b64 exec, -1
    s_waitcnt lgkmcnt(2)
    v_readfirstlane_b32 s70, v126
    v_readfirstlane_b32 s69, v127
    s_cmp_ge_u32 s33, 1536
    s_cselect_b32 s70, s70, 0
    s_cmp_gt_u32 s28, 10
    s_cselect_b32 s69, 0, s69
    s_cselect_b32 s70, 0, s70
    s_cmp_lg_u32 s70, 8
    s_cbranch_scc1 p1_h0
    s_sub_u32 s52, s33, 1536
    v_and_b32 v102, 63, v0
    s_cmp_eq_u32 s28, 10
    s_cbranch_scc1 p1_tr10
    s_mul_i32 s53, s28, 520
    v_lshl_add_u32 v100, v102, 3, s53
    s_mul_i32 s53, s28, 4160
    v_lshl_add_u32 v101, v102, 4, s53
    s_branch p1_tr20
p1_tr10:
    v_mul_u32_u24 v100, 520, v102
    v_add_u32 v100, 512, v100
    v_mul_u32_u24 v101, 4160, v102
    v_add_u32 v101, 1024, v101
    v_cmp_gt_u32 vcc, 10, v102
    v_mov_b32 v102, 0x40000000
    s_nop 0
    v_cndmask_b32 v100, v102, v100, vcc
    v_cndmask_b32 v101, v102, v101, vcc
p1_tr20:
    s_mul_i32 s52, s52, 41984
    s_add_u32 s52, s52, 469762048
    buffer_load_dwordx2 v[76:77], v100, s[16:19], s52 offen sc1
    s_add_u32 s52, s52, 5248
    buffer_load_dwordx2 v[78:79], v100, s[16:19], s52 offen sc1
    s_add_u32 s52, s52, 5248
    buffer_load_dwordx2 v[80:81], v100, s[16:19], s52 offen sc1
    s_add_u32 s52, s52, 5248
    buffer_load_dwordx2 v[82:83], v100, s[16:19], s52 offen sc1
    s_add_u32 s52, s52, 5248
    buffer_load_dwordx2 v[84:85], v100, s[16:19], s52 offen sc1
    s_add_u32 s52, s52, 5248
    buffer_load_dwordx2 v[86:87], v100, s[16:19], s52 offen sc1
    s_add_u32 s52, s52, 5248
    buffer_load_dwordx2 v[88:89], v100, s[16:19], s52 offen sc1
    s_add_u32 s52, s52, 5248
    buffer_load_dwordx2 v[90:91], v100, s[16:19], s52 offen sc1
    s_add_u32 s52, s52, 5248
p1_h0:
    v_lshlrev_b32 v117, 2, v119
    v_add_u32 v117, 52480, v117
    ds_read_b32 v110, v117 offset:0
    ds_read_b32 v111, v117 offset:4
    ds_read_b32 v112, v117 offset:8
    ds_read_b32 v113, v118 offset:10496
    ds_read_b32 v114, v118 offset:10500
    ds_read_b32 v122, v117 offset:12288
    ds_read_b32 v123, v117 offset:12292
    ds_read_b32 v124, v117 offset:12296
    ds_read_b32 v125, v118 offset:13568
    ds_read_b32 v121, v118 offset:13572
    s_waitcnt lgkmcnt(5)
    v_alignbyte_b32 v113, v114, v113, v119
    buffer_store_dwordx4 v[110:113], v120, s[20:23], 0 offen
    v_add_u32 v120, 33554432, v120
    s_nop 0
    ds_read_b32 v110, v117 offset:24576
    ds_read_b32 v111, v117 offset:24580
    ds_read_b32 v112, v117 offset:24584
    ds_read_b32 v113, v118 offset:16640
    ds_read_b32 v114, v118 offset:16644
    s_cmp_le_u32 s35, 1024
    s_cbranch_scc1 p1_ce0
    s_waitcnt lgkmcnt(5)
    v_alignbyte_b32 v125, v121, v125, v119
    buffer_store_dwordx4 v[122:125], v120, s[20:23], 0 offen
    v_add_u32 v120, 33554432, v120
    s_nop 0
    ds_read_b32 v122, v117 offset:36864
    ds_read_b32 v123, v117 offset:36868
    ds_read_b32 v124, v117 offset:36872
    ds_read_b32 v125, v118 offset:19712
    ds_read_b32 v121, v118 offset:19716
    s_cmp_le_u32 s35, 2048
    s_cbranch_scc1 p1_ce0
    s_waitcnt lgkmcnt(5)
    v_alignbyte_b32 v113, v114, v113, v119
    buffer_store_dwordx4 v[110:113], v120, s[20:23], 0 offen
    v_add_u32 v120, 33554432, v120
    s_nop 0
    ds_read_b32 v110, v117 offset:49152
    ds_read_b32 v111, v117 offset:49156
    ds_read_b32 v112, v117 offset:49160
    ds_read_b32 v113, v118 offset:22784
    ds_read_b32 v114, v118 offset:22788
    s_cmp_le_u32 s35, 3072
    s_cbranch_scc1 p1_ce0
    s_waitcnt lgkmcnt(5)
    v_alignbyte_b32 v125, v121, v125, v119
    buffer_store_dwordx4 v[122:125], v120, s[20:23], 0 offen
    v_add_u32 v120, 33554432, v120
    s_nop 0
    v_lshlrev_b32 v117, 2, v119
    v_add_u32 v117, 113920, v117
    ds_read_b32 v122, v117 offset:0
    ds_read_b32 v123, v117 offset:4
    ds_read_b32 v124, v117 offset:8
    ds_read_b32 v125, v118 offset:25856
    ds_read_b32 v121, v118 offset:25860
    s_cmp_le_u32 s35, 4096
    s_cbranch_scc1 p1_ce0
    s_waitcnt lgkmcnt(5)
    v_alignbyte_b32 v113, v114, v113, v119
    buffer_store_dwordx4 v[110:113], v120, s[20:23], 0 offen
    v_add_u32 v120, 33554432, v120
    s_nop 0
    ds_read_b32 v110, v117 offset:12288
    ds_read_b32 v111, v117 offset:12292
    ds_read_b32 v112, v117 offset:12296
    ds_read_b32 v113, v118 offset:28928
    ds_read_b32 v114, v118 offset:28932
    s_cmp_le_u32 s35, 5120
    s_cbranch_scc1 p1_ce0
    s_waitcnt lgkmcnt(5)
    v_alignbyte_b32 v125, v121, v125, v119
    buffer_store_dwordx4 v[122:125], v120, s[20:23], 0 offen
    v_add_u32 v120, 33554432, v120
    s_nop 0
    ds_read_b32 v122, v117 offset:24576
    ds_read_b32 v123, v117 offset:24580
    ds_read_b32 v124, v117 offset:24584
    ds_read_b32 v125, v118 offset:32000
    ds_read_b32 v121, v118 offset:32004
    s_cmp_le_u32 s35, 6144
    s_cbranch_scc1 p1_ce0
    s_waitcnt lgkmcnt(5)
    v_alignbyte_b32 v113, v114, v113, v119
    buffer_store_dwordx4 v[110:113], v120, s[20:23], 0 offen
    v_add_u32 v120, 33554432, v120
    s_nop 0
    ds_read_b32 v110, v117 offset:36864
    ds_read_b32 v111, v117 offset:36868
    ds_read_b32 v112, v117 offset:36872
    ds_read_b32 v113, v118 offset:35072
    ds_read_b32 v114, v118 offset:35076
    s_cmp_le_u32 s35, 7168
    s_cbranch_scc1 p1_ce0
    s_waitcnt lgkmcnt(5)
    v_alignbyte_b32 v125, v121, v125, v119
    buffer_store_dwordx4 v[122:125], v120, s[20:23], 0 offen
    v_add_u32 v120, 33554432, v120
    s_nop 0
    s_cmp_le_u32 s35, 8192
    s_cbranch_scc1 p1_ce0
    s_waitcnt lgkmcnt(0)
    v_alignbyte_b32 v113, v114, v113, v119
    buffer_store_dwordx4 v[110:113], v120, s[20:23], 0 offen nt
    v_add_u32 v120, 33554432, v120
    s_nop 0
p1_ce0:
    s_waitcnt lgkmcnt(0)
    s_cmp_lg_u32 s70, 8
    s_cbranch_scc1 p1_h1
    s_sub_u32 s52, s33, 1536
    s_mul_i32 s52, s52, 41600
    s_add_u32 s52, s52, 477822976
    s_mov_b32 s54, 0x05040100
    s_mov_b32 s55, 0x07060302
    s_waitcnt vmcnt(1)
    v_perm_b32 v92, v78, v76, s54
    v_perm_b32 v93, v82, v80, s54
    v_perm_b32 v94, v86, v84, s54
    v_perm_b32 v95, v90, v88, s54
    buffer_store_dwordx4 v[92:95], v101, s[16:19], s52 offen offset:0
    v_perm_b32 v96, v78, v76, s55
    v_perm_b32 v97, v82, v80, s55
    v_perm_b32 v98, v86, v84, s55
    v_perm_b32 v99, v90, v88, s55
    buffer_store_dwordx4 v[96:99], v101, s[16:19], s52 offen offset:1040
    v_perm_b32 v92, v79, v77, s54
    v_perm_b32 v93, v83, v81, s54
    v_perm_b32 v94, v87, v85, s54
    v_perm_b32 v95, v91, v89, s54
    buffer_store_dwordx4 v[92:95], v101, s[16:19], s52 offen offset:2080
    v_perm_b32 v96, v79, v77, s55
    v_perm_b32 v97, v83, v81, s55
    v_perm_b32 v98, v87, v85, s55
    v_perm_b32 v99, v91, v89, s55
    buffer_store_dwordx4 v[96:99], v101, s[16:19], s52 offen offset:3120
p1_h1:
    s_barrier
    s_cmp_ge_u32 s29, 1462
    s_cbranch_scc1 p1_k38
    s_cmp_le_u32 s35, 9216
    s_cbranch_scc1 p1_s1k2
    v_sub_u32 v48, 221180, v48
    ds_write_b32 v48, v12 offset:52480
    v_sub_u32 v49, 221180, v49
    ds_write_b32 v49, v13 offset:52480
    v_sub_u32 v50, 221180, v50
    ds_write_b32 v50, v14 offset:52480
    v_sub_u32 v51, 221180, v51
    ds_write_b32 v51, v15 offset:52480
p1_s1k2:
p1_k38:
    s_cmp_ge_u32 s33, 1536
    s_cbranch_scc1 p1_k39
    s_cmp_lt_u32 s33, 1462
    s_cselect_b32 s6, 204800000, 0
    s_cselect_b32 s10, 204800000, 0
    s_add_u32 s32, s30, 32768
    buffer_load_dwordx4 v[12:15], v1, s[4:7], s32 offen nt
    buffer_load_dwordx4 v[48:51], v1, s[8:11], s32 offen nt
p1_k39:
    s_cmp_ge_u32 s29, 1426
    s_cbranch_scc1 p1_k40
    s_cmp_le_u32 s35, 9216
    s_cbranch_scc1 p1_s1k3
    v_sub_u32 v52, 221180, v52
    ds_write_b32 v52, v16 offset:52480
    v_sub_u32 v53, 221180, v53
    ds_write_b32 v53, v17 offset:52480
    v_sub_u32 v54, 221180, v54
    ds_write_b32 v54, v18 offset:52480
    v_sub_u32 v55, 221180, v55
    ds_write_b32 v55, v19 offset:52480
p1_s1k3:
p1_k40:
    s_cmp_ge_u32 s29, 1389
    s_cbranch_scc1 p1_k41
    s_cmp_le_u32 s35, 9216
    s_cbranch_scc1 p1_s1k4
    v_sub_u32 v56, 221180, v56
    ds_write_b32 v56, v20 offset:52480
    v_sub_u32 v57, 221180, v57
    ds_write_b32 v57, v21 offset:52480
    v_sub_u32 v58, 221180, v58
    ds_write_b32 v58, v22 offset:52480
    v_sub_u32 v59, 221180, v59
    ds_write_b32 v59, v23 offset:52480
p1_s1k4:
p1_k41:
    s_cmp_ge_u32 s29, 1352
    s_cbranch_scc1 p1_k42
    s_cmp_le_u32 s35, 9216
    s_cbranch_scc1 p1_s1k5
    v_sub_u32 v60, 221180, v60
    ds_write_b32 v60, v24 offset:52480
    v_sub_u32 v61, 221180, v61
    ds_write_b32 v61, v25 offset:52480
    v_sub_u32 v62, 221180, v62
    ds_write_b32 v62, v26 offset:52480
    v_sub_u32 v63, 221180, v63
    ds_write_b32 v63, v27 offset:52480
p1_s1k5:
p1_k42:
    s_cmp_ge_u32 s29, 1315
    s_cbranch_scc1 p1_k43
    s_cmp_le_u32 s35, 9216
    s_cbranch_scc1 p1_s1k6
    v_sub_u32 v64, 221180, v64
    ds_write_b32 v64, v28 offset:52480
    v_sub_u32 v65, 221180, v65
    ds_write_b32 v65, v29 offset:52480
    v_sub_u32 v66, 221180, v66
    ds_write_b32 v66, v30 offset:52480
    v_sub_u32 v67, 221180, v67
    ds_write_b32 v67, v31 offset:52480
p1_s1k6:
p1_k43:
    s_cmp_ge_u32 s29, 1279
    s_cbranch_scc1 p1_k44
    s_cmp_le_u32 s35, 9216
    s_cbranch_scc1 p1_s1k7
    v_sub_u32 v68, 221180, v68
    ds_write_b32 v68, v32 offset:52480
    v_sub_u32 v69, 221180, v69
    ds_write_b32 v69, v33 offset:52480
    v_sub_u32 v70, 221180, v70
    ds_write_b32 v70, v34 offset:52480
    v_sub_u32 v71, 221180, v71
    ds_write_b32 v71, v35 offset:52480
p1_s1k7:
p1_k44:
    s_cmp_ge_u32 s29, 1242
    s_cbranch_scc1 p1_k45
    s_cmp_le_u32 s35, 9216
    s_cbranch_scc1 p1_s1k8
    v_sub_u32 v72, 221180, v72
    ds_write_b32 v72, v36 offset:52480
    v_sub_u32 v73, 221180, v73
    ds_write_b32 v73, v37 offset:52480
    v_sub_u32 v74, 221180, v74
    ds_write_b32 v74, v38 offset:52480
    v_sub_u32 v75, 221180, v75
    ds_write_b32 v75, v39 offset:52480
p1_s1k8:
p1_k45:
    s_cmp_le_u32 s35, 9216
    s_cbranch_scc1 p1_s1k0
    v_sub_u32 v40, 221180, v40
    ds_write_b32 v40, v4 offset:52480
    v_sub_u32 v41, 221180, v41
    ds_write_b32 v41, v5 offset:52480
    v_sub_u32 v42, 221180, v42
    ds_write_b32 v42, v6 offset:52480
    v_sub_u32 v43, 221180, v43
    ds_write_b32 v43, v7 offset:52480
p1_s1k0:
    s_cmp_ge_u32 s29, 1499
    s_cbranch_scc1 p1_k46
    s_cmp_le_u32 s35, 9216
    s_cbranch_scc1 p1_s1k1
    v_sub_u32 v44, 221180, v44
    ds_write_b32 v44, v8 offset:52480
    v_sub_u32 v45, 221180, v45
    ds_write_b32 v45, v9 offset:52480
    v_sub_u32 v46, 221180, v46
    ds_write_b32 v46, v10 offset:52480
    v_sub_u32 v47, 221180, v47
    ds_write_b32 v47, v11 offset:52480
p1_s1k1:
p1_k46:
    s_cmp_lg_u32 s69, 8
    s_cbranch_scc1 p1_o1
    s_lshr_b32 s52, s29, 3
    v_and_b32 v74, 63, v0
    s_cmp_eq_u32 s28, 10
    s_cbranch_scc1 p1_tr11
    s_mul_i32 s53, s28, 520
    v_lshl_add_u32 v72, v74, 3, s53
    s_mul_i32 s53, s28, 4160
    v_lshl_add_u32 v73, v74, 4, s53
    s_branch p1_tr21
p1_tr11:
    v_mul_u32_u24 v72, 520, v74
    v_add_u32 v72, 512, v72
    v_mul_u32_u24 v73, 4160, v74
    v_add_u32 v73, 1024, v73
    v_cmp_gt_u32 vcc, 10, v74
    v_mov_b32 v74, 0x40000000
    s_nop 0
    v_cndmask_b32 v72, v74, v72, vcc
    v_cndmask_b32 v73, v74, v73, vcc
p1_tr21:
    s_mul_i32 s52, s52, 41984
    s_add_u32 s52, s52, 469762048
    buffer_load_dwordx2 v[24:25], v72, s[16:19], s52 offen sc1
    s_add_u32 s52, s52, 5248
    buffer_load_dwordx2 v[26:27], v72, s[16:19], s52 offen sc1
    s_add_u32 s52, s52, 5248
    buffer_load_dwordx2 v[28:29], v72, s[16:19], s52 offen sc1
    s_add_u32 s52, s52, 5248
    buffer_load_dwordx2 v[30:31], v72, s[16:19], s52 offen sc1
    s_add_u32 s52, s52, 5248
    buffer_load_dwordx2 v[32:33], v72, s[16:19], s52 offen sc1
    s_add_u32 s52, s52, 5248
    buffer_load_dwordx2 v[34:35], v72, s[16:19], s52 offen sc1
    s_add_u32 s52, s52, 5248
    buffer_load_dwordx2 v[36:37], v72, s[16:19], s52 offen sc1
    s_add_u32 s52, s52, 5248
    buffer_load_dwordx2 v[38:39], v72, s[16:19], s52 offen sc1
    s_add_u32 s52, s52, 5248
    s_cmp_ge_u32 s33, 1536
    s_cbranch_scc1 p1_o1
    s_lshr_b32 s52, s29, 3
    s_mul_i32 s52, s52, 41600
    s_add_u32 s52, s52, 477822976
    s_mov_b32 s54, 0x05040100
    s_mov_b32 s55, 0x07060302
    s_waitcnt vmcnt(0)
    v_perm_b32 v64, v26, v24, s54
    v_perm_b32 v65, v30, v28, s54
    v_perm_b32 v66, v34, v32, s54
    v_perm_b32 v67, v38, v36, s54
    buffer_store_dwordx4 v[64:67], v73, s[16:19], s52 offen offset:0
    v_perm_b32 v68, v26, v24, s55
    v_perm_b32 v69, v30, v28, s55
    v_perm_b32 v70, v34, v32, s55
    v_perm_b32 v71, v38, v36, s55
    buffer_store_dwordx4 v[68:71], v73, s[16:19], s52 offen offset:1040
    v_perm_b32 v64, v27, v25, s54
    v_perm_b32 v65, v31, v29, s54
    v_perm_b32 v66, v35, v33, s54
    v_perm_b32 v67, v39, v37, s54
    buffer_store_dwordx4 v[64:67], v73, s[16:19], s52 offen offset:2080
    v_perm_b32 v68, v27, v25, s55
    v_perm_b32 v69, v31, v29, s55
    v_perm_b32 v70, v35, v33, s55
    v_perm_b32 v71, v39, v37, s55
    buffer_store_dwordx4 v[68:71], v73, s[16:19], s52 offen offset:3120
    s_mov_b32 s69, 0
p1_o1:
    s_waitcnt lgkmcnt(0)
    s_barrier
    s_cmp_le_u32 s35, 9216
    s_cbranch_scc1 p1_ce1
    v_lshlrev_b32 v117, 2, v119
    v_sub_u32 v117, 113908, v117
    ds_read_b32 v122, v117 offset:49160
    ds_read_b32 v123, v117 offset:49156
    ds_read_b32 v124, v117 offset:49152
    ds_read_b32 v125, v118 offset:38144
    ds_read_b32 v121, v118 offset:38148
    ds_read_b32 v110, v117 offset:36872
    ds_read_b32 v111, v117 offset:36868
    ds_read_b32 v112, v117 offset:36864
    ds_read_b32 v113, v118 offset:41216
    ds_read_b32 v114, v118 offset:41220
    s_waitcnt lgkmcnt(5)
    v_alignbyte_b32 v125, v121, v125, v119
    buffer_store_dwordx4 v[122:125], v120, s[20:23], 0 offen nt
    v_add_u32 v120, 33554432, v120
    s_nop 0
    ds_read_b32 v122, v117 offset:24584
    ds_read_b32 v123, v117 offset:24580
    ds_read_b32 v124, v117 offset:24576
    ds_read_b32 v125, v118 offset:44288
    ds_read_b32 v121, v118 offset:44292
    s_cmp_le_u32 s35, 10240
    s_cbranch_scc1 p1_ce1
    s_waitcnt lgkmcnt(5)
    v_alignbyte_b32 v113, v114, v113, v119
    buffer_store_dwordx4 v[110:113], v120, s[20:23], 0 offen nt
    v_add_u32 v120, 33554432, v120
    s_nop 0
    ds_read_b32 v110, v117 offset:12296
    ds_read_b32 v111, v117 offset:12292
    ds_read_b32 v112, v117 offset:12288
    ds_read_b32 v113, v118 offset:47360
    ds_read_b32 v114, v118 offset:47364
    s_cmp_le_u32 s35, 11264
    s_cbranch_scc1 p1_ce1
    s_waitcnt lgkmcnt(5)
    v_alignbyte_b32 v125, v121, v125, v119
    buffer_store_dwordx4 v[122:125], v120, s[20:23], 0 offen nt
    v_add_u32 v120, 33554432, v120
    s_nop 0
    ds_read_b32 v122, v117 offset:8
    ds_read_b32 v123, v117 offset:4
    ds_read_b32 v124, v117 offset:0
    ds_read_b32 v125, v118 offset:50432
    ds_read_b32 v121, v118 offset:50436
    s_cmp_le_u32 s35, 12288
    s_cbranch_scc1 p1_ce1
    s_waitcnt lgkmcnt(5)
    v_alignbyte_b32 v113, v114, v113, v119
    buffer_store_dwordx4 v[110:113], v120, s[20:23], 0 offen nt
    v_add_u32 v120, 33554432, v120
    s_nop 0
    s_cmp_le_u32 s35, 13312
    s_cbranch_scc1 p1_ce1
    s_waitcnt lgkmcnt(0)
    v_alignbyte_b32 v125, v121, v125, v119
    buffer_store_dwordx4 v[122:125], v120, s[20:23], 0 offen nt
    v_add_u32 v120, 33554432, v120
    s_nop 0
p1_ce1:
    s_waitcnt lgkmcnt(0)
    s_cmp_lg_u32 s69, 8
    s_cbranch_scc1 p1_o2
    s_lshr_b32 s52, s29, 3
    s_mul_i32 s52, s52, 41600
    s_add_u32 s52, s52, 477822976
    s_mov_b32 s54, 0x05040100
    s_mov_b32 s55, 0x07060302
    s_waitcnt vmcnt(0)
    v_perm_b32 v64, v26, v24, s54
    v_perm_b32 v65, v30, v28, s54
    v_perm_b32 v66, v34, v32, s54
    v_perm_b32 v67, v38, v36, s54
    buffer_store_dwordx4 v[64:67], v73, s[16:19], s52 offen offset:0
    v_perm_b32 v68, v26, v24, s55
    v_perm_b32 v69, v30, v28, s55
    v_perm_b32 v70, v34, v32, s55
    v_perm_b32 v71, v38, v36, s55
    buffer_store_dwordx4 v[68:71], v73, s[16:19], s52 offen offset:1040
    v_perm_b32 v64, v27, v25, s54
    v_perm_b32 v65, v31, v29, s54
    v_perm_b32 v66, v35, v33, s54
    v_perm_b32 v67, v39, v37, s54
    buffer_store_dwordx4 v[64:67], v73, s[16:19], s52 offen offset:2080
    v_perm_b32 v68, v27, v25, s55
    v_perm_b32 v69, v31, v29, s55
    v_perm_b32 v70, v35, v33, s55
    v_perm_b32 v71, v39, v37, s55
    buffer_store_dwordx4 v[68:71], v73, s[16:19], s52 offen offset:3120
p1_o2:
    s_barrier
    s_mov_b32 s29, s33
    s_cmp_lt_u32 s29, 1242
    s_cselect_b32 s34, 1, 0
    s_cmp_lt_u32 s29, 1536
    s_cbranch_scc1 p1_tile
p1_end:
    s_endpgm
.globl p2_kernel
.p2align 8
.type p2_kernel,@function
p2_kernel:
    s_cmp_ge_u32 s2, 256
    s_cbranch_scc1 p2_end
    s_load_dwordx2 s[8:9], s[0:1], 104
    v_and_b32 v112, 63, v0
    v_lshrrev_b32 v122, 6, v0
    v_lshlrev_b32 v112, 4, v112
    v_readfirstlane_b32 s10, v122
    v_mov_b32 v113, 0x83ff0000
    s_and_b32 s44, s2, 7
    s_lshr_b32 s11, s44, 1
    s_and_b32 s44, s44, 1
    s_lshl_b32 s12, s44, 5
    s_lshr_b32 s44, s2, 3
    s_add_u32 s12, s12, s44
    s_mov_b32 s25, 54272
    s_mov_b32 s31, 67175170
    s_mov_b32 s32, 83952386
    s_mov_b32 s33, 100729602
    s_mov_b32 s21, 0
    s_mul_i32 s23, s10, 3072
    s_lshl_b32 s24, s10, 9
    s_lshl_b32 s64, s10, 10
    s_sub_u32 s42, s24, s23
    s_add_u32 s42, s42, 49152
    s_movk_i32 s63, 2048
    s_mul_i32 s62, s11, 161280
    s_add_u32 s62, s62, 485810176
    s_add_u32 s62, s62, s23
    s_mov_b32 s40, 477822976
    s_mul_i32 s44, s11, 1040
    s_add_u32 s40, s40, s44
    s_lshl_b32 s44, s12, 4
    s_add_u32 s40, s40, s44
    s_waitcnt lgkmcnt(0)
    s_mov_b32 s4, s8
    s_and_b32 s5, s9, 0xffff
    s_mov_b32 s6, 819200000
    s_mov_b32 s7, 0x20000
    s_mov_b32 s68, s8
    s_and_b32 s69, s9, 0xffff
    s_mov_b32 s70, 469762048
    s_mov_b32 s71, 0x20000
    s_and_b32 s44, s2, 7
    s_lshl_b32 s44, s44, 2
    s_lshr_b32 s18, 0x00000000, s44
    s_and_b32 s18, s18, 15
p2_restart:
    s_mov_b32 s61, 0
    s_add_u32 s44, s61, s18
    s_cmp_ge_u32 s44, 10
    s_cselect_b32 s53, 10, 0
    s_sub_u32 s44, s44, s53
    s_mul_i32 s44, s44, 4160
    s_add_u32 s44, s44, s40
    v_bfe_i32 v111, v112, 6, 1
    v_lshrrev_b32 v110, 6, v112
    v_bitop3_b32 v111, v111, 15, s10 bitop3:0x6a
    v_lshl_or_b32 v110, v110, 4, v111
    v_bfe_u32 v111, v112, 2, 4
    v_mul_u32_u24 v110, 41600, v110
    v_add_u32 v111, v110, v111
    v_add_u32 v110, 256, v112
    v_and_b32 v110, 0x400, v110
    v_lshl_or_b32 v111, v110, 20, v111
    buffer_load_dword v110, v111, s[4:7], s44 offen
    buffer_load_dword v111, v111, s[4:7], s44 offen offset:16
    s_mov_b32 s61, 1
    s_add_u32 s44, s61, s18
    s_cmp_ge_u32 s44, 10
    s_cselect_b32 s53, 10, 0
    s_sub_u32 s44, s44, s53
    s_mul_i32 s44, s44, 4160
    s_add_u32 s44, s44, s40
    v_bfe_i32 v69, v112, 6, 1
    v_lshrrev_b32 v68, 6, v112
    v_bitop3_b32 v69, v69, 15, s10 bitop3:0x6a
    v_lshl_or_b32 v68, v68, 4, v69
    v_bfe_u32 v69, v112, 2, 4
    v_mul_u32_u24 v68, 41600, v68
    v_add_u32 v69, v68, v69
    v_add_u32 v68, 256, v112
    v_and_b32 v68, 0x400, v68
    v_lshl_or_b32 v69, v68, 20, v69
    buffer_load_dword v68, v69, s[4:7], s44 offen
    buffer_load_dword v69, v69, s[4:7], s44 offen offset:16
    s_mov_b32 s61, 0
    s_cmp_lt_u32 s10, 15
    s_cselect_b32 s44, s64, 0x40000000
    v_add_u32 v60, s44, v112
    s_mov_b32 s44, 492261376
    buffer_load_dwordx4 v[60:63], v60, s[4:7], s44 offen
    s_mul_i32 s20, s18, 645120
    s_add_u32 s20, s20, s62
    s_cmp_ge_u32 s10, 9
    s_cbranch_scc1 p2_nmp
    v_lshrrev_b32 v84, 1, v112
    s_add_u32 s44, s20, s42
    buffer_load_dwordx2 v[84:85], v84, s[4:7], s44 offen
p2_nmp:
    buffer_load_dwordx4 v[72:75], v112, s[4:7], s20 offen offset:0
    buffer_load_dwordx4 v[76:79], v112, s[4:7], s20 offen offset:1024
    buffer_load_dwordx4 v[80:83], v112, s[4:7], s20 offen offset:2048
    s_barrier
    v_mov_b32 v115, 0
    v_mov_b32 v116, 0
    v_mov_b32 v117, 0
    v_mov_b32 v118, 0
    v_mov_b32 v119, 0
    v_mov_b32 v120, 0
    v_mov_b32 v121, 0
    ds_write_b128 v115, v[116:119] offset:53760
    s_mov_b32 s19, 0
    s_cmp_eq_u32 s21, 2
    s_cselect_b64 s[66:67], -1, 0
    s_waitcnt lgkmcnt(0)
    s_barrier
    s_waitcnt vmcnt(6)
    s_mov_b32 m0, s23
    v_mov_b32 v53, 0x3c000
    s_movk_i32 s44, 512
    v_sub_u32_sdwa v4, v111, v110 dst_sel:DWORD dst_unused:UNUSED_PAD src0_sel:WORD_0 src1_sel:WORD_0
    v_sub_u32_sdwa v5, v111, v110 dst_sel:DWORD dst_unused:UNUSED_PAD src0_sel:WORD_1 src1_sel:WORD_1
    v_med3_i32 v4, v4, 0, s44
    v_med3_i32 v5, v5, 0, s44
    v_add_u32 v48, v4, v5
    ds_write_addtid_b32 v53 offset:0
    ds_write_addtid_b32 v53 offset:256
    ds_write_addtid_b32 v53 offset:512
    ds_write_addtid_b32 v53 offset:768
    ds_write_addtid_b32 v53 offset:1024
    ds_write_addtid_b32 v53 offset:1280
    ds_write_addtid_b32 v53 offset:1536
    ds_write_addtid_b32 v53 offset:1792
    v_bfe_i32 v53, v112, 6, 1
    v_lshrrev_b32 v49, 6, v112
    v_bitop3_b32 v53, v53, 15, s10 bitop3:0x6a
    v_lshl_or_b32 v49, v49, 4, v53
    v_and_b32 v53, 0x30, v112
    v_lshl_or_b32 v53, v49, 6, v53
    v_lshlrev_b32 v53, 15, v53
    s_nop 1
    v_add_u32_dpp v48, v48, v48 row_shr:1 row_mask:0xf bank_mask:0xf bound_ctrl:0
    s_nop 1
    v_add_u32_dpp v48, v48, v48 row_shr:2 row_mask:0xf bank_mask:0xf bound_ctrl:0
    s_nop 1
    v_add_u32_dpp v48, v48, v48 row_shr:4 row_mask:0xf bank_mask:0xf bound_ctrl:0
    s_nop 1
    v_add_u32_dpp v48, v48, v48 row_shr:8 row_mask:0xf bank_mask:0xf bound_ctrl:0
    s_nop 1
    v_add_u32_dpp v48, v48, v48 row_bcast:15 row_mask:0xa bank_mask:0xf
    s_nop 1
    v_add_u32_dpp v48, v48, v48 row_bcast:31 row_mask:0xc bank_mask:0xf
    s_nop 1
    s_nop 0
    v_readlane_b32 s38, v48, 63
    v_sub_u32 v50, v48, v5
    v_sub_u32 v49, v50, v4
    v_sub_u32 v10, 512, v49
    v_mad_u32_u16 v51, v110, 16, v53
    v_med3_i32 v10, v10, 0, v4
    v_lshl_add_u32 v49, v49, 2, s23
    v_sub_u32 v11, 512, v50
    v_mad_u32_u16 v52, v110, 16, v53 op_sel:[1,0,0,0]
    v_med3_i32 v11, v11, 0, v5
    v_lshl_add_u32 v50, v50, 2, s23
    v_lshl_add_u32 v48, v11, 16, v10
    v_add_u32 v52, 262144, v52
    v_add_u32 v110, v110, v48
    s_min_u32 s17, s38, 512
    s_add_u32 s17, s17, 63
    s_lshr_b32 s17, s17, 6
p2_xa_0:
    v_cmpx_lt_i32 vcc, 0, v10
    s_cbranch_execz p2_ya_0
    ds_write_b32 v49, v51 offset:0
    v_add_u32 v51, 16, v51
    v_cmpx_lt_i32 vcc, 1, v10
    s_cbranch_execz p2_ya_0
    ds_write_b32 v49, v51 offset:4
    v_add_u32 v51, 16, v51
    v_cmpx_lt_i32 vcc, 2, v10
    s_cbranch_execz p2_ya_0
    ds_write_b32 v49, v51 offset:8
    v_add_u32 v51, 16, v51
    v_cmpx_lt_i32 vcc, 3, v10
    s_cbranch_execz p2_ya_0
    ds_write_b32 v49, v51 offset:12
    v_add_u32 v51, 16, v51
    v_cmpx_lt_i32 vcc, 4, v10
    s_cbranch_execz p2_ya_0
    ds_write_b32 v49, v51 offset:16
    v_add_u32 v51, 16, v51
    v_cmpx_lt_i32 vcc, 5, v10
    s_cbranch_execz p2_ya_0
    ds_write_b32 v49, v51 offset:20
    v_add_u32 v51, 16, v51
    v_cmpx_lt_i32 vcc, 6, v10
    s_cbranch_execz p2_ya_0
    ds_write_b32 v49, v51 offset:24
    v_add_u32 v51, 16, v51
    v_cmpx_lt_i32 vcc, 7, v10
    s_cbranch_execz p2_ya_0
    ds_write_b32 v49, v51 offset:28
    v_add_u32 v51, 16, v51
    v_subrev_u32 v10, 8, v10
    v_add_u32 v49, 32, v49
    s_branch p2_xa_0
p2_ya_0:
    s_mov_b64 exec, -1
p2_xa_1:
    v_cmpx_lt_i32 vcc, 0, v11
    s_cbranch_execz p2_ya_1
    ds_write_b32 v50, v52 offset:0
    v_add_u32 v52, 16, v52
    v_cmpx_lt_i32 vcc, 1, v11
    s_cbranch_execz p2_ya_1
    ds_write_b32 v50, v52 offset:4
    v_add_u32 v52, 16, v52
    v_cmpx_lt_i32 vcc, 2, v11
    s_cbranch_execz p2_ya_1
    ds_write_b32 v50, v52 offset:8
    v_add_u32 v52, 16, v52
    v_cmpx_lt_i32 vcc, 3, v11
    s_cbranch_execz p2_ya_1
    ds_write_b32 v50, v52 offset:12
    v_add_u32 v52, 16, v52
    v_cmpx_lt_i32 vcc, 4, v11
    s_cbranch_execz p2_ya_1
    ds_write_b32 v50, v52 offset:16
    v_add_u32 v52, 16, v52
    v_cmpx_lt_i32 vcc, 5, v11
    s_cbranch_execz p2_ya_1
    ds_write_b32 v50, v52 offset:20
    v_add_u32 v52, 16, v52
    v_cmpx_lt_i32 vcc, 6, v11
    s_cbranch_execz p2_ya_1
    ds_write_b32 v50, v52 offset:24
    v_add_u32 v52, 16, v52
    v_cmpx_lt_i32 vcc, 7, v11
    s_cbranch_execz p2_ya_1
    ds_write_b32 v50, v52 offset:28
    v_add_u32 v52, 16, v52
    v_subrev_u32 v11, 8, v11
    v_add_u32 v50, 32, v50
    s_branch p2_xa_1
p2_ya_1:
    s_mov_b64 exec, -1
    s_cmp_lt_u32 s38, 512
    s_cbranch_scc1 p2_nomorea
    v_cmp_lt_u32_sdwa s[44:45], v110, v111 src0_sel:WORD_0 src1_sel:WORD_0
    v_cmp_lt_u32_sdwa s[46:47], v110, v111 src0_sel:WORD_1 src1_sel:WORD_1
    s_nop 0
    s_or_b64 s[44:45], s[44:45], s[46:47]
    s_cbranch_scc0 p2_nomorea
    v_mov_b32 v49, s19
    v_mov_b32 v50, 1
    ds_write_b32 v49, v50 offset:53760
p2_nomorea:
    s_mov_b32 m0, s23
    s_nop 0
    ds_read_addtid_b32 v2 offset:0
    ds_read_addtid_b32 v8 offset:256
    ds_read_addtid_b32 v14 offset:512
    ds_read_addtid_b32 v20 offset:768
    ds_read_addtid_b32 v88 offset:1024
    ds_read_addtid_b32 v92 offset:1280
    ds_read_addtid_b32 v96 offset:1536
    ds_read_addtid_b32 v100 offset:1792
    s_waitcnt lgkmcnt(0)
    v_bfe_u32 v0, v2, 14, 4
    v_lshrrev_b32 v1, 18, v2
    v_and_b32 v2, 0x3fff, v2
    v_mad_u32_u24 v0, v0, s63, v1
    v_lshl_or_b32 v2, v0, 14, v2
    buffer_load_dwordx4 v[0:3], v2, s[68:71], 0 offen
    v_bfe_u32 v6, v8, 14, 4
    v_lshrrev_b32 v7, 18, v8
    v_and_b32 v8, 0x3fff, v8
    v_mad_u32_u24 v6, v6, s63, v7
    v_lshl_or_b32 v8, v6, 14, v8
    buffer_load_dwordx4 v[6:9], v8, s[68:71], 0 offen
    s_cmp_eq_u32 s21, 0
    s_cselect_b32 s44, 1073758208, 0
    v_mov_b32 v124, s44
    v_mov_b32 v125, s44
    v_mov_b32 v126, s44
    v_mov_b32 v127, s44
    v_add_u32 v123, s64, v112
    v_add_u32 v122, s25, v123
    ds_write_b128 v122, v[124:127] offset:0
    ds_write_b128 v122, v[124:127] offset:16384
    ds_write_b128 v122, v[124:127] offset:32768
    v_add_u32 v122, 49152, v122
    ds_write_b128 v122, v[124:127] offset:0
    ds_write_b128 v122, v[124:127] offset:16384
    ds_write_b128 v122, v[124:127] offset:32768
    v_cmpx_gt_u32 vcc, 1792, v123
    ds_write_b128 v122, v[124:127] offset:49152
    s_mov_b64 exec, -1
    v_bfe_u32 v12, v14, 14, 4
    v_lshrrev_b32 v13, 18, v14
    v_and_b32 v14, 0x3fff, v14
    v_mad_u32_u24 v12, v12, s63, v13
    v_lshl_or_b32 v14, v12, 14, v14
    buffer_load_dwordx4 v[12:15], v14, s[68:71], 0 offen
    s_mov_b32 s16, s17
    s_waitcnt vmcnt(6)
    s_cmp_lg_u32 s21, 0
    s_cbranch_scc1 p2_nostat1
    v_max_u32 v60, v60, v62
    v_add_f32 v61, v61, v63
    s_nop 1
    v_max_u32_dpp v60, v60, v60 row_shr:1 row_mask:0xf bank_mask:0xf bound_ctrl:0
    v_add_f32_dpp v61, v61, v61 row_shr:1 row_mask:0xf bank_mask:0xf bound_ctrl:0
    s_nop 0
    v_max_u32_dpp v60, v60, v60 row_shr:2 row_mask:0xf bank_mask:0xf bound_ctrl:0
    v_add_f32_dpp v61, v61, v61 row_shr:2 row_mask:0xf bank_mask:0xf bound_ctrl:0
    s_nop 0
    v_max_u32_dpp v60, v60, v60 row_shr:4 row_mask:0xf bank_mask:0xf bound_ctrl:0
    v_add_f32_dpp v61, v61, v61 row_shr:4 row_mask:0xf bank_mask:0xf bound_ctrl:0
    s_nop 0
    v_max_u32_dpp v60, v60, v60 row_shr:8 row_mask:0xf bank_mask:0xf bound_ctrl:0
    v_add_f32_dpp v61, v61, v61 row_shr:8 row_mask:0xf bank_mask:0xf bound_ctrl:0
    s_nop 0
    v_max_u32_dpp v60, v60, v60 row_bcast:15 row_mask:0xa bank_mask:0xf
    v_add_f32_dpp v61, v61, v61 row_bcast:15 row_mask:0xa bank_mask:0xf
    s_nop 0
    v_max_u32_dpp v60, v60, v60 row_bcast:31 row_mask:0xc bank_mask:0xf
    v_add_f32_dpp v61, v61, v61 row_bcast:31 row_mask:0xc bank_mask:0xf
    s_nop 0
    s_nop 0
    s_lshl_b32 s44, s10, 3
    v_mov_b32 v62, s44
    s_mov_b64 exec, 1
    s_lshl_b64 exec, exec, 63
    ds_write_b64 v62, v[60:61] offset:53824
    s_mov_b64 exec, -1
p2_nostat1:
    s_waitcnt lgkmcnt(0)
    s_barrier
    v_bfe_u32 v18, v20, 14, 4
    v_lshrrev_b32 v19, 18, v20
    v_and_b32 v20, 0x3fff, v20
    v_mad_u32_u24 v18, v18, s63, v19
    v_lshl_or_b32 v20, v18, 14, v20
    buffer_load_dwordx4 v[18:21], v20, s[68:71], 0 offen
    v_mov_b32 v122, s19
    s_xor_b32 s19, s19, 4
    ds_read_b32 v125, v122 offset:53760
    s_cmp_lg_u32 s21, 0
    s_cbranch_scc1 p2_nostat2
    v_bfe_u32 v62, v112, 1, 7
    ds_read_b64 v[60:61], v62 offset:53824
    s_waitcnt lgkmcnt(0)
    s_nop 1
    v_max_u32_dpp v60, v60, v60 row_shr:1 row_mask:0xf bank_mask:0xf bound_ctrl:0
    v_add_f32_dpp v61, v61, v61 row_shr:1 row_mask:0xf bank_mask:0xf bound_ctrl:0
    s_nop 0
    v_max_u32_dpp v60, v60, v60 row_shr:2 row_mask:0xf bank_mask:0xf bound_ctrl:0
    v_add_f32_dpp v61, v61, v61 row_shr:2 row_mask:0xf bank_mask:0xf bound_ctrl:0
    s_nop 0
    v_max_u32_dpp v60, v60, v60 row_shr:4 row_mask:0xf bank_mask:0xf bound_ctrl:0
    v_add_f32_dpp v61, v61, v61 row_shr:4 row_mask:0xf bank_mask:0xf bound_ctrl:0
    s_nop 0
    v_max_u32_dpp v60, v60, v60 row_shr:8 row_mask:0xf bank_mask:0xf bound_ctrl:0
    v_add_f32_dpp v61, v61, v61 row_shr:8 row_mask:0xf bank_mask:0xf bound_ctrl:0
    s_nop 0
    v_max_u32_dpp v60, v60, v60 row_bcast:15 row_mask:0xa bank_mask:0xf
    v_add_f32_dpp v61, v61, v61 row_bcast:15 row_mask:0xa bank_mask:0xf
    s_nop 0
    v_max_u32_dpp v60, v60, v60 row_bcast:31 row_mask:0xc bank_mask:0xf
    v_add_f32_dpp v61, v61, v61 row_bcast:31 row_mask:0xc bank_mask:0xf
    s_nop 0
    s_nop 0
    v_readlane_b32 s44, v60, 15
    v_readlane_b32 s45, v61, 15
    s_nop 1
    s_lshl_b32 s44, s44, 16
    s_lshr_b32 s46, s44, 23
    s_sub_u32 s47, s46, 80
    s_cmp_lt_u32 s47, 100
    s_cselect_b32 s21, 0, 1
    v_mov_b32 v60, s45
    v_mul_f32 v60, 0x34a7c5ac, v60
    v_sqrt_f32 v60, v60
    v_mov_b32 v61, s44
    v_mul_f32 v62, 0x41800000, v60
    v_cmp_nle_f32 vcc, v61, v62
    v_mul_f32 v60, 0x3ac00000, v60
    v_mul_f32 v61, 0x3901742e, v61
    v_max_f32 v60, v60, v61
    s_cmp_lg_u64 vcc, 0
    s_cselect_b32 s21, 1, s21
    v_readfirstlane_b32 s44, v60
    s_nop 0
    s_and_b32 s47, s44, 0x7fffff
    s_or_b32 s47, s47, 0x3f000000
    s_and_b32 s48, s44, 0x7f800000
    s_add_u32 s48, s48, 0x800000
    v_rcp_f32 v60, s47
    s_nop 0
    v_rcp_f32 v61, v60
    v_mul_f32 v60, 0x7b800000, v60
    v_mul_f32 v61, s48, v61
    s_nop 0
    v_readfirstlane_b32 s26, v60
    v_readfirstlane_b32 s30, v61
    s_add_u32 s34, s48, 197132288
    s_mov_b32 s35, s34
    s_sub_u32 s36, 0, s34
    s_subb_u32 s37, 0, s34
    s_cmp_eq_u32 s21, 0
    s_cbranch_scc1 p2_nostat2
    s_waitcnt vmcnt(0) lgkmcnt(0)
    s_branch p2_restart
p2_nostat2:
    s_cmp_eq_u32 s21, 0
    s_cselect_b32 s26, s26, 0x7b800000
    v_mov_b32 v114, s26
    s_waitcnt lgkmcnt(0)
    v_readfirstlane_b32 s44, v125
    s_nop 0
    s_cmp_lg_u32 s44, 0
    s_cbranch_scc1 p2_adva
    s_mov_b32 s61, 1
    v_mov_b32 v110, v68
    v_mov_b32 v111, v69
p2_adva:
    v_bfe_u32 v86, v88, 14, 4
    v_lshrrev_b32 v87, 18, v88
    v_and_b32 v88, 0x3fff, v88
    v_mad_u32_u24 v86, v86, s63, v87
    v_lshl_or_b32 v88, v86, 14, v88
    buffer_load_dwordx4 v[86:89], v88, s[68:71], 0 offen
    s_mov_b32 m0, s23
    v_mov_b32 v53, 0x3c000
    s_movk_i32 s44, 512
    v_sub_u32_sdwa v4, v111, v110 dst_sel:DWORD dst_unused:UNUSED_PAD src0_sel:WORD_0 src1_sel:WORD_0
    v_sub_u32_sdwa v5, v111, v110 dst_sel:DWORD dst_unused:UNUSED_PAD src0_sel:WORD_1 src1_sel:WORD_1
    v_med3_i32 v4, v4, 0, s44
    v_med3_i32 v5, v5, 0, s44
    v_add_u32 v48, v4, v5
    ds_write_addtid_b32 v53 offset:0
    ds_write_addtid_b32 v53 offset:256
    ds_write_addtid_b32 v53 offset:512
    ds_write_addtid_b32 v53 offset:768
    ds_write_addtid_b32 v53 offset:1024
    ds_write_addtid_b32 v53 offset:1280
    ds_write_addtid_b32 v53 offset:1536
    ds_write_addtid_b32 v53 offset:1792
    v_bfe_i32 v53, v112, 6, 1
    v_lshrrev_b32 v49, 6, v112
    v_bitop3_b32 v53, v53, 15, s10 bitop3:0x6a
    v_lshl_or_b32 v49, v49, 4, v53
    v_and_b32 v53, 0x30, v112
    v_lshl_or_b32 v53, v49, 6, v53
    v_lshlrev_b32 v53, 15, v53
    s_nop 1
    v_add_u32_dpp v48, v48, v48 row_shr:1 row_mask:0xf bank_mask:0xf bound_ctrl:0
    s_nop 1
    v_add_u32_dpp v48, v48, v48 row_shr:2 row_mask:0xf bank_mask:0xf bound_ctrl:0
    s_nop 1
    v_add_u32_dpp v48, v48, v48 row_shr:4 row_mask:0xf bank_mask:0xf bound_ctrl:0
    s_nop 1
    v_add_u32_dpp v48, v48, v48 row_shr:8 row_mask:0xf bank_mask:0xf bound_ctrl:0
    s_nop 1
    v_add_u32_dpp v48, v48, v48 row_bcast:15 row_mask:0xa bank_mask:0xf
    s_nop 1
    v_add_u32_dpp v48, v48, v48 row_bcast:31 row_mask:0xc bank_mask:0xf
    s_nop 1
    s_nop 0
    v_readlane_b32 s38, v48, 63
    v_sub_u32 v50, v48, v5
    v_sub_u32 v49, v50, v4
    v_sub_u32 v10, 512, v49
    v_mad_u32_u16 v51, v110, 16, v53
    v_med3_i32 v10, v10, 0, v4
    v_lshl_add_u32 v49, v49, 2, s23
    v_sub_u32 v11, 512, v50
    v_mad_u32_u16 v52, v110, 16, v53 op_sel:[1,0,0,0]
    v_med3_i32 v11, v11, 0, v5
    v_lshl_add_u32 v50, v50, 2, s23
    v_lshl_add_u32 v48, v11, 16, v10
    v_add_u32 v52, 262144, v52
    v_add_u32 v110, v110, v48
    s_min_u32 s17, s38, 512
    s_add_u32 s17, s17, 63
    s_lshr_b32 s17, s17, 6
p2_xb_0:
    v_cmpx_lt_i32 vcc, 0, v10
    s_cbranch_execz p2_yb_0
    ds_write_b32 v49, v51 offset:0
    v_add_u32 v51, 16, v51
    v_cmpx_lt_i32 vcc, 1, v10
    s_cbranch_execz p2_yb_0
    ds_write_b32 v49, v51 offset:4
    v_add_u32 v51, 16, v51
    v_cmpx_lt_i32 vcc, 2, v10
    s_cbranch_execz p2_yb_0
    ds_write_b32 v49, v51 offset:8
    v_add_u32 v51, 16, v51
    v_cmpx_lt_i32 vcc, 3, v10
    s_cbranch_execz p2_yb_0
    ds_write_b32 v49, v51 offset:12
    v_add_u32 v51, 16, v51
    v_cmpx_lt_i32 vcc, 4, v10
    s_cbranch_execz p2_yb_0
    ds_write_b32 v49, v51 offset:16
    v_add_u32 v51, 16, v51
    v_cmpx_lt_i32 vcc, 5, v10
    s_cbranch_execz p2_yb_0
    ds_write_b32 v49, v51 offset:20
    v_add_u32 v51, 16, v51
    v_cmpx_lt_i32 vcc, 6, v10
    s_cbranch_execz p2_yb_0
    ds_write_b32 v49, v51 offset:24
    v_add_u32 v51, 16, v51
    v_cmpx_lt_i32 vcc, 7, v10
    s_cbranch_execz p2_yb_0
    ds_write_b32 v49, v51 offset:28
    v_add_u32 v51, 16, v51
    v_subrev_u32 v10, 8, v10
    v_add_u32 v49, 32, v49
    s_branch p2_xb_0
p2_yb_0:
    s_mov_b64 exec, -1
p2_xb_1:
    v_cmpx_lt_i32 vcc, 0, v11
    s_cbranch_execz p2_yb_1
    ds_write_b32 v50, v52 offset:0
    v_add_u32 v52, 16, v52
    v_cmpx_lt_i32 vcc, 1, v11
    s_cbranch_execz p2_yb_1
    ds_write_b32 v50, v52 offset:4
    v_add_u32 v52, 16, v52
    v_cmpx_lt_i32 vcc, 2, v11
    s_cbranch_execz p2_yb_1
    ds_write_b32 v50, v52 offset:8
    v_add_u32 v52, 16, v52
    v_cmpx_lt_i32 vcc, 3, v11
    s_cbranch_execz p2_yb_1
    ds_write_b32 v50, v52 offset:12
    v_add_u32 v52, 16, v52
    v_cmpx_lt_i32 vcc, 4, v11
    s_cbranch_execz p2_yb_1
    ds_write_b32 v50, v52 offset:16
    v_add_u32 v52, 16, v52
    v_cmpx_lt_i32 vcc, 5, v11
    s_cbranch_execz p2_yb_1
    ds_write_b32 v50, v52 offset:20
    v_add_u32 v52, 16, v52
    v_cmpx_lt_i32 vcc, 6, v11
    s_cbranch_execz p2_yb_1
    ds_write_b32 v50, v52 offset:24
    v_add_u32 v52, 16, v52
    v_cmpx_lt_i32 vcc, 7, v11
    s_cbranch_execz p2_yb_1
    ds_write_b32 v50, v52 offset:28
    v_add_u32 v52, 16, v52
    v_subrev_u32 v11, 8, v11
    v_add_u32 v50, 32, v50
    s_branch p2_xb_1
p2_yb_1:
    s_mov_b64 exec, -1
    s_cmp_lt_u32 s38, 512
    s_cbranch_scc1 p2_nomoreb
    v_cmp_lt_u32_sdwa s[44:45], v110, v111 src0_sel:WORD_0 src1_sel:WORD_0
    v_cmp_lt_u32_sdwa s[46:47], v110, v111 src0_sel:WORD_1 src1_sel:WORD_1
    s_nop 0
    s_or_b64 s[44:45], s[44:45], s[46:47]
    s_cbranch_scc0 p2_nomoreb
    v_mov_b32 v49, s19
    v_mov_b32 v50, 1
    ds_write_b32 v49, v50 offset:53760
p2_nomoreb:
    s_mov_b32 m0, s23
    s_nop 0
    ds_read_addtid_b32 v102 offset:0
    ds_read_addtid_b32 v103 offset:256
    ds_read_addtid_b32 v104 offset:512
    ds_read_addtid_b32 v105 offset:768
    ds_read_addtid_b32 v106 offset:1024
    ds_read_addtid_b32 v107 offset:1280
    ds_read_addtid_b32 v108 offset:1536
    ds_read_addtid_b32 v109 offset:1792
    v_bfe_u32 v90, v92, 14, 4
    v_lshrrev_b32 v91, 18, v92
    v_and_b32 v92, 0x3fff, v92
    v_mad_u32_u24 v90, v90, s63, v91
    v_lshl_or_b32 v92, v90, 14, v92
    buffer_load_dwordx4 v[90:93], v92, s[68:71], 0 offen
    s_waitcnt vmcnt(6)
    s_mov_b32 m0, s24
    s_cmp_ge_u32 s10, 9
    s_cbranch_scc1 p2_stp
    ds_write_addtid_b32 v84 offset:49152
    ds_write_addtid_b32 v85 offset:49408
p2_stp:
    s_mov_b32 m0, s23
    s_add_u32 s20, s20, 53760
    ds_write_addtid_b32 v72 offset:0
    ds_write_addtid_b32 v73 offset:256
    ds_write_addtid_b32 v74 offset:512
    ds_write_addtid_b32 v75 offset:768
    ds_write_addtid_b32 v76 offset:1024
    ds_write_addtid_b32 v77 offset:1280
    ds_write_addtid_b32 v78 offset:1536
    ds_write_addtid_b32 v79 offset:1792
    ds_write_addtid_b32 v80 offset:2048
    ds_write_addtid_b32 v81 offset:2304
    ds_write_addtid_b32 v82 offset:2560
    ds_write_addtid_b32 v83 offset:2816
    s_waitcnt lgkmcnt(0)
    s_barrier
    v_bfe_u32 v94, v96, 14, 4
    v_lshrrev_b32 v95, 18, v96
    v_and_b32 v96, 0x3fff, v96
    v_mad_u32_u24 v94, v94, s63, v95
    v_lshl_or_b32 v96, v94, 14, v96
    buffer_load_dwordx4 v[94:97], v96, s[68:71], 0 offen
    v_bfe_u32 v98, v100, 14, 4
    v_lshrrev_b32 v99, 18, v100
    v_and_b32 v100, 0x3fff, v100
    v_mad_u32_u24 v98, v98, s63, v99
    v_lshl_or_b32 v100, v98, 14, v100
    buffer_load_dwordx4 v[98:101], v100, s[68:71], 0 offen
    s_cmp_ge_u32 s10, 9
    s_cbranch_scc1 p2_nmq
    v_lshrrev_b32 v84, 1, v112
    s_add_u32 s44, s20, s42
    buffer_load_dwordx2 v[84:85], v84, s[4:7], s44 offen
p2_nmq:
    buffer_load_dwordx4 v[72:75], v112, s[4:7], s20 offen offset:0
    buffer_load_dwordx4 v[76:79], v112, s[4:7], s20 offen offset:1024
    buffer_load_dwordx4 v[80:83], v112, s[4:7], s20 offen offset:2048
    s_waitcnt vmcnt(10)
    v_perm_b32 v48, v3, v0, s31
    v_perm_b32 v49, v3, v1, s32
    v_perm_b32 v50, v3, v2, s33
    v_lshlrev_b16 v4, 3, v2
    v_lshlrev_b16 v2, 3, v1
    v_lshlrev_b16 v0, 3, v0
    v_cmpx_ge_u16 vcc, 0x3fff, v48
    ds_read_b64 v[0:1], v0
    s_mov_b64 exec, -1
    v_cmpx_ge_u16 vcc, 0x3fff, v49
    ds_read_b64 v[2:3], v2
    s_mov_b64 exec, -1
    v_cmpx_ge_u16 vcc, 0x3fff, v50
    ds_read_b64 v[4:5], v4
    s_mov_b64 exec, -1
    s_waitcnt vmcnt(9)
    v_perm_b32 v51, v9, v6, s31
    v_perm_b32 v52, v9, v7, s32
    v_perm_b32 v53, v9, v8, s33
    v_lshlrev_b16 v10, 3, v8
    v_lshlrev_b16 v8, 3, v7
    v_lshlrev_b16 v6, 3, v6
    v_cmpx_ge_u16 vcc, 0x3fff, v51
    ds_read_b64 v[6:7], v6
    s_mov_b64 exec, -1
    v_cmpx_ge_u16 vcc, 0x3fff, v52
    ds_read_b64 v[8:9], v8
    s_mov_b64 exec, -1
    v_cmpx_ge_u16 vcc, 0x3fff, v53
    ds_read_b64 v[10:11], v10
    s_mov_b64 exec, -1
    s_waitcnt vmcnt(8)
    v_perm_b32 v54, v15, v12, s31
    v_perm_b32 v55, v15, v13, s32
    v_perm_b32 v56, v15, v14, s33
    v_lshlrev_b16 v16, 3, v14
    v_lshlrev_b16 v14, 3, v13
    v_lshlrev_b16 v12, 3, v12
    v_cmpx_ge_u16 vcc, 0x3fff, v54
    ds_read_b64 v[12:13], v12
    s_mov_b64 exec, -1
    v_cmpx_ge_u16 vcc, 0x3fff, v55
    ds_read_b64 v[14:15], v14
    s_mov_b64 exec, -1
    v_cmpx_ge_u16 vcc, 0x3fff, v56
    ds_read_b64 v[16:17], v16
    s_mov_b64 exec, -1
    s_waitcnt vmcnt(7)
    v_perm_b32 v57, v21, v18, s31
    v_perm_b32 v58, v21, v19, s32
    v_perm_b32 v59, v21, v20, s33
    v_lshlrev_b16 v22, 3, v20
    v_lshlrev_b16 v20, 3, v19
    v_lshlrev_b16 v18, 3, v18
    v_cmpx_ge_u16 vcc, 0x3fff, v57
    ds_read_b64 v[18:19], v18
    s_mov_b64 exec, -1
    v_cmpx_ge_u16 vcc, 0x3fff, v58
    ds_read_b64 v[20:21], v20
    s_mov_b64 exec, -1
    v_cmpx_ge_u16 vcc, 0x3fff, v59
    ds_read_b64 v[22:23], v22
    s_mov_b64 exec, -1
    s_waitcnt vmcnt(6)
    v_perm_b32 v60, v89, v86, s31
    v_perm_b32 v61, v89, v87, s32
    v_perm_b32 v62, v89, v88, s33
    v_lshlrev_b16 v28, 3, v88
    v_lshlrev_b16 v26, 3, v87
    v_lshlrev_b16 v24, 3, v86
    v_cmpx_ge_u16 vcc, 0x3fff, v60
    ds_read_b64 v[24:25], v24
    s_mov_b64 exec, -1
    v_cmpx_ge_u16 vcc, 0x3fff, v61
    ds_read_b64 v[26:27], v26
    s_mov_b64 exec, -1
    v_cmpx_ge_u16 vcc, 0x3fff, v62
    ds_read_b64 v[28:29], v28
    s_mov_b64 exec, -1
    v_bfe_u32 v86, v106, 14, 4
    v_lshrrev_b32 v87, 18, v106
    v_and_b32 v106, 0x3fff, v106
    v_mad_u32_u24 v86, v86, s63, v87
    v_lshl_or_b32 v106, v86, 14, v106
    buffer_load_dwordx4 v[86:89], v106, s[68:71], 0 offen
    s_waitcnt vmcnt(6)
    v_perm_b32 v63, v93, v90, s31
    v_perm_b32 v64, v93, v91, s32
    v_perm_b32 v65, v93, v92, s33
    v_lshlrev_b16 v34, 3, v92
    v_lshlrev_b16 v32, 3, v91
    v_lshlrev_b16 v30, 3, v90
    v_cmpx_ge_u16 vcc, 0x3fff, v63
    ds_read_b64 v[30:31], v30
    s_mov_b64 exec, -1
    v_cmpx_ge_u16 vcc, 0x3fff, v64
    ds_read_b64 v[32:33], v32
    s_mov_b64 exec, -1
    v_cmpx_ge_u16 vcc, 0x3fff, v65
    ds_read_b64 v[34:35], v34
    s_mov_b64 exec, -1
    v_bfe_u32 v90, v107, 14, 4
    v_lshrrev_b32 v91, 18, v107
    v_and_b32 v107, 0x3fff, v107
    v_mad_u32_u24 v90, v90, s63, v91
    v_lshl_or_b32 v107, v90, 14, v107
    buffer_load_dwordx4 v[90:93], v107, s[68:71], 0 offen
    s_waitcnt vmcnt(6)
    v_perm_b32 v66, v97, v94, s31
    v_perm_b32 v67, v97, v95, s32
    v_perm_b32 v68, v97, v96, s33
    v_lshlrev_b16 v40, 3, v96
    v_lshlrev_b16 v38, 3, v95
    v_lshlrev_b16 v36, 3, v94
    v_cmpx_ge_u16 vcc, 0x3fff, v66
    ds_read_b64 v[36:37], v36
    s_mov_b64 exec, -1
    v_cmpx_ge_u16 vcc, 0x3fff, v67
    ds_read_b64 v[38:39], v38
    s_mov_b64 exec, -1
    v_cmpx_ge_u16 vcc, 0x3fff, v68
    ds_read_b64 v[40:41], v40
    s_mov_b64 exec, -1
    s_waitcnt vmcnt(5)
    v_perm_b32 v69, v101, v98, s31
    v_perm_b32 v70, v101, v99, s32
    v_perm_b32 v71, v101, v100, s33
    v_lshlrev_b16 v46, 3, v100
    v_lshlrev_b16 v44, 3, v99
    v_lshlrev_b16 v42, 3, v98
    s_cmp_le_u32 s16, 7
    s_cbranch_scc1 p2_gp
    v_cmpx_ge_u16 vcc, 0x3fff, v69
    ds_read_b64 v[42:43], v42
    s_mov_b64 exec, -1
    v_cmpx_ge_u16 vcc, 0x3fff, v70
    ds_read_b64 v[44:45], v44
    s_mov_b64 exec, -1
    v_cmpx_ge_u16 vcc, 0x3fff, v71
    ds_read_b64 v[46:47], v46
    s_mov_b64 exec, -1
p2_gp:
    s_waitcnt lgkmcnt(0)
    s_barrier
    s_branch p2_tail
p2_top:
    s_cmp_lg_u32 s21, 0
    s_cbranch_scc1 p2_topf
    s_cmp_eq_u32 s60, 10
    s_cbranch_scc1 p2_drain0
    s_setprio 3
    v_cmpx_gt_i16 vcc, 0, v48
    ds_read_b64 v[0:1], v0
    s_mov_b64 exec, -1
    v_cmpx_gt_i16 vcc, 0, v49
    ds_read_b64 v[2:3], v2
    s_mov_b64 exec, -1
    v_cmpx_gt_i16 vcc, 0, v50
    ds_read_b64 v[4:5], v4
    s_mov_b64 exec, -1
    v_cmpx_gt_i16 vcc, 0, v51
    ds_read_b64 v[6:7], v6
    s_mov_b64 exec, -1
    v_cmpx_gt_i16 vcc, 0, v52
    ds_read_b64 v[8:9], v8
    s_mov_b64 exec, -1
    v_cmpx_gt_i16 vcc, 0, v53
    ds_read_b64 v[10:11], v10
    s_mov_b64 exec, -1
    v_cmpx_gt_i16 vcc, 0, v54
    ds_read_b64 v[12:13], v12
    s_mov_b64 exec, -1
    v_cmpx_gt_i16 vcc, 0, v55
    ds_read_b64 v[14:15], v14
    s_mov_b64 exec, -1
    v_cmpx_gt_i16 vcc, 0, v56
    ds_read_b64 v[16:17], v16
    s_mov_b64 exec, -1
    v_cmpx_gt_i16 vcc, 0, v57
    ds_read_b64 v[18:19], v18
    s_mov_b64 exec, -1
    v_cmpx_gt_i16 vcc, 0, v58
    ds_read_b64 v[20:21], v20
    s_mov_b64 exec, -1
    v_cmpx_gt_i16 vcc, 0, v59
    ds_read_b64 v[22:23], v22
    s_mov_b64 exec, -1
    s_cmp_ge_u32 s10, 9
    s_cbranch_scc1 p2_nm0m0a
    v_lshrrev_b32 v84, 1, v112
    s_add_u32 s44, s20, s42
    buffer_load_dwordx2 v[84:85], v84, s[4:7], s44 offen
p2_nm0m0a:
    buffer_load_dwordx4 v[72:75], v112, s[4:7], s20 offen offset:0
    buffer_load_dwordx4 v[76:79], v112, s[4:7], s20 offen offset:1024
    buffer_load_dwordx4 v[80:83], v112, s[4:7], s20 offen offset:2048
    v_cmpx_gt_i16 vcc, 0, v60
    ds_read_b64 v[24:25], v24
    s_mov_b64 exec, -1
    v_cmpx_gt_i16 vcc, 0, v61
    ds_read_b64 v[26:27], v26
    s_mov_b64 exec, -1
    v_cmpx_gt_i16 vcc, 0, v62
    ds_read_b64 v[28:29], v28
    s_mov_b64 exec, -1
    v_cmpx_gt_i16 vcc, 0, v63
    ds_read_b64 v[30:31], v30
    s_mov_b64 exec, -1
    v_cmpx_gt_i16 vcc, 0, v64
    ds_read_b64 v[32:33], v32
    s_mov_b64 exec, -1
    v_cmpx_gt_i16 vcc, 0, v65
    ds_read_b64 v[34:35], v34
    s_mov_b64 exec, -1
    v_cmpx_gt_i16 vcc, 0, v66
    ds_read_b64 v[36:37], v36
    s_mov_b64 exec, -1
    v_cmpx_gt_i16 vcc, 0, v67
    ds_read_b64 v[38:39], v38
    s_mov_b64 exec, -1
    v_cmpx_gt_i16 vcc, 0, v68
    ds_read_b64 v[40:41], v40
    s_mov_b64 exec, -1
    s_cmp_le_u32 s15, 7
    s_cbranch_scc1 p2_g0r27
    v_cmpx_gt_i16 vcc, 0, v69
    ds_read_b64 v[42:43], v42
    s_mov_b64 exec, -1
    v_cmpx_gt_i16 vcc, 0, v70
    ds_read_b64 v[44:45], v44
    s_mov_b64 exec, -1
    v_cmpx_gt_i16 vcc, 0, v71
    ds_read_b64 v[46:47], v46
    s_mov_b64 exec, -1
p2_g0r27:
    s_setprio 2
    s_waitcnt lgkmcnt(15)
    v_ashrrev_i32 v122, 5, v48
    v_lshlrev_b16 v123, 2, v48
    v_lshlrev_b32 v124, 16, v0
    v_bitop3_b32 v122, v122, v113, v113 bitop3:0x0c
    v_and_b32 v125, 0xffff0000, v0
    v_lshlrev_b32 v126, 16, v1
    v_mul_f32 v122, v114, v122
    v_and_b32 v127, 0xffff0000, v1
    v_add_u32 v123, v123, v123
    v_pk_fma_f32 v[124:125], v[124:125], v[122:123], s[34:35] op_sel_hi:[1,0,1]
    v_pk_fma_f32 v[126:127], v[126:127], v[122:123], s[34:35] op_sel_hi:[1,0,1]
    v_lshl_add_u32 v124, v125, 16, v124
    v_lshl_add_u32 v125, v127, 16, v126
    s_waitcnt lgkmcnt(15)
    v_bitop3_b32 v115, v115, v116, v117 bitop3:0xfe
    v_lshl_add_u64 v[124:125], v[124:125], 0, s[36:37]
    v_cmpx_le_u32 vcc, 0x1000000, v48
    ds_add_rtn_u64 v[116:117], v123, v[124:125] offset:54272
    s_mov_b64 exec, -1
    v_ashrrev_i32 v122, 5, v49
    v_lshlrev_b16 v123, 2, v49
    v_lshlrev_b32 v124, 16, v2
    v_bitop3_b32 v122, v122, v113, v113 bitop3:0x0c
    v_and_b32 v125, 0xffff0000, v2
    v_lshlrev_b32 v126, 16, v3
    v_mul_f32 v122, v114, v122
    v_and_b32 v127, 0xffff0000, v3
    v_add_u32 v123, v123, v123
    v_pk_fma_f32 v[124:125], v[124:125], v[122:123], s[34:35] op_sel_hi:[1,0,1]
    v_pk_fma_f32 v[126:127], v[126:127], v[122:123], s[34:35] op_sel_hi:[1,0,1]
    v_lshl_add_u32 v124, v125, 16, v124
    v_lshl_add_u32 v125, v127, 16, v126
    s_waitcnt lgkmcnt(15)
    v_bitop3_b32 v115, v115, v118, v119 bitop3:0xfe
    v_lshl_add_u64 v[124:125], v[124:125], 0, s[36:37]
    v_cmpx_le_u32 vcc, 0x1000000, v49
    ds_add_rtn_u64 v[118:119], v123, v[124:125] offset:54272
    s_mov_b64 exec, -1
    v_ashrrev_i32 v122, 5, v50
    v_lshlrev_b16 v123, 2, v50
    v_lshlrev_b32 v124, 16, v4
    v_bitop3_b32 v122, v122, v113, v113 bitop3:0x0c
    v_and_b32 v125, 0xffff0000, v4
    v_lshlrev_b32 v126, 16, v5
    v_mul_f32 v122, v114, v122
    v_and_b32 v127, 0xffff0000, v5
    v_add_u32 v123, v123, v123
    v_pk_fma_f32 v[124:125], v[124:125], v[122:123], s[34:35] op_sel_hi:[1,0,1]
    v_pk_fma_f32 v[126:127], v[126:127], v[122:123], s[34:35] op_sel_hi:[1,0,1]
    v_lshl_add_u32 v124, v125, 16, v124
    v_lshl_add_u32 v125, v127, 16, v126
    s_waitcnt lgkmcnt(15)
    v_bitop3_b32 v115, v115, v120, v121 bitop3:0xfe
    v_lshl_add_u64 v[124:125], v[124:125], 0, s[36:37]
    v_cmpx_le_u32 vcc, 0x1000000, v50
    ds_add_rtn_u64 v[120:121], v123, v[124:125] offset:54272
    s_mov_b64 exec, -1
    v_bfe_u32 v0, v102, 14, 4
    v_lshrrev_b32 v1, 18, v102
    v_and_b32 v102, 0x3fff, v102
    v_mad_u32_u24 v0, v0, s63, v1
    v_lshl_or_b32 v102, v0, 14, v102
    buffer_load_dwordx4 v[0:3], v102, s[68:71], 0 offen
    s_setprio 1
    s_waitcnt lgkmcnt(15)
    v_ashrrev_i32 v122, 5, v51
    v_lshlrev_b16 v123, 2, v51
    v_lshlrev_b32 v124, 16, v6
    v_bitop3_b32 v122, v122, v113, v113 bitop3:0x0c
    v_and_b32 v125, 0xffff0000, v6
    v_lshlrev_b32 v126, 16, v7
    v_mul_f32 v122, v114, v122
    v_and_b32 v127, 0xffff0000, v7
    v_add_u32 v123, v123, v123
    v_pk_fma_f32 v[124:125], v[124:125], v[122:123], s[34:35] op_sel_hi:[1,0,1]
    v_pk_fma_f32 v[126:127], v[126:127], v[122:123], s[34:35] op_sel_hi:[1,0,1]
    v_lshl_add_u32 v124, v125, 16, v124
    v_lshl_add_u32 v125, v127, 16, v126
    s_waitcnt lgkmcnt(2)
    v_bitop3_b32 v115, v115, v116, v117 bitop3:0xfe
    v_lshl_add_u64 v[124:125], v[124:125], 0, s[36:37]
    v_cmpx_le_u32 vcc, 0x1000000, v51
    ds_add_rtn_u64 v[116:117], v123, v[124:125] offset:54272
    s_mov_b64 exec, -1
    v_ashrrev_i32 v122, 5, v52
    v_lshlrev_b16 v123, 2, v52
    v_lshlrev_b32 v124, 16, v8
    v_bitop3_b32 v122, v122, v113, v113 bitop3:0x0c
    v_and_b32 v125, 0xffff0000, v8
    v_lshlrev_b32 v126, 16, v9
    v_mul_f32 v122, v114, v122
    v_and_b32 v127, 0xffff0000, v9
    v_add_u32 v123, v123, v123
    v_pk_fma_f32 v[124:125], v[124:125], v[122:123], s[34:35] op_sel_hi:[1,0,1]
    v_pk_fma_f32 v[126:127], v[126:127], v[122:123], s[34:35] op_sel_hi:[1,0,1]
    v_lshl_add_u32 v124, v125, 16, v124
    v_lshl_add_u32 v125, v127, 16, v126
    s_waitcnt lgkmcnt(2)
    v_bitop3_b32 v115, v115, v118, v119 bitop3:0xfe
    v_lshl_add_u64 v[124:125], v[124:125], 0, s[36:37]
    v_cmpx_le_u32 vcc, 0x1000000, v52
    ds_add_rtn_u64 v[118:119], v123, v[124:125] offset:54272
    s_mov_b64 exec, -1
    v_ashrrev_i32 v122, 5, v53
    v_lshlrev_b16 v123, 2, v53
    v_lshlrev_b32 v124, 16, v10
    v_bitop3_b32 v122, v122, v113, v113 bitop3:0x0c
    v_and_b32 v125, 0xffff0000, v10
    v_lshlrev_b32 v126, 16, v11
    v_mul_f32 v122, v114, v122
    v_and_b32 v127, 0xffff0000, v11
    v_add_u32 v123, v123, v123
    v_pk_fma_f32 v[124:125], v[124:125], v[122:123], s[34:35] op_sel_hi:[1,0,1]
    v_pk_fma_f32 v[126:127], v[126:127], v[122:123], s[34:35] op_sel_hi:[1,0,1]
    v_lshl_add_u32 v124, v125, 16, v124
    v_lshl_add_u32 v125, v127, 16, v126
    s_waitcnt lgkmcnt(2)
    v_bitop3_b32 v115, v115, v120, v121 bitop3:0xfe
    v_lshl_add_u64 v[124:125], v[124:125], 0, s[36:37]
    v_cmpx_le_u32 vcc, 0x1000000, v53
    ds_add_rtn_u64 v[120:121], v123, v[124:125] offset:54272
    s_mov_b64 exec, -1
    v_bfe_u32 v6, v103, 14, 4
    v_lshrrev_b32 v7, 18, v103
    v_and_b32 v103, 0x3fff, v103
    v_mad_u32_u24 v6, v6, s63, v7
    v_lshl_or_b32 v103, v6, 14, v103
    buffer_load_dwordx4 v[6:9], v103, s[68:71], 0 offen
    s_waitcnt lgkmcnt(6)
    s_barrier
    s_setprio 3
    s_waitcnt vmcnt(6)
    s_mov_b32 m0, s23
    v_mov_b32 v53, 0x3c000
    s_movk_i32 s44, 512
    v_sub_u32_sdwa v4, v111, v110 dst_sel:DWORD dst_unused:UNUSED_PAD src0_sel:WORD_0 src1_sel:WORD_0
    v_sub_u32_sdwa v5, v111, v110 dst_sel:DWORD dst_unused:UNUSED_PAD src0_sel:WORD_1 src1_sel:WORD_1
    v_med3_i32 v4, v4, 0, s44
    v_med3_i32 v5, v5, 0, s44
    v_add_u32 v48, v4, v5
    ds_write_addtid_b32 v53 offset:0
    ds_write_addtid_b32 v53 offset:256
    ds_write_addtid_b32 v53 offset:512
    ds_write_addtid_b32 v53 offset:768
    ds_write_addtid_b32 v53 offset:1024
    ds_write_addtid_b32 v53 offset:1280
    ds_write_addtid_b32 v53 offset:1536
    ds_write_addtid_b32 v53 offset:1792
    v_bfe_i32 v53, v112, 6, 1
    v_lshrrev_b32 v49, 6, v112
    v_bitop3_b32 v53, v53, 15, s10 bitop3:0x6a
    v_lshl_or_b32 v49, v49, 4, v53
    v_and_b32 v53, 0x30, v112
    v_lshl_or_b32 v53, v49, 6, v53
    v_lshlrev_b32 v53, 15, v53
    s_nop 1
    v_add_u32_dpp v48, v48, v48 row_shr:1 row_mask:0xf bank_mask:0xf bound_ctrl:0
    s_nop 1
    v_add_u32_dpp v48, v48, v48 row_shr:2 row_mask:0xf bank_mask:0xf bound_ctrl:0
    s_nop 1
    v_add_u32_dpp v48, v48, v48 row_shr:4 row_mask:0xf bank_mask:0xf bound_ctrl:0
    s_nop 1
    v_add_u32_dpp v48, v48, v48 row_shr:8 row_mask:0xf bank_mask:0xf bound_ctrl:0
    s_nop 1
    v_add_u32_dpp v48, v48, v48 row_bcast:15 row_mask:0xa bank_mask:0xf
    s_nop 1
    v_add_u32_dpp v48, v48, v48 row_bcast:31 row_mask:0xc bank_mask:0xf
    s_nop 1
    s_nop 0
    v_readlane_b32 s38, v48, 63
    v_sub_u32 v50, v48, v5
    v_sub_u32 v49, v50, v4
    v_sub_u32 v10, 512, v49
    v_mad_u32_u16 v51, v110, 16, v53
    v_med3_i32 v10, v10, 0, v4
    v_lshl_add_u32 v49, v49, 2, s23
    v_sub_u32 v11, 512, v50
    v_mad_u32_u16 v52, v110, 16, v53 op_sel:[1,0,0,0]
    v_med3_i32 v11, v11, 0, v5
    v_lshl_add_u32 v50, v50, 2, s23
    v_lshl_add_u32 v48, v11, 16, v10
    v_add_u32 v52, 262144, v52
    v_add_u32 v110, v110, v48
    s_min_u32 s17, s38, 512
    s_add_u32 s17, s17, 63
    s_lshr_b32 s17, s17, 6
p2_x0x_0:
    v_cmpx_lt_i32 vcc, 0, v10
    s_cbranch_execz p2_y0x_0
    ds_write_b32 v49, v51 offset:0
    v_add_u32 v51, 16, v51
    v_cmpx_lt_i32 vcc, 1, v10
    s_cbranch_execz p2_y0x_0
    ds_write_b32 v49, v51 offset:4
    v_add_u32 v51, 16, v51
    v_cmpx_lt_i32 vcc, 2, v10
    s_cbranch_execz p2_y0x_0
    ds_write_b32 v49, v51 offset:8
    v_add_u32 v51, 16, v51
    v_cmpx_lt_i32 vcc, 3, v10
    s_cbranch_execz p2_y0x_0
    ds_write_b32 v49, v51 offset:12
    v_add_u32 v51, 16, v51
    v_cmpx_lt_i32 vcc, 4, v10
    s_cbranch_execz p2_y0x_0
    ds_write_b32 v49, v51 offset:16
    v_add_u32 v51, 16, v51
    v_cmpx_lt_i32 vcc, 5, v10
    s_cbranch_execz p2_y0x_0
    ds_write_b32 v49, v51 offset:20
    v_add_u32 v51, 16, v51
    v_cmpx_lt_i32 vcc, 6, v10
    s_cbranch_execz p2_y0x_0
    ds_write_b32 v49, v51 offset:24
    v_add_u32 v51, 16, v51
    v_cmpx_lt_i32 vcc, 7, v10
    s_cbranch_execz p2_y0x_0
    ds_write_b32 v49, v51 offset:28
    v_add_u32 v51, 16, v51
    v_subrev_u32 v10, 8, v10
    v_add_u32 v49, 32, v49
    s_branch p2_x0x_0
p2_y0x_0:
    s_mov_b64 exec, -1
p2_x0x_1:
    v_cmpx_lt_i32 vcc, 0, v11
    s_cbranch_execz p2_y0x_1
    ds_write_b32 v50, v52 offset:0
    v_add_u32 v52, 16, v52
    v_cmpx_lt_i32 vcc, 1, v11
    s_cbranch_execz p2_y0x_1
    ds_write_b32 v50, v52 offset:4
    v_add_u32 v52, 16, v52
    v_cmpx_lt_i32 vcc, 2, v11
    s_cbranch_execz p2_y0x_1
    ds_write_b32 v50, v52 offset:8
    v_add_u32 v52, 16, v52
    v_cmpx_lt_i32 vcc, 3, v11
    s_cbranch_execz p2_y0x_1
    ds_write_b32 v50, v52 offset:12
    v_add_u32 v52, 16, v52
    v_cmpx_lt_i32 vcc, 4, v11
    s_cbranch_execz p2_y0x_1
    ds_write_b32 v50, v52 offset:16
    v_add_u32 v52, 16, v52
    v_cmpx_lt_i32 vcc, 5, v11
    s_cbranch_execz p2_y0x_1
    ds_write_b32 v50, v52 offset:20
    v_add_u32 v52, 16, v52
    v_cmpx_lt_i32 vcc, 6, v11
    s_cbranch_execz p2_y0x_1
    ds_write_b32 v50, v52 offset:24
    v_add_u32 v52, 16, v52
    v_cmpx_lt_i32 vcc, 7, v11
    s_cbranch_execz p2_y0x_1
    ds_write_b32 v50, v52 offset:28
    v_add_u32 v52, 16, v52
    v_subrev_u32 v11, 8, v11
    v_add_u32 v50, 32, v50
    s_branch p2_x0x_1
p2_y0x_1:
    s_mov_b64 exec, -1
    s_cmp_lt_u32 s38, 512
    s_cbranch_scc1 p2_nomore0x
    v_cmp_lt_u32_sdwa s[44:45], v110, v111 src0_sel:WORD_0 src1_sel:WORD_0
    v_cmp_lt_u32_sdwa s[46:47], v110, v111 src0_sel:WORD_1 src1_sel:WORD_1
    s_nop 0
    s_or_b64 s[44:45], s[44:45], s[46:47]
    s_cbranch_scc0 p2_nomore0x
    v_mov_b32 v49, s19
    v_mov_b32 v50, 1
    ds_write_b32 v49, v50 offset:53760
p2_nomore0x:
    s_setprio 2
    s_waitcnt lgkmcnt(15)
    v_ashrrev_i32 v122, 5, v54
    v_lshlrev_b16 v123, 2, v54
    v_lshlrev_b32 v124, 16, v12
    v_bitop3_b32 v122, v122, v113, v113 bitop3:0x0c
    v_and_b32 v125, 0xffff0000, v12
    v_lshlrev_b32 v126, 16, v13
    v_mul_f32 v122, v114, v122
    v_and_b32 v127, 0xffff0000, v13
    v_add_u32 v123, v123, v123
    v_pk_fma_f32 v[124:125], v[124:125], v[122:123], s[34:35] op_sel_hi:[1,0,1]
    v_pk_fma_f32 v[126:127], v[126:127], v[122:123], s[34:35] op_sel_hi:[1,0,1]
    v_lshl_add_u32 v124, v125, 16, v124
    v_lshl_add_u32 v125, v127, 16, v126
    s_waitcnt lgkmcnt(10)
    v_bitop3_b32 v115, v115, v116, v117 bitop3:0xfe
    v_lshl_add_u64 v[124:125], v[124:125], 0, s[36:37]
    v_cmpx_le_u32 vcc, 0x1000000, v54
    ds_add_rtn_u64 v[116:117], v123, v[124:125] offset:54272
    s_mov_b64 exec, -1
    v_ashrrev_i32 v122, 5, v55
    v_lshlrev_b16 v123, 2, v55
    v_lshlrev_b32 v124, 16, v14
    v_bitop3_b32 v122, v122, v113, v113 bitop3:0x0c
    v_and_b32 v125, 0xffff0000, v14
    v_lshlrev_b32 v126, 16, v15
    v_mul_f32 v122, v114, v122
    v_and_b32 v127, 0xffff0000, v15
    v_add_u32 v123, v123, v123
    v_pk_fma_f32 v[124:125], v[124:125], v[122:123], s[34:35] op_sel_hi:[1,0,1]
    v_pk_fma_f32 v[126:127], v[126:127], v[122:123], s[34:35] op_sel_hi:[1,0,1]
    v_lshl_add_u32 v124, v125, 16, v124
    v_lshl_add_u32 v125, v127, 16, v126
    s_waitcnt lgkmcnt(10)
    v_bitop3_b32 v115, v115, v118, v119 bitop3:0xfe
    v_lshl_add_u64 v[124:125], v[124:125], 0, s[36:37]
    v_cmpx_le_u32 vcc, 0x1000000, v55
    ds_add_rtn_u64 v[118:119], v123, v[124:125] offset:54272
    s_mov_b64 exec, -1
    v_ashrrev_i32 v122, 5, v56
    v_lshlrev_b16 v123, 2, v56
    v_lshlrev_b32 v124, 16, v16
    v_bitop3_b32 v122, v122, v113, v113 bitop3:0x0c
    v_and_b32 v125, 0xffff0000, v16
    v_lshlrev_b32 v126, 16, v17
    v_mul_f32 v122, v114, v122
    v_and_b32 v127, 0xffff0000, v17
    v_add_u32 v123, v123, v123
    v_pk_fma_f32 v[124:125], v[124:125], v[122:123], s[34:35] op_sel_hi:[1,0,1]
    v_pk_fma_f32 v[126:127], v[126:127], v[122:123], s[34:35] op_sel_hi:[1,0,1]
    v_lshl_add_u32 v124, v125, 16, v124
    v_lshl_add_u32 v125, v127, 16, v126
    s_waitcnt lgkmcnt(10)
    v_bitop3_b32 v115, v115, v120, v121 bitop3:0xfe
    v_lshl_add_u64 v[124:125], v[124:125], 0, s[36:37]
    v_cmpx_le_u32 vcc, 0x1000000, v56
    ds_add_rtn_u64 v[120:121], v123, v[124:125] offset:54272
    s_mov_b64 exec, -1
    v_bfe_u32 v12, v104, 14, 4
    v_lshrrev_b32 v13, 18, v104
    v_and_b32 v104, 0x3fff, v104
    v_mad_u32_u24 v12, v12, s63, v13
    v_lshl_or_b32 v104, v12, 14, v104
    buffer_load_dwordx4 v[12:15], v104, s[68:71], 0 offen
    s_setprio 1
    s_waitcnt lgkmcnt(15)
    v_ashrrev_i32 v122, 5, v57
    v_lshlrev_b16 v123, 2, v57
    v_lshlrev_b32 v124, 16, v18
    v_bitop3_b32 v122, v122, v113, v113 bitop3:0x0c
    v_and_b32 v125, 0xffff0000, v18
    v_lshlrev_b32 v126, 16, v19
    v_mul_f32 v122, v114, v122
    v_and_b32 v127, 0xffff0000, v19
    v_add_u32 v123, v123, v123
    v_pk_fma_f32 v[124:125], v[124:125], v[122:123], s[34:35] op_sel_hi:[1,0,1]
    v_pk_fma_f32 v[126:127], v[126:127], v[122:123], s[34:35] op_sel_hi:[1,0,1]
    v_lshl_add_u32 v124, v125, 16, v124
    v_lshl_add_u32 v125, v127, 16, v126
    s_waitcnt lgkmcnt(2)
    v_bitop3_b32 v115, v115, v116, v117 bitop3:0xfe
    v_lshl_add_u64 v[124:125], v[124:125], 0, s[36:37]
    v_cmpx_le_u32 vcc, 0x1000000, v57
    ds_add_rtn_u64 v[116:117], v123, v[124:125] offset:54272
    s_mov_b64 exec, -1
    v_ashrrev_i32 v122, 5, v58
    v_lshlrev_b16 v123, 2, v58
    v_lshlrev_b32 v124, 16, v20
    v_bitop3_b32 v122, v122, v113, v113 bitop3:0x0c
    v_and_b32 v125, 0xffff0000, v20
    v_lshlrev_b32 v126, 16, v21
    v_mul_f32 v122, v114, v122
    v_and_b32 v127, 0xffff0000, v21
    v_add_u32 v123, v123, v123
    v_pk_fma_f32 v[124:125], v[124:125], v[122:123], s[34:35] op_sel_hi:[1,0,1]
    v_pk_fma_f32 v[126:127], v[126:127], v[122:123], s[34:35] op_sel_hi:[1,0,1]
    v_lshl_add_u32 v124, v125, 16, v124
    v_lshl_add_u32 v125, v127, 16, v126
    s_waitcnt lgkmcnt(2)
    v_bitop3_b32 v115, v115, v118, v119 bitop3:0xfe
    v_lshl_add_u64 v[124:125], v[124:125], 0, s[36:37]
    v_cmpx_le_u32 vcc, 0x1000000, v58
    ds_add_rtn_u64 v[118:119], v123, v[124:125] offset:54272
    s_mov_b64 exec, -1
    v_ashrrev_i32 v122, 5, v59
    v_lshlrev_b16 v123, 2, v59
    v_lshlrev_b32 v124, 16, v22
    v_bitop3_b32 v122, v122, v113, v113 bitop3:0x0c
    v_and_b32 v125, 0xffff0000, v22
    v_lshlrev_b32 v126, 16, v23
    v_mul_f32 v122, v114, v122
    v_and_b32 v127, 0xffff0000, v23
    v_add_u32 v123, v123, v123
    v_pk_fma_f32 v[124:125], v[124:125], v[122:123], s[34:35] op_sel_hi:[1,0,1]
    v_pk_fma_f32 v[126:127], v[126:127], v[122:123], s[34:35] op_sel_hi:[1,0,1]
    v_lshl_add_u32 v124, v125, 16, v124
    v_lshl_add_u32 v125, v127, 16, v126
    s_waitcnt lgkmcnt(2)
    v_bitop3_b32 v115, v115, v120, v121 bitop3:0xfe
    v_lshl_add_u64 v[124:125], v[124:125], 0, s[36:37]
    v_cmpx_le_u32 vcc, 0x1000000, v59
    ds_add_rtn_u64 v[120:121], v123, v[124:125] offset:54272
    s_mov_b64 exec, -1
    v_bfe_u32 v18, v105, 14, 4
    v_lshrrev_b32 v19, 18, v105
    v_and_b32 v105, 0x3fff, v105
    v_mad_u32_u24 v18, v18, s63, v19
    v_lshl_or_b32 v105, v18, 14, v105
    buffer_load_dwordx4 v[18:21], v105, s[68:71], 0 offen
    s_mov_b32 m0, s23
    s_nop 0
    ds_read_addtid_b32 v102 offset:0
    ds_read_addtid_b32 v103 offset:256
    ds_read_addtid_b32 v104 offset:512
    ds_read_addtid_b32 v105 offset:768
    ds_read_addtid_b32 v106 offset:1024
    ds_read_addtid_b32 v107 offset:1280
    ds_read_addtid_b32 v108 offset:1536
    ds_read_addtid_b32 v109 offset:1792
    s_waitcnt vmcnt(4)
    s_mov_b32 m0, s24
    s_cmp_ge_u32 s10, 9
    s_cbranch_scc1 p2_st0s0
    ds_write_addtid_b32 v84 offset:49152
    ds_write_addtid_b32 v85 offset:49408
p2_st0s0:
    s_mov_b32 m0, s23
    s_add_u32 s20, s20, 53760
    ds_write_addtid_b32 v72 offset:0
    ds_write_addtid_b32 v73 offset:256
    ds_write_addtid_b32 v74 offset:512
    ds_write_addtid_b32 v75 offset:768
    ds_write_addtid_b32 v76 offset:1024
    ds_write_addtid_b32 v77 offset:1280
    ds_write_addtid_b32 v78 offset:1536
    ds_write_addtid_b32 v79 offset:1792
    ds_write_addtid_b32 v80 offset:2048
    ds_write_addtid_b32 v81 offset:2304
    ds_write_addtid_b32 v82 offset:2560
    ds_write_addtid_b32 v83 offset:2816
    s_setprio 0
    s_waitcnt lgkmcnt(15)
    v_ashrrev_i32 v122, 5, v60
    v_lshlrev_b16 v123, 2, v60
    v_lshlrev_b32 v124, 16, v24
    v_bitop3_b32 v122, v122, v113, v113 bitop3:0x0c
    v_and_b32 v125, 0xffff0000, v24
    v_lshlrev_b32 v126, 16, v25
    v_mul_f32 v122, v114, v122
    v_and_b32 v127, 0xffff0000, v25
    v_add_u32 v123, v123, v123
    v_pk_fma_f32 v[124:125], v[124:125], v[122:123], s[34:35] op_sel_hi:[1,0,1]
    v_pk_fma_f32 v[126:127], v[126:127], v[122:123], s[34:35] op_sel_hi:[1,0,1]
    v_lshl_add_u32 v124, v125, 16, v124
    v_lshl_add_u32 v125, v127, 16, v126
    s_waitcnt lgkmcnt(15)
    v_bitop3_b32 v115, v115, v116, v117 bitop3:0xfe
    v_lshl_add_u64 v[124:125], v[124:125], 0, s[36:37]
    v_cmpx_le_u32 vcc, 0x1000000, v60
    ds_add_rtn_u64 v[116:117], v123, v[124:125] offset:54272
    s_mov_b64 exec, -1
    v_ashrrev_i32 v122, 5, v61
    v_lshlrev_b16 v123, 2, v61
    v_lshlrev_b32 v124, 16, v26
    v_bitop3_b32 v122, v122, v113, v113 bitop3:0x0c
    v_and_b32 v125, 0xffff0000, v26
    v_lshlrev_b32 v126, 16, v27
    v_mul_f32 v122, v114, v122
    v_and_b32 v127, 0xffff0000, v27
    v_add_u32 v123, v123, v123
    v_pk_fma_f32 v[124:125], v[124:125], v[122:123], s[34:35] op_sel_hi:[1,0,1]
    v_pk_fma_f32 v[126:127], v[126:127], v[122:123], s[34:35] op_sel_hi:[1,0,1]
    v_lshl_add_u32 v124, v125, 16, v124
    v_lshl_add_u32 v125, v127, 16, v126
    s_waitcnt lgkmcnt(15)
    v_bitop3_b32 v115, v115, v118, v119 bitop3:0xfe
    v_lshl_add_u64 v[124:125], v[124:125], 0, s[36:37]
    v_cmpx_le_u32 vcc, 0x1000000, v61
    ds_add_rtn_u64 v[118:119], v123, v[124:125] offset:54272
    s_mov_b64 exec, -1
    v_ashrrev_i32 v122, 5, v62
    v_lshlrev_b16 v123, 2, v62
    v_lshlrev_b32 v124, 16, v28
    v_bitop3_b32 v122, v122, v113, v113 bitop3:0x0c
    v_and_b32 v125, 0xffff0000, v28
    v_lshlrev_b32 v126, 16, v29
    v_mul_f32 v122, v114, v122
    v_and_b32 v127, 0xffff0000, v29
    v_add_u32 v123, v123, v123
    v_pk_fma_f32 v[124:125], v[124:125], v[122:123], s[34:35] op_sel_hi:[1,0,1]
    v_pk_fma_f32 v[126:127], v[126:127], v[122:123], s[34:35] op_sel_hi:[1,0,1]
    v_lshl_add_u32 v124, v125, 16, v124
    v_lshl_add_u32 v125, v127, 16, v126
    s_waitcnt lgkmcnt(15)
    v_bitop3_b32 v115, v115, v120, v121 bitop3:0xfe
    v_lshl_add_u64 v[124:125], v[124:125], 0, s[36:37]
    v_cmpx_le_u32 vcc, 0x1000000, v62
    ds_add_rtn_u64 v[120:121], v123, v[124:125] offset:54272
    s_mov_b64 exec, -1
    s_waitcnt vmcnt(13)
    v_perm_b32 v60, v89, v86, s31
    v_perm_b32 v61, v89, v87, s32
    v_perm_b32 v62, v89, v88, s33
    v_lshlrev_b16 v28, 3, v88
    v_lshlrev_b16 v26, 3, v87
    v_lshlrev_b16 v24, 3, v86
    s_waitcnt lgkmcnt(3)
    s_barrier
    s_setprio 3
    s_cmp_ge_u32 s10, 9
    s_cbranch_scc1 p2_nm0m1a
    v_lshrrev_b32 v84, 1, v112
    s_add_u32 s44, s20, s42
    buffer_load_dwordx2 v[84:85], v84, s[4:7], s44 offen
p2_nm0m1a:
    buffer_load_dwordx4 v[72:75], v112, s[4:7], s20 offen offset:0
    buffer_load_dwordx4 v[76:79], v112, s[4:7], s20 offen offset:1024
    buffer_load_dwordx4 v[80:83], v112, s[4:7], s20 offen offset:2048
    v_cmpx_ge_u16 vcc, 0x3fff, v60
    ds_read_b64 v[24:25], v24
    s_mov_b64 exec, -1
    v_cmpx_ge_u16 vcc, 0x3fff, v61
    ds_read_b64 v[26:27], v26
    s_mov_b64 exec, -1
    v_cmpx_ge_u16 vcc, 0x3fff, v62
    ds_read_b64 v[28:29], v28
    s_mov_b64 exec, -1
    s_waitcnt lgkmcnt(15)
    v_ashrrev_i32 v122, 5, v63
    v_lshlrev_b16 v123, 2, v63
    v_lshlrev_b32 v124, 16, v30
    v_bitop3_b32 v122, v122, v113, v113 bitop3:0x0c
    v_and_b32 v125, 0xffff0000, v30
    v_lshlrev_b32 v126, 16, v31
    v_mul_f32 v122, v114, v122
    v_and_b32 v127, 0xffff0000, v31
    v_add_u32 v123, v123, v123
    v_pk_fma_f32 v[124:125], v[124:125], v[122:123], s[34:35] op_sel_hi:[1,0,1]
    v_pk_fma_f32 v[126:127], v[126:127], v[122:123], s[34:35] op_sel_hi:[1,0,1]
    v_lshl_add_u32 v124, v125, 16, v124
    v_lshl_add_u32 v125, v127, 16, v126
    s_waitcnt lgkmcnt(5)
    v_bitop3_b32 v115, v115, v116, v117 bitop3:0xfe
    v_lshl_add_u64 v[124:125], v[124:125], 0, s[36:37]
    v_cmpx_le_u32 vcc, 0x1000000, v63
    ds_add_rtn_u64 v[116:117], v123, v[124:125] offset:54272
    s_mov_b64 exec, -1
    v_ashrrev_i32 v122, 5, v64
    v_lshlrev_b16 v123, 2, v64
    v_lshlrev_b32 v124, 16, v32
    v_bitop3_b32 v122, v122, v113, v113 bitop3:0x0c
    v_and_b32 v125, 0xffff0000, v32
    v_lshlrev_b32 v126, 16, v33
    v_mul_f32 v122, v114, v122
    v_and_b32 v127, 0xffff0000, v33
    v_add_u32 v123, v123, v123
    v_pk_fma_f32 v[124:125], v[124:125], v[122:123], s[34:35] op_sel_hi:[1,0,1]
    v_pk_fma_f32 v[126:127], v[126:127], v[122:123], s[34:35] op_sel_hi:[1,0,1]
    v_lshl_add_u32 v124, v125, 16, v124
    v_lshl_add_u32 v125, v127, 16, v126
    s_waitcnt lgkmcnt(5)
    v_bitop3_b32 v115, v115, v118, v119 bitop3:0xfe
    v_lshl_add_u64 v[124:125], v[124:125], 0, s[36:37]
    v_cmpx_le_u32 vcc, 0x1000000, v64
    ds_add_rtn_u64 v[118:119], v123, v[124:125] offset:54272
    s_mov_b64 exec, -1
    v_ashrrev_i32 v122, 5, v65
    v_lshlrev_b16 v123, 2, v65
    v_lshlrev_b32 v124, 16, v34
    v_bitop3_b32 v122, v122, v113, v113 bitop3:0x0c
    v_and_b32 v125, 0xffff0000, v34
    v_lshlrev_b32 v126, 16, v35
    v_mul_f32 v122, v114, v122
    v_and_b32 v127, 0xffff0000, v35
    v_add_u32 v123, v123, v123
    v_pk_fma_f32 v[124:125], v[124:125], v[122:123], s[34:35] op_sel_hi:[1,0,1]
    v_pk_fma_f32 v[126:127], v[126:127], v[122:123], s[34:35] op_sel_hi:[1,0,1]
    v_lshl_add_u32 v124, v125, 16, v124
    v_lshl_add_u32 v125, v127, 16, v126
    s_waitcnt lgkmcnt(5)
    v_bitop3_b32 v115, v115, v120, v121 bitop3:0xfe
    v_lshl_add_u64 v[124:125], v[124:125], 0, s[36:37]
    v_cmpx_le_u32 vcc, 0x1000000, v65
    ds_add_rtn_u64 v[120:121], v123, v[124:125] offset:54272
    s_mov_b64 exec, -1
    s_waitcnt vmcnt(15)
    v_perm_b32 v63, v93, v90, s31
    v_perm_b32 v64, v93, v91, s32
    v_perm_b32 v65, v93, v92, s33
    v_lshlrev_b16 v34, 3, v92
    v_lshlrev_b16 v32, 3, v91
    v_lshlrev_b16 v30, 3, v90
    v_cmpx_ge_u16 vcc, 0x3fff, v63
    ds_read_b64 v[30:31], v30
    s_mov_b64 exec, -1
    v_cmpx_ge_u16 vcc, 0x3fff, v64
    ds_read_b64 v[32:33], v32
    s_mov_b64 exec, -1
    v_cmpx_ge_u16 vcc, 0x3fff, v65
    ds_read_b64 v[34:35], v34
    s_mov_b64 exec, -1
    s_waitcnt lgkmcnt(15)
    v_bfe_u32 v86, v106, 14, 4
    v_lshrrev_b32 v87, 18, v106
    v_and_b32 v106, 0x3fff, v106
    v_mad_u32_u24 v86, v86, s63, v87
    v_lshl_or_b32 v106, v86, 14, v106
    buffer_load_dwordx4 v[86:89], v106, s[68:71], 0 offen
    s_setprio 2
    s_waitcnt lgkmcnt(15)
    v_ashrrev_i32 v122, 5, v66
    v_lshlrev_b16 v123, 2, v66
    v_lshlrev_b32 v124, 16, v36
    v_bitop3_b32 v122, v122, v113, v113 bitop3:0x0c
    v_and_b32 v125, 0xffff0000, v36
    v_lshlrev_b32 v126, 16, v37
    v_mul_f32 v122, v114, v122
    v_and_b32 v127, 0xffff0000, v37
    v_add_u32 v123, v123, v123
    v_pk_fma_f32 v[124:125], v[124:125], v[122:123], s[34:35] op_sel_hi:[1,0,1]
    v_pk_fma_f32 v[126:127], v[126:127], v[122:123], s[34:35] op_sel_hi:[1,0,1]
    v_lshl_add_u32 v124, v125, 16, v124
    v_lshl_add_u32 v125, v127, 16, v126
    s_waitcnt lgkmcnt(5)
    v_bitop3_b32 v115, v115, v116, v117 bitop3:0xfe
    v_lshl_add_u64 v[124:125], v[124:125], 0, s[36:37]
    v_cmpx_le_u32 vcc, 0x1000000, v66
    ds_add_rtn_u64 v[116:117], v123, v[124:125] offset:54272
    s_mov_b64 exec, -1
    v_ashrrev_i32 v122, 5, v67
    v_lshlrev_b16 v123, 2, v67
    v_lshlrev_b32 v124, 16, v38
    v_bitop3_b32 v122, v122, v113, v113 bitop3:0x0c
    v_and_b32 v125, 0xffff0000, v38
    v_lshlrev_b32 v126, 16, v39
    v_mul_f32 v122, v114, v122
    v_and_b32 v127, 0xffff0000, v39
    v_add_u32 v123, v123, v123
    v_pk_fma_f32 v[124:125], v[124:125], v[122:123], s[34:35] op_sel_hi:[1,0,1]
    v_pk_fma_f32 v[126:127], v[126:127], v[122:123], s[34:35] op_sel_hi:[1,0,1]
    v_lshl_add_u32 v124, v125, 16, v124
    v_lshl_add_u32 v125, v127, 16, v126
    s_waitcnt lgkmcnt(5)
    v_bitop3_b32 v115, v115, v118, v119 bitop3:0xfe
    v_lshl_add_u64 v[124:125], v[124:125], 0, s[36:37]
    v_cmpx_le_u32 vcc, 0x1000000, v67
    ds_add_rtn_u64 v[118:119], v123, v[124:125] offset:54272
    s_mov_b64 exec, -1
    v_ashrrev_i32 v122, 5, v68
    v_lshlrev_b16 v123, 2, v68
    v_lshlrev_b32 v124, 16, v40
    v_bitop3_b32 v122, v122, v113, v113 bitop3:0x0c
    v_and_b32 v125, 0xffff0000, v40
    v_lshlrev_b32 v126, 16, v41
    v_mul_f32 v122, v114, v122
    v_and_b32 v127, 0xffff0000, v41
    v_add_u32 v123, v123, v123
    v_pk_fma_f32 v[124:125], v[124:125], v[122:123], s[34:35] op_sel_hi:[1,0,1]
    v_pk_fma_f32 v[126:127], v[126:127], v[122:123], s[34:35] op_sel_hi:[1,0,1]
    v_lshl_add_u32 v124, v125, 16, v124
    v_lshl_add_u32 v125, v127, 16, v126
    s_waitcnt lgkmcnt(5)
    v_bitop3_b32 v115, v115, v120, v121 bitop3:0xfe
    v_lshl_add_u64 v[124:125], v[124:125], 0, s[36:37]
    v_cmpx_le_u32 vcc, 0x1000000, v68
    ds_add_rtn_u64 v[120:121], v123, v[124:125] offset:54272
    s_mov_b64 exec, -1
    s_waitcnt vmcnt(12)
    v_perm_b32 v66, v97, v94, s31
    v_perm_b32 v67, v97, v95, s32
    v_perm_b32 v68, v97, v96, s33
    v_lshlrev_b16 v40, 3, v96
    v_lshlrev_b16 v38, 3, v95
    v_lshlrev_b16 v36, 3, v94
    v_cmpx_ge_u16 vcc, 0x3fff, v66
    ds_read_b64 v[36:37], v36
    s_mov_b64 exec, -1
    v_cmpx_ge_u16 vcc, 0x3fff, v67
    ds_read_b64 v[38:39], v38
    s_mov_b64 exec, -1
    v_cmpx_ge_u16 vcc, 0x3fff, v68
    ds_read_b64 v[40:41], v40
    s_mov_b64 exec, -1
    s_waitcnt lgkmcnt(15)
    v_bfe_u32 v90, v107, 14, 4
    v_lshrrev_b32 v91, 18, v107
    v_and_b32 v107, 0x3fff, v107
    v_mad_u32_u24 v90, v90, s63, v91
    v_lshl_or_b32 v107, v90, 14, v107
    buffer_load_dwordx4 v[90:93], v107, s[68:71], 0 offen
    s_setprio 1
    s_cmp_le_u32 s15, 7
    s_cbranch_scc1 p2_na0a7
    s_waitcnt lgkmcnt(15)
    v_ashrrev_i32 v122, 5, v69
    v_lshlrev_b16 v123, 2, v69
    v_lshlrev_b32 v124, 16, v42
    v_bitop3_b32 v122, v122, v113, v113 bitop3:0x0c
    v_and_b32 v125, 0xffff0000, v42
    v_lshlrev_b32 v126, 16, v43
    v_mul_f32 v122, v114, v122
    v_and_b32 v127, 0xffff0000, v43
    v_add_u32 v123, v123, v123
    v_pk_fma_f32 v[124:125], v[124:125], v[122:123], s[34:35] op_sel_hi:[1,0,1]
    v_pk_fma_f32 v[126:127], v[126:127], v[122:123], s[34:35] op_sel_hi:[1,0,1]
    v_lshl_add_u32 v124, v125, 16, v124
    v_lshl_add_u32 v125, v127, 16, v126
    s_waitcnt lgkmcnt(5)
    v_bitop3_b32 v115, v115, v116, v117 bitop3:0xfe
    v_lshl_add_u64 v[124:125], v[124:125], 0, s[36:37]
    v_cmpx_le_u32 vcc, 0x1000000, v69
    ds_add_rtn_u64 v[116:117], v123, v[124:125] offset:54272
    s_mov_b64 exec, -1
    v_ashrrev_i32 v122, 5, v70
    v_lshlrev_b16 v123, 2, v70
    v_lshlrev_b32 v124, 16, v44
    v_bitop3_b32 v122, v122, v113, v113 bitop3:0x0c
    v_and_b32 v125, 0xffff0000, v44
    v_lshlrev_b32 v126, 16, v45
    v_mul_f32 v122, v114, v122
    v_and_b32 v127, 0xffff0000, v45
    v_add_u32 v123, v123, v123
    v_pk_fma_f32 v[124:125], v[124:125], v[122:123], s[34:35] op_sel_hi:[1,0,1]
    v_pk_fma_f32 v[126:127], v[126:127], v[122:123], s[34:35] op_sel_hi:[1,0,1]
    v_lshl_add_u32 v124, v125, 16, v124
    v_lshl_add_u32 v125, v127, 16, v126
    s_waitcnt lgkmcnt(5)
    v_bitop3_b32 v115, v115, v118, v119 bitop3:0xfe
    v_lshl_add_u64 v[124:125], v[124:125], 0, s[36:37]
    v_cmpx_le_u32 vcc, 0x1000000, v70
    ds_add_rtn_u64 v[118:119], v123, v[124:125] offset:54272
    s_mov_b64 exec, -1
    v_ashrrev_i32 v122, 5, v71
    v_lshlrev_b16 v123, 2, v71
    v_lshlrev_b32 v124, 16, v46
    v_bitop3_b32 v122, v122, v113, v113 bitop3:0x0c
    v_and_b32 v125, 0xffff0000, v46
    v_lshlrev_b32 v126, 16, v47
    v_mul_f32 v122, v114, v122
    v_and_b32 v127, 0xffff0000, v47
    v_add_u32 v123, v123, v123
    v_pk_fma_f32 v[124:125], v[124:125], v[122:123], s[34:35] op_sel_hi:[1,0,1]
    v_pk_fma_f32 v[126:127], v[126:127], v[122:123], s[34:35] op_sel_hi:[1,0,1]
    v_lshl_add_u32 v124, v125, 16, v124
    v_lshl_add_u32 v125, v127, 16, v126
    s_waitcnt lgkmcnt(5)
    v_bitop3_b32 v115, v115, v120, v121 bitop3:0xfe
    v_lshl_add_u64 v[124:125], v[124:125], 0, s[36:37]
    v_cmpx_le_u32 vcc, 0x1000000, v71
    ds_add_rtn_u64 v[120:121], v123, v[124:125] offset:54272
    s_mov_b64 exec, -1
p2_na0a7:
    s_waitcnt vmcnt(12)
    v_perm_b32 v69, v101, v98, s31
    v_perm_b32 v70, v101, v99, s32
    v_perm_b32 v71, v101, v100, s33
    v_lshlrev_b16 v46, 3, v100
    v_lshlrev_b16 v44, 3, v99
    v_lshlrev_b16 v42, 3, v98
    s_cmp_le_u32 s16, 7
    s_cbranch_scc1 p2_g0r07
    v_cmpx_ge_u16 vcc, 0x3fff, v69
    ds_read_b64 v[42:43], v42
    s_mov_b64 exec, -1
    v_cmpx_ge_u16 vcc, 0x3fff, v70
    ds_read_b64 v[44:45], v44
    s_mov_b64 exec, -1
    v_cmpx_ge_u16 vcc, 0x3fff, v71
    ds_read_b64 v[46:47], v46
    s_mov_b64 exec, -1
p2_g0r07:
    s_setprio 0
    s_waitcnt vmcnt(8)
    v_perm_b32 v48, v3, v0, s31
    v_perm_b32 v49, v3, v1, s32
    v_perm_b32 v50, v3, v2, s33
    v_lshlrev_b16 v4, 3, v2
    v_lshlrev_b16 v2, 3, v1
    v_lshlrev_b16 v0, 3, v0
    v_cmpx_ge_u16 vcc, 0x3fff, v48
    ds_read_b64 v[0:1], v0
    s_mov_b64 exec, -1
    v_cmpx_ge_u16 vcc, 0x3fff, v49
    ds_read_b64 v[2:3], v2
    s_mov_b64 exec, -1
    v_cmpx_ge_u16 vcc, 0x3fff, v50
    ds_read_b64 v[4:5], v4
    s_mov_b64 exec, -1
    s_waitcnt vmcnt(7)
    v_perm_b32 v51, v9, v6, s31
    v_perm_b32 v52, v9, v7, s32
    v_perm_b32 v53, v9, v8, s33
    v_lshlrev_b16 v10, 3, v8
    v_lshlrev_b16 v8, 3, v7
    v_lshlrev_b16 v6, 3, v6
    v_cmpx_ge_u16 vcc, 0x3fff, v51
    ds_read_b64 v[6:7], v6
    s_mov_b64 exec, -1
    v_cmpx_ge_u16 vcc, 0x3fff, v52
    ds_read_b64 v[8:9], v8
    s_mov_b64 exec, -1
    v_cmpx_ge_u16 vcc, 0x3fff, v53
    ds_read_b64 v[10:11], v10
    s_mov_b64 exec, -1
    s_waitcnt vmcnt(6)
    v_perm_b32 v54, v15, v12, s31
    v_perm_b32 v55, v15, v13, s32
    v_perm_b32 v56, v15, v14, s33
    v_lshlrev_b16 v16, 3, v14
    v_lshlrev_b16 v14, 3, v13
    v_lshlrev_b16 v12, 3, v12
    v_cmpx_ge_u16 vcc, 0x3fff, v54
    ds_read_b64 v[12:13], v12
    s_mov_b64 exec, -1
    v_cmpx_ge_u16 vcc, 0x3fff, v55
    ds_read_b64 v[14:15], v14
    s_mov_b64 exec, -1
    v_cmpx_ge_u16 vcc, 0x3fff, v56
    ds_read_b64 v[16:17], v16
    s_mov_b64 exec, -1
    s_waitcnt vmcnt(5)
    v_perm_b32 v57, v21, v18, s31
    v_perm_b32 v58, v21, v19, s32
    v_perm_b32 v59, v21, v20, s33
    v_lshlrev_b16 v22, 3, v20
    v_lshlrev_b16 v20, 3, v19
    v_lshlrev_b16 v18, 3, v18
    v_cmpx_ge_u16 vcc, 0x3fff, v57
    ds_read_b64 v[18:19], v18
    s_mov_b64 exec, -1
    v_cmpx_ge_u16 vcc, 0x3fff, v58
    ds_read_b64 v[20:21], v20
    s_mov_b64 exec, -1
    v_cmpx_ge_u16 vcc, 0x3fff, v59
    ds_read_b64 v[22:23], v22
    s_mov_b64 exec, -1
    s_waitcnt lgkmcnt(0)
    s_barrier
    s_waitcnt lgkmcnt(15)
    s_branch p2_tail
p2_drain0:
    v_cmpx_gt_i16 vcc, 0, v48
    ds_read_b64 v[0:1], v0
    s_mov_b64 exec, -1
    v_cmpx_gt_i16 vcc, 0, v49
    ds_read_b64 v[2:3], v2
    s_mov_b64 exec, -1
    v_cmpx_gt_i16 vcc, 0, v50
    ds_read_b64 v[4:5], v4
    s_mov_b64 exec, -1
    v_cmpx_gt_i16 vcc, 0, v51
    ds_read_b64 v[6:7], v6
    s_mov_b64 exec, -1
    v_cmpx_gt_i16 vcc, 0, v52
    ds_read_b64 v[8:9], v8
    s_mov_b64 exec, -1
    v_cmpx_gt_i16 vcc, 0, v53
    ds_read_b64 v[10:11], v10
    s_mov_b64 exec, -1
    v_cmpx_gt_i16 vcc, 0, v54
    ds_read_b64 v[12:13], v12
    s_mov_b64 exec, -1
    v_cmpx_gt_i16 vcc, 0, v55
    ds_read_b64 v[14:15], v14
    s_mov_b64 exec, -1
    v_cmpx_gt_i16 vcc, 0, v56
    ds_read_b64 v[16:17], v16
    s_mov_b64 exec, -1
    v_cmpx_gt_i16 vcc, 0, v57
    ds_read_b64 v[18:19], v18
    s_mov_b64 exec, -1
    v_cmpx_gt_i16 vcc, 0, v58
    ds_read_b64 v[20:21], v20
    s_mov_b64 exec, -1
    v_cmpx_gt_i16 vcc, 0, v59
    ds_read_b64 v[22:23], v22
    s_mov_b64 exec, -1
    v_cmpx_gt_i16 vcc, 0, v60
    ds_read_b64 v[24:25], v24
    s_mov_b64 exec, -1
    v_cmpx_gt_i16 vcc, 0, v61
    ds_read_b64 v[26:27], v26
    s_mov_b64 exec, -1
    v_cmpx_gt_i16 vcc, 0, v62
    ds_read_b64 v[28:29], v28
    s_mov_b64 exec, -1
    v_cmpx_gt_i16 vcc, 0, v63
    ds_read_b64 v[30:31], v30
    s_mov_b64 exec, -1
    v_cmpx_gt_i16 vcc, 0, v64
    ds_read_b64 v[32:33], v32
    s_mov_b64 exec, -1
    v_cmpx_gt_i16 vcc, 0, v65
    ds_read_b64 v[34:35], v34
    s_mov_b64 exec, -1
    v_cmpx_gt_i16 vcc, 0, v66
    ds_read_b64 v[36:37], v36
    s_mov_b64 exec, -1
    v_cmpx_gt_i16 vcc, 0, v67
    ds_read_b64 v[38:39], v38
    s_mov_b64 exec, -1
    v_cmpx_gt_i16 vcc, 0, v68
    ds_read_b64 v[40:41], v40
    s_mov_b64 exec, -1
    s_cmp_le_u32 s15, 7
    s_cbranch_scc1 p2_gd0
    v_cmpx_gt_i16 vcc, 0, v69
    ds_read_b64 v[42:43], v42
    s_mov_b64 exec, -1
    v_cmpx_gt_i16 vcc, 0, v70
    ds_read_b64 v[44:45], v44
    s_mov_b64 exec, -1
    v_cmpx_gt_i16 vcc, 0, v71
    ds_read_b64 v[46:47], v46
    s_mov_b64 exec, -1
p2_gd0:
    s_waitcnt lgkmcnt(15)
    v_ashrrev_i32 v122, 5, v48
    v_lshlrev_b16 v123, 2, v48
    v_lshlrev_b32 v124, 16, v0
    v_bitop3_b32 v122, v122, v113, v113 bitop3:0x0c
    v_and_b32 v125, 0xffff0000, v0
    v_lshlrev_b32 v126, 16, v1
    v_mul_f32 v122, v114, v122
    v_and_b32 v127, 0xffff0000, v1
    v_add_u32 v123, v123, v123
    v_pk_fma_f32 v[124:125], v[124:125], v[122:123], s[34:35] op_sel_hi:[1,0,1]
    v_pk_fma_f32 v[126:127], v[126:127], v[122:123], s[34:35] op_sel_hi:[1,0,1]
    v_lshl_add_u32 v124, v125, 16, v124
    v_lshl_add_u32 v125, v127, 16, v126
    s_waitcnt lgkmcnt(15)
    v_bitop3_b32 v115, v115, v116, v117 bitop3:0xfe
    v_lshl_add_u64 v[124:125], v[124:125], 0, s[36:37]
    v_cmpx_le_u32 vcc, 0x1000000, v48
    ds_add_rtn_u64 v[116:117], v123, v[124:125] offset:54272
    s_mov_b64 exec, -1
    v_ashrrev_i32 v122, 5, v49
    v_lshlrev_b16 v123, 2, v49
    v_lshlrev_b32 v124, 16, v2
    v_bitop3_b32 v122, v122, v113, v113 bitop3:0x0c
    v_and_b32 v125, 0xffff0000, v2
    v_lshlrev_b32 v126, 16, v3
    v_mul_f32 v122, v114, v122
    v_and_b32 v127, 0xffff0000, v3
    v_add_u32 v123, v123, v123
    v_pk_fma_f32 v[124:125], v[124:125], v[122:123], s[34:35] op_sel_hi:[1,0,1]
    v_pk_fma_f32 v[126:127], v[126:127], v[122:123], s[34:35] op_sel_hi:[1,0,1]
    v_lshl_add_u32 v124, v125, 16, v124
    v_lshl_add_u32 v125, v127, 16, v126
    s_waitcnt lgkmcnt(15)
    v_bitop3_b32 v115, v115, v118, v119 bitop3:0xfe
    v_lshl_add_u64 v[124:125], v[124:125], 0, s[36:37]
    v_cmpx_le_u32 vcc, 0x1000000, v49
    ds_add_rtn_u64 v[118:119], v123, v[124:125] offset:54272
    s_mov_b64 exec, -1
    v_ashrrev_i32 v122, 5, v50
    v_lshlrev_b16 v123, 2, v50
    v_lshlrev_b32 v124, 16, v4
    v_bitop3_b32 v122, v122, v113, v113 bitop3:0x0c
    v_and_b32 v125, 0xffff0000, v4
    v_lshlrev_b32 v126, 16, v5
    v_mul_f32 v122, v114, v122
    v_and_b32 v127, 0xffff0000, v5
    v_add_u32 v123, v123, v123
    v_pk_fma_f32 v[124:125], v[124:125], v[122:123], s[34:35] op_sel_hi:[1,0,1]
    v_pk_fma_f32 v[126:127], v[126:127], v[122:123], s[34:35] op_sel_hi:[1,0,1]
    v_lshl_add_u32 v124, v125, 16, v124
    v_lshl_add_u32 v125, v127, 16, v126
    s_waitcnt lgkmcnt(15)
    v_bitop3_b32 v115, v115, v120, v121 bitop3:0xfe
    v_lshl_add_u64 v[124:125], v[124:125], 0, s[36:37]
    v_cmpx_le_u32 vcc, 0x1000000, v50
    ds_add_rtn_u64 v[120:121], v123, v[124:125] offset:54272
    s_mov_b64 exec, -1
    s_waitcnt lgkmcnt(15)
    v_ashrrev_i32 v122, 5, v51
    v_lshlrev_b16 v123, 2, v51
    v_lshlrev_b32 v124, 16, v6
    v_bitop3_b32 v122, v122, v113, v113 bitop3:0x0c
    v_and_b32 v125, 0xffff0000, v6
    v_lshlrev_b32 v126, 16, v7
    v_mul_f32 v122, v114, v122
    v_and_b32 v127, 0xffff0000, v7
    v_add_u32 v123, v123, v123
    v_pk_fma_f32 v[124:125], v[124:125], v[122:123], s[34:35] op_sel_hi:[1,0,1]
    v_pk_fma_f32 v[126:127], v[126:127], v[122:123], s[34:35] op_sel_hi:[1,0,1]
    v_lshl_add_u32 v124, v125, 16, v124
    v_lshl_add_u32 v125, v127, 16, v126
    s_waitcnt lgkmcnt(2)
    v_bitop3_b32 v115, v115, v116, v117 bitop3:0xfe
    v_lshl_add_u64 v[124:125], v[124:125], 0, s[36:37]
    v_cmpx_le_u32 vcc, 0x1000000, v51
    ds_add_rtn_u64 v[116:117], v123, v[124:125] offset:54272
    s_mov_b64 exec, -1
    v_ashrrev_i32 v122, 5, v52
    v_lshlrev_b16 v123, 2, v52
    v_lshlrev_b32 v124, 16, v8
    v_bitop3_b32 v122, v122, v113, v113 bitop3:0x0c
    v_and_b32 v125, 0xffff0000, v8
    v_lshlrev_b32 v126, 16, v9
    v_mul_f32 v122, v114, v122
    v_and_b32 v127, 0xffff0000, v9
    v_add_u32 v123, v123, v123
    v_pk_fma_f32 v[124:125], v[124:125], v[122:123], s[34:35] op_sel_hi:[1,0,1]
    v_pk_fma_f32 v[126:127], v[126:127], v[122:123], s[34:35] op_sel_hi:[1,0,1]
    v_lshl_add_u32 v124, v125, 16, v124
    v_lshl_add_u32 v125, v127, 16, v126
    s_waitcnt lgkmcnt(2)
    v_bitop3_b32 v115, v115, v118, v119 bitop3:0xfe
    v_lshl_add_u64 v[124:125], v[124:125], 0, s[36:37]
    v_cmpx_le_u32 vcc, 0x1000000, v52
    ds_add_rtn_u64 v[118:119], v123, v[124:125] offset:54272
    s_mov_b64 exec, -1
    v_ashrrev_i32 v122, 5, v53
    v_lshlrev_b16 v123, 2, v53
    v_lshlrev_b32 v124, 16, v10
    v_bitop3_b32 v122, v122, v113, v113 bitop3:0x0c
    v_and_b32 v125, 0xffff0000, v10
    v_lshlrev_b32 v126, 16, v11
    v_mul_f32 v122, v114, v122
    v_and_b32 v127, 0xffff0000, v11
    v_add_u32 v123, v123, v123
    v_pk_fma_f32 v[124:125], v[124:125], v[122:123], s[34:35] op_sel_hi:[1,0,1]
    v_pk_fma_f32 v[126:127], v[126:127], v[122:123], s[34:35] op_sel_hi:[1,0,1]
    v_lshl_add_u32 v124, v125, 16, v124
    v_lshl_add_u32 v125, v127, 16, v126
    s_waitcnt lgkmcnt(2)
    v_bitop3_b32 v115, v115, v120, v121 bitop3:0xfe
    v_lshl_add_u64 v[124:125], v[124:125], 0, s[36:37]
    v_cmpx_le_u32 vcc, 0x1000000, v53
    ds_add_rtn_u64 v[120:121], v123, v[124:125] offset:54272
    s_mov_b64 exec, -1
    s_waitcnt lgkmcnt(15)
    v_ashrrev_i32 v122, 5, v54
    v_lshlrev_b16 v123, 2, v54
    v_lshlrev_b32 v124, 16, v12
    v_bitop3_b32 v122, v122, v113, v113 bitop3:0x0c
    v_and_b32 v125, 0xffff0000, v12
    v_lshlrev_b32 v126, 16, v13
    v_mul_f32 v122, v114, v122
    v_and_b32 v127, 0xffff0000, v13
    v_add_u32 v123, v123, v123
    v_pk_fma_f32 v[124:125], v[124:125], v[122:123], s[34:35] op_sel_hi:[1,0,1]
    v_pk_fma_f32 v[126:127], v[126:127], v[122:123], s[34:35] op_sel_hi:[1,0,1]
    v_lshl_add_u32 v124, v125, 16, v124
    v_lshl_add_u32 v125, v127, 16, v126
    s_waitcnt lgkmcnt(2)
    v_bitop3_b32 v115, v115, v116, v117 bitop3:0xfe
    v_lshl_add_u64 v[124:125], v[124:125], 0, s[36:37]
    v_cmpx_le_u32 vcc, 0x1000000, v54
    ds_add_rtn_u64 v[116:117], v123, v[124:125] offset:54272
    s_mov_b64 exec, -1
    v_ashrrev_i32 v122, 5, v55
    v_lshlrev_b16 v123, 2, v55
    v_lshlrev_b32 v124, 16, v14
    v_bitop3_b32 v122, v122, v113, v113 bitop3:0x0c
    v_and_b32 v125, 0xffff0000, v14
    v_lshlrev_b32 v126, 16, v15
    v_mul_f32 v122, v114, v122
    v_and_b32 v127, 0xffff0000, v15
    v_add_u32 v123, v123, v123
    v_pk_fma_f32 v[124:125], v[124:125], v[122:123], s[34:35] op_sel_hi:[1,0,1]
    v_pk_fma_f32 v[126:127], v[126:127], v[122:123], s[34:35] op_sel_hi:[1,0,1]
    v_lshl_add_u32 v124, v125, 16, v124
    v_lshl_add_u32 v125, v127, 16, v126
    s_waitcnt lgkmcnt(2)
    v_bitop3_b32 v115, v115, v118, v119 bitop3:0xfe
    v_lshl_add_u64 v[124:125], v[124:125], 0, s[36:37]
    v_cmpx_le_u32 vcc, 0x1000000, v55
    ds_add_rtn_u64 v[118:119], v123, v[124:125] offset:54272
    s_mov_b64 exec, -1
    v_ashrrev_i32 v122, 5, v56
    v_lshlrev_b16 v123, 2, v56
    v_lshlrev_b32 v124, 16, v16
    v_bitop3_b32 v122, v122, v113, v113 bitop3:0x0c
    v_and_b32 v125, 0xffff0000, v16
    v_lshlrev_b32 v126, 16, v17
    v_mul_f32 v122, v114, v122
    v_and_b32 v127, 0xffff0000, v17
    v_add_u32 v123, v123, v123
    v_pk_fma_f32 v[124:125], v[124:125], v[122:123], s[34:35] op_sel_hi:[1,0,1]
    v_pk_fma_f32 v[126:127], v[126:127], v[122:123], s[34:35] op_sel_hi:[1,0,1]
    v_lshl_add_u32 v124, v125, 16, v124
    v_lshl_add_u32 v125, v127, 16, v126
    s_waitcnt lgkmcnt(2)
    v_bitop3_b32 v115, v115, v120, v121 bitop3:0xfe
    v_lshl_add_u64 v[124:125], v[124:125], 0, s[36:37]
    v_cmpx_le_u32 vcc, 0x1000000, v56
    ds_add_rtn_u64 v[120:121], v123, v[124:125] offset:54272
    s_mov_b64 exec, -1
    s_waitcnt lgkmcnt(15)
    v_ashrrev_i32 v122, 5, v57
    v_lshlrev_b16 v123, 2, v57
    v_lshlrev_b32 v124, 16, v18
    v_bitop3_b32 v122, v122, v113, v113 bitop3:0x0c
    v_and_b32 v125, 0xffff0000, v18
    v_lshlrev_b32 v126, 16, v19
    v_mul_f32 v122, v114, v122
    v_and_b32 v127, 0xffff0000, v19
    v_add_u32 v123, v123, v123
    v_pk_fma_f32 v[124:125], v[124:125], v[122:123], s[34:35] op_sel_hi:[1,0,1]
    v_pk_fma_f32 v[126:127], v[126:127], v[122:123], s[34:35] op_sel_hi:[1,0,1]
    v_lshl_add_u32 v124, v125, 16, v124
    v_lshl_add_u32 v125, v127, 16, v126
    s_waitcnt lgkmcnt(2)
    v_bitop3_b32 v115, v115, v116, v117 bitop3:0xfe
    v_lshl_add_u64 v[124:125], v[124:125], 0, s[36:37]
    v_cmpx_le_u32 vcc, 0x1000000, v57
    ds_add_rtn_u64 v[116:117], v123, v[124:125] offset:54272
    s_mov_b64 exec, -1
    v_ashrrev_i32 v122, 5, v58
    v_lshlrev_b16 v123, 2, v58
    v_lshlrev_b32 v124, 16, v20
    v_bitop3_b32 v122, v122, v113, v113 bitop3:0x0c
    v_and_b32 v125, 0xffff0000, v20
    v_lshlrev_b32 v126, 16, v21
    v_mul_f32 v122, v114, v122
    v_and_b32 v127, 0xffff0000, v21
    v_add_u32 v123, v123, v123
    v_pk_fma_f32 v[124:125], v[124:125], v[122:123], s[34:35] op_sel_hi:[1,0,1]
    v_pk_fma_f32 v[126:127], v[126:127], v[122:123], s[34:35] op_sel_hi:[1,0,1]
    v_lshl_add_u32 v124, v125, 16, v124
    v_lshl_add_u32 v125, v127, 16, v126
    s_waitcnt lgkmcnt(2)
    v_bitop3_b32 v115, v115, v118, v119 bitop3:0xfe
    v_lshl_add_u64 v[124:125], v[124:125], 0, s[36:37]
    v_cmpx_le_u32 vcc, 0x1000000, v58
    ds_add_rtn_u64 v[118:119], v123, v[124:125] offset:54272
    s_mov_b64 exec, -1
    v_ashrrev_i32 v122, 5, v59
    v_lshlrev_b16 v123, 2, v59
    v_lshlrev_b32 v124, 16, v22
    v_bitop3_b32 v122, v122, v113, v113 bitop3:0x0c
    v_and_b32 v125, 0xffff0000, v22
    v_lshlrev_b32 v126, 16, v23
    v_mul_f32 v122, v114, v122
    v_and_b32 v127, 0xffff0000, v23
    v_add_u32 v123, v123, v123
    v_pk_fma_f32 v[124:125], v[124:125], v[122:123], s[34:35] op_sel_hi:[1,0,1]
    v_pk_fma_f32 v[126:127], v[126:127], v[122:123], s[34:35] op_sel_hi:[1,0,1]
    v_lshl_add_u32 v124, v125, 16, v124
    v_lshl_add_u32 v125, v127, 16, v126
    s_waitcnt lgkmcnt(2)
    v_bitop3_b32 v115, v115, v120, v121 bitop3:0xfe
    v_lshl_add_u64 v[124:125], v[124:125], 0, s[36:37]
    v_cmpx_le_u32 vcc, 0x1000000, v59
    ds_add_rtn_u64 v[120:121], v123, v[124:125] offset:54272
    s_mov_b64 exec, -1
    s_waitcnt lgkmcnt(15)
    v_ashrrev_i32 v122, 5, v60
    v_lshlrev_b16 v123, 2, v60
    v_lshlrev_b32 v124, 16, v24
    v_bitop3_b32 v122, v122, v113, v113 bitop3:0x0c
    v_and_b32 v125, 0xffff0000, v24
    v_lshlrev_b32 v126, 16, v25
    v_mul_f32 v122, v114, v122
    v_and_b32 v127, 0xffff0000, v25
    v_add_u32 v123, v123, v123
    v_pk_fma_f32 v[124:125], v[124:125], v[122:123], s[34:35] op_sel_hi:[1,0,1]
    v_pk_fma_f32 v[126:127], v[126:127], v[122:123], s[34:35] op_sel_hi:[1,0,1]
    v_lshl_add_u32 v124, v125, 16, v124
    v_lshl_add_u32 v125, v127, 16, v126
    s_waitcnt lgkmcnt(2)
    v_bitop3_b32 v115, v115, v116, v117 bitop3:0xfe
    v_lshl_add_u64 v[124:125], v[124:125], 0, s[36:37]
    v_cmpx_le_u32 vcc, 0x1000000, v60
    ds_add_rtn_u64 v[116:117], v123, v[124:125] offset:54272
    s_mov_b64 exec, -1
    v_ashrrev_i32 v122, 5, v61
    v_lshlrev_b16 v123, 2, v61
    v_lshlrev_b32 v124, 16, v26
    v_bitop3_b32 v122, v122, v113, v113 bitop3:0x0c
    v_and_b32 v125, 0xffff0000, v26
    v_lshlrev_b32 v126, 16, v27
    v_mul_f32 v122, v114, v122
    v_and_b32 v127, 0xffff0000, v27
    v_add_u32 v123, v123, v123
    v_pk_fma_f32 v[124:125], v[124:125], v[122:123], s[34:35] op_sel_hi:[1,0,1]
    v_pk_fma_f32 v[126:127], v[126:127], v[122:123], s[34:35] op_sel_hi:[1,0,1]
    v_lshl_add_u32 v124, v125, 16, v124
    v_lshl_add_u32 v125, v127, 16, v126
    s_waitcnt lgkmcnt(2)
    v_bitop3_b32 v115, v115, v118, v119 bitop3:0xfe
    v_lshl_add_u64 v[124:125], v[124:125], 0, s[36:37]
    v_cmpx_le_u32 vcc, 0x1000000, v61
    ds_add_rtn_u64 v[118:119], v123, v[124:125] offset:54272
    s_mov_b64 exec, -1
    v_ashrrev_i32 v122, 5, v62
    v_lshlrev_b16 v123, 2, v62
    v_lshlrev_b32 v124, 16, v28
    v_bitop3_b32 v122, v122, v113, v113 bitop3:0x0c
    v_and_b32 v125, 0xffff0000, v28
    v_lshlrev_b32 v126, 16, v29
    v_mul_f32 v122, v114, v122
    v_and_b32 v127, 0xffff0000, v29
    v_add_u32 v123, v123, v123
    v_pk_fma_f32 v[124:125], v[124:125], v[122:123], s[34:35] op_sel_hi:[1,0,1]
    v_pk_fma_f32 v[126:127], v[126:127], v[122:123], s[34:35] op_sel_hi:[1,0,1]
    v_lshl_add_u32 v124, v125, 16, v124
    v_lshl_add_u32 v125, v127, 16, v126
    s_waitcnt lgkmcnt(2)
    v_bitop3_b32 v115, v115, v120, v121 bitop3:0xfe
    v_lshl_add_u64 v[124:125], v[124:125], 0, s[36:37]
    v_cmpx_le_u32 vcc, 0x1000000, v62
    ds_add_rtn_u64 v[120:121], v123, v[124:125] offset:54272
    s_mov_b64 exec, -1
    s_waitcnt lgkmcnt(15)
    v_ashrrev_i32 v122, 5, v63
    v_lshlrev_b16 v123, 2, v63
    v_lshlrev_b32 v124, 16, v30
    v_bitop3_b32 v122, v122, v113, v113 bitop3:0x0c
    v_and_b32 v125, 0xffff0000, v30
    v_lshlrev_b32 v126, 16, v31
    v_mul_f32 v122, v114, v122
    v_and_b32 v127, 0xffff0000, v31
    v_add_u32 v123, v123, v123
    v_pk_fma_f32 v[124:125], v[124:125], v[122:123], s[34:35] op_sel_hi:[1,0,1]
    v_pk_fma_f32 v[126:127], v[126:127], v[122:123], s[34:35] op_sel_hi:[1,0,1]
    v_lshl_add_u32 v124, v125, 16, v124
    v_lshl_add_u32 v125, v127, 16, v126
    s_waitcnt lgkmcnt(2)
    v_bitop3_b32 v115, v115, v116, v117 bitop3:0xfe
    v_lshl_add_u64 v[124:125], v[124:125], 0, s[36:37]
    v_cmpx_le_u32 vcc, 0x1000000, v63
    ds_add_rtn_u64 v[116:117], v123, v[124:125] offset:54272
    s_mov_b64 exec, -1
    v_ashrrev_i32 v122, 5, v64
    v_lshlrev_b16 v123, 2, v64
    v_lshlrev_b32 v124, 16, v32
    v_bitop3_b32 v122, v122, v113, v113 bitop3:0x0c
    v_and_b32 v125, 0xffff0000, v32
    v_lshlrev_b32 v126, 16, v33
    v_mul_f32 v122, v114, v122
    v_and_b32 v127, 0xffff0000, v33
    v_add_u32 v123, v123, v123
    v_pk_fma_f32 v[124:125], v[124:125], v[122:123], s[34:35] op_sel_hi:[1,0,1]
    v_pk_fma_f32 v[126:127], v[126:127], v[122:123], s[34:35] op_sel_hi:[1,0,1]
    v_lshl_add_u32 v124, v125, 16, v124
    v_lshl_add_u32 v125, v127, 16, v126
    s_waitcnt lgkmcnt(2)
    v_bitop3_b32 v115, v115, v118, v119 bitop3:0xfe
    v_lshl_add_u64 v[124:125], v[124:125], 0, s[36:37]
    v_cmpx_le_u32 vcc, 0x1000000, v64
    ds_add_rtn_u64 v[118:119], v123, v[124:125] offset:54272
    s_mov_b64 exec, -1
    v_ashrrev_i32 v122, 5, v65
    v_lshlrev_b16 v123, 2, v65
    v_lshlrev_b32 v124, 16, v34
    v_bitop3_b32 v122, v122, v113, v113 bitop3:0x0c
    v_and_b32 v125, 0xffff0000, v34
    v_lshlrev_b32 v126, 16, v35
    v_mul_f32 v122, v114, v122
    v_and_b32 v127, 0xffff0000, v35
    v_add_u32 v123, v123, v123
    v_pk_fma_f32 v[124:125], v[124:125], v[122:123], s[34:35] op_sel_hi:[1,0,1]
    v_pk_fma_f32 v[126:127], v[126:127], v[122:123], s[34:35] op_sel_hi:[1,0,1]
    v_lshl_add_u32 v124, v125, 16, v124
    v_lshl_add_u32 v125, v127, 16, v126
    s_waitcnt lgkmcnt(2)
    v_bitop3_b32 v115, v115, v120, v121 bitop3:0xfe
    v_lshl_add_u64 v[124:125], v[124:125], 0, s[36:37]
    v_cmpx_le_u32 vcc, 0x1000000, v65
    ds_add_rtn_u64 v[120:121], v123, v[124:125] offset:54272
    s_mov_b64 exec, -1
    s_waitcnt lgkmcnt(15)
    v_ashrrev_i32 v122, 5, v66
    v_lshlrev_b16 v123, 2, v66
    v_lshlrev_b32 v124, 16, v36
    v_bitop3_b32 v122, v122, v113, v113 bitop3:0x0c
    v_and_b32 v125, 0xffff0000, v36
    v_lshlrev_b32 v126, 16, v37
    v_mul_f32 v122, v114, v122
    v_and_b32 v127, 0xffff0000, v37
    v_add_u32 v123, v123, v123
    v_pk_fma_f32 v[124:125], v[124:125], v[122:123], s[34:35] op_sel_hi:[1,0,1]
    v_pk_fma_f32 v[126:127], v[126:127], v[122:123], s[34:35] op_sel_hi:[1,0,1]
    v_lshl_add_u32 v124, v125, 16, v124
    v_lshl_add_u32 v125, v127, 16, v126
    s_waitcnt lgkmcnt(2)
    v_bitop3_b32 v115, v115, v116, v117 bitop3:0xfe
    v_lshl_add_u64 v[124:125], v[124:125], 0, s[36:37]
    v_cmpx_le_u32 vcc, 0x1000000, v66
    ds_add_rtn_u64 v[116:117], v123, v[124:125] offset:54272
    s_mov_b64 exec, -1
    v_ashrrev_i32 v122, 5, v67
    v_lshlrev_b16 v123, 2, v67
    v_lshlrev_b32 v124, 16, v38
    v_bitop3_b32 v122, v122, v113, v113 bitop3:0x0c
    v_and_b32 v125, 0xffff0000, v38
    v_lshlrev_b32 v126, 16, v39
    v_mul_f32 v122, v114, v122
    v_and_b32 v127, 0xffff0000, v39
    v_add_u32 v123, v123, v123
    v_pk_fma_f32 v[124:125], v[124:125], v[122:123], s[34:35] op_sel_hi:[1,0,1]
    v_pk_fma_f32 v[126:127], v[126:127], v[122:123], s[34:35] op_sel_hi:[1,0,1]
    v_lshl_add_u32 v124, v125, 16, v124
    v_lshl_add_u32 v125, v127, 16, v126
    s_waitcnt lgkmcnt(2)
    v_bitop3_b32 v115, v115, v118, v119 bitop3:0xfe
    v_lshl_add_u64 v[124:125], v[124:125], 0, s[36:37]
    v_cmpx_le_u32 vcc, 0x1000000, v67
    ds_add_rtn_u64 v[118:119], v123, v[124:125] offset:54272
    s_mov_b64 exec, -1
    v_ashrrev_i32 v122, 5, v68
    v_lshlrev_b16 v123, 2, v68
    v_lshlrev_b32 v124, 16, v40
    v_bitop3_b32 v122, v122, v113, v113 bitop3:0x0c
    v_and_b32 v125, 0xffff0000, v40
    v_lshlrev_b32 v126, 16, v41
    v_mul_f32 v122, v114, v122
    v_and_b32 v127, 0xffff0000, v41
    v_add_u32 v123, v123, v123
    v_pk_fma_f32 v[124:125], v[124:125], v[122:123], s[34:35] op_sel_hi:[1,0,1]
    v_pk_fma_f32 v[126:127], v[126:127], v[122:123], s[34:35] op_sel_hi:[1,0,1]
    v_lshl_add_u32 v124, v125, 16, v124
    v_lshl_add_u32 v125, v127, 16, v126
    s_waitcnt lgkmcnt(2)
    v_bitop3_b32 v115, v115, v120, v121 bitop3:0xfe
    v_lshl_add_u64 v[124:125], v[124:125], 0, s[36:37]
    v_cmpx_le_u32 vcc, 0x1000000, v68
    ds_add_rtn_u64 v[120:121], v123, v[124:125] offset:54272
    s_mov_b64 exec, -1
    s_cmp_le_u32 s15, 7
    s_cbranch_scc1 p2_nad0
    s_waitcnt lgkmcnt(15)
    v_ashrrev_i32 v122, 5, v69
    v_lshlrev_b16 v123, 2, v69
    v_lshlrev_b32 v124, 16, v42
    v_bitop3_b32 v122, v122, v113, v113 bitop3:0x0c
    v_and_b32 v125, 0xffff0000, v42
    v_lshlrev_b32 v126, 16, v43
    v_mul_f32 v122, v114, v122
    v_and_b32 v127, 0xffff0000, v43
    v_add_u32 v123, v123, v123
    v_pk_fma_f32 v[124:125], v[124:125], v[122:123], s[34:35] op_sel_hi:[1,0,1]
    v_pk_fma_f32 v[126:127], v[126:127], v[122:123], s[34:35] op_sel_hi:[1,0,1]
    v_lshl_add_u32 v124, v125, 16, v124
    v_lshl_add_u32 v125, v127, 16, v126
    s_waitcnt lgkmcnt(2)
    v_bitop3_b32 v115, v115, v116, v117 bitop3:0xfe
    v_lshl_add_u64 v[124:125], v[124:125], 0, s[36:37]
    v_cmpx_le_u32 vcc, 0x1000000, v69
    ds_add_rtn_u64 v[116:117], v123, v[124:125] offset:54272
    s_mov_b64 exec, -1
    v_ashrrev_i32 v122, 5, v70
    v_lshlrev_b16 v123, 2, v70
    v_lshlrev_b32 v124, 16, v44
    v_bitop3_b32 v122, v122, v113, v113 bitop3:0x0c
    v_and_b32 v125, 0xffff0000, v44
    v_lshlrev_b32 v126, 16, v45
    v_mul_f32 v122, v114, v122
    v_and_b32 v127, 0xffff0000, v45
    v_add_u32 v123, v123, v123
    v_pk_fma_f32 v[124:125], v[124:125], v[122:123], s[34:35] op_sel_hi:[1,0,1]
    v_pk_fma_f32 v[126:127], v[126:127], v[122:123], s[34:35] op_sel_hi:[1,0,1]
    v_lshl_add_u32 v124, v125, 16, v124
    v_lshl_add_u32 v125, v127, 16, v126
    s_waitcnt lgkmcnt(2)
    v_bitop3_b32 v115, v115, v118, v119 bitop3:0xfe
    v_lshl_add_u64 v[124:125], v[124:125], 0, s[36:37]
    v_cmpx_le_u32 vcc, 0x1000000, v70
    ds_add_rtn_u64 v[118:119], v123, v[124:125] offset:54272
    s_mov_b64 exec, -1
    v_ashrrev_i32 v122, 5, v71
    v_lshlrev_b16 v123, 2, v71
    v_lshlrev_b32 v124, 16, v46
    v_bitop3_b32 v122, v122, v113, v113 bitop3:0x0c
    v_and_b32 v125, 0xffff0000, v46
    v_lshlrev_b32 v126, 16, v47
    v_mul_f32 v122, v114, v122
    v_and_b32 v127, 0xffff0000, v47
    v_add_u32 v123, v123, v123
    v_pk_fma_f32 v[124:125], v[124:125], v[122:123], s[34:35] op_sel_hi:[1,0,1]
    v_pk_fma_f32 v[126:127], v[126:127], v[122:123], s[34:35] op_sel_hi:[1,0,1]
    v_lshl_add_u32 v124, v125, 16, v124
    v_lshl_add_u32 v125, v127, 16, v126
    s_waitcnt lgkmcnt(2)
    v_bitop3_b32 v115, v115, v120, v121 bitop3:0xfe
    v_lshl_add_u64 v[124:125], v[124:125], 0, s[36:37]
    v_cmpx_le_u32 vcc, 0x1000000, v71
    ds_add_rtn_u64 v[120:121], v123, v[124:125] offset:54272
    s_mov_b64 exec, -1
p2_nad0:
    s_branch p2_fin
p2_topf:
    s_cmp_eq_u32 s60, 10
    s_cbranch_scc1 p2_drain1
    s_setprio 3
    v_cmpx_gt_i16 vcc, 0, v48
    ds_read_b64 v[0:1], v0
    s_mov_b64 exec, -1
    v_cmpx_gt_i16 vcc, 0, v49
    ds_read_b64 v[2:3], v2
    s_mov_b64 exec, -1
    v_cmpx_gt_i16 vcc, 0, v50
    ds_read_b64 v[4:5], v4
    s_mov_b64 exec, -1
    v_cmpx_gt_i16 vcc, 0, v51
    ds_read_b64 v[6:7], v6
    s_mov_b64 exec, -1
    v_cmpx_gt_i16 vcc, 0, v52
    ds_read_b64 v[8:9], v8
    s_mov_b64 exec, -1
    v_cmpx_gt_i16 vcc, 0, v53
    ds_read_b64 v[10:11], v10
    s_mov_b64 exec, -1
    v_cmpx_gt_i16 vcc, 0, v54
    ds_read_b64 v[12:13], v12
    s_mov_b64 exec, -1
    v_cmpx_gt_i16 vcc, 0, v55
    ds_read_b64 v[14:15], v14
    s_mov_b64 exec, -1
    v_cmpx_gt_i16 vcc, 0, v56
    ds_read_b64 v[16:17], v16
    s_mov_b64 exec, -1
    v_cmpx_gt_i16 vcc, 0, v57
    ds_read_b64 v[18:19], v18
    s_mov_b64 exec, -1
    v_cmpx_gt_i16 vcc, 0, v58
    ds_read_b64 v[20:21], v20
    s_mov_b64 exec, -1
    v_cmpx_gt_i16 vcc, 0, v59
    ds_read_b64 v[22:23], v22
    s_mov_b64 exec, -1
    s_cmp_ge_u32 s10, 9
    s_cbranch_scc1 p2_nm1m0a
    v_lshrrev_b32 v84, 1, v112
    s_add_u32 s44, s20, s42
    buffer_load_dwordx2 v[84:85], v84, s[4:7], s44 offen
p2_nm1m0a:
    buffer_load_dwordx4 v[72:75], v112, s[4:7], s20 offen offset:0
    buffer_load_dwordx4 v[76:79], v112, s[4:7], s20 offen offset:1024
    buffer_load_dwordx4 v[80:83], v112, s[4:7], s20 offen offset:2048
    v_cmpx_gt_i16 vcc, 0, v60
    ds_read_b64 v[24:25], v24
    s_mov_b64 exec, -1
    v_cmpx_gt_i16 vcc, 0, v61
    ds_read_b64 v[26:27], v26
    s_mov_b64 exec, -1
    v_cmpx_gt_i16 vcc, 0, v62
    ds_read_b64 v[28:29], v28
    s_mov_b64 exec, -1
    v_cmpx_gt_i16 vcc, 0, v63
    ds_read_b64 v[30:31], v30
    s_mov_b64 exec, -1
    v_cmpx_gt_i16 vcc, 0, v64
    ds_read_b64 v[32:33], v32
    s_mov_b64 exec, -1
    v_cmpx_gt_i16 vcc, 0, v65
    ds_read_b64 v[34:35], v34
    s_mov_b64 exec, -1
    v_cmpx_gt_i16 vcc, 0, v66
    ds_read_b64 v[36:37], v36
    s_mov_b64 exec, -1
    v_cmpx_gt_i16 vcc, 0, v67
    ds_read_b64 v[38:39], v38
    s_mov_b64 exec, -1
    v_cmpx_gt_i16 vcc, 0, v68
    ds_read_b64 v[40:41], v40
    s_mov_b64 exec, -1
    s_cmp_le_u32 s15, 7
    s_cbranch_scc1 p2_g1r27
    v_cmpx_gt_i16 vcc, 0, v69
    ds_read_b64 v[42:43], v42
    s_mov_b64 exec, -1
    v_cmpx_gt_i16 vcc, 0, v70
    ds_read_b64 v[44:45], v44
    s_mov_b64 exec, -1
    v_cmpx_gt_i16 vcc, 0, v71
    ds_read_b64 v[46:47], v46
    s_mov_b64 exec, -1
p2_g1r27:
    s_setprio 2
    s_waitcnt lgkmcnt(15)
    v_ashrrev_i32 v122, 5, v48
    v_lshlrev_b16 v123, 2, v48
    v_cndmask_b32 v126, v0, v1, s[66:67]
    v_bitop3_b32 v122, v122, v113, v113 bitop3:0x0c
    v_lshlrev_b32 v124, 16, v126
    v_mul_f32 v122, v114, v122
    v_and_b32 v125, 0xffff0000, v126
    v_add_u32 v123, v123, v123
    v_mul_f32 v124, v122, v124
    v_mul_f32 v125, v122, v125
    v_cmpx_le_u32 vcc, 0x1000000, v48
    ds_add_f32 v123, v124 offset:54272
    ds_add_f32 v123, v125 offset:54276
    s_mov_b64 exec, -1
    v_ashrrev_i32 v122, 5, v49
    v_lshlrev_b16 v123, 2, v49
    v_cndmask_b32 v126, v2, v3, s[66:67]
    v_bitop3_b32 v122, v122, v113, v113 bitop3:0x0c
    v_lshlrev_b32 v124, 16, v126
    v_mul_f32 v122, v114, v122
    v_and_b32 v125, 0xffff0000, v126
    v_add_u32 v123, v123, v123
    v_mul_f32 v124, v122, v124
    v_mul_f32 v125, v122, v125
    v_cmpx_le_u32 vcc, 0x1000000, v49
    ds_add_f32 v123, v124 offset:54272
    ds_add_f32 v123, v125 offset:54276
    s_mov_b64 exec, -1
    v_ashrrev_i32 v122, 5, v50
    v_lshlrev_b16 v123, 2, v50
    v_cndmask_b32 v126, v4, v5, s[66:67]
    v_bitop3_b32 v122, v122, v113, v113 bitop3:0x0c
    v_lshlrev_b32 v124, 16, v126
    v_mul_f32 v122, v114, v122
    v_and_b32 v125, 0xffff0000, v126
    v_add_u32 v123, v123, v123
    v_mul_f32 v124, v122, v124
    v_mul_f32 v125, v122, v125
    v_cmpx_le_u32 vcc, 0x1000000, v50
    ds_add_f32 v123, v124 offset:54272
    ds_add_f32 v123, v125 offset:54276
    s_mov_b64 exec, -1
    v_bfe_u32 v0, v102, 14, 4
    v_lshrrev_b32 v1, 18, v102
    v_and_b32 v102, 0x3fff, v102
    v_mad_u32_u24 v0, v0, s63, v1
    v_lshl_or_b32 v102, v0, 14, v102
    buffer_load_dwordx4 v[0:3], v102, s[68:71], 0 offen
    s_setprio 1
    s_waitcnt lgkmcnt(15)
    v_ashrrev_i32 v122, 5, v51
    v_lshlrev_b16 v123, 2, v51
    v_cndmask_b32 v126, v6, v7, s[66:67]
    v_bitop3_b32 v122, v122, v113, v113 bitop3:0x0c
    v_lshlrev_b32 v124, 16, v126
    v_mul_f32 v122, v114, v122
    v_and_b32 v125, 0xffff0000, v126
    v_add_u32 v123, v123, v123
    v_mul_f32 v124, v122, v124
    v_mul_f32 v125, v122, v125
    v_cmpx_le_u32 vcc, 0x1000000, v51
    ds_add_f32 v123, v124 offset:54272
    ds_add_f32 v123, v125 offset:54276
    s_mov_b64 exec, -1
    v_ashrrev_i32 v122, 5, v52
    v_lshlrev_b16 v123, 2, v52
    v_cndmask_b32 v126, v8, v9, s[66:67]
    v_bitop3_b32 v122, v122, v113, v113 bitop3:0x0c
    v_lshlrev_b32 v124, 16, v126
    v_mul_f32 v122, v114, v122
    v_and_b32 v125, 0xffff0000, v126
    v_add_u32 v123, v123, v123
    v_mul_f32 v124, v122, v124
    v_mul_f32 v125, v122, v125
    v_cmpx_le_u32 vcc, 0x1000000, v52
    ds_add_f32 v123, v124 offset:54272
    ds_add_f32 v123, v125 offset:54276
    s_mov_b64 exec, -1
    v_ashrrev_i32 v122, 5, v53
    v_lshlrev_b16 v123, 2, v53
    v_cndmask_b32 v126, v10, v11, s[66:67]
    v_bitop3_b32 v122, v122, v113, v113 bitop3:0x0c
    v_lshlrev_b32 v124, 16, v126
    v_mul_f32 v122, v114, v122
    v_and_b32 v125, 0xffff0000, v126
    v_add_u32 v123, v123, v123
    v_mul_f32 v124, v122, v124
    v_mul_f32 v125, v122, v125
    v_cmpx_le_u32 vcc, 0x1000000, v53
    ds_add_f32 v123, v124 offset:54272
    ds_add_f32 v123, v125 offset:54276
    s_mov_b64 exec, -1
    v_bfe_u32 v6, v103, 14, 4
    v_lshrrev_b32 v7, 18, v103
    v_and_b32 v103, 0x3fff, v103
    v_mad_u32_u24 v6, v6, s63, v7
    v_lshl_or_b32 v103, v6, 14, v103
    buffer_load_dwordx4 v[6:9], v103, s[68:71], 0 offen
    s_waitcnt lgkmcnt(12)
    s_barrier
    s_setprio 3
    s_waitcnt vmcnt(6)
    s_mov_b32 m0, s23
    v_mov_b32 v53, 0x3c000
    s_movk_i32 s44, 512
    v_sub_u32_sdwa v4, v111, v110 dst_sel:DWORD dst_unused:UNUSED_PAD src0_sel:WORD_0 src1_sel:WORD_0
    v_sub_u32_sdwa v5, v111, v110 dst_sel:DWORD dst_unused:UNUSED_PAD src0_sel:WORD_1 src1_sel:WORD_1
    v_med3_i32 v4, v4, 0, s44
    v_med3_i32 v5, v5, 0, s44
    v_add_u32 v48, v4, v5
    ds_write_addtid_b32 v53 offset:0
    ds_write_addtid_b32 v53 offset:256
    ds_write_addtid_b32 v53 offset:512
    ds_write_addtid_b32 v53 offset:768
    ds_write_addtid_b32 v53 offset:1024
    ds_write_addtid_b32 v53 offset:1280
    ds_write_addtid_b32 v53 offset:1536
    ds_write_addtid_b32 v53 offset:1792
    v_bfe_i32 v53, v112, 6, 1
    v_lshrrev_b32 v49, 6, v112
    v_bitop3_b32 v53, v53, 15, s10 bitop3:0x6a
    v_lshl_or_b32 v49, v49, 4, v53
    v_and_b32 v53, 0x30, v112
    v_lshl_or_b32 v53, v49, 6, v53
    v_lshlrev_b32 v53, 15, v53
    s_nop 1
    v_add_u32_dpp v48, v48, v48 row_shr:1 row_mask:0xf bank_mask:0xf bound_ctrl:0
    s_nop 1
    v_add_u32_dpp v48, v48, v48 row_shr:2 row_mask:0xf bank_mask:0xf bound_ctrl:0
    s_nop 1
    v_add_u32_dpp v48, v48, v48 row_shr:4 row_mask:0xf bank_mask:0xf bound_ctrl:0
    s_nop 1
    v_add_u32_dpp v48, v48, v48 row_shr:8 row_mask:0xf bank_mask:0xf bound_ctrl:0
    s_nop 1
    v_add_u32_dpp v48, v48, v48 row_bcast:15 row_mask:0xa bank_mask:0xf
    s_nop 1
    v_add_u32_dpp v48, v48, v48 row_bcast:31 row_mask:0xc bank_mask:0xf
    s_nop 1
    s_nop 0
    v_readlane_b32 s38, v48, 63
    v_sub_u32 v50, v48, v5
    v_sub_u32 v49, v50, v4
    v_sub_u32 v10, 512, v49
    v_mad_u32_u16 v51, v110, 16, v53
    v_med3_i32 v10, v10, 0, v4
    v_lshl_add_u32 v49, v49, 2, s23
    v_sub_u32 v11, 512, v50
    v_mad_u32_u16 v52, v110, 16, v53 op_sel:[1,0,0,0]
    v_med3_i32 v11, v11, 0, v5
    v_lshl_add_u32 v50, v50, 2, s23
    v_lshl_add_u32 v48, v11, 16, v10
    v_add_u32 v52, 262144, v52
    v_add_u32 v110, v110, v48
    s_min_u32 s17, s38, 512
    s_add_u32 s17, s17, 63
    s_lshr_b32 s17, s17, 6
p2_x1x_0:
    v_cmpx_lt_i32 vcc, 0, v10
    s_cbranch_execz p2_y1x_0
    ds_write_b32 v49, v51 offset:0
    v_add_u32 v51, 16, v51
    v_cmpx_lt_i32 vcc, 1, v10
    s_cbranch_execz p2_y1x_0
    ds_write_b32 v49, v51 offset:4
    v_add_u32 v51, 16, v51
    v_cmpx_lt_i32 vcc, 2, v10
    s_cbranch_execz p2_y1x_0
    ds_write_b32 v49, v51 offset:8
    v_add_u32 v51, 16, v51
    v_cmpx_lt_i32 vcc, 3, v10
    s_cbranch_execz p2_y1x_0
    ds_write_b32 v49, v51 offset:12
    v_add_u32 v51, 16, v51
    v_cmpx_lt_i32 vcc, 4, v10
    s_cbranch_execz p2_y1x_0
    ds_write_b32 v49, v51 offset:16
    v_add_u32 v51, 16, v51
    v_cmpx_lt_i32 vcc, 5, v10
    s_cbranch_execz p2_y1x_0
    ds_write_b32 v49, v51 offset:20
    v_add_u32 v51, 16, v51
    v_cmpx_lt_i32 vcc, 6, v10
    s_cbranch_execz p2_y1x_0
    ds_write_b32 v49, v51 offset:24
    v_add_u32 v51, 16, v51
    v_cmpx_lt_i32 vcc, 7, v10
    s_cbranch_execz p2_y1x_0
    ds_write_b32 v49, v51 offset:28
    v_add_u32 v51, 16, v51
    v_subrev_u32 v10, 8, v10
    v_add_u32 v49, 32, v49
    s_branch p2_x1x_0
p2_y1x_0:
    s_mov_b64 exec, -1
p2_x1x_1:
    v_cmpx_lt_i32 vcc, 0, v11
    s_cbranch_execz p2_y1x_1
    ds_write_b32 v50, v52 offset:0
    v_add_u32 v52, 16, v52
    v_cmpx_lt_i32 vcc, 1, v11
    s_cbranch_execz p2_y1x_1
    ds_write_b32 v50, v52 offset:4
    v_add_u32 v52, 16, v52
    v_cmpx_lt_i32 vcc, 2, v11
    s_cbranch_execz p2_y1x_1
    ds_write_b32 v50, v52 offset:8
    v_add_u32 v52, 16, v52
    v_cmpx_lt_i32 vcc, 3, v11
    s_cbranch_execz p2_y1x_1
    ds_write_b32 v50, v52 offset:12
    v_add_u32 v52, 16, v52
    v_cmpx_lt_i32 vcc, 4, v11
    s_cbranch_execz p2_y1x_1
    ds_write_b32 v50, v52 offset:16
    v_add_u32 v52, 16, v52
    v_cmpx_lt_i32 vcc, 5, v11
    s_cbranch_execz p2_y1x_1
    ds_write_b32 v50, v52 offset:20
    v_add_u32 v52, 16, v52
    v_cmpx_lt_i32 vcc, 6, v11
    s_cbranch_execz p2_y1x_1
    ds_write_b32 v50, v52 offset:24
    v_add_u32 v52, 16, v52
    v_cmpx_lt_i32 vcc, 7, v11
    s_cbranch_execz p2_y1x_1
    ds_write_b32 v50, v52 offset:28
    v_add_u32 v52, 16, v52
    v_subrev_u32 v11, 8, v11
    v_add_u32 v50, 32, v50
    s_branch p2_x1x_1
p2_y1x_1:
    s_mov_b64 exec, -1
    s_cmp_lt_u32 s38, 512
    s_cbranch_scc1 p2_nomore1x
    v_cmp_lt_u32_sdwa s[44:45], v110, v111 src0_sel:WORD_0 src1_sel:WORD_0
    v_cmp_lt_u32_sdwa s[46:47], v110, v111 src0_sel:WORD_1 src1_sel:WORD_1
    s_nop 0
    s_or_b64 s[44:45], s[44:45], s[46:47]
    s_cbranch_scc0 p2_nomore1x
    v_mov_b32 v49, s19
    v_mov_b32 v50, 1
    ds_write_b32 v49, v50 offset:53760
p2_nomore1x:
    s_setprio 2
    s_waitcnt lgkmcnt(15)
    v_ashrrev_i32 v122, 5, v54
    v_lshlrev_b16 v123, 2, v54
    v_cndmask_b32 v126, v12, v13, s[66:67]
    v_bitop3_b32 v122, v122, v113, v113 bitop3:0x0c
    v_lshlrev_b32 v124, 16, v126
    v_mul_f32 v122, v114, v122
    v_and_b32 v125, 0xffff0000, v126
    v_add_u32 v123, v123, v123
    v_mul_f32 v124, v122, v124
    v_mul_f32 v125, v122, v125
    v_cmpx_le_u32 vcc, 0x1000000, v54
    ds_add_f32 v123, v124 offset:54272
    ds_add_f32 v123, v125 offset:54276
    s_mov_b64 exec, -1
    v_ashrrev_i32 v122, 5, v55
    v_lshlrev_b16 v123, 2, v55
    v_cndmask_b32 v126, v14, v15, s[66:67]
    v_bitop3_b32 v122, v122, v113, v113 bitop3:0x0c
    v_lshlrev_b32 v124, 16, v126
    v_mul_f32 v122, v114, v122
    v_and_b32 v125, 0xffff0000, v126
    v_add_u32 v123, v123, v123
    v_mul_f32 v124, v122, v124
    v_mul_f32 v125, v122, v125
    v_cmpx_le_u32 vcc, 0x1000000, v55
    ds_add_f32 v123, v124 offset:54272
    ds_add_f32 v123, v125 offset:54276
    s_mov_b64 exec, -1
    v_ashrrev_i32 v122, 5, v56
    v_lshlrev_b16 v123, 2, v56
    v_cndmask_b32 v126, v16, v17, s[66:67]
    v_bitop3_b32 v122, v122, v113, v113 bitop3:0x0c
    v_lshlrev_b32 v124, 16, v126
    v_mul_f32 v122, v114, v122
    v_and_b32 v125, 0xffff0000, v126
    v_add_u32 v123, v123, v123
    v_mul_f32 v124, v122, v124
    v_mul_f32 v125, v122, v125
    v_cmpx_le_u32 vcc, 0x1000000, v56
    ds_add_f32 v123, v124 offset:54272
    ds_add_f32 v123, v125 offset:54276
    s_mov_b64 exec, -1
    v_bfe_u32 v12, v104, 14, 4
    v_lshrrev_b32 v13, 18, v104
    v_and_b32 v104, 0x3fff, v104
    v_mad_u32_u24 v12, v12, s63, v13
    v_lshl_or_b32 v104, v12, 14, v104
    buffer_load_dwordx4 v[12:15], v104, s[68:71], 0 offen
    s_setprio 1
    s_waitcnt lgkmcnt(15)
    v_ashrrev_i32 v122, 5, v57
    v_lshlrev_b16 v123, 2, v57
    v_cndmask_b32 v126, v18, v19, s[66:67]
    v_bitop3_b32 v122, v122, v113, v113 bitop3:0x0c
    v_lshlrev_b32 v124, 16, v126
    v_mul_f32 v122, v114, v122
    v_and_b32 v125, 0xffff0000, v126
    v_add_u32 v123, v123, v123
    v_mul_f32 v124, v122, v124
    v_mul_f32 v125, v122, v125
    v_cmpx_le_u32 vcc, 0x1000000, v57
    ds_add_f32 v123, v124 offset:54272
    ds_add_f32 v123, v125 offset:54276
    s_mov_b64 exec, -1
    v_ashrrev_i32 v122, 5, v58
    v_lshlrev_b16 v123, 2, v58
    v_cndmask_b32 v126, v20, v21, s[66:67]
    v_bitop3_b32 v122, v122, v113, v113 bitop3:0x0c
    v_lshlrev_b32 v124, 16, v126
    v_mul_f32 v122, v114, v122
    v_and_b32 v125, 0xffff0000, v126
    v_add_u32 v123, v123, v123
    v_mul_f32 v124, v122, v124
    v_mul_f32 v125, v122, v125
    v_cmpx_le_u32 vcc, 0x1000000, v58
    ds_add_f32 v123, v124 offset:54272
    ds_add_f32 v123, v125 offset:54276
    s_mov_b64 exec, -1
    v_ashrrev_i32 v122, 5, v59
    v_lshlrev_b16 v123, 2, v59
    v_cndmask_b32 v126, v22, v23, s[66:67]
    v_bitop3_b32 v122, v122, v113, v113 bitop3:0x0c
    v_lshlrev_b32 v124, 16, v126
    v_mul_f32 v122, v114, v122
    v_and_b32 v125, 0xffff0000, v126
    v_add_u32 v123, v123, v123
    v_mul_f32 v124, v122, v124
    v_mul_f32 v125, v122, v125
    v_cmpx_le_u32 vcc, 0x1000000, v59
    ds_add_f32 v123, v124 offset:54272
    ds_add_f32 v123, v125 offset:54276
    s_mov_b64 exec, -1
    v_bfe_u32 v18, v105, 14, 4
    v_lshrrev_b32 v19, 18, v105
    v_and_b32 v105, 0x3fff, v105
    v_mad_u32_u24 v18, v18, s63, v19
    v_lshl_or_b32 v105, v18, 14, v105
    buffer_load_dwordx4 v[18:21], v105, s[68:71], 0 offen
    s_mov_b32 m0, s23
    s_nop 0
    ds_read_addtid_b32 v102 offset:0
    ds_read_addtid_b32 v103 offset:256
    ds_read_addtid_b32 v104 offset:512
    ds_read_addtid_b32 v105 offset:768
    ds_read_addtid_b32 v106 offset:1024
    ds_read_addtid_b32 v107 offset:1280
    ds_read_addtid_b32 v108 offset:1536
    ds_read_addtid_b32 v109 offset:1792
    s_waitcnt vmcnt(4)
    s_mov_b32 m0, s24
    s_cmp_ge_u32 s10, 9
    s_cbranch_scc1 p2_st1s0
    ds_write_addtid_b32 v84 offset:49152
    ds_write_addtid_b32 v85 offset:49408
p2_st1s0:
    s_mov_b32 m0, s23
    s_add_u32 s20, s20, 53760
    ds_write_addtid_b32 v72 offset:0
    ds_write_addtid_b32 v73 offset:256
    ds_write_addtid_b32 v74 offset:512
    ds_write_addtid_b32 v75 offset:768
    ds_write_addtid_b32 v76 offset:1024
    ds_write_addtid_b32 v77 offset:1280
    ds_write_addtid_b32 v78 offset:1536
    ds_write_addtid_b32 v79 offset:1792
    ds_write_addtid_b32 v80 offset:2048
    ds_write_addtid_b32 v81 offset:2304
    ds_write_addtid_b32 v82 offset:2560
    ds_write_addtid_b32 v83 offset:2816
    s_setprio 0
    s_waitcnt lgkmcnt(15)
    v_ashrrev_i32 v122, 5, v60
    v_lshlrev_b16 v123, 2, v60
    v_cndmask_b32 v126, v24, v25, s[66:67]
    v_bitop3_b32 v122, v122, v113, v113 bitop3:0x0c
    v_lshlrev_b32 v124, 16, v126
    v_mul_f32 v122, v114, v122
    v_and_b32 v125, 0xffff0000, v126
    v_add_u32 v123, v123, v123
    v_mul_f32 v124, v122, v124
    v_mul_f32 v125, v122, v125
    v_cmpx_le_u32 vcc, 0x1000000, v60
    ds_add_f32 v123, v124 offset:54272
    ds_add_f32 v123, v125 offset:54276
    s_mov_b64 exec, -1
    v_ashrrev_i32 v122, 5, v61
    v_lshlrev_b16 v123, 2, v61
    v_cndmask_b32 v126, v26, v27, s[66:67]
    v_bitop3_b32 v122, v122, v113, v113 bitop3:0x0c
    v_lshlrev_b32 v124, 16, v126
    v_mul_f32 v122, v114, v122
    v_and_b32 v125, 0xffff0000, v126
    v_add_u32 v123, v123, v123
    v_mul_f32 v124, v122, v124
    v_mul_f32 v125, v122, v125
    v_cmpx_le_u32 vcc, 0x1000000, v61
    ds_add_f32 v123, v124 offset:54272
    ds_add_f32 v123, v125 offset:54276
    s_mov_b64 exec, -1
    v_ashrrev_i32 v122, 5, v62
    v_lshlrev_b16 v123, 2, v62
    v_cndmask_b32 v126, v28, v29, s[66:67]
    v_bitop3_b32 v122, v122, v113, v113 bitop3:0x0c
    v_lshlrev_b32 v124, 16, v126
    v_mul_f32 v122, v114, v122
    v_and_b32 v125, 0xffff0000, v126
    v_add_u32 v123, v123, v123
    v_mul_f32 v124, v122, v124
    v_mul_f32 v125, v122, v125
    v_cmpx_le_u32 vcc, 0x1000000, v62
    ds_add_f32 v123, v124 offset:54272
    ds_add_f32 v123, v125 offset:54276
    s_mov_b64 exec, -1
    s_waitcnt vmcnt(13)
    v_perm_b32 v60, v89, v86, s31
    v_perm_b32 v61, v89, v87, s32
    v_perm_b32 v62, v89, v88, s33
    v_lshlrev_b16 v28, 3, v88
    v_lshlrev_b16 v26, 3, v87
    v_lshlrev_b16 v24, 3, v86
    s_waitcnt lgkmcnt(6)
    s_barrier
    s_setprio 3
    s_cmp_ge_u32 s10, 9
    s_cbranch_scc1 p2_nm1m1a
    v_lshrrev_b32 v84, 1, v112
    s_add_u32 s44, s20, s42
    buffer_load_dwordx2 v[84:85], v84, s[4:7], s44 offen
p2_nm1m1a:
    buffer_load_dwordx4 v[72:75], v112, s[4:7], s20 offen offset:0
    buffer_load_dwordx4 v[76:79], v112, s[4:7], s20 offen offset:1024
    buffer_load_dwordx4 v[80:83], v112, s[4:7], s20 offen offset:2048
    v_cmpx_ge_u16 vcc, 0x3fff, v60
    ds_read_b64 v[24:25], v24
    s_mov_b64 exec, -1
    v_cmpx_ge_u16 vcc, 0x3fff, v61
    ds_read_b64 v[26:27], v26
    s_mov_b64 exec, -1
    v_cmpx_ge_u16 vcc, 0x3fff, v62
    ds_read_b64 v[28:29], v28
    s_mov_b64 exec, -1
    s_waitcnt lgkmcnt(15)
    v_ashrrev_i32 v122, 5, v63
    v_lshlrev_b16 v123, 2, v63
    v_cndmask_b32 v126, v30, v31, s[66:67]
    v_bitop3_b32 v122, v122, v113, v113 bitop3:0x0c
    v_lshlrev_b32 v124, 16, v126
    v_mul_f32 v122, v114, v122
    v_and_b32 v125, 0xffff0000, v126
    v_add_u32 v123, v123, v123
    v_mul_f32 v124, v122, v124
    v_mul_f32 v125, v122, v125
    v_cmpx_le_u32 vcc, 0x1000000, v63
    ds_add_f32 v123, v124 offset:54272
    ds_add_f32 v123, v125 offset:54276
    s_mov_b64 exec, -1
    v_ashrrev_i32 v122, 5, v64
    v_lshlrev_b16 v123, 2, v64
    v_cndmask_b32 v126, v32, v33, s[66:67]
    v_bitop3_b32 v122, v122, v113, v113 bitop3:0x0c
    v_lshlrev_b32 v124, 16, v126
    v_mul_f32 v122, v114, v122
    v_and_b32 v125, 0xffff0000, v126
    v_add_u32 v123, v123, v123
    v_mul_f32 v124, v122, v124
    v_mul_f32 v125, v122, v125
    v_cmpx_le_u32 vcc, 0x1000000, v64
    ds_add_f32 v123, v124 offset:54272
    ds_add_f32 v123, v125 offset:54276
    s_mov_b64 exec, -1
    v_ashrrev_i32 v122, 5, v65
    v_lshlrev_b16 v123, 2, v65
    v_cndmask_b32 v126, v34, v35, s[66:67]
    v_bitop3_b32 v122, v122, v113, v113 bitop3:0x0c
    v_lshlrev_b32 v124, 16, v126
    v_mul_f32 v122, v114, v122
    v_and_b32 v125, 0xffff0000, v126
    v_add_u32 v123, v123, v123
    v_mul_f32 v124, v122, v124
    v_mul_f32 v125, v122, v125
    v_cmpx_le_u32 vcc, 0x1000000, v65
    ds_add_f32 v123, v124 offset:54272
    ds_add_f32 v123, v125 offset:54276
    s_mov_b64 exec, -1
    s_waitcnt vmcnt(15)
    v_perm_b32 v63, v93, v90, s31
    v_perm_b32 v64, v93, v91, s32
    v_perm_b32 v65, v93, v92, s33
    v_lshlrev_b16 v34, 3, v92
    v_lshlrev_b16 v32, 3, v91
    v_lshlrev_b16 v30, 3, v90
    v_cmpx_ge_u16 vcc, 0x3fff, v63
    ds_read_b64 v[30:31], v30
    s_mov_b64 exec, -1
    v_cmpx_ge_u16 vcc, 0x3fff, v64
    ds_read_b64 v[32:33], v32
    s_mov_b64 exec, -1
    v_cmpx_ge_u16 vcc, 0x3fff, v65
    ds_read_b64 v[34:35], v34
    s_mov_b64 exec, -1
    s_waitcnt lgkmcnt(15)
    v_bfe_u32 v86, v106, 14, 4
    v_lshrrev_b32 v87, 18, v106
    v_and_b32 v106, 0x3fff, v106
    v_mad_u32_u24 v86, v86, s63, v87
    v_lshl_or_b32 v106, v86, 14, v106
    buffer_load_dwordx4 v[86:89], v106, s[68:71], 0 offen
    s_setprio 2
    s_waitcnt lgkmcnt(15)
    v_ashrrev_i32 v122, 5, v66
    v_lshlrev_b16 v123, 2, v66
    v_cndmask_b32 v126, v36, v37, s[66:67]
    v_bitop3_b32 v122, v122, v113, v113 bitop3:0x0c
    v_lshlrev_b32 v124, 16, v126
    v_mul_f32 v122, v114, v122
    v_and_b32 v125, 0xffff0000, v126
    v_add_u32 v123, v123, v123
    v_mul_f32 v124, v122, v124
    v_mul_f32 v125, v122, v125
    v_cmpx_le_u32 vcc, 0x1000000, v66
    ds_add_f32 v123, v124 offset:54272
    ds_add_f32 v123, v125 offset:54276
    s_mov_b64 exec, -1
    v_ashrrev_i32 v122, 5, v67
    v_lshlrev_b16 v123, 2, v67
    v_cndmask_b32 v126, v38, v39, s[66:67]
    v_bitop3_b32 v122, v122, v113, v113 bitop3:0x0c
    v_lshlrev_b32 v124, 16, v126
    v_mul_f32 v122, v114, v122
    v_and_b32 v125, 0xffff0000, v126
    v_add_u32 v123, v123, v123
    v_mul_f32 v124, v122, v124
    v_mul_f32 v125, v122, v125
    v_cmpx_le_u32 vcc, 0x1000000, v67
    ds_add_f32 v123, v124 offset:54272
    ds_add_f32 v123, v125 offset:54276
    s_mov_b64 exec, -1
    v_ashrrev_i32 v122, 5, v68
    v_lshlrev_b16 v123, 2, v68
    v_cndmask_b32 v126, v40, v41, s[66:67]
    v_bitop3_b32 v122, v122, v113, v113 bitop3:0x0c
    v_lshlrev_b32 v124, 16, v126
    v_mul_f32 v122, v114, v122
    v_and_b32 v125, 0xffff0000, v126
    v_add_u32 v123, v123, v123
    v_mul_f32 v124, v122, v124
    v_mul_f32 v125, v122, v125
    v_cmpx_le_u32 vcc, 0x1000000, v68
    ds_add_f32 v123, v124 offset:54272
    ds_add_f32 v123, v125 offset:54276
    s_mov_b64 exec, -1
    s_waitcnt vmcnt(12)
    v_perm_b32 v66, v97, v94, s31
    v_perm_b32 v67, v97, v95, s32
    v_perm_b32 v68, v97, v96, s33
    v_lshlrev_b16 v40, 3, v96
    v_lshlrev_b16 v38, 3, v95
    v_lshlrev_b16 v36, 3, v94
    v_cmpx_ge_u16 vcc, 0x3fff, v66
    ds_read_b64 v[36:37], v36
    s_mov_b64 exec, -1
    v_cmpx_ge_u16 vcc, 0x3fff, v67
    ds_read_b64 v[38:39], v38
    s_mov_b64 exec, -1
    v_cmpx_ge_u16 vcc, 0x3fff, v68
    ds_read_b64 v[40:41], v40
    s_mov_b64 exec, -1
    s_waitcnt lgkmcnt(15)
    v_bfe_u32 v90, v107, 14, 4
    v_lshrrev_b32 v91, 18, v107
    v_and_b32 v107, 0x3fff, v107
    v_mad_u32_u24 v90, v90, s63, v91
    v_lshl_or_b32 v107, v90, 14, v107
    buffer_load_dwordx4 v[90:93], v107, s[68:71], 0 offen
    s_setprio 1
    s_cmp_le_u32 s15, 7
    s_cbranch_scc1 p2_na1a7
    s_waitcnt lgkmcnt(15)
    v_ashrrev_i32 v122, 5, v69
    v_lshlrev_b16 v123, 2, v69
    v_cndmask_b32 v126, v42, v43, s[66:67]
    v_bitop3_b32 v122, v122, v113, v113 bitop3:0x0c
    v_lshlrev_b32 v124, 16, v126
    v_mul_f32 v122, v114, v122
    v_and_b32 v125, 0xffff0000, v126
    v_add_u32 v123, v123, v123
    v_mul_f32 v124, v122, v124
    v_mul_f32 v125, v122, v125
    v_cmpx_le_u32 vcc, 0x1000000, v69
    ds_add_f32 v123, v124 offset:54272
    ds_add_f32 v123, v125 offset:54276
    s_mov_b64 exec, -1
    v_ashrrev_i32 v122, 5, v70
    v_lshlrev_b16 v123, 2, v70
    v_cndmask_b32 v126, v44, v45, s[66:67]
    v_bitop3_b32 v122, v122, v113, v113 bitop3:0x0c
    v_lshlrev_b32 v124, 16, v126
    v_mul_f32 v122, v114, v122
    v_and_b32 v125, 0xffff0000, v126
    v_add_u32 v123, v123, v123
    v_mul_f32 v124, v122, v124
    v_mul_f32 v125, v122, v125
    v_cmpx_le_u32 vcc, 0x1000000, v70
    ds_add_f32 v123, v124 offset:54272
    ds_add_f32 v123, v125 offset:54276
    s_mov_b64 exec, -1
    v_ashrrev_i32 v122, 5, v71
    v_lshlrev_b16 v123, 2, v71
    v_cndmask_b32 v126, v46, v47, s[66:67]
    v_bitop3_b32 v122, v122, v113, v113 bitop3:0x0c
    v_lshlrev_b32 v124, 16, v126
    v_mul_f32 v122, v114, v122
    v_and_b32 v125, 0xffff0000, v126
    v_add_u32 v123, v123, v123
    v_mul_f32 v124, v122, v124
    v_mul_f32 v125, v122, v125
    v_cmpx_le_u32 vcc, 0x1000000, v71
    ds_add_f32 v123, v124 offset:54272
    ds_add_f32 v123, v125 offset:54276
    s_mov_b64 exec, -1
p2_na1a7:
    s_waitcnt vmcnt(12)
    v_perm_b32 v69, v101, v98, s31
    v_perm_b32 v70, v101, v99, s32
    v_perm_b32 v71, v101, v100, s33
    v_lshlrev_b16 v46, 3, v100
    v_lshlrev_b16 v44, 3, v99
    v_lshlrev_b16 v42, 3, v98
    s_cmp_le_u32 s16, 7
    s_cbranch_scc1 p2_g1r07
    v_cmpx_ge_u16 vcc, 0x3fff, v69
    ds_read_b64 v[42:43], v42
    s_mov_b64 exec, -1
    v_cmpx_ge_u16 vcc, 0x3fff, v70
    ds_read_b64 v[44:45], v44
    s_mov_b64 exec, -1
    v_cmpx_ge_u16 vcc, 0x3fff, v71
    ds_read_b64 v[46:47], v46
    s_mov_b64 exec, -1
p2_g1r07:
    s_setprio 0
    s_waitcnt vmcnt(8)
    v_perm_b32 v48, v3, v0, s31
    v_perm_b32 v49, v3, v1, s32
    v_perm_b32 v50, v3, v2, s33
    v_lshlrev_b16 v4, 3, v2
    v_lshlrev_b16 v2, 3, v1
    v_lshlrev_b16 v0, 3, v0
    v_cmpx_ge_u16 vcc, 0x3fff, v48
    ds_read_b64 v[0:1], v0
    s_mov_b64 exec, -1
    v_cmpx_ge_u16 vcc, 0x3fff, v49
    ds_read_b64 v[2:3], v2
    s_mov_b64 exec, -1
    v_cmpx_ge_u16 vcc, 0x3fff, v50
    ds_read_b64 v[4:5], v4
    s_mov_b64 exec, -1
    s_waitcnt vmcnt(7)
    v_perm_b32 v51, v9, v6, s31
    v_perm_b32 v52, v9, v7, s32
    v_perm_b32 v53, v9, v8, s33
    v_lshlrev_b16 v10, 3, v8
    v_lshlrev_b16 v8, 3, v7
    v_lshlrev_b16 v6, 3, v6
    v_cmpx_ge_u16 vcc, 0x3fff, v51
    ds_read_b64 v[6:7], v6
    s_mov_b64 exec, -1
    v_cmpx_ge_u16 vcc, 0x3fff, v52
    ds_read_b64 v[8:9], v8
    s_mov_b64 exec, -1
    v_cmpx_ge_u16 vcc, 0x3fff, v53
    ds_read_b64 v[10:11], v10
    s_mov_b64 exec, -1
    s_waitcnt vmcnt(6)
    v_perm_b32 v54, v15, v12, s31
    v_perm_b32 v55, v15, v13, s32
    v_perm_b32 v56, v15, v14, s33
    v_lshlrev_b16 v16, 3, v14
    v_lshlrev_b16 v14, 3, v13
    v_lshlrev_b16 v12, 3, v12
    v_cmpx_ge_u16 vcc, 0x3fff, v54
    ds_read_b64 v[12:13], v12
    s_mov_b64 exec, -1
    v_cmpx_ge_u16 vcc, 0x3fff, v55
    ds_read_b64 v[14:15], v14
    s_mov_b64 exec, -1
    v_cmpx_ge_u16 vcc, 0x3fff, v56
    ds_read_b64 v[16:17], v16
    s_mov_b64 exec, -1
    s_waitcnt vmcnt(5)
    v_perm_b32 v57, v21, v18, s31
    v_perm_b32 v58, v21, v19, s32
    v_perm_b32 v59, v21, v20, s33
    v_lshlrev_b16 v22, 3, v20
    v_lshlrev_b16 v20, 3, v19
    v_lshlrev_b16 v18, 3, v18
    v_cmpx_ge_u16 vcc, 0x3fff, v57
    ds_read_b64 v[18:19], v18
    s_mov_b64 exec, -1
    v_cmpx_ge_u16 vcc, 0x3fff, v58
    ds_read_b64 v[20:21], v20
    s_mov_b64 exec, -1
    v_cmpx_ge_u16 vcc, 0x3fff, v59
    ds_read_b64 v[22:23], v22
    s_mov_b64 exec, -1
    s_waitcnt lgkmcnt(0)
    s_barrier
    s_waitcnt lgkmcnt(15)
    s_branch p2_tail
p2_drain1:
    v_cmpx_gt_i16 vcc, 0, v48
    ds_read_b64 v[0:1], v0
    s_mov_b64 exec, -1
    v_cmpx_gt_i16 vcc, 0, v49
    ds_read_b64 v[2:3], v2
    s_mov_b64 exec, -1
    v_cmpx_gt_i16 vcc, 0, v50
    ds_read_b64 v[4:5], v4
    s_mov_b64 exec, -1
    v_cmpx_gt_i16 vcc, 0, v51
    ds_read_b64 v[6:7], v6
    s_mov_b64 exec, -1
    v_cmpx_gt_i16 vcc, 0, v52
    ds_read_b64 v[8:9], v8
    s_mov_b64 exec, -1
    v_cmpx_gt_i16 vcc, 0, v53
    ds_read_b64 v[10:11], v10
    s_mov_b64 exec, -1
    v_cmpx_gt_i16 vcc, 0, v54
    ds_read_b64 v[12:13], v12
    s_mov_b64 exec, -1
    v_cmpx_gt_i16 vcc, 0, v55
    ds_read_b64 v[14:15], v14
    s_mov_b64 exec, -1
    v_cmpx_gt_i16 vcc, 0, v56
    ds_read_b64 v[16:17], v16
    s_mov_b64 exec, -1
    v_cmpx_gt_i16 vcc, 0, v57
    ds_read_b64 v[18:19], v18
    s_mov_b64 exec, -1
    v_cmpx_gt_i16 vcc, 0, v58
    ds_read_b64 v[20:21], v20
    s_mov_b64 exec, -1
    v_cmpx_gt_i16 vcc, 0, v59
    ds_read_b64 v[22:23], v22
    s_mov_b64 exec, -1
    v_cmpx_gt_i16 vcc, 0, v60
    ds_read_b64 v[24:25], v24
    s_mov_b64 exec, -1
    v_cmpx_gt_i16 vcc, 0, v61
    ds_read_b64 v[26:27], v26
    s_mov_b64 exec, -1
    v_cmpx_gt_i16 vcc, 0, v62
    ds_read_b64 v[28:29], v28
    s_mov_b64 exec, -1
    v_cmpx_gt_i16 vcc, 0, v63
    ds_read_b64 v[30:31], v30
    s_mov_b64 exec, -1
    v_cmpx_gt_i16 vcc, 0, v64
    ds_read_b64 v[32:33], v32
    s_mov_b64 exec, -1
    v_cmpx_gt_i16 vcc, 0, v65
    ds_read_b64 v[34:35], v34
    s_mov_b64 exec, -1
    v_cmpx_gt_i16 vcc, 0, v66
    ds_read_b64 v[36:37], v36
    s_mov_b64 exec, -1
    v_cmpx_gt_i16 vcc, 0, v67
    ds_read_b64 v[38:39], v38
    s_mov_b64 exec, -1
    v_cmpx_gt_i16 vcc, 0, v68
    ds_read_b64 v[40:41], v40
    s_mov_b64 exec, -1
    s_cmp_le_u32 s15, 7
    s_cbranch_scc1 p2_gd1
    v_cmpx_gt_i16 vcc, 0, v69
    ds_read_b64 v[42:43], v42
    s_mov_b64 exec, -1
    v_cmpx_gt_i16 vcc, 0, v70
    ds_read_b64 v[44:45], v44
    s_mov_b64 exec, -1
    v_cmpx_gt_i16 vcc, 0, v71
    ds_read_b64 v[46:47], v46
    s_mov_b64 exec, -1
p2_gd1:
    s_waitcnt lgkmcnt(15)
    v_ashrrev_i32 v122, 5, v48
    v_lshlrev_b16 v123, 2, v48
    v_cndmask_b32 v126, v0, v1, s[66:67]
    v_bitop3_b32 v122, v122, v113, v113 bitop3:0x0c
    v_lshlrev_b32 v124, 16, v126
    v_mul_f32 v122, v114, v122
    v_and_b32 v125, 0xffff0000, v126
    v_add_u32 v123, v123, v123
    v_mul_f32 v124, v122, v124
    v_mul_f32 v125, v122, v125
    v_cmpx_le_u32 vcc, 0x1000000, v48
    ds_add_f32 v123, v124 offset:54272
    ds_add_f32 v123, v125 offset:54276
    s_mov_b64 exec, -1
    v_ashrrev_i32 v122, 5, v49
    v_lshlrev_b16 v123, 2, v49
    v_cndmask_b32 v126, v2, v3, s[66:67]
    v_bitop3_b32 v122, v122, v113, v113 bitop3:0x0c
    v_lshlrev_b32 v124, 16, v126
    v_mul_f32 v122, v114, v122
    v_and_b32 v125, 0xffff0000, v126
    v_add_u32 v123, v123, v123
    v_mul_f32 v124, v122, v124
    v_mul_f32 v125, v122, v125
    v_cmpx_le_u32 vcc, 0x1000000, v49
    ds_add_f32 v123, v124 offset:54272
    ds_add_f32 v123, v125 offset:54276
    s_mov_b64 exec, -1
    v_ashrrev_i32 v122, 5, v50
    v_lshlrev_b16 v123, 2, v50
    v_cndmask_b32 v126, v4, v5, s[66:67]
    v_bitop3_b32 v122, v122, v113, v113 bitop3:0x0c
    v_lshlrev_b32 v124, 16, v126
    v_mul_f32 v122, v114, v122
    v_and_b32 v125, 0xffff0000, v126
    v_add_u32 v123, v123, v123
    v_mul_f32 v124, v122, v124
    v_mul_f32 v125, v122, v125
    v_cmpx_le_u32 vcc, 0x1000000, v50
    ds_add_f32 v123, v124 offset:54272
    ds_add_f32 v123, v125 offset:54276
    s_mov_b64 exec, -1
    s_waitcnt lgkmcnt(15)
    v_ashrrev_i32 v122, 5, v51
    v_lshlrev_b16 v123, 2, v51
    v_cndmask_b32 v126, v6, v7, s[66:67]
    v_bitop3_b32 v122, v122, v113, v113 bitop3:0x0c
    v_lshlrev_b32 v124, 16, v126
    v_mul_f32 v122, v114, v122
    v_and_b32 v125, 0xffff0000, v126
    v_add_u32 v123, v123, v123
    v_mul_f32 v124, v122, v124
    v_mul_f32 v125, v122, v125
    v_cmpx_le_u32 vcc, 0x1000000, v51
    ds_add_f32 v123, v124 offset:54272
    ds_add_f32 v123, v125 offset:54276
    s_mov_b64 exec, -1
    v_ashrrev_i32 v122, 5, v52
    v_lshlrev_b16 v123, 2, v52
    v_cndmask_b32 v126, v8, v9, s[66:67]
    v_bitop3_b32 v122, v122, v113, v113 bitop3:0x0c
    v_lshlrev_b32 v124, 16, v126
    v_mul_f32 v122, v114, v122
    v_and_b32 v125, 0xffff0000, v126
    v_add_u32 v123, v123, v123
    v_mul_f32 v124, v122, v124
    v_mul_f32 v125, v122, v125
    v_cmpx_le_u32 vcc, 0x1000000, v52
    ds_add_f32 v123, v124 offset:54272
    ds_add_f32 v123, v125 offset:54276
    s_mov_b64 exec, -1
    v_ashrrev_i32 v122, 5, v53
    v_lshlrev_b16 v123, 2, v53
    v_cndmask_b32 v126, v10, v11, s[66:67]
    v_bitop3_b32 v122, v122, v113, v113 bitop3:0x0c
    v_lshlrev_b32 v124, 16, v126
    v_mul_f32 v122, v114, v122
    v_and_b32 v125, 0xffff0000, v126
    v_add_u32 v123, v123, v123
    v_mul_f32 v124, v122, v124
    v_mul_f32 v125, v122, v125
    v_cmpx_le_u32 vcc, 0x1000000, v53
    ds_add_f32 v123, v124 offset:54272
    ds_add_f32 v123, v125 offset:54276
    s_mov_b64 exec, -1
    s_waitcnt lgkmcnt(15)
    v_ashrrev_i32 v122, 5, v54
    v_lshlrev_b16 v123, 2, v54
    v_cndmask_b32 v126, v12, v13, s[66:67]
    v_bitop3_b32 v122, v122, v113, v113 bitop3:0x0c
    v_lshlrev_b32 v124, 16, v126
    v_mul_f32 v122, v114, v122
    v_and_b32 v125, 0xffff0000, v126
    v_add_u32 v123, v123, v123
    v_mul_f32 v124, v122, v124
    v_mul_f32 v125, v122, v125
    v_cmpx_le_u32 vcc, 0x1000000, v54
    ds_add_f32 v123, v124 offset:54272
    ds_add_f32 v123, v125 offset:54276
    s_mov_b64 exec, -1
    v_ashrrev_i32 v122, 5, v55
    v_lshlrev_b16 v123, 2, v55
    v_cndmask_b32 v126, v14, v15, s[66:67]
    v_bitop3_b32 v122, v122, v113, v113 bitop3:0x0c
    v_lshlrev_b32 v124, 16, v126
    v_mul_f32 v122, v114, v122
    v_and_b32 v125, 0xffff0000, v126
    v_add_u32 v123, v123, v123
    v_mul_f32 v124, v122, v124
    v_mul_f32 v125, v122, v125
    v_cmpx_le_u32 vcc, 0x1000000, v55
    ds_add_f32 v123, v124 offset:54272
    ds_add_f32 v123, v125 offset:54276
    s_mov_b64 exec, -1
    v_ashrrev_i32 v122, 5, v56
    v_lshlrev_b16 v123, 2, v56
    v_cndmask_b32 v126, v16, v17, s[66:67]
    v_bitop3_b32 v122, v122, v113, v113 bitop3:0x0c
    v_lshlrev_b32 v124, 16, v126
    v_mul_f32 v122, v114, v122
    v_and_b32 v125, 0xffff0000, v126
    v_add_u32 v123, v123, v123
    v_mul_f32 v124, v122, v124
    v_mul_f32 v125, v122, v125
    v_cmpx_le_u32 vcc, 0x1000000, v56
    ds_add_f32 v123, v124 offset:54272
    ds_add_f32 v123, v125 offset:54276
    s_mov_b64 exec, -1
    s_waitcnt lgkmcnt(15)
    v_ashrrev_i32 v122, 5, v57
    v_lshlrev_b16 v123, 2, v57
    v_cndmask_b32 v126, v18, v19, s[66:67]
    v_bitop3_b32 v122, v122, v113, v113 bitop3:0x0c
    v_lshlrev_b32 v124, 16, v126
    v_mul_f32 v122, v114, v122
    v_and_b32 v125, 0xffff0000, v126
    v_add_u32 v123, v123, v123
    v_mul_f32 v124, v122, v124
    v_mul_f32 v125, v122, v125
    v_cmpx_le_u32 vcc, 0x1000000, v57
    ds_add_f32 v123, v124 offset:54272
    ds_add_f32 v123, v125 offset:54276
    s_mov_b64 exec, -1
    v_ashrrev_i32 v122, 5, v58
    v_lshlrev_b16 v123, 2, v58
    v_cndmask_b32 v126, v20, v21, s[66:67]
    v_bitop3_b32 v122, v122, v113, v113 bitop3:0x0c
    v_lshlrev_b32 v124, 16, v126
    v_mul_f32 v122, v114, v122
    v_and_b32 v125, 0xffff0000, v126
    v_add_u32 v123, v123, v123
    v_mul_f32 v124, v122, v124
    v_mul_f32 v125, v122, v125
    v_cmpx_le_u32 vcc, 0x1000000, v58
    ds_add_f32 v123, v124 offset:54272
    ds_add_f32 v123, v125 offset:54276
    s_mov_b64 exec, -1
    v_ashrrev_i32 v122, 5, v59
    v_lshlrev_b16 v123, 2, v59
    v_cndmask_b32 v126, v22, v23, s[66:67]
    v_bitop3_b32 v122, v122, v113, v113 bitop3:0x0c
    v_lshlrev_b32 v124, 16, v126
    v_mul_f32 v122, v114, v122
    v_and_b32 v125, 0xffff0000, v126
    v_add_u32 v123, v123, v123
    v_mul_f32 v124, v122, v124
    v_mul_f32 v125, v122, v125
    v_cmpx_le_u32 vcc, 0x1000000, v59
    ds_add_f32 v123, v124 offset:54272
    ds_add_f32 v123, v125 offset:54276
    s_mov_b64 exec, -1
    s_waitcnt lgkmcnt(15)
    v_ashrrev_i32 v122, 5, v60
    v_lshlrev_b16 v123, 2, v60
    v_cndmask_b32 v126, v24, v25, s[66:67]
    v_bitop3_b32 v122, v122, v113, v113 bitop3:0x0c
    v_lshlrev_b32 v124, 16, v126
    v_mul_f32 v122, v114, v122
    v_and_b32 v125, 0xffff0000, v126
    v_add_u32 v123, v123, v123
    v_mul_f32 v124, v122, v124
    v_mul_f32 v125, v122, v125
    v_cmpx_le_u32 vcc, 0x1000000, v60
    ds_add_f32 v123, v124 offset:54272
    ds_add_f32 v123, v125 offset:54276
    s_mov_b64 exec, -1
    v_ashrrev_i32 v122, 5, v61
    v_lshlrev_b16 v123, 2, v61
    v_cndmask_b32 v126, v26, v27, s[66:67]
    v_bitop3_b32 v122, v122, v113, v113 bitop3:0x0c
    v_lshlrev_b32 v124, 16, v126
    v_mul_f32 v122, v114, v122
    v_and_b32 v125, 0xffff0000, v126
    v_add_u32 v123, v123, v123
    v_mul_f32 v124, v122, v124
    v_mul_f32 v125, v122, v125
    v_cmpx_le_u32 vcc, 0x1000000, v61
    ds_add_f32 v123, v124 offset:54272
    ds_add_f32 v123, v125 offset:54276
    s_mov_b64 exec, -1
    v_ashrrev_i32 v122, 5, v62
    v_lshlrev_b16 v123, 2, v62
    v_cndmask_b32 v126, v28, v29, s[66:67]
    v_bitop3_b32 v122, v122, v113, v113 bitop3:0x0c
    v_lshlrev_b32 v124, 16, v126
    v_mul_f32 v122, v114, v122
    v_and_b32 v125, 0xffff0000, v126
    v_add_u32 v123, v123, v123
    v_mul_f32 v124, v122, v124
    v_mul_f32 v125, v122, v125
    v_cmpx_le_u32 vcc, 0x1000000, v62
    ds_add_f32 v123, v124 offset:54272
    ds_add_f32 v123, v125 offset:54276
    s_mov_b64 exec, -1
    s_waitcnt lgkmcnt(15)
    v_ashrrev_i32 v122, 5, v63
    v_lshlrev_b16 v123, 2, v63
    v_cndmask_b32 v126, v30, v31, s[66:67]
    v_bitop3_b32 v122, v122, v113, v113 bitop3:0x0c
    v_lshlrev_b32 v124, 16, v126
    v_mul_f32 v122, v114, v122
    v_and_b32 v125, 0xffff0000, v126
    v_add_u32 v123, v123, v123
    v_mul_f32 v124, v122, v124
    v_mul_f32 v125, v122, v125
    v_cmpx_le_u32 vcc, 0x1000000, v63
    ds_add_f32 v123, v124 offset:54272
    ds_add_f32 v123, v125 offset:54276
    s_mov_b64 exec, -1
    v_ashrrev_i32 v122, 5, v64
    v_lshlrev_b16 v123, 2, v64
    v_cndmask_b32 v126, v32, v33, s[66:67]
    v_bitop3_b32 v122, v122, v113, v113 bitop3:0x0c
    v_lshlrev_b32 v124, 16, v126
    v_mul_f32 v122, v114, v122
    v_and_b32 v125, 0xffff0000, v126
    v_add_u32 v123, v123, v123
    v_mul_f32 v124, v122, v124
    v_mul_f32 v125, v122, v125
    v_cmpx_le_u32 vcc, 0x1000000, v64
    ds_add_f32 v123, v124 offset:54272
    ds_add_f32 v123, v125 offset:54276
    s_mov_b64 exec, -1
    v_ashrrev_i32 v122, 5, v65
    v_lshlrev_b16 v123, 2, v65
    v_cndmask_b32 v126, v34, v35, s[66:67]
    v_bitop3_b32 v122, v122, v113, v113 bitop3:0x0c
    v_lshlrev_b32 v124, 16, v126
    v_mul_f32 v122, v114, v122
    v_and_b32 v125, 0xffff0000, v126
    v_add_u32 v123, v123, v123
    v_mul_f32 v124, v122, v124
    v_mul_f32 v125, v122, v125
    v_cmpx_le_u32 vcc, 0x1000000, v65
    ds_add_f32 v123, v124 offset:54272
    ds_add_f32 v123, v125 offset:54276
    s_mov_b64 exec, -1
    s_waitcnt lgkmcnt(15)
    v_ashrrev_i32 v122, 5, v66
    v_lshlrev_b16 v123, 2, v66
    v_cndmask_b32 v126, v36, v37, s[66:67]
    v_bitop3_b32 v122, v122, v113, v113 bitop3:0x0c
    v_lshlrev_b32 v124, 16, v126
    v_mul_f32 v122, v114, v122
    v_and_b32 v125, 0xffff0000, v126
    v_add_u32 v123, v123, v123
    v_mul_f32 v124, v122, v124
    v_mul_f32 v125, v122, v125
    v_cmpx_le_u32 vcc, 0x1000000, v66
    ds_add_f32 v123, v124 offset:54272
    ds_add_f32 v123, v125 offset:54276
    s_mov_b64 exec, -1
    v_ashrrev_i32 v122, 5, v67
    v_lshlrev_b16 v123, 2, v67
    v_cndmask_b32 v126, v38, v39, s[66:67]
    v_bitop3_b32 v122, v122, v113, v113 bitop3:0x0c
    v_lshlrev_b32 v124, 16, v126
    v_mul_f32 v122, v114, v122
    v_and_b32 v125, 0xffff0000, v126
    v_add_u32 v123, v123, v123
    v_mul_f32 v124, v122, v124
    v_mul_f32 v125, v122, v125
    v_cmpx_le_u32 vcc, 0x1000000, v67
    ds_add_f32 v123, v124 offset:54272
    ds_add_f32 v123, v125 offset:54276
    s_mov_b64 exec, -1
    v_ashrrev_i32 v122, 5, v68
    v_lshlrev_b16 v123, 2, v68
    v_cndmask_b32 v126, v40, v41, s[66:67]
    v_bitop3_b32 v122, v122, v113, v113 bitop3:0x0c
    v_lshlrev_b32 v124, 16, v126
    v_mul_f32 v122, v114, v122
    v_and_b32 v125, 0xffff0000, v126
    v_add_u32 v123, v123, v123
    v_mul_f32 v124, v122, v124
    v_mul_f32 v125, v122, v125
    v_cmpx_le_u32 vcc, 0x1000000, v68
    ds_add_f32 v123, v124 offset:54272
    ds_add_f32 v123, v125 offset:54276
    s_mov_b64 exec, -1
    s_cmp_le_u32 s15, 7
    s_cbranch_scc1 p2_nad1
    s_waitcnt lgkmcnt(15)
    v_ashrrev_i32 v122, 5, v69
    v_lshlrev_b16 v123, 2, v69
    v_cndmask_b32 v126, v42, v43, s[66:67]
    v_bitop3_b32 v122, v122, v113, v113 bitop3:0x0c
    v_lshlrev_b32 v124, 16, v126
    v_mul_f32 v122, v114, v122
    v_and_b32 v125, 0xffff0000, v126
    v_add_u32 v123, v123, v123
    v_mul_f32 v124, v122, v124
    v_mul_f32 v125, v122, v125
    v_cmpx_le_u32 vcc, 0x1000000, v69
    ds_add_f32 v123, v124 offset:54272
    ds_add_f32 v123, v125 offset:54276
    s_mov_b64 exec, -1
    v_ashrrev_i32 v122, 5, v70
    v_lshlrev_b16 v123, 2, v70
    v_cndmask_b32 v126, v44, v45, s[66:67]
    v_bitop3_b32 v122, v122, v113, v113 bitop3:0x0c
    v_lshlrev_b32 v124, 16, v126
    v_mul_f32 v122, v114, v122
    v_and_b32 v125, 0xffff0000, v126
    v_add_u32 v123, v123, v123
    v_mul_f32 v124, v122, v124
    v_mul_f32 v125, v122, v125
    v_cmpx_le_u32 vcc, 0x1000000, v70
    ds_add_f32 v123, v124 offset:54272
    ds_add_f32 v123, v125 offset:54276
    s_mov_b64 exec, -1
    v_ashrrev_i32 v122, 5, v71
    v_lshlrev_b16 v123, 2, v71
    v_cndmask_b32 v126, v46, v47, s[66:67]
    v_bitop3_b32 v122, v122, v113, v113 bitop3:0x0c
    v_lshlrev_b32 v124, 16, v126
    v_mul_f32 v122, v114, v122
    v_and_b32 v125, 0xffff0000, v126
    v_add_u32 v123, v123, v123
    v_mul_f32 v124, v122, v124
    v_mul_f32 v125, v122, v125
    v_cmpx_le_u32 vcc, 0x1000000, v71
    ds_add_f32 v123, v124 offset:54272
    ds_add_f32 v123, v125 offset:54276
    s_mov_b64 exec, -1
p2_nad1:
    s_branch p2_fin
p2_tail:
    s_mov_b32 s60, s61
    s_mov_b32 s15, s16
    s_mov_b32 s16, s17
    v_mov_b32 v122, s19
    s_xor_b32 s19, s19, 4
    ds_read_b32 v125, v122 offset:53760
    v_mov_b32 v123, s19
    v_mov_b32 v124, 0
    ds_write_b32 v123, v124 offset:53760
    s_waitcnt vmcnt(2)
    s_mov_b32 m0, s24
    s_cmp_ge_u32 s10, 9
    s_cbranch_scc1 p2_st2s1
    ds_write_addtid_b32 v84 offset:49152
    ds_write_addtid_b32 v85 offset:49408
p2_st2s1:
    s_mov_b32 m0, s23
    s_add_u32 s20, s20, 53760
    ds_write_addtid_b32 v72 offset:0
    ds_write_addtid_b32 v73 offset:256
    ds_write_addtid_b32 v74 offset:512
    ds_write_addtid_b32 v75 offset:768
    ds_write_addtid_b32 v76 offset:1024
    ds_write_addtid_b32 v77 offset:1280
    ds_write_addtid_b32 v78 offset:1536
    ds_write_addtid_b32 v79 offset:1792
    ds_write_addtid_b32 v80 offset:2048
    ds_write_addtid_b32 v81 offset:2304
    ds_write_addtid_b32 v82 offset:2560
    ds_write_addtid_b32 v83 offset:2816
    s_cmp_ge_u32 s10, 9
    s_cbranch_scc1 p2_nm2m2a
    v_lshrrev_b32 v84, 1, v112
    s_add_u32 s44, s20, s42
    buffer_load_dwordx2 v[84:85], v84, s[4:7], s44 offen
p2_nm2m2a:
    buffer_load_dwordx4 v[72:75], v112, s[4:7], s20 offen offset:0
    buffer_load_dwordx4 v[76:79], v112, s[4:7], s20 offen offset:1024
    buffer_load_dwordx4 v[80:83], v112, s[4:7], s20 offen offset:2048
    s_waitcnt lgkmcnt(0)
    s_barrier
    s_setprio 3
    v_cmpx_lt_i16 vcc, 0x3fff, v48
    ds_read_b64 v[0:1], v0
    s_mov_b64 exec, -1
    v_cmpx_lt_i16 vcc, 0x3fff, v49
    ds_read_b64 v[2:3], v2
    s_mov_b64 exec, -1
    v_cmpx_lt_i16 vcc, 0x3fff, v50
    ds_read_b64 v[4:5], v4
    s_mov_b64 exec, -1
    v_cmpx_lt_i16 vcc, 0x3fff, v51
    ds_read_b64 v[6:7], v6
    s_mov_b64 exec, -1
    v_cmpx_lt_i16 vcc, 0x3fff, v52
    ds_read_b64 v[8:9], v8
    s_mov_b64 exec, -1
    v_cmpx_lt_i16 vcc, 0x3fff, v53
    ds_read_b64 v[10:11], v10
    s_mov_b64 exec, -1
    s_waitcnt lgkmcnt(15)
    v_readfirstlane_b32 s44, v125
    s_nop 0
    s_cmp_lg_u32 s44, 0
    s_cbranch_scc1 p2_advb
    s_add_u32 s61, s61, 1
    s_min_u32 s61, s61, 10
    v_mov_b32 v110, 0
    v_mov_b32 v111, 0
    s_cmp_eq_u32 s61, 10
    s_cbranch_scc1 p2_advb
    s_add_u32 s44, s61, s18
    s_cmp_ge_u32 s44, 10
    s_cselect_b32 s53, 10, 0
    s_sub_u32 s44, s44, s53
    s_mul_i32 s44, s44, 4160
    s_add_u32 s44, s44, s40
    v_bfe_i32 v111, v112, 6, 1
    v_lshrrev_b32 v110, 6, v112
    v_bitop3_b32 v111, v111, 15, s10 bitop3:0x6a
    v_lshl_or_b32 v110, v110, 4, v111
    v_bfe_u32 v111, v112, 2, 4
    v_mul_u32_u24 v110, 41600, v110
    v_add_u32 v111, v110, v111
    v_add_u32 v110, 256, v112
    v_and_b32 v110, 0x400, v110
    v_lshl_or_b32 v111, v110, 20, v111
    buffer_load_dword v110, v111, s[4:7], s44 offen
    buffer_load_dword v111, v111, s[4:7], s44 offen offset:16
p2_advb:
    s_cmp_lg_u32 s10, 15
    s_cbranch_scc1 p2_ntg
    s_lshr_b32 s44, s2, 3
    s_mul_i32 s44, s44, 5120
    s_add_u32 s45, s60, s18
    s_cmp_ge_u32 s45, 10
    s_cselect_b32 s53, 10, 0
    s_sub_u32 s45, s45, s53
    s_mul_i32 s45, s45, 645120
    s_add_u32 s44, s44, s45
    s_add_u32 s44, s44, s62
    s_sub_u32 s44, s44, s23
    v_lshlrev_b32 v84, 3, v112
    s_mov_b32 exec_hi, 0xff
    buffer_load_dword v85, v84, s[4:7], s44 offen
    s_mov_b64 exec, -1
p2_ntg:
    v_cmpx_lt_i16 vcc, 0x3fff, v54
    ds_read_b64 v[12:13], v12
    s_mov_b64 exec, -1
    v_cmpx_lt_i16 vcc, 0x3fff, v55
    ds_read_b64 v[14:15], v14
    s_mov_b64 exec, -1
    v_cmpx_lt_i16 vcc, 0x3fff, v56
    ds_read_b64 v[16:17], v16
    s_mov_b64 exec, -1
    v_cmpx_lt_i16 vcc, 0x3fff, v57
    ds_read_b64 v[18:19], v18
    s_mov_b64 exec, -1
    v_cmpx_lt_i16 vcc, 0x3fff, v58
    ds_read_b64 v[20:21], v20
    s_mov_b64 exec, -1
    v_cmpx_lt_i16 vcc, 0x3fff, v59
    ds_read_b64 v[22:23], v22
    s_mov_b64 exec, -1
    v_bfe_u32 v94, v108, 14, 4
    v_lshrrev_b32 v95, 18, v108
    v_and_b32 v108, 0x3fff, v108
    v_mad_u32_u24 v94, v94, s63, v95
    v_lshl_or_b32 v108, v94, 14, v108
    buffer_load_dwordx4 v[94:97], v108, s[68:71], 0 offen
    s_setprio 1
    v_cmpx_lt_i16 vcc, 0x3fff, v60
    ds_read_b64 v[24:25], v24
    s_mov_b64 exec, -1
    v_cmpx_lt_i16 vcc, 0x3fff, v61
    ds_read_b64 v[26:27], v26
    s_mov_b64 exec, -1
    v_cmpx_lt_i16 vcc, 0x3fff, v62
    ds_read_b64 v[28:29], v28
    s_mov_b64 exec, -1
    v_cmpx_lt_i16 vcc, 0x3fff, v63
    ds_read_b64 v[30:31], v30
    s_mov_b64 exec, -1
    v_cmpx_lt_i16 vcc, 0x3fff, v64
    ds_read_b64 v[32:33], v32
    s_mov_b64 exec, -1
    v_cmpx_lt_i16 vcc, 0x3fff, v65
    ds_read_b64 v[34:35], v34
    s_mov_b64 exec, -1
    v_cmpx_lt_i16 vcc, 0x3fff, v66
    ds_read_b64 v[36:37], v36
    s_mov_b64 exec, -1
    v_cmpx_lt_i16 vcc, 0x3fff, v67
    ds_read_b64 v[38:39], v38
    s_mov_b64 exec, -1
    v_cmpx_lt_i16 vcc, 0x3fff, v68
    ds_read_b64 v[40:41], v40
    s_mov_b64 exec, -1
    s_cmp_le_u32 s15, 7
    s_cbranch_scc1 p2_g2r17
    v_cmpx_lt_i16 vcc, 0x3fff, v69
    ds_read_b64 v[42:43], v42
    s_mov_b64 exec, -1
    v_cmpx_lt_i16 vcc, 0x3fff, v70
    ds_read_b64 v[44:45], v44
    s_mov_b64 exec, -1
    v_cmpx_lt_i16 vcc, 0x3fff, v71
    ds_read_b64 v[46:47], v46
    s_mov_b64 exec, -1
p2_g2r17:
    v_bfe_u32 v98, v109, 14, 4
    v_lshrrev_b32 v99, 18, v109
    v_and_b32 v109, 0x3fff, v109
    v_mad_u32_u24 v98, v98, s63, v99
    v_lshl_or_b32 v109, v98, 14, v109
    buffer_load_dwordx4 v[98:101], v109, s[68:71], 0 offen
    s_waitcnt lgkmcnt(0)
    s_barrier
    s_waitcnt vmcnt(2)
    s_mov_b32 m0, s24
    s_cmp_ge_u32 s10, 9
    s_cbranch_scc1 p2_st2s2
    ds_write_addtid_b32 v84 offset:49152
    ds_write_addtid_b32 v85 offset:49408
p2_st2s2:
    s_mov_b32 m0, s23
    s_add_u32 s20, s60, s18
    s_cmp_ge_u32 s20, 10
    s_cselect_b32 s53, 10, 0
    s_sub_u32 s20, s20, s53
    s_mul_i32 s20, s20, 645120
    s_add_u32 s20, s20, s62
    ds_write_addtid_b32 v72 offset:0
    ds_write_addtid_b32 v73 offset:256
    ds_write_addtid_b32 v74 offset:512
    ds_write_addtid_b32 v75 offset:768
    ds_write_addtid_b32 v76 offset:1024
    ds_write_addtid_b32 v77 offset:1280
    ds_write_addtid_b32 v78 offset:1536
    ds_write_addtid_b32 v79 offset:1792
    ds_write_addtid_b32 v80 offset:2048
    ds_write_addtid_b32 v81 offset:2304
    ds_write_addtid_b32 v82 offset:2560
    ds_write_addtid_b32 v83 offset:2816
    s_waitcnt lgkmcnt(0)
    s_barrier
    s_branch p2_top
p2_fin:
    s_waitcnt vmcnt(0) lgkmcnt(0)
    s_barrier
    s_mov_b32 s48, s11
    s_mul_i32 s44, s48, 800768
    s_mul_i32 s45, s12, 12512
    s_add_u32 s49, s44, s45
    s_lshl_b32 s44, s49, 3
    s_add_u32 s44, s44, 492278784
    s_lshl_b32 s48, s48, 2
    s_lshl_b32 s45, s12, 4
    s_add_u32 s48, s48, s45
    s_add_u32 s48, s48, 492277760
    v_add_u32 v123, s64, v112
    v_add_u32 v122, s25, v123
    v_mov_b32 v24, 0
    v_mov_b32 v25, 0
    v_mov_b32 v26, 0
    v_mov_b32 v27, 0
    v_cmp_gt_u32 vcc, 1792, v123
    v_mov_b32 v124, 0x38000000
    v_mov_b32 v126, 0
    v_cndmask_b32 v124, v124, v123, vcc
    ds_read_b128 v[0:3], v122 offset:0
    ds_read_b128 v[4:7], v122 offset:16384
    ds_read_b128 v[8:11], v122 offset:32768
    v_add_u32 v122, 49152, v122
    ds_read_b128 v[12:15], v122 offset:0
    ds_read_b128 v[16:19], v122 offset:16384
    ds_read_b128 v[20:23], v122 offset:32768
    s_mov_b64 exec, vcc
    ds_read_b128 v[24:27], v122 offset:49152
    s_mov_b64 exec, -1
    s_cmp_lg_u32 s21, 0
    s_cbranch_scc1 p2_finf
    s_waitcnt lgkmcnt(6)
    buffer_store_dwordx4 v[0:3], v123, s[4:7], s44 offen nt
    s_add_u32 s44, s44, 16384
    s_waitcnt lgkmcnt(5)
    buffer_store_dwordx4 v[4:7], v123, s[4:7], s44 offen nt
    s_add_u32 s44, s44, 16384
    s_waitcnt lgkmcnt(4)
    buffer_store_dwordx4 v[8:11], v123, s[4:7], s44 offen nt
    s_add_u32 s44, s44, 16384
    s_waitcnt lgkmcnt(3)
    buffer_store_dwordx4 v[12:15], v123, s[4:7], s44 offen nt
    s_add_u32 s44, s44, 16384
    s_waitcnt lgkmcnt(2)
    buffer_store_dwordx4 v[16:19], v123, s[4:7], s44 offen nt
    s_add_u32 s44, s44, 16384
    s_waitcnt lgkmcnt(1)
    buffer_store_dwordx4 v[20:23], v123, s[4:7], s44 offen nt
    s_add_u32 s44, s44, 16384
    s_waitcnt lgkmcnt(0)
    buffer_store_dwordx4 v[24:27], v124, s[4:7], s44 offen nt
    s_add_u32 s44, s44, 16384
    v_bitop3_b32 v115, v115, v0, v1 bitop3:0xfe
    v_bitop3_b32 v115, v115, v2, v3 bitop3:0xfe
    v_bitop3_b32 v115, v115, v4, v5 bitop3:0xfe
    v_bitop3_b32 v115, v115, v6, v7 bitop3:0xfe
    v_bitop3_b32 v115, v115, v8, v9 bitop3:0xfe
    v_bitop3_b32 v115, v115, v10, v11 bitop3:0xfe
    v_bitop3_b32 v115, v115, v12, v13 bitop3:0xfe
    v_bitop3_b32 v115, v115, v14, v15 bitop3:0xfe
    v_bitop3_b32 v115, v115, v16, v17 bitop3:0xfe
    v_bitop3_b32 v115, v115, v18, v19 bitop3:0xfe
    v_bitop3_b32 v115, v115, v20, v21 bitop3:0xfe
    v_bitop3_b32 v115, v115, v22, v23 bitop3:0xfe
    v_bitop3_b32 v115, v115, v24, v25 bitop3:0xfe
    v_bitop3_b32 v115, v115, v26, v27 bitop3:0xfe
    v_bitop3_b32 v115, v115, v116, v117 bitop3:0xfe
    v_bitop3_b32 v115, v115, v118, v119 bitop3:0xfe
    v_bitop3_b32 v115, v115, v120, v121 bitop3:0xfe
    v_and_b32 v115, 0x80008000, v115
    v_cmpx_ne_u32 vcc, 0, v115
    ds_write_b32 v126, v115 offset:53768
    s_mov_b64 exec, -1
    s_waitcnt lgkmcnt(0)
    s_barrier
    ds_read_b32 v125, v126 offset:53768
    s_waitcnt lgkmcnt(0)
    v_readfirstlane_b32 s45, v125
    s_nop 0
    s_cmp_eq_u32 s45, 0
    s_cbranch_scc1 p2_done
    s_mov_b32 s21, 1
    s_waitcnt vmcnt(0)
    s_branch p2_restart
p2_finf:
    s_lshl_b32 s49, s49, 4
    s_lshl_b32 s45, s21, 3
    s_add_u32 s49, s49, s45
    s_add_u32 s49, s49, 517903352
    v_mov_b32 v28, 1073758208
    v_mov_b32 v29, 1073758208
    v_mov_b32 v30, 1073758208
    v_mov_b32 v31, 1073758208
    v_lshlrev_b32 v122, 1, v123
    v_lshlrev_b32 v125, 1, v124
    s_waitcnt lgkmcnt(0)
    buffer_store_dwordx4 v[28:31], v123, s[4:7], s44 offen
    s_add_u32 s44, s44, 16384
    buffer_store_dwordx2 v[0:1], v122, s[4:7], s49 offen offset:0
    buffer_store_dwordx2 v[2:3], v122, s[4:7], s49 offen offset:16
    s_add_u32 s49, s49, 32768
    buffer_store_dwordx4 v[28:31], v123, s[4:7], s44 offen
    s_add_u32 s44, s44, 16384
    buffer_store_dwordx2 v[4:5], v122, s[4:7], s49 offen offset:0
    buffer_store_dwordx2 v[6:7], v122, s[4:7], s49 offen offset:16
    s_add_u32 s49, s49, 32768
    buffer_store_dwordx4 v[28:31], v123, s[4:7], s44 offen
    s_add_u32 s44, s44, 16384
    buffer_store_dwordx2 v[8:9], v122, s[4:7], s49 offen offset:0
    buffer_store_dwordx2 v[10:11], v122, s[4:7], s49 offen offset:16
    s_add_u32 s49, s49, 32768
    buffer_store_dwordx4 v[28:31], v123, s[4:7], s44 offen
    s_add_u32 s44, s44, 16384
    buffer_store_dwordx2 v[12:13], v122, s[4:7], s49 offen offset:0
    buffer_store_dwordx2 v[14:15], v122, s[4:7], s49 offen offset:16
    s_add_u32 s49, s49, 32768
    buffer_store_dwordx4 v[28:31], v123, s[4:7], s44 offen
    s_add_u32 s44, s44, 16384
    buffer_store_dwordx2 v[16:17], v122, s[4:7], s49 offen offset:0
    buffer_store_dwordx2 v[18:19], v122, s[4:7], s49 offen offset:16
    s_add_u32 s49, s49, 32768
    buffer_store_dwordx4 v[28:31], v123, s[4:7], s44 offen
    s_add_u32 s44, s44, 16384
    buffer_store_dwordx2 v[20:21], v122, s[4:7], s49 offen offset:0
    buffer_store_dwordx2 v[22:23], v122, s[4:7], s49 offen offset:16
    s_add_u32 s49, s49, 32768
    buffer_store_dwordx4 v[28:31], v124, s[4:7], s44 offen
    s_add_u32 s44, s44, 16384
    buffer_store_dwordx2 v[24:25], v125, s[4:7], s49 offen offset:0
    buffer_store_dwordx2 v[26:27], v125, s[4:7], s49 offen offset:16
    s_add_u32 s49, s49, 32768
    s_add_u32 s21, s21, 1
    s_mov_b32 s30, 0
    s_waitcnt vmcnt(0)
    s_cmp_eq_u32 s21, 2
    s_cbranch_scc1 p2_restart
p2_done:
    v_mov_b32 v125, s30
    buffer_store_dword v125, v126, s[4:7], s48 offen
p2_end:
    s_endpgm
.globl p3_kernel
.p2align 8
.type p3_kernel,@function
p3_kernel:
    s_cmp_ge_u32 s2, 1563
    s_cbranch_scc1 p3_end
    s_load_dwordx2 s[4:5], s[0:1], 0
    s_load_dwordx2 s[6:7], s[0:1], 24
    s_load_dwordx2 s[8:9], s[0:1], 40
    s_load_dwordx8 s[12:19], s[0:1], 56
    s_load_dwordx2 s[10:11], s[0:1], 88
    s_load_dwordx2 s[20:21], s[0:1], 104
    s_lshl_b32 s3, s2, 8
    v_add_u32 v0, s3, v0
    v_lshlrev_b32 v2, 4, v0
    v_lshlrev_b32 v3, 2, v0
    v_add_u32 v0, v0, v0
    v_mul_hi_u32_u24 v1, 343268, v0
    v_lshlrev_b16 v1, 4, v1
    s_waitcnt lgkmcnt(0)
    s_load_dwordx4 s[32:35], s[8:9], 0
    s_load_dwordx16 s[36:51], s[12:13], 0
    s_load_dwordx16 s[52:67], s[14:15], 0
    s_load_dwordx8 s[68:75], s[16:17], 0
    s_load_dwordx8 s[76:83], s[18:19], 0
    s_mov_b32 s24, s6
    s_and_b32 s25, s7, 0xffff
    s_mov_b32 s26, 1600000
    s_mov_b32 s27, 0x20000
    buffer_load_dword v4, v3, s[24:27], 0 offen nt
    s_mov_b32 s28, s20
    s_and_b32 s29, s21, 0xffff
    s_mov_b32 s30, 819200000
    s_mov_b32 s31, 0x20000
    s_mov_b32 s22, 492278784
    buffer_load_dwordx4 v[40:43], v2, s[28:31], s22 offen nt
    s_mov_b32 s22, 498684928
    buffer_load_dwordx4 v[44:47], v2, s[28:31], s22 offen nt
    s_mov_b32 s22, 505091072
    buffer_load_dwordx4 v[48:51], v2, s[28:31], s22 offen nt
    s_mov_b32 s22, 511497216
    buffer_load_dwordx4 v[52:55], v2, s[28:31], s22 offen nt
    s_mov_b32 s22, 492277760
    buffer_load_dwordx4 v[56:59], v1, s[28:31], s22 offen
    s_mov_b32 s24, s4
    s_and_b32 s25, s5, 0xffff
    s_mov_b32 s26, 6400000
    s_mov_b32 s27, 0x20000
    buffer_load_dwordx4 v[60:63], v2, s[24:27], 0 offen nt
    s_mov_b32 s24, s10
    s_and_b32 s25, s11, 0xffff
    s_mov_b32 s26, 6400000
    s_mov_b32 s27, 0x20000
    s_waitcnt vmcnt(6) lgkmcnt(0)
    v_and_b32 v5, 0xffff0000, v4
    v_lshlrev_b32 v4, 16, v4
    s_lshl_b32 s14, s32, 16
    s_and_b32 s15, s32, 0xffff0000
    v_pk_add_f32 v[8:9], v[4:5], s[14:15] op_sel:[0,0] op_sel_hi:[0,1] neg_lo:[0,1] neg_hi:[0,1]
    v_pk_add_f32 v[16:17], v[4:5], s[14:15] op_sel:[1,0] op_sel_hi:[1,1] neg_lo:[0,1] neg_hi:[0,1]
    s_lshl_b32 s16, s33, 16
    s_and_b32 s17, s33, 0xffff0000
    v_pk_add_f32 v[10:11], v[4:5], s[16:17] op_sel:[0,0] op_sel_hi:[0,1] neg_lo:[0,1] neg_hi:[0,1]
    v_pk_add_f32 v[18:19], v[4:5], s[16:17] op_sel:[1,0] op_sel_hi:[1,1] neg_lo:[0,1] neg_hi:[0,1]
    s_lshl_b32 s18, s34, 16
    s_and_b32 s19, s34, 0xffff0000
    v_pk_add_f32 v[12:13], v[4:5], s[18:19] op_sel:[0,0] op_sel_hi:[0,1] neg_lo:[0,1] neg_hi:[0,1]
    v_pk_add_f32 v[20:21], v[4:5], s[18:19] op_sel:[1,0] op_sel_hi:[1,1] neg_lo:[0,1] neg_hi:[0,1]
    s_lshl_b32 s12, s35, 16
    s_and_b32 s13, s35, 0xffff0000
    v_pk_add_f32 v[14:15], v[4:5], s[12:13] op_sel:[0,0] op_sel_hi:[0,1] neg_lo:[0,1] neg_hi:[0,1]
    v_pk_add_f32 v[22:23], v[4:5], s[12:13] op_sel:[1,0] op_sel_hi:[1,1] neg_lo:[0,1] neg_hi:[0,1]
    v_cvt_pk_bf16_f32 v8, v8, v9
    v_cvt_pk_bf16_f32 v10, v10, v11
    v_cvt_pk_bf16_f32 v12, v12, v13
    v_cvt_pk_bf16_f32 v14, v14, v15
    v_cvt_pk_bf16_f32 v16, v16, v17
    v_cvt_pk_bf16_f32 v18, v18, v19
    v_cvt_pk_bf16_f32 v20, v20, v21
    v_cvt_pk_bf16_f32 v22, v22, v23
    v_and_b32 v9, 0xffff0000, v8
    v_lshlrev_b32 v8, 16, v8
    v_and_b32 v11, 0xffff0000, v10
    v_lshlrev_b32 v10, 16, v10
    v_and_b32 v13, 0xffff0000, v12
    v_lshlrev_b32 v12, 16, v12
    v_and_b32 v15, 0xffff0000, v14
    v_lshlrev_b32 v14, 16, v14
    v_and_b32 v17, 0xffff0000, v16
    v_lshlrev_b32 v16, 16, v16
    v_and_b32 v19, 0xffff0000, v18
    v_lshlrev_b32 v18, 16, v18
    v_and_b32 v21, 0xffff0000, v20
    v_lshlrev_b32 v20, 16, v20
    v_and_b32 v23, 0xffff0000, v22
    v_lshlrev_b32 v22, 16, v22
    v_mul_f32 v8, v8, v8
    v_mul_f32 v9, v9, v9
    v_mul_f32 v10, v10, v10
    v_mul_f32 v11, v11, v11
    v_mul_f32 v12, v12, v12
    v_mul_f32 v13, v13, v13
    v_mul_f32 v14, v14, v14
    v_mul_f32 v15, v15, v15
    v_mul_f32 v16, v16, v16
    v_mul_f32 v17, v17, v17
    v_mul_f32 v18, v18, v18
    v_mul_f32 v19, v19, v19
    v_mul_f32 v20, v20, v20
    v_mul_f32 v21, v21, v21
    v_mul_f32 v22, v22, v22
    v_mul_f32 v23, v23, v23
    v_cvt_pk_bf16_f32 v8, v8, v9
    v_cvt_pk_bf16_f32 v10, v10, v11
    v_cvt_pk_bf16_f32 v12, v12, v13
    v_cvt_pk_bf16_f32 v14, v14, v15
    v_cvt_pk_bf16_f32 v16, v16, v17
    v_cvt_pk_bf16_f32 v18, v18, v19
    v_cvt_pk_bf16_f32 v20, v20, v21
    v_cvt_pk_bf16_f32 v22, v22, v23
    v_and_b32 v9, 0xffff0000, v8
    v_lshlrev_b32 v8, 16, v8
    v_and_b32 v11, 0xffff0000, v10
    v_lshlrev_b32 v10, 16, v10
    v_and_b32 v13, 0xffff0000, v12
    v_lshlrev_b32 v12, 16, v12
    v_and_b32 v15, 0xffff0000, v14
    v_lshlrev_b32 v14, 16, v14
    v_and_b32 v17, 0xffff0000, v16
    v_lshlrev_b32 v16, 16, v16
    v_and_b32 v19, 0xffff0000, v18
    v_lshlrev_b32 v18, 16, v18
    v_and_b32 v21, 0xffff0000, v20
    v_lshlrev_b32 v20, 16, v20
    v_and_b32 v23, 0xffff0000, v22
    v_lshlrev_b32 v22, 16, v22
    v_mul_f32 v8, 0xc1200000, v8
    v_mul_f32 v9, 0xc1200000, v9
    v_mul_f32 v10, 0xc1200000, v10
    v_mul_f32 v11, 0xc1200000, v11
    v_mul_f32 v12, 0xc1200000, v12
    v_mul_f32 v13, 0xc1200000, v13
    v_mul_f32 v14, 0xc1200000, v14
    v_mul_f32 v15, 0xc1200000, v15
    v_mul_f32 v16, 0xc1200000, v16
    v_mul_f32 v17, 0xc1200000, v17
    v_mul_f32 v18, 0xc1200000, v18
    v_mul_f32 v19, 0xc1200000, v19
    v_mul_f32 v20, 0xc1200000, v20
    v_mul_f32 v21, 0xc1200000, v21
    v_mul_f32 v22, 0xc1200000, v22
    v_mul_f32 v23, 0xc1200000, v23
    v_cvt_pk_bf16_f32 v8, v8, v9
    v_cvt_pk_bf16_f32 v10, v10, v11
    v_cvt_pk_bf16_f32 v12, v12, v13
    v_cvt_pk_bf16_f32 v14, v14, v15
    v_cvt_pk_bf16_f32 v16, v16, v17
    v_cvt_pk_bf16_f32 v18, v18, v19
    v_cvt_pk_bf16_f32 v20, v20, v21
    v_cvt_pk_bf16_f32 v22, v22, v23
    v_and_b32 v9, 0xffff0000, v8
    v_lshlrev_b32 v8, 16, v8
    v_and_b32 v11, 0xffff0000, v10
    v_lshlrev_b32 v10, 16, v10
    v_and_b32 v13, 0xffff0000, v12
    v_lshlrev_b32 v12, 16, v12
    v_and_b32 v15, 0xffff0000, v14
    v_lshlrev_b32 v14, 16, v14
    v_and_b32 v17, 0xffff0000, v16
    v_lshlrev_b32 v16, 16, v16
    v_and_b32 v19, 0xffff0000, v18
    v_lshlrev_b32 v18, 16, v18
    v_and_b32 v21, 0xffff0000, v20
    v_lshlrev_b32 v20, 16, v20
    v_and_b32 v23, 0xffff0000, v22
    v_lshlrev_b32 v22, 16, v22
    v_mul_f32 v8, 0x3fb8aa3b, v8
    v_mul_f32 v9, 0x3fb8aa3b, v9
    v_mul_f32 v10, 0x3fb8aa3b, v10
    v_mul_f32 v11, 0x3fb8aa3b, v11
    v_mul_f32 v12, 0x3fb8aa3b, v12
    v_mul_f32 v13, 0x3fb8aa3b, v13
    v_mul_f32 v14, 0x3fb8aa3b, v14
    v_mul_f32 v15, 0x3fb8aa3b, v15
    v_mul_f32 v16, 0x3fb8aa3b, v16
    v_mul_f32 v17, 0x3fb8aa3b, v17
    v_mul_f32 v18, 0x3fb8aa3b, v18
    v_mul_f32 v19, 0x3fb8aa3b, v19
    v_mul_f32 v20, 0x3fb8aa3b, v20
    v_mul_f32 v21, 0x3fb8aa3b, v21
    v_mul_f32 v22, 0x3fb8aa3b, v22
    v_mul_f32 v23, 0x3fb8aa3b, v23
    v_exp_f32 v8, v8
    v_exp_f32 v9, v9
    v_exp_f32 v10, v10
    v_exp_f32 v11, v11
    v_exp_f32 v12, v12
    v_exp_f32 v13, v13
    v_exp_f32 v14, v14
    v_exp_f32 v15, v15
    v_exp_f32 v16, v16
    v_exp_f32 v17, v17
    v_exp_f32 v18, v18
    v_exp_f32 v19, v19
    v_exp_f32 v20, v20
    v_exp_f32 v21, v21
    v_exp_f32 v22, v22
    v_exp_f32 v23, v23
    s_nop 0
    v_cvt_pk_bf16_f32 v8, v8, v9
    v_cvt_pk_bf16_f32 v10, v10, v11
    v_cvt_pk_bf16_f32 v12, v12, v13
    v_cvt_pk_bf16_f32 v14, v14, v15
    v_cvt_pk_bf16_f32 v16, v16, v17
    v_cvt_pk_bf16_f32 v18, v18, v19
    v_cvt_pk_bf16_f32 v20, v20, v21
    v_cvt_pk_bf16_f32 v22, v22, v23
    v_and_b32 v9, 0xffff0000, v8
    v_lshlrev_b32 v8, 16, v8
    v_and_b32 v11, 0xffff0000, v10
    v_lshlrev_b32 v10, 16, v10
    v_and_b32 v13, 0xffff0000, v12
    v_lshlrev_b32 v12, 16, v12
    v_and_b32 v15, 0xffff0000, v14
    v_lshlrev_b32 v14, 16, v14
    v_and_b32 v17, 0xffff0000, v16
    v_lshlrev_b32 v16, 16, v16
    v_and_b32 v19, 0xffff0000, v18
    v_lshlrev_b32 v18, 16, v18
    v_and_b32 v21, 0xffff0000, v20
    v_lshlrev_b32 v20, 16, v20
    v_and_b32 v23, 0xffff0000, v22
    v_lshlrev_b32 v22, 16, v22
    s_lshl_b32 s14, s52, 16
    s_and_b32 s15, s52, 0xffff0000
    v_pk_mul_f32 v[24:25], v[8:9], s[14:15] op_sel:[0,0] op_sel_hi:[0,1]
    v_pk_mul_f32 v[28:29], v[16:17], s[14:15] op_sel:[0,0] op_sel_hi:[0,1]
    s_lshl_b32 s16, s53, 16
    s_and_b32 s17, s53, 0xffff0000
    v_pk_mul_f32 v[26:27], v[8:9], s[16:17] op_sel:[0,0] op_sel_hi:[0,1]
    v_pk_mul_f32 v[30:31], v[16:17], s[16:17] op_sel:[0,0] op_sel_hi:[0,1]
    s_lshl_b32 s18, s54, 16
    s_and_b32 s19, s54, 0xffff0000
    v_pk_fma_f32 v[24:25], v[8:9], s[18:19], v[24:25] op_sel:[1,0,0] op_sel_hi:[1,1,1]
    v_pk_fma_f32 v[28:29], v[16:17], s[18:19], v[28:29] op_sel:[1,0,0] op_sel_hi:[1,1,1]
    s_lshl_b32 s12, s55, 16
    s_and_b32 s13, s55, 0xffff0000
    v_pk_fma_f32 v[26:27], v[8:9], s[12:13], v[26:27] op_sel:[1,0,0] op_sel_hi:[1,1,1]
    v_pk_fma_f32 v[30:31], v[16:17], s[12:13], v[30:31] op_sel:[1,0,0] op_sel_hi:[1,1,1]
    s_lshl_b32 s14, s56, 16
    s_and_b32 s15, s56, 0xffff0000
    v_pk_fma_f32 v[24:25], v[10:11], s[14:15], v[24:25] op_sel:[0,0,0] op_sel_hi:[0,1,1]
    v_pk_fma_f32 v[28:29], v[18:19], s[14:15], v[28:29] op_sel:[0,0,0] op_sel_hi:[0,1,1]
    s_lshl_b32 s16, s57, 16
    s_and_b32 s17, s57, 0xffff0000
    v_pk_fma_f32 v[26:27], v[10:11], s[16:17], v[26:27] op_sel:[0,0,0] op_sel_hi:[0,1,1]
    v_pk_fma_f32 v[30:31], v[18:19], s[16:17], v[30:31] op_sel:[0,0,0] op_sel_hi:[0,1,1]
    s_lshl_b32 s18, s58, 16
    s_and_b32 s19, s58, 0xffff0000
    v_pk_fma_f32 v[24:25], v[10:11], s[18:19], v[24:25] op_sel:[1,0,0] op_sel_hi:[1,1,1]
    v_pk_fma_f32 v[28:29], v[18:19], s[18:19], v[28:29] op_sel:[1,0,0] op_sel_hi:[1,1,1]
    s_lshl_b32 s12, s59, 16
    s_and_b32 s13, s59, 0xffff0000
    v_pk_fma_f32 v[26:27], v[10:11], s[12:13], v[26:27] op_sel:[1,0,0] op_sel_hi:[1,1,1]
    v_pk_fma_f32 v[30:31], v[18:19], s[12:13], v[30:31] op_sel:[1,0,0] op_sel_hi:[1,1,1]
    s_lshl_b32 s14, s60, 16
    s_and_b32 s15, s60, 0xffff0000
    v_pk_fma_f32 v[24:25], v[12:13], s[14:15], v[24:25] op_sel:[0,0,0] op_sel_hi:[0,1,1]
    v_pk_fma_f32 v[28:29], v[20:21], s[14:15], v[28:29] op_sel:[0,0,0] op_sel_hi:[0,1,1]
    s_lshl_b32 s16, s61, 16
    s_and_b32 s17, s61, 0xffff0000
    v_pk_fma_f32 v[26:27], v[12:13], s[16:17], v[26:27] op_sel:[0,0,0] op_sel_hi:[0,1,1]
    v_pk_fma_f32 v[30:31], v[20:21], s[16:17], v[30:31] op_sel:[0,0,0] op_sel_hi:[0,1,1]
    s_lshl_b32 s18, s62, 16
    s_and_b32 s19, s62, 0xffff0000
    v_pk_fma_f32 v[24:25], v[12:13], s[18:19], v[24:25] op_sel:[1,0,0] op_sel_hi:[1,1,1]
    v_pk_fma_f32 v[28:29], v[20:21], s[18:19], v[28:29] op_sel:[1,0,0] op_sel_hi:[1,1,1]
    s_lshl_b32 s12, s63, 16
    s_and_b32 s13, s63, 0xffff0000
    v_pk_fma_f32 v[26:27], v[12:13], s[12:13], v[26:27] op_sel:[1,0,0] op_sel_hi:[1,1,1]
    v_pk_fma_f32 v[30:31], v[20:21], s[12:13], v[30:31] op_sel:[1,0,0] op_sel_hi:[1,1,1]
    s_lshl_b32 s14, s64, 16
    s_and_b32 s15, s64, 0xffff0000
    v_pk_fma_f32 v[24:25], v[14:15], s[14:15], v[24:25] op_sel:[0,0,0] op_sel_hi:[0,1,1]
    v_pk_fma_f32 v[28:29], v[22:23], s[14:15], v[28:29] op_sel:[0,0,0] op_sel_hi:[0,1,1]
    s_lshl_b32 s16, s65, 16
    s_and_b32 s17, s65, 0xffff0000
    v_pk_fma_f32 v[26:27], v[14:15], s[16:17], v[26:27] op_sel:[0,0,0] op_sel_hi:[0,1,1]
    v_pk_fma_f32 v[30:31], v[22:23], s[16:17], v[30:31] op_sel:[0,0,0] op_sel_hi:[0,1,1]
    s_lshl_b32 s18, s66, 16
    s_and_b32 s19, s66, 0xffff0000
    v_pk_fma_f32 v[24:25], v[14:15], s[18:19], v[24:25] op_sel:[1,0,0] op_sel_hi:[1,1,1]
    v_pk_fma_f32 v[28:29], v[22:23], s[18:19], v[28:29] op_sel:[1,0,0] op_sel_hi:[1,1,1]
    s_lshl_b32 s12, s67, 16
    s_and_b32 s13, s67, 0xffff0000
    v_pk_fma_f32 v[26:27], v[14:15], s[12:13], v[26:27] op_sel:[1,0,0] op_sel_hi:[1,1,1]
    v_pk_fma_f32 v[30:31], v[22:23], s[12:13], v[30:31] op_sel:[1,0,0] op_sel_hi:[1,1,1]
    s_lshl_b32 s14, s36, 16
    s_and_b32 s15, s36, 0xffff0000
    v_pk_mul_f32 v[32:33], v[8:9], s[14:15] op_sel:[0,0] op_sel_hi:[0,1]
    v_pk_mul_f32 v[36:37], v[16:17], s[14:15] op_sel:[0,0] op_sel_hi:[0,1]
    s_lshl_b32 s16, s37, 16
    s_and_b32 s17, s37, 0xffff0000
    v_pk_mul_f32 v[34:35], v[8:9], s[16:17] op_sel:[0,0] op_sel_hi:[0,1]
    v_pk_mul_f32 v[38:39], v[16:17], s[16:17] op_sel:[0,0] op_sel_hi:[0,1]
    s_lshl_b32 s18, s38, 16
    s_and_b32 s19, s38, 0xffff0000
    v_pk_fma_f32 v[32:33], v[8:9], s[18:19], v[32:33] op_sel:[1,0,0] op_sel_hi:[1,1,1]
    v_pk_fma_f32 v[36:37], v[16:17], s[18:19], v[36:37] op_sel:[1,0,0] op_sel_hi:[1,1,1]
    s_lshl_b32 s12, s39, 16
    s_and_b32 s13, s39, 0xffff0000
    v_pk_fma_f32 v[34:35], v[8:9], s[12:13], v[34:35] op_sel:[1,0,0] op_sel_hi:[1,1,1]
    v_pk_fma_f32 v[38:39], v[16:17], s[12:13], v[38:39] op_sel:[1,0,0] op_sel_hi:[1,1,1]
    s_lshl_b32 s14, s40, 16
    s_and_b32 s15, s40, 0xffff0000
    v_pk_fma_f32 v[32:33], v[10:11], s[14:15], v[32:33] op_sel:[0,0,0] op_sel_hi:[0,1,1]
    v_pk_fma_f32 v[36:37], v[18:19], s[14:15], v[36:37] op_sel:[0,0,0] op_sel_hi:[0,1,1]
    s_lshl_b32 s16, s41, 16
    s_and_b32 s17, s41, 0xffff0000
    v_pk_fma_f32 v[34:35], v[10:11], s[16:17], v[34:35] op_sel:[0,0,0] op_sel_hi:[0,1,1]
    v_pk_fma_f32 v[38:39], v[18:19], s[16:17], v[38:39] op_sel:[0,0,0] op_sel_hi:[0,1,1]
    s_lshl_b32 s18, s42, 16
    s_and_b32 s19, s42, 0xffff0000
    v_pk_fma_f32 v[32:33], v[10:11], s[18:19], v[32:33] op_sel:[1,0,0] op_sel_hi:[1,1,1]
    v_pk_fma_f32 v[36:37], v[18:19], s[18:19], v[36:37] op_sel:[1,0,0] op_sel_hi:[1,1,1]
    s_lshl_b32 s12, s43, 16
    s_and_b32 s13, s43, 0xffff0000
    v_pk_fma_f32 v[34:35], v[10:11], s[12:13], v[34:35] op_sel:[1,0,0] op_sel_hi:[1,1,1]
    v_pk_fma_f32 v[38:39], v[18:19], s[12:13], v[38:39] op_sel:[1,0,0] op_sel_hi:[1,1,1]
    s_lshl_b32 s14, s44, 16
    s_and_b32 s15, s44, 0xffff0000
    v_pk_fma_f32 v[32:33], v[12:13], s[14:15], v[32:33] op_sel:[0,0,0] op_sel_hi:[0,1,1]
    v_pk_fma_f32 v[36:37], v[20:21], s[14:15], v[36:37] op_sel:[0,0,0] op_sel_hi:[0,1,1]
    s_lshl_b32 s16, s45, 16
    s_and_b32 s17, s45, 0xffff0000
    v_pk_fma_f32 v[34:35], v[12:13], s[16:17], v[34:35] op_sel:[0,0,0] op_sel_hi:[0,1,1]
    v_pk_fma_f32 v[38:39], v[20:21], s[16:17], v[38:39] op_sel:[0,0,0] op_sel_hi:[0,1,1]
    s_lshl_b32 s18, s46, 16
    s_and_b32 s19, s46, 0xffff0000
    v_pk_fma_f32 v[32:33], v[12:13], s[18:19], v[32:33] op_sel:[1,0,0] op_sel_hi:[1,1,1]
    v_pk_fma_f32 v[36:37], v[20:21], s[18:19], v[36:37] op_sel:[1,0,0] op_sel_hi:[1,1,1]
    s_lshl_b32 s12, s47, 16
    s_and_b32 s13, s47, 0xffff0000
    v_pk_fma_f32 v[34:35], v[12:13], s[12:13], v[34:35] op_sel:[1,0,0] op_sel_hi:[1,1,1]
    v_pk_fma_f32 v[38:39], v[20:21], s[12:13], v[38:39] op_sel:[1,0,0] op_sel_hi:[1,1,1]
    s_lshl_b32 s14, s48, 16
    s_and_b32 s15, s48, 0xffff0000
    v_pk_fma_f32 v[32:33], v[14:15], s[14:15], v[32:33] op_sel:[0,0,0] op_sel_hi:[0,1,1]
    v_pk_fma_f32 v[36:37], v[22:23], s[14:15], v[36:37] op_sel:[0,0,0] op_sel_hi:[0,1,1]
    s_lshl_b32 s16, s49, 16
    s_and_b32 s17, s49, 0xffff0000
    v_pk_fma_f32 v[34:35], v[14:15], s[16:17], v[34:35] op_sel:[0,0,0] op_sel_hi:[0,1,1]
    v_pk_fma_f32 v[38:39], v[22:23], s[16:17], v[38:39] op_sel:[0,0,0] op_sel_hi:[0,1,1]
    s_lshl_b32 s18, s50, 16
    s_and_b32 s19, s50, 0xffff0000
    v_pk_fma_f32 v[32:33], v[14:15], s[18:19], v[32:33] op_sel:[1,0,0] op_sel_hi:[1,1,1]
    v_pk_fma_f32 v[36:37], v[22:23], s[18:19], v[36:37] op_sel:[1,0,0] op_sel_hi:[1,1,1]
    s_lshl_b32 s12, s51, 16
    s_and_b32 s13, s51, 0xffff0000
    v_pk_fma_f32 v[34:35], v[14:15], s[12:13], v[34:35] op_sel:[1,0,0] op_sel_hi:[1,1,1]
    v_pk_fma_f32 v[38:39], v[22:23], s[12:13], v[38:39] op_sel:[1,0,0] op_sel_hi:[1,1,1]
    v_cvt_pk_bf16_f32 v32, v32, v33
    v_cvt_pk_bf16_f32 v34, v34, v35
    v_cvt_pk_bf16_f32 v36, v36, v37
    v_cvt_pk_bf16_f32 v38, v38, v39
    v_and_b32 v33, 0xffff0000, v32
    v_lshlrev_b32 v32, 16, v32
    v_and_b32 v35, 0xffff0000, v34
    v_lshlrev_b32 v34, 16, v34
    v_and_b32 v37, 0xffff0000, v36
    v_lshlrev_b32 v36, 16, v36
    v_and_b32 v39, 0xffff0000, v38
    v_lshlrev_b32 v38, 16, v38
    s_waitcnt vmcnt(1)
    v_add_u32 v40, v40, v44
    v_add_u32 v48, v48, v52
    v_add_u32 v41, v41, v45
    v_add_u32 v49, v49, v53
    v_add_u32 v42, v42, v46
    v_add_u32 v50, v50, v54
    v_add_u32 v43, v43, v47
    v_add_u32 v51, v51, v55
    v_add_u32_sdwa v8, v40, v48 dst_sel:DWORD dst_unused:UNUSED_PAD src0_sel:WORD_0 src1_sel:WORD_0
    v_add_u32_sdwa v9, v40, v48 dst_sel:DWORD dst_unused:UNUSED_PAD src0_sel:WORD_1 src1_sel:WORD_1
    v_add_u32_sdwa v10, v41, v49 dst_sel:DWORD dst_unused:UNUSED_PAD src0_sel:WORD_0 src1_sel:WORD_0
    v_add_u32_sdwa v11, v41, v49 dst_sel:DWORD dst_unused:UNUSED_PAD src0_sel:WORD_1 src1_sel:WORD_1
    v_add_u32_sdwa v12, v42, v50 dst_sel:DWORD dst_unused:UNUSED_PAD src0_sel:WORD_0 src1_sel:WORD_0
    v_add_u32_sdwa v13, v42, v50 dst_sel:DWORD dst_unused:UNUSED_PAD src0_sel:WORD_1 src1_sel:WORD_1
    v_add_u32_sdwa v14, v43, v51 dst_sel:DWORD dst_unused:UNUSED_PAD src0_sel:WORD_0 src1_sel:WORD_0
    v_add_u32_sdwa v15, v43, v51 dst_sel:DWORD dst_unused:UNUSED_PAD src0_sel:WORD_1 src1_sel:WORD_1
    v_min3_u32 v5, v56, v57, v58
    v_bitop3_b32 v4, v56, v57, v58 bitop3:0xfe
    v_min_u32 v5, v5, v59
    v_or_b32 v4, v4, v59
    v_or_b32 v8, 0x4b000000, v8
    v_or_b32 v9, 0x4b000000, v9
    v_or_b32 v10, 0x4b000000, v10
    v_or_b32 v11, 0x4b000000, v11
    v_or_b32 v12, 0x4b000000, v12
    v_or_b32 v13, 0x4b000000, v13
    v_or_b32 v14, 0x4b000000, v14
    v_or_b32 v15, 0x4b000000, v15
    v_cmp_eq_u32 vcc, 0, v5
    v_add_f32 v8, 0xcb010000, v8
    v_add_f32 v9, 0xcb010000, v9
    v_add_f32 v10, 0xcb010000, v10
    v_add_f32 v11, 0xcb010000, v11
    v_add_f32 v12, 0xcb010000, v12
    v_add_f32 v13, 0xcb010000, v13
    v_add_f32 v14, 0xcb010000, v14
    v_add_f32 v15, 0xcb010000, v15
    v_mul_f32 v8, v4, v8
    v_mul_f32 v9, v4, v9
    v_mul_f32 v10, v4, v10
    v_mul_f32 v11, v4, v11
    v_mul_f32 v12, v4, v12
    v_mul_f32 v13, v4, v13
    v_mul_f32 v14, v4, v14
    v_mul_f32 v15, v4, v15
    s_cbranch_vccz p3_nof
    v_lshlrev_b32 v1, 4, v0
    v_mov_b32 v3, 0x70000000
    v_cmp_eq_u32 vcc, 0, v56
    s_mov_b32 s22, 517903360
    s_nop 0
    v_cndmask_b32 v5, v3, v1, vcc
    buffer_load_dwordx4 v[16:19], v5, s[28:31], s22 offen
    buffer_load_dwordx4 v[20:23], v5, s[28:31], s22 offen offset:16
    s_waitcnt vmcnt(0)
    v_add_f32 v8, v8, v16
    v_add_f32 v9, v9, v17
    v_add_f32 v10, v10, v18
    v_add_f32 v11, v11, v19
    v_add_f32 v12, v12, v20
    v_add_f32 v13, v13, v21
    v_add_f32 v14, v14, v22
    v_add_f32 v15, v15, v23
    v_cmp_eq_u32 vcc, 0, v57
    s_mov_b32 s22, 530715648
    s_nop 0
    v_cndmask_b32 v5, v3, v1, vcc
    buffer_load_dwordx4 v[16:19], v5, s[28:31], s22 offen
    buffer_load_dwordx4 v[20:23], v5, s[28:31], s22 offen offset:16
    s_waitcnt vmcnt(0)
    v_add_f32 v8, v8, v16
    v_add_f32 v9, v9, v17
    v_add_f32 v10, v10, v18
    v_add_f32 v11, v11, v19
    v_add_f32 v12, v12, v20
    v_add_f32 v13, v13, v21
    v_add_f32 v14, v14, v22
    v_add_f32 v15, v15, v23
    v_cmp_eq_u32 vcc, 0, v58
    s_mov_b32 s22, 543527936
    s_nop 0
    v_cndmask_b32 v5, v3, v1, vcc
    buffer_load_dwordx4 v[16:19], v5, s[28:31], s22 offen
    buffer_load_dwordx4 v[20:23], v5, s[28:31], s22 offen offset:16
    s_waitcnt vmcnt(0)
    v_add_f32 v8, v8, v16
    v_add_f32 v9, v9, v17
    v_add_f32 v10, v10, v18
    v_add_f32 v11, v11, v19
    v_add_f32 v12, v12, v20
    v_add_f32 v13, v13, v21
    v_add_f32 v14, v14, v22
    v_add_f32 v15, v15, v23
    v_cmp_eq_u32 vcc, 0, v59
    s_mov_b32 s22, 556340224
    s_nop 0
    v_cndmask_b32 v5, v3, v1, vcc
    buffer_load_dwordx4 v[16:19], v5, s[28:31], s22 offen
    buffer_load_dwordx4 v[20:23], v5, s[28:31], s22 offen offset:16
    s_waitcnt vmcnt(0)
    v_add_f32 v8, v8, v16
    v_add_f32 v9, v9, v17
    v_add_f32 v10, v10, v18
    v_add_f32 v11, v11, v19
    v_add_f32 v12, v12, v20
    v_add_f32 v13, v13, v21
    v_add_f32 v14, v14, v22
    v_add_f32 v15, v15, v23
p3_nof:
    s_lshl_b32 s14, s68, 16
    s_and_b32 s15, s68, 0xffff0000
    v_pk_mul_f32 v[16:17], v[8:9], s[14:15] op_sel:[0,0] op_sel_hi:[0,1]
    v_pk_mul_f32 v[20:21], v[12:13], s[14:15] op_sel:[0,0] op_sel_hi:[0,1]
    s_lshl_b32 s16, s69, 16
    s_and_b32 s17, s69, 0xffff0000
    v_pk_mul_f32 v[18:19], v[8:9], s[16:17] op_sel:[0,0] op_sel_hi:[0,1]
    v_pk_mul_f32 v[22:23], v[12:13], s[16:17] op_sel:[0,0] op_sel_hi:[0,1]
    s_lshl_b32 s18, s70, 16
    s_and_b32 s19, s70, 0xffff0000
    v_pk_fma_f32 v[16:17], v[8:9], s[18:19], v[16:17] op_sel:[1,0,0] op_sel_hi:[1,1,1]
    v_pk_fma_f32 v[20:21], v[12:13], s[18:19], v[20:21] op_sel:[1,0,0] op_sel_hi:[1,1,1]
    s_lshl_b32 s12, s71, 16
    s_and_b32 s13, s71, 0xffff0000
    v_pk_fma_f32 v[18:19], v[8:9], s[12:13], v[18:19] op_sel:[1,0,0] op_sel_hi:[1,1,1]
    v_pk_fma_f32 v[22:23], v[12:13], s[12:13], v[22:23] op_sel:[1,0,0] op_sel_hi:[1,1,1]
    s_lshl_b32 s14, s72, 16
    s_and_b32 s15, s72, 0xffff0000
    v_pk_fma_f32 v[16:17], v[10:11], s[14:15], v[16:17] op_sel:[0,0,0] op_sel_hi:[0,1,1]
    v_pk_fma_f32 v[20:21], v[14:15], s[14:15], v[20:21] op_sel:[0,0,0] op_sel_hi:[0,1,1]
    s_lshl_b32 s16, s73, 16
    s_and_b32 s17, s73, 0xffff0000
    v_pk_fma_f32 v[18:19], v[10:11], s[16:17], v[18:19] op_sel:[0,0,0] op_sel_hi:[0,1,1]
    v_pk_fma_f32 v[22:23], v[14:15], s[16:17], v[22:23] op_sel:[0,0,0] op_sel_hi:[0,1,1]
    s_lshl_b32 s18, s74, 16
    s_and_b32 s19, s74, 0xffff0000
    v_pk_fma_f32 v[16:17], v[10:11], s[18:19], v[16:17] op_sel:[1,0,0] op_sel_hi:[1,1,1]
    v_pk_fma_f32 v[20:21], v[14:15], s[18:19], v[20:21] op_sel:[1,0,0] op_sel_hi:[1,1,1]
    s_lshl_b32 s12, s75, 16
    s_and_b32 s13, s75, 0xffff0000
    v_pk_fma_f32 v[18:19], v[10:11], s[12:13], v[18:19] op_sel:[1,0,0] op_sel_hi:[1,1,1]
    v_pk_fma_f32 v[22:23], v[14:15], s[12:13], v[22:23] op_sel:[1,0,0] op_sel_hi:[1,1,1]
    v_mul_f32 v24, v24, v16
    v_mul_f32 v25, v25, v17
    v_mul_f32 v26, v26, v18
    v_mul_f32 v27, v27, v19
    v_mul_f32 v28, v28, v20
    v_mul_f32 v29, v29, v21
    v_mul_f32 v30, v30, v22
    v_mul_f32 v31, v31, v23
    v_cvt_pk_bf16_f32 v24, v24, v25
    v_cvt_pk_bf16_f32 v26, v26, v27
    v_cvt_pk_bf16_f32 v28, v28, v29
    v_cvt_pk_bf16_f32 v30, v30, v31
    v_and_b32 v25, 0xffff0000, v24
    v_lshlrev_b32 v24, 16, v24
    v_and_b32 v27, 0xffff0000, v26
    v_lshlrev_b32 v26, 16, v26
    v_and_b32 v29, 0xffff0000, v28
    v_lshlrev_b32 v28, 16, v28
    v_and_b32 v31, 0xffff0000, v30
    v_lshlrev_b32 v30, 16, v30
    s_lshl_b32 s14, s76, 16
    s_and_b32 s15, s76, 0xffff0000
    v_pk_mul_f32 v[16:17], v[24:25], s[14:15] op_sel:[0,0] op_sel_hi:[0,1]
    v_pk_mul_f32 v[20:21], v[28:29], s[14:15] op_sel:[0,0] op_sel_hi:[0,1]
    s_lshl_b32 s16, s77, 16
    s_and_b32 s17, s77, 0xffff0000
    v_pk_mul_f32 v[18:19], v[24:25], s[16:17] op_sel:[0,0] op_sel_hi:[0,1]
    v_pk_mul_f32 v[22:23], v[28:29], s[16:17] op_sel:[0,0] op_sel_hi:[0,1]
    s_lshl_b32 s18, s78, 16
    s_and_b32 s19, s78, 0xffff0000
    v_pk_fma_f32 v[16:17], v[24:25], s[18:19], v[16:17] op_sel:[1,0,0] op_sel_hi:[1,1,1]
    v_pk_fma_f32 v[20:21], v[28:29], s[18:19], v[20:21] op_sel:[1,0,0] op_sel_hi:[1,1,1]
    s_lshl_b32 s12, s79, 16
    s_and_b32 s13, s79, 0xffff0000
    v_pk_fma_f32 v[18:19], v[24:25], s[12:13], v[18:19] op_sel:[1,0,0] op_sel_hi:[1,1,1]
    v_pk_fma_f32 v[22:23], v[28:29], s[12:13], v[22:23] op_sel:[1,0,0] op_sel_hi:[1,1,1]
    s_lshl_b32 s14, s80, 16
    s_and_b32 s15, s80, 0xffff0000
    v_pk_fma_f32 v[16:17], v[26:27], s[14:15], v[16:17] op_sel:[0,0,0] op_sel_hi:[0,1,1]
    v_pk_fma_f32 v[20:21], v[30:31], s[14:15], v[20:21] op_sel:[0,0,0] op_sel_hi:[0,1,1]
    s_lshl_b32 s16, s81, 16
    s_and_b32 s17, s81, 0xffff0000
    v_pk_fma_f32 v[18:19], v[26:27], s[16:17], v[18:19] op_sel:[0,0,0] op_sel_hi:[0,1,1]
    v_pk_fma_f32 v[22:23], v[30:31], s[16:17], v[22:23] op_sel:[0,0,0] op_sel_hi:[0,1,1]
    s_lshl_b32 s18, s82, 16
    s_and_b32 s19, s82, 0xffff0000
    v_pk_fma_f32 v[16:17], v[26:27], s[18:19], v[16:17] op_sel:[1,0,0] op_sel_hi:[1,1,1]
    v_pk_fma_f32 v[20:21], v[30:31], s[18:19], v[20:21] op_sel:[1,0,0] op_sel_hi:[1,1,1]
    s_lshl_b32 s12, s83, 16
    s_and_b32 s13, s83, 0xffff0000
    v_pk_fma_f32 v[18:19], v[26:27], s[12:13], v[18:19] op_sel:[1,0,0] op_sel_hi:[1,1,1]
    v_pk_fma_f32 v[22:23], v[30:31], s[12:13], v[22:23] op_sel:[1,0,0] op_sel_hi:[1,1,1]
    v_cvt_pk_bf16_f32 v16, v16, v17
    v_cvt_pk_bf16_f32 v18, v18, v19
    v_cvt_pk_bf16_f32 v20, v20, v21
    v_cvt_pk_bf16_f32 v22, v22, v23
    v_and_b32 v17, 0xffff0000, v16
    v_lshlrev_b32 v16, 16, v16
    v_and_b32 v19, 0xffff0000, v18
    v_lshlrev_b32 v18, 16, v18
    v_and_b32 v21, 0xffff0000, v20
    v_lshlrev_b32 v20, 16, v20
    v_and_b32 v23, 0xffff0000, v22
    v_lshlrev_b32 v22, 16, v22
    v_mul_f32 v16, v16, v32
    v_mul_f32 v17, v17, v33
    v_mul_f32 v18, v18, v34
    v_mul_f32 v19, v19, v35
    v_mul_f32 v20, v20, v36
    v_mul_f32 v21, v21, v37
    v_mul_f32 v22, v22, v38
    v_mul_f32 v23, v23, v39
    v_cvt_pk_bf16_f32 v16, v16, v17
    v_cvt_pk_bf16_f32 v18, v18, v19
    v_cvt_pk_bf16_f32 v20, v20, v21
    v_cvt_pk_bf16_f32 v22, v22, v23
    v_and_b32 v17, 0xffff0000, v16
    v_lshlrev_b32 v16, 16, v16
    v_and_b32 v19, 0xffff0000, v18
    v_lshlrev_b32 v18, 16, v18
    v_and_b32 v21, 0xffff0000, v20
    v_lshlrev_b32 v20, 16, v20
    v_and_b32 v23, 0xffff0000, v22
    v_lshlrev_b32 v22, 16, v22
    s_waitcnt vmcnt(0)
    v_lshlrev_b32 v8, 16, v60
    v_and_b32 v9, 0xffff0000, v60
    v_lshlrev_b32 v10, 16, v61
    v_and_b32 v11, 0xffff0000, v61
    v_lshlrev_b32 v12, 16, v62
    v_and_b32 v13, 0xffff0000, v62
    v_lshlrev_b32 v14, 16, v63
    v_and_b32 v15, 0xffff0000, v63
    v_add_f32 v8, v8, v16
    v_add_f32 v9, v9, v17
    v_add_f32 v10, v10, v18
    v_add_f32 v11, v11, v19
    v_add_f32 v12, v12, v20
    v_add_f32 v13, v13, v21
    v_add_f32 v14, v14, v22
    v_add_f32 v15, v15, v23
    v_cvt_pk_bf16_f32 v4, v8, v9
    v_cvt_pk_bf16_f32 v5, v10, v11
    v_cvt_pk_bf16_f32 v6, v12, v13
    v_cvt_pk_bf16_f32 v7, v14, v15
    buffer_store_dwordx4 v[4:7], v2, s[24:27], 0 offen nt
p3_end:
    s_endpgm
.section .rodata,"a"
.p2align 6
.amdhsa_kernel p1_kernel
  .amdhsa_next_free_vgpr 128
  .amdhsa_next_free_sgpr 72
  .amdhsa_accum_offset 128
  .amdhsa_group_segment_fixed_size 0
  .amdhsa_kernarg_size 112
  .amdhsa_user_sgpr_count 2
  .amdhsa_user_sgpr_kernarg_segment_ptr 1
  .amdhsa_system_sgpr_workgroup_id_x 1
  .amdhsa_float_denorm_mode_32 3
.end_amdhsa_kernel
.p2align 6
.amdhsa_kernel p2_kernel
  .amdhsa_next_free_vgpr 128
  .amdhsa_next_free_sgpr 72
  .amdhsa_accum_offset 128
  .amdhsa_group_segment_fixed_size 0
  .amdhsa_kernarg_size 112
  .amdhsa_user_sgpr_count 2
  .amdhsa_user_sgpr_kernarg_segment_ptr 1
  .amdhsa_system_sgpr_workgroup_id_x 1
  .amdhsa_float_denorm_mode_32 3
.end_amdhsa_kernel
.p2align 6
.amdhsa_kernel p3_kernel
  .amdhsa_next_free_vgpr 64
  .amdhsa_next_free_sgpr 84
  .amdhsa_accum_offset 64
  .amdhsa_group_segment_fixed_size 0
  .amdhsa_kernarg_size 112
  .amdhsa_user_sgpr_count 2
  .amdhsa_user_sgpr_kernarg_segment_ptr 1
  .amdhsa_system_sgpr_workgroup_id_x 1
  .amdhsa_float_denorm_mode_32 3
.end_amdhsa_kernel
```

```asm
; @launch kernel=p1_kernel grid=(256,1,1) block=(1024,1,1) lds=163072
; @launch kernel=p2_kernel grid=(256,1,1) block=(1024,1,1) lds=154368
; @launch kernel=p3_kernel grid=(1563,1,1) block=(256,1,1) lds=0
.amdgcn_target "amdgcn-amd-amdhsa--gfx950"
.text
.globl p1_kernel
.p2align 8
.type p1_kernel,@function
p1_kernel:
    s_cmp_ge_u32 s2, 256
    s_cbranch_scc1 p1_end
    s_load_dwordx2 s[52:53], s[0:1], 0
    s_load_dwordx4 s[56:59], s[0:1], 8
    s_load_dwordx2 s[54:55], s[0:1], 32
    s_load_dwordx2 s[60:61], s[0:1], 48
    s_load_dwordx2 s[48:49], s[0:1], 104
    s_load_dwordx2 s[62:63], s[0:1], 96
    v_lshlrev_b32 v1, 4, v0
    v_lshlrev_b32 v2, 3, v0
    v_mov_b32 v3, 1
    v_lshrrev_b32 v117, 6, v0
    s_nop 0
    v_readfirstlane_b32 s28, v117
    s_waitcnt lgkmcnt(0)
    s_load_dword s45, s[60:61], 0
    s_mov_b32 s4, s56
    s_and_b32 s5, s57, 0xffff
    s_mov_b32 s6, 204800000
    s_mov_b32 s7, 0x20000
    s_mov_b32 s8, s58
    s_and_b32 s9, s59, 0xffff
    s_mov_b32 s10, 204800000
    s_mov_b32 s11, 0x20000
    s_mov_b32 s12, s54
    s_and_b32 s13, s55, 0xffff
    s_mov_b32 s14, 102400000
    s_mov_b32 s15, 0x20000
    s_mov_b32 s16, s48
    s_and_b32 s17, s49, 0xffff
    s_mov_b32 s18, 819200000
    s_mov_b32 s19, 0x20000
    s_mov_b32 s29, s2
    s_mul_i32 s31, s2, 73728
    s_lshl_b32 s30, s31, 1
    s_add_u32 s32, s30, 0
    buffer_load_dwordx4 v[94:97], v1, s[4:7], s32 offen nt
    buffer_load_dwordx4 v[102:105], v1, s[8:11], s32 offen nt
    s_add_u32 s32, s31, 0
    buffer_load_dwordx2 v[76:77], v2, s[12:15], s32 offen nt
    s_add_u32 s32, s30, 16384
    buffer_load_dwordx4 v[98:101], v1, s[4:7], s32 offen nt
    buffer_load_dwordx4 v[106:109], v1, s[8:11], s32 offen nt
    s_add_u32 s32, s31, 8192
    buffer_load_dwordx2 v[78:79], v2, s[12:15], s32 offen nt
    s_add_u32 s32, s30, 32768
    buffer_load_dwordx4 v[12:15], v1, s[4:7], s32 offen nt
    buffer_load_dwordx4 v[48:51], v1, s[8:11], s32 offen nt
    s_add_u32 s32, s31, 16384
    buffer_load_dwordx2 v[80:81], v2, s[12:15], s32 offen nt
    s_add_u32 s32, s31, 24576
    buffer_load_dwordx2 v[82:83], v2, s[12:15], s32 offen nt
    s_add_u32 s32, s31, 32768
    buffer_load_dwordx2 v[84:85], v2, s[12:15], s32 offen nt
    s_add_u32 s32, s31, 40960
    buffer_load_dwordx2 v[86:87], v2, s[12:15], s32 offen nt
    s_add_u32 s32, s31, 49152
    buffer_load_dwordx2 v[88:89], v2, s[12:15], s32 offen nt
    s_add_u32 s32, s31, 57344
    buffer_load_dwordx2 v[90:91], v2, s[12:15], s32 offen nt
    s_add_u32 s32, s31, 65536
    buffer_load_dwordx2 v[92:93], v2, s[12:15], s32 offen nt
    s_mov_b32 s24, s52
    s_and_b32 s25, s53, 0xffff
    s_mov_b32 s26, 6400000
    s_mov_b32 s27, 0x20000
    s_mov_b32 s20, s48
    s_and_b32 s21, s49, 0xffff
    s_mov_b32 s22, 0
    s_mov_b32 s23, 0x20000
    s_mov_b32 s40, s62
    s_and_b32 s41, s63, 0xffff
    s_mov_b32 s42, 256
    s_mov_b32 s43, 0x20000
    s_mov_b32 s36, 643827
    s_mov_b32 s37, 214609
    s_mov_b32 s38, 343268
    s_mov_b32 s39, -6671
    s_mov_b32 s44, -12512
    s_mov_b32 s34, 1
    v_mov_b32 v73, 0x40000000
    v_mov_b32 v122, 0
    v_mov_b32 v123, 0
    v_mov_b32 v124, 0
    v_mov_b32 v125, 0
    ds_write_b128 v1, v[122:125] offset:0
    s_waitcnt lgkmcnt(0)
    s_barrier
    s_lshl_b32 s45, s45, 16
p1_tile:
    v_mov_b32 v122, 0
    v_mov_b32 v123, 0
    v_mov_b32 v124, 0
    v_mov_b32 v125, 0
    ds_write_b128 v1, v[122:125] offset:10496
    ds_write_b128 v1, v[122:125] offset:26880
    ds_write_b128 v1, v[122:125] offset:43264
    s_cmp_lg_u32 s28, 15
    s_cbranch_scc1 p1_tk0
    v_mov_b32 v127, 1
    s_mov_b64 exec, 1
    buffer_atomic_add v127, off, s[40:43], 0 offset:128 sc0 sc1
    s_mov_b64 exec, -1
p1_tk0:
    v_mov_b32 v123, s45
    v_mov_b32 v124, 0x007f007f
    v_mov_b32 v125, 0xe000
    v_mov_b32 v126, 0xffff0000
    s_cmp_lt_u32 s29, 1426
    s_cselect_b32 s6, 204800000, 0
    s_cselect_b32 s10, 204800000, 0
    s_add_u32 s32, s30, 49152
    buffer_load_dwordx4 v[16:19], v1, s[4:7], s32 offen nt
    buffer_load_dwordx4 v[52:55], v1, s[8:11], s32 offen nt
    s_waitcnt vmcnt(14)
    v_lshlrev_b32 v117, 16, v76
    v_and_b32 v118, v126, v76
    v_mul_f32 v117, v123, v117
    v_mul_f32 v118, v123, v118
    v_cvt_pk_bf16_f32 v117, v117, v118
    v_and_b32 v118, v126, v117
    v_lshlrev_b32 v117, 16, v117
    v_mul_f32 v117, 0.15915494, v117
    v_mul_f32 v118, 0.15915494, v118
    v_fract_f32 v117, v117
    v_fract_f32 v118, v118
    v_cos_f32 v117, v117
    v_cos_f32 v118, v118
    v_mul_hi_u32_u24 v122, s38, v102
    v_mul_hi_u32_u24 v121, s37, v94
    v_mul_hi_u32_u24 v120, s36, v94
    v_mad_i32_i24 v110, v122, s44, v102
    v_mad_u32_u24 v40, v122, 40, v121
    v_mad_i32_i24 v4, v120, s39, v94
    v_lshlrev_b16 v40, 2, v40
    v_mad_i32_i24 v120, v121, -3, v120
    ds_add_u32 v40, v3 offset:0
    v_lshl_or_b32 v4, v110, 16, v4
    v_lshl_or_b32 v4, v120, 30, v4
    v_mul_f32 v117, 0x03800000, v117
    v_mul_f32 v118, 0x03800000, v118
    v_cvt_pk_bf16_f32 v117, v117, v118
    v_mul_hi_u32_u24 v122, s38, v103
    v_mul_hi_u32_u24 v121, s37, v95
    v_mul_hi_u32_u24 v120, s36, v95
    v_mad_i32_i24 v110, v122, s44, v103
    v_mad_u32_u24 v41, v122, 40, v121
    v_mad_i32_i24 v5, v120, s39, v95
    v_lshlrev_b16 v41, 2, v41
    v_mad_i32_i24 v120, v121, -3, v120
    ds_add_u32 v41, v3 offset:0
    v_lshl_or_b32 v5, v110, 16, v5
    v_lshl_or_b32 v5, v120, 30, v5
    v_lshrrev_b32 v118, 3, v117
    v_lshrrev_b32 v119, 8, v117
    v_lshlrev_b16 v117, 13, v117
    v_bitop3_b32 v119, v118, v119, v124 bitop3:0x1b
    v_bitop3_b32 v4, v117, v125, v4 bitop3:0xae
    v_lshl_or_b32 v40, v119, 16, v40
    v_bitop3_b32 v5, v118, v125, v5 bitop3:0xae
    v_bitop3_b32 v41, v119, v126, v41 bitop3:0xea
    v_lshlrev_b32 v117, 16, v77
    v_and_b32 v118, v126, v77
    v_mul_f32 v117, v123, v117
    v_mul_f32 v118, v123, v118
    v_cvt_pk_bf16_f32 v117, v117, v118
    v_and_b32 v118, v126, v117
    v_lshlrev_b32 v117, 16, v117
    v_mul_f32 v117, 0.15915494, v117
    v_mul_f32 v118, 0.15915494, v118
    v_fract_f32 v117, v117
    v_fract_f32 v118, v118
    v_cos_f32 v117, v117
    v_cos_f32 v118, v118
    v_mul_hi_u32_u24 v122, s38, v104
    v_mul_hi_u32_u24 v121, s37, v96
    v_mul_hi_u32_u24 v120, s36, v96
    v_mad_i32_i24 v110, v122, s44, v104
    v_mad_u32_u24 v42, v122, 40, v121
    v_mad_i32_i24 v6, v120, s39, v96
    v_lshlrev_b16 v42, 2, v42
    v_mad_i32_i24 v120, v121, -3, v120
    ds_add_u32 v42, v3 offset:0
    v_lshl_or_b32 v6, v110, 16, v6
    v_lshl_or_b32 v6, v120, 30, v6
    v_mul_f32 v117, 0x03800000, v117
    v_mul_f32 v118, 0x03800000, v118
    v_cvt_pk_bf16_f32 v117, v117, v118
    v_mul_hi_u32_u24 v122, s38, v105
    v_mul_hi_u32_u24 v121, s37, v97
    v_mul_hi_u32_u24 v120, s36, v97
    v_mad_i32_i24 v110, v122, s44, v105
    v_mad_u32_u24 v43, v122, 40, v121
    v_mad_i32_i24 v7, v120, s39, v97
    v_lshlrev_b16 v43, 2, v43
    v_mad_i32_i24 v120, v121, -3, v120
    ds_add_u32 v43, v3 offset:0
    v_lshl_or_b32 v7, v110, 16, v7
    v_lshl_or_b32 v7, v120, 30, v7
    v_lshrrev_b32 v118, 3, v117
    v_lshrrev_b32 v119, 8, v117
    v_lshlrev_b16 v117, 13, v117
    v_bitop3_b32 v119, v118, v119, v124 bitop3:0x1b
    v_bitop3_b32 v6, v117, v125, v6 bitop3:0xae
    v_lshl_or_b32 v42, v119, 16, v42
    v_bitop3_b32 v7, v118, v125, v7 bitop3:0xae
    v_bitop3_b32 v43, v119, v126, v43 bitop3:0xea
    s_cmp_lt_u32 s29, 1389
    s_cselect_b32 s6, 204800000, 0
    s_cselect_b32 s10, 204800000, 0
    s_add_u32 s32, s30, 65536
    buffer_load_dwordx4 v[20:23], v1, s[4:7], s32 offen nt
    buffer_load_dwordx4 v[56:59], v1, s[8:11], s32 offen nt
    s_cmp_ge_u32 s29, 1499
    s_cbranch_scc1 p1_k2
    s_cmp_lg_u32 s34, 0
    s_cbranch_scc1 p1_w3
    s_waitcnt vmcnt(10)
p1_w3:
    s_waitcnt vmcnt(13)
    v_lshlrev_b32 v117, 16, v78
    v_and_b32 v118, v126, v78
    v_mul_f32 v117, v123, v117
    v_mul_f32 v118, v123, v118
    v_cvt_pk_bf16_f32 v117, v117, v118
    v_and_b32 v118, v126, v117
    v_lshlrev_b32 v117, 16, v117
    v_mul_f32 v117, 0.15915494, v117
    v_mul_f32 v118, 0.15915494, v118
    v_fract_f32 v117, v117
    v_fract_f32 v118, v118
    v_cos_f32 v117, v117
    v_cos_f32 v118, v118
    v_mul_hi_u32_u24 v122, s38, v106
    v_mul_hi_u32_u24 v121, s37, v98
    v_mul_hi_u32_u24 v120, s36, v98
    v_mad_i32_i24 v110, v122, s44, v106
    v_mad_u32_u24 v44, v122, 40, v121
    v_mad_i32_i24 v8, v120, s39, v98
    v_lshlrev_b16 v44, 2, v44
    v_mad_i32_i24 v120, v121, -3, v120
    ds_add_u32 v44, v3 offset:0
    v_lshl_or_b32 v8, v110, 16, v8
    v_lshl_or_b32 v8, v120, 30, v8
    v_mul_f32 v117, 0x03800000, v117
    v_mul_f32 v118, 0x03800000, v118
    v_cvt_pk_bf16_f32 v117, v117, v118
    v_mul_hi_u32_u24 v122, s38, v107
    v_mul_hi_u32_u24 v121, s37, v99
    v_mul_hi_u32_u24 v120, s36, v99
    v_mad_i32_i24 v110, v122, s44, v107
    v_mad_u32_u24 v45, v122, 40, v121
    v_mad_i32_i24 v9, v120, s39, v99
    v_lshlrev_b16 v45, 2, v45
    v_mad_i32_i24 v120, v121, -3, v120
    ds_add_u32 v45, v3 offset:0
    v_lshl_or_b32 v9, v110, 16, v9
    v_lshl_or_b32 v9, v120, 30, v9
    v_lshrrev_b32 v118, 3, v117
    v_lshrrev_b32 v119, 8, v117
    v_lshlrev_b16 v117, 13, v117
    v_bitop3_b32 v119, v118, v119, v124 bitop3:0x1b
    v_bitop3_b32 v8, v117, v125, v8 bitop3:0xae
    v_lshl_or_b32 v44, v119, 16, v44
    v_bitop3_b32 v9, v118, v125, v9 bitop3:0xae
    v_bitop3_b32 v45, v119, v126, v45 bitop3:0xea
    v_lshlrev_b32 v117, 16, v79
    v_and_b32 v118, v126, v79
    v_mul_f32 v117, v123, v117
    v_mul_f32 v118, v123, v118
    v_cvt_pk_bf16_f32 v117, v117, v118
    v_and_b32 v118, v126, v117
    v_lshlrev_b32 v117, 16, v117
    v_mul_f32 v117, 0.15915494, v117
    v_mul_f32 v118, 0.15915494, v118
    v_fract_f32 v117, v117
    v_fract_f32 v118, v118
    v_cos_f32 v117, v117
    v_cos_f32 v118, v118
    v_mul_hi_u32_u24 v122, s38, v108
    v_mul_hi_u32_u24 v121, s37, v100
    v_mul_hi_u32_u24 v120, s36, v100
    v_mad_i32_i24 v110, v122, s44, v108
    v_mad_u32_u24 v46, v122, 40, v121
    v_mad_i32_i24 v10, v120, s39, v100
    v_lshlrev_b16 v46, 2, v46
    v_mad_i32_i24 v120, v121, -3, v120
    ds_add_u32 v46, v3 offset:0
    v_lshl_or_b32 v10, v110, 16, v10
    v_lshl_or_b32 v10, v120, 30, v10
    v_mul_f32 v117, 0x03800000, v117
    v_mul_f32 v118, 0x03800000, v118
    v_cvt_pk_bf16_f32 v117, v117, v118
    v_mul_hi_u32_u24 v122, s38, v109
    v_mul_hi_u32_u24 v121, s37, v101
    v_mul_hi_u32_u24 v120, s36, v101
    v_mad_i32_i24 v110, v122, s44, v109
    v_mad_u32_u24 v47, v122, 40, v121
    v_mad_i32_i24 v11, v120, s39, v101
    v_lshlrev_b16 v47, 2, v47
    v_mad_i32_i24 v120, v121, -3, v120
    ds_add_u32 v47, v3 offset:0
    v_lshl_or_b32 v11, v110, 16, v11
    v_lshl_or_b32 v11, v120, 30, v11
    v_lshrrev_b32 v118, 3, v117
    v_lshrrev_b32 v119, 8, v117
    v_lshlrev_b16 v117, 13, v117
    v_bitop3_b32 v119, v118, v119, v124 bitop3:0x1b
    v_bitop3_b32 v10, v117, v125, v10 bitop3:0xae
    v_lshl_or_b32 v46, v119, 16, v46
    v_bitop3_b32 v11, v118, v125, v11 bitop3:0xae
    v_bitop3_b32 v47, v119, v126, v47 bitop3:0xea
p1_k2:
    s_cmp_lt_u32 s29, 1352
    s_cselect_b32 s6, 204800000, 0
    s_cselect_b32 s10, 204800000, 0
    s_add_u32 s32, s30, 81920
    buffer_load_dwordx4 v[24:27], v1, s[4:7], s32 offen nt
    buffer_load_dwordx4 v[60:63], v1, s[8:11], s32 offen nt
    s_cmp_ge_u32 s29, 1462
    s_cbranch_scc1 p1_k4
    s_cmp_lg_u32 s34, 0
    s_cbranch_scc1 p1_w5
    s_waitcnt vmcnt(6)
p1_w5:
    s_waitcnt vmcnt(11)
    v_lshlrev_b32 v117, 16, v80
    v_and_b32 v118, v126, v80
    v_mul_f32 v117, v123, v117
    v_mul_f32 v118, v123, v118
    v_cvt_pk_bf16_f32 v117, v117, v118
    v_and_b32 v118, v126, v117
    v_lshlrev_b32 v117, 16, v117
    v_mul_f32 v117, 0.15915494, v117
    v_mul_f32 v118, 0.15915494, v118
    v_fract_f32 v117, v117
    v_fract_f32 v118, v118
    v_cos_f32 v117, v117
    v_cos_f32 v118, v118
    v_mul_hi_u32_u24 v122, s38, v48
    v_mul_hi_u32_u24 v121, s37, v12
    v_mul_hi_u32_u24 v120, s36, v12
    v_mad_i32_i24 v110, v122, s44, v48
    v_mad_u32_u24 v48, v122, 40, v121
    v_mad_i32_i24 v12, v120, s39, v12
    v_lshlrev_b16 v48, 2, v48
    v_mad_i32_i24 v120, v121, -3, v120
    ds_add_u32 v48, v3 offset:0
    v_lshl_or_b32 v12, v110, 16, v12
    v_lshl_or_b32 v12, v120, 30, v12
    v_mul_f32 v117, 0x03800000, v117
    v_mul_f32 v118, 0x03800000, v118
    v_cvt_pk_bf16_f32 v117, v117, v118
    v_mul_hi_u32_u24 v122, s38, v49
    v_mul_hi_u32_u24 v121, s37, v13
    v_mul_hi_u32_u24 v120, s36, v13
    v_mad_i32_i24 v110, v122, s44, v49
    v_mad_u32_u24 v49, v122, 40, v121
    v_mad_i32_i24 v13, v120, s39, v13
    v_lshlrev_b16 v49, 2, v49
    v_mad_i32_i24 v120, v121, -3, v120
    ds_add_u32 v49, v3 offset:0
    v_lshl_or_b32 v13, v110, 16, v13
    v_lshl_or_b32 v13, v120, 30, v13
    v_lshrrev_b32 v118, 3, v117
    v_lshrrev_b32 v119, 8, v117
    v_lshlrev_b16 v117, 13, v117
    v_bitop3_b32 v119, v118, v119, v124 bitop3:0x1b
    v_bitop3_b32 v12, v117, v125, v12 bitop3:0xae
    v_lshl_or_b32 v48, v119, 16, v48
    v_bitop3_b32 v13, v118, v125, v13 bitop3:0xae
    v_bitop3_b32 v49, v119, v126, v49 bitop3:0xea
    v_lshlrev_b32 v117, 16, v81
    v_and_b32 v118, v126, v81
    v_mul_f32 v117, v123, v117
    v_mul_f32 v118, v123, v118
    v_cvt_pk_bf16_f32 v117, v117, v118
    v_and_b32 v118, v126, v117
    v_lshlrev_b32 v117, 16, v117
    v_mul_f32 v117, 0.15915494, v117
    v_mul_f32 v118, 0.15915494, v118
    v_fract_f32 v117, v117
    v_fract_f32 v118, v118
    v_cos_f32 v117, v117
    v_cos_f32 v118, v118
    v_mul_hi_u32_u24 v122, s38, v50
    v_mul_hi_u32_u24 v121, s37, v14
    v_mul_hi_u32_u24 v120, s36, v14
    v_mad_i32_i24 v110, v122, s44, v50
    v_mad_u32_u24 v50, v122, 40, v121
    v_mad_i32_i24 v14, v120, s39, v14
    v_lshlrev_b16 v50, 2, v50
    v_mad_i32_i24 v120, v121, -3, v120
    ds_add_u32 v50, v3 offset:0
    v_lshl_or_b32 v14, v110, 16, v14
    v_lshl_or_b32 v14, v120, 30, v14
    v_mul_f32 v117, 0x03800000, v117
    v_mul_f32 v118, 0x03800000, v118
    v_cvt_pk_bf16_f32 v117, v117, v118
    v_mul_hi_u32_u24 v122, s38, v51
    v_mul_hi_u32_u24 v121, s37, v15
    v_mul_hi_u32_u24 v120, s36, v15
    v_mad_i32_i24 v110, v122, s44, v51
    v_mad_u32_u24 v51, v122, 40, v121
    v_mad_i32_i24 v15, v120, s39, v15
    v_lshlrev_b16 v51, 2, v51
    v_mad_i32_i24 v120, v121, -3, v120
    ds_add_u32 v51, v3 offset:0
    v_lshl_or_b32 v15, v110, 16, v15
    v_lshl_or_b32 v15, v120, 30, v15
    v_lshrrev_b32 v118, 3, v117
    v_lshrrev_b32 v119, 8, v117
    v_lshlrev_b16 v117, 13, v117
    v_bitop3_b32 v119, v118, v119, v124 bitop3:0x1b
    v_bitop3_b32 v14, v117, v125, v14 bitop3:0xae
    v_lshl_or_b32 v50, v119, 16, v50
    v_bitop3_b32 v15, v118, v125, v15 bitop3:0xae
    v_bitop3_b32 v51, v119, v126, v51 bitop3:0xea
p1_k4:
    s_cmp_lt_u32 s29, 1315
    s_cselect_b32 s6, 204800000, 0
    s_cselect_b32 s10, 204800000, 0
    s_add_u32 s32, s30, 98304
    buffer_load_dwordx4 v[28:31], v1, s[4:7], s32 offen nt
    buffer_load_dwordx4 v[64:67], v1, s[8:11], s32 offen nt
    s_cmp_ge_u32 s29, 1426
    s_cbranch_scc1 p1_k6
    s_waitcnt vmcnt(6)
    v_lshlrev_b32 v117, 16, v82
    v_and_b32 v118, v126, v82
    v_mul_f32 v117, v123, v117
    v_mul_f32 v118, v123, v118
    v_cvt_pk_bf16_f32 v117, v117, v118
    v_and_b32 v118, v126, v117
    v_lshlrev_b32 v117, 16, v117
    v_mul_f32 v117, 0.15915494, v117
    v_mul_f32 v118, 0.15915494, v118
    v_fract_f32 v117, v117
    v_fract_f32 v118, v118
    v_cos_f32 v117, v117
    v_cos_f32 v118, v118
    v_mul_hi_u32_u24 v122, s38, v52
    v_mul_hi_u32_u24 v121, s37, v16
    v_mul_hi_u32_u24 v120, s36, v16
    v_mad_i32_i24 v110, v122, s44, v52
    v_mad_u32_u24 v52, v122, 40, v121
    v_mad_i32_i24 v16, v120, s39, v16
    v_lshlrev_b16 v52, 2, v52
    v_mad_i32_i24 v120, v121, -3, v120
    ds_add_u32 v52, v3 offset:0
    v_lshl_or_b32 v16, v110, 16, v16
    v_lshl_or_b32 v16, v120, 30, v16
    v_mul_f32 v117, 0x03800000, v117
    v_mul_f32 v118, 0x03800000, v118
    v_cvt_pk_bf16_f32 v117, v117, v118
    v_mul_hi_u32_u24 v122, s38, v53
    v_mul_hi_u32_u24 v121, s37, v17
    v_mul_hi_u32_u24 v120, s36, v17
    v_mad_i32_i24 v110, v122, s44, v53
    v_mad_u32_u24 v53, v122, 40, v121
    v_mad_i32_i24 v17, v120, s39, v17
    v_lshlrev_b16 v53, 2, v53
    v_mad_i32_i24 v120, v121, -3, v120
    ds_add_u32 v53, v3 offset:0
    v_lshl_or_b32 v17, v110, 16, v17
    v_lshl_or_b32 v17, v120, 30, v17
    v_lshrrev_b32 v118, 3, v117
    v_lshrrev_b32 v119, 8, v117
    v_lshlrev_b16 v117, 13, v117
    v_bitop3_b32 v119, v118, v119, v124 bitop3:0x1b
    v_bitop3_b32 v16, v117, v125, v16 bitop3:0xae
    v_lshl_or_b32 v52, v119, 16, v52
    v_bitop3_b32 v17, v118, v125, v17 bitop3:0xae
    v_bitop3_b32 v53, v119, v126, v53 bitop3:0xea
    v_lshlrev_b32 v117, 16, v83
    v_and_b32 v118, v126, v83
    v_mul_f32 v117, v123, v117
    v_mul_f32 v118, v123, v118
    v_cvt_pk_bf16_f32 v117, v117, v118
    v_and_b32 v118, v126, v117
    v_lshlrev_b32 v117, 16, v117
    v_mul_f32 v117, 0.15915494, v117
    v_mul_f32 v118, 0.15915494, v118
    v_fract_f32 v117, v117
    v_fract_f32 v118, v118
    v_cos_f32 v117, v117
    v_cos_f32 v118, v118
    v_mul_hi_u32_u24 v122, s38, v54
    v_mul_hi_u32_u24 v121, s37, v18
    v_mul_hi_u32_u24 v120, s36, v18
    v_mad_i32_i24 v110, v122, s44, v54
    v_mad_u32_u24 v54, v122, 40, v121
    v_mad_i32_i24 v18, v120, s39, v18
    v_lshlrev_b16 v54, 2, v54
    v_mad_i32_i24 v120, v121, -3, v120
    ds_add_u32 v54, v3 offset:0
    v_lshl_or_b32 v18, v110, 16, v18
    v_lshl_or_b32 v18, v120, 30, v18
    v_mul_f32 v117, 0x03800000, v117
    v_mul_f32 v118, 0x03800000, v118
    v_cvt_pk_bf16_f32 v117, v117, v118
    v_mul_hi_u32_u24 v122, s38, v55
    v_mul_hi_u32_u24 v121, s37, v19
    v_mul_hi_u32_u24 v120, s36, v19
    v_mad_i32_i24 v110, v122, s44, v55
    v_mad_u32_u24 v55, v122, 40, v121
    v_mad_i32_i24 v19, v120, s39, v19
    v_lshlrev_b16 v55, 2, v55
    v_mad_i32_i24 v120, v121, -3, v120
    ds_add_u32 v55, v3 offset:0
    v_lshl_or_b32 v19, v110, 16, v19
    v_lshl_or_b32 v19, v120, 30, v19
    v_lshrrev_b32 v118, 3, v117
    v_lshrrev_b32 v119, 8, v117
    v_lshlrev_b16 v117, 13, v117
    v_bitop3_b32 v119, v118, v119, v124 bitop3:0x1b
    v_bitop3_b32 v18, v117, v125, v18 bitop3:0xae
    v_lshl_or_b32 v54, v119, 16, v54
    v_bitop3_b32 v19, v118, v125, v19 bitop3:0xae
    v_bitop3_b32 v55, v119, v126, v55 bitop3:0xea
p1_k6:
    s_cmp_lt_u32 s29, 1279
    s_cselect_b32 s6, 204800000, 0
    s_cselect_b32 s10, 204800000, 0
    s_add_u32 s32, s30, 114688
    buffer_load_dwordx4 v[32:35], v1, s[4:7], s32 offen nt
    buffer_load_dwordx4 v[68:71], v1, s[8:11], s32 offen nt
    s_cmp_ge_u32 s29, 1389
    s_cbranch_scc1 p1_k8
    s_waitcnt vmcnt(6)
    v_lshlrev_b32 v117, 16, v84
    v_and_b32 v118, v126, v84
    v_mul_f32 v117, v123, v117
    v_mul_f32 v118, v123, v118
    v_cvt_pk_bf16_f32 v117, v117, v118
    v_and_b32 v118, v126, v117
    v_lshlrev_b32 v117, 16, v117
    v_mul_f32 v117, 0.15915494, v117
    v_mul_f32 v118, 0.15915494, v118
    v_fract_f32 v117, v117
    v_fract_f32 v118, v118
    v_cos_f32 v117, v117
    v_cos_f32 v118, v118
    v_mul_hi_u32_u24 v122, s38, v56
    v_mul_hi_u32_u24 v121, s37, v20
    v_mul_hi_u32_u24 v120, s36, v20
    v_mad_i32_i24 v110, v122, s44, v56
    v_mad_u32_u24 v56, v122, 40, v121
    v_mad_i32_i24 v20, v120, s39, v20
    v_lshlrev_b16 v56, 2, v56
    v_mad_i32_i24 v120, v121, -3, v120
    ds_add_u32 v56, v3 offset:0
    v_lshl_or_b32 v20, v110, 16, v20
    v_lshl_or_b32 v20, v120, 30, v20
    v_mul_f32 v117, 0x03800000, v117
    v_mul_f32 v118, 0x03800000, v118
    v_cvt_pk_bf16_f32 v117, v117, v118
    v_mul_hi_u32_u24 v122, s38, v57
    v_mul_hi_u32_u24 v121, s37, v21
    v_mul_hi_u32_u24 v120, s36, v21
    v_mad_i32_i24 v110, v122, s44, v57
    v_mad_u32_u24 v57, v122, 40, v121
    v_mad_i32_i24 v21, v120, s39, v21
    v_lshlrev_b16 v57, 2, v57
    v_mad_i32_i24 v120, v121, -3, v120
    ds_add_u32 v57, v3 offset:0
    v_lshl_or_b32 v21, v110, 16, v21
    v_lshl_or_b32 v21, v120, 30, v21
    v_lshrrev_b32 v118, 3, v117
    v_lshrrev_b32 v119, 8, v117
    v_lshlrev_b16 v117, 13, v117
    v_bitop3_b32 v119, v118, v119, v124 bitop3:0x1b
    v_bitop3_b32 v20, v117, v125, v20 bitop3:0xae
    v_lshl_or_b32 v56, v119, 16, v56
    v_bitop3_b32 v21, v118, v125, v21 bitop3:0xae
    v_bitop3_b32 v57, v119, v126, v57 bitop3:0xea
    v_lshlrev_b32 v117, 16, v85
    v_and_b32 v118, v126, v85
    v_mul_f32 v117, v123, v117
    v_mul_f32 v118, v123, v118
    v_cvt_pk_bf16_f32 v117, v117, v118
    v_and_b32 v118, v126, v117
    v_lshlrev_b32 v117, 16, v117
    v_mul_f32 v117, 0.15915494, v117
    v_mul_f32 v118, 0.15915494, v118
    v_fract_f32 v117, v117
    v_fract_f32 v118, v118
    v_cos_f32 v117, v117
    v_cos_f32 v118, v118
    v_mul_hi_u32_u24 v122, s38, v58
    v_mul_hi_u32_u24 v121, s37, v22
    v_mul_hi_u32_u24 v120, s36, v22
    v_mad_i32_i24 v110, v122, s44, v58
    v_mad_u32_u24 v58, v122, 40, v121
    v_mad_i32_i24 v22, v120, s39, v22
    v_lshlrev_b16 v58, 2, v58
    v_mad_i32_i24 v120, v121, -3, v120
    ds_add_u32 v58, v3 offset:0
    v_lshl_or_b32 v22, v110, 16, v22
    v_lshl_or_b32 v22, v120, 30, v22
    v_mul_f32 v117, 0x03800000, v117
    v_mul_f32 v118, 0x03800000, v118
    v_cvt_pk_bf16_f32 v117, v117, v118
    v_mul_hi_u32_u24 v122, s38, v59
    v_mul_hi_u32_u24 v121, s37, v23
    v_mul_hi_u32_u24 v120, s36, v23
    v_mad_i32_i24 v110, v122, s44, v59
    v_mad_u32_u24 v59, v122, 40, v121
    v_mad_i32_i24 v23, v120, s39, v23
    v_lshlrev_b16 v59, 2, v59
    v_mad_i32_i24 v120, v121, -3, v120
    ds_add_u32 v59, v3 offset:0
    v_lshl_or_b32 v23, v110, 16, v23
    v_lshl_or_b32 v23, v120, 30, v23
    v_lshrrev_b32 v118, 3, v117
    v_lshrrev_b32 v119, 8, v117
    v_lshlrev_b16 v117, 13, v117
    v_bitop3_b32 v119, v118, v119, v124 bitop3:0x1b
    v_bitop3_b32 v22, v117, v125, v22 bitop3:0xae
    v_lshl_or_b32 v58, v119, 16, v58
    v_bitop3_b32 v23, v118, v125, v23 bitop3:0xae
    v_bitop3_b32 v59, v119, v126, v59 bitop3:0xea
p1_k8:
    s_cmp_lt_u32 s29, 1242
    s_cselect_b32 s6, 204800000, 0
    s_cselect_b32 s10, 204800000, 0
    s_add_u32 s32, s30, 131072
    buffer_load_dwordx4 v[36:39], v1, s[4:7], s32 offen nt
    buffer_load_dwordx4 v[72:75], v1, s[8:11], s32 offen nt
    s_cmp_ge_u32 s29, 1352
    s_cbranch_scc1 p1_k10
    s_waitcnt vmcnt(6)
    v_lshlrev_b32 v117, 16, v86
    v_and_b32 v118, v126, v86
    v_mul_f32 v117, v123, v117
    v_mul_f32 v118, v123, v118
    v_cvt_pk_bf16_f32 v117, v117, v118
    v_and_b32 v118, v126, v117
    v_lshlrev_b32 v117, 16, v117
    v_mul_f32 v117, 0.15915494, v117
    v_mul_f32 v118, 0.15915494, v118
    v_fract_f32 v117, v117
    v_fract_f32 v118, v118
    v_cos_f32 v117, v117
    v_cos_f32 v118, v118
    v_mul_hi_u32_u24 v122, s38, v60
    v_mul_hi_u32_u24 v121, s37, v24
    v_mul_hi_u32_u24 v120, s36, v24
    v_mad_i32_i24 v110, v122, s44, v60
    v_mad_u32_u24 v60, v122, 40, v121
    v_mad_i32_i24 v24, v120, s39, v24
    v_lshlrev_b16 v60, 2, v60
    v_mad_i32_i24 v120, v121, -3, v120
    ds_add_u32 v60, v3 offset:0
    v_lshl_or_b32 v24, v110, 16, v24
    v_lshl_or_b32 v24, v120, 30, v24
    v_mul_f32 v117, 0x03800000, v117
    v_mul_f32 v118, 0x03800000, v118
    v_cvt_pk_bf16_f32 v117, v117, v118
    v_mul_hi_u32_u24 v122, s38, v61
    v_mul_hi_u32_u24 v121, s37, v25
    v_mul_hi_u32_u24 v120, s36, v25
    v_mad_i32_i24 v110, v122, s44, v61
    v_mad_u32_u24 v61, v122, 40, v121
    v_mad_i32_i24 v25, v120, s39, v25
    v_lshlrev_b16 v61, 2, v61
    v_mad_i32_i24 v120, v121, -3, v120
    ds_add_u32 v61, v3 offset:0
    v_lshl_or_b32 v25, v110, 16, v25
    v_lshl_or_b32 v25, v120, 30, v25
    v_lshrrev_b32 v118, 3, v117
    v_lshrrev_b32 v119, 8, v117
    v_lshlrev_b16 v117, 13, v117
    v_bitop3_b32 v119, v118, v119, v124 bitop3:0x1b
    v_bitop3_b32 v24, v117, v125, v24 bitop3:0xae
    v_lshl_or_b32 v60, v119, 16, v60
    v_bitop3_b32 v25, v118, v125, v25 bitop3:0xae
    v_bitop3_b32 v61, v119, v126, v61 bitop3:0xea
    v_lshlrev_b32 v117, 16, v87
    v_and_b32 v118, v126, v87
    v_mul_f32 v117, v123, v117
    v_mul_f32 v118, v123, v118
    v_cvt_pk_bf16_f32 v117, v117, v118
    v_and_b32 v118, v126, v117
    v_lshlrev_b32 v117, 16, v117
    v_mul_f32 v117, 0.15915494, v117
    v_mul_f32 v118, 0.15915494, v118
    v_fract_f32 v117, v117
    v_fract_f32 v118, v118
    v_cos_f32 v117, v117
    v_cos_f32 v118, v118
    v_mul_hi_u32_u24 v122, s38, v62
    v_mul_hi_u32_u24 v121, s37, v26
    v_mul_hi_u32_u24 v120, s36, v26
    v_mad_i32_i24 v110, v122, s44, v62
    v_mad_u32_u24 v62, v122, 40, v121
    v_mad_i32_i24 v26, v120, s39, v26
    v_lshlrev_b16 v62, 2, v62
    v_mad_i32_i24 v120, v121, -3, v120
    ds_add_u32 v62, v3 offset:0
    v_lshl_or_b32 v26, v110, 16, v26
    v_lshl_or_b32 v26, v120, 30, v26
    v_mul_f32 v117, 0x03800000, v117
    v_mul_f32 v118, 0x03800000, v118
    v_cvt_pk_bf16_f32 v117, v117, v118
    v_mul_hi_u32_u24 v122, s38, v63
    v_mul_hi_u32_u24 v121, s37, v27
    v_mul_hi_u32_u24 v120, s36, v27
    v_mad_i32_i24 v110, v122, s44, v63
    v_mad_u32_u24 v63, v122, 40, v121
    v_mad_i32_i24 v27, v120, s39, v27
    v_lshlrev_b16 v63, 2, v63
    v_mad_i32_i24 v120, v121, -3, v120
    ds_add_u32 v63, v3 offset:0
    v_lshl_or_b32 v27, v110, 16, v27
    v_lshl_or_b32 v27, v120, 30, v27
    v_lshrrev_b32 v118, 3, v117
    v_lshrrev_b32 v119, 8, v117
    v_lshlrev_b16 v117, 13, v117
    v_bitop3_b32 v119, v118, v119, v124 bitop3:0x1b
    v_bitop3_b32 v26, v117, v125, v26 bitop3:0xae
    v_lshl_or_b32 v62, v119, 16, v62
    v_bitop3_b32 v27, v118, v125, v27 bitop3:0xae
    v_bitop3_b32 v63, v119, v126, v63 bitop3:0xea
p1_k10:
    s_cmp_ge_u32 s29, 1315
    s_cbranch_scc1 p1_k12
    s_waitcnt vmcnt(4)
    v_lshlrev_b32 v117, 16, v88
    v_and_b32 v118, v126, v88
    v_mul_f32 v117, v123, v117
    v_mul_f32 v118, v123, v118
    v_cvt_pk_bf16_f32 v117, v117, v118
    v_and_b32 v118, v126, v117
    v_lshlrev_b32 v117, 16, v117
    v_mul_f32 v117, 0.15915494, v117
    v_mul_f32 v118, 0.15915494, v118
    v_fract_f32 v117, v117
    v_fract_f32 v118, v118
    v_cos_f32 v117, v117
    v_cos_f32 v118, v118
    v_mul_hi_u32_u24 v122, s38, v64
    v_mul_hi_u32_u24 v121, s37, v28
    v_mul_hi_u32_u24 v120, s36, v28
    v_mad_i32_i24 v110, v122, s44, v64
    v_mad_u32_u24 v64, v122, 40, v121
    v_mad_i32_i24 v28, v120, s39, v28
    v_lshlrev_b16 v64, 2, v64
    v_mad_i32_i24 v120, v121, -3, v120
    ds_add_u32 v64, v3 offset:0
    v_lshl_or_b32 v28, v110, 16, v28
    v_lshl_or_b32 v28, v120, 30, v28
    v_mul_f32 v117, 0x03800000, v117
    v_mul_f32 v118, 0x03800000, v118
    v_cvt_pk_bf16_f32 v117, v117, v118
    v_mul_hi_u32_u24 v122, s38, v65
    v_mul_hi_u32_u24 v121, s37, v29
    v_mul_hi_u32_u24 v120, s36, v29
    v_mad_i32_i24 v110, v122, s44, v65
    v_mad_u32_u24 v65, v122, 40, v121
    v_mad_i32_i24 v29, v120, s39, v29
    v_lshlrev_b16 v65, 2, v65
    v_mad_i32_i24 v120, v121, -3, v120
    ds_add_u32 v65, v3 offset:0
    v_lshl_or_b32 v29, v110, 16, v29
    v_lshl_or_b32 v29, v120, 30, v29
    v_lshrrev_b32 v118, 3, v117
    v_lshrrev_b32 v119, 8, v117
    v_lshlrev_b16 v117, 13, v117
    v_bitop3_b32 v119, v118, v119, v124 bitop3:0x1b
    v_bitop3_b32 v28, v117, v125, v28 bitop3:0xae
    v_lshl_or_b32 v64, v119, 16, v64
    v_bitop3_b32 v29, v118, v125, v29 bitop3:0xae
    v_bitop3_b32 v65, v119, v126, v65 bitop3:0xea
    v_lshlrev_b32 v117, 16, v89
    v_and_b32 v118, v126, v89
    v_mul_f32 v117, v123, v117
    v_mul_f32 v118, v123, v118
    v_cvt_pk_bf16_f32 v117, v117, v118
    v_and_b32 v118, v126, v117
    v_lshlrev_b32 v117, 16, v117
    v_mul_f32 v117, 0.15915494, v117
    v_mul_f32 v118, 0.15915494, v118
    v_fract_f32 v117, v117
    v_fract_f32 v118, v118
    v_cos_f32 v117, v117
    v_cos_f32 v118, v118
    v_mul_hi_u32_u24 v122, s38, v66
    v_mul_hi_u32_u24 v121, s37, v30
    v_mul_hi_u32_u24 v120, s36, v30
    v_mad_i32_i24 v110, v122, s44, v66
    v_mad_u32_u24 v66, v122, 40, v121
    v_mad_i32_i24 v30, v120, s39, v30
    v_lshlrev_b16 v66, 2, v66
    v_mad_i32_i24 v120, v121, -3, v120
    ds_add_u32 v66, v3 offset:0
    v_lshl_or_b32 v30, v110, 16, v30
    v_lshl_or_b32 v30, v120, 30, v30
    v_mul_f32 v117, 0x03800000, v117
    v_mul_f32 v118, 0x03800000, v118
    v_cvt_pk_bf16_f32 v117, v117, v118
    v_mul_hi_u32_u24 v122, s38, v67
    v_mul_hi_u32_u24 v121, s37, v31
    v_mul_hi_u32_u24 v120, s36, v31
    v_mad_i32_i24 v110, v122, s44, v67
    v_mad_u32_u24 v67, v122, 40, v121
    v_mad_i32_i24 v31, v120, s39, v31
    v_lshlrev_b16 v67, 2, v67
    v_mad_i32_i24 v120, v121, -3, v120
    ds_add_u32 v67, v3 offset:0
    v_lshl_or_b32 v31, v110, 16, v31
    v_lshl_or_b32 v31, v120, 30, v31
    v_lshrrev_b32 v118, 3, v117
    v_lshrrev_b32 v119, 8, v117
    v_lshlrev_b16 v117, 13, v117
    v_bitop3_b32 v119, v118, v119, v124 bitop3:0x1b
    v_bitop3_b32 v30, v117, v125, v30 bitop3:0xae
    v_lshl_or_b32 v66, v119, 16, v66
    v_bitop3_b32 v31, v118, v125, v31 bitop3:0xae
    v_bitop3_b32 v67, v119, v126, v67 bitop3:0xea
p1_k12:
    s_cmp_ge_u32 s29, 1279
    s_cbranch_scc1 p1_k14
    s_waitcnt vmcnt(2)
    v_lshlrev_b32 v117, 16, v90
    v_and_b32 v118, v126, v90
    v_mul_f32 v117, v123, v117
    v_mul_f32 v118, v123, v118
    v_cvt_pk_bf16_f32 v117, v117, v118
    v_and_b32 v118, v126, v117
    v_lshlrev_b32 v117, 16, v117
    v_mul_f32 v117, 0.15915494, v117
    v_mul_f32 v118, 0.15915494, v118
    v_fract_f32 v117, v117
    v_fract_f32 v118, v118
    v_cos_f32 v117, v117
    v_cos_f32 v118, v118
    v_mul_hi_u32_u24 v122, s38, v68
    v_mul_hi_u32_u24 v121, s37, v32
    v_mul_hi_u32_u24 v120, s36, v32
    v_mad_i32_i24 v110, v122, s44, v68
    v_mad_u32_u24 v68, v122, 40, v121
    v_mad_i32_i24 v32, v120, s39, v32
    v_lshlrev_b16 v68, 2, v68
    v_mad_i32_i24 v120, v121, -3, v120
    ds_add_u32 v68, v3 offset:0
    v_lshl_or_b32 v32, v110, 16, v32
    v_lshl_or_b32 v32, v120, 30, v32
    v_mul_f32 v117, 0x03800000, v117
    v_mul_f32 v118, 0x03800000, v118
    v_cvt_pk_bf16_f32 v117, v117, v118
    v_mul_hi_u32_u24 v122, s38, v69
    v_mul_hi_u32_u24 v121, s37, v33
    v_mul_hi_u32_u24 v120, s36, v33
    v_mad_i32_i24 v110, v122, s44, v69
    v_mad_u32_u24 v69, v122, 40, v121
    v_mad_i32_i24 v33, v120, s39, v33
    v_lshlrev_b16 v69, 2, v69
    v_mad_i32_i24 v120, v121, -3, v120
    ds_add_u32 v69, v3 offset:0
    v_lshl_or_b32 v33, v110, 16, v33
    v_lshl_or_b32 v33, v120, 30, v33
    v_lshrrev_b32 v118, 3, v117
    v_lshrrev_b32 v119, 8, v117
    v_lshlrev_b16 v117, 13, v117
    v_bitop3_b32 v119, v118, v119, v124 bitop3:0x1b
    v_bitop3_b32 v32, v117, v125, v32 bitop3:0xae
    v_lshl_or_b32 v68, v119, 16, v68
    v_bitop3_b32 v33, v118, v125, v33 bitop3:0xae
    v_bitop3_b32 v69, v119, v126, v69 bitop3:0xea
    v_lshlrev_b32 v117, 16, v91
    v_and_b32 v118, v126, v91
    v_mul_f32 v117, v123, v117
    v_mul_f32 v118, v123, v118
    v_cvt_pk_bf16_f32 v117, v117, v118
    v_and_b32 v118, v126, v117
    v_lshlrev_b32 v117, 16, v117
    v_mul_f32 v117, 0.15915494, v117
    v_mul_f32 v118, 0.15915494, v118
    v_fract_f32 v117, v117
    v_fract_f32 v118, v118
    v_cos_f32 v117, v117
    v_cos_f32 v118, v118
    v_mul_hi_u32_u24 v122, s38, v70
    v_mul_hi_u32_u24 v121, s37, v34
    v_mul_hi_u32_u24 v120, s36, v34
    v_mad_i32_i24 v110, v122, s44, v70
    v_mad_u32_u24 v70, v122, 40, v121
    v_mad_i32_i24 v34, v120, s39, v34
    v_lshlrev_b16 v70, 2, v70
    v_mad_i32_i24 v120, v121, -3, v120
    ds_add_u32 v70, v3 offset:0
    v_lshl_or_b32 v34, v110, 16, v34
    v_lshl_or_b32 v34, v120, 30, v34
    v_mul_f32 v117, 0x03800000, v117
    v_mul_f32 v118, 0x03800000, v118
    v_cvt_pk_bf16_f32 v117, v117, v118
    v_mul_hi_u32_u24 v122, s38, v71
    v_mul_hi_u32_u24 v121, s37, v35
    v_mul_hi_u32_u24 v120, s36, v35
    v_mad_i32_i24 v110, v122, s44, v71
    v_mad_u32_u24 v71, v122, 40, v121
    v_mad_i32_i24 v35, v120, s39, v35
    v_lshlrev_b16 v71, 2, v71
    v_mad_i32_i24 v120, v121, -3, v120
    ds_add_u32 v71, v3 offset:0
    v_lshl_or_b32 v35, v110, 16, v35
    v_lshl_or_b32 v35, v120, 30, v35
    v_lshrrev_b32 v118, 3, v117
    v_lshrrev_b32 v119, 8, v117
    v_lshlrev_b16 v117, 13, v117
    v_bitop3_b32 v119, v118, v119, v124 bitop3:0x1b
    v_bitop3_b32 v34, v117, v125, v34 bitop3:0xae
    v_lshl_or_b32 v70, v119, 16, v70
    v_bitop3_b32 v35, v118, v125, v35 bitop3:0xae
    v_bitop3_b32 v71, v119, v126, v71 bitop3:0xea
p1_k14:
    s_cmp_ge_u32 s29, 1242
    s_cbranch_scc1 p1_k16
    s_waitcnt vmcnt(0)
    v_lshlrev_b32 v117, 16, v92
    v_and_b32 v118, v126, v92
    v_mul_f32 v117, v123, v117
    v_mul_f32 v118, v123, v118
    v_cvt_pk_bf16_f32 v117, v117, v118
    v_and_b32 v118, v126, v117
    v_lshlrev_b32 v117, 16, v117
    v_mul_f32 v117, 0.15915494, v117
    v_mul_f32 v118, 0.15915494, v118
    v_fract_f32 v117, v117
    v_fract_f32 v118, v118
    v_cos_f32 v117, v117
    v_cos_f32 v118, v118
    v_mul_hi_u32_u24 v122, s38, v72
    v_mul_hi_u32_u24 v121, s37, v36
    v_mul_hi_u32_u24 v120, s36, v36
    v_mad_i32_i24 v110, v122, s44, v72
    v_mad_u32_u24 v72, v122, 40, v121
    v_mad_i32_i24 v36, v120, s39, v36
    v_lshlrev_b16 v72, 2, v72
    v_mad_i32_i24 v120, v121, -3, v120
    ds_add_u32 v72, v3 offset:0
    v_lshl_or_b32 v36, v110, 16, v36
    v_lshl_or_b32 v36, v120, 30, v36
    v_mul_f32 v117, 0x03800000, v117
    v_mul_f32 v118, 0x03800000, v118
    v_cvt_pk_bf16_f32 v117, v117, v118
    v_mul_hi_u32_u24 v122, s38, v73
    v_mul_hi_u32_u24 v121, s37, v37
    v_mul_hi_u32_u24 v120, s36, v37
    v_mad_i32_i24 v110, v122, s44, v73
    v_mad_u32_u24 v73, v122, 40, v121
    v_mad_i32_i24 v37, v120, s39, v37
    v_lshlrev_b16 v73, 2, v73
    v_mad_i32_i24 v120, v121, -3, v120
    ds_add_u32 v73, v3 offset:0
    v_lshl_or_b32 v37, v110, 16, v37
    v_lshl_or_b32 v37, v120, 30, v37
    v_lshrrev_b32 v118, 3, v117
    v_lshrrev_b32 v119, 8, v117
    v_lshlrev_b16 v117, 13, v117
    v_bitop3_b32 v119, v118, v119, v124 bitop3:0x1b
    v_bitop3_b32 v36, v117, v125, v36 bitop3:0xae
    v_lshl_or_b32 v72, v119, 16, v72
    v_bitop3_b32 v37, v118, v125, v37 bitop3:0xae
    v_bitop3_b32 v73, v119, v126, v73 bitop3:0xea
    v_lshlrev_b32 v117, 16, v93
    v_and_b32 v118, v126, v93
    v_mul_f32 v117, v123, v117
    v_mul_f32 v118, v123, v118
    v_cvt_pk_bf16_f32 v117, v117, v118
    v_and_b32 v118, v126, v117
    v_lshlrev_b32 v117, 16, v117
    v_mul_f32 v117, 0.15915494, v117
    v_mul_f32 v118, 0.15915494, v118
    v_fract_f32 v117, v117
    v_fract_f32 v118, v118
    v_cos_f32 v117, v117
    v_cos_f32 v118, v118
    v_mul_hi_u32_u24 v122, s38, v74
    v_mul_hi_u32_u24 v121, s37, v38
    v_mul_hi_u32_u24 v120, s36, v38
    v_mad_i32_i24 v110, v122, s44, v74
    v_mad_u32_u24 v74, v122, 40, v121
    v_mad_i32_i24 v38, v120, s39, v38
    v_lshlrev_b16 v74, 2, v74
    v_mad_i32_i24 v120, v121, -3, v120
    ds_add_u32 v74, v3 offset:0
    v_lshl_or_b32 v38, v110, 16, v38
    v_lshl_or_b32 v38, v120, 30, v38
    v_mul_f32 v117, 0x03800000, v117
    v_mul_f32 v118, 0x03800000, v118
    v_cvt_pk_bf16_f32 v117, v117, v118
    v_mul_hi_u32_u24 v122, s38, v75
    v_mul_hi_u32_u24 v121, s37, v39
    v_mul_hi_u32_u24 v120, s36, v39
    v_mad_i32_i24 v110, v122, s44, v75
    v_mad_u32_u24 v75, v122, 40, v121
    v_mad_i32_i24 v39, v120, s39, v39
    v_lshlrev_b16 v75, 2, v75
    v_mad_i32_i24 v120, v121, -3, v120
    ds_add_u32 v75, v3 offset:0
    v_lshl_or_b32 v39, v110, 16, v39
    v_lshl_or_b32 v39, v120, 30, v39
    v_lshrrev_b32 v118, 3, v117
    v_lshrrev_b32 v119, 8, v117
    v_lshlrev_b16 v117, 13, v117
    v_bitop3_b32 v119, v118, v119, v124 bitop3:0x1b
    v_bitop3_b32 v38, v117, v125, v38 bitop3:0xae
    v_lshl_or_b32 v74, v119, 16, v74
    v_bitop3_b32 v39, v118, v125, v39 bitop3:0xae
    v_bitop3_b32 v75, v119, v126, v75 bitop3:0xea
p1_k16:
    s_waitcnt vmcnt(0)
    s_cmp_lg_u32 s28, 15
    s_cbranch_scc1 p1_tk1
    v_mov_b32 v126, 0
    s_mov_b64 exec, 1
    ds_write_b32 v126, v127 offset:10456
    s_mov_b64 exec, -1
p1_tk1:
    s_waitcnt lgkmcnt(0)
    s_barrier
    s_cmp_ge_u32 s28, 10
    s_cbranch_scc1 p1_s1_skip
    v_and_b32 v126, 63, v0
    s_lshl_b32 s54, s28, 4
    v_mul_u32_u24 v117, 160, v126
    v_add_u32 v117, s54, v117
    ds_read_b128 v[118:121], v117 offset:0
    s_waitcnt lgkmcnt(0)
    v_add_u32 v118, 2, v118
    v_add_u32 v119, 2, v119
    v_add_u32 v120, 2, v120
    v_add_u32 v121, 2, v121
    v_mul_u32_u24 v118, 43691, v118
    v_mul_u32_u24 v119, 43691, v119
    v_mul_u32_u24 v120, 43691, v120
    v_mul_u32_u24 v121, 43691, v121
    v_lshrrev_b32 v118, 17, v118
    v_lshrrev_b32 v119, 17, v119
    v_lshrrev_b32 v120, 17, v120
    v_lshrrev_b32 v121, 17, v121
    v_lshl_or_b32 v122, v119, 16, v118
    v_lshl_or_b32 v123, v121, 16, v120
    v_mov_b32 v124, v122
    v_mov_b32 v125, v123
    s_nop 1
    v_add_u32_dpp v124, v124, v124 row_shr:1 row_mask:0xf bank_mask:0xf bound_ctrl:0
    v_add_u32_dpp v125, v125, v125 row_shr:1 row_mask:0xf bank_mask:0xf bound_ctrl:0
    s_nop 0
    v_add_u32_dpp v124, v124, v124 row_shr:2 row_mask:0xf bank_mask:0xf bound_ctrl:0
    v_add_u32_dpp v125, v125, v125 row_shr:2 row_mask:0xf bank_mask:0xf bound_ctrl:0
    s_nop 0
    v_add_u32_dpp v124, v124, v124 row_shr:4 row_mask:0xf bank_mask:0xf bound_ctrl:0
    v_add_u32_dpp v125, v125, v125 row_shr:4 row_mask:0xf bank_mask:0xf bound_ctrl:0
    s_nop 0
    v_add_u32_dpp v124, v124, v124 row_shr:8 row_mask:0xf bank_mask:0xf bound_ctrl:0
    v_add_u32_dpp v125, v125, v125 row_shr:8 row_mask:0xf bank_mask:0xf bound_ctrl:0
    s_nop 0
    v_add_u32_dpp v124, v124, v124 row_bcast:15 row_mask:0xa bank_mask:0xf
    v_add_u32_dpp v125, v125, v125 row_bcast:15 row_mask:0xa bank_mask:0xf
    s_nop 0
    v_add_u32_dpp v124, v124, v124 row_bcast:31 row_mask:0xc bank_mask:0xf
    v_add_u32_dpp v125, v125, v125 row_bcast:31 row_mask:0xc bank_mask:0xf
    s_nop 0
    s_nop 0
    v_mov_b32 v127, s54
    v_and_b32 v118, 0xffff, v124
    v_lshrrev_b32 v119, 16, v124
    v_and_b32 v120, 0xffff, v125
    v_lshrrev_b32 v121, 16, v125
    s_mov_b64 exec, 1
    s_lshl_b64 exec, exec, 63
    ds_write_b128 v127, v[118:121] offset:10240
    s_mov_b64 exec, -1
p1_s1_skip:
    s_waitcnt lgkmcnt(0)
    s_barrier
    v_and_b32 v127, 63, v0
    v_lshlrev_b32 v118, 2, v127
    v_cmp_gt_u32 vcc, 40, v127
    ds_read_b32 v119, v118 offset:10240
    s_waitcnt lgkmcnt(0)
    v_readlane_b32 s33, v119, 54
    v_cndmask_b32 v119, 0, v119, vcc
    v_mov_b32 v120, v119
    s_nop 1
    v_add_u32_dpp v120, v120, v120 row_shr:1 row_mask:0xf bank_mask:0xf bound_ctrl:0
    s_nop 1
    v_add_u32_dpp v120, v120, v120 row_shr:2 row_mask:0xf bank_mask:0xf bound_ctrl:0
    s_nop 1
    v_add_u32_dpp v120, v120, v120 row_shr:4 row_mask:0xf bank_mask:0xf bound_ctrl:0
    s_nop 1
    v_add_u32_dpp v120, v120, v120 row_shr:8 row_mask:0xf bank_mask:0xf bound_ctrl:0
    s_nop 1
    v_add_u32_dpp v120, v120, v120 row_bcast:15 row_mask:0xa bank_mask:0xf
    s_nop 1
    v_add_u32_dpp v120, v120, v120 row_bcast:31 row_mask:0xc bank_mask:0xf
    s_nop 1
    s_nop 0
    v_sub_u32 v119, v120, v119
    v_readlane_b32 s35, v120, 63
    s_add_u32 s33, s33, 256
    s_mul_i32 s46, s33, 1
    s_min_u32 s47, s33, 1499
    s_add_u32 s46, s46, s47
    s_min_u32 s47, s33, 1462
    s_add_u32 s46, s46, s47
    s_min_u32 s47, s33, 1426
    s_add_u32 s46, s46, s47
    s_min_u32 s47, s33, 1389
    s_add_u32 s46, s46, s47
    s_min_u32 s47, s33, 1352
    s_add_u32 s46, s46, s47
    s_min_u32 s47, s33, 1315
    s_add_u32 s46, s46, s47
    s_min_u32 s47, s33, 1279
    s_add_u32 s46, s46, s47
    s_min_u32 s47, s33, 1242
    s_add_u32 s46, s46, s47
    s_lshl_b32 s30, s46, 14
    s_lshl_b32 s31, s46, 13
    s_cmp_ge_u32 s28, 10
    s_cbranch_scc1 p1_s2_skip
    s_lshl_b32 s54, s28, 2
    s_add_u32 s55, s54, 0
    v_readlane_b32 s56, v119, s55
    s_add_u32 s55, s54, 1
    v_readlane_b32 s57, v119, s55
    s_add_u32 s55, s54, 2
    v_readlane_b32 s58, v119, s55
    s_add_u32 s55, s54, 3
    v_readlane_b32 s59, v119, s55
    s_nop 0
    s_lshl_b32 s57, s57, 16
    s_or_b32 s56, s56, s57
    s_lshl_b32 s59, s59, 16
    s_or_b32 s58, s58, s59
    v_add_u32 v124, s56, v124
    v_add_u32 v125, s58, v125
    v_sub_u32 v122, v124, v122
    v_sub_u32 v123, v125, v123
    v_and_b32 v118, 0xffff, v122
    v_lshrrev_b32 v119, 16, v122
    v_and_b32 v120, 0xffff, v123
    v_lshrrev_b32 v121, 16, v123
    v_mul_u32_u24 v118, 3, v118
    v_mul_u32_u24 v119, 3, v119
    v_mul_u32_u24 v120, 3, v120
    v_mul_u32_u24 v121, 3, v121
    ds_write_b128 v117, v[118:121] offset:0
    s_mul_i32 s55, s29, 5248
    s_mul_i32 s56, s28, 520
    s_add_u32 s55, s55, s56
    s_add_u32 s55, s55, 469762048
    v_lshlrev_b32 v127, 3, v126
    buffer_store_dwordx2 v[122:123], v127, s[16:19], s55 offen sc1
    s_mov_b64 exec, 1
    s_lshl_b64 exec, exec, 63
    buffer_store_dwordx2 v[124:125], v127, s[16:19], s55 offen offset:8 sc1
    s_mov_b64 exec, -1
p1_s2_skip:
    s_mul_i32 s50, s29, 16384
    s_lshr_b32 s52, s35, 10
    s_mul_i32 s52, s52, 33554432
    s_and_b32 s53, s35, 1023
    s_lshl_b32 s53, s53, 4
    s_add_u32 s52, s52, s53
    s_add_u32 s52, s52, s50
    s_min_u32 s22, s52, 469762048
    s_mov_b32 s68, 0
    s_cmp_lt_u32 s29, 1242
    s_cselect_b32 s35, 13994, s35
    s_waitcnt lgkmcnt(0)
    s_barrier
    s_cmp_lt_u32 s33, 1536
    s_cbranch_scc1 p1_f0
    s_cmp_lg_u32 s28, 15
    s_cbranch_scc1 p1_hv0
    s_sub_u32 s52, s33, 1536
    s_and_b32 s52, s52, 255
    s_lshl_b32 s58, s52, 2
    s_and_b32 s58, s58, 28
    s_lshl_b32 s53, 1, s58
    v_mov_b32 v127, s53
    s_lshr_b32 s52, s52, 3
    s_lshl_b32 s52, s52, 2
    s_mov_b64 exec, 1
    buffer_atomic_add v127, off, s[40:43], s52 sc0 sc1
    s_mov_b64 exec, -1
p1_hv0:
    s_cmp_ge_u32 s33, 1656
    s_cbranch_scc1 p1_f0
    s_sub_u32 s52, s33, 1536
    s_mul_i32 s52, s52, 53368
    s_mul_i32 s53, s28, 3072
    s_add_u32 s53, s53, s52
    v_and_b32 v92, 63, v0
    v_lshl_add_u32 v93, v92, 2, s53
    s_lshl_b32 s53, s28, 9
    s_add_u32 s53, s53, s52
    s_add_u32 s53, s53, 49152
    s_cmp_lt_u32 s28, 9
    s_cselect_b32 s53, s53, 0x40000000
    v_lshl_add_u32 v94, v92, 2, s53
    buffer_load_dword v76, v93, s[24:27], 0 offen offset:0
    buffer_load_dword v77, v93, s[24:27], 0 offen offset:256
    buffer_load_dword v78, v93, s[24:27], 0 offen offset:512
    buffer_load_dword v79, v93, s[24:27], 0 offen offset:768
    buffer_load_dword v80, v93, s[24:27], 0 offen offset:1024
    buffer_load_dword v81, v93, s[24:27], 0 offen offset:1280
    buffer_load_dword v82, v93, s[24:27], 0 offen offset:1536
    buffer_load_dword v83, v93, s[24:27], 0 offen offset:1792
    buffer_load_dword v84, v93, s[24:27], 0 offen offset:2048
    buffer_load_dword v85, v93, s[24:27], 0 offen offset:2304
    buffer_load_dword v86, v93, s[24:27], 0 offen offset:2560
    buffer_load_dword v87, v93, s[24:27], 0 offen offset:2816
    buffer_load_dword v88, v94, s[24:27], 0 offen offset:0
    buffer_load_dword v89, v94, s[24:27], 0 offen offset:256
p1_f0:
    v_and_b32 v117, 0xffff, v40
    ds_add_rtn_u32 v117, v117, v3 offset:0
    v_and_b32 v118, 0xffff, v41
    ds_add_rtn_u32 v118, v118, v3 offset:0
    v_and_b32 v119, 0xffff, v42
    ds_add_rtn_u32 v119, v119, v3 offset:0
    v_and_b32 v120, 0xffff, v43
    ds_add_rtn_u32 v120, v120, v3 offset:0
    s_cmp_ge_u32 s33, 1536
    s_cbranch_scc1 p1_k18
    s_cmp_lt_u32 s33, 1536
    s_cselect_b32 s14, 102400000, 0
    s_add_u32 s32, s31, 0
    buffer_load_dwordx2 v[76:77], v2, s[12:15], s32 offen nt
p1_k18:
    s_cmp_ge_u32 s33, 1536
    s_cbranch_scc1 p1_k19
    s_cmp_lt_u32 s33, 1536
    s_cselect_b32 s6, 204800000, 0
    s_cselect_b32 s10, 204800000, 0
    s_add_u32 s32, s30, 0
    buffer_load_dwordx4 v[94:97], v1, s[4:7], s32 offen nt
    buffer_load_dwordx4 v[102:105], v1, s[8:11], s32 offen nt
p1_k19:
    s_cmp_lt_u32 s29, 1499
    s_cbranch_scc1 p1_pa0
    s_waitcnt lgkmcnt(0)
    s_branch p1_pb0
p1_pa0:
    v_and_b32 v121, 0xffff, v44
    ds_add_rtn_u32 v121, v121, v3 offset:0
    v_and_b32 v122, 0xffff, v45
    ds_add_rtn_u32 v122, v122, v3 offset:0
    v_and_b32 v123, 0xffff, v46
    ds_add_rtn_u32 v123, v123, v3 offset:0
    v_and_b32 v124, 0xffff, v47
    ds_add_rtn_u32 v124, v124, v3 offset:0
    s_waitcnt lgkmcnt(4)
p1_pb0:
    ds_write_b8_d16_hi v117, v40 offset:10496
    v_lshlrev_b32 v40, 2, v117
    ds_write_b32 v40, v4 offset:52480
    ds_write_b8_d16_hi v118, v41 offset:10496
    v_lshlrev_b32 v41, 2, v118
    ds_write_b32 v41, v5 offset:52480
    ds_write_b8_d16_hi v119, v42 offset:10496
    v_lshlrev_b32 v42, 2, v119
    ds_write_b32 v42, v6 offset:52480
    ds_write_b8_d16_hi v120, v43 offset:10496
    v_lshlrev_b32 v43, 2, v120
    ds_write_b32 v43, v7 offset:52480
    s_cmp_ge_u32 s33, 1536
    s_cbranch_scc1 p1_k20
    s_cmp_lt_u32 s33, 1499
    s_cselect_b32 s14, 102400000, 0
    s_add_u32 s32, s31, 8192
    buffer_load_dwordx2 v[78:79], v2, s[12:15], s32 offen nt
p1_k20:
    s_cmp_lt_u32 s29, 1462
    s_cbranch_scc1 p1_pa1
    s_waitcnt lgkmcnt(0)
    s_branch p1_pb1
p1_pa1:
    v_and_b32 v117, 0xffff, v48
    ds_add_rtn_u32 v117, v117, v3 offset:0
    v_and_b32 v118, 0xffff, v49
    ds_add_rtn_u32 v118, v118, v3 offset:0
    v_and_b32 v119, 0xffff, v50
    ds_add_rtn_u32 v119, v119, v3 offset:0
    v_and_b32 v120, 0xffff, v51
    ds_add_rtn_u32 v120, v120, v3 offset:0
    s_waitcnt lgkmcnt(4)
p1_pb1:
    s_cmp_ge_u32 s29, 1499
    s_cbranch_scc1 p1_k21
    ds_write_b8_d16_hi v121, v44 offset:10496
    v_lshlrev_b32 v44, 2, v121
    ds_write_b32 v44, v8 offset:52480
    ds_write_b8_d16_hi v122, v45 offset:10496
    v_lshlrev_b32 v45, 2, v122
    ds_write_b32 v45, v9 offset:52480
    ds_write_b8_d16_hi v123, v46 offset:10496
    v_lshlrev_b32 v46, 2, v123
    ds_write_b32 v46, v10 offset:52480
    ds_write_b8_d16_hi v124, v47 offset:10496
    v_lshlrev_b32 v47, 2, v124
    ds_write_b32 v47, v11 offset:52480
p1_k21:
    s_cmp_ge_u32 s33, 1536
    s_cbranch_scc1 p1_k22
    s_cmp_lt_u32 s33, 1462
    s_cselect_b32 s14, 102400000, 0
    s_add_u32 s32, s31, 16384
    buffer_load_dwordx2 v[80:81], v2, s[12:15], s32 offen nt
p1_k22:
    s_cmp_lt_u32 s29, 1426
    s_cbranch_scc1 p1_pa2
    s_waitcnt lgkmcnt(0)
    s_branch p1_pb2
p1_pa2:
    v_and_b32 v121, 0xffff, v52
    ds_add_rtn_u32 v121, v121, v3 offset:0
    v_and_b32 v122, 0xffff, v53
    ds_add_rtn_u32 v122, v122, v3 offset:0
    v_and_b32 v123, 0xffff, v54
    ds_add_rtn_u32 v123, v123, v3 offset:0
    v_and_b32 v124, 0xffff, v55
    ds_add_rtn_u32 v124, v124, v3 offset:0
    s_waitcnt lgkmcnt(4)
p1_pb2:
    s_cmp_ge_u32 s29, 1462
    s_cbranch_scc1 p1_k23
    ds_write_b8_d16_hi v117, v48 offset:10496
    v_lshlrev_b32 v48, 2, v117
    ds_write_b32 v48, v12 offset:52480
    ds_write_b8_d16_hi v118, v49 offset:10496
    v_lshlrev_b32 v49, 2, v118
    ds_write_b32 v49, v13 offset:52480
    ds_write_b8_d16_hi v119, v50 offset:10496
    v_lshlrev_b32 v50, 2, v119
    ds_write_b32 v50, v14 offset:52480
    ds_write_b8_d16_hi v120, v51 offset:10496
    v_lshlrev_b32 v51, 2, v120
    ds_write_b32 v51, v15 offset:52480
p1_k23:
    s_cmp_ge_u32 s28, 10
    s_cbranch_scc1 p1_jn
    s_waitcnt vmcnt(0)
    v_mov_b32 v125, 0
    s_mov_b64 exec, 1
    ds_add_rtn_u32 v125, v125, v3 offset:10432
    s_waitcnt lgkmcnt(0)
    v_readfirstlane_b32 s52, v125
    s_lshr_b32 s53, s29, 1
    s_and_b32 s53, s53, 28
    s_cmp_lg_u32 s52, 9
    s_cbranch_scc1 p1_jn1
    s_lshl_b32 s54, 1, s53
    v_mov_b32 v127, s54
    s_lshr_b32 s54, s29, 6
    s_lshl_b32 s54, s54, 2
    s_mov_b32 s68, 1
    buffer_atomic_add v127, off, s[40:43], s54 sc0 sc1
p1_jn1:
    s_mov_b64 exec, -1
p1_jn:
    s_cmp_ge_u32 s33, 1536
    s_cbranch_scc1 p1_k24
    s_cmp_lt_u32 s33, 1426
    s_cselect_b32 s14, 102400000, 0
    s_add_u32 s32, s31, 24576
    buffer_load_dwordx2 v[82:83], v2, s[12:15], s32 offen nt
p1_k24:
    s_cmp_lt_u32 s29, 1389
    s_cbranch_scc1 p1_pa3
    s_waitcnt lgkmcnt(0)
    s_branch p1_pb3
p1_pa3:
    v_and_b32 v117, 0xffff, v56
    ds_add_rtn_u32 v117, v117, v3 offset:0
    v_and_b32 v118, 0xffff, v57
    ds_add_rtn_u32 v118, v118, v3 offset:0
    v_and_b32 v119, 0xffff, v58
    ds_add_rtn_u32 v119, v119, v3 offset:0
    v_and_b32 v120, 0xffff, v59
    ds_add_rtn_u32 v120, v120, v3 offset:0
    s_waitcnt lgkmcnt(4)
p1_pb3:
    s_cmp_ge_u32 s29, 1426
    s_cbranch_scc1 p1_k25
    ds_write_b8_d16_hi v121, v52 offset:10496
    v_lshlrev_b32 v52, 2, v121
    ds_write_b32 v52, v16 offset:52480
    ds_write_b8_d16_hi v122, v53 offset:10496
    v_lshlrev_b32 v53, 2, v122
    ds_write_b32 v53, v17 offset:52480
    ds_write_b8_d16_hi v123, v54 offset:10496
    v_lshlrev_b32 v54, 2, v123
    ds_write_b32 v54, v18 offset:52480
    ds_write_b8_d16_hi v124, v55 offset:10496
    v_lshlrev_b32 v55, 2, v124
    ds_write_b32 v55, v19 offset:52480
p1_k25:
    s_cmp_ge_u32 s33, 1536
    s_cbranch_scc1 p1_k26
    s_cmp_lt_u32 s33, 1389
    s_cselect_b32 s14, 102400000, 0
    s_add_u32 s32, s31, 32768
    buffer_load_dwordx2 v[84:85], v2, s[12:15], s32 offen nt
p1_k26:
    s_cmp_ge_u32 s33, 1536
    s_cbranch_scc1 p1_k27
    s_cmp_lt_u32 s33, 1499
    s_cselect_b32 s6, 204800000, 0
    s_cselect_b32 s10, 204800000, 0
    s_add_u32 s32, s30, 16384
    buffer_load_dwordx4 v[98:101], v1, s[4:7], s32 offen nt
    buffer_load_dwordx4 v[106:109], v1, s[8:11], s32 offen nt
p1_k27:
    s_cmp_lt_u32 s29, 1352
    s_cbranch_scc1 p1_pa4
    s_waitcnt lgkmcnt(0)
    s_branch p1_pb4
p1_pa4:
    v_and_b32 v121, 0xffff, v60
    ds_add_rtn_u32 v121, v121, v3 offset:0
    v_and_b32 v122, 0xffff, v61
    ds_add_rtn_u32 v122, v122, v3 offset:0
    v_and_b32 v123, 0xffff, v62
    ds_add_rtn_u32 v123, v123, v3 offset:0
    v_and_b32 v124, 0xffff, v63
    ds_add_rtn_u32 v124, v124, v3 offset:0
    s_waitcnt lgkmcnt(4)
p1_pb4:
    s_cmp_ge_u32 s29, 1389
    s_cbranch_scc1 p1_k28
    ds_write_b8_d16_hi v117, v56 offset:10496
    v_lshlrev_b32 v56, 2, v117
    ds_write_b32 v56, v20 offset:52480
    ds_write_b8_d16_hi v118, v57 offset:10496
    v_lshlrev_b32 v57, 2, v118
    ds_write_b32 v57, v21 offset:52480
    ds_write_b8_d16_hi v119, v58 offset:10496
    v_lshlrev_b32 v58, 2, v119
    ds_write_b32 v58, v22 offset:52480
    ds_write_b8_d16_hi v120, v59 offset:10496
    v_lshlrev_b32 v59, 2, v120
    ds_write_b32 v59, v23 offset:52480
p1_k28:
    s_cmp_ge_u32 s33, 1536
    s_cbranch_scc1 p1_k29
    s_cmp_lt_u32 s33, 1352
    s_cselect_b32 s14, 102400000, 0
    s_add_u32 s32, s31, 40960
    buffer_load_dwordx2 v[86:87], v2, s[12:15], s32 offen nt
p1_k29:
    s_cmp_lt_u32 s29, 1315
    s_cbranch_scc1 p1_pa5
    s_waitcnt lgkmcnt(0)
    s_branch p1_pb5
p1_pa5:
    v_and_b32 v117, 0xffff, v64
    ds_add_rtn_u32 v117, v117, v3 offset:0
    v_and_b32 v118, 0xffff, v65
    ds_add_rtn_u32 v118, v118, v3 offset:0
    v_and_b32 v119, 0xffff, v66
    ds_add_rtn_u32 v119, v119, v3 offset:0
    v_and_b32 v120, 0xffff, v67
    ds_add_rtn_u32 v120, v120, v3 offset:0
    s_waitcnt lgkmcnt(4)
p1_pb5:
    s_cmp_ge_u32 s29, 1352
    s_cbranch_scc1 p1_k30
    ds_write_b8_d16_hi v121, v60 offset:10496
    v_lshlrev_b32 v60, 2, v121
    ds_write_b32 v60, v24 offset:52480
    ds_write_b8_d16_hi v122, v61 offset:10496
    v_lshlrev_b32 v61, 2, v122
    ds_write_b32 v61, v25 offset:52480
    ds_write_b8_d16_hi v123, v62 offset:10496
    v_lshlrev_b32 v62, 2, v123
    ds_write_b32 v62, v26 offset:52480
    ds_write_b8_d16_hi v124, v63 offset:10496
    v_lshlrev_b32 v63, 2, v124
    ds_write_b32 v63, v27 offset:52480
p1_k30:
    s_cmp_ge_u32 s33, 1536
    s_cbranch_scc1 p1_k31
    s_cmp_lt_u32 s33, 1315
    s_cselect_b32 s14, 102400000, 0
    s_add_u32 s32, s31, 49152
    buffer_load_dwordx2 v[88:89], v2, s[12:15], s32 offen nt
p1_k31:
    s_cmp_lt_u32 s29, 1279
    s_cbranch_scc1 p1_pa6
    s_waitcnt lgkmcnt(0)
    s_branch p1_pb6
p1_pa6:
    v_and_b32 v121, 0xffff, v68
    ds_add_rtn_u32 v121, v121, v3 offset:0
    v_and_b32 v122, 0xffff, v69
    ds_add_rtn_u32 v122, v122, v3 offset:0
    v_and_b32 v123, 0xffff, v70
    ds_add_rtn_u32 v123, v123, v3 offset:0
    v_and_b32 v124, 0xffff, v71
    ds_add_rtn_u32 v124, v124, v3 offset:0
    s_waitcnt lgkmcnt(4)
p1_pb6:
    s_cmp_ge_u32 s29, 1315
    s_cbranch_scc1 p1_k32
    ds_write_b8_d16_hi v117, v64 offset:10496
    v_lshlrev_b32 v64, 2, v117
    ds_write_b32 v64, v28 offset:52480
    ds_write_b8_d16_hi v118, v65 offset:10496
    v_lshlrev_b32 v65, 2, v118
    ds_write_b32 v65, v29 offset:52480
    ds_write_b8_d16_hi v119, v66 offset:10496
    v_lshlrev_b32 v66, 2, v119
    ds_write_b32 v66, v30 offset:52480
    ds_write_b8_d16_hi v120, v67 offset:10496
    v_lshlrev_b32 v67, 2, v120
    ds_write_b32 v67, v31 offset:52480
p1_k32:
    s_cmp_ge_u32 s33, 1536
    s_cbranch_scc1 p1_k33
    s_cmp_lt_u32 s33, 1279
    s_cselect_b32 s14, 102400000, 0
    s_add_u32 s32, s31, 57344
    buffer_load_dwordx2 v[90:91], v2, s[12:15], s32 offen nt
p1_k33:
    s_cmp_lt_u32 s29, 1242
    s_cbranch_scc1 p1_pa7
    s_waitcnt lgkmcnt(0)
    s_branch p1_pb7
p1_pa7:
    v_and_b32 v117, 0xffff, v72
    ds_add_rtn_u32 v117, v117, v3 offset:0
    v_and_b32 v118, 0xffff, v73
    ds_add_rtn_u32 v118, v118, v3 offset:0
    v_and_b32 v119, 0xffff, v74
    ds_add_rtn_u32 v119, v119, v3 offset:0
    v_and_b32 v120, 0xffff, v75
    ds_add_rtn_u32 v120, v120, v3 offset:0
    s_waitcnt lgkmcnt(4)
p1_pb7:
    s_cmp_ge_u32 s29, 1279
    s_cbranch_scc1 p1_k34
    ds_write_b8_d16_hi v121, v68 offset:10496
    v_lshlrev_b32 v68, 2, v121
    ds_write_b32 v68, v32 offset:52480
    ds_write_b8_d16_hi v122, v69 offset:10496
    v_lshlrev_b32 v69, 2, v122
    ds_write_b32 v69, v33 offset:52480
    ds_write_b8_d16_hi v123, v70 offset:10496
    v_lshlrev_b32 v70, 2, v123
    ds_write_b32 v70, v34 offset:52480
    ds_write_b8_d16_hi v124, v71 offset:10496
    v_lshlrev_b32 v71, 2, v124
    ds_write_b32 v71, v35 offset:52480
p1_k34:
    s_cmp_ge_u32 s33, 1536
    s_cbranch_scc1 p1_k35
    s_cmp_lt_u32 s33, 1242
    s_cselect_b32 s14, 102400000, 0
    s_add_u32 s32, s31, 65536
    buffer_load_dwordx2 v[92:93], v2, s[12:15], s32 offen nt
p1_k35:
    s_waitcnt lgkmcnt(0)
    s_cmp_ge_u32 s29, 1242
    s_cbranch_scc1 p1_k36
    ds_write_b8_d16_hi v117, v72 offset:10496
    v_lshlrev_b32 v72, 2, v117
    ds_write_b32 v72, v36 offset:52480
    ds_write_b8_d16_hi v118, v73 offset:10496
    v_lshlrev_b32 v73, 2, v118
    ds_write_b32 v73, v37 offset:52480
    ds_write_b8_d16_hi v119, v74 offset:10496
    v_lshlrev_b32 v74, 2, v119
    ds_write_b32 v74, v38 offset:52480
    ds_write_b8_d16_hi v120, v75 offset:10496
    v_lshlrev_b32 v75, 2, v120
    ds_write_b32 v75, v39 offset:52480
p1_k36:
    s_cmp_eq_u32 s68, 0
    s_cbranch_scc1 p1_sg
    s_cmp_lt_u32 s33, 1536
    s_cbranch_scc1 p1_w37
    s_waitcnt vmcnt(0)
p1_w37:
    s_waitcnt vmcnt(8)
    v_bfe_u32 v127, v127, s53, 4
    v_mov_b32 v125, 0
    s_mov_b64 exec, 1
    ds_write_b32 v125, v127 offset:10452
    s_mov_b64 exec, -1
p1_sg:
    s_cmp_lt_u32 s33, 1536
    s_cbranch_scc1 p1_f1
    s_cmp_lg_u32 s28, 15
    s_cbranch_scc1 p1_hv1
    s_waitcnt vmcnt(0)
    v_bfe_u32 v127, v127, s58, 4
    v_mov_b32 v125, 0
    s_mov_b64 exec, 1
    ds_write_b32 v125, v127 offset:10448
    s_mov_b64 exec, -1
p1_hv1:
    s_cmp_ge_u32 s33, 1656
    s_cbranch_scc1 p1_f1
    s_sub_u32 s52, s33, 1536
    s_mul_i32 s53, s52, 53760
    s_add_u32 s53, s53, 485810176
    s_mul_i32 s54, s28, 3072
    v_lshl_add_u32 v93, v92, 4, s54
    s_lshl_b32 s54, s28, 9
    s_add_u32 s54, s54, 49152
    s_cmp_lt_u32 s28, 9
    s_cselect_b32 s54, s54, 0x40000000
    v_lshl_add_u32 v94, v92, 3, s54
    v_mov_b32 v96, 0
    v_mov_b32 v97, 0
    s_waitcnt vmcnt(0)
    buffer_store_dwordx4 v[76:79], v93, s[16:19], s53 offen offset:0
    buffer_store_dwordx4 v[80:83], v93, s[16:19], s53 offen offset:1024
    buffer_store_dwordx4 v[84:87], v93, s[16:19], s53 offen offset:2048
    buffer_store_dwordx2 v[88:89], v94, s[16:19], s53 offen
    v_and_b32 v98, 0x7fff7fff, v76
    v_pk_max_u16 v96, v96, v98
    v_lshlrev_b32 v99, 16, v98
    v_and_b32 v98, 0xffff0000, v98
    v_fmac_f32 v97, v99, v99
    v_fmac_f32 v97, v98, v98
    v_and_b32 v98, 0x7fff7fff, v77
    v_pk_max_u16 v96, v96, v98
    v_lshlrev_b32 v99, 16, v98
    v_and_b32 v98, 0xffff0000, v98
    v_fmac_f32 v97, v99, v99
    v_fmac_f32 v97, v98, v98
    v_and_b32 v98, 0x7fff7fff, v78
    v_pk_max_u16 v96, v96, v98
    v_lshlrev_b32 v99, 16, v98
    v_and_b32 v98, 0xffff0000, v98
    v_fmac_f32 v97, v99, v99
    v_fmac_f32 v97, v98, v98
    v_and_b32 v98, 0x7fff7fff, v79
    v_pk_max_u16 v96, v96, v98
    v_lshlrev_b32 v99, 16, v98
    v_and_b32 v98, 0xffff0000, v98
    v_fmac_f32 v97, v99, v99
    v_fmac_f32 v97, v98, v98
    v_and_b32 v98, 0x7fff7fff, v80
    v_pk_max_u16 v96, v96, v98
    v_lshlrev_b32 v99, 16, v98
    v_and_b32 v98, 0xffff0000, v98
    v_fmac_f32 v97, v99, v99
    v_fmac_f32 v97, v98, v98
    v_and_b32 v98, 0x7fff7fff, v81
    v_pk_max_u16 v96, v96, v98
    v_lshlrev_b32 v99, 16, v98
    v_and_b32 v98, 0xffff0000, v98
    v_fmac_f32 v97, v99, v99
    v_fmac_f32 v97, v98, v98
    v_and_b32 v98, 0x7fff7fff, v82
    v_pk_max_u16 v96, v96, v98
    v_lshlrev_b32 v99, 16, v98
    v_and_b32 v98, 0xffff0000, v98
    v_fmac_f32 v97, v99, v99
    v_fmac_f32 v97, v98, v98
    v_and_b32 v98, 0x7fff7fff, v83
    v_pk_max_u16 v96, v96, v98
    v_lshlrev_b32 v99, 16, v98
    v_and_b32 v98, 0xffff0000, v98
    v_fmac_f32 v97, v99, v99
    v_fmac_f32 v97, v98, v98
    v_and_b32 v98, 0x7fff7fff, v84
    v_pk_max_u16 v96, v96, v98
    v_lshlrev_b32 v99, 16, v98
    v_and_b32 v98, 0xffff0000, v98
    v_fmac_f32 v97, v99, v99
    v_fmac_f32 v97, v98, v98
    v_and_b32 v98, 0x7fff7fff, v85
    v_pk_max_u16 v96, v96, v98
    v_lshlrev_b32 v99, 16, v98
    v_and_b32 v98, 0xffff0000, v98
    v_fmac_f32 v97, v99, v99
    v_fmac_f32 v97, v98, v98
    v_and_b32 v98, 0x7fff7fff, v86
    v_pk_max_u16 v96, v96, v98
    v_lshlrev_b32 v99, 16, v98
    v_and_b32 v98, 0xffff0000, v98
    v_fmac_f32 v97, v99, v99
    v_fmac_f32 v97, v98, v98
    v_and_b32 v98, 0x7fff7fff, v87
    v_pk_max_u16 v96, v96, v98
    v_lshlrev_b32 v99, 16, v98
    v_and_b32 v98, 0xffff0000, v98
    v_fmac_f32 v97, v99, v99
    v_fmac_f32 v97, v98, v98
    v_and_b32 v98, 0x7fff7fff, v88
    v_pk_max_u16 v96, v96, v98
    v_lshlrev_b32 v99, 16, v98
    v_and_b32 v98, 0xffff0000, v98
    v_fmac_f32 v97, v99, v99
    v_fmac_f32 v97, v98, v98
    v_and_b32 v98, 0x7fff7fff, v89
    v_pk_max_u16 v96, v96, v98
    v_lshlrev_b32 v99, 16, v98
    v_and_b32 v98, 0xffff0000, v98
    v_fmac_f32 v97, v99, v99
    v_fmac_f32 v97, v98, v98
    v_lshrrev_b32 v98, 16, v96
    v_and_b32 v96, 0xffff, v96
    v_max_u32 v96, v96, v98
    s_nop 1
    v_max_u32_dpp v96, v96, v96 row_shr:1 row_mask:0xf bank_mask:0xf bound_ctrl:0
    v_add_f32_dpp v97, v97, v97 row_shr:1 row_mask:0xf bank_mask:0xf bound_ctrl:0
    s_nop 0
    v_max_u32_dpp v96, v96, v96 row_shr:2 row_mask:0xf bank_mask:0xf bound_ctrl:0
    v_add_f32_dpp v97, v97, v97 row_shr:2 row_mask:0xf bank_mask:0xf bound_ctrl:0
    s_nop 0
    v_max_u32_dpp v96, v96, v96 row_shr:4 row_mask:0xf bank_mask:0xf bound_ctrl:0
    v_add_f32_dpp v97, v97, v97 row_shr:4 row_mask:0xf bank_mask:0xf bound_ctrl:0
    s_nop 0
    v_max_u32_dpp v96, v96, v96 row_shr:8 row_mask:0xf bank_mask:0xf bound_ctrl:0
    v_add_f32_dpp v97, v97, v97 row_shr:8 row_mask:0xf bank_mask:0xf bound_ctrl:0
    s_nop 0
    v_max_u32_dpp v96, v96, v96 row_bcast:15 row_mask:0xa bank_mask:0xf
    v_add_f32_dpp v97, v97, v97 row_bcast:15 row_mask:0xa bank_mask:0xf
    s_nop 0
    v_max_u32_dpp v96, v96, v96 row_bcast:31 row_mask:0xc bank_mask:0xf
    v_add_f32_dpp v97, v97, v97 row_bcast:31 row_mask:0xc bank_mask:0xf
    s_nop 0
    s_nop 0
    s_lshl_b32 s52, s52, 4
    s_add_u32 s52, s52, s28
    s_lshl_b32 s52, s52, 3
    s_add_u32 s52, s52, 492261376
    s_mov_b64 exec, 1
    s_lshl_b64 exec, exec, 63
    buffer_store_dwordx2 v[96:97], off, s[16:19], s52
    s_mov_b64 exec, -1
p1_f1:
    s_waitcnt lgkmcnt(0)
    s_barrier
    v_mul_u32_u24 v119, 3, v0
    v_and_b32 v118, -4, v119
    v_add_u32 v120, s50, v1
    v_mov_b32 v122, 0
    v_mov_b32 v123, 0
    v_mov_b32 v124, 0
    v_mov_b32 v125, 0
    ds_read_b64 v[126:127], v122 offset:10448
    ds_write_b32 v122, v122 offset:10432
    v_cmp_gt_u32 vcc, 640, v0
    s_and_saveexec_b64 s[52:53], vcc
    ds_write_b128 v1, v[122:125] offset:0
    s_mov_b64 exec, -1
    s_waitcnt lgkmcnt(2)
    v_readfirstlane_b32 s70, v126
    v_readfirstlane_b32 s69, v127
    s_cmp_ge_u32 s33, 1536
    s_cselect_b32 s70, s70, 0
    s_cmp_gt_u32 s28, 10
    s_cselect_b32 s69, 0, s69
    s_cselect_b32 s70, 0, s70
    s_cmp_lg_u32 s70, 8
    s_cbranch_scc1 p1_h0
    s_sub_u32 s52, s33, 1536
    v_and_b32 v102, 63, v0
    s_cmp_eq_u32 s28, 10
    s_cbranch_scc1 p1_tr10
    s_mul_i32 s53, s28, 520
    v_lshl_add_u32 v100, v102, 3, s53
    s_mul_i32 s53, s28, 4160
    v_lshl_add_u32 v101, v102, 4, s53
    s_branch p1_tr20
p1_tr10:
    v_mul_u32_u24 v100, 520, v102
    v_add_u32 v100, 512, v100
    v_mul_u32_u24 v101, 4160, v102
    v_add_u32 v101, 1024, v101
    v_cmp_gt_u32 vcc, 10, v102
    v_mov_b32 v102, 0x40000000
    s_nop 0
    v_cndmask_b32 v100, v102, v100, vcc
    v_cndmask_b32 v101, v102, v101, vcc
p1_tr20:
    s_mul_i32 s52, s52, 41984
    s_add_u32 s52, s52, 469762048
    buffer_load_dwordx2 v[76:77], v100, s[16:19], s52 offen sc1
    s_add_u32 s52, s52, 5248
    buffer_load_dwordx2 v[78:79], v100, s[16:19], s52 offen sc1
    s_add_u32 s52, s52, 5248
    buffer_load_dwordx2 v[80:81], v100, s[16:19], s52 offen sc1
    s_add_u32 s52, s52, 5248
    buffer_load_dwordx2 v[82:83], v100, s[16:19], s52 offen sc1
    s_add_u32 s52, s52, 5248
    buffer_load_dwordx2 v[84:85], v100, s[16:19], s52 offen sc1
    s_add_u32 s52, s52, 5248
    buffer_load_dwordx2 v[86:87], v100, s[16:19], s52 offen sc1
    s_add_u32 s52, s52, 5248
    buffer_load_dwordx2 v[88:89], v100, s[16:19], s52 offen sc1
    s_add_u32 s52, s52, 5248
    buffer_load_dwordx2 v[90:91], v100, s[16:19], s52 offen sc1
    s_add_u32 s52, s52, 5248
p1_h0:
    v_lshlrev_b32 v117, 2, v119
    v_add_u32 v117, 52480, v117
    ds_read_b32 v110, v117 offset:0
    ds_read_b32 v111, v117 offset:4
    ds_read_b32 v112, v117 offset:8
    ds_read_b32 v113, v118 offset:10496
    ds_read_b32 v114, v118 offset:10500
    ds_read_b32 v122, v117 offset:12288
    ds_read_b32 v123, v117 offset:12292
    ds_read_b32 v124, v117 offset:12296
    ds_read_b32 v125, v118 offset:13568
    ds_read_b32 v121, v118 offset:13572
    s_waitcnt lgkmcnt(5)
    v_alignbyte_b32 v113, v114, v113, v119
    buffer_store_dwordx4 v[110:113], v120, s[20:23], 0 offen
    v_add_u32 v120, 33554432, v120
    s_nop 0
    ds_read_b32 v110, v117 offset:24576
    ds_read_b32 v111, v117 offset:24580
    ds_read_b32 v112, v117 offset:24584
    ds_read_b32 v113, v118 offset:16640
    ds_read_b32 v114, v118 offset:16644
    s_cmp_le_u32 s35, 1024
    s_cbranch_scc1 p1_ce0
    s_waitcnt lgkmcnt(5)
    v_alignbyte_b32 v125, v121, v125, v119
    buffer_store_dwordx4 v[122:125], v120, s[20:23], 0 offen
    v_add_u32 v120, 33554432, v120
    s_nop 0
    ds_read_b32 v122, v117 offset:36864
    ds_read_b32 v123, v117 offset:36868
    ds_read_b32 v124, v117 offset:36872
    ds_read_b32 v125, v118 offset:19712
    ds_read_b32 v121, v118 offset:19716
    s_cmp_le_u32 s35, 2048
    s_cbranch_scc1 p1_ce0
    s_waitcnt lgkmcnt(5)
    v_alignbyte_b32 v113, v114, v113, v119
    buffer_store_dwordx4 v[110:113], v120, s[20:23], 0 offen
    v_add_u32 v120, 33554432, v120
    s_nop 0
    ds_read_b32 v110, v117 offset:49152
    ds_read_b32 v111, v117 offset:49156
    ds_read_b32 v112, v117 offset:49160
    ds_read_b32 v113, v118 offset:22784
    ds_read_b32 v114, v118 offset:22788
    s_cmp_le_u32 s35, 3072
    s_cbranch_scc1 p1_ce0
    s_waitcnt lgkmcnt(5)
    v_alignbyte_b32 v125, v121, v125, v119
    buffer_store_dwordx4 v[122:125], v120, s[20:23], 0 offen
    v_add_u32 v120, 33554432, v120
    s_nop 0
    v_lshlrev_b32 v117, 2, v119
    v_add_u32 v117, 113920, v117
    ds_read_b32 v122, v117 offset:0
    ds_read_b32 v123, v117 offset:4
    ds_read_b32 v124, v117 offset:8
    ds_read_b32 v125, v118 offset:25856
    ds_read_b32 v121, v118 offset:25860
    s_cmp_le_u32 s35, 4096
    s_cbranch_scc1 p1_ce0
    s_waitcnt lgkmcnt(5)
    v_alignbyte_b32 v113, v114, v113, v119
    buffer_store_dwordx4 v[110:113], v120, s[20:23], 0 offen
    v_add_u32 v120, 33554432, v120
    s_nop 0
    ds_read_b32 v110, v117 offset:12288
    ds_read_b32 v111, v117 offset:12292
    ds_read_b32 v112, v117 offset:12296
    ds_read_b32 v113, v118 offset:28928
    ds_read_b32 v114, v118 offset:28932
    s_cmp_le_u32 s35, 5120
    s_cbranch_scc1 p1_ce0
    s_waitcnt lgkmcnt(5)
    v_alignbyte_b32 v125, v121, v125, v119
    buffer_store_dwordx4 v[122:125], v120, s[20:23], 0 offen
    v_add_u32 v120, 33554432, v120
    s_nop 0
    ds_read_b32 v122, v117 offset:24576
    ds_read_b32 v123, v117 offset:24580
    ds_read_b32 v124, v117 offset:24584
    ds_read_b32 v125, v118 offset:32000
    ds_read_b32 v121, v118 offset:32004
    s_cmp_le_u32 s35, 6144
    s_cbranch_scc1 p1_ce0
    s_waitcnt lgkmcnt(5)
    v_alignbyte_b32 v113, v114, v113, v119
    buffer_store_dwordx4 v[110:113], v120, s[20:23], 0 offen
    v_add_u32 v120, 33554432, v120
    s_nop 0
    ds_read_b32 v110, v117 offset:36864
    ds_read_b32 v111, v117 offset:36868
    ds_read_b32 v112, v117 offset:36872
    ds_read_b32 v113, v118 offset:35072
    ds_read_b32 v114, v118 offset:35076
    s_cmp_le_u32 s35, 7168
    s_cbranch_scc1 p1_ce0
    s_waitcnt lgkmcnt(5)
    v_alignbyte_b32 v125, v121, v125, v119
    buffer_store_dwordx4 v[122:125], v120, s[20:23], 0 offen
    v_add_u32 v120, 33554432, v120
    s_nop 0
    s_cmp_le_u32 s35, 8192
    s_cbranch_scc1 p1_ce0
    s_waitcnt lgkmcnt(0)
    v_alignbyte_b32 v113, v114, v113, v119
    buffer_store_dwordx4 v[110:113], v120, s[20:23], 0 offen nt
    v_add_u32 v120, 33554432, v120
    s_nop 0
p1_ce0:
    s_waitcnt lgkmcnt(0)
    s_cmp_lg_u32 s70, 8
    s_cbranch_scc1 p1_h1
    s_sub_u32 s52, s33, 1536
    s_mul_i32 s52, s52, 41600
    s_add_u32 s52, s52, 477822976
    s_mov_b32 s54, 0x05040100
    s_mov_b32 s55, 0x07060302
    s_waitcnt vmcnt(1)
    v_perm_b32 v92, v78, v76, s54
    v_perm_b32 v93, v82, v80, s54
    v_perm_b32 v94, v86, v84, s54
    v_perm_b32 v95, v90, v88, s54
    buffer_store_dwordx4 v[92:95], v101, s[16:19], s52 offen offset:0
    v_perm_b32 v96, v78, v76, s55
    v_perm_b32 v97, v82, v80, s55
    v_perm_b32 v98, v86, v84, s55
    v_perm_b32 v99, v90, v88, s55
    buffer_store_dwordx4 v[96:99], v101, s[16:19], s52 offen offset:1040
    v_perm_b32 v92, v79, v77, s54
    v_perm_b32 v93, v83, v81, s54
    v_perm_b32 v94, v87, v85, s54
    v_perm_b32 v95, v91, v89, s54
    buffer_store_dwordx4 v[92:95], v101, s[16:19], s52 offen offset:2080
    v_perm_b32 v96, v79, v77, s55
    v_perm_b32 v97, v83, v81, s55
    v_perm_b32 v98, v87, v85, s55
    v_perm_b32 v99, v91, v89, s55
    buffer_store_dwordx4 v[96:99], v101, s[16:19], s52 offen offset:3120
p1_h1:
    s_barrier
    s_cmp_ge_u32 s29, 1462
    s_cbranch_scc1 p1_k38
    s_cmp_le_u32 s35, 9216
    s_cbranch_scc1 p1_s1k2
    v_sub_u32 v48, 221180, v48
    ds_write_b32 v48, v12 offset:52480
    v_sub_u32 v49, 221180, v49
    ds_write_b32 v49, v13 offset:52480
    v_sub_u32 v50, 221180, v50
    ds_write_b32 v50, v14 offset:52480
    v_sub_u32 v51, 221180, v51
    ds_write_b32 v51, v15 offset:52480
p1_s1k2:
p1_k38:
    s_cmp_ge_u32 s33, 1536
    s_cbranch_scc1 p1_k39
    s_cmp_lt_u32 s33, 1462
    s_cselect_b32 s6, 204800000, 0
    s_cselect_b32 s10, 204800000, 0
    s_add_u32 s32, s30, 32768
    buffer_load_dwordx4 v[12:15], v1, s[4:7], s32 offen nt
    buffer_load_dwordx4 v[48:51], v1, s[8:11], s32 offen nt
p1_k39:
    s_cmp_ge_u32 s29, 1426
    s_cbranch_scc1 p1_k40
    s_cmp_le_u32 s35, 9216
    s_cbranch_scc1 p1_s1k3
    v_sub_u32 v52, 221180, v52
    ds_write_b32 v52, v16 offset:52480
    v_sub_u32 v53, 221180, v53
    ds_write_b32 v53, v17 offset:52480
    v_sub_u32 v54, 221180, v54
    ds_write_b32 v54, v18 offset:52480
    v_sub_u32 v55, 221180, v55
    ds_write_b32 v55, v19 offset:52480
p1_s1k3:
p1_k40:
    s_cmp_ge_u32 s29, 1389
    s_cbranch_scc1 p1_k41
    s_cmp_le_u32 s35, 9216
    s_cbranch_scc1 p1_s1k4
    v_sub_u32 v56, 221180, v56
    ds_write_b32 v56, v20 offset:52480
    v_sub_u32 v57, 221180, v57
    ds_write_b32 v57, v21 offset:52480
    v_sub_u32 v58, 221180, v58
    ds_write_b32 v58, v22 offset:52480
    v_sub_u32 v59, 221180, v59
    ds_write_b32 v59, v23 offset:52480
p1_s1k4:
p1_k41:
    s_cmp_ge_u32 s29, 1352
    s_cbranch_scc1 p1_k42
    s_cmp_le_u32 s35, 9216
    s_cbranch_scc1 p1_s1k5
    v_sub_u32 v60, 221180, v60
    ds_write_b32 v60, v24 offset:52480
    v_sub_u32 v61, 221180, v61
    ds_write_b32 v61, v25 offset:52480
    v_sub_u32 v62, 221180, v62
    ds_write_b32 v62, v26 offset:52480
    v_sub_u32 v63, 221180, v63
    ds_write_b32 v63, v27 offset:52480
p1_s1k5:
p1_k42:
    s_cmp_ge_u32 s29, 1315
    s_cbranch_scc1 p1_k43
    s_cmp_le_u32 s35, 9216
    s_cbranch_scc1 p1_s1k6
    v_sub_u32 v64, 221180, v64
    ds_write_b32 v64, v28 offset:52480
    v_sub_u32 v65, 221180, v65
    ds_write_b32 v65, v29 offset:52480
    v_sub_u32 v66, 221180, v66
    ds_write_b32 v66, v30 offset:52480
    v_sub_u32 v67, 221180, v67
    ds_write_b32 v67, v31 offset:52480
p1_s1k6:
p1_k43:
    s_cmp_ge_u32 s29, 1279
    s_cbranch_scc1 p1_k44
    s_cmp_le_u32 s35, 9216
    s_cbranch_scc1 p1_s1k7
    v_sub_u32 v68, 221180, v68
    ds_write_b32 v68, v32 offset:52480
    v_sub_u32 v69, 221180, v69
    ds_write_b32 v69, v33 offset:52480
    v_sub_u32 v70, 221180, v70
    ds_write_b32 v70, v34 offset:52480
    v_sub_u32 v71, 221180, v71
    ds_write_b32 v71, v35 offset:52480
p1_s1k7:
p1_k44:
    s_cmp_ge_u32 s29, 1242
    s_cbranch_scc1 p1_k45
    s_cmp_le_u32 s35, 9216
    s_cbranch_scc1 p1_s1k8
    v_sub_u32 v72, 221180, v72
    ds_write_b32 v72, v36 offset:52480
    v_sub_u32 v73, 221180, v73
    ds_write_b32 v73, v37 offset:52480
    v_sub_u32 v74, 221180, v74
    ds_write_b32 v74, v38 offset:52480
    v_sub_u32 v75, 221180, v75
    ds_write_b32 v75, v39 offset:52480
p1_s1k8:
p1_k45:
    s_cmp_le_u32 s35, 9216
    s_cbranch_scc1 p1_s1k0
    v_sub_u32 v40, 221180, v40
    ds_write_b32 v40, v4 offset:52480
    v_sub_u32 v41, 221180, v41
    ds_write_b32 v41, v5 offset:52480
    v_sub_u32 v42, 221180, v42
    ds_write_b32 v42, v6 offset:52480
    v_sub_u32 v43, 221180, v43
    ds_write_b32 v43, v7 offset:52480
p1_s1k0:
    s_cmp_ge_u32 s29, 1499
    s_cbranch_scc1 p1_k46
    s_cmp_le_u32 s35, 9216
    s_cbranch_scc1 p1_s1k1
    v_sub_u32 v44, 221180, v44
    ds_write_b32 v44, v8 offset:52480
    v_sub_u32 v45, 221180, v45
    ds_write_b32 v45, v9 offset:52480
    v_sub_u32 v46, 221180, v46
    ds_write_b32 v46, v10 offset:52480
    v_sub_u32 v47, 221180, v47
    ds_write_b32 v47, v11 offset:52480
p1_s1k1:
p1_k46:
    s_cmp_lg_u32 s69, 8
    s_cbranch_scc1 p1_o1
    s_lshr_b32 s52, s29, 3
    v_and_b32 v74, 63, v0
    s_cmp_eq_u32 s28, 10
    s_cbranch_scc1 p1_tr11
    s_mul_i32 s53, s28, 520
    v_lshl_add_u32 v72, v74, 3, s53
    s_mul_i32 s53, s28, 4160
    v_lshl_add_u32 v73, v74, 4, s53
    s_branch p1_tr21
p1_tr11:
    v_mul_u32_u24 v72, 520, v74
    v_add_u32 v72, 512, v72
    v_mul_u32_u24 v73, 4160, v74
    v_add_u32 v73, 1024, v73
    v_cmp_gt_u32 vcc, 10, v74
    v_mov_b32 v74, 0x40000000
    s_nop 0
    v_cndmask_b32 v72, v74, v72, vcc
    v_cndmask_b32 v73, v74, v73, vcc
p1_tr21:
    s_mul_i32 s52, s52, 41984
    s_add_u32 s52, s52, 469762048
    buffer_load_dwordx2 v[24:25], v72, s[16:19], s52 offen sc1
    s_add_u32 s52, s52, 5248
    buffer_load_dwordx2 v[26:27], v72, s[16:19], s52 offen sc1
    s_add_u32 s52, s52, 5248
    buffer_load_dwordx2 v[28:29], v72, s[16:19], s52 offen sc1
    s_add_u32 s52, s52, 5248
    buffer_load_dwordx2 v[30:31], v72, s[16:19], s52 offen sc1
    s_add_u32 s52, s52, 5248
    buffer_load_dwordx2 v[32:33], v72, s[16:19], s52 offen sc1
    s_add_u32 s52, s52, 5248
    buffer_load_dwordx2 v[34:35], v72, s[16:19], s52 offen sc1
    s_add_u32 s52, s52, 5248
    buffer_load_dwordx2 v[36:37], v72, s[16:19], s52 offen sc1
    s_add_u32 s52, s52, 5248
    buffer_load_dwordx2 v[38:39], v72, s[16:19], s52 offen sc1
    s_add_u32 s52, s52, 5248
    s_cmp_ge_u32 s33, 1536
    s_cbranch_scc1 p1_o1
    s_lshr_b32 s52, s29, 3
    s_mul_i32 s52, s52, 41600
    s_add_u32 s52, s52, 477822976
    s_mov_b32 s54, 0x05040100
    s_mov_b32 s55, 0x07060302
    s_waitcnt vmcnt(0)
    v_perm_b32 v64, v26, v24, s54
    v_perm_b32 v65, v30, v28, s54
    v_perm_b32 v66, v34, v32, s54
    v_perm_b32 v67, v38, v36, s54
    buffer_store_dwordx4 v[64:67], v73, s[16:19], s52 offen offset:0
    v_perm_b32 v68, v26, v24, s55
    v_perm_b32 v69, v30, v28, s55
    v_perm_b32 v70, v34, v32, s55
    v_perm_b32 v71, v38, v36, s55
    buffer_store_dwordx4 v[68:71], v73, s[16:19], s52 offen offset:1040
    v_perm_b32 v64, v27, v25, s54
    v_perm_b32 v65, v31, v29, s54
    v_perm_b32 v66, v35, v33, s54
    v_perm_b32 v67, v39, v37, s54
    buffer_store_dwordx4 v[64:67], v73, s[16:19], s52 offen offset:2080
    v_perm_b32 v68, v27, v25, s55
    v_perm_b32 v69, v31, v29, s55
    v_perm_b32 v70, v35, v33, s55
    v_perm_b32 v71, v39, v37, s55
    buffer_store_dwordx4 v[68:71], v73, s[16:19], s52 offen offset:3120
    s_mov_b32 s69, 0
p1_o1:
    s_waitcnt lgkmcnt(0)
    s_barrier
    s_cmp_le_u32 s35, 9216
    s_cbranch_scc1 p1_ce1
    v_lshlrev_b32 v117, 2, v119
    v_sub_u32 v117, 113908, v117
    ds_read_b32 v122, v117 offset:49160
    ds_read_b32 v123, v117 offset:49156
    ds_read_b32 v124, v117 offset:49152
    ds_read_b32 v125, v118 offset:38144
    ds_read_b32 v121, v118 offset:38148
    ds_read_b32 v110, v117 offset:36872
    ds_read_b32 v111, v117 offset:36868
    ds_read_b32 v112, v117 offset:36864
    ds_read_b32 v113, v118 offset:41216
    ds_read_b32 v114, v118 offset:41220
    s_waitcnt lgkmcnt(5)
    v_alignbyte_b32 v125, v121, v125, v119
    buffer_store_dwordx4 v[122:125], v120, s[20:23], 0 offen nt
    v_add_u32 v120, 33554432, v120
    s_nop 0
    ds_read_b32 v122, v117 offset:24584
    ds_read_b32 v123, v117 offset:24580
    ds_read_b32 v124, v117 offset:24576
    ds_read_b32 v125, v118 offset:44288
    ds_read_b32 v121, v118 offset:44292
    s_cmp_le_u32 s35, 10240
    s_cbranch_scc1 p1_ce1
    s_waitcnt lgkmcnt(5)
    v_alignbyte_b32 v113, v114, v113, v119
    buffer_store_dwordx4 v[110:113], v120, s[20:23], 0 offen nt
    v_add_u32 v120, 33554432, v120
    s_nop 0
    ds_read_b32 v110, v117 offset:12296
    ds_read_b32 v111, v117 offset:12292
    ds_read_b32 v112, v117 offset:12288
    ds_read_b32 v113, v118 offset:47360
    ds_read_b32 v114, v118 offset:47364
    s_cmp_le_u32 s35, 11264
    s_cbranch_scc1 p1_ce1
    s_waitcnt lgkmcnt(5)
    v_alignbyte_b32 v125, v121, v125, v119
    buffer_store_dwordx4 v[122:125], v120, s[20:23], 0 offen nt
    v_add_u32 v120, 33554432, v120
    s_nop 0
    ds_read_b32 v122, v117 offset:8
    ds_read_b32 v123, v117 offset:4
    ds_read_b32 v124, v117 offset:0
    ds_read_b32 v125, v118 offset:50432
    ds_read_b32 v121, v118 offset:50436
    s_cmp_le_u32 s35, 12288
    s_cbranch_scc1 p1_ce1
    s_waitcnt lgkmcnt(5)
    v_alignbyte_b32 v113, v114, v113, v119
    buffer_store_dwordx4 v[110:113], v120, s[20:23], 0 offen nt
    v_add_u32 v120, 33554432, v120
    s_nop 0
    s_cmp_le_u32 s35, 13312
    s_cbranch_scc1 p1_ce1
    s_waitcnt lgkmcnt(0)
    v_alignbyte_b32 v125, v121, v125, v119
    buffer_store_dwordx4 v[122:125], v120, s[20:23], 0 offen nt
    v_add_u32 v120, 33554432, v120
    s_nop 0
p1_ce1:
    s_waitcnt lgkmcnt(0)
    s_cmp_lg_u32 s69, 8
    s_cbranch_scc1 p1_o2
    s_lshr_b32 s52, s29, 3
    s_mul_i32 s52, s52, 41600
    s_add_u32 s52, s52, 477822976
    s_mov_b32 s54, 0x05040100
    s_mov_b32 s55, 0x07060302
    s_waitcnt vmcnt(0)
    v_perm_b32 v64, v26, v24, s54
    v_perm_b32 v65, v30, v28, s54
    v_perm_b32 v66, v34, v32, s54
    v_perm_b32 v67, v38, v36, s54
    buffer_store_dwordx4 v[64:67], v73, s[16:19], s52 offen offset:0
    v_perm_b32 v68, v26, v24, s55
    v_perm_b32 v69, v30, v28, s55
    v_perm_b32 v70, v34, v32, s55
    v_perm_b32 v71, v38, v36, s55
    buffer_store_dwordx4 v[68:71], v73, s[16:19], s52 offen offset:1040
    v_perm_b32 v64, v27, v25, s54
    v_perm_b32 v65, v31, v29, s54
    v_perm_b32 v66, v35, v33, s54
    v_perm_b32 v67, v39, v37, s54
    buffer_store_dwordx4 v[64:67], v73, s[16:19], s52 offen offset:2080
    v_perm_b32 v68, v27, v25, s55
    v_perm_b32 v69, v31, v29, s55
    v_perm_b32 v70, v35, v33, s55
    v_perm_b32 v71, v39, v37, s55
    buffer_store_dwordx4 v[68:71], v73, s[16:19], s52 offen offset:3120
p1_o2:
    s_barrier
    s_mov_b32 s29, s33
    s_cmp_lt_u32 s29, 1242
    s_cselect_b32 s34, 1, 0
    s_cmp_lt_u32 s29, 1536
    s_cbranch_scc1 p1_tile
p1_end:
    s_endpgm
.globl p2_kernel
.p2align 8
.type p2_kernel,@function
p2_kernel:
    s_cmp_ge_u32 s2, 256
    s_cbranch_scc1 p2_end
    s_load_dwordx2 s[8:9], s[0:1], 104
    v_and_b32 v112, 63, v0
    v_lshrrev_b32 v122, 6, v0
    v_lshlrev_b32 v112, 4, v112
    v_readfirstlane_b32 s10, v122
    v_mov_b32 v113, 0x83ff0000
    s_and_b32 s44, s2, 7
    s_lshr_b32 s11, s44, 1
    s_and_b32 s44, s44, 1
    s_lshl_b32 s12, s44, 5
    s_lshr_b32 s44, s2, 3
    s_add_u32 s12, s12, s44
    s_mov_b32 s25, 54272
    s_mov_b32 s31, 67175170
    s_mov_b32 s32, 83952386
    s_mov_b32 s33, 100729602
    s_mov_b32 s21, 0
    s_mul_i32 s23, s10, 3072
    s_lshl_b32 s24, s10, 9
    s_lshl_b32 s64, s10, 10
    s_sub_u32 s42, s24, s23
    s_add_u32 s42, s42, 49152
    s_movk_i32 s63, 2048
    s_mul_i32 s62, s11, 161280
    s_add_u32 s62, s62, 485810176
    s_add_u32 s62, s62, s23
    s_mov_b32 s40, 477822976
    s_mul_i32 s44, s11, 1040
    s_add_u32 s40, s40, s44
    s_lshl_b32 s44, s12, 4
    s_add_u32 s40, s40, s44
    s_waitcnt lgkmcnt(0)
    s_mov_b32 s4, s8
    s_and_b32 s5, s9, 0xffff
    s_mov_b32 s6, 819200000
    s_mov_b32 s7, 0x20000
    s_mov_b32 s68, s8
    s_and_b32 s69, s9, 0xffff
    s_mov_b32 s70, 469762048
    s_mov_b32 s71, 0x20000
    s_and_b32 s44, s2, 7
    s_lshl_b32 s44, s44, 2
    s_lshr_b32 s18, 0x00000000, s44
    s_and_b32 s18, s18, 15
p2_restart:
    s_mov_b32 s61, 0
    s_add_u32 s44, s61, s18
    s_cmp_ge_u32 s44, 10
    s_cselect_b32 s53, 10, 0
    s_sub_u32 s44, s44, s53
    s_mul_i32 s44, s44, 4160
    s_add_u32 s44, s44, s40
    v_bfe_i32 v111, v112, 6, 1
    v_lshrrev_b32 v110, 6, v112
    v_bitop3_b32 v111, v111, 15, s10 bitop3:0x6a
    v_lshl_or_b32 v110, v110, 4, v111
    v_bfe_u32 v111, v112, 2, 4
    v_mul_u32_u24 v110, 41600, v110
    v_add_u32 v111, v110, v111
    v_add_u32 v110, 256, v112
    v_and_b32 v110, 0x400, v110
    v_lshl_or_b32 v111, v110, 20, v111
    buffer_load_dword v110, v111, s[4:7], s44 offen
    buffer_load_dword v111, v111, s[4:7], s44 offen offset:16
    s_mov_b32 s61, 1
    s_add_u32 s44, s61, s18
    s_cmp_ge_u32 s44, 10
    s_cselect_b32 s53, 10, 0
    s_sub_u32 s44, s44, s53
    s_mul_i32 s44, s44, 4160
    s_add_u32 s44, s44, s40
    v_bfe_i32 v69, v112, 6, 1
    v_lshrrev_b32 v68, 6, v112
    v_bitop3_b32 v69, v69, 15, s10 bitop3:0x6a
    v_lshl_or_b32 v68, v68, 4, v69
    v_bfe_u32 v69, v112, 2, 4
    v_mul_u32_u24 v68, 41600, v68
    v_add_u32 v69, v68, v69
    v_add_u32 v68, 256, v112
    v_and_b32 v68, 0x400, v68
    v_lshl_or_b32 v69, v68, 20, v69
    buffer_load_dword v68, v69, s[4:7], s44 offen
    buffer_load_dword v69, v69, s[4:7], s44 offen offset:16
    s_mov_b32 s61, 0
    s_cmp_lt_u32 s10, 15
    s_cselect_b32 s44, s64, 0x40000000
    v_add_u32 v60, s44, v112
    s_mov_b32 s44, 492261376
    buffer_load_dwordx4 v[60:63], v60, s[4:7], s44 offen
    s_mul_i32 s20, s18, 645120
    s_add_u32 s20, s20, s62
    s_cmp_ge_u32 s10, 9
    s_cbranch_scc1 p2_nmp
    v_lshrrev_b32 v84, 1, v112
    s_add_u32 s44, s20, s42
    buffer_load_dwordx2 v[84:85], v84, s[4:7], s44 offen
p2_nmp:
    buffer_load_dwordx4 v[72:75], v112, s[4:7], s20 offen offset:0
    buffer_load_dwordx4 v[76:79], v112, s[4:7], s20 offen offset:1024
    buffer_load_dwordx4 v[80:83], v112, s[4:7], s20 offen offset:2048
    s_barrier
    v_mov_b32 v115, 0
    v_mov_b32 v116, 0
    v_mov_b32 v117, 0
    v_mov_b32 v118, 0
    v_mov_b32 v119, 0
    v_mov_b32 v120, 0
    v_mov_b32 v121, 0
    ds_write_b128 v115, v[116:119] offset:53760
    s_mov_b32 s19, 0
    s_cmp_eq_u32 s21, 2
    s_cselect_b64 s[66:67], -1, 0
    s_waitcnt lgkmcnt(0)
    s_barrier
    s_waitcnt vmcnt(6)
    s_mov_b32 m0, s23
    v_mov_b32 v53, 0
    s_movk_i32 s44, 512
    v_sub_u32_sdwa v4, v111, v110 dst_sel:DWORD dst_unused:UNUSED_PAD src0_sel:WORD_0 src1_sel:WORD_0
    v_sub_u32_sdwa v5, v111, v110 dst_sel:DWORD dst_unused:UNUSED_PAD src0_sel:WORD_1 src1_sel:WORD_1
    v_med3_i32 v4, v4, 0, s44
    v_med3_i32 v5, v5, 0, s44
    v_add_u32 v48, v4, v5
    ds_write_addtid_b32 v53 offset:0
    ds_write_addtid_b32 v53 offset:256
    ds_write_addtid_b32 v53 offset:512
    ds_write_addtid_b32 v53 offset:768
    ds_write_addtid_b32 v53 offset:1024
    ds_write_addtid_b32 v53 offset:1280
    ds_write_addtid_b32 v53 offset:1536
    ds_write_addtid_b32 v53 offset:1792
    v_bfe_i32 v53, v112, 6, 1
    v_lshrrev_b32 v49, 6, v112
    v_bitop3_b32 v53, v53, 15, s10 bitop3:0x6a
    v_lshl_or_b32 v49, v49, 4, v53
    v_and_b32 v53, 0x30, v112
    v_lshl_or_b32 v53, v49, 6, v53
    v_lshlrev_b32 v53, 15, v53
    s_nop 1
    v_add_u32_dpp v48, v48, v48 row_shr:1 row_mask:0xf bank_mask:0xf bound_ctrl:0
    s_nop 1
    v_add_u32_dpp v48, v48, v48 row_shr:2 row_mask:0xf bank_mask:0xf bound_ctrl:0
    s_nop 1
    v_add_u32_dpp v48, v48, v48 row_shr:4 row_mask:0xf bank_mask:0xf bound_ctrl:0
    s_nop 1
    v_add_u32_dpp v48, v48, v48 row_shr:8 row_mask:0xf bank_mask:0xf bound_ctrl:0
    s_nop 1
    v_add_u32_dpp v48, v48, v48 row_bcast:15 row_mask:0xa bank_mask:0xf
    s_nop 1
    v_add_u32_dpp v48, v48, v48 row_bcast:31 row_mask:0xc bank_mask:0xf
    s_nop 1
    s_nop 0
    v_readlane_b32 s38, v48, 63
    v_sub_u32 v50, v48, v5
    v_sub_u32 v49, v50, v4
    v_writelane_b32 v5, 1, 63
    v_sub_u32 v10, 512, v49
    v_mad_u32_u16 v51, v110, 16, v53
    v_lshl_add_u32 v51, v10, 4, v51
    v_med3_i32 v10, v10, 0, v4
    v_lshl_add_u32 v49, v49, 2, s23
    v_sub_u32 v11, 512, v50
    v_mad_u32_u16 v52, v110, 16, v53 op_sel:[1,0,0,0]
    v_add_u32 v52, 262144, v52
    s_mov_b32 s44, 0x1fffc000
    v_writelane_b32 v52, s44, 63
    v_lshl_add_u32 v52, v11, 4, v52
    v_med3_i32 v11, v11, 0, v5
    v_lshl_add_u32 v50, v50, 2, s23
    v_lshl_add_u32 v48, v11, 16, v10
    v_add_u32 v110, v110, v48
    s_min_u32 s17, s38, 512
    s_add_u32 s17, s17, 63
    s_lshr_b32 s17, s17, 6
    v_cmpx_lt_i32 vcc, 0, v10
    ds_write_b32 v49, v51
    s_mov_b64 exec, -1
    v_cmpx_lt_i32 vcc, 0, v11
    ds_write_b32 v50, v52
    s_mov_b64 exec, -1
    s_cmp_lt_u32 s38, 512
    s_cbranch_scc1 p2_nomorea
    v_cmp_lt_u32_sdwa s[44:45], v110, v111 src0_sel:WORD_0 src1_sel:WORD_0
    v_cmp_lt_u32_sdwa s[46:47], v110, v111 src0_sel:WORD_1 src1_sel:WORD_1
    s_nop 0
    s_or_b64 s[44:45], s[44:45], s[46:47]
    s_cbranch_scc0 p2_nomorea
    v_mov_b32 v49, s19
    v_mov_b32 v50, 1
    ds_write_b32 v49, v50 offset:53760
p2_nomorea:
    s_mov_b32 m0, s23
    s_nop 0
    ds_read_addtid_b32 v2 offset:1024
    ds_read_addtid_b32 v8 offset:1280
    ds_read_addtid_b32 v14 offset:1536
    ds_read_addtid_b32 v20 offset:1792
    ds_read_addtid_b32 v88 offset:0
    ds_read_addtid_b32 v92 offset:256
    ds_read_addtid_b32 v96 offset:512
    ds_read_addtid_b32 v100 offset:768
    s_waitcnt lgkmcnt(0)
    s_nop 2
    s_nop 1
    v_max_u32_dpp v88, v88, v88 row_shr:1 row_mask:0xf bank_mask:0xf bound_ctrl:0
    v_max_u32_dpp v92, v92, v92 row_shr:1 row_mask:0xf bank_mask:0xf bound_ctrl:0
    v_max_u32_dpp v96, v96, v96 row_shr:1 row_mask:0xf bank_mask:0xf bound_ctrl:0
    v_max_u32_dpp v100, v100, v100 row_shr:1 row_mask:0xf bank_mask:0xf bound_ctrl:0
    v_max_u32_dpp v2, v2, v2 row_shr:1 row_mask:0xf bank_mask:0xf bound_ctrl:0
    v_max_u32_dpp v8, v8, v8 row_shr:1 row_mask:0xf bank_mask:0xf bound_ctrl:0
    v_max_u32_dpp v14, v14, v14 row_shr:1 row_mask:0xf bank_mask:0xf bound_ctrl:0
    v_max_u32_dpp v20, v20, v20 row_shr:1 row_mask:0xf bank_mask:0xf bound_ctrl:0
    v_max_u32_dpp v88, v88, v88 row_shr:2 row_mask:0xf bank_mask:0xf bound_ctrl:0
    v_max_u32_dpp v92, v92, v92 row_shr:2 row_mask:0xf bank_mask:0xf bound_ctrl:0
    v_max_u32_dpp v96, v96, v96 row_shr:2 row_mask:0xf bank_mask:0xf bound_ctrl:0
    v_max_u32_dpp v100, v100, v100 row_shr:2 row_mask:0xf bank_mask:0xf bound_ctrl:0
    v_max_u32_dpp v2, v2, v2 row_shr:2 row_mask:0xf bank_mask:0xf bound_ctrl:0
    v_max_u32_dpp v8, v8, v8 row_shr:2 row_mask:0xf bank_mask:0xf bound_ctrl:0
    v_max_u32_dpp v14, v14, v14 row_shr:2 row_mask:0xf bank_mask:0xf bound_ctrl:0
    v_max_u32_dpp v20, v20, v20 row_shr:2 row_mask:0xf bank_mask:0xf bound_ctrl:0
    v_max_u32_dpp v88, v88, v88 row_shr:4 row_mask:0xf bank_mask:0xf bound_ctrl:0
    v_max_u32_dpp v92, v92, v92 row_shr:4 row_mask:0xf bank_mask:0xf bound_ctrl:0
    v_max_u32_dpp v96, v96, v96 row_shr:4 row_mask:0xf bank_mask:0xf bound_ctrl:0
    v_max_u32_dpp v100, v100, v100 row_shr:4 row_mask:0xf bank_mask:0xf bound_ctrl:0
    v_max_u32_dpp v2, v2, v2 row_shr:4 row_mask:0xf bank_mask:0xf bound_ctrl:0
    v_max_u32_dpp v8, v8, v8 row_shr:4 row_mask:0xf bank_mask:0xf bound_ctrl:0
    v_max_u32_dpp v14, v14, v14 row_shr:4 row_mask:0xf bank_mask:0xf bound_ctrl:0
    v_max_u32_dpp v20, v20, v20 row_shr:4 row_mask:0xf bank_mask:0xf bound_ctrl:0
    v_max_u32_dpp v88, v88, v88 row_shr:8 row_mask:0xf bank_mask:0xf bound_ctrl:0
    v_max_u32_dpp v92, v92, v92 row_shr:8 row_mask:0xf bank_mask:0xf bound_ctrl:0
    v_max_u32_dpp v96, v96, v96 row_shr:8 row_mask:0xf bank_mask:0xf bound_ctrl:0
    v_max_u32_dpp v100, v100, v100 row_shr:8 row_mask:0xf bank_mask:0xf bound_ctrl:0
    v_max_u32_dpp v2, v2, v2 row_shr:8 row_mask:0xf bank_mask:0xf bound_ctrl:0
    v_max_u32_dpp v8, v8, v8 row_shr:8 row_mask:0xf bank_mask:0xf bound_ctrl:0
    v_max_u32_dpp v14, v14, v14 row_shr:8 row_mask:0xf bank_mask:0xf bound_ctrl:0
    v_max_u32_dpp v20, v20, v20 row_shr:8 row_mask:0xf bank_mask:0xf bound_ctrl:0
    v_max_u32_dpp v88, v88, v88 row_bcast:15 row_mask:0xa bank_mask:0xf
    v_max_u32_dpp v92, v92, v92 row_bcast:15 row_mask:0xa bank_mask:0xf
    v_max_u32_dpp v96, v96, v96 row_bcast:15 row_mask:0xa bank_mask:0xf
    v_max_u32_dpp v100, v100, v100 row_bcast:15 row_mask:0xa bank_mask:0xf
    v_max_u32_dpp v2, v2, v2 row_bcast:15 row_mask:0xa bank_mask:0xf
    v_max_u32_dpp v8, v8, v8 row_bcast:15 row_mask:0xa bank_mask:0xf
    v_max_u32_dpp v14, v14, v14 row_bcast:15 row_mask:0xa bank_mask:0xf
    v_max_u32_dpp v20, v20, v20 row_bcast:15 row_mask:0xa bank_mask:0xf
    v_max_u32_dpp v88, v88, v88 row_bcast:31 row_mask:0xc bank_mask:0xf
    v_max_u32_dpp v92, v92, v92 row_bcast:31 row_mask:0xc bank_mask:0xf
    v_max_u32_dpp v96, v96, v96 row_bcast:31 row_mask:0xc bank_mask:0xf
    v_max_u32_dpp v100, v100, v100 row_bcast:31 row_mask:0xc bank_mask:0xf
    v_max_u32_dpp v2, v2, v2 row_bcast:31 row_mask:0xc bank_mask:0xf
    v_max_u32_dpp v8, v8, v8 row_bcast:31 row_mask:0xc bank_mask:0xf
    v_max_u32_dpp v14, v14, v14 row_bcast:31 row_mask:0xc bank_mask:0xf
    v_max_u32_dpp v20, v20, v20 row_bcast:31 row_mask:0xc bank_mask:0xf
    s_nop 0
    v_readlane_b32 s41, v88, 63
    v_add_u32 v88, v88, v112
    v_add_u32 v88, 4294959104, v88
    v_max_u32 v92, s41, v92
    s_nop 0
    v_readlane_b32 s41, v92, 63
    v_add_u32 v92, v92, v112
    v_add_u32 v92, 4294960128, v92
    v_max_u32 v96, s41, v96
    s_nop 0
    v_readlane_b32 s41, v96, 63
    v_add_u32 v96, v96, v112
    v_add_u32 v96, 4294961152, v96
    v_max_u32 v100, s41, v100
    s_nop 0
    v_readlane_b32 s41, v100, 63
    v_add_u32 v100, v100, v112
    v_add_u32 v100, 4294962176, v100
    v_max_u32 v2, s41, v2
    s_nop 0
    v_readlane_b32 s41, v2, 63
    v_add_u32 v2, v2, v112
    v_add_u32 v2, 4294963200, v2
    v_max_u32 v8, s41, v8
    s_nop 0
    v_readlane_b32 s41, v8, 63
    v_add_u32 v8, v8, v112
    v_add_u32 v8, 4294964224, v8
    v_max_u32 v14, s41, v14
    s_nop 0
    v_readlane_b32 s41, v14, 63
    v_add_u32 v14, v14, v112
    v_add_u32 v14, 4294965248, v14
    v_max_u32 v20, s41, v20
    s_nop 0
    v_readlane_b32 s41, v20, 63
    v_add_u32 v20, v20, v112
    v_add_u32 v20, 4294966272, v20
    v_bfe_u32 v0, v2, 14, 4
    v_lshrrev_b32 v1, 18, v2
    v_and_b32 v2, 0x3fff, v2
    v_mad_u32_u24 v0, v0, s63, v1
    v_lshl_or_b32 v2, v0, 14, v2
    buffer_load_dwordx4 v[0:3], v2, s[68:71], 0 offen
    v_bfe_u32 v6, v8, 14, 4
    v_lshrrev_b32 v7, 18, v8
    v_and_b32 v8, 0x3fff, v8
    v_mad_u32_u24 v6, v6, s63, v7
    v_lshl_or_b32 v8, v6, 14, v8
    buffer_load_dwordx4 v[6:9], v8, s[68:71], 0 offen
    s_cmp_eq_u32 s21, 0
    s_cselect_b32 s44, 1073758208, 0
    v_mov_b32 v124, s44
    v_mov_b32 v125, s44
    v_mov_b32 v126, s44
    v_mov_b32 v127, s44
    v_add_u32 v123, s64, v112
    v_add_u32 v122, s25, v123
    ds_write_b128 v122, v[124:127] offset:0
    ds_write_b128 v122, v[124:127] offset:16384
    ds_write_b128 v122, v[124:127] offset:32768
    v_add_u32 v122, 49152, v122
    ds_write_b128 v122, v[124:127] offset:0
    ds_write_b128 v122, v[124:127] offset:16384
    ds_write_b128 v122, v[124:127] offset:32768
    v_cmpx_gt_u32 vcc, 1792, v123
    ds_write_b128 v122, v[124:127] offset:49152
    s_mov_b64 exec, -1
    v_bfe_u32 v12, v14, 14, 4
    v_lshrrev_b32 v13, 18, v14
    v_and_b32 v14, 0x3fff, v14
    v_mad_u32_u24 v12, v12, s63, v13
    v_lshl_or_b32 v14, v12, 14, v14
    buffer_load_dwordx4 v[12:15], v14, s[68:71], 0 offen
    s_mov_b32 s16, s17
    s_waitcnt vmcnt(6)
    s_cmp_lg_u32 s21, 0
    s_cbranch_scc1 p2_nostat1
    v_max_u32 v60, v60, v62
    v_add_f32 v61, v61, v63
    s_nop 1
    v_max_u32_dpp v60, v60, v60 row_shr:1 row_mask:0xf bank_mask:0xf bound_ctrl:0
    v_add_f32_dpp v61, v61, v61 row_shr:1 row_mask:0xf bank_mask:0xf bound_ctrl:0
    s_nop 0
    v_max_u32_dpp v60, v60, v60 row_shr:2 row_mask:0xf bank_mask:0xf bound_ctrl:0
    v_add_f32_dpp v61, v61, v61 row_shr:2 row_mask:0xf bank_mask:0xf bound_ctrl:0
    s_nop 0
    v_max_u32_dpp v60, v60, v60 row_shr:4 row_mask:0xf bank_mask:0xf bound_ctrl:0
    v_add_f32_dpp v61, v61, v61 row_shr:4 row_mask:0xf bank_mask:0xf bound_ctrl:0
    s_nop 0
    v_max_u32_dpp v60, v60, v60 row_shr:8 row_mask:0xf bank_mask:0xf bound_ctrl:0
    v_add_f32_dpp v61, v61, v61 row_shr:8 row_mask:0xf bank_mask:0xf bound_ctrl:0
    s_nop 0
    v_max_u32_dpp v60, v60, v60 row_bcast:15 row_mask:0xa bank_mask:0xf
    v_add_f32_dpp v61, v61, v61 row_bcast:15 row_mask:0xa bank_mask:0xf
    s_nop 0
    v_max_u32_dpp v60, v60, v60 row_bcast:31 row_mask:0xc bank_mask:0xf
    v_add_f32_dpp v61, v61, v61 row_bcast:31 row_mask:0xc bank_mask:0xf
    s_nop 0
    s_nop 0
    s_lshl_b32 s44, s10, 3
    v_mov_b32 v62, s44
    s_mov_b64 exec, 1
    s_lshl_b64 exec, exec, 63
    ds_write_b64 v62, v[60:61] offset:53824
    s_mov_b64 exec, -1
p2_nostat1:
    s_waitcnt lgkmcnt(0)
    s_barrier
    v_bfe_u32 v18, v20, 14, 4
    v_lshrrev_b32 v19, 18, v20
    v_and_b32 v20, 0x3fff, v20
    v_mad_u32_u24 v18, v18, s63, v19
    v_lshl_or_b32 v20, v18, 14, v20
    buffer_load_dwordx4 v[18:21], v20, s[68:71], 0 offen
    v_mov_b32 v122, s19
    s_xor_b32 s19, s19, 4
    ds_read_b32 v125, v122 offset:53760
    s_cmp_lg_u32 s21, 0
    s_cbranch_scc1 p2_nostat2
    v_bfe_u32 v62, v112, 1, 7
    ds_read_b64 v[60:61], v62 offset:53824
    s_waitcnt lgkmcnt(0)
    s_nop 1
    v_max_u32_dpp v60, v60, v60 row_shr:1 row_mask:0xf bank_mask:0xf bound_ctrl:0
    v_add_f32_dpp v61, v61, v61 row_shr:1 row_mask:0xf bank_mask:0xf bound_ctrl:0
    s_nop 0
    v_max_u32_dpp v60, v60, v60 row_shr:2 row_mask:0xf bank_mask:0xf bound_ctrl:0
    v_add_f32_dpp v61, v61, v61 row_shr:2 row_mask:0xf bank_mask:0xf bound_ctrl:0
    s_nop 0
    v_max_u32_dpp v60, v60, v60 row_shr:4 row_mask:0xf bank_mask:0xf bound_ctrl:0
    v_add_f32_dpp v61, v61, v61 row_shr:4 row_mask:0xf bank_mask:0xf bound_ctrl:0
    s_nop 0
    v_max_u32_dpp v60, v60, v60 row_shr:8 row_mask:0xf bank_mask:0xf bound_ctrl:0
    v_add_f32_dpp v61, v61, v61 row_shr:8 row_mask:0xf bank_mask:0xf bound_ctrl:0
    s_nop 0
    v_max_u32_dpp v60, v60, v60 row_bcast:15 row_mask:0xa bank_mask:0xf
    v_add_f32_dpp v61, v61, v61 row_bcast:15 row_mask:0xa bank_mask:0xf
    s_nop 0
    v_max_u32_dpp v60, v60, v60 row_bcast:31 row_mask:0xc bank_mask:0xf
    v_add_f32_dpp v61, v61, v61 row_bcast:31 row_mask:0xc bank_mask:0xf
    s_nop 0
    s_nop 0
    v_readlane_b32 s44, v60, 15
    v_readlane_b32 s45, v61, 15
    s_nop 1
    s_lshl_b32 s44, s44, 16
    s_lshr_b32 s46, s44, 23
    s_sub_u32 s47, s46, 80
    s_cmp_lt_u32 s47, 100
    s_cselect_b32 s21, 0, 1
    v_mov_b32 v60, s45
    v_mul_f32 v60, 0x34a7c5ac, v60
    v_sqrt_f32 v60, v60
    v_mov_b32 v61, s44
    v_mul_f32 v62, 0x41800000, v60
    v_cmp_nle_f32 vcc, v61, v62
    v_mul_f32 v60, 0x3ac00000, v60
    v_mul_f32 v61, 0x3901742e, v61
    v_max_f32 v60, v60, v61
    s_cmp_lg_u64 vcc, 0
    s_cselect_b32 s21, 1, s21
    v_readfirstlane_b32 s44, v60
    s_nop 0
    s_and_b32 s47, s44, 0x7fffff
    s_or_b32 s47, s47, 0x3f000000
    s_and_b32 s48, s44, 0x7f800000
    s_add_u32 s48, s48, 0x800000
    v_rcp_f32 v60, s47
    s_nop 0
    v_rcp_f32 v61, v60
    v_mul_f32 v60, 0x7b800000, v60
    v_mul_f32 v61, s48, v61
    s_nop 0
    v_readfirstlane_b32 s26, v60
    v_readfirstlane_b32 s30, v61
    s_add_u32 s34, s48, 197132288
    s_mov_b32 s35, s34
    s_sub_u32 s36, 0, s34
    s_subb_u32 s37, 0, s34
    s_cmp_eq_u32 s21, 0
    s_cbranch_scc1 p2_nostat2
    s_waitcnt vmcnt(0) lgkmcnt(0)
    s_branch p2_restart
p2_nostat2:
    s_cmp_eq_u32 s21, 0
    s_cselect_b32 s26, s26, 0x7b800000
    v_mov_b32 v114, s26
    s_waitcnt lgkmcnt(0)
    v_readfirstlane_b32 s44, v125
    s_nop 0
    s_cmp_lg_u32 s44, 0
    s_cbranch_scc1 p2_adva
    s_mov_b32 s61, 1
    v_mov_b32 v110, v68
    v_mov_b32 v111, v69
p2_adva:
    v_bfe_u32 v86, v88, 14, 4
    v_lshrrev_b32 v87, 18, v88
    v_and_b32 v88, 0x3fff, v88
    v_mad_u32_u24 v86, v86, s63, v87
    v_lshl_or_b32 v88, v86, 14, v88
    buffer_load_dwordx4 v[86:89], v88, s[68:71], 0 offen
    s_mov_b32 m0, s23
    v_mov_b32 v53, 0
    s_movk_i32 s44, 512
    v_sub_u32_sdwa v4, v111, v110 dst_sel:DWORD dst_unused:UNUSED_PAD src0_sel:WORD_0 src1_sel:WORD_0
    v_sub_u32_sdwa v5, v111, v110 dst_sel:DWORD dst_unused:UNUSED_PAD src0_sel:WORD_1 src1_sel:WORD_1
    v_med3_i32 v4, v4, 0, s44
    v_med3_i32 v5, v5, 0, s44
    v_add_u32 v48, v4, v5
    ds_write_addtid_b32 v53 offset:0
    ds_write_addtid_b32 v53 offset:256
    ds_write_addtid_b32 v53 offset:512
    ds_write_addtid_b32 v53 offset:768
    ds_write_addtid_b32 v53 offset:1024
    ds_write_addtid_b32 v53 offset:1280
    ds_write_addtid_b32 v53 offset:1536
    ds_write_addtid_b32 v53 offset:1792
    v_bfe_i32 v53, v112, 6, 1
    v_lshrrev_b32 v49, 6, v112
    v_bitop3_b32 v53, v53, 15, s10 bitop3:0x6a
    v_lshl_or_b32 v49, v49, 4, v53
    v_and_b32 v53, 0x30, v112
    v_lshl_or_b32 v53, v49, 6, v53
    v_lshlrev_b32 v53, 15, v53
    s_nop 1
    v_add_u32_dpp v48, v48, v48 row_shr:1 row_mask:0xf bank_mask:0xf bound_ctrl:0
    s_nop 1
    v_add_u32_dpp v48, v48, v48 row_shr:2 row_mask:0xf bank_mask:0xf bound_ctrl:0
    s_nop 1
    v_add_u32_dpp v48, v48, v48 row_shr:4 row_mask:0xf bank_mask:0xf bound_ctrl:0
    s_nop 1
    v_add_u32_dpp v48, v48, v48 row_shr:8 row_mask:0xf bank_mask:0xf bound_ctrl:0
    s_nop 1
    v_add_u32_dpp v48, v48, v48 row_bcast:15 row_mask:0xa bank_mask:0xf
    s_nop 1
    v_add_u32_dpp v48, v48, v48 row_bcast:31 row_mask:0xc bank_mask:0xf
    s_nop 1
    s_nop 0
    v_readlane_b32 s38, v48, 63
    v_sub_u32 v50, v48, v5
    v_sub_u32 v49, v50, v4
    v_writelane_b32 v5, 1, 63
    v_sub_u32 v10, 512, v49
    v_mad_u32_u16 v51, v110, 16, v53
    v_lshl_add_u32 v51, v10, 4, v51
    v_med3_i32 v10, v10, 0, v4
    v_lshl_add_u32 v49, v49, 2, s23
    v_sub_u32 v11, 512, v50
    v_mad_u32_u16 v52, v110, 16, v53 op_sel:[1,0,0,0]
    v_add_u32 v52, 262144, v52
    s_mov_b32 s44, 0x1fffc000
    v_writelane_b32 v52, s44, 63
    v_lshl_add_u32 v52, v11, 4, v52
    v_med3_i32 v11, v11, 0, v5
    v_lshl_add_u32 v50, v50, 2, s23
    v_lshl_add_u32 v48, v11, 16, v10
    v_add_u32 v110, v110, v48
    s_min_u32 s17, s38, 512
    s_add_u32 s17, s17, 63
    s_lshr_b32 s17, s17, 6
    v_cmpx_lt_i32 vcc, 0, v10
    ds_write_b32 v49, v51
    s_mov_b64 exec, -1
    v_cmpx_lt_i32 vcc, 0, v11
    ds_write_b32 v50, v52
    s_mov_b64 exec, -1
    s_cmp_lt_u32 s38, 512
    s_cbranch_scc1 p2_nomoreb
    v_cmp_lt_u32_sdwa s[44:45], v110, v111 src0_sel:WORD_0 src1_sel:WORD_0
    v_cmp_lt_u32_sdwa s[46:47], v110, v111 src0_sel:WORD_1 src1_sel:WORD_1
    s_nop 0
    s_or_b64 s[44:45], s[44:45], s[46:47]
    s_cbranch_scc0 p2_nomoreb
    v_mov_b32 v49, s19
    v_mov_b32 v50, 1
    ds_write_b32 v49, v50 offset:53760
p2_nomoreb:
    s_mov_b32 m0, s23
    s_nop 0
    ds_read_addtid_b32 v102 offset:1024
    ds_read_addtid_b32 v103 offset:1280
    ds_read_addtid_b32 v104 offset:1536
    ds_read_addtid_b32 v105 offset:1792
    ds_read_addtid_b32 v106 offset:0
    ds_read_addtid_b32 v107 offset:256
    ds_read_addtid_b32 v108 offset:512
    ds_read_addtid_b32 v109 offset:768
    v_bfe_u32 v90, v92, 14, 4
    v_lshrrev_b32 v91, 18, v92
    v_and_b32 v92, 0x3fff, v92
    v_mad_u32_u24 v90, v90, s63, v91
    v_lshl_or_b32 v92, v90, 14, v92
    buffer_load_dwordx4 v[90:93], v92, s[68:71], 0 offen
    s_waitcnt vmcnt(6)
    s_mov_b32 m0, s24
    s_cmp_ge_u32 s10, 9
    s_cbranch_scc1 p2_stp
    ds_write_addtid_b32 v84 offset:49152
    ds_write_addtid_b32 v85 offset:49408
p2_stp:
    s_mov_b32 m0, s23
    s_add_u32 s20, s20, 53760
    ds_write_addtid_b32 v72 offset:0
    ds_write_addtid_b32 v73 offset:256
    ds_write_addtid_b32 v74 offset:512
    ds_write_addtid_b32 v75 offset:768
    ds_write_addtid_b32 v76 offset:1024
    ds_write_addtid_b32 v77 offset:1280
    ds_write_addtid_b32 v78 offset:1536
    ds_write_addtid_b32 v79 offset:1792
    ds_write_addtid_b32 v80 offset:2048
    ds_write_addtid_b32 v81 offset:2304
    ds_write_addtid_b32 v82 offset:2560
    ds_write_addtid_b32 v83 offset:2816
    s_waitcnt lgkmcnt(0)
    s_barrier
    v_bfe_u32 v94, v96, 14, 4
    v_lshrrev_b32 v95, 18, v96
    v_and_b32 v96, 0x3fff, v96
    v_mad_u32_u24 v94, v94, s63, v95
    v_lshl_or_b32 v96, v94, 14, v96
    buffer_load_dwordx4 v[94:97], v96, s[68:71], 0 offen
    v_bfe_u32 v98, v100, 14, 4
    v_lshrrev_b32 v99, 18, v100
    v_and_b32 v100, 0x3fff, v100
    v_mad_u32_u24 v98, v98, s63, v99
    v_lshl_or_b32 v100, v98, 14, v100
    buffer_load_dwordx4 v[98:101], v100, s[68:71], 0 offen
    s_nop 2
    s_nop 1
    v_max_u32_dpp v106, v106, v106 row_shr:1 row_mask:0xf bank_mask:0xf bound_ctrl:0
    v_max_u32_dpp v107, v107, v107 row_shr:1 row_mask:0xf bank_mask:0xf bound_ctrl:0
    v_max_u32_dpp v108, v108, v108 row_shr:1 row_mask:0xf bank_mask:0xf bound_ctrl:0
    v_max_u32_dpp v109, v109, v109 row_shr:1 row_mask:0xf bank_mask:0xf bound_ctrl:0
    v_max_u32_dpp v106, v106, v106 row_shr:2 row_mask:0xf bank_mask:0xf bound_ctrl:0
    v_max_u32_dpp v107, v107, v107 row_shr:2 row_mask:0xf bank_mask:0xf bound_ctrl:0
    v_max_u32_dpp v108, v108, v108 row_shr:2 row_mask:0xf bank_mask:0xf bound_ctrl:0
    v_max_u32_dpp v109, v109, v109 row_shr:2 row_mask:0xf bank_mask:0xf bound_ctrl:0
    v_max_u32_dpp v106, v106, v106 row_shr:4 row_mask:0xf bank_mask:0xf bound_ctrl:0
    v_max_u32_dpp v107, v107, v107 row_shr:4 row_mask:0xf bank_mask:0xf bound_ctrl:0
    v_max_u32_dpp v108, v108, v108 row_shr:4 row_mask:0xf bank_mask:0xf bound_ctrl:0
    v_max_u32_dpp v109, v109, v109 row_shr:4 row_mask:0xf bank_mask:0xf bound_ctrl:0
    v_max_u32_dpp v106, v106, v106 row_shr:8 row_mask:0xf bank_mask:0xf bound_ctrl:0
    v_max_u32_dpp v107, v107, v107 row_shr:8 row_mask:0xf bank_mask:0xf bound_ctrl:0
    v_max_u32_dpp v108, v108, v108 row_shr:8 row_mask:0xf bank_mask:0xf bound_ctrl:0
    v_max_u32_dpp v109, v109, v109 row_shr:8 row_mask:0xf bank_mask:0xf bound_ctrl:0
    v_max_u32_dpp v106, v106, v106 row_bcast:15 row_mask:0xa bank_mask:0xf
    v_max_u32_dpp v107, v107, v107 row_bcast:15 row_mask:0xa bank_mask:0xf
    v_max_u32_dpp v108, v108, v108 row_bcast:15 row_mask:0xa bank_mask:0xf
    v_max_u32_dpp v109, v109, v109 row_bcast:15 row_mask:0xa bank_mask:0xf
    v_max_u32_dpp v106, v106, v106 row_bcast:31 row_mask:0xc bank_mask:0xf
    v_max_u32_dpp v107, v107, v107 row_bcast:31 row_mask:0xc bank_mask:0xf
    v_max_u32_dpp v108, v108, v108 row_bcast:31 row_mask:0xc bank_mask:0xf
    v_max_u32_dpp v109, v109, v109 row_bcast:31 row_mask:0xc bank_mask:0xf
    s_nop 0
    v_readlane_b32 s41, v106, 63
    v_add_u32 v106, v106, v112
    v_add_u32 v106, 4294959104, v106
    v_max_u32 v107, s41, v107
    s_nop 0
    v_readlane_b32 s41, v107, 63
    v_add_u32 v107, v107, v112
    v_add_u32 v107, 4294960128, v107
    v_max_u32 v108, s41, v108
    s_nop 0
    v_readlane_b32 s41, v108, 63
    v_add_u32 v108, v108, v112
    v_add_u32 v108, 4294961152, v108
    v_max_u32 v109, s41, v109
    s_nop 0
    v_readlane_b32 s41, v109, 63
    v_add_u32 v109, v109, v112
    v_add_u32 v109, 4294962176, v109
    s_waitcnt vmcnt(7)
    v_perm_b32 v48, v3, v0, s31
    v_perm_b32 v49, v3, v1, s32
    v_perm_b32 v50, v3, v2, s33
    v_lshlrev_b16 v4, 3, v2
    v_lshlrev_b16 v2, 3, v1
    v_lshlrev_b16 v0, 3, v0
    v_cmpx_ge_u16 vcc, 0x3fff, v48
    ds_read_b64 v[0:1], v0
    s_mov_b64 exec, -1
    v_cmpx_ge_u16 vcc, 0x3fff, v49
    ds_read_b64 v[2:3], v2
    s_mov_b64 exec, -1
    v_cmpx_ge_u16 vcc, 0x3fff, v50
    ds_read_b64 v[4:5], v4
    s_mov_b64 exec, -1
    s_waitcnt vmcnt(6)
    v_perm_b32 v51, v9, v6, s31
    v_perm_b32 v52, v9, v7, s32
    v_perm_b32 v53, v9, v8, s33
    v_lshlrev_b16 v10, 3, v8
    v_lshlrev_b16 v8, 3, v7
    v_lshlrev_b16 v6, 3, v6
    v_cmpx_ge_u16 vcc, 0x3fff, v51
    ds_read_b64 v[6:7], v6
    s_mov_b64 exec, -1
    v_cmpx_ge_u16 vcc, 0x3fff, v52
    ds_read_b64 v[8:9], v8
    s_mov_b64 exec, -1
    v_cmpx_ge_u16 vcc, 0x3fff, v53
    ds_read_b64 v[10:11], v10
    s_mov_b64 exec, -1
    s_waitcnt vmcnt(5)
    v_perm_b32 v54, v15, v12, s31
    v_perm_b32 v55, v15, v13, s32
    v_perm_b32 v56, v15, v14, s33
    v_lshlrev_b16 v16, 3, v14
    v_lshlrev_b16 v14, 3, v13
    v_lshlrev_b16 v12, 3, v12
    v_cmpx_ge_u16 vcc, 0x3fff, v54
    ds_read_b64 v[12:13], v12
    s_mov_b64 exec, -1
    v_cmpx_ge_u16 vcc, 0x3fff, v55
    ds_read_b64 v[14:15], v14
    s_mov_b64 exec, -1
    v_cmpx_ge_u16 vcc, 0x3fff, v56
    ds_read_b64 v[16:17], v16
    s_mov_b64 exec, -1
    s_waitcnt vmcnt(4)
    v_perm_b32 v57, v21, v18, s31
    v_perm_b32 v58, v21, v19, s32
    v_perm_b32 v59, v21, v20, s33
    v_lshlrev_b16 v22, 3, v20
    v_lshlrev_b16 v20, 3, v19
    v_lshlrev_b16 v18, 3, v18
    s_cmp_lt_u32 s16, 8
    s_cbranch_scc1 p2_gp
    v_cmpx_ge_u16 vcc, 0x3fff, v57
    ds_read_b64 v[18:19], v18
    s_mov_b64 exec, -1
    v_cmpx_ge_u16 vcc, 0x3fff, v58
    ds_read_b64 v[20:21], v20
    s_mov_b64 exec, -1
    v_cmpx_ge_u16 vcc, 0x3fff, v59
    ds_read_b64 v[22:23], v22
    s_mov_b64 exec, -1
p2_gp:
    s_waitcnt vmcnt(3)
    v_perm_b32 v60, v89, v86, s31
    v_perm_b32 v61, v89, v87, s32
    v_perm_b32 v62, v89, v88, s33
    v_lshlrev_b16 v28, 3, v88
    v_lshlrev_b16 v26, 3, v87
    v_lshlrev_b16 v24, 3, v86
    v_cmpx_ge_u16 vcc, 0x3fff, v60
    ds_read_b64 v[24:25], v24
    s_mov_b64 exec, -1
    v_cmpx_ge_u16 vcc, 0x3fff, v61
    ds_read_b64 v[26:27], v26
    s_mov_b64 exec, -1
    v_cmpx_ge_u16 vcc, 0x3fff, v62
    ds_read_b64 v[28:29], v28
    s_mov_b64 exec, -1
    v_bfe_u32 v86, v106, 14, 4
    v_lshrrev_b32 v87, 18, v106
    v_and_b32 v106, 0x3fff, v106
    v_mad_u32_u24 v86, v86, s63, v87
    v_lshl_or_b32 v106, v86, 14, v106
    buffer_load_dwordx4 v[86:89], v106, s[68:71], 0 offen
    s_cmp_ge_u32 s10, 9
    s_cbranch_scc1 p2_nmq
    v_lshrrev_b32 v84, 1, v112
    s_add_u32 s44, s20, s42
    buffer_load_dwordx2 v[84:85], v84, s[4:7], s44 offen
p2_nmq:
    buffer_load_dwordx4 v[72:75], v112, s[4:7], s20 offen offset:0
    buffer_load_dwordx4 v[76:79], v112, s[4:7], s20 offen offset:1024
    buffer_load_dwordx4 v[80:83], v112, s[4:7], s20 offen offset:2048
    s_waitcnt vmcnt(6)
    v_perm_b32 v63, v93, v90, s31
    v_perm_b32 v64, v93, v91, s32
    v_perm_b32 v65, v93, v92, s33
    v_lshlrev_b16 v34, 3, v92
    v_lshlrev_b16 v32, 3, v91
    v_lshlrev_b16 v30, 3, v90
    v_cmpx_ge_u16 vcc, 0x3fff, v63
    ds_read_b64 v[30:31], v30
    s_mov_b64 exec, -1
    v_cmpx_ge_u16 vcc, 0x3fff, v64
    ds_read_b64 v[32:33], v32
    s_mov_b64 exec, -1
    v_cmpx_ge_u16 vcc, 0x3fff, v65
    ds_read_b64 v[34:35], v34
    s_mov_b64 exec, -1
    v_bfe_u32 v90, v107, 14, 4
    v_lshrrev_b32 v91, 18, v107
    v_and_b32 v107, 0x3fff, v107
    v_mad_u32_u24 v90, v90, s63, v91
    v_lshl_or_b32 v107, v90, 14, v107
    buffer_load_dwordx4 v[90:93], v107, s[68:71], 0 offen
    s_waitcnt vmcnt(6)
    v_perm_b32 v66, v97, v94, s31
    v_perm_b32 v67, v97, v95, s32
    v_perm_b32 v68, v97, v96, s33
    v_lshlrev_b16 v40, 3, v96
    v_lshlrev_b16 v38, 3, v95
    v_lshlrev_b16 v36, 3, v94
    v_cmpx_ge_u16 vcc, 0x3fff, v66
    ds_read_b64 v[36:37], v36
    s_mov_b64 exec, -1
    v_cmpx_ge_u16 vcc, 0x3fff, v67
    ds_read_b64 v[38:39], v38
    s_mov_b64 exec, -1
    v_cmpx_ge_u16 vcc, 0x3fff, v68
    ds_read_b64 v[40:41], v40
    s_mov_b64 exec, -1
    v_bfe_u32 v94, v108, 14, 4
    v_lshrrev_b32 v95, 18, v108
    v_and_b32 v108, 0x3fff, v108
    v_mad_u32_u24 v94, v94, s63, v95
    v_lshl_or_b32 v108, v94, 14, v108
    buffer_load_dwordx4 v[94:97], v108, s[68:71], 0 offen
    s_waitcnt vmcnt(6)
    v_perm_b32 v69, v101, v98, s31
    v_perm_b32 v70, v101, v99, s32
    v_perm_b32 v71, v101, v100, s33
    v_lshlrev_b16 v46, 3, v100
    v_lshlrev_b16 v44, 3, v99
    v_lshlrev_b16 v42, 3, v98
    v_cmpx_ge_u16 vcc, 0x3fff, v69
    ds_read_b64 v[42:43], v42
    s_mov_b64 exec, -1
    v_cmpx_ge_u16 vcc, 0x3fff, v70
    ds_read_b64 v[44:45], v44
    s_mov_b64 exec, -1
    v_cmpx_ge_u16 vcc, 0x3fff, v71
    ds_read_b64 v[46:47], v46
    s_mov_b64 exec, -1
    s_waitcnt lgkmcnt(0)
    s_barrier
    s_branch p2_tail
p2_top:
    s_cmp_lg_u32 s21, 0
    s_cbranch_scc1 p2_topf
    s_cmp_eq_u32 s60, 10
    s_cbranch_scc1 p2_drain0
    s_setprio 3
    v_cmpx_gt_i16 vcc, 0, v48
    ds_read_b64 v[0:1], v0
    s_mov_b64 exec, -1
    v_cmpx_gt_i16 vcc, 0, v49
    ds_read_b64 v[2:3], v2
    s_mov_b64 exec, -1
    v_cmpx_gt_i16 vcc, 0, v50
    ds_read_b64 v[4:5], v4
    s_mov_b64 exec, -1
    v_cmpx_gt_i16 vcc, 0, v51
    ds_read_b64 v[6:7], v6
    s_mov_b64 exec, -1
    v_cmpx_gt_i16 vcc, 0, v52
    ds_read_b64 v[8:9], v8
    s_mov_b64 exec, -1
    v_cmpx_gt_i16 vcc, 0, v53
    ds_read_b64 v[10:11], v10
    s_mov_b64 exec, -1
    v_cmpx_gt_i16 vcc, 0, v54
    ds_read_b64 v[12:13], v12
    s_mov_b64 exec, -1
    v_cmpx_gt_i16 vcc, 0, v55
    ds_read_b64 v[14:15], v14
    s_mov_b64 exec, -1
    v_cmpx_gt_i16 vcc, 0, v56
    ds_read_b64 v[16:17], v16
    s_mov_b64 exec, -1
    s_cmp_lt_u32 s15, 8
    s_cbranch_scc1 p2_g0r23
    v_cmpx_gt_i16 vcc, 0, v57
    ds_read_b64 v[18:19], v18
    s_mov_b64 exec, -1
    v_cmpx_gt_i16 vcc, 0, v58
    ds_read_b64 v[20:21], v20
    s_mov_b64 exec, -1
    v_cmpx_gt_i16 vcc, 0, v59
    ds_read_b64 v[22:23], v22
    s_mov_b64 exec, -1
p2_g0r23:
    s_cmp_ge_u32 s10, 9
    s_cbranch_scc1 p2_nm0m0a
    v_lshrrev_b32 v84, 1, v112
    s_add_u32 s44, s20, s42
    buffer_load_dwordx2 v[84:85], v84, s[4:7], s44 offen
p2_nm0m0a:
    buffer_load_dwordx4 v[72:75], v112, s[4:7], s20 offen offset:0
    buffer_load_dwordx4 v[76:79], v112, s[4:7], s20 offen offset:1024
    buffer_load_dwordx4 v[80:83], v112, s[4:7], s20 offen offset:2048
    v_cmpx_gt_i16 vcc, 0, v60
    ds_read_b64 v[24:25], v24
    s_mov_b64 exec, -1
    v_cmpx_gt_i16 vcc, 0, v61
    ds_read_b64 v[26:27], v26
    s_mov_b64 exec, -1
    v_cmpx_gt_i16 vcc, 0, v62
    ds_read_b64 v[28:29], v28
    s_mov_b64 exec, -1
    v_cmpx_gt_i16 vcc, 0, v63
    ds_read_b64 v[30:31], v30
    s_mov_b64 exec, -1
    v_cmpx_gt_i16 vcc, 0, v64
    ds_read_b64 v[32:33], v32
    s_mov_b64 exec, -1
    v_cmpx_gt_i16 vcc, 0, v65
    ds_read_b64 v[34:35], v34
    s_mov_b64 exec, -1
    v_cmpx_gt_i16 vcc, 0, v66
    ds_read_b64 v[36:37], v36
    s_mov_b64 exec, -1
    v_cmpx_gt_i16 vcc, 0, v67
    ds_read_b64 v[38:39], v38
    s_mov_b64 exec, -1
    v_cmpx_gt_i16 vcc, 0, v68
    ds_read_b64 v[40:41], v40
    s_mov_b64 exec, -1
    v_cmpx_gt_i16 vcc, 0, v69
    ds_read_b64 v[42:43], v42
    s_mov_b64 exec, -1
    v_cmpx_gt_i16 vcc, 0, v70
    ds_read_b64 v[44:45], v44
    s_mov_b64 exec, -1
    v_cmpx_gt_i16 vcc, 0, v71
    ds_read_b64 v[46:47], v46
    s_mov_b64 exec, -1
    s_setprio 2
    s_waitcnt lgkmcnt(15)
    v_ashrrev_i32 v122, 5, v48
    v_lshlrev_b16 v123, 2, v48
    v_lshlrev_b32 v124, 16, v0
    v_bitop3_b32 v122, v122, v113, v113 bitop3:0x0c
    v_and_b32 v125, 0xffff0000, v0
    v_lshlrev_b32 v126, 16, v1
    v_mul_f32 v122, v114, v122
    v_and_b32 v127, 0xffff0000, v1
    v_add_u32 v123, v123, v123
    v_pk_fma_f32 v[124:125], v[124:125], v[122:123], s[34:35] op_sel_hi:[1,0,1]
    v_pk_fma_f32 v[126:127], v[126:127], v[122:123], s[34:35] op_sel_hi:[1,0,1]
    v_lshl_add_u32 v124, v125, 16, v124
    v_lshl_add_u32 v125, v127, 16, v126
    s_waitcnt lgkmcnt(15)
    v_bitop3_b32 v115, v115, v116, v117 bitop3:0xfe
    v_lshl_add_u64 v[124:125], v[124:125], 0, s[36:37]
    v_cmpx_le_u32 vcc, 0x1000000, v48
    ds_add_rtn_u64 v[116:117], v123, v[124:125] offset:54272
    s_mov_b64 exec, -1
    v_ashrrev_i32 v122, 5, v49
    v_lshlrev_b16 v123, 2, v49
    v_lshlrev_b32 v124, 16, v2
    v_bitop3_b32 v122, v122, v113, v113 bitop3:0x0c
    v_and_b32 v125, 0xffff0000, v2
    v_lshlrev_b32 v126, 16, v3
    v_mul_f32 v122, v114, v122
    v_and_b32 v127, 0xffff0000, v3
    v_add_u32 v123, v123, v123
    v_pk_fma_f32 v[124:125], v[124:125], v[122:123], s[34:35] op_sel_hi:[1,0,1]
    v_pk_fma_f32 v[126:127], v[126:127], v[122:123], s[34:35] op_sel_hi:[1,0,1]
    v_lshl_add_u32 v124, v125, 16, v124
    v_lshl_add_u32 v125, v127, 16, v126
    s_waitcnt lgkmcnt(15)
    v_bitop3_b32 v115, v115, v118, v119 bitop3:0xfe
    v_lshl_add_u64 v[124:125], v[124:125], 0, s[36:37]
    v_cmpx_le_u32 vcc, 0x1000000, v49
    ds_add_rtn_u64 v[118:119], v123, v[124:125] offset:54272
    s_mov_b64 exec, -1
    v_ashrrev_i32 v122, 5, v50
    v_lshlrev_b16 v123, 2, v50
    v_lshlrev_b32 v124, 16, v4
    v_bitop3_b32 v122, v122, v113, v113 bitop3:0x0c
    v_and_b32 v125, 0xffff0000, v4
    v_lshlrev_b32 v126, 16, v5
    v_mul_f32 v122, v114, v122
    v_and_b32 v127, 0xffff0000, v5
    v_add_u32 v123, v123, v123
    v_pk_fma_f32 v[124:125], v[124:125], v[122:123], s[34:35] op_sel_hi:[1,0,1]
    v_pk_fma_f32 v[126:127], v[126:127], v[122:123], s[34:35] op_sel_hi:[1,0,1]
    v_lshl_add_u32 v124, v125, 16, v124
    v_lshl_add_u32 v125, v127, 16, v126
    s_waitcnt lgkmcnt(15)
    v_bitop3_b32 v115, v115, v120, v121 bitop3:0xfe
    v_lshl_add_u64 v[124:125], v[124:125], 0, s[36:37]
    v_cmpx_le_u32 vcc, 0x1000000, v50
    ds_add_rtn_u64 v[120:121], v123, v[124:125] offset:54272
    s_mov_b64 exec, -1
    v_bfe_u32 v0, v102, 14, 4
    v_lshrrev_b32 v1, 18, v102
    v_and_b32 v102, 0x3fff, v102
    v_mad_u32_u24 v0, v0, s63, v1
    v_lshl_or_b32 v102, v0, 14, v102
    buffer_load_dwordx4 v[0:3], v102, s[68:71], 0 offen
    s_setprio 1
    s_waitcnt lgkmcnt(15)
    v_ashrrev_i32 v122, 5, v51
    v_lshlrev_b16 v123, 2, v51
    v_lshlrev_b32 v124, 16, v6
    v_bitop3_b32 v122, v122, v113, v113 bitop3:0x0c
    v_and_b32 v125, 0xffff0000, v6
    v_lshlrev_b32 v126, 16, v7
    v_mul_f32 v122, v114, v122
    v_and_b32 v127, 0xffff0000, v7
    v_add_u32 v123, v123, v123
    v_pk_fma_f32 v[124:125], v[124:125], v[122:123], s[34:35] op_sel_hi:[1,0,1]
    v_pk_fma_f32 v[126:127], v[126:127], v[122:123], s[34:35] op_sel_hi:[1,0,1]
    v_lshl_add_u32 v124, v125, 16, v124
    v_lshl_add_u32 v125, v127, 16, v126
    s_waitcnt lgkmcnt(2)
    v_bitop3_b32 v115, v115, v116, v117 bitop3:0xfe
    v_lshl_add_u64 v[124:125], v[124:125], 0, s[36:37]
    v_cmpx_le_u32 vcc, 0x1000000, v51
    ds_add_rtn_u64 v[116:117], v123, v[124:125] offset:54272
    s_mov_b64 exec, -1
    v_ashrrev_i32 v122, 5, v52
    v_lshlrev_b16 v123, 2, v52
    v_lshlrev_b32 v124, 16, v8
    v_bitop3_b32 v122, v122, v113, v113 bitop3:0x0c
    v_and_b32 v125, 0xffff0000, v8
    v_lshlrev_b32 v126, 16, v9
    v_mul_f32 v122, v114, v122
    v_and_b32 v127, 0xffff0000, v9
    v_add_u32 v123, v123, v123
    v_pk_fma_f32 v[124:125], v[124:125], v[122:123], s[34:35] op_sel_hi:[1,0,1]
    v_pk_fma_f32 v[126:127], v[126:127], v[122:123], s[34:35] op_sel_hi:[1,0,1]
    v_lshl_add_u32 v124, v125, 16, v124
    v_lshl_add_u32 v125, v127, 16, v126
    s_waitcnt lgkmcnt(2)
    v_bitop3_b32 v115, v115, v118, v119 bitop3:0xfe
    v_lshl_add_u64 v[124:125], v[124:125], 0, s[36:37]
    v_cmpx_le_u32 vcc, 0x1000000, v52
    ds_add_rtn_u64 v[118:119], v123, v[124:125] offset:54272
    s_mov_b64 exec, -1
    v_ashrrev_i32 v122, 5, v53
    v_lshlrev_b16 v123, 2, v53
    v_lshlrev_b32 v124, 16, v10
    v_bitop3_b32 v122, v122, v113, v113 bitop3:0x0c
    v_and_b32 v125, 0xffff0000, v10
    v_lshlrev_b32 v126, 16, v11
    v_mul_f32 v122, v114, v122
    v_and_b32 v127, 0xffff0000, v11
    v_add_u32 v123, v123, v123
    v_pk_fma_f32 v[124:125], v[124:125], v[122:123], s[34:35] op_sel_hi:[1,0,1]
    v_pk_fma_f32 v[126:127], v[126:127], v[122:123], s[34:35] op_sel_hi:[1,0,1]
    v_lshl_add_u32 v124, v125, 16, v124
    v_lshl_add_u32 v125, v127, 16, v126
    s_waitcnt lgkmcnt(2)
    v_bitop3_b32 v115, v115, v120, v121 bitop3:0xfe
    v_lshl_add_u64 v[124:125], v[124:125], 0, s[36:37]
    v_cmpx_le_u32 vcc, 0x1000000, v53
    ds_add_rtn_u64 v[120:121], v123, v[124:125] offset:54272
    s_mov_b64 exec, -1
    v_bfe_u32 v6, v103, 14, 4
    v_lshrrev_b32 v7, 18, v103
    v_and_b32 v103, 0x3fff, v103
    v_mad_u32_u24 v6, v6, s63, v7
    v_lshl_or_b32 v103, v6, 14, v103
    buffer_load_dwordx4 v[6:9], v103, s[68:71], 0 offen
    s_waitcnt lgkmcnt(6)
    s_barrier
    s_setprio 3
    s_waitcnt vmcnt(5)
    s_mov_b32 m0, s23
    v_mov_b32 v53, 0
    s_movk_i32 s44, 512
    v_sub_u32_sdwa v4, v111, v110 dst_sel:DWORD dst_unused:UNUSED_PAD src0_sel:WORD_0 src1_sel:WORD_0
    v_sub_u32_sdwa v5, v111, v110 dst_sel:DWORD dst_unused:UNUSED_PAD src0_sel:WORD_1 src1_sel:WORD_1
    v_med3_i32 v4, v4, 0, s44
    v_med3_i32 v5, v5, 0, s44
    v_add_u32 v48, v4, v5
    ds_write_addtid_b32 v53 offset:0
    ds_write_addtid_b32 v53 offset:256
    ds_write_addtid_b32 v53 offset:512
    ds_write_addtid_b32 v53 offset:768
    ds_write_addtid_b32 v53 offset:1024
    ds_write_addtid_b32 v53 offset:1280
    ds_write_addtid_b32 v53 offset:1536
    ds_write_addtid_b32 v53 offset:1792
    v_bfe_i32 v53, v112, 6, 1
    v_lshrrev_b32 v49, 6, v112
    v_bitop3_b32 v53, v53, 15, s10 bitop3:0x6a
    v_lshl_or_b32 v49, v49, 4, v53
    v_and_b32 v53, 0x30, v112
    v_lshl_or_b32 v53, v49, 6, v53
    v_lshlrev_b32 v53, 15, v53
    s_nop 1
    v_add_u32_dpp v48, v48, v48 row_shr:1 row_mask:0xf bank_mask:0xf bound_ctrl:0
    s_nop 1
    v_add_u32_dpp v48, v48, v48 row_shr:2 row_mask:0xf bank_mask:0xf bound_ctrl:0
    s_nop 1
    v_add_u32_dpp v48, v48, v48 row_shr:4 row_mask:0xf bank_mask:0xf bound_ctrl:0
    s_nop 1
    v_add_u32_dpp v48, v48, v48 row_shr:8 row_mask:0xf bank_mask:0xf bound_ctrl:0
    s_nop 1
    v_add_u32_dpp v48, v48, v48 row_bcast:15 row_mask:0xa bank_mask:0xf
    s_nop 1
    v_add_u32_dpp v48, v48, v48 row_bcast:31 row_mask:0xc bank_mask:0xf
    s_nop 1
    s_nop 0
    v_readlane_b32 s38, v48, 63
    v_sub_u32 v50, v48, v5
    v_sub_u32 v49, v50, v4
    v_writelane_b32 v5, 1, 63
    v_sub_u32 v10, 512, v49
    v_mad_u32_u16 v51, v110, 16, v53
    v_lshl_add_u32 v51, v10, 4, v51
    v_med3_i32 v10, v10, 0, v4
    v_lshl_add_u32 v49, v49, 2, s23
    v_sub_u32 v11, 512, v50
    v_mad_u32_u16 v52, v110, 16, v53 op_sel:[1,0,0,0]
    v_add_u32 v52, 262144, v52
    s_mov_b32 s44, 0x1fffc000
    v_writelane_b32 v52, s44, 63
    v_lshl_add_u32 v52, v11, 4, v52
    v_med3_i32 v11, v11, 0, v5
    v_lshl_add_u32 v50, v50, 2, s23
    v_lshl_add_u32 v48, v11, 16, v10
    v_add_u32 v110, v110, v48
    s_min_u32 s17, s38, 512
    s_add_u32 s17, s17, 63
    s_lshr_b32 s17, s17, 6
    v_cmpx_lt_i32 vcc, 0, v10
    ds_write_b32 v49, v51
    s_mov_b64 exec, -1
    v_cmpx_lt_i32 vcc, 0, v11
    ds_write_b32 v50, v52
    s_mov_b64 exec, -1
    s_cmp_lt_u32 s38, 512
    s_cbranch_scc1 p2_nomore0x
    v_cmp_lt_u32_sdwa s[44:45], v110, v111 src0_sel:WORD_0 src1_sel:WORD_0
    v_cmp_lt_u32_sdwa s[46:47], v110, v111 src0_sel:WORD_1 src1_sel:WORD_1
    s_nop 0
    s_or_b64 s[44:45], s[44:45], s[46:47]
    s_cbranch_scc0 p2_nomore0x
    v_mov_b32 v49, s19
    v_mov_b32 v50, 1
    ds_write_b32 v49, v50 offset:53760
p2_nomore0x:
    s_setprio 2
    s_waitcnt lgkmcnt(15)
    v_ashrrev_i32 v122, 5, v54
    v_lshlrev_b16 v123, 2, v54
    v_lshlrev_b32 v124, 16, v12
    v_bitop3_b32 v122, v122, v113, v113 bitop3:0x0c
    v_and_b32 v125, 0xffff0000, v12
    v_lshlrev_b32 v126, 16, v13
    v_mul_f32 v122, v114, v122
    v_and_b32 v127, 0xffff0000, v13
    v_add_u32 v123, v123, v123
    v_pk_fma_f32 v[124:125], v[124:125], v[122:123], s[34:35] op_sel_hi:[1,0,1]
    v_pk_fma_f32 v[126:127], v[126:127], v[122:123], s[34:35] op_sel_hi:[1,0,1]
    v_lshl_add_u32 v124, v125, 16, v124
    v_lshl_add_u32 v125, v127, 16, v126
    s_waitcnt lgkmcnt(12)
    v_bitop3_b32 v115, v115, v116, v117 bitop3:0xfe
    v_lshl_add_u64 v[124:125], v[124:125], 0, s[36:37]
    v_cmpx_le_u32 vcc, 0x1000000, v54
    ds_add_rtn_u64 v[116:117], v123, v[124:125] offset:54272
    s_mov_b64 exec, -1
    v_ashrrev_i32 v122, 5, v55
    v_lshlrev_b16 v123, 2, v55
    v_lshlrev_b32 v124, 16, v14
    v_bitop3_b32 v122, v122, v113, v113 bitop3:0x0c
    v_and_b32 v125, 0xffff0000, v14
    v_lshlrev_b32 v126, 16, v15
    v_mul_f32 v122, v114, v122
    v_and_b32 v127, 0xffff0000, v15
    v_add_u32 v123, v123, v123
    v_pk_fma_f32 v[124:125], v[124:125], v[122:123], s[34:35] op_sel_hi:[1,0,1]
    v_pk_fma_f32 v[126:127], v[126:127], v[122:123], s[34:35] op_sel_hi:[1,0,1]
    v_lshl_add_u32 v124, v125, 16, v124
    v_lshl_add_u32 v125, v127, 16, v126
    s_waitcnt lgkmcnt(12)
    v_bitop3_b32 v115, v115, v118, v119 bitop3:0xfe
    v_lshl_add_u64 v[124:125], v[124:125], 0, s[36:37]
    v_cmpx_le_u32 vcc, 0x1000000, v55
    ds_add_rtn_u64 v[118:119], v123, v[124:125] offset:54272
    s_mov_b64 exec, -1
    v_ashrrev_i32 v122, 5, v56
    v_lshlrev_b16 v123, 2, v56
    v_lshlrev_b32 v124, 16, v16
    v_bitop3_b32 v122, v122, v113, v113 bitop3:0x0c
    v_and_b32 v125, 0xffff0000, v16
    v_lshlrev_b32 v126, 16, v17
    v_mul_f32 v122, v114, v122
    v_and_b32 v127, 0xffff0000, v17
    v_add_u32 v123, v123, v123
    v_pk_fma_f32 v[124:125], v[124:125], v[122:123], s[34:35] op_sel_hi:[1,0,1]
    v_pk_fma_f32 v[126:127], v[126:127], v[122:123], s[34:35] op_sel_hi:[1,0,1]
    v_lshl_add_u32 v124, v125, 16, v124
    v_lshl_add_u32 v125, v127, 16, v126
    s_waitcnt lgkmcnt(12)
    v_bitop3_b32 v115, v115, v120, v121 bitop3:0xfe
    v_lshl_add_u64 v[124:125], v[124:125], 0, s[36:37]
    v_cmpx_le_u32 vcc, 0x1000000, v56
    ds_add_rtn_u64 v[120:121], v123, v[124:125] offset:54272
    s_mov_b64 exec, -1
    v_bfe_u32 v12, v104, 14, 4
    v_lshrrev_b32 v13, 18, v104
    v_and_b32 v104, 0x3fff, v104
    v_mad_u32_u24 v12, v12, s63, v13
    v_lshl_or_b32 v104, v12, 14, v104
    buffer_load_dwordx4 v[12:15], v104, s[68:71], 0 offen
    s_cmp_lt_u32 s15, 8
    s_cbranch_scc1 p2_na0a3
    s_waitcnt lgkmcnt(15)
    v_ashrrev_i32 v122, 5, v57
    v_lshlrev_b16 v123, 2, v57
    v_lshlrev_b32 v124, 16, v18
    v_bitop3_b32 v122, v122, v113, v113 bitop3:0x0c
    v_and_b32 v125, 0xffff0000, v18
    v_lshlrev_b32 v126, 16, v19
    v_mul_f32 v122, v114, v122
    v_and_b32 v127, 0xffff0000, v19
    v_add_u32 v123, v123, v123
    v_pk_fma_f32 v[124:125], v[124:125], v[122:123], s[34:35] op_sel_hi:[1,0,1]
    v_pk_fma_f32 v[126:127], v[126:127], v[122:123], s[34:35] op_sel_hi:[1,0,1]
    v_lshl_add_u32 v124, v125, 16, v124
    v_lshl_add_u32 v125, v127, 16, v126
    s_waitcnt lgkmcnt(2)
    v_bitop3_b32 v115, v115, v116, v117 bitop3:0xfe
    v_lshl_add_u64 v[124:125], v[124:125], 0, s[36:37]
    v_cmpx_le_u32 vcc, 0x1000000, v57
    ds_add_rtn_u64 v[116:117], v123, v[124:125] offset:54272
    s_mov_b64 exec, -1
    v_ashrrev_i32 v122, 5, v58
    v_lshlrev_b16 v123, 2, v58
    v_lshlrev_b32 v124, 16, v20
    v_bitop3_b32 v122, v122, v113, v113 bitop3:0x0c
    v_and_b32 v125, 0xffff0000, v20
    v_lshlrev_b32 v126, 16, v21
    v_mul_f32 v122, v114, v122
    v_and_b32 v127, 0xffff0000, v21
    v_add_u32 v123, v123, v123
    v_pk_fma_f32 v[124:125], v[124:125], v[122:123], s[34:35] op_sel_hi:[1,0,1]
    v_pk_fma_f32 v[126:127], v[126:127], v[122:123], s[34:35] op_sel_hi:[1,0,1]
    v_lshl_add_u32 v124, v125, 16, v124
    v_lshl_add_u32 v125, v127, 16, v126
    s_waitcnt lgkmcnt(2)
    v_bitop3_b32 v115, v115, v118, v119 bitop3:0xfe
    v_lshl_add_u64 v[124:125], v[124:125], 0, s[36:37]
    v_cmpx_le_u32 vcc, 0x1000000, v58
    ds_add_rtn_u64 v[118:119], v123, v[124:125] offset:54272
    s_mov_b64 exec, -1
    v_ashrrev_i32 v122, 5, v59
    v_lshlrev_b16 v123, 2, v59
    v_lshlrev_b32 v124, 16, v22
    v_bitop3_b32 v122, v122, v113, v113 bitop3:0x0c
    v_and_b32 v125, 0xffff0000, v22
    v_lshlrev_b32 v126, 16, v23
    v_mul_f32 v122, v114, v122
    v_and_b32 v127, 0xffff0000, v23
    v_add_u32 v123, v123, v123
    v_pk_fma_f32 v[124:125], v[124:125], v[122:123], s[34:35] op_sel_hi:[1,0,1]
    v_pk_fma_f32 v[126:127], v[126:127], v[122:123], s[34:35] op_sel_hi:[1,0,1]
    v_lshl_add_u32 v124, v125, 16, v124
    v_lshl_add_u32 v125, v127, 16, v126
    s_waitcnt lgkmcnt(2)
    v_bitop3_b32 v115, v115, v120, v121 bitop3:0xfe
    v_lshl_add_u64 v[124:125], v[124:125], 0, s[36:37]
    v_cmpx_le_u32 vcc, 0x1000000, v59
    ds_add_rtn_u64 v[120:121], v123, v[124:125] offset:54272
    s_mov_b64 exec, -1
p2_na0a3:
    v_bfe_u32 v18, v105, 14, 4
    v_lshrrev_b32 v19, 18, v105
    v_and_b32 v105, 0x3fff, v105
    v_mad_u32_u24 v18, v18, s63, v19
    v_lshl_or_b32 v105, v18, 14, v105
    buffer_load_dwordx4 v[18:21], v105, s[68:71], 0 offen
    s_mov_b32 m0, s23
    s_nop 0
    ds_read_addtid_b32 v102 offset:1024
    ds_read_addtid_b32 v103 offset:1280
    ds_read_addtid_b32 v104 offset:1536
    ds_read_addtid_b32 v105 offset:1792
    ds_read_addtid_b32 v106 offset:0
    ds_read_addtid_b32 v107 offset:256
    ds_read_addtid_b32 v108 offset:512
    ds_read_addtid_b32 v109 offset:768
    s_waitcnt vmcnt(4)
    s_mov_b32 m0, s24
    s_cmp_ge_u32 s10, 9
    s_cbranch_scc1 p2_st0s0
    ds_write_addtid_b32 v84 offset:49152
    ds_write_addtid_b32 v85 offset:49408
p2_st0s0:
    s_mov_b32 m0, s23
    s_add_u32 s20, s20, 53760
    ds_write_addtid_b32 v72 offset:0
    ds_write_addtid_b32 v73 offset:256
    ds_write_addtid_b32 v74 offset:512
    ds_write_addtid_b32 v75 offset:768
    ds_write_addtid_b32 v76 offset:1024
    ds_write_addtid_b32 v77 offset:1280
    ds_write_addtid_b32 v78 offset:1536
    ds_write_addtid_b32 v79 offset:1792
    ds_write_addtid_b32 v80 offset:2048
    ds_write_addtid_b32 v81 offset:2304
    ds_write_addtid_b32 v82 offset:2560
    ds_write_addtid_b32 v83 offset:2816
    s_setprio 1
    s_waitcnt lgkmcnt(15)
    v_ashrrev_i32 v122, 5, v60
    v_lshlrev_b16 v123, 2, v60
    v_lshlrev_b32 v124, 16, v24
    v_bitop3_b32 v122, v122, v113, v113 bitop3:0x0c
    v_and_b32 v125, 0xffff0000, v24
    v_lshlrev_b32 v126, 16, v25
    v_mul_f32 v122, v114, v122
    v_and_b32 v127, 0xffff0000, v25
    v_add_u32 v123, v123, v123
    v_pk_fma_f32 v[124:125], v[124:125], v[122:123], s[34:35] op_sel_hi:[1,0,1]
    v_pk_fma_f32 v[126:127], v[126:127], v[122:123], s[34:35] op_sel_hi:[1,0,1]
    v_lshl_add_u32 v124, v125, 16, v124
    v_lshl_add_u32 v125, v127, 16, v126
    s_waitcnt lgkmcnt(15)
    v_bitop3_b32 v115, v115, v116, v117 bitop3:0xfe
    v_lshl_add_u64 v[124:125], v[124:125], 0, s[36:37]
    v_cmpx_le_u32 vcc, 0x1000000, v60
    ds_add_rtn_u64 v[116:117], v123, v[124:125] offset:54272
    s_mov_b64 exec, -1
    v_ashrrev_i32 v122, 5, v61
    v_lshlrev_b16 v123, 2, v61
    v_lshlrev_b32 v124, 16, v26
    v_bitop3_b32 v122, v122, v113, v113 bitop3:0x0c
    v_and_b32 v125, 0xffff0000, v26
    v_lshlrev_b32 v126, 16, v27
    v_mul_f32 v122, v114, v122
    v_and_b32 v127, 0xffff0000, v27
    v_add_u32 v123, v123, v123
    v_pk_fma_f32 v[124:125], v[124:125], v[122:123], s[34:35] op_sel_hi:[1,0,1]
    v_pk_fma_f32 v[126:127], v[126:127], v[122:123], s[34:35] op_sel_hi:[1,0,1]
    v_lshl_add_u32 v124, v125, 16, v124
    v_lshl_add_u32 v125, v127, 16, v126
    s_waitcnt lgkmcnt(15)
    v_bitop3_b32 v115, v115, v118, v119 bitop3:0xfe
    v_lshl_add_u64 v[124:125], v[124:125], 0, s[36:37]
    v_cmpx_le_u32 vcc, 0x1000000, v61
    ds_add_rtn_u64 v[118:119], v123, v[124:125] offset:54272
    s_mov_b64 exec, -1
    v_ashrrev_i32 v122, 5, v62
    v_lshlrev_b16 v123, 2, v62
    v_lshlrev_b32 v124, 16, v28
    v_bitop3_b32 v122, v122, v113, v113 bitop3:0x0c
    v_and_b32 v125, 0xffff0000, v28
    v_lshlrev_b32 v126, 16, v29
    v_mul_f32 v122, v114, v122
    v_and_b32 v127, 0xffff0000, v29
    v_add_u32 v123, v123, v123
    v_pk_fma_f32 v[124:125], v[124:125], v[122:123], s[34:35] op_sel_hi:[1,0,1]
    v_pk_fma_f32 v[126:127], v[126:127], v[122:123], s[34:35] op_sel_hi:[1,0,1]
    v_lshl_add_u32 v124, v125, 16, v124
    v_lshl_add_u32 v125, v127, 16, v126
    s_waitcnt lgkmcnt(15)
    v_bitop3_b32 v115, v115, v120, v121 bitop3:0xfe
    v_lshl_add_u64 v[124:125], v[124:125], 0, s[36:37]
    v_cmpx_le_u32 vcc, 0x1000000, v62
    ds_add_rtn_u64 v[120:121], v123, v[124:125] offset:54272
    s_mov_b64 exec, -1
    s_waitcnt vmcnt(16)
    v_perm_b32 v60, v89, v86, s31
    v_perm_b32 v61, v89, v87, s32
    v_perm_b32 v62, v89, v88, s33
    v_lshlrev_b16 v28, 3, v88
    v_lshlrev_b16 v26, 3, v87
    v_lshlrev_b16 v24, 3, v86
    s_waitcnt lgkmcnt(15)
    s_nop 2
    s_nop 1
    v_max_u32_dpp v106, v106, v106 row_shr:1 row_mask:0xf bank_mask:0xf bound_ctrl:0
    v_max_u32_dpp v107, v107, v107 row_shr:1 row_mask:0xf bank_mask:0xf bound_ctrl:0
    s_nop 0
    v_max_u32_dpp v106, v106, v106 row_shr:2 row_mask:0xf bank_mask:0xf bound_ctrl:0
    v_max_u32_dpp v107, v107, v107 row_shr:2 row_mask:0xf bank_mask:0xf bound_ctrl:0
    s_nop 0
    v_max_u32_dpp v106, v106, v106 row_shr:4 row_mask:0xf bank_mask:0xf bound_ctrl:0
    v_max_u32_dpp v107, v107, v107 row_shr:4 row_mask:0xf bank_mask:0xf bound_ctrl:0
    s_nop 0
    v_max_u32_dpp v106, v106, v106 row_shr:8 row_mask:0xf bank_mask:0xf bound_ctrl:0
    v_max_u32_dpp v107, v107, v107 row_shr:8 row_mask:0xf bank_mask:0xf bound_ctrl:0
    s_nop 0
    v_max_u32_dpp v106, v106, v106 row_bcast:15 row_mask:0xa bank_mask:0xf
    v_max_u32_dpp v107, v107, v107 row_bcast:15 row_mask:0xa bank_mask:0xf
    s_nop 0
    v_max_u32_dpp v106, v106, v106 row_bcast:31 row_mask:0xc bank_mask:0xf
    v_max_u32_dpp v107, v107, v107 row_bcast:31 row_mask:0xc bank_mask:0xf
    s_nop 0
    s_nop 0
    v_readlane_b32 s41, v106, 63
    v_add_u32 v106, v106, v112
    v_add_u32 v106, 4294959104, v106
    v_max_u32 v107, s41, v107
    s_nop 0
    v_readlane_b32 s41, v107, 63
    v_add_u32 v107, v107, v112
    v_add_u32 v107, 4294960128, v107
    v_bfe_u32 v86, v106, 14, 4
    v_lshrrev_b32 v87, 18, v106
    v_and_b32 v106, 0x3fff, v106
    v_mad_u32_u24 v86, v86, s63, v87
    v_lshl_or_b32 v106, v86, 14, v106
    buffer_load_dwordx4 v[86:89], v106, s[68:71], 0 offen
    s_setprio 0
    s_waitcnt lgkmcnt(15)
    v_ashrrev_i32 v122, 5, v63
    v_lshlrev_b16 v123, 2, v63
    v_lshlrev_b32 v124, 16, v30
    v_bitop3_b32 v122, v122, v113, v113 bitop3:0x0c
    v_and_b32 v125, 0xffff0000, v30
    v_lshlrev_b32 v126, 16, v31
    v_mul_f32 v122, v114, v122
    v_and_b32 v127, 0xffff0000, v31
    v_add_u32 v123, v123, v123
    v_pk_fma_f32 v[124:125], v[124:125], v[122:123], s[34:35] op_sel_hi:[1,0,1]
    v_pk_fma_f32 v[126:127], v[126:127], v[122:123], s[34:35] op_sel_hi:[1,0,1]
    v_lshl_add_u32 v124, v125, 16, v124
    v_lshl_add_u32 v125, v127, 16, v126
    s_waitcnt lgkmcnt(2)
    v_bitop3_b32 v115, v115, v116, v117 bitop3:0xfe
    v_lshl_add_u64 v[124:125], v[124:125], 0, s[36:37]
    v_cmpx_le_u32 vcc, 0x1000000, v63
    ds_add_rtn_u64 v[116:117], v123, v[124:125] offset:54272
    s_mov_b64 exec, -1
    v_ashrrev_i32 v122, 5, v64
    v_lshlrev_b16 v123, 2, v64
    v_lshlrev_b32 v124, 16, v32
    v_bitop3_b32 v122, v122, v113, v113 bitop3:0x0c
    v_and_b32 v125, 0xffff0000, v32
    v_lshlrev_b32 v126, 16, v33
    v_mul_f32 v122, v114, v122
    v_and_b32 v127, 0xffff0000, v33
    v_add_u32 v123, v123, v123
    v_pk_fma_f32 v[124:125], v[124:125], v[122:123], s[34:35] op_sel_hi:[1,0,1]
    v_pk_fma_f32 v[126:127], v[126:127], v[122:123], s[34:35] op_sel_hi:[1,0,1]
    v_lshl_add_u32 v124, v125, 16, v124
    v_lshl_add_u32 v125, v127, 16, v126
    s_waitcnt lgkmcnt(2)
    v_bitop3_b32 v115, v115, v118, v119 bitop3:0xfe
    v_lshl_add_u64 v[124:125], v[124:125], 0, s[36:37]
    v_cmpx_le_u32 vcc, 0x1000000, v64
    ds_add_rtn_u64 v[118:119], v123, v[124:125] offset:54272
    s_mov_b64 exec, -1
    v_ashrrev_i32 v122, 5, v65
    v_lshlrev_b16 v123, 2, v65
    v_lshlrev_b32 v124, 16, v34
    v_bitop3_b32 v122, v122, v113, v113 bitop3:0x0c
    v_and_b32 v125, 0xffff0000, v34
    v_lshlrev_b32 v126, 16, v35
    v_mul_f32 v122, v114, v122
    v_and_b32 v127, 0xffff0000, v35
    v_add_u32 v123, v123, v123
    v_pk_fma_f32 v[124:125], v[124:125], v[122:123], s[34:35] op_sel_hi:[1,0,1]
    v_pk_fma_f32 v[126:127], v[126:127], v[122:123], s[34:35] op_sel_hi:[1,0,1]
    v_lshl_add_u32 v124, v125, 16, v124
    v_lshl_add_u32 v125, v127, 16, v126
    s_waitcnt lgkmcnt(2)
    v_bitop3_b32 v115, v115, v120, v121 bitop3:0xfe
    v_lshl_add_u64 v[124:125], v[124:125], 0, s[36:37]
    v_cmpx_le_u32 vcc, 0x1000000, v65
    ds_add_rtn_u64 v[120:121], v123, v[124:125] offset:54272
    s_mov_b64 exec, -1
    s_waitcnt vmcnt(13)
    v_perm_b32 v63, v93, v90, s31
    v_perm_b32 v64, v93, v91, s32
    v_perm_b32 v65, v93, v92, s33
    v_lshlrev_b16 v34, 3, v92
    v_lshlrev_b16 v32, 3, v91
    v_lshlrev_b16 v30, 3, v90
    s_waitcnt lgkmcnt(6)
    s_barrier
    s_setprio 3
    s_cmp_ge_u32 s10, 9
    s_cbranch_scc1 p2_nm0m1a
    v_lshrrev_b32 v84, 1, v112
    s_add_u32 s44, s20, s42
    buffer_load_dwordx2 v[84:85], v84, s[4:7], s44 offen
p2_nm0m1a:
    buffer_load_dwordx4 v[72:75], v112, s[4:7], s20 offen offset:0
    buffer_load_dwordx4 v[76:79], v112, s[4:7], s20 offen offset:1024
    buffer_load_dwordx4 v[80:83], v112, s[4:7], s20 offen offset:2048
    v_cmpx_ge_u16 vcc, 0x3fff, v60
    ds_read_b64 v[24:25], v24
    s_mov_b64 exec, -1
    v_cmpx_ge_u16 vcc, 0x3fff, v61
    ds_read_b64 v[26:27], v26
    s_mov_b64 exec, -1
    v_cmpx_ge_u16 vcc, 0x3fff, v62
    ds_read_b64 v[28:29], v28
    s_mov_b64 exec, -1
    v_cmpx_ge_u16 vcc, 0x3fff, v63
    ds_read_b64 v[30:31], v30
    s_mov_b64 exec, -1
    v_cmpx_ge_u16 vcc, 0x3fff, v64
    ds_read_b64 v[32:33], v32
    s_mov_b64 exec, -1
    v_cmpx_ge_u16 vcc, 0x3fff, v65
    ds_read_b64 v[34:35], v34
    s_mov_b64 exec, -1
    s_setprio 2
    s_waitcnt lgkmcnt(15)
    v_ashrrev_i32 v122, 5, v66
    v_lshlrev_b16 v123, 2, v66
    v_lshlrev_b32 v124, 16, v36
    v_bitop3_b32 v122, v122, v113, v113 bitop3:0x0c
    v_and_b32 v125, 0xffff0000, v36
    v_lshlrev_b32 v126, 16, v37
    v_mul_f32 v122, v114, v122
    v_and_b32 v127, 0xffff0000, v37
    v_add_u32 v123, v123, v123
    v_pk_fma_f32 v[124:125], v[124:125], v[122:123], s[34:35] op_sel_hi:[1,0,1]
    v_pk_fma_f32 v[126:127], v[126:127], v[122:123], s[34:35] op_sel_hi:[1,0,1]
    v_lshl_add_u32 v124, v125, 16, v124
    v_lshl_add_u32 v125, v127, 16, v126
    s_waitcnt lgkmcnt(8)
    v_bitop3_b32 v115, v115, v116, v117 bitop3:0xfe
    v_lshl_add_u64 v[124:125], v[124:125], 0, s[36:37]
    v_cmpx_le_u32 vcc, 0x1000000, v66
    ds_add_rtn_u64 v[116:117], v123, v[124:125] offset:54272
    s_mov_b64 exec, -1
    v_ashrrev_i32 v122, 5, v67
    v_lshlrev_b16 v123, 2, v67
    v_lshlrev_b32 v124, 16, v38
    v_bitop3_b32 v122, v122, v113, v113 bitop3:0x0c
    v_and_b32 v125, 0xffff0000, v38
    v_lshlrev_b32 v126, 16, v39
    v_mul_f32 v122, v114, v122
    v_and_b32 v127, 0xffff0000, v39
    v_add_u32 v123, v123, v123
    v_pk_fma_f32 v[124:125], v[124:125], v[122:123], s[34:35] op_sel_hi:[1,0,1]
    v_pk_fma_f32 v[126:127], v[126:127], v[122:123], s[34:35] op_sel_hi:[1,0,1]
    v_lshl_add_u32 v124, v125, 16, v124
    v_lshl_add_u32 v125, v127, 16, v126
    s_waitcnt lgkmcnt(8)
    v_bitop3_b32 v115, v115, v118, v119 bitop3:0xfe
    v_lshl_add_u64 v[124:125], v[124:125], 0, s[36:37]
    v_cmpx_le_u32 vcc, 0x1000000, v67
    ds_add_rtn_u64 v[118:119], v123, v[124:125] offset:54272
    s_mov_b64 exec, -1
    v_ashrrev_i32 v122, 5, v68
    v_lshlrev_b16 v123, 2, v68
    v_lshlrev_b32 v124, 16, v40
    v_bitop3_b32 v122, v122, v113, v113 bitop3:0x0c
    v_and_b32 v125, 0xffff0000, v40
    v_lshlrev_b32 v126, 16, v41
    v_mul_f32 v122, v114, v122
    v_and_b32 v127, 0xffff0000, v41
    v_add_u32 v123, v123, v123
    v_pk_fma_f32 v[124:125], v[124:125], v[122:123], s[34:35] op_sel_hi:[1,0,1]
    v_pk_fma_f32 v[126:127], v[126:127], v[122:123], s[34:35] op_sel_hi:[1,0,1]
    v_lshl_add_u32 v124, v125, 16, v124
    v_lshl_add_u32 v125, v127, 16, v126
    s_waitcnt lgkmcnt(8)
    v_bitop3_b32 v115, v115, v120, v121 bitop3:0xfe
    v_lshl_add_u64 v[124:125], v[124:125], 0, s[36:37]
    v_cmpx_le_u32 vcc, 0x1000000, v68
    ds_add_rtn_u64 v[120:121], v123, v[124:125] offset:54272
    s_mov_b64 exec, -1
    s_waitcnt vmcnt(15)
    v_perm_b32 v66, v97, v94, s31
    v_perm_b32 v67, v97, v95, s32
    v_perm_b32 v68, v97, v96, s33
    v_lshlrev_b16 v40, 3, v96
    v_lshlrev_b16 v38, 3, v95
    v_lshlrev_b16 v36, 3, v94
    v_cmpx_ge_u16 vcc, 0x3fff, v66
    ds_read_b64 v[36:37], v36
    s_mov_b64 exec, -1
    v_cmpx_ge_u16 vcc, 0x3fff, v67
    ds_read_b64 v[38:39], v38
    s_mov_b64 exec, -1
    v_cmpx_ge_u16 vcc, 0x3fff, v68
    ds_read_b64 v[40:41], v40
    s_mov_b64 exec, -1
    v_bfe_u32 v90, v107, 14, 4
    v_lshrrev_b32 v91, 18, v107
    v_and_b32 v107, 0x3fff, v107
    v_mad_u32_u24 v90, v90, s63, v91
    v_lshl_or_b32 v107, v90, 14, v107
    buffer_load_dwordx4 v[90:93], v107, s[68:71], 0 offen
    s_setprio 1
    s_waitcnt lgkmcnt(15)
    v_ashrrev_i32 v122, 5, v69
    v_lshlrev_b16 v123, 2, v69
    v_lshlrev_b32 v124, 16, v42
    v_bitop3_b32 v122, v122, v113, v113 bitop3:0x0c
    v_and_b32 v125, 0xffff0000, v42
    v_lshlrev_b32 v126, 16, v43
    v_mul_f32 v122, v114, v122
    v_and_b32 v127, 0xffff0000, v43
    v_add_u32 v123, v123, v123
    v_pk_fma_f32 v[124:125], v[124:125], v[122:123], s[34:35] op_sel_hi:[1,0,1]
    v_pk_fma_f32 v[126:127], v[126:127], v[122:123], s[34:35] op_sel_hi:[1,0,1]
    v_lshl_add_u32 v124, v125, 16, v124
    v_lshl_add_u32 v125, v127, 16, v126
    s_waitcnt lgkmcnt(5)
    v_bitop3_b32 v115, v115, v116, v117 bitop3:0xfe
    v_lshl_add_u64 v[124:125], v[124:125], 0, s[36:37]
    v_cmpx_le_u32 vcc, 0x1000000, v69
    ds_add_rtn_u64 v[116:117], v123, v[124:125] offset:54272
    s_mov_b64 exec, -1
    v_ashrrev_i32 v122, 5, v70
    v_lshlrev_b16 v123, 2, v70
    v_lshlrev_b32 v124, 16, v44
    v_bitop3_b32 v122, v122, v113, v113 bitop3:0x0c
    v_and_b32 v125, 0xffff0000, v44
    v_lshlrev_b32 v126, 16, v45
    v_mul_f32 v122, v114, v122
    v_and_b32 v127, 0xffff0000, v45
    v_add_u32 v123, v123, v123
    v_pk_fma_f32 v[124:125], v[124:125], v[122:123], s[34:35] op_sel_hi:[1,0,1]
    v_pk_fma_f32 v[126:127], v[126:127], v[122:123], s[34:35] op_sel_hi:[1,0,1]
    v_lshl_add_u32 v124, v125, 16, v124
    v_lshl_add_u32 v125, v127, 16, v126
    s_waitcnt lgkmcnt(5)
    v_bitop3_b32 v115, v115, v118, v119 bitop3:0xfe
    v_lshl_add_u64 v[124:125], v[124:125], 0, s[36:37]
    v_cmpx_le_u32 vcc, 0x1000000, v70
    ds_add_rtn_u64 v[118:119], v123, v[124:125] offset:54272
    s_mov_b64 exec, -1
    v_ashrrev_i32 v122, 5, v71
    v_lshlrev_b16 v123, 2, v71
    v_lshlrev_b32 v124, 16, v46
    v_bitop3_b32 v122, v122, v113, v113 bitop3:0x0c
    v_and_b32 v125, 0xffff0000, v46
    v_lshlrev_b32 v126, 16, v47
    v_mul_f32 v122, v114, v122
    v_and_b32 v127, 0xffff0000, v47
    v_add_u32 v123, v123, v123
    v_pk_fma_f32 v[124:125], v[124:125], v[122:123], s[34:35] op_sel_hi:[1,0,1]
    v_pk_fma_f32 v[126:127], v[126:127], v[122:123], s[34:35] op_sel_hi:[1,0,1]
    v_lshl_add_u32 v124, v125, 16, v124
    v_lshl_add_u32 v125, v127, 16, v126
    s_waitcnt lgkmcnt(5)
    v_bitop3_b32 v115, v115, v120, v121 bitop3:0xfe
    v_lshl_add_u64 v[124:125], v[124:125], 0, s[36:37]
    v_cmpx_le_u32 vcc, 0x1000000, v71
    ds_add_rtn_u64 v[120:121], v123, v[124:125] offset:54272
    s_mov_b64 exec, -1
    s_waitcnt vmcnt(12)
    v_perm_b32 v69, v101, v98, s31
    v_perm_b32 v70, v101, v99, s32
    v_perm_b32 v71, v101, v100, s33
    v_lshlrev_b16 v46, 3, v100
    v_lshlrev_b16 v44, 3, v99
    v_lshlrev_b16 v42, 3, v98
    v_cmpx_ge_u16 vcc, 0x3fff, v69
    ds_read_b64 v[42:43], v42
    s_mov_b64 exec, -1
    v_cmpx_ge_u16 vcc, 0x3fff, v70
    ds_read_b64 v[44:45], v44
    s_mov_b64 exec, -1
    v_cmpx_ge_u16 vcc, 0x3fff, v71
    ds_read_b64 v[46:47], v46
    s_mov_b64 exec, -1
    s_waitcnt lgkmcnt(15)
    s_nop 2
    s_nop 1
    v_max_u32_dpp v108, v108, v108 row_shr:1 row_mask:0xf bank_mask:0xf bound_ctrl:0
    v_max_u32_dpp v109, v109, v109 row_shr:1 row_mask:0xf bank_mask:0xf bound_ctrl:0
    s_nop 0
    v_max_u32_dpp v108, v108, v108 row_shr:2 row_mask:0xf bank_mask:0xf bound_ctrl:0
    v_max_u32_dpp v109, v109, v109 row_shr:2 row_mask:0xf bank_mask:0xf bound_ctrl:0
    s_nop 0
    v_max_u32_dpp v108, v108, v108 row_shr:4 row_mask:0xf bank_mask:0xf bound_ctrl:0
    v_max_u32_dpp v109, v109, v109 row_shr:4 row_mask:0xf bank_mask:0xf bound_ctrl:0
    s_nop 0
    v_max_u32_dpp v108, v108, v108 row_shr:8 row_mask:0xf bank_mask:0xf bound_ctrl:0
    v_max_u32_dpp v109, v109, v109 row_shr:8 row_mask:0xf bank_mask:0xf bound_ctrl:0
    s_nop 0
    v_max_u32_dpp v108, v108, v108 row_bcast:15 row_mask:0xa bank_mask:0xf
    v_max_u32_dpp v109, v109, v109 row_bcast:15 row_mask:0xa bank_mask:0xf
    s_nop 0
    v_max_u32_dpp v108, v108, v108 row_bcast:31 row_mask:0xc bank_mask:0xf
    v_max_u32_dpp v109, v109, v109 row_bcast:31 row_mask:0xc bank_mask:0xf
    s_nop 0
    s_nop 0
    v_max_u32 v108, s41, v108
    s_nop 0
    v_readlane_b32 s41, v108, 63
    v_add_u32 v108, v108, v112
    v_add_u32 v108, 4294961152, v108
    v_max_u32 v109, s41, v109
    s_nop 0
    v_readlane_b32 s41, v109, 63
    v_add_u32 v109, v109, v112
    v_add_u32 v109, 4294962176, v109
    v_bfe_u32 v94, v108, 14, 4
    v_lshrrev_b32 v95, 18, v108
    v_and_b32 v108, 0x3fff, v108
    v_mad_u32_u24 v94, v94, s63, v95
    v_lshl_or_b32 v108, v94, 14, v108
    buffer_load_dwordx4 v[94:97], v108, s[68:71], 0 offen
    s_setprio 0
    s_waitcnt vmcnt(9)
    v_perm_b32 v48, v3, v0, s31
    v_perm_b32 v49, v3, v1, s32
    v_perm_b32 v50, v3, v2, s33
    v_lshlrev_b16 v4, 3, v2
    v_lshlrev_b16 v2, 3, v1
    v_lshlrev_b16 v0, 3, v0
    v_cmpx_ge_u16 vcc, 0x3fff, v48
    ds_read_b64 v[0:1], v0
    s_mov_b64 exec, -1
    v_cmpx_ge_u16 vcc, 0x3fff, v49
    ds_read_b64 v[2:3], v2
    s_mov_b64 exec, -1
    v_cmpx_ge_u16 vcc, 0x3fff, v50
    ds_read_b64 v[4:5], v4
    s_mov_b64 exec, -1
    s_waitcnt vmcnt(8)
    v_perm_b32 v51, v9, v6, s31
    v_perm_b32 v52, v9, v7, s32
    v_perm_b32 v53, v9, v8, s33
    v_lshlrev_b16 v10, 3, v8
    v_lshlrev_b16 v8, 3, v7
    v_lshlrev_b16 v6, 3, v6
    v_cmpx_ge_u16 vcc, 0x3fff, v51
    ds_read_b64 v[6:7], v6
    s_mov_b64 exec, -1
    v_cmpx_ge_u16 vcc, 0x3fff, v52
    ds_read_b64 v[8:9], v8
    s_mov_b64 exec, -1
    v_cmpx_ge_u16 vcc, 0x3fff, v53
    ds_read_b64 v[10:11], v10
    s_mov_b64 exec, -1
    s_waitcnt vmcnt(7)
    v_perm_b32 v54, v15, v12, s31
    v_perm_b32 v55, v15, v13, s32
    v_perm_b32 v56, v15, v14, s33
    v_lshlrev_b16 v16, 3, v14
    v_lshlrev_b16 v14, 3, v13
    v_lshlrev_b16 v12, 3, v12
    v_cmpx_ge_u16 vcc, 0x3fff, v54
    ds_read_b64 v[12:13], v12
    s_mov_b64 exec, -1
    v_cmpx_ge_u16 vcc, 0x3fff, v55
    ds_read_b64 v[14:15], v14
    s_mov_b64 exec, -1
    v_cmpx_ge_u16 vcc, 0x3fff, v56
    ds_read_b64 v[16:17], v16
    s_mov_b64 exec, -1
    s_waitcnt vmcnt(6)
    v_perm_b32 v57, v21, v18, s31
    v_perm_b32 v58, v21, v19, s32
    v_perm_b32 v59, v21, v20, s33
    v_lshlrev_b16 v22, 3, v20
    v_lshlrev_b16 v20, 3, v19
    v_lshlrev_b16 v18, 3, v18
    s_cmp_lt_u32 s16, 8
    s_cbranch_scc1 p2_g0r03
    v_cmpx_ge_u16 vcc, 0x3fff, v57
    ds_read_b64 v[18:19], v18
    s_mov_b64 exec, -1
    v_cmpx_ge_u16 vcc, 0x3fff, v58
    ds_read_b64 v[20:21], v20
    s_mov_b64 exec, -1
    v_cmpx_ge_u16 vcc, 0x3fff, v59
    ds_read_b64 v[22:23], v22
    s_mov_b64 exec, -1
p2_g0r03:
    s_waitcnt lgkmcnt(0)
    s_barrier
    s_waitcnt lgkmcnt(15)
    s_branch p2_tail
p2_drain0:
    v_cmpx_gt_i16 vcc, 0, v48
    ds_read_b64 v[0:1], v0
    s_mov_b64 exec, -1
    v_cmpx_gt_i16 vcc, 0, v49
    ds_read_b64 v[2:3], v2
    s_mov_b64 exec, -1
    v_cmpx_gt_i16 vcc, 0, v50
    ds_read_b64 v[4:5], v4
    s_mov_b64 exec, -1
    v_cmpx_gt_i16 vcc, 0, v51
    ds_read_b64 v[6:7], v6
    s_mov_b64 exec, -1
    v_cmpx_gt_i16 vcc, 0, v52
    ds_read_b64 v[8:9], v8
    s_mov_b64 exec, -1
    v_cmpx_gt_i16 vcc, 0, v53
    ds_read_b64 v[10:11], v10
    s_mov_b64 exec, -1
    v_cmpx_gt_i16 vcc, 0, v54
    ds_read_b64 v[12:13], v12
    s_mov_b64 exec, -1
    v_cmpx_gt_i16 vcc, 0, v55
    ds_read_b64 v[14:15], v14
    s_mov_b64 exec, -1
    v_cmpx_gt_i16 vcc, 0, v56
    ds_read_b64 v[16:17], v16
    s_mov_b64 exec, -1
    s_cmp_lt_u32 s15, 8
    s_cbranch_scc1 p2_gd0
    v_cmpx_gt_i16 vcc, 0, v57
    ds_read_b64 v[18:19], v18
    s_mov_b64 exec, -1
    v_cmpx_gt_i16 vcc, 0, v58
    ds_read_b64 v[20:21], v20
    s_mov_b64 exec, -1
    v_cmpx_gt_i16 vcc, 0, v59
    ds_read_b64 v[22:23], v22
    s_mov_b64 exec, -1
p2_gd0:
    v_cmpx_gt_i16 vcc, 0, v60
    ds_read_b64 v[24:25], v24
    s_mov_b64 exec, -1
    v_cmpx_gt_i16 vcc, 0, v61
    ds_read_b64 v[26:27], v26
    s_mov_b64 exec, -1
    v_cmpx_gt_i16 vcc, 0, v62
    ds_read_b64 v[28:29], v28
    s_mov_b64 exec, -1
    v_cmpx_gt_i16 vcc, 0, v63
    ds_read_b64 v[30:31], v30
    s_mov_b64 exec, -1
    v_cmpx_gt_i16 vcc, 0, v64
    ds_read_b64 v[32:33], v32
    s_mov_b64 exec, -1
    v_cmpx_gt_i16 vcc, 0, v65
    ds_read_b64 v[34:35], v34
    s_mov_b64 exec, -1
    v_cmpx_gt_i16 vcc, 0, v66
    ds_read_b64 v[36:37], v36
    s_mov_b64 exec, -1
    v_cmpx_gt_i16 vcc, 0, v67
    ds_read_b64 v[38:39], v38
    s_mov_b64 exec, -1
    v_cmpx_gt_i16 vcc, 0, v68
    ds_read_b64 v[40:41], v40
    s_mov_b64 exec, -1
    v_cmpx_gt_i16 vcc, 0, v69
    ds_read_b64 v[42:43], v42
    s_mov_b64 exec, -1
    v_cmpx_gt_i16 vcc, 0, v70
    ds_read_b64 v[44:45], v44
    s_mov_b64 exec, -1
    v_cmpx_gt_i16 vcc, 0, v71
    ds_read_b64 v[46:47], v46
    s_mov_b64 exec, -1
    s_waitcnt lgkmcnt(15)
    v_ashrrev_i32 v122, 5, v48
    v_lshlrev_b16 v123, 2, v48
    v_lshlrev_b32 v124, 16, v0
    v_bitop3_b32 v122, v122, v113, v113 bitop3:0x0c
    v_and_b32 v125, 0xffff0000, v0
    v_lshlrev_b32 v126, 16, v1
    v_mul_f32 v122, v114, v122
    v_and_b32 v127, 0xffff0000, v1
    v_add_u32 v123, v123, v123
    v_pk_fma_f32 v[124:125], v[124:125], v[122:123], s[34:35] op_sel_hi:[1,0,1]
    v_pk_fma_f32 v[126:127], v[126:127], v[122:123], s[34:35] op_sel_hi:[1,0,1]
    v_lshl_add_u32 v124, v125, 16, v124
    v_lshl_add_u32 v125, v127, 16, v126
    s_waitcnt lgkmcnt(15)
    v_bitop3_b32 v115, v115, v116, v117 bitop3:0xfe
    v_lshl_add_u64 v[124:125], v[124:125], 0, s[36:37]
    v_cmpx_le_u32 vcc, 0x1000000, v48
    ds_add_rtn_u64 v[116:117], v123, v[124:125] offset:54272
    s_mov_b64 exec, -1
    v_ashrrev_i32 v122, 5, v49
    v_lshlrev_b16 v123, 2, v49
    v_lshlrev_b32 v124, 16, v2
    v_bitop3_b32 v122, v122, v113, v113 bitop3:0x0c
    v_and_b32 v125, 0xffff0000, v2
    v_lshlrev_b32 v126, 16, v3
    v_mul_f32 v122, v114, v122
    v_and_b32 v127, 0xffff0000, v3
    v_add_u32 v123, v123, v123
    v_pk_fma_f32 v[124:125], v[124:125], v[122:123], s[34:35] op_sel_hi:[1,0,1]
    v_pk_fma_f32 v[126:127], v[126:127], v[122:123], s[34:35] op_sel_hi:[1,0,1]
    v_lshl_add_u32 v124, v125, 16, v124
    v_lshl_add_u32 v125, v127, 16, v126
    s_waitcnt lgkmcnt(15)
    v_bitop3_b32 v115, v115, v118, v119 bitop3:0xfe
    v_lshl_add_u64 v[124:125], v[124:125], 0, s[36:37]
    v_cmpx_le_u32 vcc, 0x1000000, v49
    ds_add_rtn_u64 v[118:119], v123, v[124:125] offset:54272
    s_mov_b64 exec, -1
    v_ashrrev_i32 v122, 5, v50
    v_lshlrev_b16 v123, 2, v50
    v_lshlrev_b32 v124, 16, v4
    v_bitop3_b32 v122, v122, v113, v113 bitop3:0x0c
    v_and_b32 v125, 0xffff0000, v4
    v_lshlrev_b32 v126, 16, v5
    v_mul_f32 v122, v114, v122
    v_and_b32 v127, 0xffff0000, v5
    v_add_u32 v123, v123, v123
    v_pk_fma_f32 v[124:125], v[124:125], v[122:123], s[34:35] op_sel_hi:[1,0,1]
    v_pk_fma_f32 v[126:127], v[126:127], v[122:123], s[34:35] op_sel_hi:[1,0,1]
    v_lshl_add_u32 v124, v125, 16, v124
    v_lshl_add_u32 v125, v127, 16, v126
    s_waitcnt lgkmcnt(15)
    v_bitop3_b32 v115, v115, v120, v121 bitop3:0xfe
    v_lshl_add_u64 v[124:125], v[124:125], 0, s[36:37]
    v_cmpx_le_u32 vcc, 0x1000000, v50
    ds_add_rtn_u64 v[120:121], v123, v[124:125] offset:54272
    s_mov_b64 exec, -1
    s_waitcnt lgkmcnt(15)
    v_ashrrev_i32 v122, 5, v51
    v_lshlrev_b16 v123, 2, v51
    v_lshlrev_b32 v124, 16, v6
    v_bitop3_b32 v122, v122, v113, v113 bitop3:0x0c
    v_and_b32 v125, 0xffff0000, v6
    v_lshlrev_b32 v126, 16, v7
    v_mul_f32 v122, v114, v122
    v_and_b32 v127, 0xffff0000, v7
    v_add_u32 v123, v123, v123
    v_pk_fma_f32 v[124:125], v[124:125], v[122:123], s[34:35] op_sel_hi:[1,0,1]
    v_pk_fma_f32 v[126:127], v[126:127], v[122:123], s[34:35] op_sel_hi:[1,0,1]
    v_lshl_add_u32 v124, v125, 16, v124
    v_lshl_add_u32 v125, v127, 16, v126
    s_waitcnt lgkmcnt(2)
    v_bitop3_b32 v115, v115, v116, v117 bitop3:0xfe
    v_lshl_add_u64 v[124:125], v[124:125], 0, s[36:37]
    v_cmpx_le_u32 vcc, 0x1000000, v51
    ds_add_rtn_u64 v[116:117], v123, v[124:125] offset:54272
    s_mov_b64 exec, -1
    v_ashrrev_i32 v122, 5, v52
    v_lshlrev_b16 v123, 2, v52
    v_lshlrev_b32 v124, 16, v8
    v_bitop3_b32 v122, v122, v113, v113 bitop3:0x0c
    v_and_b32 v125, 0xffff0000, v8
    v_lshlrev_b32 v126, 16, v9
    v_mul_f32 v122, v114, v122
    v_and_b32 v127, 0xffff0000, v9
    v_add_u32 v123, v123, v123
    v_pk_fma_f32 v[124:125], v[124:125], v[122:123], s[34:35] op_sel_hi:[1,0,1]
    v_pk_fma_f32 v[126:127], v[126:127], v[122:123], s[34:35] op_sel_hi:[1,0,1]
    v_lshl_add_u32 v124, v125, 16, v124
    v_lshl_add_u32 v125, v127, 16, v126
    s_waitcnt lgkmcnt(2)
    v_bitop3_b32 v115, v115, v118, v119 bitop3:0xfe
    v_lshl_add_u64 v[124:125], v[124:125], 0, s[36:37]
    v_cmpx_le_u32 vcc, 0x1000000, v52
    ds_add_rtn_u64 v[118:119], v123, v[124:125] offset:54272
    s_mov_b64 exec, -1
    v_ashrrev_i32 v122, 5, v53
    v_lshlrev_b16 v123, 2, v53
    v_lshlrev_b32 v124, 16, v10
    v_bitop3_b32 v122, v122, v113, v113 bitop3:0x0c
    v_and_b32 v125, 0xffff0000, v10
    v_lshlrev_b32 v126, 16, v11
    v_mul_f32 v122, v114, v122
    v_and_b32 v127, 0xffff0000, v11
    v_add_u32 v123, v123, v123
    v_pk_fma_f32 v[124:125], v[124:125], v[122:123], s[34:35] op_sel_hi:[1,0,1]
    v_pk_fma_f32 v[126:127], v[126:127], v[122:123], s[34:35] op_sel_hi:[1,0,1]
    v_lshl_add_u32 v124, v125, 16, v124
    v_lshl_add_u32 v125, v127, 16, v126
    s_waitcnt lgkmcnt(2)
    v_bitop3_b32 v115, v115, v120, v121 bitop3:0xfe
    v_lshl_add_u64 v[124:125], v[124:125], 0, s[36:37]
    v_cmpx_le_u32 vcc, 0x1000000, v53
    ds_add_rtn_u64 v[120:121], v123, v[124:125] offset:54272
    s_mov_b64 exec, -1
    s_waitcnt lgkmcnt(15)
    v_ashrrev_i32 v122, 5, v54
    v_lshlrev_b16 v123, 2, v54
    v_lshlrev_b32 v124, 16, v12
    v_bitop3_b32 v122, v122, v113, v113 bitop3:0x0c
    v_and_b32 v125, 0xffff0000, v12
    v_lshlrev_b32 v126, 16, v13
    v_mul_f32 v122, v114, v122
    v_and_b32 v127, 0xffff0000, v13
    v_add_u32 v123, v123, v123
    v_pk_fma_f32 v[124:125], v[124:125], v[122:123], s[34:35] op_sel_hi:[1,0,1]
    v_pk_fma_f32 v[126:127], v[126:127], v[122:123], s[34:35] op_sel_hi:[1,0,1]
    v_lshl_add_u32 v124, v125, 16, v124
    v_lshl_add_u32 v125, v127, 16, v126
    s_waitcnt lgkmcnt(2)
    v_bitop3_b32 v115, v115, v116, v117 bitop3:0xfe
    v_lshl_add_u64 v[124:125], v[124:125], 0, s[36:37]
    v_cmpx_le_u32 vcc, 0x1000000, v54
    ds_add_rtn_u64 v[116:117], v123, v[124:125] offset:54272
    s_mov_b64 exec, -1
    v_ashrrev_i32 v122, 5, v55
    v_lshlrev_b16 v123, 2, v55
    v_lshlrev_b32 v124, 16, v14
    v_bitop3_b32 v122, v122, v113, v113 bitop3:0x0c
    v_and_b32 v125, 0xffff0000, v14
    v_lshlrev_b32 v126, 16, v15
    v_mul_f32 v122, v114, v122
    v_and_b32 v127, 0xffff0000, v15
    v_add_u32 v123, v123, v123
    v_pk_fma_f32 v[124:125], v[124:125], v[122:123], s[34:35] op_sel_hi:[1,0,1]
    v_pk_fma_f32 v[126:127], v[126:127], v[122:123], s[34:35] op_sel_hi:[1,0,1]
    v_lshl_add_u32 v124, v125, 16, v124
    v_lshl_add_u32 v125, v127, 16, v126
    s_waitcnt lgkmcnt(2)
    v_bitop3_b32 v115, v115, v118, v119 bitop3:0xfe
    v_lshl_add_u64 v[124:125], v[124:125], 0, s[36:37]
    v_cmpx_le_u32 vcc, 0x1000000, v55
    ds_add_rtn_u64 v[118:119], v123, v[124:125] offset:54272
    s_mov_b64 exec, -1
    v_ashrrev_i32 v122, 5, v56
    v_lshlrev_b16 v123, 2, v56
    v_lshlrev_b32 v124, 16, v16
    v_bitop3_b32 v122, v122, v113, v113 bitop3:0x0c
    v_and_b32 v125, 0xffff0000, v16
    v_lshlrev_b32 v126, 16, v17
    v_mul_f32 v122, v114, v122
    v_and_b32 v127, 0xffff0000, v17
    v_add_u32 v123, v123, v123
    v_pk_fma_f32 v[124:125], v[124:125], v[122:123], s[34:35] op_sel_hi:[1,0,1]
    v_pk_fma_f32 v[126:127], v[126:127], v[122:123], s[34:35] op_sel_hi:[1,0,1]
    v_lshl_add_u32 v124, v125, 16, v124
    v_lshl_add_u32 v125, v127, 16, v126
    s_waitcnt lgkmcnt(2)
    v_bitop3_b32 v115, v115, v120, v121 bitop3:0xfe
    v_lshl_add_u64 v[124:125], v[124:125], 0, s[36:37]
    v_cmpx_le_u32 vcc, 0x1000000, v56
    ds_add_rtn_u64 v[120:121], v123, v[124:125] offset:54272
    s_mov_b64 exec, -1
    s_cmp_lt_u32 s15, 8
    s_cbranch_scc1 p2_nad0
    s_waitcnt lgkmcnt(15)
    v_ashrrev_i32 v122, 5, v57
    v_lshlrev_b16 v123, 2, v57
    v_lshlrev_b32 v124, 16, v18
    v_bitop3_b32 v122, v122, v113, v113 bitop3:0x0c
    v_and_b32 v125, 0xffff0000, v18
    v_lshlrev_b32 v126, 16, v19
    v_mul_f32 v122, v114, v122
    v_and_b32 v127, 0xffff0000, v19
    v_add_u32 v123, v123, v123
    v_pk_fma_f32 v[124:125], v[124:125], v[122:123], s[34:35] op_sel_hi:[1,0,1]
    v_pk_fma_f32 v[126:127], v[126:127], v[122:123], s[34:35] op_sel_hi:[1,0,1]
    v_lshl_add_u32 v124, v125, 16, v124
    v_lshl_add_u32 v125, v127, 16, v126
    s_waitcnt lgkmcnt(2)
    v_bitop3_b32 v115, v115, v116, v117 bitop3:0xfe
    v_lshl_add_u64 v[124:125], v[124:125], 0, s[36:37]
    v_cmpx_le_u32 vcc, 0x1000000, v57
    ds_add_rtn_u64 v[116:117], v123, v[124:125] offset:54272
    s_mov_b64 exec, -1
    v_ashrrev_i32 v122, 5, v58
    v_lshlrev_b16 v123, 2, v58
    v_lshlrev_b32 v124, 16, v20
    v_bitop3_b32 v122, v122, v113, v113 bitop3:0x0c
    v_and_b32 v125, 0xffff0000, v20
    v_lshlrev_b32 v126, 16, v21
    v_mul_f32 v122, v114, v122
    v_and_b32 v127, 0xffff0000, v21
    v_add_u32 v123, v123, v123
    v_pk_fma_f32 v[124:125], v[124:125], v[122:123], s[34:35] op_sel_hi:[1,0,1]
    v_pk_fma_f32 v[126:127], v[126:127], v[122:123], s[34:35] op_sel_hi:[1,0,1]
    v_lshl_add_u32 v124, v125, 16, v124
    v_lshl_add_u32 v125, v127, 16, v126
    s_waitcnt lgkmcnt(2)
    v_bitop3_b32 v115, v115, v118, v119 bitop3:0xfe
    v_lshl_add_u64 v[124:125], v[124:125], 0, s[36:37]
    v_cmpx_le_u32 vcc, 0x1000000, v58
    ds_add_rtn_u64 v[118:119], v123, v[124:125] offset:54272
    s_mov_b64 exec, -1
    v_ashrrev_i32 v122, 5, v59
    v_lshlrev_b16 v123, 2, v59
    v_lshlrev_b32 v124, 16, v22
    v_bitop3_b32 v122, v122, v113, v113 bitop3:0x0c
    v_and_b32 v125, 0xffff0000, v22
    v_lshlrev_b32 v126, 16, v23
    v_mul_f32 v122, v114, v122
    v_and_b32 v127, 0xffff0000, v23
    v_add_u32 v123, v123, v123
    v_pk_fma_f32 v[124:125], v[124:125], v[122:123], s[34:35] op_sel_hi:[1,0,1]
    v_pk_fma_f32 v[126:127], v[126:127], v[122:123], s[34:35] op_sel_hi:[1,0,1]
    v_lshl_add_u32 v124, v125, 16, v124
    v_lshl_add_u32 v125, v127, 16, v126
    s_waitcnt lgkmcnt(2)
    v_bitop3_b32 v115, v115, v120, v121 bitop3:0xfe
    v_lshl_add_u64 v[124:125], v[124:125], 0, s[36:37]
    v_cmpx_le_u32 vcc, 0x1000000, v59
    ds_add_rtn_u64 v[120:121], v123, v[124:125] offset:54272
    s_mov_b64 exec, -1
p2_nad0:
    s_waitcnt lgkmcnt(15)
    v_ashrrev_i32 v122, 5, v60
    v_lshlrev_b16 v123, 2, v60
    v_lshlrev_b32 v124, 16, v24
    v_bitop3_b32 v122, v122, v113, v113 bitop3:0x0c
    v_and_b32 v125, 0xffff0000, v24
    v_lshlrev_b32 v126, 16, v25
    v_mul_f32 v122, v114, v122
    v_and_b32 v127, 0xffff0000, v25
    v_add_u32 v123, v123, v123
    v_pk_fma_f32 v[124:125], v[124:125], v[122:123], s[34:35] op_sel_hi:[1,0,1]
    v_pk_fma_f32 v[126:127], v[126:127], v[122:123], s[34:35] op_sel_hi:[1,0,1]
    v_lshl_add_u32 v124, v125, 16, v124
    v_lshl_add_u32 v125, v127, 16, v126
    s_waitcnt lgkmcnt(2)
    v_bitop3_b32 v115, v115, v116, v117 bitop3:0xfe
    v_lshl_add_u64 v[124:125], v[124:125], 0, s[36:37]
    v_cmpx_le_u32 vcc, 0x1000000, v60
    ds_add_rtn_u64 v[116:117], v123, v[124:125] offset:54272
    s_mov_b64 exec, -1
    v_ashrrev_i32 v122, 5, v61
    v_lshlrev_b16 v123, 2, v61
    v_lshlrev_b32 v124, 16, v26
    v_bitop3_b32 v122, v122, v113, v113 bitop3:0x0c
    v_and_b32 v125, 0xffff0000, v26
    v_lshlrev_b32 v126, 16, v27
    v_mul_f32 v122, v114, v122
    v_and_b32 v127, 0xffff0000, v27
    v_add_u32 v123, v123, v123
    v_pk_fma_f32 v[124:125], v[124:125], v[122:123], s[34:35] op_sel_hi:[1,0,1]
    v_pk_fma_f32 v[126:127], v[126:127], v[122:123], s[34:35] op_sel_hi:[1,0,1]
    v_lshl_add_u32 v124, v125, 16, v124
    v_lshl_add_u32 v125, v127, 16, v126
    s_waitcnt lgkmcnt(2)
    v_bitop3_b32 v115, v115, v118, v119 bitop3:0xfe
    v_lshl_add_u64 v[124:125], v[124:125], 0, s[36:37]
    v_cmpx_le_u32 vcc, 0x1000000, v61
    ds_add_rtn_u64 v[118:119], v123, v[124:125] offset:54272
    s_mov_b64 exec, -1
    v_ashrrev_i32 v122, 5, v62
    v_lshlrev_b16 v123, 2, v62
    v_lshlrev_b32 v124, 16, v28
    v_bitop3_b32 v122, v122, v113, v113 bitop3:0x0c
    v_and_b32 v125, 0xffff0000, v28
    v_lshlrev_b32 v126, 16, v29
    v_mul_f32 v122, v114, v122
    v_and_b32 v127, 0xffff0000, v29
    v_add_u32 v123, v123, v123
    v_pk_fma_f32 v[124:125], v[124:125], v[122:123], s[34:35] op_sel_hi:[1,0,1]
    v_pk_fma_f32 v[126:127], v[126:127], v[122:123], s[34:35] op_sel_hi:[1,0,1]
    v_lshl_add_u32 v124, v125, 16, v124
    v_lshl_add_u32 v125, v127, 16, v126
    s_waitcnt lgkmcnt(2)
    v_bitop3_b32 v115, v115, v120, v121 bitop3:0xfe
    v_lshl_add_u64 v[124:125], v[124:125], 0, s[36:37]
    v_cmpx_le_u32 vcc, 0x1000000, v62
    ds_add_rtn_u64 v[120:121], v123, v[124:125] offset:54272
    s_mov_b64 exec, -1
    s_waitcnt lgkmcnt(15)
    v_ashrrev_i32 v122, 5, v63
    v_lshlrev_b16 v123, 2, v63
    v_lshlrev_b32 v124, 16, v30
    v_bitop3_b32 v122, v122, v113, v113 bitop3:0x0c
    v_and_b32 v125, 0xffff0000, v30
    v_lshlrev_b32 v126, 16, v31
    v_mul_f32 v122, v114, v122
    v_and_b32 v127, 0xffff0000, v31
    v_add_u32 v123, v123, v123
    v_pk_fma_f32 v[124:125], v[124:125], v[122:123], s[34:35] op_sel_hi:[1,0,1]
    v_pk_fma_f32 v[126:127], v[126:127], v[122:123], s[34:35] op_sel_hi:[1,0,1]
    v_lshl_add_u32 v124, v125, 16, v124
    v_lshl_add_u32 v125, v127, 16, v126
    s_waitcnt lgkmcnt(2)
    v_bitop3_b32 v115, v115, v116, v117 bitop3:0xfe
    v_lshl_add_u64 v[124:125], v[124:125], 0, s[36:37]
    v_cmpx_le_u32 vcc, 0x1000000, v63
    ds_add_rtn_u64 v[116:117], v123, v[124:125] offset:54272
    s_mov_b64 exec, -1
    v_ashrrev_i32 v122, 5, v64
    v_lshlrev_b16 v123, 2, v64
    v_lshlrev_b32 v124, 16, v32
    v_bitop3_b32 v122, v122, v113, v113 bitop3:0x0c
    v_and_b32 v125, 0xffff0000, v32
    v_lshlrev_b32 v126, 16, v33
    v_mul_f32 v122, v114, v122
    v_and_b32 v127, 0xffff0000, v33
    v_add_u32 v123, v123, v123
    v_pk_fma_f32 v[124:125], v[124:125], v[122:123], s[34:35] op_sel_hi:[1,0,1]
    v_pk_fma_f32 v[126:127], v[126:127], v[122:123], s[34:35] op_sel_hi:[1,0,1]
    v_lshl_add_u32 v124, v125, 16, v124
    v_lshl_add_u32 v125, v127, 16, v126
    s_waitcnt lgkmcnt(2)
    v_bitop3_b32 v115, v115, v118, v119 bitop3:0xfe
    v_lshl_add_u64 v[124:125], v[124:125], 0, s[36:37]
    v_cmpx_le_u32 vcc, 0x1000000, v64
    ds_add_rtn_u64 v[118:119], v123, v[124:125] offset:54272
    s_mov_b64 exec, -1
    v_ashrrev_i32 v122, 5, v65
    v_lshlrev_b16 v123, 2, v65
    v_lshlrev_b32 v124, 16, v34
    v_bitop3_b32 v122, v122, v113, v113 bitop3:0x0c
    v_and_b32 v125, 0xffff0000, v34
    v_lshlrev_b32 v126, 16, v35
    v_mul_f32 v122, v114, v122
    v_and_b32 v127, 0xffff0000, v35
    v_add_u32 v123, v123, v123
    v_pk_fma_f32 v[124:125], v[124:125], v[122:123], s[34:35] op_sel_hi:[1,0,1]
    v_pk_fma_f32 v[126:127], v[126:127], v[122:123], s[34:35] op_sel_hi:[1,0,1]
    v_lshl_add_u32 v124, v125, 16, v124
    v_lshl_add_u32 v125, v127, 16, v126
    s_waitcnt lgkmcnt(2)
    v_bitop3_b32 v115, v115, v120, v121 bitop3:0xfe
    v_lshl_add_u64 v[124:125], v[124:125], 0, s[36:37]
    v_cmpx_le_u32 vcc, 0x1000000, v65
    ds_add_rtn_u64 v[120:121], v123, v[124:125] offset:54272
    s_mov_b64 exec, -1
    s_waitcnt lgkmcnt(15)
    v_ashrrev_i32 v122, 5, v66
    v_lshlrev_b16 v123, 2, v66
    v_lshlrev_b32 v124, 16, v36
    v_bitop3_b32 v122, v122, v113, v113 bitop3:0x0c
    v_and_b32 v125, 0xffff0000, v36
    v_lshlrev_b32 v126, 16, v37
    v_mul_f32 v122, v114, v122
    v_and_b32 v127, 0xffff0000, v37
    v_add_u32 v123, v123, v123
    v_pk_fma_f32 v[124:125], v[124:125], v[122:123], s[34:35] op_sel_hi:[1,0,1]
    v_pk_fma_f32 v[126:127], v[126:127], v[122:123], s[34:35] op_sel_hi:[1,0,1]
    v_lshl_add_u32 v124, v125, 16, v124
    v_lshl_add_u32 v125, v127, 16, v126
    s_waitcnt lgkmcnt(2)
    v_bitop3_b32 v115, v115, v116, v117 bitop3:0xfe
    v_lshl_add_u64 v[124:125], v[124:125], 0, s[36:37]
    v_cmpx_le_u32 vcc, 0x1000000, v66
    ds_add_rtn_u64 v[116:117], v123, v[124:125] offset:54272
    s_mov_b64 exec, -1
    v_ashrrev_i32 v122, 5, v67
    v_lshlrev_b16 v123, 2, v67
    v_lshlrev_b32 v124, 16, v38
    v_bitop3_b32 v122, v122, v113, v113 bitop3:0x0c
    v_and_b32 v125, 0xffff0000, v38
    v_lshlrev_b32 v126, 16, v39
    v_mul_f32 v122, v114, v122
    v_and_b32 v127, 0xffff0000, v39
    v_add_u32 v123, v123, v123
    v_pk_fma_f32 v[124:125], v[124:125], v[122:123], s[34:35] op_sel_hi:[1,0,1]
    v_pk_fma_f32 v[126:127], v[126:127], v[122:123], s[34:35] op_sel_hi:[1,0,1]
    v_lshl_add_u32 v124, v125, 16, v124
    v_lshl_add_u32 v125, v127, 16, v126
    s_waitcnt lgkmcnt(2)
    v_bitop3_b32 v115, v115, v118, v119 bitop3:0xfe
    v_lshl_add_u64 v[124:125], v[124:125], 0, s[36:37]
    v_cmpx_le_u32 vcc, 0x1000000, v67
    ds_add_rtn_u64 v[118:119], v123, v[124:125] offset:54272
    s_mov_b64 exec, -1
    v_ashrrev_i32 v122, 5, v68
    v_lshlrev_b16 v123, 2, v68
    v_lshlrev_b32 v124, 16, v40
    v_bitop3_b32 v122, v122, v113, v113 bitop3:0x0c
    v_and_b32 v125, 0xffff0000, v40
    v_lshlrev_b32 v126, 16, v41
    v_mul_f32 v122, v114, v122
    v_and_b32 v127, 0xffff0000, v41
    v_add_u32 v123, v123, v123
    v_pk_fma_f32 v[124:125], v[124:125], v[122:123], s[34:35] op_sel_hi:[1,0,1]
    v_pk_fma_f32 v[126:127], v[126:127], v[122:123], s[34:35] op_sel_hi:[1,0,1]
    v_lshl_add_u32 v124, v125, 16, v124
    v_lshl_add_u32 v125, v127, 16, v126
    s_waitcnt lgkmcnt(2)
    v_bitop3_b32 v115, v115, v120, v121 bitop3:0xfe
    v_lshl_add_u64 v[124:125], v[124:125], 0, s[36:37]
    v_cmpx_le_u32 vcc, 0x1000000, v68
    ds_add_rtn_u64 v[120:121], v123, v[124:125] offset:54272
    s_mov_b64 exec, -1
    s_waitcnt lgkmcnt(15)
    v_ashrrev_i32 v122, 5, v69
    v_lshlrev_b16 v123, 2, v69
    v_lshlrev_b32 v124, 16, v42
    v_bitop3_b32 v122, v122, v113, v113 bitop3:0x0c
    v_and_b32 v125, 0xffff0000, v42
    v_lshlrev_b32 v126, 16, v43
    v_mul_f32 v122, v114, v122
    v_and_b32 v127, 0xffff0000, v43
    v_add_u32 v123, v123, v123
    v_pk_fma_f32 v[124:125], v[124:125], v[122:123], s[34:35] op_sel_hi:[1,0,1]
    v_pk_fma_f32 v[126:127], v[126:127], v[122:123], s[34:35] op_sel_hi:[1,0,1]
    v_lshl_add_u32 v124, v125, 16, v124
    v_lshl_add_u32 v125, v127, 16, v126
    s_waitcnt lgkmcnt(2)
    v_bitop3_b32 v115, v115, v116, v117 bitop3:0xfe
    v_lshl_add_u64 v[124:125], v[124:125], 0, s[36:37]
    v_cmpx_le_u32 vcc, 0x1000000, v69
    ds_add_rtn_u64 v[116:117], v123, v[124:125] offset:54272
    s_mov_b64 exec, -1
    v_ashrrev_i32 v122, 5, v70
    v_lshlrev_b16 v123, 2, v70
    v_lshlrev_b32 v124, 16, v44
    v_bitop3_b32 v122, v122, v113, v113 bitop3:0x0c
    v_and_b32 v125, 0xffff0000, v44
    v_lshlrev_b32 v126, 16, v45
    v_mul_f32 v122, v114, v122
    v_and_b32 v127, 0xffff0000, v45
    v_add_u32 v123, v123, v123
    v_pk_fma_f32 v[124:125], v[124:125], v[122:123], s[34:35] op_sel_hi:[1,0,1]
    v_pk_fma_f32 v[126:127], v[126:127], v[122:123], s[34:35] op_sel_hi:[1,0,1]
    v_lshl_add_u32 v124, v125, 16, v124
    v_lshl_add_u32 v125, v127, 16, v126
    s_waitcnt lgkmcnt(2)
    v_bitop3_b32 v115, v115, v118, v119 bitop3:0xfe
    v_lshl_add_u64 v[124:125], v[124:125], 0, s[36:37]
    v_cmpx_le_u32 vcc, 0x1000000, v70
    ds_add_rtn_u64 v[118:119], v123, v[124:125] offset:54272
    s_mov_b64 exec, -1
    v_ashrrev_i32 v122, 5, v71
    v_lshlrev_b16 v123, 2, v71
    v_lshlrev_b32 v124, 16, v46
    v_bitop3_b32 v122, v122, v113, v113 bitop3:0x0c
    v_and_b32 v125, 0xffff0000, v46
    v_lshlrev_b32 v126, 16, v47
    v_mul_f32 v122, v114, v122
    v_and_b32 v127, 0xffff0000, v47
    v_add_u32 v123, v123, v123
    v_pk_fma_f32 v[124:125], v[124:125], v[122:123], s[34:35] op_sel_hi:[1,0,1]
    v_pk_fma_f32 v[126:127], v[126:127], v[122:123], s[34:35] op_sel_hi:[1,0,1]
    v_lshl_add_u32 v124, v125, 16, v124
    v_lshl_add_u32 v125, v127, 16, v126
    s_waitcnt lgkmcnt(2)
    v_bitop3_b32 v115, v115, v120, v121 bitop3:0xfe
    v_lshl_add_u64 v[124:125], v[124:125], 0, s[36:37]
    v_cmpx_le_u32 vcc, 0x1000000, v71
    ds_add_rtn_u64 v[120:121], v123, v[124:125] offset:54272
    s_mov_b64 exec, -1
    s_branch p2_fin
p2_topf:
    s_cmp_eq_u32 s60, 10
    s_cbranch_scc1 p2_drain1
    s_setprio 3
    v_cmpx_gt_i16 vcc, 0, v48
    ds_read_b64 v[0:1], v0
    s_mov_b64 exec, -1
    v_cmpx_gt_i16 vcc, 0, v49
    ds_read_b64 v[2:3], v2
    s_mov_b64 exec, -1
    v_cmpx_gt_i16 vcc, 0, v50
    ds_read_b64 v[4:5], v4
    s_mov_b64 exec, -1
    v_cmpx_gt_i16 vcc, 0, v51
    ds_read_b64 v[6:7], v6
    s_mov_b64 exec, -1
    v_cmpx_gt_i16 vcc, 0, v52
    ds_read_b64 v[8:9], v8
    s_mov_b64 exec, -1
    v_cmpx_gt_i16 vcc, 0, v53
    ds_read_b64 v[10:11], v10
    s_mov_b64 exec, -1
    v_cmpx_gt_i16 vcc, 0, v54
    ds_read_b64 v[12:13], v12
    s_mov_b64 exec, -1
    v_cmpx_gt_i16 vcc, 0, v55
    ds_read_b64 v[14:15], v14
    s_mov_b64 exec, -1
    v_cmpx_gt_i16 vcc, 0, v56
    ds_read_b64 v[16:17], v16
    s_mov_b64 exec, -1
    s_cmp_lt_u32 s15, 8
    s_cbranch_scc1 p2_g1r23
    v_cmpx_gt_i16 vcc, 0, v57
    ds_read_b64 v[18:19], v18
    s_mov_b64 exec, -1
    v_cmpx_gt_i16 vcc, 0, v58
    ds_read_b64 v[20:21], v20
    s_mov_b64 exec, -1
    v_cmpx_gt_i16 vcc, 0, v59
    ds_read_b64 v[22:23], v22
    s_mov_b64 exec, -1
p2_g1r23:
    s_cmp_ge_u32 s10, 9
    s_cbranch_scc1 p2_nm1m0a
    v_lshrrev_b32 v84, 1, v112
    s_add_u32 s44, s20, s42
    buffer_load_dwordx2 v[84:85], v84, s[4:7], s44 offen
p2_nm1m0a:
    buffer_load_dwordx4 v[72:75], v112, s[4:7], s20 offen offset:0
    buffer_load_dwordx4 v[76:79], v112, s[4:7], s20 offen offset:1024
    buffer_load_dwordx4 v[80:83], v112, s[4:7], s20 offen offset:2048
    v_cmpx_gt_i16 vcc, 0, v60
    ds_read_b64 v[24:25], v24
    s_mov_b64 exec, -1
    v_cmpx_gt_i16 vcc, 0, v61
    ds_read_b64 v[26:27], v26
    s_mov_b64 exec, -1
    v_cmpx_gt_i16 vcc, 0, v62
    ds_read_b64 v[28:29], v28
    s_mov_b64 exec, -1
    v_cmpx_gt_i16 vcc, 0, v63
    ds_read_b64 v[30:31], v30
    s_mov_b64 exec, -1
    v_cmpx_gt_i16 vcc, 0, v64
    ds_read_b64 v[32:33], v32
    s_mov_b64 exec, -1
    v_cmpx_gt_i16 vcc, 0, v65
    ds_read_b64 v[34:35], v34
    s_mov_b64 exec, -1
    v_cmpx_gt_i16 vcc, 0, v66
    ds_read_b64 v[36:37], v36
    s_mov_b64 exec, -1
    v_cmpx_gt_i16 vcc, 0, v67
    ds_read_b64 v[38:39], v38
    s_mov_b64 exec, -1
    v_cmpx_gt_i16 vcc, 0, v68
    ds_read_b64 v[40:41], v40
    s_mov_b64 exec, -1
    v_cmpx_gt_i16 vcc, 0, v69
    ds_read_b64 v[42:43], v42
    s_mov_b64 exec, -1
    v_cmpx_gt_i16 vcc, 0, v70
    ds_read_b64 v[44:45], v44
    s_mov_b64 exec, -1
    v_cmpx_gt_i16 vcc, 0, v71
    ds_read_b64 v[46:47], v46
    s_mov_b64 exec, -1
    s_setprio 2
    s_waitcnt lgkmcnt(15)
    v_ashrrev_i32 v122, 5, v48
    v_lshlrev_b16 v123, 2, v48
    v_cndmask_b32 v126, v0, v1, s[66:67]
    v_bitop3_b32 v122, v122, v113, v113 bitop3:0x0c
    v_lshlrev_b32 v124, 16, v126
    v_mul_f32 v122, v114, v122
    v_and_b32 v125, 0xffff0000, v126
    v_add_u32 v123, v123, v123
    v_mul_f32 v124, v122, v124
    v_mul_f32 v125, v122, v125
    v_cmpx_le_u32 vcc, 0x1000000, v48
    ds_add_f32 v123, v124 offset:54272
    ds_add_f32 v123, v125 offset:54276
    s_mov_b64 exec, -1
    v_ashrrev_i32 v122, 5, v49
    v_lshlrev_b16 v123, 2, v49
    v_cndmask_b32 v126, v2, v3, s[66:67]
    v_bitop3_b32 v122, v122, v113, v113 bitop3:0x0c
    v_lshlrev_b32 v124, 16, v126
    v_mul_f32 v122, v114, v122
    v_and_b32 v125, 0xffff0000, v126
    v_add_u32 v123, v123, v123
    v_mul_f32 v124, v122, v124
    v_mul_f32 v125, v122, v125
    v_cmpx_le_u32 vcc, 0x1000000, v49
    ds_add_f32 v123, v124 offset:54272
    ds_add_f32 v123, v125 offset:54276
    s_mov_b64 exec, -1
    v_ashrrev_i32 v122, 5, v50
    v_lshlrev_b16 v123, 2, v50
    v_cndmask_b32 v126, v4, v5, s[66:67]
    v_bitop3_b32 v122, v122, v113, v113 bitop3:0x0c
    v_lshlrev_b32 v124, 16, v126
    v_mul_f32 v122, v114, v122
    v_and_b32 v125, 0xffff0000, v126
    v_add_u32 v123, v123, v123
    v_mul_f32 v124, v122, v124
    v_mul_f32 v125, v122, v125
    v_cmpx_le_u32 vcc, 0x1000000, v50
    ds_add_f32 v123, v124 offset:54272
    ds_add_f32 v123, v125 offset:54276
    s_mov_b64 exec, -1
    v_bfe_u32 v0, v102, 14, 4
    v_lshrrev_b32 v1, 18, v102
    v_and_b32 v102, 0x3fff, v102
    v_mad_u32_u24 v0, v0, s63, v1
    v_lshl_or_b32 v102, v0, 14, v102
    buffer_load_dwordx4 v[0:3], v102, s[68:71], 0 offen
    s_setprio 1
    s_waitcnt lgkmcnt(15)
    v_ashrrev_i32 v122, 5, v51
    v_lshlrev_b16 v123, 2, v51
    v_cndmask_b32 v126, v6, v7, s[66:67]
    v_bitop3_b32 v122, v122, v113, v113 bitop3:0x0c
    v_lshlrev_b32 v124, 16, v126
    v_mul_f32 v122, v114, v122
    v_and_b32 v125, 0xffff0000, v126
    v_add_u32 v123, v123, v123
    v_mul_f32 v124, v122, v124
    v_mul_f32 v125, v122, v125
    v_cmpx_le_u32 vcc, 0x1000000, v51
    ds_add_f32 v123, v124 offset:54272
    ds_add_f32 v123, v125 offset:54276
    s_mov_b64 exec, -1
    v_ashrrev_i32 v122, 5, v52
    v_lshlrev_b16 v123, 2, v52
    v_cndmask_b32 v126, v8, v9, s[66:67]
    v_bitop3_b32 v122, v122, v113, v113 bitop3:0x0c
    v_lshlrev_b32 v124, 16, v126
    v_mul_f32 v122, v114, v122
    v_and_b32 v125, 0xffff0000, v126
    v_add_u32 v123, v123, v123
    v_mul_f32 v124, v122, v124
    v_mul_f32 v125, v122, v125
    v_cmpx_le_u32 vcc, 0x1000000, v52
    ds_add_f32 v123, v124 offset:54272
    ds_add_f32 v123, v125 offset:54276
    s_mov_b64 exec, -1
    v_ashrrev_i32 v122, 5, v53
    v_lshlrev_b16 v123, 2, v53
    v_cndmask_b32 v126, v10, v11, s[66:67]
    v_bitop3_b32 v122, v122, v113, v113 bitop3:0x0c
    v_lshlrev_b32 v124, 16, v126
    v_mul_f32 v122, v114, v122
    v_and_b32 v125, 0xffff0000, v126
    v_add_u32 v123, v123, v123
    v_mul_f32 v124, v122, v124
    v_mul_f32 v125, v122, v125
    v_cmpx_le_u32 vcc, 0x1000000, v53
    ds_add_f32 v123, v124 offset:54272
    ds_add_f32 v123, v125 offset:54276
    s_mov_b64 exec, -1
    v_bfe_u32 v6, v103, 14, 4
    v_lshrrev_b32 v7, 18, v103
    v_and_b32 v103, 0x3fff, v103
    v_mad_u32_u24 v6, v6, s63, v7
    v_lshl_or_b32 v103, v6, 14, v103
    buffer_load_dwordx4 v[6:9], v103, s[68:71], 0 offen
    s_waitcnt lgkmcnt(12)
    s_barrier
    s_setprio 3
    s_waitcnt vmcnt(5)
    s_mov_b32 m0, s23
    v_mov_b32 v53, 0
    s_movk_i32 s44, 512
    v_sub_u32_sdwa v4, v111, v110 dst_sel:DWORD dst_unused:UNUSED_PAD src0_sel:WORD_0 src1_sel:WORD_0
    v_sub_u32_sdwa v5, v111, v110 dst_sel:DWORD dst_unused:UNUSED_PAD src0_sel:WORD_1 src1_sel:WORD_1
    v_med3_i32 v4, v4, 0, s44
    v_med3_i32 v5, v5, 0, s44
    v_add_u32 v48, v4, v5
    ds_write_addtid_b32 v53 offset:0
    ds_write_addtid_b32 v53 offset:256
    ds_write_addtid_b32 v53 offset:512
    ds_write_addtid_b32 v53 offset:768
    ds_write_addtid_b32 v53 offset:1024
    ds_write_addtid_b32 v53 offset:1280
    ds_write_addtid_b32 v53 offset:1536
    ds_write_addtid_b32 v53 offset:1792
    v_bfe_i32 v53, v112, 6, 1
    v_lshrrev_b32 v49, 6, v112
    v_bitop3_b32 v53, v53, 15, s10 bitop3:0x6a
    v_lshl_or_b32 v49, v49, 4, v53
    v_and_b32 v53, 0x30, v112
    v_lshl_or_b32 v53, v49, 6, v53
    v_lshlrev_b32 v53, 15, v53
    s_nop 1
    v_add_u32_dpp v48, v48, v48 row_shr:1 row_mask:0xf bank_mask:0xf bound_ctrl:0
    s_nop 1
    v_add_u32_dpp v48, v48, v48 row_shr:2 row_mask:0xf bank_mask:0xf bound_ctrl:0
    s_nop 1
    v_add_u32_dpp v48, v48, v48 row_shr:4 row_mask:0xf bank_mask:0xf bound_ctrl:0
    s_nop 1
    v_add_u32_dpp v48, v48, v48 row_shr:8 row_mask:0xf bank_mask:0xf bound_ctrl:0
    s_nop 1
    v_add_u32_dpp v48, v48, v48 row_bcast:15 row_mask:0xa bank_mask:0xf
    s_nop 1
    v_add_u32_dpp v48, v48, v48 row_bcast:31 row_mask:0xc bank_mask:0xf
    s_nop 1
    s_nop 0
    v_readlane_b32 s38, v48, 63
    v_sub_u32 v50, v48, v5
    v_sub_u32 v49, v50, v4
    v_writelane_b32 v5, 1, 63
    v_sub_u32 v10, 512, v49
    v_mad_u32_u16 v51, v110, 16, v53
    v_lshl_add_u32 v51, v10, 4, v51
    v_med3_i32 v10, v10, 0, v4
    v_lshl_add_u32 v49, v49, 2, s23
    v_sub_u32 v11, 512, v50
    v_mad_u32_u16 v52, v110, 16, v53 op_sel:[1,0,0,0]
    v_add_u32 v52, 262144, v52
    s_mov_b32 s44, 0x1fffc000
    v_writelane_b32 v52, s44, 63
    v_lshl_add_u32 v52, v11, 4, v52
    v_med3_i32 v11, v11, 0, v5
    v_lshl_add_u32 v50, v50, 2, s23
    v_lshl_add_u32 v48, v11, 16, v10
    v_add_u32 v110, v110, v48
    s_min_u32 s17, s38, 512
    s_add_u32 s17, s17, 63
    s_lshr_b32 s17, s17, 6
    v_cmpx_lt_i32 vcc, 0, v10
    ds_write_b32 v49, v51
    s_mov_b64 exec, -1
    v_cmpx_lt_i32 vcc, 0, v11
    ds_write_b32 v50, v52
    s_mov_b64 exec, -1
    s_cmp_lt_u32 s38, 512
    s_cbranch_scc1 p2_nomore1x
    v_cmp_lt_u32_sdwa s[44:45], v110, v111 src0_sel:WORD_0 src1_sel:WORD_0
    v_cmp_lt_u32_sdwa s[46:47], v110, v111 src0_sel:WORD_1 src1_sel:WORD_1
    s_nop 0
    s_or_b64 s[44:45], s[44:45], s[46:47]
    s_cbranch_scc0 p2_nomore1x
    v_mov_b32 v49, s19
    v_mov_b32 v50, 1
    ds_write_b32 v49, v50 offset:53760
p2_nomore1x:
    s_setprio 2
    s_waitcnt lgkmcnt(15)
    v_ashrrev_i32 v122, 5, v54
    v_lshlrev_b16 v123, 2, v54
    v_cndmask_b32 v126, v12, v13, s[66:67]
    v_bitop3_b32 v122, v122, v113, v113 bitop3:0x0c
    v_lshlrev_b32 v124, 16, v126
    v_mul_f32 v122, v114, v122
    v_and_b32 v125, 0xffff0000, v126
    v_add_u32 v123, v123, v123
    v_mul_f32 v124, v122, v124
    v_mul_f32 v125, v122, v125
    v_cmpx_le_u32 vcc, 0x1000000, v54
    ds_add_f32 v123, v124 offset:54272
    ds_add_f32 v123, v125 offset:54276
    s_mov_b64 exec, -1
    v_ashrrev_i32 v122, 5, v55
    v_lshlrev_b16 v123, 2, v55
    v_cndmask_b32 v126, v14, v15, s[66:67]
    v_bitop3_b32 v122, v122, v113, v113 bitop3:0x0c
    v_lshlrev_b32 v124, 16, v126
    v_mul_f32 v122, v114, v122
    v_and_b32 v125, 0xffff0000, v126
    v_add_u32 v123, v123, v123
    v_mul_f32 v124, v122, v124
    v_mul_f32 v125, v122, v125
    v_cmpx_le_u32 vcc, 0x1000000, v55
    ds_add_f32 v123, v124 offset:54272
    ds_add_f32 v123, v125 offset:54276
    s_mov_b64 exec, -1
    v_ashrrev_i32 v122, 5, v56
    v_lshlrev_b16 v123, 2, v56
    v_cndmask_b32 v126, v16, v17, s[66:67]
    v_bitop3_b32 v122, v122, v113, v113 bitop3:0x0c
    v_lshlrev_b32 v124, 16, v126
    v_mul_f32 v122, v114, v122
    v_and_b32 v125, 0xffff0000, v126
    v_add_u32 v123, v123, v123
    v_mul_f32 v124, v122, v124
    v_mul_f32 v125, v122, v125
    v_cmpx_le_u32 vcc, 0x1000000, v56
    ds_add_f32 v123, v124 offset:54272
    ds_add_f32 v123, v125 offset:54276
    s_mov_b64 exec, -1
    v_bfe_u32 v12, v104, 14, 4
    v_lshrrev_b32 v13, 18, v104
    v_and_b32 v104, 0x3fff, v104
    v_mad_u32_u24 v12, v12, s63, v13
    v_lshl_or_b32 v104, v12, 14, v104
    buffer_load_dwordx4 v[12:15], v104, s[68:71], 0 offen
    s_cmp_lt_u32 s15, 8
    s_cbranch_scc1 p2_na1a3
    s_waitcnt lgkmcnt(15)
    v_ashrrev_i32 v122, 5, v57
    v_lshlrev_b16 v123, 2, v57
    v_cndmask_b32 v126, v18, v19, s[66:67]
    v_bitop3_b32 v122, v122, v113, v113 bitop3:0x0c
    v_lshlrev_b32 v124, 16, v126
    v_mul_f32 v122, v114, v122
    v_and_b32 v125, 0xffff0000, v126
    v_add_u32 v123, v123, v123
    v_mul_f32 v124, v122, v124
    v_mul_f32 v125, v122, v125
    v_cmpx_le_u32 vcc, 0x1000000, v57
    ds_add_f32 v123, v124 offset:54272
    ds_add_f32 v123, v125 offset:54276
    s_mov_b64 exec, -1
    v_ashrrev_i32 v122, 5, v58
    v_lshlrev_b16 v123, 2, v58
    v_cndmask_b32 v126, v20, v21, s[66:67]
    v_bitop3_b32 v122, v122, v113, v113 bitop3:0x0c
    v_lshlrev_b32 v124, 16, v126
    v_mul_f32 v122, v114, v122
    v_and_b32 v125, 0xffff0000, v126
    v_add_u32 v123, v123, v123
    v_mul_f32 v124, v122, v124
    v_mul_f32 v125, v122, v125
    v_cmpx_le_u32 vcc, 0x1000000, v58
    ds_add_f32 v123, v124 offset:54272
    ds_add_f32 v123, v125 offset:54276
    s_mov_b64 exec, -1
    v_ashrrev_i32 v122, 5, v59
    v_lshlrev_b16 v123, 2, v59
    v_cndmask_b32 v126, v22, v23, s[66:67]
    v_bitop3_b32 v122, v122, v113, v113 bitop3:0x0c
    v_lshlrev_b32 v124, 16, v126
    v_mul_f32 v122, v114, v122
    v_and_b32 v125, 0xffff0000, v126
    v_add_u32 v123, v123, v123
    v_mul_f32 v124, v122, v124
    v_mul_f32 v125, v122, v125
    v_cmpx_le_u32 vcc, 0x1000000, v59
    ds_add_f32 v123, v124 offset:54272
    ds_add_f32 v123, v125 offset:54276
    s_mov_b64 exec, -1
p2_na1a3:
    v_bfe_u32 v18, v105, 14, 4
    v_lshrrev_b32 v19, 18, v105
    v_and_b32 v105, 0x3fff, v105
    v_mad_u32_u24 v18, v18, s63, v19
    v_lshl_or_b32 v105, v18, 14, v105
    buffer_load_dwordx4 v[18:21], v105, s[68:71], 0 offen
    s_mov_b32 m0, s23
    s_nop 0
    ds_read_addtid_b32 v102 offset:1024
    ds_read_addtid_b32 v103 offset:1280
    ds_read_addtid_b32 v104 offset:1536
    ds_read_addtid_b32 v105 offset:1792
    ds_read_addtid_b32 v106 offset:0
    ds_read_addtid_b32 v107 offset:256
    ds_read_addtid_b32 v108 offset:512
    ds_read_addtid_b32 v109 offset:768
    s_waitcnt vmcnt(4)
    s_mov_b32 m0, s24
    s_cmp_ge_u32 s10, 9
    s_cbranch_scc1 p2_st1s0
    ds_write_addtid_b32 v84 offset:49152
    ds_write_addtid_b32 v85 offset:49408
p2_st1s0:
    s_mov_b32 m0, s23
    s_add_u32 s20, s20, 53760
    ds_write_addtid_b32 v72 offset:0
    ds_write_addtid_b32 v73 offset:256
    ds_write_addtid_b32 v74 offset:512
    ds_write_addtid_b32 v75 offset:768
    ds_write_addtid_b32 v76 offset:1024
    ds_write_addtid_b32 v77 offset:1280
    ds_write_addtid_b32 v78 offset:1536
    ds_write_addtid_b32 v79 offset:1792
    ds_write_addtid_b32 v80 offset:2048
    ds_write_addtid_b32 v81 offset:2304
    ds_write_addtid_b32 v82 offset:2560
    ds_write_addtid_b32 v83 offset:2816
    s_setprio 1
    s_waitcnt lgkmcnt(15)
    v_ashrrev_i32 v122, 5, v60
    v_lshlrev_b16 v123, 2, v60
    v_cndmask_b32 v126, v24, v25, s[66:67]
    v_bitop3_b32 v122, v122, v113, v113 bitop3:0x0c
    v_lshlrev_b32 v124, 16, v126
    v_mul_f32 v122, v114, v122
    v_and_b32 v125, 0xffff0000, v126
    v_add_u32 v123, v123, v123
    v_mul_f32 v124, v122, v124
    v_mul_f32 v125, v122, v125
    v_cmpx_le_u32 vcc, 0x1000000, v60
    ds_add_f32 v123, v124 offset:54272
    ds_add_f32 v123, v125 offset:54276
    s_mov_b64 exec, -1
    v_ashrrev_i32 v122, 5, v61
    v_lshlrev_b16 v123, 2, v61
    v_cndmask_b32 v126, v26, v27, s[66:67]
    v_bitop3_b32 v122, v122, v113, v113 bitop3:0x0c
    v_lshlrev_b32 v124, 16, v126
    v_mul_f32 v122, v114, v122
    v_and_b32 v125, 0xffff0000, v126
    v_add_u32 v123, v123, v123
    v_mul_f32 v124, v122, v124
    v_mul_f32 v125, v122, v125
    v_cmpx_le_u32 vcc, 0x1000000, v61
    ds_add_f32 v123, v124 offset:54272
    ds_add_f32 v123, v125 offset:54276
    s_mov_b64 exec, -1
    v_ashrrev_i32 v122, 5, v62
    v_lshlrev_b16 v123, 2, v62
    v_cndmask_b32 v126, v28, v29, s[66:67]
    v_bitop3_b32 v122, v122, v113, v113 bitop3:0x0c
    v_lshlrev_b32 v124, 16, v126
    v_mul_f32 v122, v114, v122
    v_and_b32 v125, 0xffff0000, v126
    v_add_u32 v123, v123, v123
    v_mul_f32 v124, v122, v124
    v_mul_f32 v125, v122, v125
    v_cmpx_le_u32 vcc, 0x1000000, v62
    ds_add_f32 v123, v124 offset:54272
    ds_add_f32 v123, v125 offset:54276
    s_mov_b64 exec, -1
    s_waitcnt vmcnt(16)
    v_perm_b32 v60, v89, v86, s31
    v_perm_b32 v61, v89, v87, s32
    v_perm_b32 v62, v89, v88, s33
    v_lshlrev_b16 v28, 3, v88
    v_lshlrev_b16 v26, 3, v87
    v_lshlrev_b16 v24, 3, v86
    s_waitcnt lgkmcnt(15)
    s_nop 2
    s_nop 1
    v_max_u32_dpp v106, v106, v106 row_shr:1 row_mask:0xf bank_mask:0xf bound_ctrl:0
    v_max_u32_dpp v107, v107, v107 row_shr:1 row_mask:0xf bank_mask:0xf bound_ctrl:0
    s_nop 0
    v_max_u32_dpp v106, v106, v106 row_shr:2 row_mask:0xf bank_mask:0xf bound_ctrl:0
    v_max_u32_dpp v107, v107, v107 row_shr:2 row_mask:0xf bank_mask:0xf bound_ctrl:0
    s_nop 0
    v_max_u32_dpp v106, v106, v106 row_shr:4 row_mask:0xf bank_mask:0xf bound_ctrl:0
    v_max_u32_dpp v107, v107, v107 row_shr:4 row_mask:0xf bank_mask:0xf bound_ctrl:0
    s_nop 0
    v_max_u32_dpp v106, v106, v106 row_shr:8 row_mask:0xf bank_mask:0xf bound_ctrl:0
    v_max_u32_dpp v107, v107, v107 row_shr:8 row_mask:0xf bank_mask:0xf bound_ctrl:0
    s_nop 0
    v_max_u32_dpp v106, v106, v106 row_bcast:15 row_mask:0xa bank_mask:0xf
    v_max_u32_dpp v107, v107, v107 row_bcast:15 row_mask:0xa bank_mask:0xf
    s_nop 0
    v_max_u32_dpp v106, v106, v106 row_bcast:31 row_mask:0xc bank_mask:0xf
    v_max_u32_dpp v107, v107, v107 row_bcast:31 row_mask:0xc bank_mask:0xf
    s_nop 0
    s_nop 0
    v_readlane_b32 s41, v106, 63
    v_add_u32 v106, v106, v112
    v_add_u32 v106, 4294959104, v106
    v_max_u32 v107, s41, v107
    s_nop 0
    v_readlane_b32 s41, v107, 63
    v_add_u32 v107, v107, v112
    v_add_u32 v107, 4294960128, v107
    v_bfe_u32 v86, v106, 14, 4
    v_lshrrev_b32 v87, 18, v106
    v_and_b32 v106, 0x3fff, v106
    v_mad_u32_u24 v86, v86, s63, v87
    v_lshl_or_b32 v106, v86, 14, v106
    buffer_load_dwordx4 v[86:89], v106, s[68:71], 0 offen
    s_setprio 0
    s_waitcnt lgkmcnt(15)
    v_ashrrev_i32 v122, 5, v63
    v_lshlrev_b16 v123, 2, v63
    v_cndmask_b32 v126, v30, v31, s[66:67]
    v_bitop3_b32 v122, v122, v113, v113 bitop3:0x0c
    v_lshlrev_b32 v124, 16, v126
    v_mul_f32 v122, v114, v122
    v_and_b32 v125, 0xffff0000, v126
    v_add_u32 v123, v123, v123
    v_mul_f32 v124, v122, v124
    v_mul_f32 v125, v122, v125
    v_cmpx_le_u32 vcc, 0x1000000, v63
    ds_add_f32 v123, v124 offset:54272
    ds_add_f32 v123, v125 offset:54276
    s_mov_b64 exec, -1
    v_ashrrev_i32 v122, 5, v64
    v_lshlrev_b16 v123, 2, v64
    v_cndmask_b32 v126, v32, v33, s[66:67]
    v_bitop3_b32 v122, v122, v113, v113 bitop3:0x0c
    v_lshlrev_b32 v124, 16, v126
    v_mul_f32 v122, v114, v122
    v_and_b32 v125, 0xffff0000, v126
    v_add_u32 v123, v123, v123
    v_mul_f32 v124, v122, v124
    v_mul_f32 v125, v122, v125
    v_cmpx_le_u32 vcc, 0x1000000, v64
    ds_add_f32 v123, v124 offset:54272
    ds_add_f32 v123, v125 offset:54276
    s_mov_b64 exec, -1
    v_ashrrev_i32 v122, 5, v65
    v_lshlrev_b16 v123, 2, v65
    v_cndmask_b32 v126, v34, v35, s[66:67]
    v_bitop3_b32 v122, v122, v113, v113 bitop3:0x0c
    v_lshlrev_b32 v124, 16, v126
    v_mul_f32 v122, v114, v122
    v_and_b32 v125, 0xffff0000, v126
    v_add_u32 v123, v123, v123
    v_mul_f32 v124, v122, v124
    v_mul_f32 v125, v122, v125
    v_cmpx_le_u32 vcc, 0x1000000, v65
    ds_add_f32 v123, v124 offset:54272
    ds_add_f32 v123, v125 offset:54276
    s_mov_b64 exec, -1
    s_waitcnt vmcnt(13)
    v_perm_b32 v63, v93, v90, s31
    v_perm_b32 v64, v93, v91, s32
    v_perm_b32 v65, v93, v92, s33
    v_lshlrev_b16 v34, 3, v92
    v_lshlrev_b16 v32, 3, v91
    v_lshlrev_b16 v30, 3, v90
    s_waitcnt lgkmcnt(12)
    s_barrier
    s_setprio 3
    s_cmp_ge_u32 s10, 9
    s_cbranch_scc1 p2_nm1m1a
    v_lshrrev_b32 v84, 1, v112
    s_add_u32 s44, s20, s42
    buffer_load_dwordx2 v[84:85], v84, s[4:7], s44 offen
p2_nm1m1a:
    buffer_load_dwordx4 v[72:75], v112, s[4:7], s20 offen offset:0
    buffer_load_dwordx4 v[76:79], v112, s[4:7], s20 offen offset:1024
    buffer_load_dwordx4 v[80:83], v112, s[4:7], s20 offen offset:2048
    v_cmpx_ge_u16 vcc, 0x3fff, v60
    ds_read_b64 v[24:25], v24
    s_mov_b64 exec, -1
    v_cmpx_ge_u16 vcc, 0x3fff, v61
    ds_read_b64 v[26:27], v26
    s_mov_b64 exec, -1
    v_cmpx_ge_u16 vcc, 0x3fff, v62
    ds_read_b64 v[28:29], v28
    s_mov_b64 exec, -1
    v_cmpx_ge_u16 vcc, 0x3fff, v63
    ds_read_b64 v[30:31], v30
    s_mov_b64 exec, -1
    v_cmpx_ge_u16 vcc, 0x3fff, v64
    ds_read_b64 v[32:33], v32
    s_mov_b64 exec, -1
    v_cmpx_ge_u16 vcc, 0x3fff, v65
    ds_read_b64 v[34:35], v34
    s_mov_b64 exec, -1
    s_setprio 2
    s_waitcnt lgkmcnt(15)
    v_ashrrev_i32 v122, 5, v66
    v_lshlrev_b16 v123, 2, v66
    v_cndmask_b32 v126, v36, v37, s[66:67]
    v_bitop3_b32 v122, v122, v113, v113 bitop3:0x0c
    v_lshlrev_b32 v124, 16, v126
    v_mul_f32 v122, v114, v122
    v_and_b32 v125, 0xffff0000, v126
    v_add_u32 v123, v123, v123
    v_mul_f32 v124, v122, v124
    v_mul_f32 v125, v122, v125
    v_cmpx_le_u32 vcc, 0x1000000, v66
    ds_add_f32 v123, v124 offset:54272
    ds_add_f32 v123, v125 offset:54276
    s_mov_b64 exec, -1
    v_ashrrev_i32 v122, 5, v67
    v_lshlrev_b16 v123, 2, v67
    v_cndmask_b32 v126, v38, v39, s[66:67]
    v_bitop3_b32 v122, v122, v113, v113 bitop3:0x0c
    v_lshlrev_b32 v124, 16, v126
    v_mul_f32 v122, v114, v122
    v_and_b32 v125, 0xffff0000, v126
    v_add_u32 v123, v123, v123
    v_mul_f32 v124, v122, v124
    v_mul_f32 v125, v122, v125
    v_cmpx_le_u32 vcc, 0x1000000, v67
    ds_add_f32 v123, v124 offset:54272
    ds_add_f32 v123, v125 offset:54276
    s_mov_b64 exec, -1
    v_ashrrev_i32 v122, 5, v68
    v_lshlrev_b16 v123, 2, v68
    v_cndmask_b32 v126, v40, v41, s[66:67]
    v_bitop3_b32 v122, v122, v113, v113 bitop3:0x0c
    v_lshlrev_b32 v124, 16, v126
    v_mul_f32 v122, v114, v122
    v_and_b32 v125, 0xffff0000, v126
    v_add_u32 v123, v123, v123
    v_mul_f32 v124, v122, v124
    v_mul_f32 v125, v122, v125
    v_cmpx_le_u32 vcc, 0x1000000, v68
    ds_add_f32 v123, v124 offset:54272
    ds_add_f32 v123, v125 offset:54276
    s_mov_b64 exec, -1
    s_waitcnt vmcnt(15)
    v_perm_b32 v66, v97, v94, s31
    v_perm_b32 v67, v97, v95, s32
    v_perm_b32 v68, v97, v96, s33
    v_lshlrev_b16 v40, 3, v96
    v_lshlrev_b16 v38, 3, v95
    v_lshlrev_b16 v36, 3, v94
    v_cmpx_ge_u16 vcc, 0x3fff, v66
    ds_read_b64 v[36:37], v36
    s_mov_b64 exec, -1
    v_cmpx_ge_u16 vcc, 0x3fff, v67
    ds_read_b64 v[38:39], v38
    s_mov_b64 exec, -1
    v_cmpx_ge_u16 vcc, 0x3fff, v68
    ds_read_b64 v[40:41], v40
    s_mov_b64 exec, -1
    v_bfe_u32 v90, v107, 14, 4
    v_lshrrev_b32 v91, 18, v107
    v_and_b32 v107, 0x3fff, v107
    v_mad_u32_u24 v90, v90, s63, v91
    v_lshl_or_b32 v107, v90, 14, v107
    buffer_load_dwordx4 v[90:93], v107, s[68:71], 0 offen
    s_setprio 1
    s_waitcnt lgkmcnt(15)
    v_ashrrev_i32 v122, 5, v69
    v_lshlrev_b16 v123, 2, v69
    v_cndmask_b32 v126, v42, v43, s[66:67]
    v_bitop3_b32 v122, v122, v113, v113 bitop3:0x0c
    v_lshlrev_b32 v124, 16, v126
    v_mul_f32 v122, v114, v122
    v_and_b32 v125, 0xffff0000, v126
    v_add_u32 v123, v123, v123
    v_mul_f32 v124, v122, v124
    v_mul_f32 v125, v122, v125
    v_cmpx_le_u32 vcc, 0x1000000, v69
    ds_add_f32 v123, v124 offset:54272
    ds_add_f32 v123, v125 offset:54276
    s_mov_b64 exec, -1
    v_ashrrev_i32 v122, 5, v70
    v_lshlrev_b16 v123, 2, v70
    v_cndmask_b32 v126, v44, v45, s[66:67]
    v_bitop3_b32 v122, v122, v113, v113 bitop3:0x0c
    v_lshlrev_b32 v124, 16, v126
    v_mul_f32 v122, v114, v122
    v_and_b32 v125, 0xffff0000, v126
    v_add_u32 v123, v123, v123
    v_mul_f32 v124, v122, v124
    v_mul_f32 v125, v122, v125
    v_cmpx_le_u32 vcc, 0x1000000, v70
    ds_add_f32 v123, v124 offset:54272
    ds_add_f32 v123, v125 offset:54276
    s_mov_b64 exec, -1
    v_ashrrev_i32 v122, 5, v71
    v_lshlrev_b16 v123, 2, v71
    v_cndmask_b32 v126, v46, v47, s[66:67]
    v_bitop3_b32 v122, v122, v113, v113 bitop3:0x0c
    v_lshlrev_b32 v124, 16, v126
    v_mul_f32 v122, v114, v122
    v_and_b32 v125, 0xffff0000, v126
    v_add_u32 v123, v123, v123
    v_mul_f32 v124, v122, v124
    v_mul_f32 v125, v122, v125
    v_cmpx_le_u32 vcc, 0x1000000, v71
    ds_add_f32 v123, v124 offset:54272
    ds_add_f32 v123, v125 offset:54276
    s_mov_b64 exec, -1
    s_waitcnt vmcnt(12)
    v_perm_b32 v69, v101, v98, s31
    v_perm_b32 v70, v101, v99, s32
    v_perm_b32 v71, v101, v100, s33
    v_lshlrev_b16 v46, 3, v100
    v_lshlrev_b16 v44, 3, v99
    v_lshlrev_b16 v42, 3, v98
    v_cmpx_ge_u16 vcc, 0x3fff, v69
    ds_read_b64 v[42:43], v42
    s_mov_b64 exec, -1
    v_cmpx_ge_u16 vcc, 0x3fff, v70
    ds_read_b64 v[44:45], v44
    s_mov_b64 exec, -1
    v_cmpx_ge_u16 vcc, 0x3fff, v71
    ds_read_b64 v[46:47], v46
    s_mov_b64 exec, -1
    s_waitcnt lgkmcnt(15)
    s_nop 2
    s_nop 1
    v_max_u32_dpp v108, v108, v108 row_shr:1 row_mask:0xf bank_mask:0xf bound_ctrl:0
    v_max_u32_dpp v109, v109, v109 row_shr:1 row_mask:0xf bank_mask:0xf bound_ctrl:0
    s_nop 0
    v_max_u32_dpp v108, v108, v108 row_shr:2 row_mask:0xf bank_mask:0xf bound_ctrl:0
    v_max_u32_dpp v109, v109, v109 row_shr:2 row_mask:0xf bank_mask:0xf bound_ctrl:0
    s_nop 0
    v_max_u32_dpp v108, v108, v108 row_shr:4 row_mask:0xf bank_mask:0xf bound_ctrl:0
    v_max_u32_dpp v109, v109, v109 row_shr:4 row_mask:0xf bank_mask:0xf bound_ctrl:0
    s_nop 0
    v_max_u32_dpp v108, v108, v108 row_shr:8 row_mask:0xf bank_mask:0xf bound_ctrl:0
    v_max_u32_dpp v109, v109, v109 row_shr:8 row_mask:0xf bank_mask:0xf bound_ctrl:0
    s_nop 0
    v_max_u32_dpp v108, v108, v108 row_bcast:15 row_mask:0xa bank_mask:0xf
    v_max_u32_dpp v109, v109, v109 row_bcast:15 row_mask:0xa bank_mask:0xf
    s_nop 0
    v_max_u32_dpp v108, v108, v108 row_bcast:31 row_mask:0xc bank_mask:0xf
    v_max_u32_dpp v109, v109, v109 row_bcast:31 row_mask:0xc bank_mask:0xf
    s_nop 0
    s_nop 0
    v_max_u32 v108, s41, v108
    s_nop 0
    v_readlane_b32 s41, v108, 63
    v_add_u32 v108, v108, v112
    v_add_u32 v108, 4294961152, v108
    v_max_u32 v109, s41, v109
    s_nop 0
    v_readlane_b32 s41, v109, 63
    v_add_u32 v109, v109, v112
    v_add_u32 v109, 4294962176, v109
    v_bfe_u32 v94, v108, 14, 4
    v_lshrrev_b32 v95, 18, v108
    v_and_b32 v108, 0x3fff, v108
    v_mad_u32_u24 v94, v94, s63, v95
    v_lshl_or_b32 v108, v94, 14, v108
    buffer_load_dwordx4 v[94:97], v108, s[68:71], 0 offen
    s_setprio 0
    s_waitcnt vmcnt(9)
    v_perm_b32 v48, v3, v0, s31
    v_perm_b32 v49, v3, v1, s32
    v_perm_b32 v50, v3, v2, s33
    v_lshlrev_b16 v4, 3, v2
    v_lshlrev_b16 v2, 3, v1
    v_lshlrev_b16 v0, 3, v0
    v_cmpx_ge_u16 vcc, 0x3fff, v48
    ds_read_b64 v[0:1], v0
    s_mov_b64 exec, -1
    v_cmpx_ge_u16 vcc, 0x3fff, v49
    ds_read_b64 v[2:3], v2
    s_mov_b64 exec, -1
    v_cmpx_ge_u16 vcc, 0x3fff, v50
    ds_read_b64 v[4:5], v4
    s_mov_b64 exec, -1
    s_waitcnt vmcnt(8)
    v_perm_b32 v51, v9, v6, s31
    v_perm_b32 v52, v9, v7, s32
    v_perm_b32 v53, v9, v8, s33
    v_lshlrev_b16 v10, 3, v8
    v_lshlrev_b16 v8, 3, v7
    v_lshlrev_b16 v6, 3, v6
    v_cmpx_ge_u16 vcc, 0x3fff, v51
    ds_read_b64 v[6:7], v6
    s_mov_b64 exec, -1
    v_cmpx_ge_u16 vcc, 0x3fff, v52
    ds_read_b64 v[8:9], v8
    s_mov_b64 exec, -1
    v_cmpx_ge_u16 vcc, 0x3fff, v53
    ds_read_b64 v[10:11], v10
    s_mov_b64 exec, -1
    s_waitcnt vmcnt(7)
    v_perm_b32 v54, v15, v12, s31
    v_perm_b32 v55, v15, v13, s32
    v_perm_b32 v56, v15, v14, s33
    v_lshlrev_b16 v16, 3, v14
    v_lshlrev_b16 v14, 3, v13
    v_lshlrev_b16 v12, 3, v12
    v_cmpx_ge_u16 vcc, 0x3fff, v54
    ds_read_b64 v[12:13], v12
    s_mov_b64 exec, -1
    v_cmpx_ge_u16 vcc, 0x3fff, v55
    ds_read_b64 v[14:15], v14
    s_mov_b64 exec, -1
    v_cmpx_ge_u16 vcc, 0x3fff, v56
    ds_read_b64 v[16:17], v16
    s_mov_b64 exec, -1
    s_waitcnt vmcnt(6)
    v_perm_b32 v57, v21, v18, s31
    v_perm_b32 v58, v21, v19, s32
    v_perm_b32 v59, v21, v20, s33
    v_lshlrev_b16 v22, 3, v20
    v_lshlrev_b16 v20, 3, v19
    v_lshlrev_b16 v18, 3, v18
    s_cmp_lt_u32 s16, 8
    s_cbranch_scc1 p2_g1r03
    v_cmpx_ge_u16 vcc, 0x3fff, v57
    ds_read_b64 v[18:19], v18
    s_mov_b64 exec, -1
    v_cmpx_ge_u16 vcc, 0x3fff, v58
    ds_read_b64 v[20:21], v20
    s_mov_b64 exec, -1
    v_cmpx_ge_u16 vcc, 0x3fff, v59
    ds_read_b64 v[22:23], v22
    s_mov_b64 exec, -1
p2_g1r03:
    s_waitcnt lgkmcnt(0)
    s_barrier
    s_waitcnt lgkmcnt(15)
    s_branch p2_tail
p2_drain1:
    v_cmpx_gt_i16 vcc, 0, v48
    ds_read_b64 v[0:1], v0
    s_mov_b64 exec, -1
    v_cmpx_gt_i16 vcc, 0, v49
    ds_read_b64 v[2:3], v2
    s_mov_b64 exec, -1
    v_cmpx_gt_i16 vcc, 0, v50
    ds_read_b64 v[4:5], v4
    s_mov_b64 exec, -1
    v_cmpx_gt_i16 vcc, 0, v51
    ds_read_b64 v[6:7], v6
    s_mov_b64 exec, -1
    v_cmpx_gt_i16 vcc, 0, v52
    ds_read_b64 v[8:9], v8
    s_mov_b64 exec, -1
    v_cmpx_gt_i16 vcc, 0, v53
    ds_read_b64 v[10:11], v10
    s_mov_b64 exec, -1
    v_cmpx_gt_i16 vcc, 0, v54
    ds_read_b64 v[12:13], v12
    s_mov_b64 exec, -1
    v_cmpx_gt_i16 vcc, 0, v55
    ds_read_b64 v[14:15], v14
    s_mov_b64 exec, -1
    v_cmpx_gt_i16 vcc, 0, v56
    ds_read_b64 v[16:17], v16
    s_mov_b64 exec, -1
    s_cmp_lt_u32 s15, 8
    s_cbranch_scc1 p2_gd1
    v_cmpx_gt_i16 vcc, 0, v57
    ds_read_b64 v[18:19], v18
    s_mov_b64 exec, -1
    v_cmpx_gt_i16 vcc, 0, v58
    ds_read_b64 v[20:21], v20
    s_mov_b64 exec, -1
    v_cmpx_gt_i16 vcc, 0, v59
    ds_read_b64 v[22:23], v22
    s_mov_b64 exec, -1
p2_gd1:
    v_cmpx_gt_i16 vcc, 0, v60
    ds_read_b64 v[24:25], v24
    s_mov_b64 exec, -1
    v_cmpx_gt_i16 vcc, 0, v61
    ds_read_b64 v[26:27], v26
    s_mov_b64 exec, -1
    v_cmpx_gt_i16 vcc, 0, v62
    ds_read_b64 v[28:29], v28
    s_mov_b64 exec, -1
    v_cmpx_gt_i16 vcc, 0, v63
    ds_read_b64 v[30:31], v30
    s_mov_b64 exec, -1
    v_cmpx_gt_i16 vcc, 0, v64
    ds_read_b64 v[32:33], v32
    s_mov_b64 exec, -1
    v_cmpx_gt_i16 vcc, 0, v65
    ds_read_b64 v[34:35], v34
    s_mov_b64 exec, -1
    v_cmpx_gt_i16 vcc, 0, v66
    ds_read_b64 v[36:37], v36
    s_mov_b64 exec, -1
    v_cmpx_gt_i16 vcc, 0, v67
    ds_read_b64 v[38:39], v38
    s_mov_b64 exec, -1
    v_cmpx_gt_i16 vcc, 0, v68
    ds_read_b64 v[40:41], v40
    s_mov_b64 exec, -1
    v_cmpx_gt_i16 vcc, 0, v69
    ds_read_b64 v[42:43], v42
    s_mov_b64 exec, -1
    v_cmpx_gt_i16 vcc, 0, v70
    ds_read_b64 v[44:45], v44
    s_mov_b64 exec, -1
    v_cmpx_gt_i16 vcc, 0, v71
    ds_read_b64 v[46:47], v46
    s_mov_b64 exec, -1
    s_waitcnt lgkmcnt(15)
    v_ashrrev_i32 v122, 5, v48
    v_lshlrev_b16 v123, 2, v48
    v_cndmask_b32 v126, v0, v1, s[66:67]
    v_bitop3_b32 v122, v122, v113, v113 bitop3:0x0c
    v_lshlrev_b32 v124, 16, v126
    v_mul_f32 v122, v114, v122
    v_and_b32 v125, 0xffff0000, v126
    v_add_u32 v123, v123, v123
    v_mul_f32 v124, v122, v124
    v_mul_f32 v125, v122, v125
    v_cmpx_le_u32 vcc, 0x1000000, v48
    ds_add_f32 v123, v124 offset:54272
    ds_add_f32 v123, v125 offset:54276
    s_mov_b64 exec, -1
    v_ashrrev_i32 v122, 5, v49
    v_lshlrev_b16 v123, 2, v49
    v_cndmask_b32 v126, v2, v3, s[66:67]
    v_bitop3_b32 v122, v122, v113, v113 bitop3:0x0c
    v_lshlrev_b32 v124, 16, v126
    v_mul_f32 v122, v114, v122
    v_and_b32 v125, 0xffff0000, v126
    v_add_u32 v123, v123, v123
    v_mul_f32 v124, v122, v124
    v_mul_f32 v125, v122, v125
    v_cmpx_le_u32 vcc, 0x1000000, v49
    ds_add_f32 v123, v124 offset:54272
    ds_add_f32 v123, v125 offset:54276
    s_mov_b64 exec, -1
    v_ashrrev_i32 v122, 5, v50
    v_lshlrev_b16 v123, 2, v50
    v_cndmask_b32 v126, v4, v5, s[66:67]
    v_bitop3_b32 v122, v122, v113, v113 bitop3:0x0c
    v_lshlrev_b32 v124, 16, v126
    v_mul_f32 v122, v114, v122
    v_and_b32 v125, 0xffff0000, v126
    v_add_u32 v123, v123, v123
    v_mul_f32 v124, v122, v124
    v_mul_f32 v125, v122, v125
    v_cmpx_le_u32 vcc, 0x1000000, v50
    ds_add_f32 v123, v124 offset:54272
    ds_add_f32 v123, v125 offset:54276
    s_mov_b64 exec, -1
    s_waitcnt lgkmcnt(15)
    v_ashrrev_i32 v122, 5, v51
    v_lshlrev_b16 v123, 2, v51
    v_cndmask_b32 v126, v6, v7, s[66:67]
    v_bitop3_b32 v122, v122, v113, v113 bitop3:0x0c
    v_lshlrev_b32 v124, 16, v126
    v_mul_f32 v122, v114, v122
    v_and_b32 v125, 0xffff0000, v126
    v_add_u32 v123, v123, v123
    v_mul_f32 v124, v122, v124
    v_mul_f32 v125, v122, v125
    v_cmpx_le_u32 vcc, 0x1000000, v51
    ds_add_f32 v123, v124 offset:54272
    ds_add_f32 v123, v125 offset:54276
    s_mov_b64 exec, -1
    v_ashrrev_i32 v122, 5, v52
    v_lshlrev_b16 v123, 2, v52
    v_cndmask_b32 v126, v8, v9, s[66:67]
    v_bitop3_b32 v122, v122, v113, v113 bitop3:0x0c
    v_lshlrev_b32 v124, 16, v126
    v_mul_f32 v122, v114, v122
    v_and_b32 v125, 0xffff0000, v126
    v_add_u32 v123, v123, v123
    v_mul_f32 v124, v122, v124
    v_mul_f32 v125, v122, v125
    v_cmpx_le_u32 vcc, 0x1000000, v52
    ds_add_f32 v123, v124 offset:54272
    ds_add_f32 v123, v125 offset:54276
    s_mov_b64 exec, -1
    v_ashrrev_i32 v122, 5, v53
    v_lshlrev_b16 v123, 2, v53
    v_cndmask_b32 v126, v10, v11, s[66:67]
    v_bitop3_b32 v122, v122, v113, v113 bitop3:0x0c
    v_lshlrev_b32 v124, 16, v126
    v_mul_f32 v122, v114, v122
    v_and_b32 v125, 0xffff0000, v126
    v_add_u32 v123, v123, v123
    v_mul_f32 v124, v122, v124
    v_mul_f32 v125, v122, v125
    v_cmpx_le_u32 vcc, 0x1000000, v53
    ds_add_f32 v123, v124 offset:54272
    ds_add_f32 v123, v125 offset:54276
    s_mov_b64 exec, -1
    s_waitcnt lgkmcnt(15)
    v_ashrrev_i32 v122, 5, v54
    v_lshlrev_b16 v123, 2, v54
    v_cndmask_b32 v126, v12, v13, s[66:67]
    v_bitop3_b32 v122, v122, v113, v113 bitop3:0x0c
    v_lshlrev_b32 v124, 16, v126
    v_mul_f32 v122, v114, v122
    v_and_b32 v125, 0xffff0000, v126
    v_add_u32 v123, v123, v123
    v_mul_f32 v124, v122, v124
    v_mul_f32 v125, v122, v125
    v_cmpx_le_u32 vcc, 0x1000000, v54
    ds_add_f32 v123, v124 offset:54272
    ds_add_f32 v123, v125 offset:54276
    s_mov_b64 exec, -1
    v_ashrrev_i32 v122, 5, v55
    v_lshlrev_b16 v123, 2, v55
    v_cndmask_b32 v126, v14, v15, s[66:67]
    v_bitop3_b32 v122, v122, v113, v113 bitop3:0x0c
    v_lshlrev_b32 v124, 16, v126
    v_mul_f32 v122, v114, v122
    v_and_b32 v125, 0xffff0000, v126
    v_add_u32 v123, v123, v123
    v_mul_f32 v124, v122, v124
    v_mul_f32 v125, v122, v125
    v_cmpx_le_u32 vcc, 0x1000000, v55
    ds_add_f32 v123, v124 offset:54272
    ds_add_f32 v123, v125 offset:54276
    s_mov_b64 exec, -1
    v_ashrrev_i32 v122, 5, v56
    v_lshlrev_b16 v123, 2, v56
    v_cndmask_b32 v126, v16, v17, s[66:67]
    v_bitop3_b32 v122, v122, v113, v113 bitop3:0x0c
    v_lshlrev_b32 v124, 16, v126
    v_mul_f32 v122, v114, v122
    v_and_b32 v125, 0xffff0000, v126
    v_add_u32 v123, v123, v123
    v_mul_f32 v124, v122, v124
    v_mul_f32 v125, v122, v125
    v_cmpx_le_u32 vcc, 0x1000000, v56
    ds_add_f32 v123, v124 offset:54272
    ds_add_f32 v123, v125 offset:54276
    s_mov_b64 exec, -1
    s_cmp_lt_u32 s15, 8
    s_cbranch_scc1 p2_nad1
    s_waitcnt lgkmcnt(15)
    v_ashrrev_i32 v122, 5, v57
    v_lshlrev_b16 v123, 2, v57
    v_cndmask_b32 v126, v18, v19, s[66:67]
    v_bitop3_b32 v122, v122, v113, v113 bitop3:0x0c
    v_lshlrev_b32 v124, 16, v126
    v_mul_f32 v122, v114, v122
    v_and_b32 v125, 0xffff0000, v126
    v_add_u32 v123, v123, v123
    v_mul_f32 v124, v122, v124
    v_mul_f32 v125, v122, v125
    v_cmpx_le_u32 vcc, 0x1000000, v57
    ds_add_f32 v123, v124 offset:54272
    ds_add_f32 v123, v125 offset:54276
    s_mov_b64 exec, -1
    v_ashrrev_i32 v122, 5, v58
    v_lshlrev_b16 v123, 2, v58
    v_cndmask_b32 v126, v20, v21, s[66:67]
    v_bitop3_b32 v122, v122, v113, v113 bitop3:0x0c
    v_lshlrev_b32 v124, 16, v126
    v_mul_f32 v122, v114, v122
    v_and_b32 v125, 0xffff0000, v126
    v_add_u32 v123, v123, v123
    v_mul_f32 v124, v122, v124
    v_mul_f32 v125, v122, v125
    v_cmpx_le_u32 vcc, 0x1000000, v58
    ds_add_f32 v123, v124 offset:54272
    ds_add_f32 v123, v125 offset:54276
    s_mov_b64 exec, -1
    v_ashrrev_i32 v122, 5, v59
    v_lshlrev_b16 v123, 2, v59
    v_cndmask_b32 v126, v22, v23, s[66:67]
    v_bitop3_b32 v122, v122, v113, v113 bitop3:0x0c
    v_lshlrev_b32 v124, 16, v126
    v_mul_f32 v122, v114, v122
    v_and_b32 v125, 0xffff0000, v126
    v_add_u32 v123, v123, v123
    v_mul_f32 v124, v122, v124
    v_mul_f32 v125, v122, v125
    v_cmpx_le_u32 vcc, 0x1000000, v59
    ds_add_f32 v123, v124 offset:54272
    ds_add_f32 v123, v125 offset:54276
    s_mov_b64 exec, -1
p2_nad1:
    s_waitcnt lgkmcnt(15)
    v_ashrrev_i32 v122, 5, v60
    v_lshlrev_b16 v123, 2, v60
    v_cndmask_b32 v126, v24, v25, s[66:67]
    v_bitop3_b32 v122, v122, v113, v113 bitop3:0x0c
    v_lshlrev_b32 v124, 16, v126
    v_mul_f32 v122, v114, v122
    v_and_b32 v125, 0xffff0000, v126
    v_add_u32 v123, v123, v123
    v_mul_f32 v124, v122, v124
    v_mul_f32 v125, v122, v125
    v_cmpx_le_u32 vcc, 0x1000000, v60
    ds_add_f32 v123, v124 offset:54272
    ds_add_f32 v123, v125 offset:54276
    s_mov_b64 exec, -1
    v_ashrrev_i32 v122, 5, v61
    v_lshlrev_b16 v123, 2, v61
    v_cndmask_b32 v126, v26, v27, s[66:67]
    v_bitop3_b32 v122, v122, v113, v113 bitop3:0x0c
    v_lshlrev_b32 v124, 16, v126
    v_mul_f32 v122, v114, v122
    v_and_b32 v125, 0xffff0000, v126
    v_add_u32 v123, v123, v123
    v_mul_f32 v124, v122, v124
    v_mul_f32 v125, v122, v125
    v_cmpx_le_u32 vcc, 0x1000000, v61
    ds_add_f32 v123, v124 offset:54272
    ds_add_f32 v123, v125 offset:54276
    s_mov_b64 exec, -1
    v_ashrrev_i32 v122, 5, v62
    v_lshlrev_b16 v123, 2, v62
    v_cndmask_b32 v126, v28, v29, s[66:67]
    v_bitop3_b32 v122, v122, v113, v113 bitop3:0x0c
    v_lshlrev_b32 v124, 16, v126
    v_mul_f32 v122, v114, v122
    v_and_b32 v125, 0xffff0000, v126
    v_add_u32 v123, v123, v123
    v_mul_f32 v124, v122, v124
    v_mul_f32 v125, v122, v125
    v_cmpx_le_u32 vcc, 0x1000000, v62
    ds_add_f32 v123, v124 offset:54272
    ds_add_f32 v123, v125 offset:54276
    s_mov_b64 exec, -1
    s_waitcnt lgkmcnt(15)
    v_ashrrev_i32 v122, 5, v63
    v_lshlrev_b16 v123, 2, v63
    v_cndmask_b32 v126, v30, v31, s[66:67]
    v_bitop3_b32 v122, v122, v113, v113 bitop3:0x0c
    v_lshlrev_b32 v124, 16, v126
    v_mul_f32 v122, v114, v122
    v_and_b32 v125, 0xffff0000, v126
    v_add_u32 v123, v123, v123
    v_mul_f32 v124, v122, v124
    v_mul_f32 v125, v122, v125
    v_cmpx_le_u32 vcc, 0x1000000, v63
    ds_add_f32 v123, v124 offset:54272
    ds_add_f32 v123, v125 offset:54276
    s_mov_b64 exec, -1
    v_ashrrev_i32 v122, 5, v64
    v_lshlrev_b16 v123, 2, v64
    v_cndmask_b32 v126, v32, v33, s[66:67]
    v_bitop3_b32 v122, v122, v113, v113 bitop3:0x0c
    v_lshlrev_b32 v124, 16, v126
    v_mul_f32 v122, v114, v122
    v_and_b32 v125, 0xffff0000, v126
    v_add_u32 v123, v123, v123
    v_mul_f32 v124, v122, v124
    v_mul_f32 v125, v122, v125
    v_cmpx_le_u32 vcc, 0x1000000, v64
    ds_add_f32 v123, v124 offset:54272
    ds_add_f32 v123, v125 offset:54276
    s_mov_b64 exec, -1
    v_ashrrev_i32 v122, 5, v65
    v_lshlrev_b16 v123, 2, v65
    v_cndmask_b32 v126, v34, v35, s[66:67]
    v_bitop3_b32 v122, v122, v113, v113 bitop3:0x0c
    v_lshlrev_b32 v124, 16, v126
    v_mul_f32 v122, v114, v122
    v_and_b32 v125, 0xffff0000, v126
    v_add_u32 v123, v123, v123
    v_mul_f32 v124, v122, v124
    v_mul_f32 v125, v122, v125
    v_cmpx_le_u32 vcc, 0x1000000, v65
    ds_add_f32 v123, v124 offset:54272
    ds_add_f32 v123, v125 offset:54276
    s_mov_b64 exec, -1
    s_waitcnt lgkmcnt(15)
    v_ashrrev_i32 v122, 5, v66
    v_lshlrev_b16 v123, 2, v66
    v_cndmask_b32 v126, v36, v37, s[66:67]
    v_bitop3_b32 v122, v122, v113, v113 bitop3:0x0c
    v_lshlrev_b32 v124, 16, v126
    v_mul_f32 v122, v114, v122
    v_and_b32 v125, 0xffff0000, v126
    v_add_u32 v123, v123, v123
    v_mul_f32 v124, v122, v124
    v_mul_f32 v125, v122, v125
    v_cmpx_le_u32 vcc, 0x1000000, v66
    ds_add_f32 v123, v124 offset:54272
    ds_add_f32 v123, v125 offset:54276
    s_mov_b64 exec, -1
    v_ashrrev_i32 v122, 5, v67
    v_lshlrev_b16 v123, 2, v67
    v_cndmask_b32 v126, v38, v39, s[66:67]
    v_bitop3_b32 v122, v122, v113, v113 bitop3:0x0c
    v_lshlrev_b32 v124, 16, v126
    v_mul_f32 v122, v114, v122
    v_and_b32 v125, 0xffff0000, v126
    v_add_u32 v123, v123, v123
    v_mul_f32 v124, v122, v124
    v_mul_f32 v125, v122, v125
    v_cmpx_le_u32 vcc, 0x1000000, v67
    ds_add_f32 v123, v124 offset:54272
    ds_add_f32 v123, v125 offset:54276
    s_mov_b64 exec, -1
    v_ashrrev_i32 v122, 5, v68
    v_lshlrev_b16 v123, 2, v68
    v_cndmask_b32 v126, v40, v41, s[66:67]
    v_bitop3_b32 v122, v122, v113, v113 bitop3:0x0c
    v_lshlrev_b32 v124, 16, v126
    v_mul_f32 v122, v114, v122
    v_and_b32 v125, 0xffff0000, v126
    v_add_u32 v123, v123, v123
    v_mul_f32 v124, v122, v124
    v_mul_f32 v125, v122, v125
    v_cmpx_le_u32 vcc, 0x1000000, v68
    ds_add_f32 v123, v124 offset:54272
    ds_add_f32 v123, v125 offset:54276
    s_mov_b64 exec, -1
    s_waitcnt lgkmcnt(15)
    v_ashrrev_i32 v122, 5, v69
    v_lshlrev_b16 v123, 2, v69
    v_cndmask_b32 v126, v42, v43, s[66:67]
    v_bitop3_b32 v122, v122, v113, v113 bitop3:0x0c
    v_lshlrev_b32 v124, 16, v126
    v_mul_f32 v122, v114, v122
    v_and_b32 v125, 0xffff0000, v126
    v_add_u32 v123, v123, v123
    v_mul_f32 v124, v122, v124
    v_mul_f32 v125, v122, v125
    v_cmpx_le_u32 vcc, 0x1000000, v69
    ds_add_f32 v123, v124 offset:54272
    ds_add_f32 v123, v125 offset:54276
    s_mov_b64 exec, -1
    v_ashrrev_i32 v122, 5, v70
    v_lshlrev_b16 v123, 2, v70
    v_cndmask_b32 v126, v44, v45, s[66:67]
    v_bitop3_b32 v122, v122, v113, v113 bitop3:0x0c
    v_lshlrev_b32 v124, 16, v126
    v_mul_f32 v122, v114, v122
    v_and_b32 v125, 0xffff0000, v126
    v_add_u32 v123, v123, v123
    v_mul_f32 v124, v122, v124
    v_mul_f32 v125, v122, v125
    v_cmpx_le_u32 vcc, 0x1000000, v70
    ds_add_f32 v123, v124 offset:54272
    ds_add_f32 v123, v125 offset:54276
    s_mov_b64 exec, -1
    v_ashrrev_i32 v122, 5, v71
    v_lshlrev_b16 v123, 2, v71
    v_cndmask_b32 v126, v46, v47, s[66:67]
    v_bitop3_b32 v122, v122, v113, v113 bitop3:0x0c
    v_lshlrev_b32 v124, 16, v126
    v_mul_f32 v122, v114, v122
    v_and_b32 v125, 0xffff0000, v126
    v_add_u32 v123, v123, v123
    v_mul_f32 v124, v122, v124
    v_mul_f32 v125, v122, v125
    v_cmpx_le_u32 vcc, 0x1000000, v71
    ds_add_f32 v123, v124 offset:54272
    ds_add_f32 v123, v125 offset:54276
    s_mov_b64 exec, -1
    s_branch p2_fin
p2_tail:
    s_mov_b32 s60, s61
    s_mov_b32 s15, s16
    s_mov_b32 s16, s17
    v_mov_b32 v122, s19
    s_xor_b32 s19, s19, 4
    ds_read_b32 v125, v122 offset:53760
    v_mov_b32 v123, s19
    v_mov_b32 v124, 0
    ds_write_b32 v123, v124 offset:53760
    s_waitcnt vmcnt(2)
    s_mov_b32 m0, s24
    s_cmp_ge_u32 s10, 9
    s_cbranch_scc1 p2_st2s1
    ds_write_addtid_b32 v84 offset:49152
    ds_write_addtid_b32 v85 offset:49408
p2_st2s1:
    s_mov_b32 m0, s23
    s_add_u32 s20, s20, 53760
    ds_write_addtid_b32 v72 offset:0
    ds_write_addtid_b32 v73 offset:256
    ds_write_addtid_b32 v74 offset:512
    ds_write_addtid_b32 v75 offset:768
    ds_write_addtid_b32 v76 offset:1024
    ds_write_addtid_b32 v77 offset:1280
    ds_write_addtid_b32 v78 offset:1536
    ds_write_addtid_b32 v79 offset:1792
    ds_write_addtid_b32 v80 offset:2048
    ds_write_addtid_b32 v81 offset:2304
    ds_write_addtid_b32 v82 offset:2560
    ds_write_addtid_b32 v83 offset:2816
    s_cmp_ge_u32 s10, 9
    s_cbranch_scc1 p2_nm2m2a
    v_lshrrev_b32 v84, 1, v112
    s_add_u32 s44, s20, s42
    buffer_load_dwordx2 v[84:85], v84, s[4:7], s44 offen
p2_nm2m2a:
    buffer_load_dwordx4 v[72:75], v112, s[4:7], s20 offen offset:0
    buffer_load_dwordx4 v[76:79], v112, s[4:7], s20 offen offset:1024
    buffer_load_dwordx4 v[80:83], v112, s[4:7], s20 offen offset:2048
    s_waitcnt lgkmcnt(0)
    s_barrier
    s_setprio 3
    v_cmpx_lt_i16 vcc, 0x3fff, v48
    ds_read_b64 v[0:1], v0
    s_mov_b64 exec, -1
    v_cmpx_lt_i16 vcc, 0x3fff, v49
    ds_read_b64 v[2:3], v2
    s_mov_b64 exec, -1
    v_cmpx_lt_i16 vcc, 0x3fff, v50
    ds_read_b64 v[4:5], v4
    s_mov_b64 exec, -1
    v_cmpx_lt_i16 vcc, 0x3fff, v51
    ds_read_b64 v[6:7], v6
    s_mov_b64 exec, -1
    v_cmpx_lt_i16 vcc, 0x3fff, v52
    ds_read_b64 v[8:9], v8
    s_mov_b64 exec, -1
    v_cmpx_lt_i16 vcc, 0x3fff, v53
    ds_read_b64 v[10:11], v10
    s_mov_b64 exec, -1
    s_waitcnt lgkmcnt(15)
    s_nop 1
    v_readfirstlane_b32 s44, v125
    s_nop 0
    s_cmp_lg_u32 s44, 0
    s_cbranch_scc1 p2_advb
    s_add_u32 s61, s61, 1
    s_min_u32 s61, s61, 10
    v_mov_b32 v110, 0
    v_mov_b32 v111, 0
    s_cmp_eq_u32 s61, 10
    s_cbranch_scc1 p2_advb
    s_add_u32 s44, s61, s18
    s_cmp_ge_u32 s44, 10
    s_cselect_b32 s53, 10, 0
    s_sub_u32 s44, s44, s53
    s_mul_i32 s44, s44, 4160
    s_add_u32 s44, s44, s40
    v_bfe_i32 v111, v112, 6, 1
    v_lshrrev_b32 v110, 6, v112
    v_bitop3_b32 v111, v111, 15, s10 bitop3:0x6a
    v_lshl_or_b32 v110, v110, 4, v111
    v_bfe_u32 v111, v112, 2, 4
    v_mul_u32_u24 v110, 41600, v110
    v_add_u32 v111, v110, v111
    v_add_u32 v110, 256, v112
    v_and_b32 v110, 0x400, v110
    v_lshl_or_b32 v111, v110, 20, v111
    buffer_load_dword v110, v111, s[4:7], s44 offen
    buffer_load_dword v111, v111, s[4:7], s44 offen offset:16
p2_advb:
    s_cmp_lg_u32 s10, 15
    s_cbranch_scc1 p2_ntg
    s_lshr_b32 s44, s2, 3
    s_mul_i32 s44, s44, 5120
    s_add_u32 s45, s60, s18
    s_cmp_ge_u32 s45, 10
    s_cselect_b32 s53, 10, 0
    s_sub_u32 s45, s45, s53
    s_mul_i32 s45, s45, 645120
    s_add_u32 s44, s44, s45
    s_add_u32 s44, s44, s62
    s_sub_u32 s44, s44, s23
    v_lshlrev_b32 v84, 3, v112
    s_mov_b32 exec_hi, 0xff
    buffer_load_dword v85, v84, s[4:7], s44 offen
    s_mov_b64 exec, -1
p2_ntg:
    v_cmpx_lt_i16 vcc, 0x3fff, v54
    ds_read_b64 v[12:13], v12
    s_mov_b64 exec, -1
    v_cmpx_lt_i16 vcc, 0x3fff, v55
    ds_read_b64 v[14:15], v14
    s_mov_b64 exec, -1
    v_cmpx_lt_i16 vcc, 0x3fff, v56
    ds_read_b64 v[16:17], v16
    s_mov_b64 exec, -1
    s_cmp_lt_u32 s15, 8
    s_cbranch_scc1 p2_g2r13
    v_cmpx_lt_i16 vcc, 0x3fff, v57
    ds_read_b64 v[18:19], v18
    s_mov_b64 exec, -1
    v_cmpx_lt_i16 vcc, 0x3fff, v58
    ds_read_b64 v[20:21], v20
    s_mov_b64 exec, -1
    v_cmpx_lt_i16 vcc, 0x3fff, v59
    ds_read_b64 v[22:23], v22
    s_mov_b64 exec, -1
p2_g2r13:
    v_bfe_u32 v98, v109, 14, 4
    v_lshrrev_b32 v99, 18, v109
    v_and_b32 v109, 0x3fff, v109
    v_mad_u32_u24 v98, v98, s63, v99
    v_lshl_or_b32 v109, v98, 14, v109
    buffer_load_dwordx4 v[98:101], v109, s[68:71], 0 offen
    s_setprio 1
    v_cmpx_lt_i16 vcc, 0x3fff, v60
    ds_read_b64 v[24:25], v24
    s_mov_b64 exec, -1
    v_cmpx_lt_i16 vcc, 0x3fff, v61
    ds_read_b64 v[26:27], v26
    s_mov_b64 exec, -1
    v_cmpx_lt_i16 vcc, 0x3fff, v62
    ds_read_b64 v[28:29], v28
    s_mov_b64 exec, -1
    v_cmpx_lt_i16 vcc, 0x3fff, v63
    ds_read_b64 v[30:31], v30
    s_mov_b64 exec, -1
    v_cmpx_lt_i16 vcc, 0x3fff, v64
    ds_read_b64 v[32:33], v32
    s_mov_b64 exec, -1
    v_cmpx_lt_i16 vcc, 0x3fff, v65
    ds_read_b64 v[34:35], v34
    s_mov_b64 exec, -1
    s_nop 2
    s_nop 1
    v_max_u32_dpp v102, v102, v102 row_shr:1 row_mask:0xf bank_mask:0xf bound_ctrl:0
    v_max_u32_dpp v103, v103, v103 row_shr:1 row_mask:0xf bank_mask:0xf bound_ctrl:0
    s_nop 0
    v_max_u32_dpp v102, v102, v102 row_shr:2 row_mask:0xf bank_mask:0xf bound_ctrl:0
    v_max_u32_dpp v103, v103, v103 row_shr:2 row_mask:0xf bank_mask:0xf bound_ctrl:0
    s_nop 0
    v_max_u32_dpp v102, v102, v102 row_shr:4 row_mask:0xf bank_mask:0xf bound_ctrl:0
    v_max_u32_dpp v103, v103, v103 row_shr:4 row_mask:0xf bank_mask:0xf bound_ctrl:0
    s_nop 0
    v_max_u32_dpp v102, v102, v102 row_shr:8 row_mask:0xf bank_mask:0xf bound_ctrl:0
    v_max_u32_dpp v103, v103, v103 row_shr:8 row_mask:0xf bank_mask:0xf bound_ctrl:0
    s_nop 0
    v_max_u32_dpp v102, v102, v102 row_bcast:15 row_mask:0xa bank_mask:0xf
    v_max_u32_dpp v103, v103, v103 row_bcast:15 row_mask:0xa bank_mask:0xf
    s_nop 0
    v_max_u32_dpp v102, v102, v102 row_bcast:31 row_mask:0xc bank_mask:0xf
    v_max_u32_dpp v103, v103, v103 row_bcast:31 row_mask:0xc bank_mask:0xf
    s_nop 0
    s_nop 0
    v_max_u32 v102, s41, v102
    s_nop 0
    v_readlane_b32 s41, v102, 63
    v_add_u32 v102, v102, v112
    v_add_u32 v102, 4294963200, v102
    v_max_u32 v103, s41, v103
    s_nop 0
    v_readlane_b32 s41, v103, 63
    v_add_u32 v103, v103, v112
    v_add_u32 v103, 4294964224, v103
    v_cmpx_lt_i16 vcc, 0x3fff, v66
    ds_read_b64 v[36:37], v36
    s_mov_b64 exec, -1
    v_cmpx_lt_i16 vcc, 0x3fff, v67
    ds_read_b64 v[38:39], v38
    s_mov_b64 exec, -1
    v_cmpx_lt_i16 vcc, 0x3fff, v68
    ds_read_b64 v[40:41], v40
    s_mov_b64 exec, -1
    v_cmpx_lt_i16 vcc, 0x3fff, v69
    ds_read_b64 v[42:43], v42
    s_mov_b64 exec, -1
    v_cmpx_lt_i16 vcc, 0x3fff, v70
    ds_read_b64 v[44:45], v44
    s_mov_b64 exec, -1
    v_cmpx_lt_i16 vcc, 0x3fff, v71
    ds_read_b64 v[46:47], v46
    s_mov_b64 exec, -1
    s_waitcnt lgkmcnt(0)
    s_barrier
    s_waitcnt vmcnt(1)
    s_mov_b32 m0, s24
    s_cmp_ge_u32 s10, 9
    s_cbranch_scc1 p2_st2s2
    ds_write_addtid_b32 v84 offset:49152
    ds_write_addtid_b32 v85 offset:49408
p2_st2s2:
    s_mov_b32 m0, s23
    s_add_u32 s20, s60, s18
    s_cmp_ge_u32 s20, 10
    s_cselect_b32 s53, 10, 0
    s_sub_u32 s20, s20, s53
    s_mul_i32 s20, s20, 645120
    s_add_u32 s20, s20, s62
    ds_write_addtid_b32 v72 offset:0
    ds_write_addtid_b32 v73 offset:256
    ds_write_addtid_b32 v74 offset:512
    ds_write_addtid_b32 v75 offset:768
    ds_write_addtid_b32 v76 offset:1024
    ds_write_addtid_b32 v77 offset:1280
    ds_write_addtid_b32 v78 offset:1536
    ds_write_addtid_b32 v79 offset:1792
    ds_write_addtid_b32 v80 offset:2048
    ds_write_addtid_b32 v81 offset:2304
    ds_write_addtid_b32 v82 offset:2560
    ds_write_addtid_b32 v83 offset:2816
    s_nop 2
    s_nop 1
    v_max_u32_dpp v104, v104, v104 row_shr:1 row_mask:0xf bank_mask:0xf bound_ctrl:0
    v_max_u32_dpp v105, v105, v105 row_shr:1 row_mask:0xf bank_mask:0xf bound_ctrl:0
    s_nop 0
    v_max_u32_dpp v104, v104, v104 row_shr:2 row_mask:0xf bank_mask:0xf bound_ctrl:0
    v_max_u32_dpp v105, v105, v105 row_shr:2 row_mask:0xf bank_mask:0xf bound_ctrl:0
    s_nop 0
    v_max_u32_dpp v104, v104, v104 row_shr:4 row_mask:0xf bank_mask:0xf bound_ctrl:0
    v_max_u32_dpp v105, v105, v105 row_shr:4 row_mask:0xf bank_mask:0xf bound_ctrl:0
    s_nop 0
    v_max_u32_dpp v104, v104, v104 row_shr:8 row_mask:0xf bank_mask:0xf bound_ctrl:0
    v_max_u32_dpp v105, v105, v105 row_shr:8 row_mask:0xf bank_mask:0xf bound_ctrl:0
    s_nop 0
    v_max_u32_dpp v104, v104, v104 row_bcast:15 row_mask:0xa bank_mask:0xf
    v_max_u32_dpp v105, v105, v105 row_bcast:15 row_mask:0xa bank_mask:0xf
    s_nop 0
    v_max_u32_dpp v104, v104, v104 row_bcast:31 row_mask:0xc bank_mask:0xf
    v_max_u32_dpp v105, v105, v105 row_bcast:31 row_mask:0xc bank_mask:0xf
    s_nop 0
    s_nop 0
    v_max_u32 v104, s41, v104
    s_nop 0
    v_readlane_b32 s41, v104, 63
    v_add_u32 v104, v104, v112
    v_add_u32 v104, 4294965248, v104
    v_max_u32 v105, s41, v105
    s_nop 0
    v_readlane_b32 s41, v105, 63
    v_add_u32 v105, v105, v112
    v_add_u32 v105, 4294966272, v105
    s_waitcnt lgkmcnt(0)
    s_barrier
    s_branch p2_top
p2_fin:
    s_waitcnt vmcnt(0) lgkmcnt(0)
    s_barrier
    s_mov_b32 s48, s11
    s_mul_i32 s44, s48, 800768
    s_mul_i32 s45, s12, 12512
    s_add_u32 s49, s44, s45
    s_lshl_b32 s44, s49, 3
    s_add_u32 s44, s44, 492278784
    s_lshl_b32 s48, s48, 2
    s_lshl_b32 s45, s12, 4
    s_add_u32 s48, s48, s45
    s_add_u32 s48, s48, 492277760
    v_add_u32 v123, s64, v112
    v_add_u32 v122, s25, v123
    v_mov_b32 v24, 0
    v_mov_b32 v25, 0
    v_mov_b32 v26, 0
    v_mov_b32 v27, 0
    v_cmp_gt_u32 vcc, 1792, v123
    v_mov_b32 v124, 0x38000000
    v_mov_b32 v126, 0
    v_cndmask_b32 v124, v124, v123, vcc
    ds_read_b128 v[0:3], v122 offset:0
    ds_read_b128 v[4:7], v122 offset:16384
    ds_read_b128 v[8:11], v122 offset:32768
    v_add_u32 v122, 49152, v122
    ds_read_b128 v[12:15], v122 offset:0
    ds_read_b128 v[16:19], v122 offset:16384
    ds_read_b128 v[20:23], v122 offset:32768
    s_mov_b64 exec, vcc
    ds_read_b128 v[24:27], v122 offset:49152
    s_mov_b64 exec, -1
    s_cmp_lg_u32 s21, 0
    s_cbranch_scc1 p2_finf
    s_waitcnt lgkmcnt(6)
    buffer_store_dwordx4 v[0:3], v123, s[4:7], s44 offen nt
    s_add_u32 s44, s44, 16384
    s_waitcnt lgkmcnt(5)
    buffer_store_dwordx4 v[4:7], v123, s[4:7], s44 offen nt
    s_add_u32 s44, s44, 16384
    s_waitcnt lgkmcnt(4)
    buffer_store_dwordx4 v[8:11], v123, s[4:7], s44 offen nt
    s_add_u32 s44, s44, 16384
    s_waitcnt lgkmcnt(3)
    buffer_store_dwordx4 v[12:15], v123, s[4:7], s44 offen nt
    s_add_u32 s44, s44, 16384
    s_waitcnt lgkmcnt(2)
    buffer_store_dwordx4 v[16:19], v123, s[4:7], s44 offen nt
    s_add_u32 s44, s44, 16384
    s_waitcnt lgkmcnt(1)
    buffer_store_dwordx4 v[20:23], v123, s[4:7], s44 offen nt
    s_add_u32 s44, s44, 16384
    s_waitcnt lgkmcnt(0)
    buffer_store_dwordx4 v[24:27], v124, s[4:7], s44 offen nt
    s_add_u32 s44, s44, 16384
    v_bitop3_b32 v115, v115, v0, v1 bitop3:0xfe
    v_bitop3_b32 v115, v115, v2, v3 bitop3:0xfe
    v_bitop3_b32 v115, v115, v4, v5 bitop3:0xfe
    v_bitop3_b32 v115, v115, v6, v7 bitop3:0xfe
    v_bitop3_b32 v115, v115, v8, v9 bitop3:0xfe
    v_bitop3_b32 v115, v115, v10, v11 bitop3:0xfe
    v_bitop3_b32 v115, v115, v12, v13 bitop3:0xfe
    v_bitop3_b32 v115, v115, v14, v15 bitop3:0xfe
    v_bitop3_b32 v115, v115, v16, v17 bitop3:0xfe
    v_bitop3_b32 v115, v115, v18, v19 bitop3:0xfe
    v_bitop3_b32 v115, v115, v20, v21 bitop3:0xfe
    v_bitop3_b32 v115, v115, v22, v23 bitop3:0xfe
    v_bitop3_b32 v115, v115, v24, v25 bitop3:0xfe
    v_bitop3_b32 v115, v115, v26, v27 bitop3:0xfe
    v_bitop3_b32 v115, v115, v116, v117 bitop3:0xfe
    v_bitop3_b32 v115, v115, v118, v119 bitop3:0xfe
    v_bitop3_b32 v115, v115, v120, v121 bitop3:0xfe
    v_and_b32 v115, 0x80008000, v115
    v_cmpx_ne_u32 vcc, 0, v115
    ds_write_b32 v126, v115 offset:53768
    s_mov_b64 exec, -1
    s_waitcnt lgkmcnt(0)
    s_barrier
    ds_read_b32 v125, v126 offset:53768
    s_waitcnt lgkmcnt(0)
    v_readfirstlane_b32 s45, v125
    s_nop 0
    s_cmp_eq_u32 s45, 0
    s_cbranch_scc1 p2_done
    s_mov_b32 s21, 1
    s_waitcnt vmcnt(0)
    s_branch p2_restart
p2_finf:
    s_lshl_b32 s49, s49, 4
    s_lshl_b32 s45, s21, 3
    s_add_u32 s49, s49, s45
    s_add_u32 s49, s49, 517903352
    v_mov_b32 v28, 1073758208
    v_mov_b32 v29, 1073758208
    v_mov_b32 v30, 1073758208
    v_mov_b32 v31, 1073758208
    v_lshlrev_b32 v122, 1, v123
    v_lshlrev_b32 v125, 1, v124
    s_waitcnt lgkmcnt(0)
    buffer_store_dwordx4 v[28:31], v123, s[4:7], s44 offen
    s_add_u32 s44, s44, 16384
    buffer_store_dwordx2 v[0:1], v122, s[4:7], s49 offen offset:0
    buffer_store_dwordx2 v[2:3], v122, s[4:7], s49 offen offset:16
    s_add_u32 s49, s49, 32768
    buffer_store_dwordx4 v[28:31], v123, s[4:7], s44 offen
    s_add_u32 s44, s44, 16384
    buffer_store_dwordx2 v[4:5], v122, s[4:7], s49 offen offset:0
    buffer_store_dwordx2 v[6:7], v122, s[4:7], s49 offen offset:16
    s_add_u32 s49, s49, 32768
    buffer_store_dwordx4 v[28:31], v123, s[4:7], s44 offen
    s_add_u32 s44, s44, 16384
    buffer_store_dwordx2 v[8:9], v122, s[4:7], s49 offen offset:0
    buffer_store_dwordx2 v[10:11], v122, s[4:7], s49 offen offset:16
    s_add_u32 s49, s49, 32768
    buffer_store_dwordx4 v[28:31], v123, s[4:7], s44 offen
    s_add_u32 s44, s44, 16384
    buffer_store_dwordx2 v[12:13], v122, s[4:7], s49 offen offset:0
    buffer_store_dwordx2 v[14:15], v122, s[4:7], s49 offen offset:16
    s_add_u32 s49, s49, 32768
    buffer_store_dwordx4 v[28:31], v123, s[4:7], s44 offen
    s_add_u32 s44, s44, 16384
    buffer_store_dwordx2 v[16:17], v122, s[4:7], s49 offen offset:0
    buffer_store_dwordx2 v[18:19], v122, s[4:7], s49 offen offset:16
    s_add_u32 s49, s49, 32768
    buffer_store_dwordx4 v[28:31], v123, s[4:7], s44 offen
    s_add_u32 s44, s44, 16384
    buffer_store_dwordx2 v[20:21], v122, s[4:7], s49 offen offset:0
    buffer_store_dwordx2 v[22:23], v122, s[4:7], s49 offen offset:16
    s_add_u32 s49, s49, 32768
    buffer_store_dwordx4 v[28:31], v124, s[4:7], s44 offen
    s_add_u32 s44, s44, 16384
    buffer_store_dwordx2 v[24:25], v125, s[4:7], s49 offen offset:0
    buffer_store_dwordx2 v[26:27], v125, s[4:7], s49 offen offset:16
    s_add_u32 s49, s49, 32768
    s_add_u32 s21, s21, 1
    s_mov_b32 s30, 0
    s_waitcnt vmcnt(0)
    s_cmp_eq_u32 s21, 2
    s_cbranch_scc1 p2_restart
p2_done:
    v_mov_b32 v125, s30
    buffer_store_dword v125, v126, s[4:7], s48 offen
p2_end:
    s_endpgm
.globl p3_kernel
.p2align 8
.type p3_kernel,@function
p3_kernel:
    s_cmp_ge_u32 s2, 1563
    s_cbranch_scc1 p3_end
    s_load_dwordx2 s[4:5], s[0:1], 0
    s_load_dwordx2 s[6:7], s[0:1], 24
    s_load_dwordx2 s[8:9], s[0:1], 40
    s_load_dwordx8 s[12:19], s[0:1], 56
    s_load_dwordx2 s[10:11], s[0:1], 88
    s_load_dwordx2 s[20:21], s[0:1], 104
    s_lshl_b32 s3, s2, 8
    v_add_u32 v0, s3, v0
    v_lshlrev_b32 v2, 4, v0
    v_lshlrev_b32 v3, 2, v0
    v_add_u32 v0, v0, v0
    v_mul_hi_u32_u24 v1, 343268, v0
    v_lshlrev_b16 v1, 4, v1
    s_waitcnt lgkmcnt(0)
    s_load_dwordx4 s[32:35], s[8:9], 0
    s_load_dwordx16 s[36:51], s[12:13], 0
    s_load_dwordx16 s[52:67], s[14:15], 0
    s_load_dwordx8 s[68:75], s[16:17], 0
    s_load_dwordx8 s[76:83], s[18:19], 0
    s_mov_b32 s24, s6
    s_and_b32 s25, s7, 0xffff
    s_mov_b32 s26, 1600000
    s_mov_b32 s27, 0x20000
    buffer_load_dword v4, v3, s[24:27], 0 offen nt
    s_mov_b32 s28, s20
    s_and_b32 s29, s21, 0xffff
    s_mov_b32 s30, 819200000
    s_mov_b32 s31, 0x20000
    s_mov_b32 s22, 492278784
    buffer_load_dwordx4 v[40:43], v2, s[28:31], s22 offen nt
    s_mov_b32 s22, 498684928
    buffer_load_dwordx4 v[44:47], v2, s[28:31], s22 offen nt
    s_mov_b32 s22, 505091072
    buffer_load_dwordx4 v[48:51], v2, s[28:31], s22 offen nt
    s_mov_b32 s22, 511497216
    buffer_load_dwordx4 v[52:55], v2, s[28:31], s22 offen nt
    s_mov_b32 s22, 492277760
    buffer_load_dwordx4 v[56:59], v1, s[28:31], s22 offen
    s_mov_b32 s24, s4
    s_and_b32 s25, s5, 0xffff
    s_mov_b32 s26, 6400000
    s_mov_b32 s27, 0x20000
    buffer_load_dwordx4 v[60:63], v2, s[24:27], 0 offen nt
    s_mov_b32 s24, s10
    s_and_b32 s25, s11, 0xffff
    s_mov_b32 s26, 6400000
    s_mov_b32 s27, 0x20000
    s_waitcnt vmcnt(6) lgkmcnt(0)
    v_and_b32 v5, 0xffff0000, v4
    v_lshlrev_b32 v4, 16, v4
    s_lshl_b32 s14, s32, 16
    s_and_b32 s15, s32, 0xffff0000
    v_pk_add_f32 v[8:9], v[4:5], s[14:15] op_sel:[0,0] op_sel_hi:[0,1] neg_lo:[0,1] neg_hi:[0,1]
    v_pk_add_f32 v[16:17], v[4:5], s[14:15] op_sel:[1,0] op_sel_hi:[1,1] neg_lo:[0,1] neg_hi:[0,1]
    s_lshl_b32 s16, s33, 16
    s_and_b32 s17, s33, 0xffff0000
    v_pk_add_f32 v[10:11], v[4:5], s[16:17] op_sel:[0,0] op_sel_hi:[0,1] neg_lo:[0,1] neg_hi:[0,1]
    v_pk_add_f32 v[18:19], v[4:5], s[16:17] op_sel:[1,0] op_sel_hi:[1,1] neg_lo:[0,1] neg_hi:[0,1]
    s_lshl_b32 s18, s34, 16
    s_and_b32 s19, s34, 0xffff0000
    v_pk_add_f32 v[12:13], v[4:5], s[18:19] op_sel:[0,0] op_sel_hi:[0,1] neg_lo:[0,1] neg_hi:[0,1]
    v_pk_add_f32 v[20:21], v[4:5], s[18:19] op_sel:[1,0] op_sel_hi:[1,1] neg_lo:[0,1] neg_hi:[0,1]
    s_lshl_b32 s12, s35, 16
    s_and_b32 s13, s35, 0xffff0000
    v_pk_add_f32 v[14:15], v[4:5], s[12:13] op_sel:[0,0] op_sel_hi:[0,1] neg_lo:[0,1] neg_hi:[0,1]
    v_pk_add_f32 v[22:23], v[4:5], s[12:13] op_sel:[1,0] op_sel_hi:[1,1] neg_lo:[0,1] neg_hi:[0,1]
    v_cvt_pk_bf16_f32 v8, v8, v9
    v_cvt_pk_bf16_f32 v10, v10, v11
    v_cvt_pk_bf16_f32 v12, v12, v13
    v_cvt_pk_bf16_f32 v14, v14, v15
    v_cvt_pk_bf16_f32 v16, v16, v17
    v_cvt_pk_bf16_f32 v18, v18, v19
    v_cvt_pk_bf16_f32 v20, v20, v21
    v_cvt_pk_bf16_f32 v22, v22, v23
    v_and_b32 v9, 0xffff0000, v8
    v_lshlrev_b32 v8, 16, v8
    v_and_b32 v11, 0xffff0000, v10
    v_lshlrev_b32 v10, 16, v10
    v_and_b32 v13, 0xffff0000, v12
    v_lshlrev_b32 v12, 16, v12
    v_and_b32 v15, 0xffff0000, v14
    v_lshlrev_b32 v14, 16, v14
    v_and_b32 v17, 0xffff0000, v16
    v_lshlrev_b32 v16, 16, v16
    v_and_b32 v19, 0xffff0000, v18
    v_lshlrev_b32 v18, 16, v18
    v_and_b32 v21, 0xffff0000, v20
    v_lshlrev_b32 v20, 16, v20
    v_and_b32 v23, 0xffff0000, v22
    v_lshlrev_b32 v22, 16, v22
    v_mul_f32 v8, v8, v8
    v_mul_f32 v9, v9, v9
    v_mul_f32 v10, v10, v10
    v_mul_f32 v11, v11, v11
    v_mul_f32 v12, v12, v12
    v_mul_f32 v13, v13, v13
    v_mul_f32 v14, v14, v14
    v_mul_f32 v15, v15, v15
    v_mul_f32 v16, v16, v16
    v_mul_f32 v17, v17, v17
    v_mul_f32 v18, v18, v18
    v_mul_f32 v19, v19, v19
    v_mul_f32 v20, v20, v20
    v_mul_f32 v21, v21, v21
    v_mul_f32 v22, v22, v22
    v_mul_f32 v23, v23, v23
    v_cvt_pk_bf16_f32 v8, v8, v9
    v_cvt_pk_bf16_f32 v10, v10, v11
    v_cvt_pk_bf16_f32 v12, v12, v13
    v_cvt_pk_bf16_f32 v14, v14, v15
    v_cvt_pk_bf16_f32 v16, v16, v17
    v_cvt_pk_bf16_f32 v18, v18, v19
    v_cvt_pk_bf16_f32 v20, v20, v21
    v_cvt_pk_bf16_f32 v22, v22, v23
    v_and_b32 v9, 0xffff0000, v8
    v_lshlrev_b32 v8, 16, v8
    v_and_b32 v11, 0xffff0000, v10
    v_lshlrev_b32 v10, 16, v10
    v_and_b32 v13, 0xffff0000, v12
    v_lshlrev_b32 v12, 16, v12
    v_and_b32 v15, 0xffff0000, v14
    v_lshlrev_b32 v14, 16, v14
    v_and_b32 v17, 0xffff0000, v16
    v_lshlrev_b32 v16, 16, v16
    v_and_b32 v19, 0xffff0000, v18
    v_lshlrev_b32 v18, 16, v18
    v_and_b32 v21, 0xffff0000, v20
    v_lshlrev_b32 v20, 16, v20
    v_and_b32 v23, 0xffff0000, v22
    v_lshlrev_b32 v22, 16, v22
    v_mul_f32 v8, 0xc1200000, v8
    v_mul_f32 v9, 0xc1200000, v9
    v_mul_f32 v10, 0xc1200000, v10
    v_mul_f32 v11, 0xc1200000, v11
    v_mul_f32 v12, 0xc1200000, v12
    v_mul_f32 v13, 0xc1200000, v13
    v_mul_f32 v14, 0xc1200000, v14
    v_mul_f32 v15, 0xc1200000, v15
    v_mul_f32 v16, 0xc1200000, v16
    v_mul_f32 v17, 0xc1200000, v17
    v_mul_f32 v18, 0xc1200000, v18
    v_mul_f32 v19, 0xc1200000, v19
    v_mul_f32 v20, 0xc1200000, v20
    v_mul_f32 v21, 0xc1200000, v21
    v_mul_f32 v22, 0xc1200000, v22
    v_mul_f32 v23, 0xc1200000, v23
    v_cvt_pk_bf16_f32 v8, v8, v9
    v_cvt_pk_bf16_f32 v10, v10, v11
    v_cvt_pk_bf16_f32 v12, v12, v13
    v_cvt_pk_bf16_f32 v14, v14, v15
    v_cvt_pk_bf16_f32 v16, v16, v17
    v_cvt_pk_bf16_f32 v18, v18, v19
    v_cvt_pk_bf16_f32 v20, v20, v21
    v_cvt_pk_bf16_f32 v22, v22, v23
    v_and_b32 v9, 0xffff0000, v8
    v_lshlrev_b32 v8, 16, v8
    v_and_b32 v11, 0xffff0000, v10
    v_lshlrev_b32 v10, 16, v10
    v_and_b32 v13, 0xffff0000, v12
    v_lshlrev_b32 v12, 16, v12
    v_and_b32 v15, 0xffff0000, v14
    v_lshlrev_b32 v14, 16, v14
    v_and_b32 v17, 0xffff0000, v16
    v_lshlrev_b32 v16, 16, v16
    v_and_b32 v19, 0xffff0000, v18
    v_lshlrev_b32 v18, 16, v18
    v_and_b32 v21, 0xffff0000, v20
    v_lshlrev_b32 v20, 16, v20
    v_and_b32 v23, 0xffff0000, v22
    v_lshlrev_b32 v22, 16, v22
    v_mul_f32 v8, 0x3fb8aa3b, v8
    v_mul_f32 v9, 0x3fb8aa3b, v9
    v_mul_f32 v10, 0x3fb8aa3b, v10
    v_mul_f32 v11, 0x3fb8aa3b, v11
    v_mul_f32 v12, 0x3fb8aa3b, v12
    v_mul_f32 v13, 0x3fb8aa3b, v13
    v_mul_f32 v14, 0x3fb8aa3b, v14
    v_mul_f32 v15, 0x3fb8aa3b, v15
    v_mul_f32 v16, 0x3fb8aa3b, v16
    v_mul_f32 v17, 0x3fb8aa3b, v17
    v_mul_f32 v18, 0x3fb8aa3b, v18
    v_mul_f32 v19, 0x3fb8aa3b, v19
    v_mul_f32 v20, 0x3fb8aa3b, v20
    v_mul_f32 v21, 0x3fb8aa3b, v21
    v_mul_f32 v22, 0x3fb8aa3b, v22
    v_mul_f32 v23, 0x3fb8aa3b, v23
    v_exp_f32 v8, v8
    v_exp_f32 v9, v9
    v_exp_f32 v10, v10
    v_exp_f32 v11, v11
    v_exp_f32 v12, v12
    v_exp_f32 v13, v13
    v_exp_f32 v14, v14
    v_exp_f32 v15, v15
    v_exp_f32 v16, v16
    v_exp_f32 v17, v17
    v_exp_f32 v18, v18
    v_exp_f32 v19, v19
    v_exp_f32 v20, v20
    v_exp_f32 v21, v21
    v_exp_f32 v22, v22
    v_exp_f32 v23, v23
    s_nop 0
    v_cvt_pk_bf16_f32 v8, v8, v9
    v_cvt_pk_bf16_f32 v10, v10, v11
    v_cvt_pk_bf16_f32 v12, v12, v13
    v_cvt_pk_bf16_f32 v14, v14, v15
    v_cvt_pk_bf16_f32 v16, v16, v17
    v_cvt_pk_bf16_f32 v18, v18, v19
    v_cvt_pk_bf16_f32 v20, v20, v21
    v_cvt_pk_bf16_f32 v22, v22, v23
    v_and_b32 v9, 0xffff0000, v8
    v_lshlrev_b32 v8, 16, v8
    v_and_b32 v11, 0xffff0000, v10
    v_lshlrev_b32 v10, 16, v10
    v_and_b32 v13, 0xffff0000, v12
    v_lshlrev_b32 v12, 16, v12
    v_and_b32 v15, 0xffff0000, v14
    v_lshlrev_b32 v14, 16, v14
    v_and_b32 v17, 0xffff0000, v16
    v_lshlrev_b32 v16, 16, v16
    v_and_b32 v19, 0xffff0000, v18
    v_lshlrev_b32 v18, 16, v18
    v_and_b32 v21, 0xffff0000, v20
    v_lshlrev_b32 v20, 16, v20
    v_and_b32 v23, 0xffff0000, v22
    v_lshlrev_b32 v22, 16, v22
    s_lshl_b32 s14, s52, 16
    s_and_b32 s15, s52, 0xffff0000
    v_pk_mul_f32 v[24:25], v[8:9], s[14:15] op_sel:[0,0] op_sel_hi:[0,1]
    v_pk_mul_f32 v[28:29], v[16:17], s[14:15] op_sel:[0,0] op_sel_hi:[0,1]
    s_lshl_b32 s16, s53, 16
    s_and_b32 s17, s53, 0xffff0000
    v_pk_mul_f32 v[26:27], v[8:9], s[16:17] op_sel:[0,0] op_sel_hi:[0,1]
    v_pk_mul_f32 v[30:31], v[16:17], s[16:17] op_sel:[0,0] op_sel_hi:[0,1]
    s_lshl_b32 s18, s54, 16
    s_and_b32 s19, s54, 0xffff0000
    v_pk_fma_f32 v[24:25], v[8:9], s[18:19], v[24:25] op_sel:[1,0,0] op_sel_hi:[1,1,1]
    v_pk_fma_f32 v[28:29], v[16:17], s[18:19], v[28:29] op_sel:[1,0,0] op_sel_hi:[1,1,1]
    s_lshl_b32 s12, s55, 16
    s_and_b32 s13, s55, 0xffff0000
    v_pk_fma_f32 v[26:27], v[8:9], s[12:13], v[26:27] op_sel:[1,0,0] op_sel_hi:[1,1,1]
    v_pk_fma_f32 v[30:31], v[16:17], s[12:13], v[30:31] op_sel:[1,0,0] op_sel_hi:[1,1,1]
    s_lshl_b32 s14, s56, 16
    s_and_b32 s15, s56, 0xffff0000
    v_pk_fma_f32 v[24:25], v[10:11], s[14:15], v[24:25] op_sel:[0,0,0] op_sel_hi:[0,1,1]
    v_pk_fma_f32 v[28:29], v[18:19], s[14:15], v[28:29] op_sel:[0,0,0] op_sel_hi:[0,1,1]
    s_lshl_b32 s16, s57, 16
    s_and_b32 s17, s57, 0xffff0000
    v_pk_fma_f32 v[26:27], v[10:11], s[16:17], v[26:27] op_sel:[0,0,0] op_sel_hi:[0,1,1]
    v_pk_fma_f32 v[30:31], v[18:19], s[16:17], v[30:31] op_sel:[0,0,0] op_sel_hi:[0,1,1]
    s_lshl_b32 s18, s58, 16
    s_and_b32 s19, s58, 0xffff0000
    v_pk_fma_f32 v[24:25], v[10:11], s[18:19], v[24:25] op_sel:[1,0,0] op_sel_hi:[1,1,1]
    v_pk_fma_f32 v[28:29], v[18:19], s[18:19], v[28:29] op_sel:[1,0,0] op_sel_hi:[1,1,1]
    s_lshl_b32 s12, s59, 16
    s_and_b32 s13, s59, 0xffff0000
    v_pk_fma_f32 v[26:27], v[10:11], s[12:13], v[26:27] op_sel:[1,0,0] op_sel_hi:[1,1,1]
    v_pk_fma_f32 v[30:31], v[18:19], s[12:13], v[30:31] op_sel:[1,0,0] op_sel_hi:[1,1,1]
    s_lshl_b32 s14, s60, 16
    s_and_b32 s15, s60, 0xffff0000
    v_pk_fma_f32 v[24:25], v[12:13], s[14:15], v[24:25] op_sel:[0,0,0] op_sel_hi:[0,1,1]
    v_pk_fma_f32 v[28:29], v[20:21], s[14:15], v[28:29] op_sel:[0,0,0] op_sel_hi:[0,1,1]
    s_lshl_b32 s16, s61, 16
    s_and_b32 s17, s61, 0xffff0000
    v_pk_fma_f32 v[26:27], v[12:13], s[16:17], v[26:27] op_sel:[0,0,0] op_sel_hi:[0,1,1]
    v_pk_fma_f32 v[30:31], v[20:21], s[16:17], v[30:31] op_sel:[0,0,0] op_sel_hi:[0,1,1]
    s_lshl_b32 s18, s62, 16
    s_and_b32 s19, s62, 0xffff0000
    v_pk_fma_f32 v[24:25], v[12:13], s[18:19], v[24:25] op_sel:[1,0,0] op_sel_hi:[1,1,1]
    v_pk_fma_f32 v[28:29], v[20:21], s[18:19], v[28:29] op_sel:[1,0,0] op_sel_hi:[1,1,1]
    s_lshl_b32 s12, s63, 16
    s_and_b32 s13, s63, 0xffff0000
    v_pk_fma_f32 v[26:27], v[12:13], s[12:13], v[26:27] op_sel:[1,0,0] op_sel_hi:[1,1,1]
    v_pk_fma_f32 v[30:31], v[20:21], s[12:13], v[30:31] op_sel:[1,0,0] op_sel_hi:[1,1,1]
    s_lshl_b32 s14, s64, 16
    s_and_b32 s15, s64, 0xffff0000
    v_pk_fma_f32 v[24:25], v[14:15], s[14:15], v[24:25] op_sel:[0,0,0] op_sel_hi:[0,1,1]
    v_pk_fma_f32 v[28:29], v[22:23], s[14:15], v[28:29] op_sel:[0,0,0] op_sel_hi:[0,1,1]
    s_lshl_b32 s16, s65, 16
    s_and_b32 s17, s65, 0xffff0000
    v_pk_fma_f32 v[26:27], v[14:15], s[16:17], v[26:27] op_sel:[0,0,0] op_sel_hi:[0,1,1]
    v_pk_fma_f32 v[30:31], v[22:23], s[16:17], v[30:31] op_sel:[0,0,0] op_sel_hi:[0,1,1]
    s_lshl_b32 s18, s66, 16
    s_and_b32 s19, s66, 0xffff0000
    v_pk_fma_f32 v[24:25], v[14:15], s[18:19], v[24:25] op_sel:[1,0,0] op_sel_hi:[1,1,1]
    v_pk_fma_f32 v[28:29], v[22:23], s[18:19], v[28:29] op_sel:[1,0,0] op_sel_hi:[1,1,1]
    s_lshl_b32 s12, s67, 16
    s_and_b32 s13, s67, 0xffff0000
    v_pk_fma_f32 v[26:27], v[14:15], s[12:13], v[26:27] op_sel:[1,0,0] op_sel_hi:[1,1,1]
    v_pk_fma_f32 v[30:31], v[22:23], s[12:13], v[30:31] op_sel:[1,0,0] op_sel_hi:[1,1,1]
    s_lshl_b32 s14, s36, 16
    s_and_b32 s15, s36, 0xffff0000
    v_pk_mul_f32 v[32:33], v[8:9], s[14:15] op_sel:[0,0] op_sel_hi:[0,1]
    v_pk_mul_f32 v[36:37], v[16:17], s[14:15] op_sel:[0,0] op_sel_hi:[0,1]
    s_lshl_b32 s16, s37, 16
    s_and_b32 s17, s37, 0xffff0000
    v_pk_mul_f32 v[34:35], v[8:9], s[16:17] op_sel:[0,0] op_sel_hi:[0,1]
    v_pk_mul_f32 v[38:39], v[16:17], s[16:17] op_sel:[0,0] op_sel_hi:[0,1]
    s_lshl_b32 s18, s38, 16
    s_and_b32 s19, s38, 0xffff0000
    v_pk_fma_f32 v[32:33], v[8:9], s[18:19], v[32:33] op_sel:[1,0,0] op_sel_hi:[1,1,1]
    v_pk_fma_f32 v[36:37], v[16:17], s[18:19], v[36:37] op_sel:[1,0,0] op_sel_hi:[1,1,1]
    s_lshl_b32 s12, s39, 16
    s_and_b32 s13, s39, 0xffff0000
    v_pk_fma_f32 v[34:35], v[8:9], s[12:13], v[34:35] op_sel:[1,0,0] op_sel_hi:[1,1,1]
    v_pk_fma_f32 v[38:39], v[16:17], s[12:13], v[38:39] op_sel:[1,0,0] op_sel_hi:[1,1,1]
    s_lshl_b32 s14, s40, 16
    s_and_b32 s15, s40, 0xffff0000
    v_pk_fma_f32 v[32:33], v[10:11], s[14:15], v[32:33] op_sel:[0,0,0] op_sel_hi:[0,1,1]
    v_pk_fma_f32 v[36:37], v[18:19], s[14:15], v[36:37] op_sel:[0,0,0] op_sel_hi:[0,1,1]
    s_lshl_b32 s16, s41, 16
    s_and_b32 s17, s41, 0xffff0000
    v_pk_fma_f32 v[34:35], v[10:11], s[16:17], v[34:35] op_sel:[0,0,0] op_sel_hi:[0,1,1]
    v_pk_fma_f32 v[38:39], v[18:19], s[16:17], v[38:39] op_sel:[0,0,0] op_sel_hi:[0,1,1]
    s_lshl_b32 s18, s42, 16
    s_and_b32 s19, s42, 0xffff0000
    v_pk_fma_f32 v[32:33], v[10:11], s[18:19], v[32:33] op_sel:[1,0,0] op_sel_hi:[1,1,1]
    v_pk_fma_f32 v[36:37], v[18:19], s[18:19], v[36:37] op_sel:[1,0,0] op_sel_hi:[1,1,1]
    s_lshl_b32 s12, s43, 16
    s_and_b32 s13, s43, 0xffff0000
    v_pk_fma_f32 v[34:35], v[10:11], s[12:13], v[34:35] op_sel:[1,0,0] op_sel_hi:[1,1,1]
    v_pk_fma_f32 v[38:39], v[18:19], s[12:13], v[38:39] op_sel:[1,0,0] op_sel_hi:[1,1,1]
    s_lshl_b32 s14, s44, 16
    s_and_b32 s15, s44, 0xffff0000
    v_pk_fma_f32 v[32:33], v[12:13], s[14:15], v[32:33] op_sel:[0,0,0] op_sel_hi:[0,1,1]
    v_pk_fma_f32 v[36:37], v[20:21], s[14:15], v[36:37] op_sel:[0,0,0] op_sel_hi:[0,1,1]
    s_lshl_b32 s16, s45, 16
    s_and_b32 s17, s45, 0xffff0000
    v_pk_fma_f32 v[34:35], v[12:13], s[16:17], v[34:35] op_sel:[0,0,0] op_sel_hi:[0,1,1]
    v_pk_fma_f32 v[38:39], v[20:21], s[16:17], v[38:39] op_sel:[0,0,0] op_sel_hi:[0,1,1]
    s_lshl_b32 s18, s46, 16
    s_and_b32 s19, s46, 0xffff0000
    v_pk_fma_f32 v[32:33], v[12:13], s[18:19], v[32:33] op_sel:[1,0,0] op_sel_hi:[1,1,1]
    v_pk_fma_f32 v[36:37], v[20:21], s[18:19], v[36:37] op_sel:[1,0,0] op_sel_hi:[1,1,1]
    s_lshl_b32 s12, s47, 16
    s_and_b32 s13, s47, 0xffff0000
    v_pk_fma_f32 v[34:35], v[12:13], s[12:13], v[34:35] op_sel:[1,0,0] op_sel_hi:[1,1,1]
    v_pk_fma_f32 v[38:39], v[20:21], s[12:13], v[38:39] op_sel:[1,0,0] op_sel_hi:[1,1,1]
    s_lshl_b32 s14, s48, 16
    s_and_b32 s15, s48, 0xffff0000
    v_pk_fma_f32 v[32:33], v[14:15], s[14:15], v[32:33] op_sel:[0,0,0] op_sel_hi:[0,1,1]
    v_pk_fma_f32 v[36:37], v[22:23], s[14:15], v[36:37] op_sel:[0,0,0] op_sel_hi:[0,1,1]
    s_lshl_b32 s16, s49, 16
    s_and_b32 s17, s49, 0xffff0000
    v_pk_fma_f32 v[34:35], v[14:15], s[16:17], v[34:35] op_sel:[0,0,0] op_sel_hi:[0,1,1]
    v_pk_fma_f32 v[38:39], v[22:23], s[16:17], v[38:39] op_sel:[0,0,0] op_sel_hi:[0,1,1]
    s_lshl_b32 s18, s50, 16
    s_and_b32 s19, s50, 0xffff0000
    v_pk_fma_f32 v[32:33], v[14:15], s[18:19], v[32:33] op_sel:[1,0,0] op_sel_hi:[1,1,1]
    v_pk_fma_f32 v[36:37], v[22:23], s[18:19], v[36:37] op_sel:[1,0,0] op_sel_hi:[1,1,1]
    s_lshl_b32 s12, s51, 16
    s_and_b32 s13, s51, 0xffff0000
    v_pk_fma_f32 v[34:35], v[14:15], s[12:13], v[34:35] op_sel:[1,0,0] op_sel_hi:[1,1,1]
    v_pk_fma_f32 v[38:39], v[22:23], s[12:13], v[38:39] op_sel:[1,0,0] op_sel_hi:[1,1,1]
    v_cvt_pk_bf16_f32 v32, v32, v33
    v_cvt_pk_bf16_f32 v34, v34, v35
    v_cvt_pk_bf16_f32 v36, v36, v37
    v_cvt_pk_bf16_f32 v38, v38, v39
    v_and_b32 v33, 0xffff0000, v32
    v_lshlrev_b32 v32, 16, v32
    v_and_b32 v35, 0xffff0000, v34
    v_lshlrev_b32 v34, 16, v34
    v_and_b32 v37, 0xffff0000, v36
    v_lshlrev_b32 v36, 16, v36
    v_and_b32 v39, 0xffff0000, v38
    v_lshlrev_b32 v38, 16, v38
    s_waitcnt vmcnt(1)
    v_add_u32 v40, v40, v44
    v_add_u32 v48, v48, v52
    v_add_u32 v41, v41, v45
    v_add_u32 v49, v49, v53
    v_add_u32 v42, v42, v46
    v_add_u32 v50, v50, v54
    v_add_u32 v43, v43, v47
    v_add_u32 v51, v51, v55
    v_add_u32_sdwa v8, v40, v48 dst_sel:DWORD dst_unused:UNUSED_PAD src0_sel:WORD_0 src1_sel:WORD_0
    v_add_u32_sdwa v9, v40, v48 dst_sel:DWORD dst_unused:UNUSED_PAD src0_sel:WORD_1 src1_sel:WORD_1
    v_add_u32_sdwa v10, v41, v49 dst_sel:DWORD dst_unused:UNUSED_PAD src0_sel:WORD_0 src1_sel:WORD_0
    v_add_u32_sdwa v11, v41, v49 dst_sel:DWORD dst_unused:UNUSED_PAD src0_sel:WORD_1 src1_sel:WORD_1
    v_add_u32_sdwa v12, v42, v50 dst_sel:DWORD dst_unused:UNUSED_PAD src0_sel:WORD_0 src1_sel:WORD_0
    v_add_u32_sdwa v13, v42, v50 dst_sel:DWORD dst_unused:UNUSED_PAD src0_sel:WORD_1 src1_sel:WORD_1
    v_add_u32_sdwa v14, v43, v51 dst_sel:DWORD dst_unused:UNUSED_PAD src0_sel:WORD_0 src1_sel:WORD_0
    v_add_u32_sdwa v15, v43, v51 dst_sel:DWORD dst_unused:UNUSED_PAD src0_sel:WORD_1 src1_sel:WORD_1
    v_min3_u32 v5, v56, v57, v58
    v_bitop3_b32 v4, v56, v57, v58 bitop3:0xfe
    v_min_u32 v5, v5, v59
    v_or_b32 v4, v4, v59
    v_or_b32 v8, 0x4b000000, v8
    v_or_b32 v9, 0x4b000000, v9
    v_or_b32 v10, 0x4b000000, v10
    v_or_b32 v11, 0x4b000000, v11
    v_or_b32 v12, 0x4b000000, v12
    v_or_b32 v13, 0x4b000000, v13
    v_or_b32 v14, 0x4b000000, v14
    v_or_b32 v15, 0x4b000000, v15
    v_cmp_eq_u32 vcc, 0, v5
    v_add_f32 v8, 0xcb010000, v8
    v_add_f32 v9, 0xcb010000, v9
    v_add_f32 v10, 0xcb010000, v10
    v_add_f32 v11, 0xcb010000, v11
    v_add_f32 v12, 0xcb010000, v12
    v_add_f32 v13, 0xcb010000, v13
    v_add_f32 v14, 0xcb010000, v14
    v_add_f32 v15, 0xcb010000, v15
    v_mul_f32 v8, v4, v8
    v_mul_f32 v9, v4, v9
    v_mul_f32 v10, v4, v10
    v_mul_f32 v11, v4, v11
    v_mul_f32 v12, v4, v12
    v_mul_f32 v13, v4, v13
    v_mul_f32 v14, v4, v14
    v_mul_f32 v15, v4, v15
    s_cbranch_vccz p3_nof
    v_lshlrev_b32 v1, 4, v0
    v_mov_b32 v3, 0x70000000
    v_cmp_eq_u32 vcc, 0, v56
    s_mov_b32 s22, 517903360
    s_nop 0
    v_cndmask_b32 v5, v3, v1, vcc
    buffer_load_dwordx4 v[16:19], v5, s[28:31], s22 offen
    buffer_load_dwordx4 v[20:23], v5, s[28:31], s22 offen offset:16
    s_waitcnt vmcnt(0)
    v_add_f32 v8, v8, v16
    v_add_f32 v9, v9, v17
    v_add_f32 v10, v10, v18
    v_add_f32 v11, v11, v19
    v_add_f32 v12, v12, v20
    v_add_f32 v13, v13, v21
    v_add_f32 v14, v14, v22
    v_add_f32 v15, v15, v23
    v_cmp_eq_u32 vcc, 0, v57
    s_mov_b32 s22, 530715648
    s_nop 0
    v_cndmask_b32 v5, v3, v1, vcc
    buffer_load_dwordx4 v[16:19], v5, s[28:31], s22 offen
    buffer_load_dwordx4 v[20:23], v5, s[28:31], s22 offen offset:16
    s_waitcnt vmcnt(0)
    v_add_f32 v8, v8, v16
    v_add_f32 v9, v9, v17
    v_add_f32 v10, v10, v18
    v_add_f32 v11, v11, v19
    v_add_f32 v12, v12, v20
    v_add_f32 v13, v13, v21
    v_add_f32 v14, v14, v22
    v_add_f32 v15, v15, v23
    v_cmp_eq_u32 vcc, 0, v58
    s_mov_b32 s22, 543527936
    s_nop 0
    v_cndmask_b32 v5, v3, v1, vcc
    buffer_load_dwordx4 v[16:19], v5, s[28:31], s22 offen
    buffer_load_dwordx4 v[20:23], v5, s[28:31], s22 offen offset:16
    s_waitcnt vmcnt(0)
    v_add_f32 v8, v8, v16
    v_add_f32 v9, v9, v17
    v_add_f32 v10, v10, v18
    v_add_f32 v11, v11, v19
    v_add_f32 v12, v12, v20
    v_add_f32 v13, v13, v21
    v_add_f32 v14, v14, v22
    v_add_f32 v15, v15, v23
    v_cmp_eq_u32 vcc, 0, v59
    s_mov_b32 s22, 556340224
    s_nop 0
    v_cndmask_b32 v5, v3, v1, vcc
    buffer_load_dwordx4 v[16:19], v5, s[28:31], s22 offen
    buffer_load_dwordx4 v[20:23], v5, s[28:31], s22 offen offset:16
    s_waitcnt vmcnt(0)
    v_add_f32 v8, v8, v16
    v_add_f32 v9, v9, v17
    v_add_f32 v10, v10, v18
    v_add_f32 v11, v11, v19
    v_add_f32 v12, v12, v20
    v_add_f32 v13, v13, v21
    v_add_f32 v14, v14, v22
    v_add_f32 v15, v15, v23
p3_nof:
    s_lshl_b32 s14, s68, 16
    s_and_b32 s15, s68, 0xffff0000
    v_pk_mul_f32 v[16:17], v[8:9], s[14:15] op_sel:[0,0] op_sel_hi:[0,1]
    v_pk_mul_f32 v[20:21], v[12:13], s[14:15] op_sel:[0,0] op_sel_hi:[0,1]
    s_lshl_b32 s16, s69, 16
    s_and_b32 s17, s69, 0xffff0000
    v_pk_mul_f32 v[18:19], v[8:9], s[16:17] op_sel:[0,0] op_sel_hi:[0,1]
    v_pk_mul_f32 v[22:23], v[12:13], s[16:17] op_sel:[0,0] op_sel_hi:[0,1]
    s_lshl_b32 s18, s70, 16
    s_and_b32 s19, s70, 0xffff0000
    v_pk_fma_f32 v[16:17], v[8:9], s[18:19], v[16:17] op_sel:[1,0,0] op_sel_hi:[1,1,1]
    v_pk_fma_f32 v[20:21], v[12:13], s[18:19], v[20:21] op_sel:[1,0,0] op_sel_hi:[1,1,1]
    s_lshl_b32 s12, s71, 16
    s_and_b32 s13, s71, 0xffff0000
    v_pk_fma_f32 v[18:19], v[8:9], s[12:13], v[18:19] op_sel:[1,0,0] op_sel_hi:[1,1,1]
    v_pk_fma_f32 v[22:23], v[12:13], s[12:13], v[22:23] op_sel:[1,0,0] op_sel_hi:[1,1,1]
    s_lshl_b32 s14, s72, 16
    s_and_b32 s15, s72, 0xffff0000
    v_pk_fma_f32 v[16:17], v[10:11], s[14:15], v[16:17] op_sel:[0,0,0] op_sel_hi:[0,1,1]
    v_pk_fma_f32 v[20:21], v[14:15], s[14:15], v[20:21] op_sel:[0,0,0] op_sel_hi:[0,1,1]
    s_lshl_b32 s16, s73, 16
    s_and_b32 s17, s73, 0xffff0000
    v_pk_fma_f32 v[18:19], v[10:11], s[16:17], v[18:19] op_sel:[0,0,0] op_sel_hi:[0,1,1]
    v_pk_fma_f32 v[22:23], v[14:15], s[16:17], v[22:23] op_sel:[0,0,0] op_sel_hi:[0,1,1]
    s_lshl_b32 s18, s74, 16
    s_and_b32 s19, s74, 0xffff0000
    v_pk_fma_f32 v[16:17], v[10:11], s[18:19], v[16:17] op_sel:[1,0,0] op_sel_hi:[1,1,1]
    v_pk_fma_f32 v[20:21], v[14:15], s[18:19], v[20:21] op_sel:[1,0,0] op_sel_hi:[1,1,1]
    s_lshl_b32 s12, s75, 16
    s_and_b32 s13, s75, 0xffff0000
    v_pk_fma_f32 v[18:19], v[10:11], s[12:13], v[18:19] op_sel:[1,0,0] op_sel_hi:[1,1,1]
    v_pk_fma_f32 v[22:23], v[14:15], s[12:13], v[22:23] op_sel:[1,0,0] op_sel_hi:[1,1,1]
    v_mul_f32 v24, v24, v16
    v_mul_f32 v25, v25, v17
    v_mul_f32 v26, v26, v18
    v_mul_f32 v27, v27, v19
    v_mul_f32 v28, v28, v20
    v_mul_f32 v29, v29, v21
    v_mul_f32 v30, v30, v22
    v_mul_f32 v31, v31, v23
    v_cvt_pk_bf16_f32 v24, v24, v25
    v_cvt_pk_bf16_f32 v26, v26, v27
    v_cvt_pk_bf16_f32 v28, v28, v29
    v_cvt_pk_bf16_f32 v30, v30, v31
    v_and_b32 v25, 0xffff0000, v24
    v_lshlrev_b32 v24, 16, v24
    v_and_b32 v27, 0xffff0000, v26
    v_lshlrev_b32 v26, 16, v26
    v_and_b32 v29, 0xffff0000, v28
    v_lshlrev_b32 v28, 16, v28
    v_and_b32 v31, 0xffff0000, v30
    v_lshlrev_b32 v30, 16, v30
    s_lshl_b32 s14, s76, 16
    s_and_b32 s15, s76, 0xffff0000
    v_pk_mul_f32 v[16:17], v[24:25], s[14:15] op_sel:[0,0] op_sel_hi:[0,1]
    v_pk_mul_f32 v[20:21], v[28:29], s[14:15] op_sel:[0,0] op_sel_hi:[0,1]
    s_lshl_b32 s16, s77, 16
    s_and_b32 s17, s77, 0xffff0000
    v_pk_mul_f32 v[18:19], v[24:25], s[16:17] op_sel:[0,0] op_sel_hi:[0,1]
    v_pk_mul_f32 v[22:23], v[28:29], s[16:17] op_sel:[0,0] op_sel_hi:[0,1]
    s_lshl_b32 s18, s78, 16
    s_and_b32 s19, s78, 0xffff0000
    v_pk_fma_f32 v[16:17], v[24:25], s[18:19], v[16:17] op_sel:[1,0,0] op_sel_hi:[1,1,1]
    v_pk_fma_f32 v[20:21], v[28:29], s[18:19], v[20:21] op_sel:[1,0,0] op_sel_hi:[1,1,1]
    s_lshl_b32 s12, s79, 16
    s_and_b32 s13, s79, 0xffff0000
    v_pk_fma_f32 v[18:19], v[24:25], s[12:13], v[18:19] op_sel:[1,0,0] op_sel_hi:[1,1,1]
    v_pk_fma_f32 v[22:23], v[28:29], s[12:13], v[22:23] op_sel:[1,0,0] op_sel_hi:[1,1,1]
    s_lshl_b32 s14, s80, 16
    s_and_b32 s15, s80, 0xffff0000
    v_pk_fma_f32 v[16:17], v[26:27], s[14:15], v[16:17] op_sel:[0,0,0] op_sel_hi:[0,1,1]
    v_pk_fma_f32 v[20:21], v[30:31], s[14:15], v[20:21] op_sel:[0,0,0] op_sel_hi:[0,1,1]
    s_lshl_b32 s16, s81, 16
    s_and_b32 s17, s81, 0xffff0000
    v_pk_fma_f32 v[18:19], v[26:27], s[16:17], v[18:19] op_sel:[0,0,0] op_sel_hi:[0,1,1]
    v_pk_fma_f32 v[22:23], v[30:31], s[16:17], v[22:23] op_sel:[0,0,0] op_sel_hi:[0,1,1]
    s_lshl_b32 s18, s82, 16
    s_and_b32 s19, s82, 0xffff0000
    v_pk_fma_f32 v[16:17], v[26:27], s[18:19], v[16:17] op_sel:[1,0,0] op_sel_hi:[1,1,1]
    v_pk_fma_f32 v[20:21], v[30:31], s[18:19], v[20:21] op_sel:[1,0,0] op_sel_hi:[1,1,1]
    s_lshl_b32 s12, s83, 16
    s_and_b32 s13, s83, 0xffff0000
    v_pk_fma_f32 v[18:19], v[26:27], s[12:13], v[18:19] op_sel:[1,0,0] op_sel_hi:[1,1,1]
    v_pk_fma_f32 v[22:23], v[30:31], s[12:13], v[22:23] op_sel:[1,0,0] op_sel_hi:[1,1,1]
    v_cvt_pk_bf16_f32 v16, v16, v17
    v_cvt_pk_bf16_f32 v18, v18, v19
    v_cvt_pk_bf16_f32 v20, v20, v21
    v_cvt_pk_bf16_f32 v22, v22, v23
    v_and_b32 v17, 0xffff0000, v16
    v_lshlrev_b32 v16, 16, v16
    v_and_b32 v19, 0xffff0000, v18
    v_lshlrev_b32 v18, 16, v18
    v_and_b32 v21, 0xffff0000, v20
    v_lshlrev_b32 v20, 16, v20
    v_and_b32 v23, 0xffff0000, v22
    v_lshlrev_b32 v22, 16, v22
    v_mul_f32 v16, v16, v32
    v_mul_f32 v17, v17, v33
    v_mul_f32 v18, v18, v34
    v_mul_f32 v19, v19, v35
    v_mul_f32 v20, v20, v36
    v_mul_f32 v21, v21, v37
    v_mul_f32 v22, v22, v38
    v_mul_f32 v23, v23, v39
    v_cvt_pk_bf16_f32 v16, v16, v17
    v_cvt_pk_bf16_f32 v18, v18, v19
    v_cvt_pk_bf16_f32 v20, v20, v21
    v_cvt_pk_bf16_f32 v22, v22, v23
    v_and_b32 v17, 0xffff0000, v16
    v_lshlrev_b32 v16, 16, v16
    v_and_b32 v19, 0xffff0000, v18
    v_lshlrev_b32 v18, 16, v18
    v_and_b32 v21, 0xffff0000, v20
    v_lshlrev_b32 v20, 16, v20
    v_and_b32 v23, 0xffff0000, v22
    v_lshlrev_b32 v22, 16, v22
    s_waitcnt vmcnt(0)
    v_lshlrev_b32 v8, 16, v60
    v_and_b32 v9, 0xffff0000, v60
    v_lshlrev_b32 v10, 16, v61
    v_and_b32 v11, 0xffff0000, v61
    v_lshlrev_b32 v12, 16, v62
    v_and_b32 v13, 0xffff0000, v62
    v_lshlrev_b32 v14, 16, v63
    v_and_b32 v15, 0xffff0000, v63
    v_add_f32 v8, v8, v16
    v_add_f32 v9, v9, v17
    v_add_f32 v10, v10, v18
    v_add_f32 v11, v11, v19
    v_add_f32 v12, v12, v20
    v_add_f32 v13, v13, v21
    v_add_f32 v14, v14, v22
    v_add_f32 v15, v15, v23
    v_cvt_pk_bf16_f32 v4, v8, v9
    v_cvt_pk_bf16_f32 v5, v10, v11
    v_cvt_pk_bf16_f32 v6, v12, v13
    v_cvt_pk_bf16_f32 v7, v14, v15
    buffer_store_dwordx4 v[4:7], v2, s[24:27], 0 offen nt
p3_end:
    s_endpgm
.section .rodata,"a"
.p2align 6
.amdhsa_kernel p1_kernel
  .amdhsa_next_free_vgpr 128
  .amdhsa_next_free_sgpr 72
  .amdhsa_accum_offset 128
  .amdhsa_group_segment_fixed_size 0
  .amdhsa_kernarg_size 112
  .amdhsa_user_sgpr_count 2
  .amdhsa_user_sgpr_kernarg_segment_ptr 1
  .amdhsa_system_sgpr_workgroup_id_x 1
  .amdhsa_float_denorm_mode_32 3
.end_amdhsa_kernel
.p2align 6
.amdhsa_kernel p2_kernel
  .amdhsa_next_free_vgpr 128
  .amdhsa_next_free_sgpr 72
  .amdhsa_accum_offset 128
  .amdhsa_group_segment_fixed_size 0
  .amdhsa_kernarg_size 112
  .amdhsa_user_sgpr_count 2
  .amdhsa_user_sgpr_kernarg_segment_ptr 1
  .amdhsa_system_sgpr_workgroup_id_x 1
  .amdhsa_float_denorm_mode_32 3
.end_amdhsa_kernel
.p2align 6
.amdhsa_kernel p3_kernel
  .amdhsa_next_free_vgpr 64
  .amdhsa_next_free_sgpr 84
  .amdhsa_accum_offset 64
  .amdhsa_group_segment_fixed_size 0
  .amdhsa_kernarg_size 112
  .amdhsa_user_sgpr_count 2
  .amdhsa_user_sgpr_kernarg_segment_ptr 1
  .amdhsa_system_sgpr_workgroup_id_x 1
  .amdhsa_float_denorm_mode_32 3
.end_amdhsa_kernel
```

```asm
; @launch kernel=p1_kernel grid=(256,1,1) block=(1024,1,1) lds=163072
; @launch kernel=p2_kernel grid=(256,1,1) block=(1024,1,1) lds=154368
; @launch kernel=p3_kernel grid=(1563,1,1) block=(256,1,1) lds=0
.amdgcn_target "amdgcn-amd-amdhsa--gfx950"
.text
.globl p1_kernel
.p2align 8
.type p1_kernel,@function
p1_kernel:
    s_cmp_ge_u32 s2, 256
    s_cbranch_scc1 p1_end
    s_load_dwordx2 s[52:53], s[0:1], 0
    s_load_dwordx4 s[56:59], s[0:1], 8
    s_load_dwordx2 s[54:55], s[0:1], 32
    s_load_dwordx2 s[60:61], s[0:1], 48
    s_load_dwordx2 s[48:49], s[0:1], 104
    s_load_dwordx2 s[62:63], s[0:1], 96
    v_lshlrev_b32 v1, 4, v0
    v_lshlrev_b32 v2, 3, v0
    v_mov_b32 v3, 1
    v_lshrrev_b32 v117, 6, v0
    s_nop 0
    v_readfirstlane_b32 s28, v117
    s_waitcnt lgkmcnt(0)
    s_load_dword s45, s[60:61], 0
    s_mov_b32 s4, s56
    s_and_b32 s5, s57, 0xffff
    s_mov_b32 s6, 204800000
    s_mov_b32 s7, 0x20000
    s_mov_b32 s8, s58
    s_and_b32 s9, s59, 0xffff
    s_mov_b32 s10, 204800000
    s_mov_b32 s11, 0x20000
    s_mov_b32 s12, s54
    s_and_b32 s13, s55, 0xffff
    s_mov_b32 s14, 102400000
    s_mov_b32 s15, 0x20000
    s_mov_b32 s16, s48
    s_and_b32 s17, s49, 0xffff
    s_mov_b32 s18, 819200000
    s_mov_b32 s19, 0x20000
    s_mov_b32 s29, s2
    s_mul_i32 s31, s2, 73728
    s_lshl_b32 s30, s31, 1
    s_add_u32 s32, s30, 0
    buffer_load_dwordx4 v[94:97], v1, s[4:7], s32 offen nt
    buffer_load_dwordx4 v[102:105], v1, s[8:11], s32 offen nt
    s_add_u32 s32, s31, 0
    buffer_load_dwordx2 v[76:77], v2, s[12:15], s32 offen nt
    s_add_u32 s32, s30, 16384
    buffer_load_dwordx4 v[98:101], v1, s[4:7], s32 offen nt
    buffer_load_dwordx4 v[106:109], v1, s[8:11], s32 offen nt
    s_add_u32 s32, s31, 8192
    buffer_load_dwordx2 v[78:79], v2, s[12:15], s32 offen nt
    s_add_u32 s32, s30, 32768
    buffer_load_dwordx4 v[12:15], v1, s[4:7], s32 offen nt
    buffer_load_dwordx4 v[48:51], v1, s[8:11], s32 offen nt
    s_add_u32 s32, s31, 16384
    buffer_load_dwordx2 v[80:81], v2, s[12:15], s32 offen nt
    s_add_u32 s32, s31, 24576
    buffer_load_dwordx2 v[82:83], v2, s[12:15], s32 offen nt
    s_add_u32 s32, s31, 32768
    buffer_load_dwordx2 v[84:85], v2, s[12:15], s32 offen nt
    s_add_u32 s32, s31, 40960
    buffer_load_dwordx2 v[86:87], v2, s[12:15], s32 offen nt
    s_add_u32 s32, s31, 49152
    buffer_load_dwordx2 v[88:89], v2, s[12:15], s32 offen nt
    s_add_u32 s32, s31, 57344
    buffer_load_dwordx2 v[90:91], v2, s[12:15], s32 offen nt
    s_add_u32 s32, s31, 65536
    buffer_load_dwordx2 v[92:93], v2, s[12:15], s32 offen nt
    s_mov_b32 s24, s52
    s_and_b32 s25, s53, 0xffff
    s_mov_b32 s26, 6400000
    s_mov_b32 s27, 0x20000
    s_mov_b32 s20, s48
    s_and_b32 s21, s49, 0xffff
    s_mov_b32 s22, 0
    s_mov_b32 s23, 0x20000
    s_mov_b32 s40, s62
    s_and_b32 s41, s63, 0xffff
    s_mov_b32 s42, 256
    s_mov_b32 s43, 0x20000
    s_mov_b32 s36, 643827
    s_mov_b32 s37, 214609
    s_mov_b32 s38, 343268
    s_mov_b32 s39, -6671
    s_mov_b32 s44, -12512
    s_mov_b32 s34, 1
    v_mov_b32 v73, 0x40000000
    v_mov_b32 v122, 0
    v_mov_b32 v123, 0
    v_mov_b32 v124, 0
    v_mov_b32 v125, 0
    ds_write_b128 v1, v[122:125] offset:0
    s_waitcnt lgkmcnt(0)
    s_barrier
    s_lshl_b32 s45, s45, 16
p1_tile:
    v_mov_b32 v122, 0
    v_mov_b32 v123, 0
    v_mov_b32 v124, 0
    v_mov_b32 v125, 0
    ds_write_b128 v1, v[122:125] offset:10496
    ds_write_b128 v1, v[122:125] offset:26880
    ds_write_b128 v1, v[122:125] offset:43264
    s_cmp_lg_u32 s28, 15
    s_cbranch_scc1 p1_tk0
    v_mov_b32 v127, 1
    s_mov_b64 exec, 1
    buffer_atomic_add v127, off, s[40:43], 0 offset:128 sc0 sc1
    s_mov_b64 exec, -1
p1_tk0:
    v_mov_b32 v123, s45
    v_mov_b32 v124, 0x007f007f
    v_mov_b32 v125, 0xe000
    v_mov_b32 v126, 0xffff0000
    s_cmp_lt_u32 s29, 1426
    s_cselect_b32 s6, 204800000, 0
    s_cselect_b32 s10, 204800000, 0
    s_add_u32 s32, s30, 49152
    buffer_load_dwordx4 v[16:19], v1, s[4:7], s32 offen nt
    buffer_load_dwordx4 v[52:55], v1, s[8:11], s32 offen nt
    s_waitcnt vmcnt(14)
    v_lshlrev_b32 v117, 16, v76
    v_and_b32 v118, v126, v76
    v_mul_f32 v117, v123, v117
    v_mul_f32 v118, v123, v118
    v_cvt_pk_bf16_f32 v117, v117, v118
    v_and_b32 v118, v126, v117
    v_lshlrev_b32 v117, 16, v117
    v_mul_f32 v117, 0.15915494, v117
    v_mul_f32 v118, 0.15915494, v118
    v_fract_f32 v117, v117
    v_fract_f32 v118, v118
    v_cos_f32 v117, v117
    v_cos_f32 v118, v118
    v_mul_hi_u32_u24 v122, s38, v102
    v_mul_hi_u32_u24 v121, s37, v94
    v_mul_hi_u32_u24 v120, s36, v94
    v_mad_i32_i24 v110, v122, s44, v102
    v_mad_u32_u24 v40, v122, 40, v121
    v_mad_i32_i24 v4, v120, s39, v94
    v_lshlrev_b16 v40, 2, v40
    v_mad_i32_i24 v120, v121, -3, v120
    ds_add_u32 v40, v3 offset:0
    v_lshl_or_b32 v4, v110, 16, v4
    v_lshl_or_b32 v4, v120, 30, v4
    v_mul_f32 v117, 0x03800000, v117
    v_mul_f32 v118, 0x03800000, v118
    v_cvt_pk_bf16_f32 v117, v117, v118
    v_mul_hi_u32_u24 v122, s38, v103
    v_mul_hi_u32_u24 v121, s37, v95
    v_mul_hi_u32_u24 v120, s36, v95
    v_mad_i32_i24 v110, v122, s44, v103
    v_mad_u32_u24 v41, v122, 40, v121
    v_mad_i32_i24 v5, v120, s39, v95
    v_lshlrev_b16 v41, 2, v41
    v_mad_i32_i24 v120, v121, -3, v120
    ds_add_u32 v41, v3 offset:0
    v_lshl_or_b32 v5, v110, 16, v5
    v_lshl_or_b32 v5, v120, 30, v5
    v_lshrrev_b32 v118, 3, v117
    v_lshrrev_b32 v119, 8, v117
    v_lshlrev_b16 v117, 13, v117
    v_bitop3_b32 v119, v118, v119, v124 bitop3:0x1b
    v_bitop3_b32 v4, v117, v125, v4 bitop3:0xae
    v_lshl_or_b32 v40, v119, 16, v40
    v_bitop3_b32 v5, v118, v125, v5 bitop3:0xae
    v_bitop3_b32 v41, v119, v126, v41 bitop3:0xea
    v_lshlrev_b32 v117, 16, v77
    v_and_b32 v118, v126, v77
    v_mul_f32 v117, v123, v117
    v_mul_f32 v118, v123, v118
    v_cvt_pk_bf16_f32 v117, v117, v118
    v_and_b32 v118, v126, v117
    v_lshlrev_b32 v117, 16, v117
    v_mul_f32 v117, 0.15915494, v117
    v_mul_f32 v118, 0.15915494, v118
    v_fract_f32 v117, v117
    v_fract_f32 v118, v118
    v_cos_f32 v117, v117
    v_cos_f32 v118, v118
    v_mul_hi_u32_u24 v122, s38, v104
    v_mul_hi_u32_u24 v121, s37, v96
    v_mul_hi_u32_u24 v120, s36, v96
    v_mad_i32_i24 v110, v122, s44, v104
    v_mad_u32_u24 v42, v122, 40, v121
    v_mad_i32_i24 v6, v120, s39, v96
    v_lshlrev_b16 v42, 2, v42
    v_mad_i32_i24 v120, v121, -3, v120
    ds_add_u32 v42, v3 offset:0
    v_lshl_or_b32 v6, v110, 16, v6
    v_lshl_or_b32 v6, v120, 30, v6
    v_mul_f32 v117, 0x03800000, v117
    v_mul_f32 v118, 0x03800000, v118
    v_cvt_pk_bf16_f32 v117, v117, v118
    v_mul_hi_u32_u24 v122, s38, v105
    v_mul_hi_u32_u24 v121, s37, v97
    v_mul_hi_u32_u24 v120, s36, v97
    v_mad_i32_i24 v110, v122, s44, v105
    v_mad_u32_u24 v43, v122, 40, v121
    v_mad_i32_i24 v7, v120, s39, v97
    v_lshlrev_b16 v43, 2, v43
    v_mad_i32_i24 v120, v121, -3, v120
    ds_add_u32 v43, v3 offset:0
    v_lshl_or_b32 v7, v110, 16, v7
    v_lshl_or_b32 v7, v120, 30, v7
    v_lshrrev_b32 v118, 3, v117
    v_lshrrev_b32 v119, 8, v117
    v_lshlrev_b16 v117, 13, v117
    v_bitop3_b32 v119, v118, v119, v124 bitop3:0x1b
    v_bitop3_b32 v6, v117, v125, v6 bitop3:0xae
    v_lshl_or_b32 v42, v119, 16, v42
    v_bitop3_b32 v7, v118, v125, v7 bitop3:0xae
    v_bitop3_b32 v43, v119, v126, v43 bitop3:0xea
    s_cmp_lt_u32 s29, 1389
    s_cselect_b32 s6, 204800000, 0
    s_cselect_b32 s10, 204800000, 0
    s_add_u32 s32, s30, 65536
    buffer_load_dwordx4 v[20:23], v1, s[4:7], s32 offen nt
    buffer_load_dwordx4 v[56:59], v1, s[8:11], s32 offen nt
    s_cmp_ge_u32 s29, 1499
    s_cbranch_scc1 p1_k2
    s_cmp_lg_u32 s34, 0
    s_cbranch_scc1 p1_w3
    s_waitcnt vmcnt(10)
p1_w3:
    s_waitcnt vmcnt(13)
    v_lshlrev_b32 v117, 16, v78
    v_and_b32 v118, v126, v78
    v_mul_f32 v117, v123, v117
    v_mul_f32 v118, v123, v118
    v_cvt_pk_bf16_f32 v117, v117, v118
    v_and_b32 v118, v126, v117
    v_lshlrev_b32 v117, 16, v117
    v_mul_f32 v117, 0.15915494, v117
    v_mul_f32 v118, 0.15915494, v118
    v_fract_f32 v117, v117
    v_fract_f32 v118, v118
    v_cos_f32 v117, v117
    v_cos_f32 v118, v118
    v_mul_hi_u32_u24 v122, s38, v106
    v_mul_hi_u32_u24 v121, s37, v98
    v_mul_hi_u32_u24 v120, s36, v98
    v_mad_i32_i24 v110, v122, s44, v106
    v_mad_u32_u24 v44, v122, 40, v121
    v_mad_i32_i24 v8, v120, s39, v98
    v_lshlrev_b16 v44, 2, v44
    v_mad_i32_i24 v120, v121, -3, v120
    ds_add_u32 v44, v3 offset:0
    v_lshl_or_b32 v8, v110, 16, v8
    v_lshl_or_b32 v8, v120, 30, v8
    v_mul_f32 v117, 0x03800000, v117
    v_mul_f32 v118, 0x03800000, v118
    v_cvt_pk_bf16_f32 v117, v117, v118
    v_mul_hi_u32_u24 v122, s38, v107
    v_mul_hi_u32_u24 v121, s37, v99
    v_mul_hi_u32_u24 v120, s36, v99
    v_mad_i32_i24 v110, v122, s44, v107
    v_mad_u32_u24 v45, v122, 40, v121
    v_mad_i32_i24 v9, v120, s39, v99
    v_lshlrev_b16 v45, 2, v45
    v_mad_i32_i24 v120, v121, -3, v120
    ds_add_u32 v45, v3 offset:0
    v_lshl_or_b32 v9, v110, 16, v9
    v_lshl_or_b32 v9, v120, 30, v9
    v_lshrrev_b32 v118, 3, v117
    v_lshrrev_b32 v119, 8, v117
    v_lshlrev_b16 v117, 13, v117
    v_bitop3_b32 v119, v118, v119, v124 bitop3:0x1b
    v_bitop3_b32 v8, v117, v125, v8 bitop3:0xae
    v_lshl_or_b32 v44, v119, 16, v44
    v_bitop3_b32 v9, v118, v125, v9 bitop3:0xae
    v_bitop3_b32 v45, v119, v126, v45 bitop3:0xea
    v_lshlrev_b32 v117, 16, v79
    v_and_b32 v118, v126, v79
    v_mul_f32 v117, v123, v117
    v_mul_f32 v118, v123, v118
    v_cvt_pk_bf16_f32 v117, v117, v118
    v_and_b32 v118, v126, v117
    v_lshlrev_b32 v117, 16, v117
    v_mul_f32 v117, 0.15915494, v117
    v_mul_f32 v118, 0.15915494, v118
    v_fract_f32 v117, v117
    v_fract_f32 v118, v118
    v_cos_f32 v117, v117
    v_cos_f32 v118, v118
    v_mul_hi_u32_u24 v122, s38, v108
    v_mul_hi_u32_u24 v121, s37, v100
    v_mul_hi_u32_u24 v120, s36, v100
    v_mad_i32_i24 v110, v122, s44, v108
    v_mad_u32_u24 v46, v122, 40, v121
    v_mad_i32_i24 v10, v120, s39, v100
    v_lshlrev_b16 v46, 2, v46
    v_mad_i32_i24 v120, v121, -3, v120
    ds_add_u32 v46, v3 offset:0
    v_lshl_or_b32 v10, v110, 16, v10
    v_lshl_or_b32 v10, v120, 30, v10
    v_mul_f32 v117, 0x03800000, v117
    v_mul_f32 v118, 0x03800000, v118
    v_cvt_pk_bf16_f32 v117, v117, v118
    v_mul_hi_u32_u24 v122, s38, v109
    v_mul_hi_u32_u24 v121, s37, v101
    v_mul_hi_u32_u24 v120, s36, v101
    v_mad_i32_i24 v110, v122, s44, v109
    v_mad_u32_u24 v47, v122, 40, v121
    v_mad_i32_i24 v11, v120, s39, v101
    v_lshlrev_b16 v47, 2, v47
    v_mad_i32_i24 v120, v121, -3, v120
    ds_add_u32 v47, v3 offset:0
    v_lshl_or_b32 v11, v110, 16, v11
    v_lshl_or_b32 v11, v120, 30, v11
    v_lshrrev_b32 v118, 3, v117
    v_lshrrev_b32 v119, 8, v117
    v_lshlrev_b16 v117, 13, v117
    v_bitop3_b32 v119, v118, v119, v124 bitop3:0x1b
    v_bitop3_b32 v10, v117, v125, v10 bitop3:0xae
    v_lshl_or_b32 v46, v119, 16, v46
    v_bitop3_b32 v11, v118, v125, v11 bitop3:0xae
    v_bitop3_b32 v47, v119, v126, v47 bitop3:0xea
p1_k2:
    s_cmp_lt_u32 s29, 1352
    s_cselect_b32 s6, 204800000, 0
    s_cselect_b32 s10, 204800000, 0
    s_add_u32 s32, s30, 81920
    buffer_load_dwordx4 v[24:27], v1, s[4:7], s32 offen nt
    buffer_load_dwordx4 v[60:63], v1, s[8:11], s32 offen nt
    s_cmp_ge_u32 s29, 1462
    s_cbranch_scc1 p1_k4
    s_cmp_lg_u32 s34, 0
    s_cbranch_scc1 p1_w5
    s_waitcnt vmcnt(6)
p1_w5:
    s_waitcnt vmcnt(11)
    v_lshlrev_b32 v117, 16, v80
    v_and_b32 v118, v126, v80
    v_mul_f32 v117, v123, v117
    v_mul_f32 v118, v123, v118
    v_cvt_pk_bf16_f32 v117, v117, v118
    v_and_b32 v118, v126, v117
    v_lshlrev_b32 v117, 16, v117
    v_mul_f32 v117, 0.15915494, v117
    v_mul_f32 v118, 0.15915494, v118
    v_fract_f32 v117, v117
    v_fract_f32 v118, v118
    v_cos_f32 v117, v117
    v_cos_f32 v118, v118
    v_mul_hi_u32_u24 v122, s38, v48
    v_mul_hi_u32_u24 v121, s37, v12
    v_mul_hi_u32_u24 v120, s36, v12
    v_mad_i32_i24 v110, v122, s44, v48
    v_mad_u32_u24 v48, v122, 40, v121
    v_mad_i32_i24 v12, v120, s39, v12
    v_lshlrev_b16 v48, 2, v48
    v_mad_i32_i24 v120, v121, -3, v120
    ds_add_u32 v48, v3 offset:0
    v_lshl_or_b32 v12, v110, 16, v12
    v_lshl_or_b32 v12, v120, 30, v12
    v_mul_f32 v117, 0x03800000, v117
    v_mul_f32 v118, 0x03800000, v118
    v_cvt_pk_bf16_f32 v117, v117, v118
    v_mul_hi_u32_u24 v122, s38, v49
    v_mul_hi_u32_u24 v121, s37, v13
    v_mul_hi_u32_u24 v120, s36, v13
    v_mad_i32_i24 v110, v122, s44, v49
    v_mad_u32_u24 v49, v122, 40, v121
    v_mad_i32_i24 v13, v120, s39, v13
    v_lshlrev_b16 v49, 2, v49
    v_mad_i32_i24 v120, v121, -3, v120
    ds_add_u32 v49, v3 offset:0
    v_lshl_or_b32 v13, v110, 16, v13
    v_lshl_or_b32 v13, v120, 30, v13
    v_lshrrev_b32 v118, 3, v117
    v_lshrrev_b32 v119, 8, v117
    v_lshlrev_b16 v117, 13, v117
    v_bitop3_b32 v119, v118, v119, v124 bitop3:0x1b
    v_bitop3_b32 v12, v117, v125, v12 bitop3:0xae
    v_lshl_or_b32 v48, v119, 16, v48
    v_bitop3_b32 v13, v118, v125, v13 bitop3:0xae
    v_bitop3_b32 v49, v119, v126, v49 bitop3:0xea
    v_lshlrev_b32 v117, 16, v81
    v_and_b32 v118, v126, v81
    v_mul_f32 v117, v123, v117
    v_mul_f32 v118, v123, v118
    v_cvt_pk_bf16_f32 v117, v117, v118
    v_and_b32 v118, v126, v117
    v_lshlrev_b32 v117, 16, v117
    v_mul_f32 v117, 0.15915494, v117
    v_mul_f32 v118, 0.15915494, v118
    v_fract_f32 v117, v117
    v_fract_f32 v118, v118
    v_cos_f32 v117, v117
    v_cos_f32 v118, v118
    v_mul_hi_u32_u24 v122, s38, v50
    v_mul_hi_u32_u24 v121, s37, v14
    v_mul_hi_u32_u24 v120, s36, v14
    v_mad_i32_i24 v110, v122, s44, v50
    v_mad_u32_u24 v50, v122, 40, v121
    v_mad_i32_i24 v14, v120, s39, v14
    v_lshlrev_b16 v50, 2, v50
    v_mad_i32_i24 v120, v121, -3, v120
    ds_add_u32 v50, v3 offset:0
    v_lshl_or_b32 v14, v110, 16, v14
    v_lshl_or_b32 v14, v120, 30, v14
    v_mul_f32 v117, 0x03800000, v117
    v_mul_f32 v118, 0x03800000, v118
    v_cvt_pk_bf16_f32 v117, v117, v118
    v_mul_hi_u32_u24 v122, s38, v51
    v_mul_hi_u32_u24 v121, s37, v15
    v_mul_hi_u32_u24 v120, s36, v15
    v_mad_i32_i24 v110, v122, s44, v51
    v_mad_u32_u24 v51, v122, 40, v121
    v_mad_i32_i24 v15, v120, s39, v15
    v_lshlrev_b16 v51, 2, v51
    v_mad_i32_i24 v120, v121, -3, v120
    ds_add_u32 v51, v3 offset:0
    v_lshl_or_b32 v15, v110, 16, v15
    v_lshl_or_b32 v15, v120, 30, v15
    v_lshrrev_b32 v118, 3, v117
    v_lshrrev_b32 v119, 8, v117
    v_lshlrev_b16 v117, 13, v117
    v_bitop3_b32 v119, v118, v119, v124 bitop3:0x1b
    v_bitop3_b32 v14, v117, v125, v14 bitop3:0xae
    v_lshl_or_b32 v50, v119, 16, v50
    v_bitop3_b32 v15, v118, v125, v15 bitop3:0xae
    v_bitop3_b32 v51, v119, v126, v51 bitop3:0xea
p1_k4:
    s_cmp_lt_u32 s29, 1315
    s_cselect_b32 s6, 204800000, 0
    s_cselect_b32 s10, 204800000, 0
    s_add_u32 s32, s30, 98304
    buffer_load_dwordx4 v[28:31], v1, s[4:7], s32 offen nt
    buffer_load_dwordx4 v[64:67], v1, s[8:11], s32 offen nt
    s_cmp_ge_u32 s29, 1426
    s_cbranch_scc1 p1_k6
    s_waitcnt vmcnt(6)
    v_lshlrev_b32 v117, 16, v82
    v_and_b32 v118, v126, v82
    v_mul_f32 v117, v123, v117
    v_mul_f32 v118, v123, v118
    v_cvt_pk_bf16_f32 v117, v117, v118
    v_and_b32 v118, v126, v117
    v_lshlrev_b32 v117, 16, v117
    v_mul_f32 v117, 0.15915494, v117
    v_mul_f32 v118, 0.15915494, v118
    v_fract_f32 v117, v117
    v_fract_f32 v118, v118
    v_cos_f32 v117, v117
    v_cos_f32 v118, v118
    v_mul_hi_u32_u24 v122, s38, v52
    v_mul_hi_u32_u24 v121, s37, v16
    v_mul_hi_u32_u24 v120, s36, v16
    v_mad_i32_i24 v110, v122, s44, v52
    v_mad_u32_u24 v52, v122, 40, v121
    v_mad_i32_i24 v16, v120, s39, v16
    v_lshlrev_b16 v52, 2, v52
    v_mad_i32_i24 v120, v121, -3, v120
    ds_add_u32 v52, v3 offset:0
    v_lshl_or_b32 v16, v110, 16, v16
    v_lshl_or_b32 v16, v120, 30, v16
    v_mul_f32 v117, 0x03800000, v117
    v_mul_f32 v118, 0x03800000, v118
    v_cvt_pk_bf16_f32 v117, v117, v118
    v_mul_hi_u32_u24 v122, s38, v53
    v_mul_hi_u32_u24 v121, s37, v17
    v_mul_hi_u32_u24 v120, s36, v17
    v_mad_i32_i24 v110, v122, s44, v53
    v_mad_u32_u24 v53, v122, 40, v121
    v_mad_i32_i24 v17, v120, s39, v17
    v_lshlrev_b16 v53, 2, v53
    v_mad_i32_i24 v120, v121, -3, v120
    ds_add_u32 v53, v3 offset:0
    v_lshl_or_b32 v17, v110, 16, v17
    v_lshl_or_b32 v17, v120, 30, v17
    v_lshrrev_b32 v118, 3, v117
    v_lshrrev_b32 v119, 8, v117
    v_lshlrev_b16 v117, 13, v117
    v_bitop3_b32 v119, v118, v119, v124 bitop3:0x1b
    v_bitop3_b32 v16, v117, v125, v16 bitop3:0xae
    v_lshl_or_b32 v52, v119, 16, v52
    v_bitop3_b32 v17, v118, v125, v17 bitop3:0xae
    v_bitop3_b32 v53, v119, v126, v53 bitop3:0xea
    v_lshlrev_b32 v117, 16, v83
    v_and_b32 v118, v126, v83
    v_mul_f32 v117, v123, v117
    v_mul_f32 v118, v123, v118
    v_cvt_pk_bf16_f32 v117, v117, v118
    v_and_b32 v118, v126, v117
    v_lshlrev_b32 v117, 16, v117
    v_mul_f32 v117, 0.15915494, v117
    v_mul_f32 v118, 0.15915494, v118
    v_fract_f32 v117, v117
    v_fract_f32 v118, v118
    v_cos_f32 v117, v117
    v_cos_f32 v118, v118
    v_mul_hi_u32_u24 v122, s38, v54
    v_mul_hi_u32_u24 v121, s37, v18
    v_mul_hi_u32_u24 v120, s36, v18
    v_mad_i32_i24 v110, v122, s44, v54
    v_mad_u32_u24 v54, v122, 40, v121
    v_mad_i32_i24 v18, v120, s39, v18
    v_lshlrev_b16 v54, 2, v54
    v_mad_i32_i24 v120, v121, -3, v120
    ds_add_u32 v54, v3 offset:0
    v_lshl_or_b32 v18, v110, 16, v18
    v_lshl_or_b32 v18, v120, 30, v18
    v_mul_f32 v117, 0x03800000, v117
    v_mul_f32 v118, 0x03800000, v118
    v_cvt_pk_bf16_f32 v117, v117, v118
    v_mul_hi_u32_u24 v122, s38, v55
    v_mul_hi_u32_u24 v121, s37, v19
    v_mul_hi_u32_u24 v120, s36, v19
    v_mad_i32_i24 v110, v122, s44, v55
    v_mad_u32_u24 v55, v122, 40, v121
    v_mad_i32_i24 v19, v120, s39, v19
    v_lshlrev_b16 v55, 2, v55
    v_mad_i32_i24 v120, v121, -3, v120
    ds_add_u32 v55, v3 offset:0
    v_lshl_or_b32 v19, v110, 16, v19
    v_lshl_or_b32 v19, v120, 30, v19
    v_lshrrev_b32 v118, 3, v117
    v_lshrrev_b32 v119, 8, v117
    v_lshlrev_b16 v117, 13, v117
    v_bitop3_b32 v119, v118, v119, v124 bitop3:0x1b
    v_bitop3_b32 v18, v117, v125, v18 bitop3:0xae
    v_lshl_or_b32 v54, v119, 16, v54
    v_bitop3_b32 v19, v118, v125, v19 bitop3:0xae
    v_bitop3_b32 v55, v119, v126, v55 bitop3:0xea
p1_k6:
    s_cmp_lt_u32 s29, 1279
    s_cselect_b32 s6, 204800000, 0
    s_cselect_b32 s10, 204800000, 0
    s_add_u32 s32, s30, 114688
    buffer_load_dwordx4 v[32:35], v1, s[4:7], s32 offen nt
    buffer_load_dwordx4 v[68:71], v1, s[8:11], s32 offen nt
    s_cmp_ge_u32 s29, 1389
    s_cbranch_scc1 p1_k8
    s_waitcnt vmcnt(6)
    v_lshlrev_b32 v117, 16, v84
    v_and_b32 v118, v126, v84
    v_mul_f32 v117, v123, v117
    v_mul_f32 v118, v123, v118
    v_cvt_pk_bf16_f32 v117, v117, v118
    v_and_b32 v118, v126, v117
    v_lshlrev_b32 v117, 16, v117
    v_mul_f32 v117, 0.15915494, v117
    v_mul_f32 v118, 0.15915494, v118
    v_fract_f32 v117, v117
    v_fract_f32 v118, v118
    v_cos_f32 v117, v117
    v_cos_f32 v118, v118
    v_mul_hi_u32_u24 v122, s38, v56
    v_mul_hi_u32_u24 v121, s37, v20
    v_mul_hi_u32_u24 v120, s36, v20
    v_mad_i32_i24 v110, v122, s44, v56
    v_mad_u32_u24 v56, v122, 40, v121
    v_mad_i32_i24 v20, v120, s39, v20
    v_lshlrev_b16 v56, 2, v56
    v_mad_i32_i24 v120, v121, -3, v120
    ds_add_u32 v56, v3 offset:0
    v_lshl_or_b32 v20, v110, 16, v20
    v_lshl_or_b32 v20, v120, 30, v20
    v_mul_f32 v117, 0x03800000, v117
    v_mul_f32 v118, 0x03800000, v118
    v_cvt_pk_bf16_f32 v117, v117, v118
    v_mul_hi_u32_u24 v122, s38, v57
    v_mul_hi_u32_u24 v121, s37, v21
    v_mul_hi_u32_u24 v120, s36, v21
    v_mad_i32_i24 v110, v122, s44, v57
    v_mad_u32_u24 v57, v122, 40, v121
    v_mad_i32_i24 v21, v120, s39, v21
    v_lshlrev_b16 v57, 2, v57
    v_mad_i32_i24 v120, v121, -3, v120
    ds_add_u32 v57, v3 offset:0
    v_lshl_or_b32 v21, v110, 16, v21
    v_lshl_or_b32 v21, v120, 30, v21
    v_lshrrev_b32 v118, 3, v117
    v_lshrrev_b32 v119, 8, v117
    v_lshlrev_b16 v117, 13, v117
    v_bitop3_b32 v119, v118, v119, v124 bitop3:0x1b
    v_bitop3_b32 v20, v117, v125, v20 bitop3:0xae
    v_lshl_or_b32 v56, v119, 16, v56
    v_bitop3_b32 v21, v118, v125, v21 bitop3:0xae
    v_bitop3_b32 v57, v119, v126, v57 bitop3:0xea
    v_lshlrev_b32 v117, 16, v85
    v_and_b32 v118, v126, v85
    v_mul_f32 v117, v123, v117
    v_mul_f32 v118, v123, v118
    v_cvt_pk_bf16_f32 v117, v117, v118
    v_and_b32 v118, v126, v117
    v_lshlrev_b32 v117, 16, v117
    v_mul_f32 v117, 0.15915494, v117
    v_mul_f32 v118, 0.15915494, v118
    v_fract_f32 v117, v117
    v_fract_f32 v118, v118
    v_cos_f32 v117, v117
    v_cos_f32 v118, v118
    v_mul_hi_u32_u24 v122, s38, v58
    v_mul_hi_u32_u24 v121, s37, v22
    v_mul_hi_u32_u24 v120, s36, v22
    v_mad_i32_i24 v110, v122, s44, v58
    v_mad_u32_u24 v58, v122, 40, v121
    v_mad_i32_i24 v22, v120, s39, v22
    v_lshlrev_b16 v58, 2, v58
    v_mad_i32_i24 v120, v121, -3, v120
    ds_add_u32 v58, v3 offset:0
    v_lshl_or_b32 v22, v110, 16, v22
    v_lshl_or_b32 v22, v120, 30, v22
    v_mul_f32 v117, 0x03800000, v117
    v_mul_f32 v118, 0x03800000, v118
    v_cvt_pk_bf16_f32 v117, v117, v118
    v_mul_hi_u32_u24 v122, s38, v59
    v_mul_hi_u32_u24 v121, s37, v23
    v_mul_hi_u32_u24 v120, s36, v23
    v_mad_i32_i24 v110, v122, s44, v59
    v_mad_u32_u24 v59, v122, 40, v121
    v_mad_i32_i24 v23, v120, s39, v23
    v_lshlrev_b16 v59, 2, v59
    v_mad_i32_i24 v120, v121, -3, v120
    ds_add_u32 v59, v3 offset:0
    v_lshl_or_b32 v23, v110, 16, v23
    v_lshl_or_b32 v23, v120, 30, v23
    v_lshrrev_b32 v118, 3, v117
    v_lshrrev_b32 v119, 8, v117
    v_lshlrev_b16 v117, 13, v117
    v_bitop3_b32 v119, v118, v119, v124 bitop3:0x1b
    v_bitop3_b32 v22, v117, v125, v22 bitop3:0xae
    v_lshl_or_b32 v58, v119, 16, v58
    v_bitop3_b32 v23, v118, v125, v23 bitop3:0xae
    v_bitop3_b32 v59, v119, v126, v59 bitop3:0xea
p1_k8:
    s_cmp_lt_u32 s29, 1242
    s_cselect_b32 s6, 204800000, 0
    s_cselect_b32 s10, 204800000, 0
    s_add_u32 s32, s30, 131072
    buffer_load_dwordx4 v[36:39], v1, s[4:7], s32 offen nt
    buffer_load_dwordx4 v[72:75], v1, s[8:11], s32 offen nt
    s_cmp_ge_u32 s29, 1352
    s_cbranch_scc1 p1_k10
    s_waitcnt vmcnt(6)
    v_lshlrev_b32 v117, 16, v86
    v_and_b32 v118, v126, v86
    v_mul_f32 v117, v123, v117
    v_mul_f32 v118, v123, v118
    v_cvt_pk_bf16_f32 v117, v117, v118
    v_and_b32 v118, v126, v117
    v_lshlrev_b32 v117, 16, v117
    v_mul_f32 v117, 0.15915494, v117
    v_mul_f32 v118, 0.15915494, v118
    v_fract_f32 v117, v117
    v_fract_f32 v118, v118
    v_cos_f32 v117, v117
    v_cos_f32 v118, v118
    v_mul_hi_u32_u24 v122, s38, v60
    v_mul_hi_u32_u24 v121, s37, v24
    v_mul_hi_u32_u24 v120, s36, v24
    v_mad_i32_i24 v110, v122, s44, v60
    v_mad_u32_u24 v60, v122, 40, v121
    v_mad_i32_i24 v24, v120, s39, v24
    v_lshlrev_b16 v60, 2, v60
    v_mad_i32_i24 v120, v121, -3, v120
    ds_add_u32 v60, v3 offset:0
    v_lshl_or_b32 v24, v110, 16, v24
    v_lshl_or_b32 v24, v120, 30, v24
    v_mul_f32 v117, 0x03800000, v117
    v_mul_f32 v118, 0x03800000, v118
    v_cvt_pk_bf16_f32 v117, v117, v118
    v_mul_hi_u32_u24 v122, s38, v61
    v_mul_hi_u32_u24 v121, s37, v25
    v_mul_hi_u32_u24 v120, s36, v25
    v_mad_i32_i24 v110, v122, s44, v61
    v_mad_u32_u24 v61, v122, 40, v121
    v_mad_i32_i24 v25, v120, s39, v25
    v_lshlrev_b16 v61, 2, v61
    v_mad_i32_i24 v120, v121, -3, v120
    ds_add_u32 v61, v3 offset:0
    v_lshl_or_b32 v25, v110, 16, v25
    v_lshl_or_b32 v25, v120, 30, v25
    v_lshrrev_b32 v118, 3, v117
    v_lshrrev_b32 v119, 8, v117
    v_lshlrev_b16 v117, 13, v117
    v_bitop3_b32 v119, v118, v119, v124 bitop3:0x1b
    v_bitop3_b32 v24, v117, v125, v24 bitop3:0xae
    v_lshl_or_b32 v60, v119, 16, v60
    v_bitop3_b32 v25, v118, v125, v25 bitop3:0xae
    v_bitop3_b32 v61, v119, v126, v61 bitop3:0xea
    v_lshlrev_b32 v117, 16, v87
    v_and_b32 v118, v126, v87
    v_mul_f32 v117, v123, v117
    v_mul_f32 v118, v123, v118
    v_cvt_pk_bf16_f32 v117, v117, v118
    v_and_b32 v118, v126, v117
    v_lshlrev_b32 v117, 16, v117
    v_mul_f32 v117, 0.15915494, v117
    v_mul_f32 v118, 0.15915494, v118
    v_fract_f32 v117, v117
    v_fract_f32 v118, v118
    v_cos_f32 v117, v117
    v_cos_f32 v118, v118
    v_mul_hi_u32_u24 v122, s38, v62
    v_mul_hi_u32_u24 v121, s37, v26
    v_mul_hi_u32_u24 v120, s36, v26
    v_mad_i32_i24 v110, v122, s44, v62
    v_mad_u32_u24 v62, v122, 40, v121
    v_mad_i32_i24 v26, v120, s39, v26
    v_lshlrev_b16 v62, 2, v62
    v_mad_i32_i24 v120, v121, -3, v120
    ds_add_u32 v62, v3 offset:0
    v_lshl_or_b32 v26, v110, 16, v26
    v_lshl_or_b32 v26, v120, 30, v26
    v_mul_f32 v117, 0x03800000, v117
    v_mul_f32 v118, 0x03800000, v118
    v_cvt_pk_bf16_f32 v117, v117, v118
    v_mul_hi_u32_u24 v122, s38, v63
    v_mul_hi_u32_u24 v121, s37, v27
    v_mul_hi_u32_u24 v120, s36, v27
    v_mad_i32_i24 v110, v122, s44, v63
    v_mad_u32_u24 v63, v122, 40, v121
    v_mad_i32_i24 v27, v120, s39, v27
    v_lshlrev_b16 v63, 2, v63
    v_mad_i32_i24 v120, v121, -3, v120
    ds_add_u32 v63, v3 offset:0
    v_lshl_or_b32 v27, v110, 16, v27
    v_lshl_or_b32 v27, v120, 30, v27
    v_lshrrev_b32 v118, 3, v117
    v_lshrrev_b32 v119, 8, v117
    v_lshlrev_b16 v117, 13, v117
    v_bitop3_b32 v119, v118, v119, v124 bitop3:0x1b
    v_bitop3_b32 v26, v117, v125, v26 bitop3:0xae
    v_lshl_or_b32 v62, v119, 16, v62
    v_bitop3_b32 v27, v118, v125, v27 bitop3:0xae
    v_bitop3_b32 v63, v119, v126, v63 bitop3:0xea
p1_k10:
    s_cmp_ge_u32 s29, 1315
    s_cbranch_scc1 p1_k12
    s_waitcnt vmcnt(4)
    v_lshlrev_b32 v117, 16, v88
    v_and_b32 v118, v126, v88
    v_mul_f32 v117, v123, v117
    v_mul_f32 v118, v123, v118
    v_cvt_pk_bf16_f32 v117, v117, v118
    v_and_b32 v118, v126, v117
    v_lshlrev_b32 v117, 16, v117
    v_mul_f32 v117, 0.15915494, v117
    v_mul_f32 v118, 0.15915494, v118
    v_fract_f32 v117, v117
    v_fract_f32 v118, v118
    v_cos_f32 v117, v117
    v_cos_f32 v118, v118
    v_mul_hi_u32_u24 v122, s38, v64
    v_mul_hi_u32_u24 v121, s37, v28
    v_mul_hi_u32_u24 v120, s36, v28
    v_mad_i32_i24 v110, v122, s44, v64
    v_mad_u32_u24 v64, v122, 40, v121
    v_mad_i32_i24 v28, v120, s39, v28
    v_lshlrev_b16 v64, 2, v64
    v_mad_i32_i24 v120, v121, -3, v120
    ds_add_u32 v64, v3 offset:0
    v_lshl_or_b32 v28, v110, 16, v28
    v_lshl_or_b32 v28, v120, 30, v28
    v_mul_f32 v117, 0x03800000, v117
    v_mul_f32 v118, 0x03800000, v118
    v_cvt_pk_bf16_f32 v117, v117, v118
    v_mul_hi_u32_u24 v122, s38, v65
    v_mul_hi_u32_u24 v121, s37, v29
    v_mul_hi_u32_u24 v120, s36, v29
    v_mad_i32_i24 v110, v122, s44, v65
    v_mad_u32_u24 v65, v122, 40, v121
    v_mad_i32_i24 v29, v120, s39, v29
    v_lshlrev_b16 v65, 2, v65
    v_mad_i32_i24 v120, v121, -3, v120
    ds_add_u32 v65, v3 offset:0
    v_lshl_or_b32 v29, v110, 16, v29
    v_lshl_or_b32 v29, v120, 30, v29
    v_lshrrev_b32 v118, 3, v117
    v_lshrrev_b32 v119, 8, v117
    v_lshlrev_b16 v117, 13, v117
    v_bitop3_b32 v119, v118, v119, v124 bitop3:0x1b
    v_bitop3_b32 v28, v117, v125, v28 bitop3:0xae
    v_lshl_or_b32 v64, v119, 16, v64
    v_bitop3_b32 v29, v118, v125, v29 bitop3:0xae
    v_bitop3_b32 v65, v119, v126, v65 bitop3:0xea
    v_lshlrev_b32 v117, 16, v89
    v_and_b32 v118, v126, v89
    v_mul_f32 v117, v123, v117
    v_mul_f32 v118, v123, v118
    v_cvt_pk_bf16_f32 v117, v117, v118
    v_and_b32 v118, v126, v117
    v_lshlrev_b32 v117, 16, v117
    v_mul_f32 v117, 0.15915494, v117
    v_mul_f32 v118, 0.15915494, v118
    v_fract_f32 v117, v117
    v_fract_f32 v118, v118
    v_cos_f32 v117, v117
    v_cos_f32 v118, v118
    v_mul_hi_u32_u24 v122, s38, v66
    v_mul_hi_u32_u24 v121, s37, v30
    v_mul_hi_u32_u24 v120, s36, v30
    v_mad_i32_i24 v110, v122, s44, v66
    v_mad_u32_u24 v66, v122, 40, v121
    v_mad_i32_i24 v30, v120, s39, v30
    v_lshlrev_b16 v66, 2, v66
    v_mad_i32_i24 v120, v121, -3, v120
    ds_add_u32 v66, v3 offset:0
    v_lshl_or_b32 v30, v110, 16, v30
    v_lshl_or_b32 v30, v120, 30, v30
    v_mul_f32 v117, 0x03800000, v117
    v_mul_f32 v118, 0x03800000, v118
    v_cvt_pk_bf16_f32 v117, v117, v118
    v_mul_hi_u32_u24 v122, s38, v67
    v_mul_hi_u32_u24 v121, s37, v31
    v_mul_hi_u32_u24 v120, s36, v31
    v_mad_i32_i24 v110, v122, s44, v67
    v_mad_u32_u24 v67, v122, 40, v121
    v_mad_i32_i24 v31, v120, s39, v31
    v_lshlrev_b16 v67, 2, v67
    v_mad_i32_i24 v120, v121, -3, v120
    ds_add_u32 v67, v3 offset:0
    v_lshl_or_b32 v31, v110, 16, v31
    v_lshl_or_b32 v31, v120, 30, v31
    v_lshrrev_b32 v118, 3, v117
    v_lshrrev_b32 v119, 8, v117
    v_lshlrev_b16 v117, 13, v117
    v_bitop3_b32 v119, v118, v119, v124 bitop3:0x1b
    v_bitop3_b32 v30, v117, v125, v30 bitop3:0xae
    v_lshl_or_b32 v66, v119, 16, v66
    v_bitop3_b32 v31, v118, v125, v31 bitop3:0xae
    v_bitop3_b32 v67, v119, v126, v67 bitop3:0xea
p1_k12:
    s_cmp_ge_u32 s29, 1279
    s_cbranch_scc1 p1_k14
    s_waitcnt vmcnt(2)
    v_lshlrev_b32 v117, 16, v90
    v_and_b32 v118, v126, v90
    v_mul_f32 v117, v123, v117
    v_mul_f32 v118, v123, v118
    v_cvt_pk_bf16_f32 v117, v117, v118
    v_and_b32 v118, v126, v117
    v_lshlrev_b32 v117, 16, v117
    v_mul_f32 v117, 0.15915494, v117
    v_mul_f32 v118, 0.15915494, v118
    v_fract_f32 v117, v117
    v_fract_f32 v118, v118
    v_cos_f32 v117, v117
    v_cos_f32 v118, v118
    v_mul_hi_u32_u24 v122, s38, v68
    v_mul_hi_u32_u24 v121, s37, v32
    v_mul_hi_u32_u24 v120, s36, v32
    v_mad_i32_i24 v110, v122, s44, v68
    v_mad_u32_u24 v68, v122, 40, v121
    v_mad_i32_i24 v32, v120, s39, v32
    v_lshlrev_b16 v68, 2, v68
    v_mad_i32_i24 v120, v121, -3, v120
    ds_add_u32 v68, v3 offset:0
    v_lshl_or_b32 v32, v110, 16, v32
    v_lshl_or_b32 v32, v120, 30, v32
    v_mul_f32 v117, 0x03800000, v117
    v_mul_f32 v118, 0x03800000, v118
    v_cvt_pk_bf16_f32 v117, v117, v118
    v_mul_hi_u32_u24 v122, s38, v69
    v_mul_hi_u32_u24 v121, s37, v33
    v_mul_hi_u32_u24 v120, s36, v33
    v_mad_i32_i24 v110, v122, s44, v69
    v_mad_u32_u24 v69, v122, 40, v121
    v_mad_i32_i24 v33, v120, s39, v33
    v_lshlrev_b16 v69, 2, v69
    v_mad_i32_i24 v120, v121, -3, v120
    ds_add_u32 v69, v3 offset:0
    v_lshl_or_b32 v33, v110, 16, v33
    v_lshl_or_b32 v33, v120, 30, v33
    v_lshrrev_b32 v118, 3, v117
    v_lshrrev_b32 v119, 8, v117
    v_lshlrev_b16 v117, 13, v117
    v_bitop3_b32 v119, v118, v119, v124 bitop3:0x1b
    v_bitop3_b32 v32, v117, v125, v32 bitop3:0xae
    v_lshl_or_b32 v68, v119, 16, v68
    v_bitop3_b32 v33, v118, v125, v33 bitop3:0xae
    v_bitop3_b32 v69, v119, v126, v69 bitop3:0xea
    v_lshlrev_b32 v117, 16, v91
    v_and_b32 v118, v126, v91
    v_mul_f32 v117, v123, v117
    v_mul_f32 v118, v123, v118
    v_cvt_pk_bf16_f32 v117, v117, v118
    v_and_b32 v118, v126, v117
    v_lshlrev_b32 v117, 16, v117
    v_mul_f32 v117, 0.15915494, v117
    v_mul_f32 v118, 0.15915494, v118
    v_fract_f32 v117, v117
    v_fract_f32 v118, v118
    v_cos_f32 v117, v117
    v_cos_f32 v118, v118
    v_mul_hi_u32_u24 v122, s38, v70
    v_mul_hi_u32_u24 v121, s37, v34
    v_mul_hi_u32_u24 v120, s36, v34
    v_mad_i32_i24 v110, v122, s44, v70
    v_mad_u32_u24 v70, v122, 40, v121
    v_mad_i32_i24 v34, v120, s39, v34
    v_lshlrev_b16 v70, 2, v70
    v_mad_i32_i24 v120, v121, -3, v120
    ds_add_u32 v70, v3 offset:0
    v_lshl_or_b32 v34, v110, 16, v34
    v_lshl_or_b32 v34, v120, 30, v34
    v_mul_f32 v117, 0x03800000, v117
    v_mul_f32 v118, 0x03800000, v118
    v_cvt_pk_bf16_f32 v117, v117, v118
    v_mul_hi_u32_u24 v122, s38, v71
    v_mul_hi_u32_u24 v121, s37, v35
    v_mul_hi_u32_u24 v120, s36, v35
    v_mad_i32_i24 v110, v122, s44, v71
    v_mad_u32_u24 v71, v122, 40, v121
    v_mad_i32_i24 v35, v120, s39, v35
    v_lshlrev_b16 v71, 2, v71
    v_mad_i32_i24 v120, v121, -3, v120
    ds_add_u32 v71, v3 offset:0
    v_lshl_or_b32 v35, v110, 16, v35
    v_lshl_or_b32 v35, v120, 30, v35
    v_lshrrev_b32 v118, 3, v117
    v_lshrrev_b32 v119, 8, v117
    v_lshlrev_b16 v117, 13, v117
    v_bitop3_b32 v119, v118, v119, v124 bitop3:0x1b
    v_bitop3_b32 v34, v117, v125, v34 bitop3:0xae
    v_lshl_or_b32 v70, v119, 16, v70
    v_bitop3_b32 v35, v118, v125, v35 bitop3:0xae
    v_bitop3_b32 v71, v119, v126, v71 bitop3:0xea
p1_k14:
    s_cmp_ge_u32 s29, 1242
    s_cbranch_scc1 p1_k16
    s_waitcnt vmcnt(0)
    v_lshlrev_b32 v117, 16, v92
    v_and_b32 v118, v126, v92
    v_mul_f32 v117, v123, v117
    v_mul_f32 v118, v123, v118
    v_cvt_pk_bf16_f32 v117, v117, v118
    v_and_b32 v118, v126, v117
    v_lshlrev_b32 v117, 16, v117
    v_mul_f32 v117, 0.15915494, v117
    v_mul_f32 v118, 0.15915494, v118
    v_fract_f32 v117, v117
    v_fract_f32 v118, v118
    v_cos_f32 v117, v117
    v_cos_f32 v118, v118
    v_mul_hi_u32_u24 v122, s38, v72
    v_mul_hi_u32_u24 v121, s37, v36
    v_mul_hi_u32_u24 v120, s36, v36
    v_mad_i32_i24 v110, v122, s44, v72
    v_mad_u32_u24 v72, v122, 40, v121
    v_mad_i32_i24 v36, v120, s39, v36
    v_lshlrev_b16 v72, 2, v72
    v_mad_i32_i24 v120, v121, -3, v120
    ds_add_u32 v72, v3 offset:0
    v_lshl_or_b32 v36, v110, 16, v36
    v_lshl_or_b32 v36, v120, 30, v36
    v_mul_f32 v117, 0x03800000, v117
    v_mul_f32 v118, 0x03800000, v118
    v_cvt_pk_bf16_f32 v117, v117, v118
    v_mul_hi_u32_u24 v122, s38, v73
    v_mul_hi_u32_u24 v121, s37, v37
    v_mul_hi_u32_u24 v120, s36, v37
    v_mad_i32_i24 v110, v122, s44, v73
    v_mad_u32_u24 v73, v122, 40, v121
    v_mad_i32_i24 v37, v120, s39, v37
    v_lshlrev_b16 v73, 2, v73
    v_mad_i32_i24 v120, v121, -3, v120
    ds_add_u32 v73, v3 offset:0
    v_lshl_or_b32 v37, v110, 16, v37
    v_lshl_or_b32 v37, v120, 30, v37
    v_lshrrev_b32 v118, 3, v117
    v_lshrrev_b32 v119, 8, v117
    v_lshlrev_b16 v117, 13, v117
    v_bitop3_b32 v119, v118, v119, v124 bitop3:0x1b
    v_bitop3_b32 v36, v117, v125, v36 bitop3:0xae
    v_lshl_or_b32 v72, v119, 16, v72
    v_bitop3_b32 v37, v118, v125, v37 bitop3:0xae
    v_bitop3_b32 v73, v119, v126, v73 bitop3:0xea
    v_lshlrev_b32 v117, 16, v93
    v_and_b32 v118, v126, v93
    v_mul_f32 v117, v123, v117
    v_mul_f32 v118, v123, v118
    v_cvt_pk_bf16_f32 v117, v117, v118
    v_and_b32 v118, v126, v117
    v_lshlrev_b32 v117, 16, v117
    v_mul_f32 v117, 0.15915494, v117
    v_mul_f32 v118, 0.15915494, v118
    v_fract_f32 v117, v117
    v_fract_f32 v118, v118
    v_cos_f32 v117, v117
    v_cos_f32 v118, v118
    v_mul_hi_u32_u24 v122, s38, v74
    v_mul_hi_u32_u24 v121, s37, v38
    v_mul_hi_u32_u24 v120, s36, v38
    v_mad_i32_i24 v110, v122, s44, v74
    v_mad_u32_u24 v74, v122, 40, v121
    v_mad_i32_i24 v38, v120, s39, v38
    v_lshlrev_b16 v74, 2, v74
    v_mad_i32_i24 v120, v121, -3, v120
    ds_add_u32 v74, v3 offset:0
    v_lshl_or_b32 v38, v110, 16, v38
    v_lshl_or_b32 v38, v120, 30, v38
    v_mul_f32 v117, 0x03800000, v117
    v_mul_f32 v118, 0x03800000, v118
    v_cvt_pk_bf16_f32 v117, v117, v118
    v_mul_hi_u32_u24 v122, s38, v75
    v_mul_hi_u32_u24 v121, s37, v39
    v_mul_hi_u32_u24 v120, s36, v39
    v_mad_i32_i24 v110, v122, s44, v75
    v_mad_u32_u24 v75, v122, 40, v121
    v_mad_i32_i24 v39, v120, s39, v39
    v_lshlrev_b16 v75, 2, v75
    v_mad_i32_i24 v120, v121, -3, v120
    ds_add_u32 v75, v3 offset:0
    v_lshl_or_b32 v39, v110, 16, v39
    v_lshl_or_b32 v39, v120, 30, v39
    v_lshrrev_b32 v118, 3, v117
    v_lshrrev_b32 v119, 8, v117
    v_lshlrev_b16 v117, 13, v117
    v_bitop3_b32 v119, v118, v119, v124 bitop3:0x1b
    v_bitop3_b32 v38, v117, v125, v38 bitop3:0xae
    v_lshl_or_b32 v74, v119, 16, v74
    v_bitop3_b32 v39, v118, v125, v39 bitop3:0xae
    v_bitop3_b32 v75, v119, v126, v75 bitop3:0xea
p1_k16:
    s_waitcnt vmcnt(0)
    s_cmp_lg_u32 s28, 15
    s_cbranch_scc1 p1_tk1
    v_mov_b32 v126, 0
    s_mov_b64 exec, 1
    ds_write_b32 v126, v127 offset:10456
    s_mov_b64 exec, -1
p1_tk1:
    s_waitcnt lgkmcnt(0)
    s_barrier
    s_cmp_ge_u32 s28, 10
    s_cbranch_scc1 p1_s1_skip
    v_and_b32 v126, 63, v0
    s_lshl_b32 s54, s28, 4
    v_mul_u32_u24 v117, 160, v126
    v_add_u32 v117, s54, v117
    ds_read_b128 v[118:121], v117 offset:0
    s_waitcnt lgkmcnt(0)
    v_add_u32 v118, 2, v118
    v_add_u32 v119, 2, v119
    v_add_u32 v120, 2, v120
    v_add_u32 v121, 2, v121
    v_mul_u32_u24 v118, 43691, v118
    v_mul_u32_u24 v119, 43691, v119
    v_mul_u32_u24 v120, 43691, v120
    v_mul_u32_u24 v121, 43691, v121
    v_lshrrev_b32 v118, 17, v118
    v_lshrrev_b32 v119, 17, v119
    v_lshrrev_b32 v120, 17, v120
    v_lshrrev_b32 v121, 17, v121
    v_lshl_or_b32 v122, v119, 16, v118
    v_lshl_or_b32 v123, v121, 16, v120
    v_mov_b32 v124, v122
    v_mov_b32 v125, v123
    s_nop 1
    v_add_u32_dpp v124, v124, v124 row_shr:1 row_mask:0xf bank_mask:0xf bound_ctrl:0
    v_add_u32_dpp v125, v125, v125 row_shr:1 row_mask:0xf bank_mask:0xf bound_ctrl:0
    s_nop 0
    v_add_u32_dpp v124, v124, v124 row_shr:2 row_mask:0xf bank_mask:0xf bound_ctrl:0
    v_add_u32_dpp v125, v125, v125 row_shr:2 row_mask:0xf bank_mask:0xf bound_ctrl:0
    s_nop 0
    v_add_u32_dpp v124, v124, v124 row_shr:4 row_mask:0xf bank_mask:0xf bound_ctrl:0
    v_add_u32_dpp v125, v125, v125 row_shr:4 row_mask:0xf bank_mask:0xf bound_ctrl:0
    s_nop 0
    v_add_u32_dpp v124, v124, v124 row_shr:8 row_mask:0xf bank_mask:0xf bound_ctrl:0
    v_add_u32_dpp v125, v125, v125 row_shr:8 row_mask:0xf bank_mask:0xf bound_ctrl:0
    s_nop 0
    v_add_u32_dpp v124, v124, v124 row_bcast:15 row_mask:0xa bank_mask:0xf
    v_add_u32_dpp v125, v125, v125 row_bcast:15 row_mask:0xa bank_mask:0xf
    s_nop 0
    v_add_u32_dpp v124, v124, v124 row_bcast:31 row_mask:0xc bank_mask:0xf
    v_add_u32_dpp v125, v125, v125 row_bcast:31 row_mask:0xc bank_mask:0xf
    s_nop 0
    s_nop 0
    v_mov_b32 v127, s54
    v_and_b32 v118, 0xffff, v124
    v_lshrrev_b32 v119, 16, v124
    v_and_b32 v120, 0xffff, v125
    v_lshrrev_b32 v121, 16, v125
    s_mov_b64 exec, 1
    s_lshl_b64 exec, exec, 63
    ds_write_b128 v127, v[118:121] offset:10240
    s_mov_b64 exec, -1
p1_s1_skip:
    s_waitcnt lgkmcnt(0)
    s_barrier
    v_and_b32 v127, 63, v0
    v_lshlrev_b32 v118, 2, v127
    v_cmp_gt_u32 vcc, 40, v127
    ds_read_b32 v119, v118 offset:10240
    s_waitcnt lgkmcnt(0)
    v_readlane_b32 s33, v119, 54
    v_cndmask_b32 v119, 0, v119, vcc
    v_mov_b32 v120, v119
    s_nop 1
    v_add_u32_dpp v120, v120, v120 row_shr:1 row_mask:0xf bank_mask:0xf bound_ctrl:0
    s_nop 1
    v_add_u32_dpp v120, v120, v120 row_shr:2 row_mask:0xf bank_mask:0xf bound_ctrl:0
    s_nop 1
    v_add_u32_dpp v120, v120, v120 row_shr:4 row_mask:0xf bank_mask:0xf bound_ctrl:0
    s_nop 1
    v_add_u32_dpp v120, v120, v120 row_shr:8 row_mask:0xf bank_mask:0xf bound_ctrl:0
    s_nop 1
    v_add_u32_dpp v120, v120, v120 row_bcast:15 row_mask:0xa bank_mask:0xf
    s_nop 1
    v_add_u32_dpp v120, v120, v120 row_bcast:31 row_mask:0xc bank_mask:0xf
    s_nop 1
    s_nop 0
    v_sub_u32 v119, v120, v119
    v_readlane_b32 s35, v120, 63
    s_add_u32 s33, s33, 256
    s_mul_i32 s46, s33, 1
    s_min_u32 s47, s33, 1499
    s_add_u32 s46, s46, s47
    s_min_u32 s47, s33, 1462
    s_add_u32 s46, s46, s47
    s_min_u32 s47, s33, 1426
    s_add_u32 s46, s46, s47
    s_min_u32 s47, s33, 1389
    s_add_u32 s46, s46, s47
    s_min_u32 s47, s33, 1352
    s_add_u32 s46, s46, s47
    s_min_u32 s47, s33, 1315
    s_add_u32 s46, s46, s47
    s_min_u32 s47, s33, 1279
    s_add_u32 s46, s46, s47
    s_min_u32 s47, s33, 1242
    s_add_u32 s46, s46, s47
    s_lshl_b32 s30, s46, 14
    s_lshl_b32 s31, s46, 13
    s_cmp_ge_u32 s28, 10
    s_cbranch_scc1 p1_s2_skip
    s_lshl_b32 s54, s28, 2
    s_add_u32 s55, s54, 0
    v_readlane_b32 s56, v119, s55
    s_add_u32 s55, s54, 1
    v_readlane_b32 s57, v119, s55
    s_add_u32 s55, s54, 2
    v_readlane_b32 s58, v119, s55
    s_add_u32 s55, s54, 3
    v_readlane_b32 s59, v119, s55
    s_nop 0
    s_lshl_b32 s57, s57, 16
    s_or_b32 s56, s56, s57
    s_lshl_b32 s59, s59, 16
    s_or_b32 s58, s58, s59
    v_add_u32 v124, s56, v124
    v_add_u32 v125, s58, v125
    v_sub_u32 v122, v124, v122
    v_sub_u32 v123, v125, v123
    v_and_b32 v118, 0xffff, v122
    v_lshrrev_b32 v119, 16, v122
    v_and_b32 v120, 0xffff, v123
    v_lshrrev_b32 v121, 16, v123
    v_mul_u32_u24 v118, 3, v118
    v_mul_u32_u24 v119, 3, v119
    v_mul_u32_u24 v120, 3, v120
    v_mul_u32_u24 v121, 3, v121
    ds_write_b128 v117, v[118:121] offset:0
    s_mul_i32 s55, s29, 5248
    s_mul_i32 s56, s28, 520
    s_add_u32 s55, s55, s56
    s_add_u32 s55, s55, 469762048
    v_lshlrev_b32 v127, 3, v126
    buffer_store_dwordx2 v[122:123], v127, s[16:19], s55 offen sc1
    s_mov_b64 exec, 1
    s_lshl_b64 exec, exec, 63
    buffer_store_dwordx2 v[124:125], v127, s[16:19], s55 offen offset:8 sc1
    s_mov_b64 exec, -1
p1_s2_skip:
    s_mul_i32 s50, s29, 16384
    s_lshr_b32 s52, s35, 10
    s_mul_i32 s52, s52, 33554432
    s_and_b32 s53, s35, 1023
    s_lshl_b32 s53, s53, 4
    s_add_u32 s52, s52, s53
    s_add_u32 s52, s52, s50
    s_min_u32 s22, s52, 469762048
    s_mov_b32 s68, 0
    s_cmp_lt_u32 s29, 1242
    s_cselect_b32 s35, 13994, s35
    s_waitcnt lgkmcnt(0)
    s_barrier
    s_cmp_lt_u32 s33, 1536
    s_cbranch_scc1 p1_f0
    s_cmp_lg_u32 s28, 15
    s_cbranch_scc1 p1_hv0
    s_sub_u32 s52, s33, 1536
    s_and_b32 s52, s52, 255
    s_lshl_b32 s58, s52, 2
    s_and_b32 s58, s58, 28
    s_lshl_b32 s53, 1, s58
    v_mov_b32 v127, s53
    s_lshr_b32 s52, s52, 3
    s_lshl_b32 s52, s52, 2
    s_mov_b64 exec, 1
    buffer_atomic_add v127, off, s[40:43], s52 sc0 sc1
    s_mov_b64 exec, -1
p1_hv0:
    s_cmp_ge_u32 s33, 1656
    s_cbranch_scc1 p1_f0
    s_sub_u32 s52, s33, 1536
    s_mul_i32 s52, s52, 53368
    s_mul_i32 s53, s28, 3072
    s_add_u32 s53, s53, s52
    v_and_b32 v92, 63, v0
    v_lshl_add_u32 v93, v92, 2, s53
    s_lshl_b32 s53, s28, 9
    s_add_u32 s53, s53, s52
    s_add_u32 s53, s53, 49152
    s_cmp_lt_u32 s28, 9
    s_cselect_b32 s53, s53, 0x40000000
    v_lshl_add_u32 v94, v92, 2, s53
    buffer_load_dword v76, v93, s[24:27], 0 offen offset:0
    buffer_load_dword v77, v93, s[24:27], 0 offen offset:256
    buffer_load_dword v78, v93, s[24:27], 0 offen offset:512
    buffer_load_dword v79, v93, s[24:27], 0 offen offset:768
    buffer_load_dword v80, v93, s[24:27], 0 offen offset:1024
    buffer_load_dword v81, v93, s[24:27], 0 offen offset:1280
    buffer_load_dword v82, v93, s[24:27], 0 offen offset:1536
    buffer_load_dword v83, v93, s[24:27], 0 offen offset:1792
    buffer_load_dword v84, v93, s[24:27], 0 offen offset:2048
    buffer_load_dword v85, v93, s[24:27], 0 offen offset:2304
    buffer_load_dword v86, v93, s[24:27], 0 offen offset:2560
    buffer_load_dword v87, v93, s[24:27], 0 offen offset:2816
    buffer_load_dword v88, v94, s[24:27], 0 offen offset:0
    buffer_load_dword v89, v94, s[24:27], 0 offen offset:256
p1_f0:
    v_and_b32 v117, 0xffff, v40
    ds_add_rtn_u32 v117, v117, v3 offset:0
    v_and_b32 v118, 0xffff, v41
    ds_add_rtn_u32 v118, v118, v3 offset:0
    v_and_b32 v119, 0xffff, v42
    ds_add_rtn_u32 v119, v119, v3 offset:0
    v_and_b32 v120, 0xffff, v43
    ds_add_rtn_u32 v120, v120, v3 offset:0
    s_cmp_ge_u32 s33, 1536
    s_cbranch_scc1 p1_k18
    s_cmp_lt_u32 s33, 1536
    s_cselect_b32 s14, 102400000, 0
    s_add_u32 s32, s31, 0
    buffer_load_dwordx2 v[76:77], v2, s[12:15], s32 offen nt
p1_k18:
    s_cmp_ge_u32 s33, 1536
    s_cbranch_scc1 p1_k19
    s_cmp_lt_u32 s33, 1536
    s_cselect_b32 s6, 204800000, 0
    s_cselect_b32 s10, 204800000, 0
    s_add_u32 s32, s30, 0
    buffer_load_dwordx4 v[94:97], v1, s[4:7], s32 offen nt
    buffer_load_dwordx4 v[102:105], v1, s[8:11], s32 offen nt
p1_k19:
    s_cmp_lt_u32 s29, 1499
    s_cbranch_scc1 p1_pa0
    s_waitcnt lgkmcnt(0)
    s_branch p1_pb0
p1_pa0:
    v_and_b32 v121, 0xffff, v44
    ds_add_rtn_u32 v121, v121, v3 offset:0
    v_and_b32 v122, 0xffff, v45
    ds_add_rtn_u32 v122, v122, v3 offset:0
    v_and_b32 v123, 0xffff, v46
    ds_add_rtn_u32 v123, v123, v3 offset:0
    v_and_b32 v124, 0xffff, v47
    ds_add_rtn_u32 v124, v124, v3 offset:0
    s_waitcnt lgkmcnt(4)
p1_pb0:
    ds_write_b8_d16_hi v117, v40 offset:10496
    v_lshlrev_b32 v40, 2, v117
    ds_write_b32 v40, v4 offset:52480
    ds_write_b8_d16_hi v118, v41 offset:10496
    v_lshlrev_b32 v41, 2, v118
    ds_write_b32 v41, v5 offset:52480
    ds_write_b8_d16_hi v119, v42 offset:10496
    v_lshlrev_b32 v42, 2, v119
    ds_write_b32 v42, v6 offset:52480
    ds_write_b8_d16_hi v120, v43 offset:10496
    v_lshlrev_b32 v43, 2, v120
    ds_write_b32 v43, v7 offset:52480
    s_cmp_ge_u32 s33, 1536
    s_cbranch_scc1 p1_k20
    s_cmp_lt_u32 s33, 1499
    s_cselect_b32 s14, 102400000, 0
    s_add_u32 s32, s31, 8192
    buffer_load_dwordx2 v[78:79], v2, s[12:15], s32 offen nt
p1_k20:
    s_cmp_lt_u32 s29, 1462
    s_cbranch_scc1 p1_pa1
    s_waitcnt lgkmcnt(0)
    s_branch p1_pb1
p1_pa1:
    v_and_b32 v117, 0xffff, v48
    ds_add_rtn_u32 v117, v117, v3 offset:0
    v_and_b32 v118, 0xffff, v49
    ds_add_rtn_u32 v118, v118, v3 offset:0
    v_and_b32 v119, 0xffff, v50
    ds_add_rtn_u32 v119, v119, v3 offset:0
    v_and_b32 v120, 0xffff, v51
    ds_add_rtn_u32 v120, v120, v3 offset:0
    s_waitcnt lgkmcnt(4)
p1_pb1:
    s_cmp_ge_u32 s29, 1499
    s_cbranch_scc1 p1_k21
    ds_write_b8_d16_hi v121, v44 offset:10496
    v_lshlrev_b32 v44, 2, v121
    ds_write_b32 v44, v8 offset:52480
    ds_write_b8_d16_hi v122, v45 offset:10496
    v_lshlrev_b32 v45, 2, v122
    ds_write_b32 v45, v9 offset:52480
    ds_write_b8_d16_hi v123, v46 offset:10496
    v_lshlrev_b32 v46, 2, v123
    ds_write_b32 v46, v10 offset:52480
    ds_write_b8_d16_hi v124, v47 offset:10496
    v_lshlrev_b32 v47, 2, v124
    ds_write_b32 v47, v11 offset:52480
p1_k21:
    s_cmp_ge_u32 s33, 1536
    s_cbranch_scc1 p1_k22
    s_cmp_lt_u32 s33, 1462
    s_cselect_b32 s14, 102400000, 0
    s_add_u32 s32, s31, 16384
    buffer_load_dwordx2 v[80:81], v2, s[12:15], s32 offen nt
p1_k22:
    s_cmp_lt_u32 s29, 1426
    s_cbranch_scc1 p1_pa2
    s_waitcnt lgkmcnt(0)
    s_branch p1_pb2
p1_pa2:
    v_and_b32 v121, 0xffff, v52
    ds_add_rtn_u32 v121, v121, v3 offset:0
    v_and_b32 v122, 0xffff, v53
    ds_add_rtn_u32 v122, v122, v3 offset:0
    v_and_b32 v123, 0xffff, v54
    ds_add_rtn_u32 v123, v123, v3 offset:0
    v_and_b32 v124, 0xffff, v55
    ds_add_rtn_u32 v124, v124, v3 offset:0
    s_waitcnt lgkmcnt(4)
p1_pb2:
    s_cmp_ge_u32 s29, 1462
    s_cbranch_scc1 p1_k23
    ds_write_b8_d16_hi v117, v48 offset:10496
    v_lshlrev_b32 v48, 2, v117
    ds_write_b32 v48, v12 offset:52480
    ds_write_b8_d16_hi v118, v49 offset:10496
    v_lshlrev_b32 v49, 2, v118
    ds_write_b32 v49, v13 offset:52480
    ds_write_b8_d16_hi v119, v50 offset:10496
    v_lshlrev_b32 v50, 2, v119
    ds_write_b32 v50, v14 offset:52480
    ds_write_b8_d16_hi v120, v51 offset:10496
    v_lshlrev_b32 v51, 2, v120
    ds_write_b32 v51, v15 offset:52480
p1_k23:
    s_cmp_ge_u32 s28, 10
    s_cbranch_scc1 p1_jn
    s_waitcnt vmcnt(0)
    v_mov_b32 v125, 0
    s_mov_b64 exec, 1
    ds_add_rtn_u32 v125, v125, v3 offset:10432
    s_waitcnt lgkmcnt(0)
    v_readfirstlane_b32 s52, v125
    s_lshr_b32 s53, s29, 1
    s_and_b32 s53, s53, 28
    s_cmp_lg_u32 s52, 9
    s_cbranch_scc1 p1_jn1
    s_lshl_b32 s54, 1, s53
    v_mov_b32 v127, s54
    s_lshr_b32 s54, s29, 6
    s_lshl_b32 s54, s54, 2
    s_mov_b32 s68, 1
    buffer_atomic_add v127, off, s[40:43], s54 sc0 sc1
p1_jn1:
    s_mov_b64 exec, -1
p1_jn:
    s_cmp_ge_u32 s33, 1536
    s_cbranch_scc1 p1_k24
    s_cmp_lt_u32 s33, 1426
    s_cselect_b32 s14, 102400000, 0
    s_add_u32 s32, s31, 24576
    buffer_load_dwordx2 v[82:83], v2, s[12:15], s32 offen nt
p1_k24:
    s_cmp_lt_u32 s29, 1389
    s_cbranch_scc1 p1_pa3
    s_waitcnt lgkmcnt(0)
    s_branch p1_pb3
p1_pa3:
    v_and_b32 v117, 0xffff, v56
    ds_add_rtn_u32 v117, v117, v3 offset:0
    v_and_b32 v118, 0xffff, v57
    ds_add_rtn_u32 v118, v118, v3 offset:0
    v_and_b32 v119, 0xffff, v58
    ds_add_rtn_u32 v119, v119, v3 offset:0
    v_and_b32 v120, 0xffff, v59
    ds_add_rtn_u32 v120, v120, v3 offset:0
    s_waitcnt lgkmcnt(4)
p1_pb3:
    s_cmp_ge_u32 s29, 1426
    s_cbranch_scc1 p1_k25
    ds_write_b8_d16_hi v121, v52 offset:10496
    v_lshlrev_b32 v52, 2, v121
    ds_write_b32 v52, v16 offset:52480
    ds_write_b8_d16_hi v122, v53 offset:10496
    v_lshlrev_b32 v53, 2, v122
    ds_write_b32 v53, v17 offset:52480
    ds_write_b8_d16_hi v123, v54 offset:10496
    v_lshlrev_b32 v54, 2, v123
    ds_write_b32 v54, v18 offset:52480
    ds_write_b8_d16_hi v124, v55 offset:10496
    v_lshlrev_b32 v55, 2, v124
    ds_write_b32 v55, v19 offset:52480
p1_k25:
    s_cmp_ge_u32 s33, 1536
    s_cbranch_scc1 p1_k26
    s_cmp_lt_u32 s33, 1389
    s_cselect_b32 s14, 102400000, 0
    s_add_u32 s32, s31, 32768
    buffer_load_dwordx2 v[84:85], v2, s[12:15], s32 offen nt
p1_k26:
    s_cmp_ge_u32 s33, 1536
    s_cbranch_scc1 p1_k27
    s_cmp_lt_u32 s33, 1499
    s_cselect_b32 s6, 204800000, 0
    s_cselect_b32 s10, 204800000, 0
    s_add_u32 s32, s30, 16384
    buffer_load_dwordx4 v[98:101], v1, s[4:7], s32 offen nt
    buffer_load_dwordx4 v[106:109], v1, s[8:11], s32 offen nt
p1_k27:
    s_cmp_lt_u32 s29, 1352
    s_cbranch_scc1 p1_pa4
    s_waitcnt lgkmcnt(0)
    s_branch p1_pb4
p1_pa4:
    v_and_b32 v121, 0xffff, v60
    ds_add_rtn_u32 v121, v121, v3 offset:0
    v_and_b32 v122, 0xffff, v61
    ds_add_rtn_u32 v122, v122, v3 offset:0
    v_and_b32 v123, 0xffff, v62
    ds_add_rtn_u32 v123, v123, v3 offset:0
    v_and_b32 v124, 0xffff, v63
    ds_add_rtn_u32 v124, v124, v3 offset:0
    s_waitcnt lgkmcnt(4)
p1_pb4:
    s_cmp_ge_u32 s29, 1389
    s_cbranch_scc1 p1_k28
    ds_write_b8_d16_hi v117, v56 offset:10496
    v_lshlrev_b32 v56, 2, v117
    ds_write_b32 v56, v20 offset:52480
    ds_write_b8_d16_hi v118, v57 offset:10496
    v_lshlrev_b32 v57, 2, v118
    ds_write_b32 v57, v21 offset:52480
    ds_write_b8_d16_hi v119, v58 offset:10496
    v_lshlrev_b32 v58, 2, v119
    ds_write_b32 v58, v22 offset:52480
    ds_write_b8_d16_hi v120, v59 offset:10496
    v_lshlrev_b32 v59, 2, v120
    ds_write_b32 v59, v23 offset:52480
p1_k28:
    s_cmp_ge_u32 s33, 1536
    s_cbranch_scc1 p1_k29
    s_cmp_lt_u32 s33, 1352
    s_cselect_b32 s14, 102400000, 0
    s_add_u32 s32, s31, 40960
    buffer_load_dwordx2 v[86:87], v2, s[12:15], s32 offen nt
p1_k29:
    s_cmp_lt_u32 s29, 1315
    s_cbranch_scc1 p1_pa5
    s_waitcnt lgkmcnt(0)
    s_branch p1_pb5
p1_pa5:
    v_and_b32 v117, 0xffff, v64
    ds_add_rtn_u32 v117, v117, v3 offset:0
    v_and_b32 v118, 0xffff, v65
    ds_add_rtn_u32 v118, v118, v3 offset:0
    v_and_b32 v119, 0xffff, v66
    ds_add_rtn_u32 v119, v119, v3 offset:0
    v_and_b32 v120, 0xffff, v67
    ds_add_rtn_u32 v120, v120, v3 offset:0
    s_waitcnt lgkmcnt(4)
p1_pb5:
    s_cmp_ge_u32 s29, 1352
    s_cbranch_scc1 p1_k30
    ds_write_b8_d16_hi v121, v60 offset:10496
    v_lshlrev_b32 v60, 2, v121
    ds_write_b32 v60, v24 offset:52480
    ds_write_b8_d16_hi v122, v61 offset:10496
    v_lshlrev_b32 v61, 2, v122
    ds_write_b32 v61, v25 offset:52480
    ds_write_b8_d16_hi v123, v62 offset:10496
    v_lshlrev_b32 v62, 2, v123
    ds_write_b32 v62, v26 offset:52480
    ds_write_b8_d16_hi v124, v63 offset:10496
    v_lshlrev_b32 v63, 2, v124
    ds_write_b32 v63, v27 offset:52480
p1_k30:
    s_cmp_ge_u32 s33, 1536
    s_cbranch_scc1 p1_k31
    s_cmp_lt_u32 s33, 1315
    s_cselect_b32 s14, 102400000, 0
    s_add_u32 s32, s31, 49152
    buffer_load_dwordx2 v[88:89], v2, s[12:15], s32 offen nt
p1_k31:
    s_cmp_lt_u32 s29, 1279
    s_cbranch_scc1 p1_pa6
    s_waitcnt lgkmcnt(0)
    s_branch p1_pb6
p1_pa6:
    v_and_b32 v121, 0xffff, v68
    ds_add_rtn_u32 v121, v121, v3 offset:0
    v_and_b32 v122, 0xffff, v69
    ds_add_rtn_u32 v122, v122, v3 offset:0
    v_and_b32 v123, 0xffff, v70
    ds_add_rtn_u32 v123, v123, v3 offset:0
    v_and_b32 v124, 0xffff, v71
    ds_add_rtn_u32 v124, v124, v3 offset:0
    s_waitcnt lgkmcnt(4)
p1_pb6:
    s_cmp_ge_u32 s29, 1315
    s_cbranch_scc1 p1_k32
    ds_write_b8_d16_hi v117, v64 offset:10496
    v_lshlrev_b32 v64, 2, v117
    ds_write_b32 v64, v28 offset:52480
    ds_write_b8_d16_hi v118, v65 offset:10496
    v_lshlrev_b32 v65, 2, v118
    ds_write_b32 v65, v29 offset:52480
    ds_write_b8_d16_hi v119, v66 offset:10496
    v_lshlrev_b32 v66, 2, v119
    ds_write_b32 v66, v30 offset:52480
    ds_write_b8_d16_hi v120, v67 offset:10496
    v_lshlrev_b32 v67, 2, v120
    ds_write_b32 v67, v31 offset:52480
p1_k32:
    s_cmp_ge_u32 s33, 1536
    s_cbranch_scc1 p1_k33
    s_cmp_lt_u32 s33, 1279
    s_cselect_b32 s14, 102400000, 0
    s_add_u32 s32, s31, 57344
    buffer_load_dwordx2 v[90:91], v2, s[12:15], s32 offen nt
p1_k33:
    s_cmp_lt_u32 s29, 1242
    s_cbranch_scc1 p1_pa7
    s_waitcnt lgkmcnt(0)
    s_branch p1_pb7
p1_pa7:
    v_and_b32 v117, 0xffff, v72
    ds_add_rtn_u32 v117, v117, v3 offset:0
    v_and_b32 v118, 0xffff, v73
    ds_add_rtn_u32 v118, v118, v3 offset:0
    v_and_b32 v119, 0xffff, v74
    ds_add_rtn_u32 v119, v119, v3 offset:0
    v_and_b32 v120, 0xffff, v75
    ds_add_rtn_u32 v120, v120, v3 offset:0
    s_waitcnt lgkmcnt(4)
p1_pb7:
    s_cmp_ge_u32 s29, 1279
    s_cbranch_scc1 p1_k34
    ds_write_b8_d16_hi v121, v68 offset:10496
    v_lshlrev_b32 v68, 2, v121
    ds_write_b32 v68, v32 offset:52480
    ds_write_b8_d16_hi v122, v69 offset:10496
    v_lshlrev_b32 v69, 2, v122
    ds_write_b32 v69, v33 offset:52480
    ds_write_b8_d16_hi v123, v70 offset:10496
    v_lshlrev_b32 v70, 2, v123
    ds_write_b32 v70, v34 offset:52480
    ds_write_b8_d16_hi v124, v71 offset:10496
    v_lshlrev_b32 v71, 2, v124
    ds_write_b32 v71, v35 offset:52480
p1_k34:
    s_cmp_ge_u32 s33, 1536
    s_cbranch_scc1 p1_k35
    s_cmp_lt_u32 s33, 1242
    s_cselect_b32 s14, 102400000, 0
    s_add_u32 s32, s31, 65536
    buffer_load_dwordx2 v[92:93], v2, s[12:15], s32 offen nt
p1_k35:
    s_waitcnt lgkmcnt(0)
    s_cmp_ge_u32 s29, 1242
    s_cbranch_scc1 p1_k36
    ds_write_b8_d16_hi v117, v72 offset:10496
    v_lshlrev_b32 v72, 2, v117
    ds_write_b32 v72, v36 offset:52480
    ds_write_b8_d16_hi v118, v73 offset:10496
    v_lshlrev_b32 v73, 2, v118
    ds_write_b32 v73, v37 offset:52480
    ds_write_b8_d16_hi v119, v74 offset:10496
    v_lshlrev_b32 v74, 2, v119
    ds_write_b32 v74, v38 offset:52480
    ds_write_b8_d16_hi v120, v75 offset:10496
    v_lshlrev_b32 v75, 2, v120
    ds_write_b32 v75, v39 offset:52480
p1_k36:
    s_cmp_eq_u32 s68, 0
    s_cbranch_scc1 p1_sg
    s_cmp_lt_u32 s33, 1536
    s_cbranch_scc1 p1_w37
    s_waitcnt vmcnt(0)
p1_w37:
    s_waitcnt vmcnt(8)
    v_bfe_u32 v127, v127, s53, 4
    v_mov_b32 v125, 0
    s_mov_b64 exec, 1
    ds_write_b32 v125, v127 offset:10452
    s_mov_b64 exec, -1
p1_sg:
    s_cmp_lt_u32 s33, 1536
    s_cbranch_scc1 p1_f1
    s_cmp_lg_u32 s28, 15
    s_cbranch_scc1 p1_hv1
    s_waitcnt vmcnt(0)
    v_bfe_u32 v127, v127, s58, 4
    v_mov_b32 v125, 0
    s_mov_b64 exec, 1
    ds_write_b32 v125, v127 offset:10448
    s_mov_b64 exec, -1
p1_hv1:
    s_cmp_ge_u32 s33, 1656
    s_cbranch_scc1 p1_f1
    s_sub_u32 s52, s33, 1536
    s_mul_i32 s53, s52, 53760
    s_add_u32 s53, s53, 485810176
    s_mul_i32 s54, s28, 3072
    v_lshl_add_u32 v93, v92, 4, s54
    s_lshl_b32 s54, s28, 9
    s_add_u32 s54, s54, 49152
    s_cmp_lt_u32 s28, 9
    s_cselect_b32 s54, s54, 0x40000000
    v_lshl_add_u32 v94, v92, 3, s54
    v_mov_b32 v96, 0
    v_mov_b32 v97, 0
    s_waitcnt vmcnt(0)
    buffer_store_dwordx4 v[76:79], v93, s[16:19], s53 offen offset:0
    buffer_store_dwordx4 v[80:83], v93, s[16:19], s53 offen offset:1024
    buffer_store_dwordx4 v[84:87], v93, s[16:19], s53 offen offset:2048
    buffer_store_dwordx2 v[88:89], v94, s[16:19], s53 offen
    v_and_b32 v98, 0x7fff7fff, v76
    v_pk_max_u16 v96, v96, v98
    v_lshlrev_b32 v99, 16, v98
    v_and_b32 v98, 0xffff0000, v98
    v_fmac_f32 v97, v99, v99
    v_fmac_f32 v97, v98, v98
    v_and_b32 v98, 0x7fff7fff, v77
    v_pk_max_u16 v96, v96, v98
    v_lshlrev_b32 v99, 16, v98
    v_and_b32 v98, 0xffff0000, v98
    v_fmac_f32 v97, v99, v99
    v_fmac_f32 v97, v98, v98
    v_and_b32 v98, 0x7fff7fff, v78
    v_pk_max_u16 v96, v96, v98
    v_lshlrev_b32 v99, 16, v98
    v_and_b32 v98, 0xffff0000, v98
    v_fmac_f32 v97, v99, v99
    v_fmac_f32 v97, v98, v98
    v_and_b32 v98, 0x7fff7fff, v79
    v_pk_max_u16 v96, v96, v98
    v_lshlrev_b32 v99, 16, v98
    v_and_b32 v98, 0xffff0000, v98
    v_fmac_f32 v97, v99, v99
    v_fmac_f32 v97, v98, v98
    v_and_b32 v98, 0x7fff7fff, v80
    v_pk_max_u16 v96, v96, v98
    v_lshlrev_b32 v99, 16, v98
    v_and_b32 v98, 0xffff0000, v98
    v_fmac_f32 v97, v99, v99
    v_fmac_f32 v97, v98, v98
    v_and_b32 v98, 0x7fff7fff, v81
    v_pk_max_u16 v96, v96, v98
    v_lshlrev_b32 v99, 16, v98
    v_and_b32 v98, 0xffff0000, v98
    v_fmac_f32 v97, v99, v99
    v_fmac_f32 v97, v98, v98
    v_and_b32 v98, 0x7fff7fff, v82
    v_pk_max_u16 v96, v96, v98
    v_lshlrev_b32 v99, 16, v98
    v_and_b32 v98, 0xffff0000, v98
    v_fmac_f32 v97, v99, v99
    v_fmac_f32 v97, v98, v98
    v_and_b32 v98, 0x7fff7fff, v83
    v_pk_max_u16 v96, v96, v98
    v_lshlrev_b32 v99, 16, v98
    v_and_b32 v98, 0xffff0000, v98
    v_fmac_f32 v97, v99, v99
    v_fmac_f32 v97, v98, v98
    v_and_b32 v98, 0x7fff7fff, v84
    v_pk_max_u16 v96, v96, v98
    v_lshlrev_b32 v99, 16, v98
    v_and_b32 v98, 0xffff0000, v98
    v_fmac_f32 v97, v99, v99
    v_fmac_f32 v97, v98, v98
    v_and_b32 v98, 0x7fff7fff, v85
    v_pk_max_u16 v96, v96, v98
    v_lshlrev_b32 v99, 16, v98
    v_and_b32 v98, 0xffff0000, v98
    v_fmac_f32 v97, v99, v99
    v_fmac_f32 v97, v98, v98
    v_and_b32 v98, 0x7fff7fff, v86
    v_pk_max_u16 v96, v96, v98
    v_lshlrev_b32 v99, 16, v98
    v_and_b32 v98, 0xffff0000, v98
    v_fmac_f32 v97, v99, v99
    v_fmac_f32 v97, v98, v98
    v_and_b32 v98, 0x7fff7fff, v87
    v_pk_max_u16 v96, v96, v98
    v_lshlrev_b32 v99, 16, v98
    v_and_b32 v98, 0xffff0000, v98
    v_fmac_f32 v97, v99, v99
    v_fmac_f32 v97, v98, v98
    v_and_b32 v98, 0x7fff7fff, v88
    v_pk_max_u16 v96, v96, v98
    v_lshlrev_b32 v99, 16, v98
    v_and_b32 v98, 0xffff0000, v98
    v_fmac_f32 v97, v99, v99
    v_fmac_f32 v97, v98, v98
    v_and_b32 v98, 0x7fff7fff, v89
    v_pk_max_u16 v96, v96, v98
    v_lshlrev_b32 v99, 16, v98
    v_and_b32 v98, 0xffff0000, v98
    v_fmac_f32 v97, v99, v99
    v_fmac_f32 v97, v98, v98
    v_lshrrev_b32 v98, 16, v96
    v_and_b32 v96, 0xffff, v96
    v_max_u32 v96, v96, v98
    s_nop 1
    v_max_u32_dpp v96, v96, v96 row_shr:1 row_mask:0xf bank_mask:0xf bound_ctrl:0
    v_add_f32_dpp v97, v97, v97 row_shr:1 row_mask:0xf bank_mask:0xf bound_ctrl:0
    s_nop 0
    v_max_u32_dpp v96, v96, v96 row_shr:2 row_mask:0xf bank_mask:0xf bound_ctrl:0
    v_add_f32_dpp v97, v97, v97 row_shr:2 row_mask:0xf bank_mask:0xf bound_ctrl:0
    s_nop 0
    v_max_u32_dpp v96, v96, v96 row_shr:4 row_mask:0xf bank_mask:0xf bound_ctrl:0
    v_add_f32_dpp v97, v97, v97 row_shr:4 row_mask:0xf bank_mask:0xf bound_ctrl:0
    s_nop 0
    v_max_u32_dpp v96, v96, v96 row_shr:8 row_mask:0xf bank_mask:0xf bound_ctrl:0
    v_add_f32_dpp v97, v97, v97 row_shr:8 row_mask:0xf bank_mask:0xf bound_ctrl:0
    s_nop 0
    v_max_u32_dpp v96, v96, v96 row_bcast:15 row_mask:0xa bank_mask:0xf
    v_add_f32_dpp v97, v97, v97 row_bcast:15 row_mask:0xa bank_mask:0xf
    s_nop 0
    v_max_u32_dpp v96, v96, v96 row_bcast:31 row_mask:0xc bank_mask:0xf
    v_add_f32_dpp v97, v97, v97 row_bcast:31 row_mask:0xc bank_mask:0xf
    s_nop 0
    s_nop 0
    s_lshl_b32 s52, s52, 4
    s_add_u32 s52, s52, s28
    s_lshl_b32 s52, s52, 3
    s_add_u32 s52, s52, 492261376
    s_mov_b64 exec, 1
    s_lshl_b64 exec, exec, 63
    buffer_store_dwordx2 v[96:97], off, s[16:19], s52
    s_mov_b64 exec, -1
p1_f1:
    s_waitcnt lgkmcnt(0)
    s_barrier
    v_mul_u32_u24 v119, 3, v0
    v_and_b32 v118, -4, v119
    v_add_u32 v120, s50, v1
    v_mov_b32 v122, 0
    v_mov_b32 v123, 0
    v_mov_b32 v124, 0
    v_mov_b32 v125, 0
    ds_read_b64 v[126:127], v122 offset:10448
    ds_write_b32 v122, v122 offset:10432
    v_cmp_gt_u32 vcc, 640, v0
    s_and_saveexec_b64 s[52:53], vcc
    ds_write_b128 v1, v[122:125] offset:0
    s_mov_b64 exec, -1
    s_waitcnt lgkmcnt(2)
    v_readfirstlane_b32 s70, v126
    v_readfirstlane_b32 s69, v127
    s_cmp_ge_u32 s33, 1536
    s_cselect_b32 s70, s70, 0
    s_cmp_gt_u32 s28, 10
    s_cselect_b32 s69, 0, s69
    s_cselect_b32 s70, 0, s70
    s_cmp_lg_u32 s70, 8
    s_cbranch_scc1 p1_h0
    s_sub_u32 s52, s33, 1536
    v_and_b32 v102, 63, v0
    s_cmp_eq_u32 s28, 10
    s_cbranch_scc1 p1_tr10
    s_mul_i32 s53, s28, 520
    v_lshl_add_u32 v100, v102, 3, s53
    s_mul_i32 s53, s28, 4160
    v_lshl_add_u32 v101, v102, 4, s53
    s_branch p1_tr20
p1_tr10:
    v_mul_u32_u24 v100, 520, v102
    v_add_u32 v100, 512, v100
    v_mul_u32_u24 v101, 4160, v102
    v_add_u32 v101, 1024, v101
    v_cmp_gt_u32 vcc, 10, v102
    v_mov_b32 v102, 0x40000000
    s_nop 0
    v_cndmask_b32 v100, v102, v100, vcc
    v_cndmask_b32 v101, v102, v101, vcc
p1_tr20:
    s_mul_i32 s52, s52, 41984
    s_add_u32 s52, s52, 469762048
    buffer_load_dwordx2 v[76:77], v100, s[16:19], s52 offen sc1
    s_add_u32 s52, s52, 5248
    buffer_load_dwordx2 v[78:79], v100, s[16:19], s52 offen sc1
    s_add_u32 s52, s52, 5248
    buffer_load_dwordx2 v[80:81], v100, s[16:19], s52 offen sc1
    s_add_u32 s52, s52, 5248
    buffer_load_dwordx2 v[82:83], v100, s[16:19], s52 offen sc1
    s_add_u32 s52, s52, 5248
    buffer_load_dwordx2 v[84:85], v100, s[16:19], s52 offen sc1
    s_add_u32 s52, s52, 5248
    buffer_load_dwordx2 v[86:87], v100, s[16:19], s52 offen sc1
    s_add_u32 s52, s52, 5248
    buffer_load_dwordx2 v[88:89], v100, s[16:19], s52 offen sc1
    s_add_u32 s52, s52, 5248
    buffer_load_dwordx2 v[90:91], v100, s[16:19], s52 offen sc1
    s_add_u32 s52, s52, 5248
p1_h0:
    v_lshlrev_b32 v117, 2, v119
    v_add_u32 v117, 52480, v117
    ds_read_b32 v110, v117 offset:0
    ds_read_b32 v111, v117 offset:4
    ds_read_b32 v112, v117 offset:8
    ds_read_b32 v113, v118 offset:10496
    ds_read_b32 v114, v118 offset:10500
    ds_read_b32 v122, v117 offset:12288
    ds_read_b32 v123, v117 offset:12292
    ds_read_b32 v124, v117 offset:12296
    ds_read_b32 v125, v118 offset:13568
    ds_read_b32 v121, v118 offset:13572
    s_waitcnt lgkmcnt(5)
    v_alignbyte_b32 v113, v114, v113, v119
    buffer_store_dwordx4 v[110:113], v120, s[20:23], 0 offen
    v_add_u32 v120, 33554432, v120
    s_nop 0
    ds_read_b32 v110, v117 offset:24576
    ds_read_b32 v111, v117 offset:24580
    ds_read_b32 v112, v117 offset:24584
    ds_read_b32 v113, v118 offset:16640
    ds_read_b32 v114, v118 offset:16644
    s_cmp_le_u32 s35, 1024
    s_cbranch_scc1 p1_ce0
    s_waitcnt lgkmcnt(5)
    v_alignbyte_b32 v125, v121, v125, v119
    buffer_store_dwordx4 v[122:125], v120, s[20:23], 0 offen
    v_add_u32 v120, 33554432, v120
    s_nop 0
    ds_read_b32 v122, v117 offset:36864
    ds_read_b32 v123, v117 offset:36868
    ds_read_b32 v124, v117 offset:36872
    ds_read_b32 v125, v118 offset:19712
    ds_read_b32 v121, v118 offset:19716
    s_cmp_le_u32 s35, 2048
    s_cbranch_scc1 p1_ce0
    s_waitcnt lgkmcnt(5)
    v_alignbyte_b32 v113, v114, v113, v119
    buffer_store_dwordx4 v[110:113], v120, s[20:23], 0 offen
    v_add_u32 v120, 33554432, v120
    s_nop 0
    ds_read_b32 v110, v117 offset:49152
    ds_read_b32 v111, v117 offset:49156
    ds_read_b32 v112, v117 offset:49160
    ds_read_b32 v113, v118 offset:22784
    ds_read_b32 v114, v118 offset:22788
    s_cmp_le_u32 s35, 3072
    s_cbranch_scc1 p1_ce0
    s_waitcnt lgkmcnt(5)
    v_alignbyte_b32 v125, v121, v125, v119
    buffer_store_dwordx4 v[122:125], v120, s[20:23], 0 offen
    v_add_u32 v120, 33554432, v120
    s_nop 0
    v_lshlrev_b32 v117, 2, v119
    v_add_u32 v117, 113920, v117
    ds_read_b32 v122, v117 offset:0
    ds_read_b32 v123, v117 offset:4
    ds_read_b32 v124, v117 offset:8
    ds_read_b32 v125, v118 offset:25856
    ds_read_b32 v121, v118 offset:25860
    s_cmp_le_u32 s35, 4096
    s_cbranch_scc1 p1_ce0
    s_waitcnt lgkmcnt(5)
    v_alignbyte_b32 v113, v114, v113, v119
    buffer_store_dwordx4 v[110:113], v120, s[20:23], 0 offen
    v_add_u32 v120, 33554432, v120
    s_nop 0
    ds_read_b32 v110, v117 offset:12288
    ds_read_b32 v111, v117 offset:12292
    ds_read_b32 v112, v117 offset:12296
    ds_read_b32 v113, v118 offset:28928
    ds_read_b32 v114, v118 offset:28932
    s_cmp_le_u32 s35, 5120
    s_cbranch_scc1 p1_ce0
    s_waitcnt lgkmcnt(5)
    v_alignbyte_b32 v125, v121, v125, v119
    buffer_store_dwordx4 v[122:125], v120, s[20:23], 0 offen
    v_add_u32 v120, 33554432, v120
    s_nop 0
    ds_read_b32 v122, v117 offset:24576
    ds_read_b32 v123, v117 offset:24580
    ds_read_b32 v124, v117 offset:24584
    ds_read_b32 v125, v118 offset:32000
    ds_read_b32 v121, v118 offset:32004
    s_cmp_le_u32 s35, 6144
    s_cbranch_scc1 p1_ce0
    s_waitcnt lgkmcnt(5)
    v_alignbyte_b32 v113, v114, v113, v119
    buffer_store_dwordx4 v[110:113], v120, s[20:23], 0 offen
    v_add_u32 v120, 33554432, v120
    s_nop 0
    ds_read_b32 v110, v117 offset:36864
    ds_read_b32 v111, v117 offset:36868
    ds_read_b32 v112, v117 offset:36872
    ds_read_b32 v113, v118 offset:35072
    ds_read_b32 v114, v118 offset:35076
    s_cmp_le_u32 s35, 7168
    s_cbranch_scc1 p1_ce0
    s_waitcnt lgkmcnt(5)
    v_alignbyte_b32 v125, v121, v125, v119
    s_cmp_ge_u32 s28, 12
    s_cbranch_scc1 p1_pw0
    buffer_store_dwordx4 v[122:125], v120, s[20:23], 0 offen
    s_branch p1_pw1
p1_pw0:
    buffer_store_dwordx4 v[122:125], v120, s[20:23], 0 offen nt
p1_pw1:
    v_add_u32 v120, 33554432, v120
    s_nop 0
    s_cmp_le_u32 s35, 8192
    s_cbranch_scc1 p1_ce0
    s_waitcnt lgkmcnt(0)
    v_alignbyte_b32 v113, v114, v113, v119
    buffer_store_dwordx4 v[110:113], v120, s[20:23], 0 offen nt
    v_add_u32 v120, 33554432, v120
    s_nop 0
p1_ce0:
    s_waitcnt lgkmcnt(0)
    s_cmp_lg_u32 s70, 8
    s_cbranch_scc1 p1_h1
    s_sub_u32 s52, s33, 1536
    s_mul_i32 s52, s52, 41600
    s_add_u32 s52, s52, 477822976
    s_mov_b32 s54, 0x05040100
    s_mov_b32 s55, 0x07060302
    s_waitcnt vmcnt(1)
    v_perm_b32 v92, v78, v76, s54
    v_perm_b32 v93, v82, v80, s54
    v_perm_b32 v94, v86, v84, s54
    v_perm_b32 v95, v90, v88, s54
    buffer_store_dwordx4 v[92:95], v101, s[16:19], s52 offen offset:0
    v_perm_b32 v96, v78, v76, s55
    v_perm_b32 v97, v82, v80, s55
    v_perm_b32 v98, v86, v84, s55
    v_perm_b32 v99, v90, v88, s55
    buffer_store_dwordx4 v[96:99], v101, s[16:19], s52 offen offset:1040
    v_perm_b32 v92, v79, v77, s54
    v_perm_b32 v93, v83, v81, s54
    v_perm_b32 v94, v87, v85, s54
    v_perm_b32 v95, v91, v89, s54
    buffer_store_dwordx4 v[92:95], v101, s[16:19], s52 offen offset:2080
    v_perm_b32 v96, v79, v77, s55
    v_perm_b32 v97, v83, v81, s55
    v_perm_b32 v98, v87, v85, s55
    v_perm_b32 v99, v91, v89, s55
    buffer_store_dwordx4 v[96:99], v101, s[16:19], s52 offen offset:3120
p1_h1:
    s_barrier
    s_cmp_ge_u32 s29, 1462
    s_cbranch_scc1 p1_k38
    s_cmp_le_u32 s35, 9216
    s_cbranch_scc1 p1_s1k2
    v_sub_u32 v48, 221180, v48
    ds_write_b32 v48, v12 offset:52480
    v_sub_u32 v49, 221180, v49
    ds_write_b32 v49, v13 offset:52480
    v_sub_u32 v50, 221180, v50
    ds_write_b32 v50, v14 offset:52480
    v_sub_u32 v51, 221180, v51
    ds_write_b32 v51, v15 offset:52480
p1_s1k2:
p1_k38:
    s_cmp_ge_u32 s33, 1536
    s_cbranch_scc1 p1_k39
    s_cmp_lt_u32 s33, 1462
    s_cselect_b32 s6, 204800000, 0
    s_cselect_b32 s10, 204800000, 0
    s_add_u32 s32, s30, 32768
    buffer_load_dwordx4 v[12:15], v1, s[4:7], s32 offen nt
    buffer_load_dwordx4 v[48:51], v1, s[8:11], s32 offen nt
p1_k39:
    s_cmp_ge_u32 s29, 1426
    s_cbranch_scc1 p1_k40
    s_cmp_le_u32 s35, 9216
    s_cbranch_scc1 p1_s1k3
    v_sub_u32 v52, 221180, v52
    ds_write_b32 v52, v16 offset:52480
    v_sub_u32 v53, 221180, v53
    ds_write_b32 v53, v17 offset:52480
    v_sub_u32 v54, 221180, v54
    ds_write_b32 v54, v18 offset:52480
    v_sub_u32 v55, 221180, v55
    ds_write_b32 v55, v19 offset:52480
p1_s1k3:
p1_k40:
    s_cmp_ge_u32 s29, 1389
    s_cbranch_scc1 p1_k41
    s_cmp_le_u32 s35, 9216
    s_cbranch_scc1 p1_s1k4
    v_sub_u32 v56, 221180, v56
    ds_write_b32 v56, v20 offset:52480
    v_sub_u32 v57, 221180, v57
    ds_write_b32 v57, v21 offset:52480
    v_sub_u32 v58, 221180, v58
    ds_write_b32 v58, v22 offset:52480
    v_sub_u32 v59, 221180, v59
    ds_write_b32 v59, v23 offset:52480
p1_s1k4:
p1_k41:
    s_cmp_ge_u32 s29, 1352
    s_cbranch_scc1 p1_k42
    s_cmp_le_u32 s35, 9216
    s_cbranch_scc1 p1_s1k5
    v_sub_u32 v60, 221180, v60
    ds_write_b32 v60, v24 offset:52480
    v_sub_u32 v61, 221180, v61
    ds_write_b32 v61, v25 offset:52480
    v_sub_u32 v62, 221180, v62
    ds_write_b32 v62, v26 offset:52480
    v_sub_u32 v63, 221180, v63
    ds_write_b32 v63, v27 offset:52480
p1_s1k5:
p1_k42:
    s_cmp_ge_u32 s29, 1315
    s_cbranch_scc1 p1_k43
    s_cmp_le_u32 s35, 9216
    s_cbranch_scc1 p1_s1k6
    v_sub_u32 v64, 221180, v64
    ds_write_b32 v64, v28 offset:52480
    v_sub_u32 v65, 221180, v65
    ds_write_b32 v65, v29 offset:52480
    v_sub_u32 v66, 221180, v66
    ds_write_b32 v66, v30 offset:52480
    v_sub_u32 v67, 221180, v67
    ds_write_b32 v67, v31 offset:52480
p1_s1k6:
p1_k43:
    s_cmp_ge_u32 s29, 1279
    s_cbranch_scc1 p1_k44
    s_cmp_le_u32 s35, 9216
    s_cbranch_scc1 p1_s1k7
    v_sub_u32 v68, 221180, v68
    ds_write_b32 v68, v32 offset:52480
    v_sub_u32 v69, 221180, v69
    ds_write_b32 v69, v33 offset:52480
    v_sub_u32 v70, 221180, v70
    ds_write_b32 v70, v34 offset:52480
    v_sub_u32 v71, 221180, v71
    ds_write_b32 v71, v35 offset:52480
p1_s1k7:
p1_k44:
    s_cmp_ge_u32 s29, 1242
    s_cbranch_scc1 p1_k45
    s_cmp_le_u32 s35, 9216
    s_cbranch_scc1 p1_s1k8
    v_sub_u32 v72, 221180, v72
    ds_write_b32 v72, v36 offset:52480
    v_sub_u32 v73, 221180, v73
    ds_write_b32 v73, v37 offset:52480
    v_sub_u32 v74, 221180, v74
    ds_write_b32 v74, v38 offset:52480
    v_sub_u32 v75, 221180, v75
    ds_write_b32 v75, v39 offset:52480
p1_s1k8:
p1_k45:
    s_cmp_le_u32 s35, 9216
    s_cbranch_scc1 p1_s1k0
    v_sub_u32 v40, 221180, v40
    ds_write_b32 v40, v4 offset:52480
    v_sub_u32 v41, 221180, v41
    ds_write_b32 v41, v5 offset:52480
    v_sub_u32 v42, 221180, v42
    ds_write_b32 v42, v6 offset:52480
    v_sub_u32 v43, 221180, v43
    ds_write_b32 v43, v7 offset:52480
p1_s1k0:
    s_cmp_ge_u32 s29, 1499
    s_cbranch_scc1 p1_k46
    s_cmp_le_u32 s35, 9216
    s_cbranch_scc1 p1_s1k1
    v_sub_u32 v44, 221180, v44
    ds_write_b32 v44, v8 offset:52480
    v_sub_u32 v45, 221180, v45
    ds_write_b32 v45, v9 offset:52480
    v_sub_u32 v46, 221180, v46
    ds_write_b32 v46, v10 offset:52480
    v_sub_u32 v47, 221180, v47
    ds_write_b32 v47, v11 offset:52480
p1_s1k1:
p1_k46:
    s_cmp_lg_u32 s69, 8
    s_cbranch_scc1 p1_o1
    s_lshr_b32 s52, s29, 3
    v_and_b32 v74, 63, v0
    s_cmp_eq_u32 s28, 10
    s_cbranch_scc1 p1_tr11
    s_mul_i32 s53, s28, 520
    v_lshl_add_u32 v72, v74, 3, s53
    s_mul_i32 s53, s28, 4160
    v_lshl_add_u32 v73, v74, 4, s53
    s_branch p1_tr21
p1_tr11:
    v_mul_u32_u24 v72, 520, v74
    v_add_u32 v72, 512, v72
    v_mul_u32_u24 v73, 4160, v74
    v_add_u32 v73, 1024, v73
    v_cmp_gt_u32 vcc, 10, v74
    v_mov_b32 v74, 0x40000000
    s_nop 0
    v_cndmask_b32 v72, v74, v72, vcc
    v_cndmask_b32 v73, v74, v73, vcc
p1_tr21:
    s_mul_i32 s52, s52, 41984
    s_add_u32 s52, s52, 469762048
    buffer_load_dwordx2 v[24:25], v72, s[16:19], s52 offen sc1
    s_add_u32 s52, s52, 5248
    buffer_load_dwordx2 v[26:27], v72, s[16:19], s52 offen sc1
    s_add_u32 s52, s52, 5248
    buffer_load_dwordx2 v[28:29], v72, s[16:19], s52 offen sc1
    s_add_u32 s52, s52, 5248
    buffer_load_dwordx2 v[30:31], v72, s[16:19], s52 offen sc1
    s_add_u32 s52, s52, 5248
    buffer_load_dwordx2 v[32:33], v72, s[16:19], s52 offen sc1
    s_add_u32 s52, s52, 5248
    buffer_load_dwordx2 v[34:35], v72, s[16:19], s52 offen sc1
    s_add_u32 s52, s52, 5248
    buffer_load_dwordx2 v[36:37], v72, s[16:19], s52 offen sc1
    s_add_u32 s52, s52, 5248
    buffer_load_dwordx2 v[38:39], v72, s[16:19], s52 offen sc1
    s_add_u32 s52, s52, 5248
    s_cmp_ge_u32 s33, 1536
    s_cbranch_scc1 p1_o1
    s_lshr_b32 s52, s29, 3
    s_mul_i32 s52, s52, 41600
    s_add_u32 s52, s52, 477822976
    s_mov_b32 s54, 0x05040100
    s_mov_b32 s55, 0x07060302
    s_waitcnt vmcnt(0)
    v_perm_b32 v64, v26, v24, s54
    v_perm_b32 v65, v30, v28, s54
    v_perm_b32 v66, v34, v32, s54
    v_perm_b32 v67, v38, v36, s54
    buffer_store_dwordx4 v[64:67], v73, s[16:19], s52 offen offset:0
    v_perm_b32 v68, v26, v24, s55
    v_perm_b32 v69, v30, v28, s55
    v_perm_b32 v70, v34, v32, s55
    v_perm_b32 v71, v38, v36, s55
    buffer_store_dwordx4 v[68:71], v73, s[16:19], s52 offen offset:1040
    v_perm_b32 v64, v27, v25, s54
    v_perm_b32 v65, v31, v29, s54
    v_perm_b32 v66, v35, v33, s54
    v_perm_b32 v67, v39, v37, s54
    buffer_store_dwordx4 v[64:67], v73, s[16:19], s52 offen offset:2080
    v_perm_b32 v68, v27, v25, s55
    v_perm_b32 v69, v31, v29, s55
    v_perm_b32 v70, v35, v33, s55
    v_perm_b32 v71, v39, v37, s55
    buffer_store_dwordx4 v[68:71], v73, s[16:19], s52 offen offset:3120
    s_mov_b32 s69, 0
p1_o1:
    s_waitcnt lgkmcnt(0)
    s_barrier
    s_cmp_le_u32 s35, 9216
    s_cbranch_scc1 p1_ce1
    v_lshlrev_b32 v117, 2, v119
    v_sub_u32 v117, 113908, v117
    ds_read_b32 v122, v117 offset:49160
    ds_read_b32 v123, v117 offset:49156
    ds_read_b32 v124, v117 offset:49152
    ds_read_b32 v125, v118 offset:38144
    ds_read_b32 v121, v118 offset:38148
    ds_read_b32 v110, v117 offset:36872
    ds_read_b32 v111, v117 offset:36868
    ds_read_b32 v112, v117 offset:36864
    ds_read_b32 v113, v118 offset:41216
    ds_read_b32 v114, v118 offset:41220
    s_waitcnt lgkmcnt(5)
    v_alignbyte_b32 v125, v121, v125, v119
    buffer_store_dwordx4 v[122:125], v120, s[20:23], 0 offen nt
    v_add_u32 v120, 33554432, v120
    s_nop 0
    ds_read_b32 v122, v117 offset:24584
    ds_read_b32 v123, v117 offset:24580
    ds_read_b32 v124, v117 offset:24576
    ds_read_b32 v125, v118 offset:44288
    ds_read_b32 v121, v118 offset:44292
    s_cmp_le_u32 s35, 10240
    s_cbranch_scc1 p1_ce1
    s_waitcnt lgkmcnt(5)
    v_alignbyte_b32 v113, v114, v113, v119
    buffer_store_dwordx4 v[110:113], v120, s[20:23], 0 offen nt
    v_add_u32 v120, 33554432, v120
    s_nop 0
    ds_read_b32 v110, v117 offset:12296
    ds_read_b32 v111, v117 offset:12292
    ds_read_b32 v112, v117 offset:12288
    ds_read_b32 v113, v118 offset:47360
    ds_read_b32 v114, v118 offset:47364
    s_cmp_le_u32 s35, 11264
    s_cbranch_scc1 p1_ce1
    s_waitcnt lgkmcnt(5)
    v_alignbyte_b32 v125, v121, v125, v119
    buffer_store_dwordx4 v[122:125], v120, s[20:23], 0 offen nt
    v_add_u32 v120, 33554432, v120
    s_nop 0
    ds_read_b32 v122, v117 offset:8
    ds_read_b32 v123, v117 offset:4
    ds_read_b32 v124, v117 offset:0
    ds_read_b32 v125, v118 offset:50432
    ds_read_b32 v121, v118 offset:50436
    s_cmp_le_u32 s35, 12288
    s_cbranch_scc1 p1_ce1
    s_waitcnt lgkmcnt(5)
    v_alignbyte_b32 v113, v114, v113, v119
    buffer_store_dwordx4 v[110:113], v120, s[20:23], 0 offen nt
    v_add_u32 v120, 33554432, v120
    s_nop 0
    s_cmp_le_u32 s35, 13312
    s_cbranch_scc1 p1_ce1
    s_waitcnt lgkmcnt(0)
    v_alignbyte_b32 v125, v121, v125, v119
    buffer_store_dwordx4 v[122:125], v120, s[20:23], 0 offen nt
    v_add_u32 v120, 33554432, v120
    s_nop 0
p1_ce1:
    s_waitcnt lgkmcnt(0)
    s_cmp_lg_u32 s69, 8
    s_cbranch_scc1 p1_o2
    s_lshr_b32 s52, s29, 3
    s_mul_i32 s52, s52, 41600
    s_add_u32 s52, s52, 477822976
    s_mov_b32 s54, 0x05040100
    s_mov_b32 s55, 0x07060302
    s_waitcnt vmcnt(0)
    v_perm_b32 v64, v26, v24, s54
    v_perm_b32 v65, v30, v28, s54
    v_perm_b32 v66, v34, v32, s54
    v_perm_b32 v67, v38, v36, s54
    buffer_store_dwordx4 v[64:67], v73, s[16:19], s52 offen offset:0
    v_perm_b32 v68, v26, v24, s55
    v_perm_b32 v69, v30, v28, s55
    v_perm_b32 v70, v34, v32, s55
    v_perm_b32 v71, v38, v36, s55
    buffer_store_dwordx4 v[68:71], v73, s[16:19], s52 offen offset:1040
    v_perm_b32 v64, v27, v25, s54
    v_perm_b32 v65, v31, v29, s54
    v_perm_b32 v66, v35, v33, s54
    v_perm_b32 v67, v39, v37, s54
    buffer_store_dwordx4 v[64:67], v73, s[16:19], s52 offen offset:2080
    v_perm_b32 v68, v27, v25, s55
    v_perm_b32 v69, v31, v29, s55
    v_perm_b32 v70, v35, v33, s55
    v_perm_b32 v71, v39, v37, s55
    buffer_store_dwordx4 v[68:71], v73, s[16:19], s52 offen offset:3120
p1_o2:
    s_barrier
    s_mov_b32 s29, s33
    s_cmp_lt_u32 s29, 1242
    s_cselect_b32 s34, 1, 0
    s_cmp_lt_u32 s29, 1536
    s_cbranch_scc1 p1_tile
p1_end:
    s_endpgm
.globl p2_kernel
.p2align 8
.type p2_kernel,@function
p2_kernel:
    s_cmp_ge_u32 s2, 256
    s_cbranch_scc1 p2_end
    s_load_dwordx2 s[8:9], s[0:1], 104
    v_and_b32 v112, 63, v0
    v_lshrrev_b32 v122, 6, v0
    v_lshlrev_b32 v112, 4, v112
    v_readfirstlane_b32 s10, v122
    v_mov_b32 v113, 0x83ff0000
    s_and_b32 s44, s2, 7
    s_lshr_b32 s11, s44, 1
    s_and_b32 s44, s44, 1
    s_lshl_b32 s12, s44, 5
    s_lshr_b32 s44, s2, 3
    s_add_u32 s12, s12, s44
    s_mov_b32 s25, 54272
    s_mov_b32 s31, 67175170
    s_mov_b32 s32, 83952386
    s_mov_b32 s33, 100729602
    s_mov_b32 s21, 0
    s_mul_i32 s23, s10, 3072
    s_lshl_b32 s24, s10, 9
    s_lshl_b32 s64, s10, 10
    s_sub_u32 s42, s24, s23
    s_add_u32 s42, s42, 49152
    s_movk_i32 s63, 2048
    s_movk_i32 s65, 16384
    s_mul_i32 s62, s11, 161280
    s_add_u32 s62, s62, 485810176
    s_add_u32 s62, s62, s23
    s_mov_b32 s40, 477822976
    s_mul_i32 s44, s11, 1040
    s_add_u32 s40, s40, s44
    s_lshl_b32 s44, s12, 4
    s_add_u32 s40, s40, s44
    s_waitcnt lgkmcnt(0)
    s_mov_b32 s4, s8
    s_and_b32 s5, s9, 0xffff
    s_mov_b32 s6, 819200000
    s_mov_b32 s7, 0x20000
    s_mov_b32 s68, s8
    s_and_b32 s69, s9, 0xffff
    s_mov_b32 s70, 469762048
    s_mov_b32 s71, 0x20000
    s_and_b32 s44, s2, 7
    s_lshl_b32 s44, s44, 2
    s_lshr_b32 s18, 0x00000000, s44
    s_and_b32 s18, s18, 15
p2_restart:
    s_mov_b32 s61, 0
    s_add_u32 s44, s61, s18
    s_cmp_ge_u32 s44, 10
    s_cselect_b32 s53, 10, 0
    s_sub_u32 s44, s44, s53
    s_mul_i32 s44, s44, 4160
    s_add_u32 s44, s44, s40
    v_bfe_i32 v111, v112, 6, 1
    v_lshrrev_b32 v110, 6, v112
    v_bitop3_b32 v111, v111, 15, s10 bitop3:0x6a
    v_lshl_or_b32 v110, v110, 4, v111
    v_bfe_u32 v111, v112, 2, 4
    v_mul_u32_u24 v110, 41600, v110
    v_add_u32 v111, v110, v111
    v_add_u32 v110, 256, v112
    v_and_b32 v110, 0x400, v110
    v_lshl_or_b32 v111, v110, 20, v111
    buffer_load_dword v110, v111, s[4:7], s44 offen
    buffer_load_dword v111, v111, s[4:7], s44 offen offset:16
    s_mov_b32 s61, 1
    s_add_u32 s44, s61, s18
    s_cmp_ge_u32 s44, 10
    s_cselect_b32 s53, 10, 0
    s_sub_u32 s44, s44, s53
    s_mul_i32 s44, s44, 4160
    s_add_u32 s44, s44, s40
    v_bfe_i32 v69, v112, 6, 1
    v_lshrrev_b32 v68, 6, v112
    v_bitop3_b32 v69, v69, 15, s10 bitop3:0x6a
    v_lshl_or_b32 v68, v68, 4, v69
    v_bfe_u32 v69, v112, 2, 4
    v_mul_u32_u24 v68, 41600, v68
    v_add_u32 v69, v68, v69
    v_add_u32 v68, 256, v112
    v_and_b32 v68, 0x400, v68
    v_lshl_or_b32 v69, v68, 20, v69
    buffer_load_dword v68, v69, s[4:7], s44 offen
    buffer_load_dword v69, v69, s[4:7], s44 offen offset:16
    s_mov_b32 s61, 0
    s_cmp_lt_u32 s10, 15
    s_cselect_b32 s44, s64, 0x40000000
    v_add_u32 v60, s44, v112
    s_mov_b32 s44, 492261376
    buffer_load_dwordx4 v[60:63], v60, s[4:7], s44 offen
    s_mul_i32 s20, s18, 645120
    s_add_u32 s20, s20, s62
    s_cmp_ge_u32 s10, 9
    s_cbranch_scc1 p2_nmp
    v_lshrrev_b32 v84, 1, v112
    s_add_u32 s44, s20, s42
    buffer_load_dwordx2 v[84:85], v84, s[4:7], s44 offen
p2_nmp:
    buffer_load_dwordx4 v[72:75], v112, s[4:7], s20 offen offset:0
    buffer_load_dwordx4 v[76:79], v112, s[4:7], s20 offen offset:1024
    buffer_load_dwordx4 v[80:83], v112, s[4:7], s20 offen offset:2048
    s_barrier
    v_mov_b32 v115, 0
    v_mov_b32 v116, 0
    v_mov_b32 v117, 0
    v_mov_b32 v118, 0
    v_mov_b32 v119, 0
    v_mov_b32 v120, 0
    v_mov_b32 v121, 0
    ds_write_b128 v115, v[116:119] offset:53760
    s_mov_b32 s19, 0
    s_cmp_eq_u32 s21, 2
    s_cselect_b64 s[66:67], -1, 0
    s_waitcnt lgkmcnt(0)
    s_barrier
    s_waitcnt vmcnt(6)
    s_mov_b32 m0, s23
    v_mov_b32 v53, 0
    s_movk_i32 s44, 512
    v_sub_u32_sdwa v4, v111, v110 dst_sel:DWORD dst_unused:UNUSED_PAD src0_sel:WORD_0 src1_sel:WORD_0
    v_sub_u32_sdwa v5, v111, v110 dst_sel:DWORD dst_unused:UNUSED_PAD src0_sel:WORD_1 src1_sel:WORD_1
    v_med3_i32 v4, v4, 0, s44
    v_med3_i32 v5, v5, 0, s44
    v_add_u32 v48, v4, v5
    ds_write_addtid_b32 v53 offset:0
    ds_write_addtid_b32 v53 offset:256
    ds_write_addtid_b32 v53 offset:512
    ds_write_addtid_b32 v53 offset:768
    ds_write_addtid_b32 v53 offset:1024
    ds_write_addtid_b32 v53 offset:1280
    ds_write_addtid_b32 v53 offset:1536
    ds_write_addtid_b32 v53 offset:1792
    v_bfe_i32 v53, v112, 6, 1
    v_lshrrev_b32 v49, 6, v112
    v_bitop3_b32 v53, v53, 15, s10 bitop3:0x6a
    v_lshl_or_b32 v49, v49, 4, v53
    v_and_b32 v53, 0x30, v112
    v_lshl_or_b32 v53, v49, 6, v53
    v_lshlrev_b32 v53, 15, v53
    s_nop 1
    v_add_u32_dpp v48, v48, v48 row_shr:1 row_mask:0xf bank_mask:0xf bound_ctrl:0
    s_nop 1
    v_add_u32_dpp v48, v48, v48 row_shr:2 row_mask:0xf bank_mask:0xf bound_ctrl:0
    s_nop 1
    v_add_u32_dpp v48, v48, v48 row_shr:4 row_mask:0xf bank_mask:0xf bound_ctrl:0
    s_nop 1
    v_add_u32_dpp v48, v48, v48 row_shr:8 row_mask:0xf bank_mask:0xf bound_ctrl:0
    s_nop 1
    v_add_u32_dpp v48, v48, v48 row_bcast:15 row_mask:0xa bank_mask:0xf
    s_nop 1
    v_add_u32_dpp v48, v48, v48 row_bcast:31 row_mask:0xc bank_mask:0xf
    s_nop 1
    s_nop 0
    v_readlane_b32 s38, v48, 63
    v_sub_u32 v50, v48, v5
    v_sub_u32 v49, v50, v4
    v_writelane_b32 v5, 1, 63
    v_sub_u32 v10, 512, v49
    v_mad_u32_u16 v51, v110, 16, v53
    v_lshl_add_u32 v51, v10, 4, v51
    v_med3_i32 v10, v10, 0, v4
    v_lshl_add_u32 v49, v49, 2, s23
    v_sub_u32 v11, 512, v50
    v_mad_u32_u16 v52, v110, 16, v53 op_sel:[1,0,0,0]
    v_add_u32 v52, 262144, v52
    s_mov_b32 s44, 0x1fffc000
    v_writelane_b32 v52, s44, 63
    v_lshl_add_u32 v52, v11, 4, v52
    v_med3_i32 v11, v11, 0, v5
    v_lshl_add_u32 v50, v50, 2, s23
    v_lshl_add_u32 v48, v11, 16, v10
    v_add_u32 v110, v110, v48
    s_min_u32 s17, s38, 512
    s_add_u32 s17, s17, 63
    s_lshr_b32 s17, s17, 6
    v_cmpx_lt_i32 vcc, 0, v10
    ds_write_b32 v49, v51
    s_mov_b64 exec, -1
    v_cmpx_lt_i32 vcc, 0, v11
    ds_write_b32 v50, v52
    s_mov_b64 exec, -1
    s_cmp_lt_u32 s38, 512
    s_cbranch_scc1 p2_nomorea
    v_cmp_lt_u32_sdwa s[44:45], v110, v111 src0_sel:WORD_0 src1_sel:WORD_0
    v_cmp_lt_u32_sdwa s[46:47], v110, v111 src0_sel:WORD_1 src1_sel:WORD_1
    s_nop 0
    s_or_b64 s[44:45], s[44:45], s[46:47]
    s_cbranch_scc0 p2_nomorea
    v_mov_b32 v49, s19
    v_mov_b32 v50, 1
    ds_write_b32 v49, v50 offset:53760
p2_nomorea:
    s_mov_b32 m0, s23
    s_nop 0
    ds_read_addtid_b32 v2 offset:1024
    ds_read_addtid_b32 v8 offset:1280
    ds_read_addtid_b32 v14 offset:1536
    ds_read_addtid_b32 v20 offset:1792
    ds_read_addtid_b32 v88 offset:0
    ds_read_addtid_b32 v92 offset:256
    ds_read_addtid_b32 v96 offset:512
    ds_read_addtid_b32 v100 offset:768
    s_waitcnt lgkmcnt(0)
    s_nop 2
    s_nop 1
    v_max_u32_dpp v88, v88, v88 row_shr:1 row_mask:0xf bank_mask:0xf bound_ctrl:0
    v_max_u32_dpp v92, v92, v92 row_shr:1 row_mask:0xf bank_mask:0xf bound_ctrl:0
    v_max_u32_dpp v96, v96, v96 row_shr:1 row_mask:0xf bank_mask:0xf bound_ctrl:0
    v_max_u32_dpp v100, v100, v100 row_shr:1 row_mask:0xf bank_mask:0xf bound_ctrl:0
    v_max_u32_dpp v2, v2, v2 row_shr:1 row_mask:0xf bank_mask:0xf bound_ctrl:0
    v_max_u32_dpp v8, v8, v8 row_shr:1 row_mask:0xf bank_mask:0xf bound_ctrl:0
    v_max_u32_dpp v14, v14, v14 row_shr:1 row_mask:0xf bank_mask:0xf bound_ctrl:0
    v_max_u32_dpp v20, v20, v20 row_shr:1 row_mask:0xf bank_mask:0xf bound_ctrl:0
    v_max_u32_dpp v88, v88, v88 row_shr:2 row_mask:0xf bank_mask:0xf bound_ctrl:0
    v_max_u32_dpp v92, v92, v92 row_shr:2 row_mask:0xf bank_mask:0xf bound_ctrl:0
    v_max_u32_dpp v96, v96, v96 row_shr:2 row_mask:0xf bank_mask:0xf bound_ctrl:0
    v_max_u32_dpp v100, v100, v100 row_shr:2 row_mask:0xf bank_mask:0xf bound_ctrl:0
    v_max_u32_dpp v2, v2, v2 row_shr:2 row_mask:0xf bank_mask:0xf bound_ctrl:0
    v_max_u32_dpp v8, v8, v8 row_shr:2 row_mask:0xf bank_mask:0xf bound_ctrl:0
    v_max_u32_dpp v14, v14, v14 row_shr:2 row_mask:0xf bank_mask:0xf bound_ctrl:0
    v_max_u32_dpp v20, v20, v20 row_shr:2 row_mask:0xf bank_mask:0xf bound_ctrl:0
    v_max_u32_dpp v88, v88, v88 row_shr:4 row_mask:0xf bank_mask:0xf bound_ctrl:0
    v_max_u32_dpp v92, v92, v92 row_shr:4 row_mask:0xf bank_mask:0xf bound_ctrl:0
    v_max_u32_dpp v96, v96, v96 row_shr:4 row_mask:0xf bank_mask:0xf bound_ctrl:0
    v_max_u32_dpp v100, v100, v100 row_shr:4 row_mask:0xf bank_mask:0xf bound_ctrl:0
    v_max_u32_dpp v2, v2, v2 row_shr:4 row_mask:0xf bank_mask:0xf bound_ctrl:0
    v_max_u32_dpp v8, v8, v8 row_shr:4 row_mask:0xf bank_mask:0xf bound_ctrl:0
    v_max_u32_dpp v14, v14, v14 row_shr:4 row_mask:0xf bank_mask:0xf bound_ctrl:0
    v_max_u32_dpp v20, v20, v20 row_shr:4 row_mask:0xf bank_mask:0xf bound_ctrl:0
    v_max_u32_dpp v88, v88, v88 row_shr:8 row_mask:0xf bank_mask:0xf bound_ctrl:0
    v_max_u32_dpp v92, v92, v92 row_shr:8 row_mask:0xf bank_mask:0xf bound_ctrl:0
    v_max_u32_dpp v96, v96, v96 row_shr:8 row_mask:0xf bank_mask:0xf bound_ctrl:0
    v_max_u32_dpp v100, v100, v100 row_shr:8 row_mask:0xf bank_mask:0xf bound_ctrl:0
    v_max_u32_dpp v2, v2, v2 row_shr:8 row_mask:0xf bank_mask:0xf bound_ctrl:0
    v_max_u32_dpp v8, v8, v8 row_shr:8 row_mask:0xf bank_mask:0xf bound_ctrl:0
    v_max_u32_dpp v14, v14, v14 row_shr:8 row_mask:0xf bank_mask:0xf bound_ctrl:0
    v_max_u32_dpp v20, v20, v20 row_shr:8 row_mask:0xf bank_mask:0xf bound_ctrl:0
    v_max_u32_dpp v88, v88, v88 row_bcast:15 row_mask:0xa bank_mask:0xf
    v_max_u32_dpp v92, v92, v92 row_bcast:15 row_mask:0xa bank_mask:0xf
    v_max_u32_dpp v96, v96, v96 row_bcast:15 row_mask:0xa bank_mask:0xf
    v_max_u32_dpp v100, v100, v100 row_bcast:15 row_mask:0xa bank_mask:0xf
    v_max_u32_dpp v2, v2, v2 row_bcast:15 row_mask:0xa bank_mask:0xf
    v_max_u32_dpp v8, v8, v8 row_bcast:15 row_mask:0xa bank_mask:0xf
    v_max_u32_dpp v14, v14, v14 row_bcast:15 row_mask:0xa bank_mask:0xf
    v_max_u32_dpp v20, v20, v20 row_bcast:15 row_mask:0xa bank_mask:0xf
    v_max_u32_dpp v88, v88, v88 row_bcast:31 row_mask:0xc bank_mask:0xf
    v_max_u32_dpp v92, v92, v92 row_bcast:31 row_mask:0xc bank_mask:0xf
    v_max_u32_dpp v96, v96, v96 row_bcast:31 row_mask:0xc bank_mask:0xf
    v_max_u32_dpp v100, v100, v100 row_bcast:31 row_mask:0xc bank_mask:0xf
    v_max_u32_dpp v2, v2, v2 row_bcast:31 row_mask:0xc bank_mask:0xf
    v_max_u32_dpp v8, v8, v8 row_bcast:31 row_mask:0xc bank_mask:0xf
    v_max_u32_dpp v14, v14, v14 row_bcast:31 row_mask:0xc bank_mask:0xf
    v_max_u32_dpp v20, v20, v20 row_bcast:31 row_mask:0xc bank_mask:0xf
    s_nop 0
    v_readlane_b32 s41, v88, 63
    v_add_u32 v88, v88, v112
    v_add_u32 v88, 4294959104, v88
    v_max_u32 v92, s41, v92
    s_nop 0
    v_readlane_b32 s41, v92, 63
    v_add_u32 v92, v92, v112
    v_add_u32 v92, 4294960128, v92
    v_max_u32 v96, s41, v96
    s_nop 0
    v_readlane_b32 s41, v96, 63
    v_add_u32 v96, v96, v112
    v_add_u32 v96, 4294961152, v96
    v_max_u32 v100, s41, v100
    s_nop 0
    v_readlane_b32 s41, v100, 63
    v_add_u32 v100, v100, v112
    v_add_u32 v100, 4294962176, v100
    v_max_u32 v2, s41, v2
    s_nop 0
    v_readlane_b32 s41, v2, 63
    v_add_u32 v2, v2, v112
    v_add_u32 v2, 4294963200, v2
    v_max_u32 v8, s41, v8
    s_nop 0
    v_readlane_b32 s41, v8, 63
    v_add_u32 v8, v8, v112
    v_add_u32 v8, 4294964224, v8
    v_max_u32 v14, s41, v14
    s_nop 0
    v_readlane_b32 s41, v14, 63
    v_add_u32 v14, v14, v112
    v_add_u32 v14, 4294965248, v14
    v_max_u32 v20, s41, v20
    s_nop 0
    v_readlane_b32 s41, v20, 63
    v_add_u32 v20, v20, v112
    v_add_u32 v20, 4294966272, v20
    v_bfe_u32 v0, v2, 14, 4
    v_lshrrev_b32 v1, 18, v2
    v_and_b32 v2, 0x3fff, v2
    v_mad_u32_u24 v0, v0, s63, v1
    v_mad_u32_u24 v2, v0, s65, v2
    buffer_load_dwordx4 v[0:3], v2, s[68:71], 0 offen
    v_bfe_u32 v6, v8, 14, 4
    v_lshrrev_b32 v7, 18, v8
    v_and_b32 v8, 0x3fff, v8
    v_mad_u32_u24 v6, v6, s63, v7
    v_mad_u32_u24 v8, v6, s65, v8
    buffer_load_dwordx4 v[6:9], v8, s[68:71], 0 offen
    s_cmp_eq_u32 s21, 0
    s_cselect_b32 s44, 1073758208, 0
    v_mov_b32 v124, s44
    v_mov_b32 v125, s44
    v_mov_b32 v126, s44
    v_mov_b32 v127, s44
    v_add_u32 v123, s64, v112
    v_add_u32 v122, s25, v123
    ds_write_b128 v122, v[124:127] offset:0
    ds_write_b128 v122, v[124:127] offset:16384
    ds_write_b128 v122, v[124:127] offset:32768
    v_add_u32 v122, 49152, v122
    ds_write_b128 v122, v[124:127] offset:0
    ds_write_b128 v122, v[124:127] offset:16384
    ds_write_b128 v122, v[124:127] offset:32768
    v_cmpx_gt_u32 vcc, 1792, v123
    ds_write_b128 v122, v[124:127] offset:49152
    s_mov_b64 exec, -1
    v_bfe_u32 v12, v14, 14, 4
    v_lshrrev_b32 v13, 18, v14
    v_and_b32 v14, 0x3fff, v14
    v_mad_u32_u24 v12, v12, s63, v13
    v_mad_u32_u24 v14, v12, s65, v14
    buffer_load_dwordx4 v[12:15], v14, s[68:71], 0 offen
    s_mov_b32 s16, s17
    s_waitcnt vmcnt(6)
    s_cmp_lg_u32 s21, 0
    s_cbranch_scc1 p2_nostat1
    v_max_u32 v60, v60, v62
    v_add_f32 v61, v61, v63
    s_nop 1
    v_max_u32_dpp v60, v60, v60 row_shr:1 row_mask:0xf bank_mask:0xf bound_ctrl:0
    v_add_f32_dpp v61, v61, v61 row_shr:1 row_mask:0xf bank_mask:0xf bound_ctrl:0
    s_nop 0
    v_max_u32_dpp v60, v60, v60 row_shr:2 row_mask:0xf bank_mask:0xf bound_ctrl:0
    v_add_f32_dpp v61, v61, v61 row_shr:2 row_mask:0xf bank_mask:0xf bound_ctrl:0
    s_nop 0
    v_max_u32_dpp v60, v60, v60 row_shr:4 row_mask:0xf bank_mask:0xf bound_ctrl:0
    v_add_f32_dpp v61, v61, v61 row_shr:4 row_mask:0xf bank_mask:0xf bound_ctrl:0
    s_nop 0
    v_max_u32_dpp v60, v60, v60 row_shr:8 row_mask:0xf bank_mask:0xf bound_ctrl:0
    v_add_f32_dpp v61, v61, v61 row_shr:8 row_mask:0xf bank_mask:0xf bound_ctrl:0
    s_nop 0
    v_max_u32_dpp v60, v60, v60 row_bcast:15 row_mask:0xa bank_mask:0xf
    v_add_f32_dpp v61, v61, v61 row_bcast:15 row_mask:0xa bank_mask:0xf
    s_nop 0
    v_max_u32_dpp v60, v60, v60 row_bcast:31 row_mask:0xc bank_mask:0xf
    v_add_f32_dpp v61, v61, v61 row_bcast:31 row_mask:0xc bank_mask:0xf
    s_nop 0
    s_nop 0
    s_lshl_b32 s44, s10, 3
    v_mov_b32 v62, s44
    s_mov_b64 exec, 1
    s_lshl_b64 exec, exec, 63
    ds_write_b64 v62, v[60:61] offset:53824
    s_mov_b64 exec, -1
p2_nostat1:
    s_waitcnt lgkmcnt(0)
    s_barrier
    v_bfe_u32 v18, v20, 14, 4
    v_lshrrev_b32 v19, 18, v20
    v_and_b32 v20, 0x3fff, v20
    v_mad_u32_u24 v18, v18, s63, v19
    v_mad_u32_u24 v20, v18, s65, v20
    buffer_load_dwordx4 v[18:21], v20, s[68:71], 0 offen
    v_mov_b32 v122, s19
    s_xor_b32 s19, s19, 4
    ds_read_b32 v125, v122 offset:53760
    s_cmp_lg_u32 s21, 0
    s_cbranch_scc1 p2_nostat2
    v_bfe_u32 v62, v112, 1, 7
    ds_read_b64 v[60:61], v62 offset:53824
    s_waitcnt lgkmcnt(0)
    s_nop 1
    v_max_u32_dpp v60, v60, v60 row_shr:1 row_mask:0xf bank_mask:0xf bound_ctrl:0
    v_add_f32_dpp v61, v61, v61 row_shr:1 row_mask:0xf bank_mask:0xf bound_ctrl:0
    s_nop 0
    v_max_u32_dpp v60, v60, v60 row_shr:2 row_mask:0xf bank_mask:0xf bound_ctrl:0
    v_add_f32_dpp v61, v61, v61 row_shr:2 row_mask:0xf bank_mask:0xf bound_ctrl:0
    s_nop 0
    v_max_u32_dpp v60, v60, v60 row_shr:4 row_mask:0xf bank_mask:0xf bound_ctrl:0
    v_add_f32_dpp v61, v61, v61 row_shr:4 row_mask:0xf bank_mask:0xf bound_ctrl:0
    s_nop 0
    v_max_u32_dpp v60, v60, v60 row_shr:8 row_mask:0xf bank_mask:0xf bound_ctrl:0
    v_add_f32_dpp v61, v61, v61 row_shr:8 row_mask:0xf bank_mask:0xf bound_ctrl:0
    s_nop 0
    v_max_u32_dpp v60, v60, v60 row_bcast:15 row_mask:0xa bank_mask:0xf
    v_add_f32_dpp v61, v61, v61 row_bcast:15 row_mask:0xa bank_mask:0xf
    s_nop 0
    v_max_u32_dpp v60, v60, v60 row_bcast:31 row_mask:0xc bank_mask:0xf
    v_add_f32_dpp v61, v61, v61 row_bcast:31 row_mask:0xc bank_mask:0xf
    s_nop 0
    s_nop 0
    v_readlane_b32 s44, v60, 15
    v_readlane_b32 s45, v61, 15
    s_nop 1
    s_lshl_b32 s44, s44, 16
    s_lshr_b32 s46, s44, 23
    s_sub_u32 s47, s46, 80
    s_cmp_lt_u32 s47, 100
    s_cselect_b32 s21, 0, 1
    v_mov_b32 v60, s45
    v_mul_f32 v60, 0x34a7c5ac, v60
    v_sqrt_f32 v60, v60
    v_mov_b32 v61, s44
    v_mul_f32 v62, 0x41800000, v60
    v_cmp_nle_f32 vcc, v61, v62
    v_mul_f32 v60, 0x3ac00000, v60
    v_mul_f32 v61, 0x3901742e, v61
    v_max_f32 v60, v60, v61
    s_cmp_lg_u64 vcc, 0
    s_cselect_b32 s21, 1, s21
    v_readfirstlane_b32 s44, v60
    s_nop 0
    s_and_b32 s47, s44, 0x7fffff
    s_or_b32 s47, s47, 0x3f000000
    s_and_b32 s48, s44, 0x7f800000
    s_add_u32 s48, s48, 0x800000
    v_rcp_f32 v60, s47
    s_nop 0
    v_rcp_f32 v61, v60
    v_mul_f32 v60, 0x7b800000, v60
    v_mul_f32 v61, s48, v61
    s_nop 0
    v_readfirstlane_b32 s26, v60
    v_readfirstlane_b32 s30, v61
    s_add_u32 s34, s48, 197132288
    s_mov_b32 s35, s34
    s_sub_u32 s36, 0, s34
    s_subb_u32 s37, 0, s34
    s_cmp_eq_u32 s21, 0
    s_cbranch_scc1 p2_nostat2
    s_waitcnt vmcnt(0) lgkmcnt(0)
    s_branch p2_restart
p2_nostat2:
    s_cmp_eq_u32 s21, 0
    s_cselect_b32 s26, s26, 0x7b800000
    v_mov_b32 v114, s26
    s_waitcnt lgkmcnt(0)
    v_readfirstlane_b32 s44, v125
    s_nop 0
    s_cmp_lg_u32 s44, 0
    s_cbranch_scc1 p2_adva
    s_mov_b32 s61, 1
    v_mov_b32 v110, v68
    v_mov_b32 v111, v69
p2_adva:
    v_bfe_u32 v86, v88, 14, 4
    v_lshrrev_b32 v87, 18, v88
    v_and_b32 v88, 0x3fff, v88
    v_mad_u32_u24 v86, v86, s63, v87
    v_mad_u32_u24 v88, v86, s65, v88
    buffer_load_dwordx4 v[86:89], v88, s[68:71], 0 offen
    s_mov_b32 m0, s23
    v_mov_b32 v53, 0
    s_movk_i32 s44, 512
    v_sub_u32_sdwa v4, v111, v110 dst_sel:DWORD dst_unused:UNUSED_PAD src0_sel:WORD_0 src1_sel:WORD_0
    v_sub_u32_sdwa v5, v111, v110 dst_sel:DWORD dst_unused:UNUSED_PAD src0_sel:WORD_1 src1_sel:WORD_1
    v_med3_i32 v4, v4, 0, s44
    v_med3_i32 v5, v5, 0, s44
    v_add_u32 v48, v4, v5
    ds_write_addtid_b32 v53 offset:0
    ds_write_addtid_b32 v53 offset:256
    ds_write_addtid_b32 v53 offset:512
    ds_write_addtid_b32 v53 offset:768
    ds_write_addtid_b32 v53 offset:1024
    ds_write_addtid_b32 v53 offset:1280
    ds_write_addtid_b32 v53 offset:1536
    ds_write_addtid_b32 v53 offset:1792
    v_bfe_i32 v53, v112, 6, 1
    v_lshrrev_b32 v49, 6, v112
    v_bitop3_b32 v53, v53, 15, s10 bitop3:0x6a
    v_lshl_or_b32 v49, v49, 4, v53
    v_and_b32 v53, 0x30, v112
    v_lshl_or_b32 v53, v49, 6, v53
    v_lshlrev_b32 v53, 15, v53
    s_nop 1
    v_add_u32_dpp v48, v48, v48 row_shr:1 row_mask:0xf bank_mask:0xf bound_ctrl:0
    s_nop 1
    v_add_u32_dpp v48, v48, v48 row_shr:2 row_mask:0xf bank_mask:0xf bound_ctrl:0
    s_nop 1
    v_add_u32_dpp v48, v48, v48 row_shr:4 row_mask:0xf bank_mask:0xf bound_ctrl:0
    s_nop 1
    v_add_u32_dpp v48, v48, v48 row_shr:8 row_mask:0xf bank_mask:0xf bound_ctrl:0
    s_nop 1
    v_add_u32_dpp v48, v48, v48 row_bcast:15 row_mask:0xa bank_mask:0xf
    s_nop 1
    v_add_u32_dpp v48, v48, v48 row_bcast:31 row_mask:0xc bank_mask:0xf
    s_nop 1
    s_nop 0
    v_readlane_b32 s38, v48, 63
    v_sub_u32 v50, v48, v5
    v_sub_u32 v49, v50, v4
    v_writelane_b32 v5, 1, 63
    v_sub_u32 v10, 512, v49
    v_mad_u32_u16 v51, v110, 16, v53
    v_lshl_add_u32 v51, v10, 4, v51
    v_med3_i32 v10, v10, 0, v4
    v_lshl_add_u32 v49, v49, 2, s23
    v_sub_u32 v11, 512, v50
    v_mad_u32_u16 v52, v110, 16, v53 op_sel:[1,0,0,0]
    v_add_u32 v52, 262144, v52
    s_mov_b32 s44, 0x1fffc000
    v_writelane_b32 v52, s44, 63
    v_lshl_add_u32 v52, v11, 4, v52
    v_med3_i32 v11, v11, 0, v5
    v_lshl_add_u32 v50, v50, 2, s23
    v_lshl_add_u32 v48, v11, 16, v10
    v_add_u32 v110, v110, v48
    s_min_u32 s17, s38, 512
    s_add_u32 s17, s17, 63
    s_lshr_b32 s17, s17, 6
    v_cmpx_lt_i32 vcc, 0, v10
    ds_write_b32 v49, v51
    s_mov_b64 exec, -1
    v_cmpx_lt_i32 vcc, 0, v11
    ds_write_b32 v50, v52
    s_mov_b64 exec, -1
    s_cmp_lt_u32 s38, 512
    s_cbranch_scc1 p2_nomoreb
    v_cmp_lt_u32_sdwa s[44:45], v110, v111 src0_sel:WORD_0 src1_sel:WORD_0
    v_cmp_lt_u32_sdwa s[46:47], v110, v111 src0_sel:WORD_1 src1_sel:WORD_1
    s_nop 0
    s_or_b64 s[44:45], s[44:45], s[46:47]
    s_cbranch_scc0 p2_nomoreb
    v_mov_b32 v49, s19
    v_mov_b32 v50, 1
    ds_write_b32 v49, v50 offset:53760
p2_nomoreb:
    s_mov_b32 m0, s23
    s_nop 0
    ds_read_addtid_b32 v102 offset:1024
    ds_read_addtid_b32 v103 offset:1280
    ds_read_addtid_b32 v104 offset:1536
    ds_read_addtid_b32 v105 offset:1792
    ds_read_addtid_b32 v106 offset:0
    ds_read_addtid_b32 v107 offset:256
    ds_read_addtid_b32 v108 offset:512
    ds_read_addtid_b32 v109 offset:768
    v_bfe_u32 v90, v92, 14, 4
    v_lshrrev_b32 v91, 18, v92
    v_and_b32 v92, 0x3fff, v92
    v_mad_u32_u24 v90, v90, s63, v91
    v_mad_u32_u24 v92, v90, s65, v92
    buffer_load_dwordx4 v[90:93], v92, s[68:71], 0 offen
    s_waitcnt vmcnt(6)
    s_mov_b32 m0, s24
    s_cmp_ge_u32 s10, 9
    s_cbranch_scc1 p2_stp
    ds_write_addtid_b32 v84 offset:49152
    ds_write_addtid_b32 v85 offset:49408
p2_stp:
    s_mov_b32 m0, s23
    s_add_u32 s20, s20, 53760
    ds_write_addtid_b32 v72 offset:0
    ds_write_addtid_b32 v73 offset:256
    ds_write_addtid_b32 v74 offset:512
    ds_write_addtid_b32 v75 offset:768
    ds_write_addtid_b32 v76 offset:1024
    ds_write_addtid_b32 v77 offset:1280
    ds_write_addtid_b32 v78 offset:1536
    ds_write_addtid_b32 v79 offset:1792
    ds_write_addtid_b32 v80 offset:2048
    ds_write_addtid_b32 v81 offset:2304
    ds_write_addtid_b32 v82 offset:2560
    ds_write_addtid_b32 v83 offset:2816
    s_waitcnt lgkmcnt(0)
    s_barrier
    v_bfe_u32 v94, v96, 14, 4
    v_lshrrev_b32 v95, 18, v96
    v_and_b32 v96, 0x3fff, v96
    v_mad_u32_u24 v94, v94, s63, v95
    v_mad_u32_u24 v96, v94, s65, v96
    buffer_load_dwordx4 v[94:97], v96, s[68:71], 0 offen
    v_bfe_u32 v98, v100, 14, 4
    v_lshrrev_b32 v99, 18, v100
    v_and_b32 v100, 0x3fff, v100
    v_mad_u32_u24 v98, v98, s63, v99
    v_mad_u32_u24 v100, v98, s65, v100
    buffer_load_dwordx4 v[98:101], v100, s[68:71], 0 offen
    s_nop 2
    s_nop 1
    v_max_u32_dpp v106, v106, v106 row_shr:1 row_mask:0xf bank_mask:0xf bound_ctrl:0
    v_max_u32_dpp v107, v107, v107 row_shr:1 row_mask:0xf bank_mask:0xf bound_ctrl:0
    v_max_u32_dpp v108, v108, v108 row_shr:1 row_mask:0xf bank_mask:0xf bound_ctrl:0
    v_max_u32_dpp v109, v109, v109 row_shr:1 row_mask:0xf bank_mask:0xf bound_ctrl:0
    v_max_u32_dpp v106, v106, v106 row_shr:2 row_mask:0xf bank_mask:0xf bound_ctrl:0
    v_max_u32_dpp v107, v107, v107 row_shr:2 row_mask:0xf bank_mask:0xf bound_ctrl:0
    v_max_u32_dpp v108, v108, v108 row_shr:2 row_mask:0xf bank_mask:0xf bound_ctrl:0
    v_max_u32_dpp v109, v109, v109 row_shr:2 row_mask:0xf bank_mask:0xf bound_ctrl:0
    v_max_u32_dpp v106, v106, v106 row_shr:4 row_mask:0xf bank_mask:0xf bound_ctrl:0
    v_max_u32_dpp v107, v107, v107 row_shr:4 row_mask:0xf bank_mask:0xf bound_ctrl:0
    v_max_u32_dpp v108, v108, v108 row_shr:4 row_mask:0xf bank_mask:0xf bound_ctrl:0
    v_max_u32_dpp v109, v109, v109 row_shr:4 row_mask:0xf bank_mask:0xf bound_ctrl:0
    v_max_u32_dpp v106, v106, v106 row_shr:8 row_mask:0xf bank_mask:0xf bound_ctrl:0
    v_max_u32_dpp v107, v107, v107 row_shr:8 row_mask:0xf bank_mask:0xf bound_ctrl:0
    v_max_u32_dpp v108, v108, v108 row_shr:8 row_mask:0xf bank_mask:0xf bound_ctrl:0
    v_max_u32_dpp v109, v109, v109 row_shr:8 row_mask:0xf bank_mask:0xf bound_ctrl:0
    v_max_u32_dpp v106, v106, v106 row_bcast:15 row_mask:0xa bank_mask:0xf
    v_max_u32_dpp v107, v107, v107 row_bcast:15 row_mask:0xa bank_mask:0xf
    v_max_u32_dpp v108, v108, v108 row_bcast:15 row_mask:0xa bank_mask:0xf
    v_max_u32_dpp v109, v109, v109 row_bcast:15 row_mask:0xa bank_mask:0xf
    v_max_u32_dpp v106, v106, v106 row_bcast:31 row_mask:0xc bank_mask:0xf
    v_max_u32_dpp v107, v107, v107 row_bcast:31 row_mask:0xc bank_mask:0xf
    v_max_u32_dpp v108, v108, v108 row_bcast:31 row_mask:0xc bank_mask:0xf
    v_max_u32_dpp v109, v109, v109 row_bcast:31 row_mask:0xc bank_mask:0xf
    s_nop 0
    v_readlane_b32 s41, v106, 63
    v_add_u32 v106, v106, v112
    v_add_u32 v106, 4294959104, v106
    v_max_u32 v107, s41, v107
    s_nop 0
    v_readlane_b32 s41, v107, 63
    v_add_u32 v107, v107, v112
    v_add_u32 v107, 4294960128, v107
    v_max_u32 v108, s41, v108
    s_nop 0
    v_readlane_b32 s41, v108, 63
    v_add_u32 v108, v108, v112
    v_add_u32 v108, 4294961152, v108
    v_max_u32 v109, s41, v109
    s_nop 0
    v_readlane_b32 s41, v109, 63
    v_add_u32 v109, v109, v112
    v_add_u32 v109, 4294962176, v109
    s_waitcnt vmcnt(7)
    v_perm_b32 v48, v3, v0, s31
    v_perm_b32 v49, v3, v1, s32
    v_perm_b32 v50, v3, v2, s33
    v_lshlrev_b16 v4, 3, v2
    v_lshlrev_b16 v2, 3, v1
    v_lshlrev_b16 v0, 3, v0
    v_cmpx_ge_u16 vcc, 0x3fff, v48
    ds_read_b64 v[0:1], v0
    s_mov_b64 exec, -1
    v_cmpx_ge_u16 vcc, 0x3fff, v49
    ds_read_b64 v[2:3], v2
    s_mov_b64 exec, -1
    v_cmpx_ge_u16 vcc, 0x3fff, v50
    ds_read_b64 v[4:5], v4
    s_mov_b64 exec, -1
    s_waitcnt vmcnt(6)
    v_perm_b32 v51, v9, v6, s31
    v_perm_b32 v52, v9, v7, s32
    v_perm_b32 v53, v9, v8, s33
    v_lshlrev_b16 v10, 3, v8
    v_lshlrev_b16 v8, 3, v7
    v_lshlrev_b16 v6, 3, v6
    v_cmpx_ge_u16 vcc, 0x3fff, v51
    ds_read_b64 v[6:7], v6
    s_mov_b64 exec, -1
    v_cmpx_ge_u16 vcc, 0x3fff, v52
    ds_read_b64 v[8:9], v8
    s_mov_b64 exec, -1
    v_cmpx_ge_u16 vcc, 0x3fff, v53
    ds_read_b64 v[10:11], v10
    s_mov_b64 exec, -1
    s_waitcnt vmcnt(5)
    v_perm_b32 v54, v15, v12, s31
    v_perm_b32 v55, v15, v13, s32
    v_perm_b32 v56, v15, v14, s33
    v_lshlrev_b16 v16, 3, v14
    v_lshlrev_b16 v14, 3, v13
    v_lshlrev_b16 v12, 3, v12
    v_cmpx_ge_u16 vcc, 0x3fff, v54
    ds_read_b64 v[12:13], v12
    s_mov_b64 exec, -1
    v_cmpx_ge_u16 vcc, 0x3fff, v55
    ds_read_b64 v[14:15], v14
    s_mov_b64 exec, -1
    v_cmpx_ge_u16 vcc, 0x3fff, v56
    ds_read_b64 v[16:17], v16
    s_mov_b64 exec, -1
    s_waitcnt vmcnt(4)
    v_perm_b32 v57, v21, v18, s31
    v_perm_b32 v58, v21, v19, s32
    v_perm_b32 v59, v21, v20, s33
    v_lshlrev_b16 v22, 3, v20
    v_lshlrev_b16 v20, 3, v19
    v_lshlrev_b16 v18, 3, v18
    s_cmp_lt_u32 s16, 8
    s_cbranch_scc1 p2_gp
    v_cmpx_ge_u16 vcc, 0x3fff, v57
    ds_read_b64 v[18:19], v18
    s_mov_b64 exec, -1
    v_cmpx_ge_u16 vcc, 0x3fff, v58
    ds_read_b64 v[20:21], v20
    s_mov_b64 exec, -1
    v_cmpx_ge_u16 vcc, 0x3fff, v59
    ds_read_b64 v[22:23], v22
    s_mov_b64 exec, -1
p2_gp:
    s_waitcnt vmcnt(3)
    v_perm_b32 v60, v89, v86, s31
    v_perm_b32 v61, v89, v87, s32
    v_perm_b32 v62, v89, v88, s33
    v_lshlrev_b16 v28, 3, v88
    v_lshlrev_b16 v26, 3, v87
    v_lshlrev_b16 v24, 3, v86
    v_cmpx_ge_u16 vcc, 0x3fff, v60
    ds_read_b64 v[24:25], v24
    s_mov_b64 exec, -1
    v_cmpx_ge_u16 vcc, 0x3fff, v61
    ds_read_b64 v[26:27], v26
    s_mov_b64 exec, -1
    v_cmpx_ge_u16 vcc, 0x3fff, v62
    ds_read_b64 v[28:29], v28
    s_mov_b64 exec, -1
    v_bfe_u32 v86, v106, 14, 4
    v_lshrrev_b32 v87, 18, v106
    v_and_b32 v106, 0x3fff, v106
    v_mad_u32_u24 v86, v86, s63, v87
    v_mad_u32_u24 v106, v86, s65, v106
    buffer_load_dwordx4 v[86:89], v106, s[68:71], 0 offen
    s_cmp_ge_u32 s10, 9
    s_cbranch_scc1 p2_nmq
    v_lshrrev_b32 v84, 1, v112
    s_add_u32 s44, s20, s42
    buffer_load_dwordx2 v[84:85], v84, s[4:7], s44 offen
p2_nmq:
    buffer_load_dwordx4 v[72:75], v112, s[4:7], s20 offen offset:0
    buffer_load_dwordx4 v[76:79], v112, s[4:7], s20 offen offset:1024
    buffer_load_dwordx4 v[80:83], v112, s[4:7], s20 offen offset:2048
    s_waitcnt vmcnt(6)
    v_perm_b32 v63, v93, v90, s31
    v_perm_b32 v64, v93, v91, s32
    v_perm_b32 v65, v93, v92, s33
    v_lshlrev_b16 v34, 3, v92
    v_lshlrev_b16 v32, 3, v91
    v_lshlrev_b16 v30, 3, v90
    v_cmpx_ge_u16 vcc, 0x3fff, v63
    ds_read_b64 v[30:31], v30
    s_mov_b64 exec, -1
    v_cmpx_ge_u16 vcc, 0x3fff, v64
    ds_read_b64 v[32:33], v32
    s_mov_b64 exec, -1
    v_cmpx_ge_u16 vcc, 0x3fff, v65
    ds_read_b64 v[34:35], v34
    s_mov_b64 exec, -1
    v_bfe_u32 v90, v107, 14, 4
    v_lshrrev_b32 v91, 18, v107
    v_and_b32 v107, 0x3fff, v107
    v_mad_u32_u24 v90, v90, s63, v91
    v_mad_u32_u24 v107, v90, s65, v107
    buffer_load_dwordx4 v[90:93], v107, s[68:71], 0 offen
    s_waitcnt vmcnt(6)
    v_perm_b32 v66, v97, v94, s31
    v_perm_b32 v67, v97, v95, s32
    v_perm_b32 v68, v97, v96, s33
    v_lshlrev_b16 v40, 3, v96
    v_lshlrev_b16 v38, 3, v95
    v_lshlrev_b16 v36, 3, v94
    v_cmpx_ge_u16 vcc, 0x3fff, v66
    ds_read_b64 v[36:37], v36
    s_mov_b64 exec, -1
    v_cmpx_ge_u16 vcc, 0x3fff, v67
    ds_read_b64 v[38:39], v38
    s_mov_b64 exec, -1
    v_cmpx_ge_u16 vcc, 0x3fff, v68
    ds_read_b64 v[40:41], v40
    s_mov_b64 exec, -1
    v_bfe_u32 v94, v108, 14, 4
    v_lshrrev_b32 v95, 18, v108
    v_and_b32 v108, 0x3fff, v108
    v_mad_u32_u24 v94, v94, s63, v95
    v_mad_u32_u24 v108, v94, s65, v108
    buffer_load_dwordx4 v[94:97], v108, s[68:71], 0 offen
    s_waitcnt vmcnt(6)
    v_perm_b32 v69, v101, v98, s31
    v_perm_b32 v70, v101, v99, s32
    v_perm_b32 v71, v101, v100, s33
    v_lshlrev_b16 v46, 3, v100
    v_lshlrev_b16 v44, 3, v99
    v_lshlrev_b16 v42, 3, v98
    v_cmpx_ge_u16 vcc, 0x3fff, v69
    ds_read_b64 v[42:43], v42
    s_mov_b64 exec, -1
    v_cmpx_ge_u16 vcc, 0x3fff, v70
    ds_read_b64 v[44:45], v44
    s_mov_b64 exec, -1
    v_cmpx_ge_u16 vcc, 0x3fff, v71
    ds_read_b64 v[46:47], v46
    s_mov_b64 exec, -1
    s_waitcnt lgkmcnt(0)
    s_barrier
    s_branch p2_tail
p2_top:
    s_cmp_lg_u32 s21, 0
    s_cbranch_scc1 p2_topf
    s_cmp_eq_u32 s60, 10
    s_cbranch_scc1 p2_drain0
    s_setprio 3
    v_cmpx_gt_i16 vcc, 0, v48
    ds_read_b64 v[0:1], v0
    s_mov_b64 exec, -1
    v_cmpx_gt_i16 vcc, 0, v49
    ds_read_b64 v[2:3], v2
    s_mov_b64 exec, -1
    v_cmpx_gt_i16 vcc, 0, v50
    ds_read_b64 v[4:5], v4
    s_mov_b64 exec, -1
    v_cmpx_gt_i16 vcc, 0, v51
    ds_read_b64 v[6:7], v6
    s_mov_b64 exec, -1
    v_cmpx_gt_i16 vcc, 0, v52
    ds_read_b64 v[8:9], v8
    s_mov_b64 exec, -1
    v_cmpx_gt_i16 vcc, 0, v53
    ds_read_b64 v[10:11], v10
    s_mov_b64 exec, -1
    v_cmpx_gt_i16 vcc, 0, v54
    ds_read_b64 v[12:13], v12
    s_mov_b64 exec, -1
    v_cmpx_gt_i16 vcc, 0, v55
    ds_read_b64 v[14:15], v14
    s_mov_b64 exec, -1
    v_cmpx_gt_i16 vcc, 0, v56
    ds_read_b64 v[16:17], v16
    s_mov_b64 exec, -1
    s_cmp_lt_u32 s15, 8
    s_cbranch_scc1 p2_g0r23
    v_cmpx_gt_i16 vcc, 0, v57
    ds_read_b64 v[18:19], v18
    s_mov_b64 exec, -1
    v_cmpx_gt_i16 vcc, 0, v58
    ds_read_b64 v[20:21], v20
    s_mov_b64 exec, -1
    v_cmpx_gt_i16 vcc, 0, v59
    ds_read_b64 v[22:23], v22
    s_mov_b64 exec, -1
p2_g0r23:
    s_cmp_ge_u32 s10, 9
    s_cbranch_scc1 p2_nm0m0a
    v_lshrrev_b32 v84, 1, v112
    s_add_u32 s44, s20, s42
    buffer_load_dwordx2 v[84:85], v84, s[4:7], s44 offen
p2_nm0m0a:
    buffer_load_dwordx4 v[72:75], v112, s[4:7], s20 offen offset:0
    buffer_load_dwordx4 v[76:79], v112, s[4:7], s20 offen offset:1024
    buffer_load_dwordx4 v[80:83], v112, s[4:7], s20 offen offset:2048
    v_cmpx_gt_i16 vcc, 0, v60
    ds_read_b64 v[24:25], v24
    s_mov_b64 exec, -1
    v_cmpx_gt_i16 vcc, 0, v61
    ds_read_b64 v[26:27], v26
    s_mov_b64 exec, -1
    v_cmpx_gt_i16 vcc, 0, v62
    ds_read_b64 v[28:29], v28
    s_mov_b64 exec, -1
    v_cmpx_gt_i16 vcc, 0, v63
    ds_read_b64 v[30:31], v30
    s_mov_b64 exec, -1
    v_cmpx_gt_i16 vcc, 0, v64
    ds_read_b64 v[32:33], v32
    s_mov_b64 exec, -1
    v_cmpx_gt_i16 vcc, 0, v65
    ds_read_b64 v[34:35], v34
    s_mov_b64 exec, -1
    v_cmpx_gt_i16 vcc, 0, v66
    ds_read_b64 v[36:37], v36
    s_mov_b64 exec, -1
    v_cmpx_gt_i16 vcc, 0, v67
    ds_read_b64 v[38:39], v38
    s_mov_b64 exec, -1
    v_cmpx_gt_i16 vcc, 0, v68
    ds_read_b64 v[40:41], v40
    s_mov_b64 exec, -1
    v_cmpx_gt_i16 vcc, 0, v69
    ds_read_b64 v[42:43], v42
    s_mov_b64 exec, -1
    v_cmpx_gt_i16 vcc, 0, v70
    ds_read_b64 v[44:45], v44
    s_mov_b64 exec, -1
    v_cmpx_gt_i16 vcc, 0, v71
    ds_read_b64 v[46:47], v46
    s_mov_b64 exec, -1
    s_setprio 2
    s_waitcnt lgkmcnt(15)
    v_ashrrev_i32 v122, 5, v48
    v_lshlrev_b16 v123, 2, v48
    v_lshlrev_b32 v124, 16, v0
    v_bitop3_b32 v122, v122, v113, v113 bitop3:0x0c
    v_and_b32 v125, 0xffff0000, v0
    v_lshlrev_b32 v126, 16, v1
    v_mul_f32 v122, v114, v122
    v_and_b32 v127, 0xffff0000, v1
    v_add_u32 v123, v123, v123
    v_pk_fma_f32 v[124:125], v[124:125], v[122:123], s[34:35] op_sel_hi:[1,0,1]
    v_pk_fma_f32 v[126:127], v[126:127], v[122:123], s[34:35] op_sel_hi:[1,0,1]
    v_lshl_add_u32 v124, v125, 16, v124
    v_lshl_add_u32 v125, v127, 16, v126
    s_waitcnt lgkmcnt(15)
    v_bitop3_b32 v115, v115, v116, v117 bitop3:0xfe
    v_lshl_add_u64 v[124:125], v[124:125], 0, s[36:37]
    v_cmpx_le_u32 vcc, 0x1000000, v48
    ds_add_rtn_u64 v[116:117], v123, v[124:125] offset:54272
    s_mov_b64 exec, -1
    v_ashrrev_i32 v122, 5, v49
    v_lshlrev_b16 v123, 2, v49
    v_lshlrev_b32 v124, 16, v2
    v_bitop3_b32 v122, v122, v113, v113 bitop3:0x0c
    v_and_b32 v125, 0xffff0000, v2
    v_lshlrev_b32 v126, 16, v3
    v_mul_f32 v122, v114, v122
    v_and_b32 v127, 0xffff0000, v3
    v_add_u32 v123, v123, v123
    v_pk_fma_f32 v[124:125], v[124:125], v[122:123], s[34:35] op_sel_hi:[1,0,1]
    v_pk_fma_f32 v[126:127], v[126:127], v[122:123], s[34:35] op_sel_hi:[1,0,1]
    v_lshl_add_u32 v124, v125, 16, v124
    v_lshl_add_u32 v125, v127, 16, v126
    s_waitcnt lgkmcnt(15)
    v_bitop3_b32 v115, v115, v118, v119 bitop3:0xfe
    v_lshl_add_u64 v[124:125], v[124:125], 0, s[36:37]
    v_cmpx_le_u32 vcc, 0x1000000, v49
    ds_add_rtn_u64 v[118:119], v123, v[124:125] offset:54272
    s_mov_b64 exec, -1
    v_ashrrev_i32 v122, 5, v50
    v_lshlrev_b16 v123, 2, v50
    v_lshlrev_b32 v124, 16, v4
    v_bitop3_b32 v122, v122, v113, v113 bitop3:0x0c
    v_and_b32 v125, 0xffff0000, v4
    v_lshlrev_b32 v126, 16, v5
    v_mul_f32 v122, v114, v122
    v_and_b32 v127, 0xffff0000, v5
    v_add_u32 v123, v123, v123
    v_pk_fma_f32 v[124:125], v[124:125], v[122:123], s[34:35] op_sel_hi:[1,0,1]
    v_pk_fma_f32 v[126:127], v[126:127], v[122:123], s[34:35] op_sel_hi:[1,0,1]
    v_lshl_add_u32 v124, v125, 16, v124
    v_lshl_add_u32 v125, v127, 16, v126
    s_waitcnt lgkmcnt(15)
    v_bitop3_b32 v115, v115, v120, v121 bitop3:0xfe
    v_lshl_add_u64 v[124:125], v[124:125], 0, s[36:37]
    v_cmpx_le_u32 vcc, 0x1000000, v50
    ds_add_rtn_u64 v[120:121], v123, v[124:125] offset:54272
    s_mov_b64 exec, -1
    v_bfe_u32 v0, v102, 14, 4
    v_lshrrev_b32 v1, 18, v102
    v_and_b32 v102, 0x3fff, v102
    v_mad_u32_u24 v0, v0, s63, v1
    v_mad_u32_u24 v102, v0, s65, v102
    buffer_load_dwordx4 v[0:3], v102, s[68:71], 0 offen
    s_setprio 1
    s_waitcnt lgkmcnt(15)
    v_ashrrev_i32 v122, 5, v51
    v_lshlrev_b16 v123, 2, v51
    v_lshlrev_b32 v124, 16, v6
    v_bitop3_b32 v122, v122, v113, v113 bitop3:0x0c
    v_and_b32 v125, 0xffff0000, v6
    v_lshlrev_b32 v126, 16, v7
    v_mul_f32 v122, v114, v122
    v_and_b32 v127, 0xffff0000, v7
    v_add_u32 v123, v123, v123
    v_pk_fma_f32 v[124:125], v[124:125], v[122:123], s[34:35] op_sel_hi:[1,0,1]
    v_pk_fma_f32 v[126:127], v[126:127], v[122:123], s[34:35] op_sel_hi:[1,0,1]
    v_lshl_add_u32 v124, v125, 16, v124
    v_lshl_add_u32 v125, v127, 16, v126
    s_waitcnt lgkmcnt(2)
    v_bitop3_b32 v115, v115, v116, v117 bitop3:0xfe
    v_lshl_add_u64 v[124:125], v[124:125], 0, s[36:37]
    v_cmpx_le_u32 vcc, 0x1000000, v51
    ds_add_rtn_u64 v[116:117], v123, v[124:125] offset:54272
    s_mov_b64 exec, -1
    v_ashrrev_i32 v122, 5, v52
    v_lshlrev_b16 v123, 2, v52
    v_lshlrev_b32 v124, 16, v8
    v_bitop3_b32 v122, v122, v113, v113 bitop3:0x0c
    v_and_b32 v125, 0xffff0000, v8
    v_lshlrev_b32 v126, 16, v9
    v_mul_f32 v122, v114, v122
    v_and_b32 v127, 0xffff0000, v9
    v_add_u32 v123, v123, v123
    v_pk_fma_f32 v[124:125], v[124:125], v[122:123], s[34:35] op_sel_hi:[1,0,1]
    v_pk_fma_f32 v[126:127], v[126:127], v[122:123], s[34:35] op_sel_hi:[1,0,1]
    v_lshl_add_u32 v124, v125, 16, v124
    v_lshl_add_u32 v125, v127, 16, v126
    s_waitcnt lgkmcnt(2)
    v_bitop3_b32 v115, v115, v118, v119 bitop3:0xfe
    v_lshl_add_u64 v[124:125], v[124:125], 0, s[36:37]
    v_cmpx_le_u32 vcc, 0x1000000, v52
    ds_add_rtn_u64 v[118:119], v123, v[124:125] offset:54272
    s_mov_b64 exec, -1
    v_ashrrev_i32 v122, 5, v53
    v_lshlrev_b16 v123, 2, v53
    v_lshlrev_b32 v124, 16, v10
    v_bitop3_b32 v122, v122, v113, v113 bitop3:0x0c
    v_and_b32 v125, 0xffff0000, v10
    v_lshlrev_b32 v126, 16, v11
    v_mul_f32 v122, v114, v122
    v_and_b32 v127, 0xffff0000, v11
    v_add_u32 v123, v123, v123
    v_pk_fma_f32 v[124:125], v[124:125], v[122:123], s[34:35] op_sel_hi:[1,0,1]
    v_pk_fma_f32 v[126:127], v[126:127], v[122:123], s[34:35] op_sel_hi:[1,0,1]
    v_lshl_add_u32 v124, v125, 16, v124
    v_lshl_add_u32 v125, v127, 16, v126
    s_waitcnt lgkmcnt(2)
    v_bitop3_b32 v115, v115, v120, v121 bitop3:0xfe
    v_lshl_add_u64 v[124:125], v[124:125], 0, s[36:37]
    v_cmpx_le_u32 vcc, 0x1000000, v53
    ds_add_rtn_u64 v[120:121], v123, v[124:125] offset:54272
    s_mov_b64 exec, -1
    v_bfe_u32 v6, v103, 14, 4
    v_lshrrev_b32 v7, 18, v103
    v_and_b32 v103, 0x3fff, v103
    v_mad_u32_u24 v6, v6, s63, v7
    v_mad_u32_u24 v103, v6, s65, v103
    buffer_load_dwordx4 v[6:9], v103, s[68:71], 0 offen
    s_waitcnt lgkmcnt(6)
    s_barrier
    s_setprio 3
    s_waitcnt vmcnt(5)
    s_mov_b32 m0, s23
    v_mov_b32 v53, 0
    s_movk_i32 s44, 512
    v_sub_u32_sdwa v4, v111, v110 dst_sel:DWORD dst_unused:UNUSED_PAD src0_sel:WORD_0 src1_sel:WORD_0
    v_sub_u32_sdwa v5, v111, v110 dst_sel:DWORD dst_unused:UNUSED_PAD src0_sel:WORD_1 src1_sel:WORD_1
    v_med3_i32 v4, v4, 0, s44
    v_med3_i32 v5, v5, 0, s44
    v_add_u32 v48, v4, v5
    ds_write_addtid_b32 v53 offset:0
    ds_write_addtid_b32 v53 offset:256
    ds_write_addtid_b32 v53 offset:512
    ds_write_addtid_b32 v53 offset:768
    ds_write_addtid_b32 v53 offset:1024
    ds_write_addtid_b32 v53 offset:1280
    ds_write_addtid_b32 v53 offset:1536
    ds_write_addtid_b32 v53 offset:1792
    v_bfe_i32 v53, v112, 6, 1
    v_lshrrev_b32 v49, 6, v112
    v_bitop3_b32 v53, v53, 15, s10 bitop3:0x6a
    v_lshl_or_b32 v49, v49, 4, v53
    v_and_b32 v53, 0x30, v112
    v_lshl_or_b32 v53, v49, 6, v53
    v_lshlrev_b32 v53, 15, v53
    s_nop 1
    v_add_u32_dpp v48, v48, v48 row_shr:1 row_mask:0xf bank_mask:0xf bound_ctrl:0
    s_nop 1
    v_add_u32_dpp v48, v48, v48 row_shr:2 row_mask:0xf bank_mask:0xf bound_ctrl:0
    s_nop 1
    v_add_u32_dpp v48, v48, v48 row_shr:4 row_mask:0xf bank_mask:0xf bound_ctrl:0
    s_nop 1
    v_add_u32_dpp v48, v48, v48 row_shr:8 row_mask:0xf bank_mask:0xf bound_ctrl:0
    s_nop 1
    v_add_u32_dpp v48, v48, v48 row_bcast:15 row_mask:0xa bank_mask:0xf
    s_nop 1
    v_add_u32_dpp v48, v48, v48 row_bcast:31 row_mask:0xc bank_mask:0xf
    s_nop 1
    s_nop 0
    v_readlane_b32 s38, v48, 63
    v_sub_u32 v50, v48, v5
    v_sub_u32 v49, v50, v4
    v_writelane_b32 v5, 1, 63
    v_sub_u32 v10, 512, v49
    v_mad_u32_u16 v51, v110, 16, v53
    v_lshl_add_u32 v51, v10, 4, v51
    v_med3_i32 v10, v10, 0, v4
    v_lshl_add_u32 v49, v49, 2, s23
    v_sub_u32 v11, 512, v50
    v_mad_u32_u16 v52, v110, 16, v53 op_sel:[1,0,0,0]
    v_add_u32 v52, 262144, v52
    s_mov_b32 s44, 0x1fffc000
    v_writelane_b32 v52, s44, 63
    v_lshl_add_u32 v52, v11, 4, v52
    v_med3_i32 v11, v11, 0, v5
    v_lshl_add_u32 v50, v50, 2, s23
    v_lshl_add_u32 v48, v11, 16, v10
    v_add_u32 v110, v110, v48
    s_min_u32 s17, s38, 512
    s_add_u32 s17, s17, 63
    s_lshr_b32 s17, s17, 6
    v_cmpx_lt_i32 vcc, 0, v10
    ds_write_b32 v49, v51
    s_mov_b64 exec, -1
    v_cmpx_lt_i32 vcc, 0, v11
    ds_write_b32 v50, v52
    s_mov_b64 exec, -1
    s_cmp_lt_u32 s38, 512
    s_cbranch_scc1 p2_nomore0x
    v_cmp_lt_u32_sdwa s[44:45], v110, v111 src0_sel:WORD_0 src1_sel:WORD_0
    v_cmp_lt_u32_sdwa s[46:47], v110, v111 src0_sel:WORD_1 src1_sel:WORD_1
    s_nop 0
    s_or_b64 s[44:45], s[44:45], s[46:47]
    s_cbranch_scc0 p2_nomore0x
    v_mov_b32 v49, s19
    v_mov_b32 v50, 1
    ds_write_b32 v49, v50 offset:53760
p2_nomore0x:
    s_setprio 2
    s_waitcnt lgkmcnt(15)
    v_ashrrev_i32 v122, 5, v54
    v_lshlrev_b16 v123, 2, v54
    v_lshlrev_b32 v124, 16, v12
    v_bitop3_b32 v122, v122, v113, v113 bitop3:0x0c
    v_and_b32 v125, 0xffff0000, v12
    v_lshlrev_b32 v126, 16, v13
    v_mul_f32 v122, v114, v122
    v_and_b32 v127, 0xffff0000, v13
    v_add_u32 v123, v123, v123
    v_pk_fma_f32 v[124:125], v[124:125], v[122:123], s[34:35] op_sel_hi:[1,0,1]
    v_pk_fma_f32 v[126:127], v[126:127], v[122:123], s[34:35] op_sel_hi:[1,0,1]
    v_lshl_add_u32 v124, v125, 16, v124
    v_lshl_add_u32 v125, v127, 16, v126
    s_waitcnt lgkmcnt(12)
    v_bitop3_b32 v115, v115, v116, v117 bitop3:0xfe
    v_lshl_add_u64 v[124:125], v[124:125], 0, s[36:37]
    v_cmpx_le_u32 vcc, 0x1000000, v54
    ds_add_rtn_u64 v[116:117], v123, v[124:125] offset:54272
    s_mov_b64 exec, -1
    v_ashrrev_i32 v122, 5, v55
    v_lshlrev_b16 v123, 2, v55
    v_lshlrev_b32 v124, 16, v14
    v_bitop3_b32 v122, v122, v113, v113 bitop3:0x0c
    v_and_b32 v125, 0xffff0000, v14
    v_lshlrev_b32 v126, 16, v15
    v_mul_f32 v122, v114, v122
    v_and_b32 v127, 0xffff0000, v15
    v_add_u32 v123, v123, v123
    v_pk_fma_f32 v[124:125], v[124:125], v[122:123], s[34:35] op_sel_hi:[1,0,1]
    v_pk_fma_f32 v[126:127], v[126:127], v[122:123], s[34:35] op_sel_hi:[1,0,1]
    v_lshl_add_u32 v124, v125, 16, v124
    v_lshl_add_u32 v125, v127, 16, v126
    s_waitcnt lgkmcnt(12)
    v_bitop3_b32 v115, v115, v118, v119 bitop3:0xfe
    v_lshl_add_u64 v[124:125], v[124:125], 0, s[36:37]
    v_cmpx_le_u32 vcc, 0x1000000, v55
    ds_add_rtn_u64 v[118:119], v123, v[124:125] offset:54272
    s_mov_b64 exec, -1
    v_ashrrev_i32 v122, 5, v56
    v_lshlrev_b16 v123, 2, v56
    v_lshlrev_b32 v124, 16, v16
    v_bitop3_b32 v122, v122, v113, v113 bitop3:0x0c
    v_and_b32 v125, 0xffff0000, v16
    v_lshlrev_b32 v126, 16, v17
    v_mul_f32 v122, v114, v122
    v_and_b32 v127, 0xffff0000, v17
    v_add_u32 v123, v123, v123
    v_pk_fma_f32 v[124:125], v[124:125], v[122:123], s[34:35] op_sel_hi:[1,0,1]
    v_pk_fma_f32 v[126:127], v[126:127], v[122:123], s[34:35] op_sel_hi:[1,0,1]
    v_lshl_add_u32 v124, v125, 16, v124
    v_lshl_add_u32 v125, v127, 16, v126
    s_waitcnt lgkmcnt(12)
    v_bitop3_b32 v115, v115, v120, v121 bitop3:0xfe
    v_lshl_add_u64 v[124:125], v[124:125], 0, s[36:37]
    v_cmpx_le_u32 vcc, 0x1000000, v56
    ds_add_rtn_u64 v[120:121], v123, v[124:125] offset:54272
    s_mov_b64 exec, -1
    v_bfe_u32 v12, v104, 14, 4
    v_lshrrev_b32 v13, 18, v104
    v_and_b32 v104, 0x3fff, v104
    v_mad_u32_u24 v12, v12, s63, v13
    v_mad_u32_u24 v104, v12, s65, v104
    buffer_load_dwordx4 v[12:15], v104, s[68:71], 0 offen
    s_cmp_lt_u32 s15, 8
    s_cbranch_scc1 p2_na0a3
    s_waitcnt lgkmcnt(15)
    v_ashrrev_i32 v122, 5, v57
    v_lshlrev_b16 v123, 2, v57
    v_lshlrev_b32 v124, 16, v18
    v_bitop3_b32 v122, v122, v113, v113 bitop3:0x0c
    v_and_b32 v125, 0xffff0000, v18
    v_lshlrev_b32 v126, 16, v19
    v_mul_f32 v122, v114, v122
    v_and_b32 v127, 0xffff0000, v19
    v_add_u32 v123, v123, v123
    v_pk_fma_f32 v[124:125], v[124:125], v[122:123], s[34:35] op_sel_hi:[1,0,1]
    v_pk_fma_f32 v[126:127], v[126:127], v[122:123], s[34:35] op_sel_hi:[1,0,1]
    v_lshl_add_u32 v124, v125, 16, v124
    v_lshl_add_u32 v125, v127, 16, v126
    s_waitcnt lgkmcnt(2)
    v_bitop3_b32 v115, v115, v116, v117 bitop3:0xfe
    v_lshl_add_u64 v[124:125], v[124:125], 0, s[36:37]
    v_cmpx_le_u32 vcc, 0x1000000, v57
    ds_add_rtn_u64 v[116:117], v123, v[124:125] offset:54272
    s_mov_b64 exec, -1
    v_ashrrev_i32 v122, 5, v58
    v_lshlrev_b16 v123, 2, v58
    v_lshlrev_b32 v124, 16, v20
    v_bitop3_b32 v122, v122, v113, v113 bitop3:0x0c
    v_and_b32 v125, 0xffff0000, v20
    v_lshlrev_b32 v126, 16, v21
    v_mul_f32 v122, v114, v122
    v_and_b32 v127, 0xffff0000, v21
    v_add_u32 v123, v123, v123
    v_pk_fma_f32 v[124:125], v[124:125], v[122:123], s[34:35] op_sel_hi:[1,0,1]
    v_pk_fma_f32 v[126:127], v[126:127], v[122:123], s[34:35] op_sel_hi:[1,0,1]
    v_lshl_add_u32 v124, v125, 16, v124
    v_lshl_add_u32 v125, v127, 16, v126
    s_waitcnt lgkmcnt(2)
    v_bitop3_b32 v115, v115, v118, v119 bitop3:0xfe
    v_lshl_add_u64 v[124:125], v[124:125], 0, s[36:37]
    v_cmpx_le_u32 vcc, 0x1000000, v58
    ds_add_rtn_u64 v[118:119], v123, v[124:125] offset:54272
    s_mov_b64 exec, -1
    v_ashrrev_i32 v122, 5, v59
    v_lshlrev_b16 v123, 2, v59
    v_lshlrev_b32 v124, 16, v22
    v_bitop3_b32 v122, v122, v113, v113 bitop3:0x0c
    v_and_b32 v125, 0xffff0000, v22
    v_lshlrev_b32 v126, 16, v23
    v_mul_f32 v122, v114, v122
    v_and_b32 v127, 0xffff0000, v23
    v_add_u32 v123, v123, v123
    v_pk_fma_f32 v[124:125], v[124:125], v[122:123], s[34:35] op_sel_hi:[1,0,1]
    v_pk_fma_f32 v[126:127], v[126:127], v[122:123], s[34:35] op_sel_hi:[1,0,1]
    v_lshl_add_u32 v124, v125, 16, v124
    v_lshl_add_u32 v125, v127, 16, v126
    s_waitcnt lgkmcnt(2)
    v_bitop3_b32 v115, v115, v120, v121 bitop3:0xfe
    v_lshl_add_u64 v[124:125], v[124:125], 0, s[36:37]
    v_cmpx_le_u32 vcc, 0x1000000, v59
    ds_add_rtn_u64 v[120:121], v123, v[124:125] offset:54272
    s_mov_b64 exec, -1
p2_na0a3:
    v_bfe_u32 v18, v105, 14, 4
    v_lshrrev_b32 v19, 18, v105
    v_and_b32 v105, 0x3fff, v105
    v_mad_u32_u24 v18, v18, s63, v19
    v_mad_u32_u24 v105, v18, s65, v105
    buffer_load_dwordx4 v[18:21], v105, s[68:71], 0 offen
    s_mov_b32 m0, s23
    s_nop 0
    ds_read_addtid_b32 v102 offset:1024
    ds_read_addtid_b32 v103 offset:1280
    ds_read_addtid_b32 v104 offset:1536
    ds_read_addtid_b32 v105 offset:1792
    ds_read_addtid_b32 v106 offset:0
    ds_read_addtid_b32 v107 offset:256
    ds_read_addtid_b32 v108 offset:512
    ds_read_addtid_b32 v109 offset:768
    s_waitcnt vmcnt(4)
    s_mov_b32 m0, s24
    s_cmp_ge_u32 s10, 9
    s_cbranch_scc1 p2_st0s0
    ds_write_addtid_b32 v84 offset:49152
    ds_write_addtid_b32 v85 offset:49408
p2_st0s0:
    s_mov_b32 m0, s23
    s_add_u32 s20, s20, 53760
    ds_write_addtid_b32 v72 offset:0
    ds_write_addtid_b32 v73 offset:256
    ds_write_addtid_b32 v74 offset:512
    ds_write_addtid_b32 v75 offset:768
    ds_write_addtid_b32 v76 offset:1024
    ds_write_addtid_b32 v77 offset:1280
    ds_write_addtid_b32 v78 offset:1536
    ds_write_addtid_b32 v79 offset:1792
    ds_write_addtid_b32 v80 offset:2048
    ds_write_addtid_b32 v81 offset:2304
    ds_write_addtid_b32 v82 offset:2560
    ds_write_addtid_b32 v83 offset:2816
    s_setprio 1
    s_waitcnt lgkmcnt(15)
    v_ashrrev_i32 v122, 5, v60
    v_lshlrev_b16 v123, 2, v60
    v_lshlrev_b32 v124, 16, v24
    v_bitop3_b32 v122, v122, v113, v113 bitop3:0x0c
    v_and_b32 v125, 0xffff0000, v24
    v_lshlrev_b32 v126, 16, v25
    v_mul_f32 v122, v114, v122
    v_and_b32 v127, 0xffff0000, v25
    v_add_u32 v123, v123, v123
    v_pk_fma_f32 v[124:125], v[124:125], v[122:123], s[34:35] op_sel_hi:[1,0,1]
    v_pk_fma_f32 v[126:127], v[126:127], v[122:123], s[34:35] op_sel_hi:[1,0,1]
    v_lshl_add_u32 v124, v125, 16, v124
    v_lshl_add_u32 v125, v127, 16, v126
    s_waitcnt lgkmcnt(15)
    v_bitop3_b32 v115, v115, v116, v117 bitop3:0xfe
    v_lshl_add_u64 v[124:125], v[124:125], 0, s[36:37]
    v_cmpx_le_u32 vcc, 0x1000000, v60
    ds_add_rtn_u64 v[116:117], v123, v[124:125] offset:54272
    s_mov_b64 exec, -1
    v_ashrrev_i32 v122, 5, v61
    v_lshlrev_b16 v123, 2, v61
    v_lshlrev_b32 v124, 16, v26
    v_bitop3_b32 v122, v122, v113, v113 bitop3:0x0c
    v_and_b32 v125, 0xffff0000, v26
    v_lshlrev_b32 v126, 16, v27
    v_mul_f32 v122, v114, v122
    v_and_b32 v127, 0xffff0000, v27
    v_add_u32 v123, v123, v123
    v_pk_fma_f32 v[124:125], v[124:125], v[122:123], s[34:35] op_sel_hi:[1,0,1]
    v_pk_fma_f32 v[126:127], v[126:127], v[122:123], s[34:35] op_sel_hi:[1,0,1]
    v_lshl_add_u32 v124, v125, 16, v124
    v_lshl_add_u32 v125, v127, 16, v126
    s_waitcnt lgkmcnt(15)
    v_bitop3_b32 v115, v115, v118, v119 bitop3:0xfe
    v_lshl_add_u64 v[124:125], v[124:125], 0, s[36:37]
    v_cmpx_le_u32 vcc, 0x1000000, v61
    ds_add_rtn_u64 v[118:119], v123, v[124:125] offset:54272
    s_mov_b64 exec, -1
    v_ashrrev_i32 v122, 5, v62
    v_lshlrev_b16 v123, 2, v62
    v_lshlrev_b32 v124, 16, v28
    v_bitop3_b32 v122, v122, v113, v113 bitop3:0x0c
    v_and_b32 v125, 0xffff0000, v28
    v_lshlrev_b32 v126, 16, v29
    v_mul_f32 v122, v114, v122
    v_and_b32 v127, 0xffff0000, v29
    v_add_u32 v123, v123, v123
    v_pk_fma_f32 v[124:125], v[124:125], v[122:123], s[34:35] op_sel_hi:[1,0,1]
    v_pk_fma_f32 v[126:127], v[126:127], v[122:123], s[34:35] op_sel_hi:[1,0,1]
    v_lshl_add_u32 v124, v125, 16, v124
    v_lshl_add_u32 v125, v127, 16, v126
    s_waitcnt lgkmcnt(15)
    v_bitop3_b32 v115, v115, v120, v121 bitop3:0xfe
    v_lshl_add_u64 v[124:125], v[124:125], 0, s[36:37]
    v_cmpx_le_u32 vcc, 0x1000000, v62
    ds_add_rtn_u64 v[120:121], v123, v[124:125] offset:54272
    s_mov_b64 exec, -1
    s_waitcnt vmcnt(16)
    v_perm_b32 v60, v89, v86, s31
    v_perm_b32 v61, v89, v87, s32
    v_perm_b32 v62, v89, v88, s33
    v_lshlrev_b16 v28, 3, v88
    v_lshlrev_b16 v26, 3, v87
    v_lshlrev_b16 v24, 3, v86
    s_waitcnt lgkmcnt(15)
    s_nop 2
    s_nop 1
    v_max_u32_dpp v106, v106, v106 row_shr:1 row_mask:0xf bank_mask:0xf bound_ctrl:0
    v_max_u32_dpp v107, v107, v107 row_shr:1 row_mask:0xf bank_mask:0xf bound_ctrl:0
    s_nop 0
    v_max_u32_dpp v106, v106, v106 row_shr:2 row_mask:0xf bank_mask:0xf bound_ctrl:0
    v_max_u32_dpp v107, v107, v107 row_shr:2 row_mask:0xf bank_mask:0xf bound_ctrl:0
    s_nop 0
    v_max_u32_dpp v106, v106, v106 row_shr:4 row_mask:0xf bank_mask:0xf bound_ctrl:0
    v_max_u32_dpp v107, v107, v107 row_shr:4 row_mask:0xf bank_mask:0xf bound_ctrl:0
    s_nop 0
    v_max_u32_dpp v106, v106, v106 row_shr:8 row_mask:0xf bank_mask:0xf bound_ctrl:0
    v_max_u32_dpp v107, v107, v107 row_shr:8 row_mask:0xf bank_mask:0xf bound_ctrl:0
    s_nop 0
    v_max_u32_dpp v106, v106, v106 row_bcast:15 row_mask:0xa bank_mask:0xf
    v_max_u32_dpp v107, v107, v107 row_bcast:15 row_mask:0xa bank_mask:0xf
    s_nop 0
    v_max_u32_dpp v106, v106, v106 row_bcast:31 row_mask:0xc bank_mask:0xf
    v_max_u32_dpp v107, v107, v107 row_bcast:31 row_mask:0xc bank_mask:0xf
    s_nop 0
    s_nop 0
    v_readlane_b32 s41, v106, 63
    v_add_u32 v106, v106, v112
    v_add_u32 v106, 4294959104, v106
    v_max_u32 v107, s41, v107
    s_nop 0
    v_readlane_b32 s41, v107, 63
    v_add_u32 v107, v107, v112
    v_add_u32 v107, 4294960128, v107
    v_bfe_u32 v86, v106, 14, 4
    v_lshrrev_b32 v87, 18, v106
    v_and_b32 v106, 0x3fff, v106
    v_mad_u32_u24 v86, v86, s63, v87
    v_mad_u32_u24 v106, v86, s65, v106
    buffer_load_dwordx4 v[86:89], v106, s[68:71], 0 offen
    s_setprio 0
    s_waitcnt lgkmcnt(15)
    v_ashrrev_i32 v122, 5, v63
    v_lshlrev_b16 v123, 2, v63
    v_lshlrev_b32 v124, 16, v30
    v_bitop3_b32 v122, v122, v113, v113 bitop3:0x0c
    v_and_b32 v125, 0xffff0000, v30
    v_lshlrev_b32 v126, 16, v31
    v_mul_f32 v122, v114, v122
    v_and_b32 v127, 0xffff0000, v31
    v_add_u32 v123, v123, v123
    v_pk_fma_f32 v[124:125], v[124:125], v[122:123], s[34:35] op_sel_hi:[1,0,1]
    v_pk_fma_f32 v[126:127], v[126:127], v[122:123], s[34:35] op_sel_hi:[1,0,1]
    v_lshl_add_u32 v124, v125, 16, v124
    v_lshl_add_u32 v125, v127, 16, v126
    s_waitcnt lgkmcnt(2)
    v_bitop3_b32 v115, v115, v116, v117 bitop3:0xfe
    v_lshl_add_u64 v[124:125], v[124:125], 0, s[36:37]
    v_cmpx_le_u32 vcc, 0x1000000, v63
    ds_add_rtn_u64 v[116:117], v123, v[124:125] offset:54272
    s_mov_b64 exec, -1
    v_ashrrev_i32 v122, 5, v64
    v_lshlrev_b16 v123, 2, v64
    v_lshlrev_b32 v124, 16, v32
    v_bitop3_b32 v122, v122, v113, v113 bitop3:0x0c
    v_and_b32 v125, 0xffff0000, v32
    v_lshlrev_b32 v126, 16, v33
    v_mul_f32 v122, v114, v122
    v_and_b32 v127, 0xffff0000, v33
    v_add_u32 v123, v123, v123
    v_pk_fma_f32 v[124:125], v[124:125], v[122:123], s[34:35] op_sel_hi:[1,0,1]
    v_pk_fma_f32 v[126:127], v[126:127], v[122:123], s[34:35] op_sel_hi:[1,0,1]
    v_lshl_add_u32 v124, v125, 16, v124
    v_lshl_add_u32 v125, v127, 16, v126
    s_waitcnt lgkmcnt(2)
    v_bitop3_b32 v115, v115, v118, v119 bitop3:0xfe
    v_lshl_add_u64 v[124:125], v[124:125], 0, s[36:37]
    v_cmpx_le_u32 vcc, 0x1000000, v64
    ds_add_rtn_u64 v[118:119], v123, v[124:125] offset:54272
    s_mov_b64 exec, -1
    v_ashrrev_i32 v122, 5, v65
    v_lshlrev_b16 v123, 2, v65
    v_lshlrev_b32 v124, 16, v34
    v_bitop3_b32 v122, v122, v113, v113 bitop3:0x0c
    v_and_b32 v125, 0xffff0000, v34
    v_lshlrev_b32 v126, 16, v35
    v_mul_f32 v122, v114, v122
    v_and_b32 v127, 0xffff0000, v35
    v_add_u32 v123, v123, v123
    v_pk_fma_f32 v[124:125], v[124:125], v[122:123], s[34:35] op_sel_hi:[1,0,1]
    v_pk_fma_f32 v[126:127], v[126:127], v[122:123], s[34:35] op_sel_hi:[1,0,1]
    v_lshl_add_u32 v124, v125, 16, v124
    v_lshl_add_u32 v125, v127, 16, v126
    s_waitcnt lgkmcnt(2)
    v_bitop3_b32 v115, v115, v120, v121 bitop3:0xfe
    v_lshl_add_u64 v[124:125], v[124:125], 0, s[36:37]
    v_cmpx_le_u32 vcc, 0x1000000, v65
    ds_add_rtn_u64 v[120:121], v123, v[124:125] offset:54272
    s_mov_b64 exec, -1
    s_waitcnt vmcnt(13)
    v_perm_b32 v63, v93, v90, s31
    v_perm_b32 v64, v93, v91, s32
    v_perm_b32 v65, v93, v92, s33
    v_lshlrev_b16 v34, 3, v92
    v_lshlrev_b16 v32, 3, v91
    v_lshlrev_b16 v30, 3, v90
    s_waitcnt lgkmcnt(6)
    s_barrier
    s_setprio 3
    s_cmp_ge_u32 s10, 9
    s_cbranch_scc1 p2_nm0m1a
    v_lshrrev_b32 v84, 1, v112
    s_add_u32 s44, s20, s42
    buffer_load_dwordx2 v[84:85], v84, s[4:7], s44 offen
p2_nm0m1a:
    buffer_load_dwordx4 v[72:75], v112, s[4:7], s20 offen offset:0
    buffer_load_dwordx4 v[76:79], v112, s[4:7], s20 offen offset:1024
    buffer_load_dwordx4 v[80:83], v112, s[4:7], s20 offen offset:2048
    v_cmpx_ge_u16 vcc, 0x3fff, v60
    ds_read_b64 v[24:25], v24
    s_mov_b64 exec, -1
    v_cmpx_ge_u16 vcc, 0x3fff, v61
    ds_read_b64 v[26:27], v26
    s_mov_b64 exec, -1
    v_cmpx_ge_u16 vcc, 0x3fff, v62
    ds_read_b64 v[28:29], v28
    s_mov_b64 exec, -1
    v_cmpx_ge_u16 vcc, 0x3fff, v63
    ds_read_b64 v[30:31], v30
    s_mov_b64 exec, -1
    v_cmpx_ge_u16 vcc, 0x3fff, v64
    ds_read_b64 v[32:33], v32
    s_mov_b64 exec, -1
    v_cmpx_ge_u16 vcc, 0x3fff, v65
    ds_read_b64 v[34:35], v34
    s_mov_b64 exec, -1
    s_setprio 2
    s_waitcnt lgkmcnt(15)
    v_ashrrev_i32 v122, 5, v66
    v_lshlrev_b16 v123, 2, v66
    v_lshlrev_b32 v124, 16, v36
    v_bitop3_b32 v122, v122, v113, v113 bitop3:0x0c
    v_and_b32 v125, 0xffff0000, v36
    v_lshlrev_b32 v126, 16, v37
    v_mul_f32 v122, v114, v122
    v_and_b32 v127, 0xffff0000, v37
    v_add_u32 v123, v123, v123
    v_pk_fma_f32 v[124:125], v[124:125], v[122:123], s[34:35] op_sel_hi:[1,0,1]
    v_pk_fma_f32 v[126:127], v[126:127], v[122:123], s[34:35] op_sel_hi:[1,0,1]
    v_lshl_add_u32 v124, v125, 16, v124
    v_lshl_add_u32 v125, v127, 16, v126
    s_waitcnt lgkmcnt(8)
    v_bitop3_b32 v115, v115, v116, v117 bitop3:0xfe
    v_lshl_add_u64 v[124:125], v[124:125], 0, s[36:37]
    v_cmpx_le_u32 vcc, 0x1000000, v66
    ds_add_rtn_u64 v[116:117], v123, v[124:125] offset:54272
    s_mov_b64 exec, -1
    v_ashrrev_i32 v122, 5, v67
    v_lshlrev_b16 v123, 2, v67
    v_lshlrev_b32 v124, 16, v38
    v_bitop3_b32 v122, v122, v113, v113 bitop3:0x0c
    v_and_b32 v125, 0xffff0000, v38
    v_lshlrev_b32 v126, 16, v39
    v_mul_f32 v122, v114, v122
    v_and_b32 v127, 0xffff0000, v39
    v_add_u32 v123, v123, v123
    v_pk_fma_f32 v[124:125], v[124:125], v[122:123], s[34:35] op_sel_hi:[1,0,1]
    v_pk_fma_f32 v[126:127], v[126:127], v[122:123], s[34:35] op_sel_hi:[1,0,1]
    v_lshl_add_u32 v124, v125, 16, v124
    v_lshl_add_u32 v125, v127, 16, v126
    s_waitcnt lgkmcnt(8)
    v_bitop3_b32 v115, v115, v118, v119 bitop3:0xfe
    v_lshl_add_u64 v[124:125], v[124:125], 0, s[36:37]
    v_cmpx_le_u32 vcc, 0x1000000, v67
    ds_add_rtn_u64 v[118:119], v123, v[124:125] offset:54272
    s_mov_b64 exec, -1
    v_ashrrev_i32 v122, 5, v68
    v_lshlrev_b16 v123, 2, v68
    v_lshlrev_b32 v124, 16, v40
    v_bitop3_b32 v122, v122, v113, v113 bitop3:0x0c
    v_and_b32 v125, 0xffff0000, v40
    v_lshlrev_b32 v126, 16, v41
    v_mul_f32 v122, v114, v122
    v_and_b32 v127, 0xffff0000, v41
    v_add_u32 v123, v123, v123
    v_pk_fma_f32 v[124:125], v[124:125], v[122:123], s[34:35] op_sel_hi:[1,0,1]
    v_pk_fma_f32 v[126:127], v[126:127], v[122:123], s[34:35] op_sel_hi:[1,0,1]
    v_lshl_add_u32 v124, v125, 16, v124
    v_lshl_add_u32 v125, v127, 16, v126
    s_waitcnt lgkmcnt(8)
    v_bitop3_b32 v115, v115, v120, v121 bitop3:0xfe
    v_lshl_add_u64 v[124:125], v[124:125], 0, s[36:37]
    v_cmpx_le_u32 vcc, 0x1000000, v68
    ds_add_rtn_u64 v[120:121], v123, v[124:125] offset:54272
    s_mov_b64 exec, -1
    s_waitcnt vmcnt(15)
    v_perm_b32 v66, v97, v94, s31
    v_perm_b32 v67, v97, v95, s32
    v_perm_b32 v68, v97, v96, s33
    v_lshlrev_b16 v40, 3, v96
    v_lshlrev_b16 v38, 3, v95
    v_lshlrev_b16 v36, 3, v94
    v_cmpx_ge_u16 vcc, 0x3fff, v66
    ds_read_b64 v[36:37], v36
    s_mov_b64 exec, -1
    v_cmpx_ge_u16 vcc, 0x3fff, v67
    ds_read_b64 v[38:39], v38
    s_mov_b64 exec, -1
    v_cmpx_ge_u16 vcc, 0x3fff, v68
    ds_read_b64 v[40:41], v40
    s_mov_b64 exec, -1
    v_bfe_u32 v90, v107, 14, 4
    v_lshrrev_b32 v91, 18, v107
    v_and_b32 v107, 0x3fff, v107
    v_mad_u32_u24 v90, v90, s63, v91
    v_mad_u32_u24 v107, v90, s65, v107
    buffer_load_dwordx4 v[90:93], v107, s[68:71], 0 offen
    s_setprio 1
    s_waitcnt lgkmcnt(15)
    v_ashrrev_i32 v122, 5, v69
    v_lshlrev_b16 v123, 2, v69
    v_lshlrev_b32 v124, 16, v42
    v_bitop3_b32 v122, v122, v113, v113 bitop3:0x0c
    v_and_b32 v125, 0xffff0000, v42
    v_lshlrev_b32 v126, 16, v43
    v_mul_f32 v122, v114, v122
    v_and_b32 v127, 0xffff0000, v43
    v_add_u32 v123, v123, v123
    v_pk_fma_f32 v[124:125], v[124:125], v[122:123], s[34:35] op_sel_hi:[1,0,1]
    v_pk_fma_f32 v[126:127], v[126:127], v[122:123], s[34:35] op_sel_hi:[1,0,1]
    v_lshl_add_u32 v124, v125, 16, v124
    v_lshl_add_u32 v125, v127, 16, v126
    s_waitcnt lgkmcnt(5)
    v_bitop3_b32 v115, v115, v116, v117 bitop3:0xfe
    v_lshl_add_u64 v[124:125], v[124:125], 0, s[36:37]
    v_cmpx_le_u32 vcc, 0x1000000, v69
    ds_add_rtn_u64 v[116:117], v123, v[124:125] offset:54272
    s_mov_b64 exec, -1
    v_ashrrev_i32 v122, 5, v70
    v_lshlrev_b16 v123, 2, v70
    v_lshlrev_b32 v124, 16, v44
    v_bitop3_b32 v122, v122, v113, v113 bitop3:0x0c
    v_and_b32 v125, 0xffff0000, v44
    v_lshlrev_b32 v126, 16, v45
    v_mul_f32 v122, v114, v122
    v_and_b32 v127, 0xffff0000, v45
    v_add_u32 v123, v123, v123
    v_pk_fma_f32 v[124:125], v[124:125], v[122:123], s[34:35] op_sel_hi:[1,0,1]
    v_pk_fma_f32 v[126:127], v[126:127], v[122:123], s[34:35] op_sel_hi:[1,0,1]
    v_lshl_add_u32 v124, v125, 16, v124
    v_lshl_add_u32 v125, v127, 16, v126
    s_waitcnt lgkmcnt(5)
    v_bitop3_b32 v115, v115, v118, v119 bitop3:0xfe
    v_lshl_add_u64 v[124:125], v[124:125], 0, s[36:37]
    v_cmpx_le_u32 vcc, 0x1000000, v70
    ds_add_rtn_u64 v[118:119], v123, v[124:125] offset:54272
    s_mov_b64 exec, -1
    v_ashrrev_i32 v122, 5, v71
    v_lshlrev_b16 v123, 2, v71
    v_lshlrev_b32 v124, 16, v46
    v_bitop3_b32 v122, v122, v113, v113 bitop3:0x0c
    v_and_b32 v125, 0xffff0000, v46
    v_lshlrev_b32 v126, 16, v47
    v_mul_f32 v122, v114, v122
    v_and_b32 v127, 0xffff0000, v47
    v_add_u32 v123, v123, v123
    v_pk_fma_f32 v[124:125], v[124:125], v[122:123], s[34:35] op_sel_hi:[1,0,1]
    v_pk_fma_f32 v[126:127], v[126:127], v[122:123], s[34:35] op_sel_hi:[1,0,1]
    v_lshl_add_u32 v124, v125, 16, v124
    v_lshl_add_u32 v125, v127, 16, v126
    s_waitcnt lgkmcnt(5)
    v_bitop3_b32 v115, v115, v120, v121 bitop3:0xfe
    v_lshl_add_u64 v[124:125], v[124:125], 0, s[36:37]
    v_cmpx_le_u32 vcc, 0x1000000, v71
    ds_add_rtn_u64 v[120:121], v123, v[124:125] offset:54272
    s_mov_b64 exec, -1
    s_waitcnt vmcnt(12)
    v_perm_b32 v69, v101, v98, s31
    v_perm_b32 v70, v101, v99, s32
    v_perm_b32 v71, v101, v100, s33
    v_lshlrev_b16 v46, 3, v100
    v_lshlrev_b16 v44, 3, v99
    v_lshlrev_b16 v42, 3, v98
    v_cmpx_ge_u16 vcc, 0x3fff, v69
    ds_read_b64 v[42:43], v42
    s_mov_b64 exec, -1
    v_cmpx_ge_u16 vcc, 0x3fff, v70
    ds_read_b64 v[44:45], v44
    s_mov_b64 exec, -1
    v_cmpx_ge_u16 vcc, 0x3fff, v71
    ds_read_b64 v[46:47], v46
    s_mov_b64 exec, -1
    s_waitcnt lgkmcnt(15)
    s_nop 2
    s_nop 1
    v_max_u32_dpp v108, v108, v108 row_shr:1 row_mask:0xf bank_mask:0xf bound_ctrl:0
    v_max_u32_dpp v109, v109, v109 row_shr:1 row_mask:0xf bank_mask:0xf bound_ctrl:0
    s_nop 0
    v_max_u32_dpp v108, v108, v108 row_shr:2 row_mask:0xf bank_mask:0xf bound_ctrl:0
    v_max_u32_dpp v109, v109, v109 row_shr:2 row_mask:0xf bank_mask:0xf bound_ctrl:0
    s_nop 0
    v_max_u32_dpp v108, v108, v108 row_shr:4 row_mask:0xf bank_mask:0xf bound_ctrl:0
    v_max_u32_dpp v109, v109, v109 row_shr:4 row_mask:0xf bank_mask:0xf bound_ctrl:0
    s_nop 0
    v_max_u32_dpp v108, v108, v108 row_shr:8 row_mask:0xf bank_mask:0xf bound_ctrl:0
    v_max_u32_dpp v109, v109, v109 row_shr:8 row_mask:0xf bank_mask:0xf bound_ctrl:0
    s_nop 0
    v_max_u32_dpp v108, v108, v108 row_bcast:15 row_mask:0xa bank_mask:0xf
    v_max_u32_dpp v109, v109, v109 row_bcast:15 row_mask:0xa bank_mask:0xf
    s_nop 0
    v_max_u32_dpp v108, v108, v108 row_bcast:31 row_mask:0xc bank_mask:0xf
    v_max_u32_dpp v109, v109, v109 row_bcast:31 row_mask:0xc bank_mask:0xf
    s_nop 0
    s_nop 0
    v_max_u32 v108, s41, v108
    s_nop 0
    v_readlane_b32 s41, v108, 63
    v_add_u32 v108, v108, v112
    v_add_u32 v108, 4294961152, v108
    v_max_u32 v109, s41, v109
    s_nop 0
    v_readlane_b32 s41, v109, 63
    v_add_u32 v109, v109, v112
    v_add_u32 v109, 4294962176, v109
    v_bfe_u32 v94, v108, 14, 4
    v_lshrrev_b32 v95, 18, v108
    v_and_b32 v108, 0x3fff, v108
    v_mad_u32_u24 v94, v94, s63, v95
    v_mad_u32_u24 v108, v94, s65, v108
    buffer_load_dwordx4 v[94:97], v108, s[68:71], 0 offen
    s_setprio 0
    s_waitcnt vmcnt(9)
    v_perm_b32 v48, v3, v0, s31
    v_perm_b32 v49, v3, v1, s32
    v_perm_b32 v50, v3, v2, s33
    v_lshlrev_b16 v4, 3, v2
    v_lshlrev_b16 v2, 3, v1
    v_lshlrev_b16 v0, 3, v0
    v_cmpx_ge_u16 vcc, 0x3fff, v48
    ds_read_b64 v[0:1], v0
    s_mov_b64 exec, -1
    v_cmpx_ge_u16 vcc, 0x3fff, v49
    ds_read_b64 v[2:3], v2
    s_mov_b64 exec, -1
    v_cmpx_ge_u16 vcc, 0x3fff, v50
    ds_read_b64 v[4:5], v4
    s_mov_b64 exec, -1
    s_waitcnt vmcnt(8)
    v_perm_b32 v51, v9, v6, s31
    v_perm_b32 v52, v9, v7, s32
    v_perm_b32 v53, v9, v8, s33
    v_lshlrev_b16 v10, 3, v8
    v_lshlrev_b16 v8, 3, v7
    v_lshlrev_b16 v6, 3, v6
    v_cmpx_ge_u16 vcc, 0x3fff, v51
    ds_read_b64 v[6:7], v6
    s_mov_b64 exec, -1
    v_cmpx_ge_u16 vcc, 0x3fff, v52
    ds_read_b64 v[8:9], v8
    s_mov_b64 exec, -1
    v_cmpx_ge_u16 vcc, 0x3fff, v53
    ds_read_b64 v[10:11], v10
    s_mov_b64 exec, -1
    s_waitcnt vmcnt(7)
    v_perm_b32 v54, v15, v12, s31
    v_perm_b32 v55, v15, v13, s32
    v_perm_b32 v56, v15, v14, s33
    v_lshlrev_b16 v16, 3, v14
    v_lshlrev_b16 v14, 3, v13
    v_lshlrev_b16 v12, 3, v12
    v_cmpx_ge_u16 vcc, 0x3fff, v54
    ds_read_b64 v[12:13], v12
    s_mov_b64 exec, -1
    v_cmpx_ge_u16 vcc, 0x3fff, v55
    ds_read_b64 v[14:15], v14
    s_mov_b64 exec, -1
    v_cmpx_ge_u16 vcc, 0x3fff, v56
    ds_read_b64 v[16:17], v16
    s_mov_b64 exec, -1
    s_waitcnt vmcnt(6)
    v_perm_b32 v57, v21, v18, s31
    v_perm_b32 v58, v21, v19, s32
    v_perm_b32 v59, v21, v20, s33
    v_lshlrev_b16 v22, 3, v20
    v_lshlrev_b16 v20, 3, v19
    v_lshlrev_b16 v18, 3, v18
    s_cmp_lt_u32 s16, 8
    s_cbranch_scc1 p2_g0r03
    v_cmpx_ge_u16 vcc, 0x3fff, v57
    ds_read_b64 v[18:19], v18
    s_mov_b64 exec, -1
    v_cmpx_ge_u16 vcc, 0x3fff, v58
    ds_read_b64 v[20:21], v20
    s_mov_b64 exec, -1
    v_cmpx_ge_u16 vcc, 0x3fff, v59
    ds_read_b64 v[22:23], v22
    s_mov_b64 exec, -1
p2_g0r03:
    s_waitcnt lgkmcnt(0)
    s_barrier
    s_waitcnt lgkmcnt(15)
    s_branch p2_tail
p2_drain0:
    v_cmpx_gt_i16 vcc, 0, v48
    ds_read_b64 v[0:1], v0
    s_mov_b64 exec, -1
    v_cmpx_gt_i16 vcc, 0, v49
    ds_read_b64 v[2:3], v2
    s_mov_b64 exec, -1
    v_cmpx_gt_i16 vcc, 0, v50
    ds_read_b64 v[4:5], v4
    s_mov_b64 exec, -1
    v_cmpx_gt_i16 vcc, 0, v51
    ds_read_b64 v[6:7], v6
    s_mov_b64 exec, -1
    v_cmpx_gt_i16 vcc, 0, v52
    ds_read_b64 v[8:9], v8
    s_mov_b64 exec, -1
    v_cmpx_gt_i16 vcc, 0, v53
    ds_read_b64 v[10:11], v10
    s_mov_b64 exec, -1
    v_cmpx_gt_i16 vcc, 0, v54
    ds_read_b64 v[12:13], v12
    s_mov_b64 exec, -1
    v_cmpx_gt_i16 vcc, 0, v55
    ds_read_b64 v[14:15], v14
    s_mov_b64 exec, -1
    v_cmpx_gt_i16 vcc, 0, v56
    ds_read_b64 v[16:17], v16
    s_mov_b64 exec, -1
    s_cmp_lt_u32 s15, 8
    s_cbranch_scc1 p2_gd0
    v_cmpx_gt_i16 vcc, 0, v57
    ds_read_b64 v[18:19], v18
    s_mov_b64 exec, -1
    v_cmpx_gt_i16 vcc, 0, v58
    ds_read_b64 v[20:21], v20
    s_mov_b64 exec, -1
    v_cmpx_gt_i16 vcc, 0, v59
    ds_read_b64 v[22:23], v22
    s_mov_b64 exec, -1
p2_gd0:
    v_cmpx_gt_i16 vcc, 0, v60
    ds_read_b64 v[24:25], v24
    s_mov_b64 exec, -1
    v_cmpx_gt_i16 vcc, 0, v61
    ds_read_b64 v[26:27], v26
    s_mov_b64 exec, -1
    v_cmpx_gt_i16 vcc, 0, v62
    ds_read_b64 v[28:29], v28
    s_mov_b64 exec, -1
    v_cmpx_gt_i16 vcc, 0, v63
    ds_read_b64 v[30:31], v30
    s_mov_b64 exec, -1
    v_cmpx_gt_i16 vcc, 0, v64
    ds_read_b64 v[32:33], v32
    s_mov_b64 exec, -1
    v_cmpx_gt_i16 vcc, 0, v65
    ds_read_b64 v[34:35], v34
    s_mov_b64 exec, -1
    v_cmpx_gt_i16 vcc, 0, v66
    ds_read_b64 v[36:37], v36
    s_mov_b64 exec, -1
    v_cmpx_gt_i16 vcc, 0, v67
    ds_read_b64 v[38:39], v38
    s_mov_b64 exec, -1
    v_cmpx_gt_i16 vcc, 0, v68
    ds_read_b64 v[40:41], v40
    s_mov_b64 exec, -1
    v_cmpx_gt_i16 vcc, 0, v69
    ds_read_b64 v[42:43], v42
    s_mov_b64 exec, -1
    v_cmpx_gt_i16 vcc, 0, v70
    ds_read_b64 v[44:45], v44
    s_mov_b64 exec, -1
    v_cmpx_gt_i16 vcc, 0, v71
    ds_read_b64 v[46:47], v46
    s_mov_b64 exec, -1
    s_waitcnt lgkmcnt(15)
    v_ashrrev_i32 v122, 5, v48
    v_lshlrev_b16 v123, 2, v48
    v_lshlrev_b32 v124, 16, v0
    v_bitop3_b32 v122, v122, v113, v113 bitop3:0x0c
    v_and_b32 v125, 0xffff0000, v0
    v_lshlrev_b32 v126, 16, v1
    v_mul_f32 v122, v114, v122
    v_and_b32 v127, 0xffff0000, v1
    v_add_u32 v123, v123, v123
    v_pk_fma_f32 v[124:125], v[124:125], v[122:123], s[34:35] op_sel_hi:[1,0,1]
    v_pk_fma_f32 v[126:127], v[126:127], v[122:123], s[34:35] op_sel_hi:[1,0,1]
    v_lshl_add_u32 v124, v125, 16, v124
    v_lshl_add_u32 v125, v127, 16, v126
    s_waitcnt lgkmcnt(15)
    v_bitop3_b32 v115, v115, v116, v117 bitop3:0xfe
    v_lshl_add_u64 v[124:125], v[124:125], 0, s[36:37]
    v_cmpx_le_u32 vcc, 0x1000000, v48
    ds_add_rtn_u64 v[116:117], v123, v[124:125] offset:54272
    s_mov_b64 exec, -1
    v_ashrrev_i32 v122, 5, v49
    v_lshlrev_b16 v123, 2, v49
    v_lshlrev_b32 v124, 16, v2
    v_bitop3_b32 v122, v122, v113, v113 bitop3:0x0c
    v_and_b32 v125, 0xffff0000, v2
    v_lshlrev_b32 v126, 16, v3
    v_mul_f32 v122, v114, v122
    v_and_b32 v127, 0xffff0000, v3
    v_add_u32 v123, v123, v123
    v_pk_fma_f32 v[124:125], v[124:125], v[122:123], s[34:35] op_sel_hi:[1,0,1]
    v_pk_fma_f32 v[126:127], v[126:127], v[122:123], s[34:35] op_sel_hi:[1,0,1]
    v_lshl_add_u32 v124, v125, 16, v124
    v_lshl_add_u32 v125, v127, 16, v126
    s_waitcnt lgkmcnt(15)
    v_bitop3_b32 v115, v115, v118, v119 bitop3:0xfe
    v_lshl_add_u64 v[124:125], v[124:125], 0, s[36:37]
    v_cmpx_le_u32 vcc, 0x1000000, v49
    ds_add_rtn_u64 v[118:119], v123, v[124:125] offset:54272
    s_mov_b64 exec, -1
    v_ashrrev_i32 v122, 5, v50
    v_lshlrev_b16 v123, 2, v50
    v_lshlrev_b32 v124, 16, v4
    v_bitop3_b32 v122, v122, v113, v113 bitop3:0x0c
    v_and_b32 v125, 0xffff0000, v4
    v_lshlrev_b32 v126, 16, v5
    v_mul_f32 v122, v114, v122
    v_and_b32 v127, 0xffff0000, v5
    v_add_u32 v123, v123, v123
    v_pk_fma_f32 v[124:125], v[124:125], v[122:123], s[34:35] op_sel_hi:[1,0,1]
    v_pk_fma_f32 v[126:127], v[126:127], v[122:123], s[34:35] op_sel_hi:[1,0,1]
    v_lshl_add_u32 v124, v125, 16, v124
    v_lshl_add_u32 v125, v127, 16, v126
    s_waitcnt lgkmcnt(15)
    v_bitop3_b32 v115, v115, v120, v121 bitop3:0xfe
    v_lshl_add_u64 v[124:125], v[124:125], 0, s[36:37]
    v_cmpx_le_u32 vcc, 0x1000000, v50
    ds_add_rtn_u64 v[120:121], v123, v[124:125] offset:54272
    s_mov_b64 exec, -1
    s_waitcnt lgkmcnt(15)
    v_ashrrev_i32 v122, 5, v51
    v_lshlrev_b16 v123, 2, v51
    v_lshlrev_b32 v124, 16, v6
    v_bitop3_b32 v122, v122, v113, v113 bitop3:0x0c
    v_and_b32 v125, 0xffff0000, v6
    v_lshlrev_b32 v126, 16, v7
    v_mul_f32 v122, v114, v122
    v_and_b32 v127, 0xffff0000, v7
    v_add_u32 v123, v123, v123
    v_pk_fma_f32 v[124:125], v[124:125], v[122:123], s[34:35] op_sel_hi:[1,0,1]
    v_pk_fma_f32 v[126:127], v[126:127], v[122:123], s[34:35] op_sel_hi:[1,0,1]
    v_lshl_add_u32 v124, v125, 16, v124
    v_lshl_add_u32 v125, v127, 16, v126
    s_waitcnt lgkmcnt(2)
    v_bitop3_b32 v115, v115, v116, v117 bitop3:0xfe
    v_lshl_add_u64 v[124:125], v[124:125], 0, s[36:37]
    v_cmpx_le_u32 vcc, 0x1000000, v51
    ds_add_rtn_u64 v[116:117], v123, v[124:125] offset:54272
    s_mov_b64 exec, -1
    v_ashrrev_i32 v122, 5, v52
    v_lshlrev_b16 v123, 2, v52
    v_lshlrev_b32 v124, 16, v8
    v_bitop3_b32 v122, v122, v113, v113 bitop3:0x0c
    v_and_b32 v125, 0xffff0000, v8
    v_lshlrev_b32 v126, 16, v9
    v_mul_f32 v122, v114, v122
    v_and_b32 v127, 0xffff0000, v9
    v_add_u32 v123, v123, v123
    v_pk_fma_f32 v[124:125], v[124:125], v[122:123], s[34:35] op_sel_hi:[1,0,1]
    v_pk_fma_f32 v[126:127], v[126:127], v[122:123], s[34:35] op_sel_hi:[1,0,1]
    v_lshl_add_u32 v124, v125, 16, v124
    v_lshl_add_u32 v125, v127, 16, v126
    s_waitcnt lgkmcnt(2)
    v_bitop3_b32 v115, v115, v118, v119 bitop3:0xfe
    v_lshl_add_u64 v[124:125], v[124:125], 0, s[36:37]
    v_cmpx_le_u32 vcc, 0x1000000, v52
    ds_add_rtn_u64 v[118:119], v123, v[124:125] offset:54272
    s_mov_b64 exec, -1
    v_ashrrev_i32 v122, 5, v53
    v_lshlrev_b16 v123, 2, v53
    v_lshlrev_b32 v124, 16, v10
    v_bitop3_b32 v122, v122, v113, v113 bitop3:0x0c
    v_and_b32 v125, 0xffff0000, v10
    v_lshlrev_b32 v126, 16, v11
    v_mul_f32 v122, v114, v122
    v_and_b32 v127, 0xffff0000, v11
    v_add_u32 v123, v123, v123
    v_pk_fma_f32 v[124:125], v[124:125], v[122:123], s[34:35] op_sel_hi:[1,0,1]
    v_pk_fma_f32 v[126:127], v[126:127], v[122:123], s[34:35] op_sel_hi:[1,0,1]
    v_lshl_add_u32 v124, v125, 16, v124
    v_lshl_add_u32 v125, v127, 16, v126
    s_waitcnt lgkmcnt(2)
    v_bitop3_b32 v115, v115, v120, v121 bitop3:0xfe
    v_lshl_add_u64 v[124:125], v[124:125], 0, s[36:37]
    v_cmpx_le_u32 vcc, 0x1000000, v53
    ds_add_rtn_u64 v[120:121], v123, v[124:125] offset:54272
    s_mov_b64 exec, -1
    s_waitcnt lgkmcnt(15)
    v_ashrrev_i32 v122, 5, v54
    v_lshlrev_b16 v123, 2, v54
    v_lshlrev_b32 v124, 16, v12
    v_bitop3_b32 v122, v122, v113, v113 bitop3:0x0c
    v_and_b32 v125, 0xffff0000, v12
    v_lshlrev_b32 v126, 16, v13
    v_mul_f32 v122, v114, v122
    v_and_b32 v127, 0xffff0000, v13
    v_add_u32 v123, v123, v123
    v_pk_fma_f32 v[124:125], v[124:125], v[122:123], s[34:35] op_sel_hi:[1,0,1]
    v_pk_fma_f32 v[126:127], v[126:127], v[122:123], s[34:35] op_sel_hi:[1,0,1]
    v_lshl_add_u32 v124, v125, 16, v124
    v_lshl_add_u32 v125, v127, 16, v126
    s_waitcnt lgkmcnt(2)
    v_bitop3_b32 v115, v115, v116, v117 bitop3:0xfe
    v_lshl_add_u64 v[124:125], v[124:125], 0, s[36:37]
    v_cmpx_le_u32 vcc, 0x1000000, v54
    ds_add_rtn_u64 v[116:117], v123, v[124:125] offset:54272
    s_mov_b64 exec, -1
    v_ashrrev_i32 v122, 5, v55
    v_lshlrev_b16 v123, 2, v55
    v_lshlrev_b32 v124, 16, v14
    v_bitop3_b32 v122, v122, v113, v113 bitop3:0x0c
    v_and_b32 v125, 0xffff0000, v14
    v_lshlrev_b32 v126, 16, v15
    v_mul_f32 v122, v114, v122
    v_and_b32 v127, 0xffff0000, v15
    v_add_u32 v123, v123, v123
    v_pk_fma_f32 v[124:125], v[124:125], v[122:123], s[34:35] op_sel_hi:[1,0,1]
    v_pk_fma_f32 v[126:127], v[126:127], v[122:123], s[34:35] op_sel_hi:[1,0,1]
    v_lshl_add_u32 v124, v125, 16, v124
    v_lshl_add_u32 v125, v127, 16, v126
    s_waitcnt lgkmcnt(2)
    v_bitop3_b32 v115, v115, v118, v119 bitop3:0xfe
    v_lshl_add_u64 v[124:125], v[124:125], 0, s[36:37]
    v_cmpx_le_u32 vcc, 0x1000000, v55
    ds_add_rtn_u64 v[118:119], v123, v[124:125] offset:54272
    s_mov_b64 exec, -1
    v_ashrrev_i32 v122, 5, v56
    v_lshlrev_b16 v123, 2, v56
    v_lshlrev_b32 v124, 16, v16
    v_bitop3_b32 v122, v122, v113, v113 bitop3:0x0c
    v_and_b32 v125, 0xffff0000, v16
    v_lshlrev_b32 v126, 16, v17
    v_mul_f32 v122, v114, v122
    v_and_b32 v127, 0xffff0000, v17
    v_add_u32 v123, v123, v123
    v_pk_fma_f32 v[124:125], v[124:125], v[122:123], s[34:35] op_sel_hi:[1,0,1]
    v_pk_fma_f32 v[126:127], v[126:127], v[122:123], s[34:35] op_sel_hi:[1,0,1]
    v_lshl_add_u32 v124, v125, 16, v124
    v_lshl_add_u32 v125, v127, 16, v126
    s_waitcnt lgkmcnt(2)
    v_bitop3_b32 v115, v115, v120, v121 bitop3:0xfe
    v_lshl_add_u64 v[124:125], v[124:125], 0, s[36:37]
    v_cmpx_le_u32 vcc, 0x1000000, v56
    ds_add_rtn_u64 v[120:121], v123, v[124:125] offset:54272
    s_mov_b64 exec, -1
    s_cmp_lt_u32 s15, 8
    s_cbranch_scc1 p2_nad0
    s_waitcnt lgkmcnt(15)
    v_ashrrev_i32 v122, 5, v57
    v_lshlrev_b16 v123, 2, v57
    v_lshlrev_b32 v124, 16, v18
    v_bitop3_b32 v122, v122, v113, v113 bitop3:0x0c
    v_and_b32 v125, 0xffff0000, v18
    v_lshlrev_b32 v126, 16, v19
    v_mul_f32 v122, v114, v122
    v_and_b32 v127, 0xffff0000, v19
    v_add_u32 v123, v123, v123
    v_pk_fma_f32 v[124:125], v[124:125], v[122:123], s[34:35] op_sel_hi:[1,0,1]
    v_pk_fma_f32 v[126:127], v[126:127], v[122:123], s[34:35] op_sel_hi:[1,0,1]
    v_lshl_add_u32 v124, v125, 16, v124
    v_lshl_add_u32 v125, v127, 16, v126
    s_waitcnt lgkmcnt(2)
    v_bitop3_b32 v115, v115, v116, v117 bitop3:0xfe
    v_lshl_add_u64 v[124:125], v[124:125], 0, s[36:37]
    v_cmpx_le_u32 vcc, 0x1000000, v57
    ds_add_rtn_u64 v[116:117], v123, v[124:125] offset:54272
    s_mov_b64 exec, -1
    v_ashrrev_i32 v122, 5, v58
    v_lshlrev_b16 v123, 2, v58
    v_lshlrev_b32 v124, 16, v20
    v_bitop3_b32 v122, v122, v113, v113 bitop3:0x0c
    v_and_b32 v125, 0xffff0000, v20
    v_lshlrev_b32 v126, 16, v21
    v_mul_f32 v122, v114, v122
    v_and_b32 v127, 0xffff0000, v21
    v_add_u32 v123, v123, v123
    v_pk_fma_f32 v[124:125], v[124:125], v[122:123], s[34:35] op_sel_hi:[1,0,1]
    v_pk_fma_f32 v[126:127], v[126:127], v[122:123], s[34:35] op_sel_hi:[1,0,1]
    v_lshl_add_u32 v124, v125, 16, v124
    v_lshl_add_u32 v125, v127, 16, v126
    s_waitcnt lgkmcnt(2)
    v_bitop3_b32 v115, v115, v118, v119 bitop3:0xfe
    v_lshl_add_u64 v[124:125], v[124:125], 0, s[36:37]
    v_cmpx_le_u32 vcc, 0x1000000, v58
    ds_add_rtn_u64 v[118:119], v123, v[124:125] offset:54272
    s_mov_b64 exec, -1
    v_ashrrev_i32 v122, 5, v59
    v_lshlrev_b16 v123, 2, v59
    v_lshlrev_b32 v124, 16, v22
    v_bitop3_b32 v122, v122, v113, v113 bitop3:0x0c
    v_and_b32 v125, 0xffff0000, v22
    v_lshlrev_b32 v126, 16, v23
    v_mul_f32 v122, v114, v122
    v_and_b32 v127, 0xffff0000, v23
    v_add_u32 v123, v123, v123
    v_pk_fma_f32 v[124:125], v[124:125], v[122:123], s[34:35] op_sel_hi:[1,0,1]
    v_pk_fma_f32 v[126:127], v[126:127], v[122:123], s[34:35] op_sel_hi:[1,0,1]
    v_lshl_add_u32 v124, v125, 16, v124
    v_lshl_add_u32 v125, v127, 16, v126
    s_waitcnt lgkmcnt(2)
    v_bitop3_b32 v115, v115, v120, v121 bitop3:0xfe
    v_lshl_add_u64 v[124:125], v[124:125], 0, s[36:37]
    v_cmpx_le_u32 vcc, 0x1000000, v59
    ds_add_rtn_u64 v[120:121], v123, v[124:125] offset:54272
    s_mov_b64 exec, -1
p2_nad0:
    s_waitcnt lgkmcnt(15)
    v_ashrrev_i32 v122, 5, v60
    v_lshlrev_b16 v123, 2, v60
    v_lshlrev_b32 v124, 16, v24
    v_bitop3_b32 v122, v122, v113, v113 bitop3:0x0c
    v_and_b32 v125, 0xffff0000, v24
    v_lshlrev_b32 v126, 16, v25
    v_mul_f32 v122, v114, v122
    v_and_b32 v127, 0xffff0000, v25
    v_add_u32 v123, v123, v123
    v_pk_fma_f32 v[124:125], v[124:125], v[122:123], s[34:35] op_sel_hi:[1,0,1]
    v_pk_fma_f32 v[126:127], v[126:127], v[122:123], s[34:35] op_sel_hi:[1,0,1]
    v_lshl_add_u32 v124, v125, 16, v124
    v_lshl_add_u32 v125, v127, 16, v126
    s_waitcnt lgkmcnt(2)
    v_bitop3_b32 v115, v115, v116, v117 bitop3:0xfe
    v_lshl_add_u64 v[124:125], v[124:125], 0, s[36:37]
    v_cmpx_le_u32 vcc, 0x1000000, v60
    ds_add_rtn_u64 v[116:117], v123, v[124:125] offset:54272
    s_mov_b64 exec, -1
    v_ashrrev_i32 v122, 5, v61
    v_lshlrev_b16 v123, 2, v61
    v_lshlrev_b32 v124, 16, v26
    v_bitop3_b32 v122, v122, v113, v113 bitop3:0x0c
    v_and_b32 v125, 0xffff0000, v26
    v_lshlrev_b32 v126, 16, v27
    v_mul_f32 v122, v114, v122
    v_and_b32 v127, 0xffff0000, v27
    v_add_u32 v123, v123, v123
    v_pk_fma_f32 v[124:125], v[124:125], v[122:123], s[34:35] op_sel_hi:[1,0,1]
    v_pk_fma_f32 v[126:127], v[126:127], v[122:123], s[34:35] op_sel_hi:[1,0,1]
    v_lshl_add_u32 v124, v125, 16, v124
    v_lshl_add_u32 v125, v127, 16, v126
    s_waitcnt lgkmcnt(2)
    v_bitop3_b32 v115, v115, v118, v119 bitop3:0xfe
    v_lshl_add_u64 v[124:125], v[124:125], 0, s[36:37]
    v_cmpx_le_u32 vcc, 0x1000000, v61
    ds_add_rtn_u64 v[118:119], v123, v[124:125] offset:54272
    s_mov_b64 exec, -1
    v_ashrrev_i32 v122, 5, v62
    v_lshlrev_b16 v123, 2, v62
    v_lshlrev_b32 v124, 16, v28
    v_bitop3_b32 v122, v122, v113, v113 bitop3:0x0c
    v_and_b32 v125, 0xffff0000, v28
    v_lshlrev_b32 v126, 16, v29
    v_mul_f32 v122, v114, v122
    v_and_b32 v127, 0xffff0000, v29
    v_add_u32 v123, v123, v123
    v_pk_fma_f32 v[124:125], v[124:125], v[122:123], s[34:35] op_sel_hi:[1,0,1]
    v_pk_fma_f32 v[126:127], v[126:127], v[122:123], s[34:35] op_sel_hi:[1,0,1]
    v_lshl_add_u32 v124, v125, 16, v124
    v_lshl_add_u32 v125, v127, 16, v126
    s_waitcnt lgkmcnt(2)
    v_bitop3_b32 v115, v115, v120, v121 bitop3:0xfe
    v_lshl_add_u64 v[124:125], v[124:125], 0, s[36:37]
    v_cmpx_le_u32 vcc, 0x1000000, v62
    ds_add_rtn_u64 v[120:121], v123, v[124:125] offset:54272
    s_mov_b64 exec, -1
    s_waitcnt lgkmcnt(15)
    v_ashrrev_i32 v122, 5, v63
    v_lshlrev_b16 v123, 2, v63
    v_lshlrev_b32 v124, 16, v30
    v_bitop3_b32 v122, v122, v113, v113 bitop3:0x0c
    v_and_b32 v125, 0xffff0000, v30
    v_lshlrev_b32 v126, 16, v31
    v_mul_f32 v122, v114, v122
    v_and_b32 v127, 0xffff0000, v31
    v_add_u32 v123, v123, v123
    v_pk_fma_f32 v[124:125], v[124:125], v[122:123], s[34:35] op_sel_hi:[1,0,1]
    v_pk_fma_f32 v[126:127], v[126:127], v[122:123], s[34:35] op_sel_hi:[1,0,1]
    v_lshl_add_u32 v124, v125, 16, v124
    v_lshl_add_u32 v125, v127, 16, v126
    s_waitcnt lgkmcnt(2)
    v_bitop3_b32 v115, v115, v116, v117 bitop3:0xfe
    v_lshl_add_u64 v[124:125], v[124:125], 0, s[36:37]
    v_cmpx_le_u32 vcc, 0x1000000, v63
    ds_add_rtn_u64 v[116:117], v123, v[124:125] offset:54272
    s_mov_b64 exec, -1
    v_ashrrev_i32 v122, 5, v64
    v_lshlrev_b16 v123, 2, v64
    v_lshlrev_b32 v124, 16, v32
    v_bitop3_b32 v122, v122, v113, v113 bitop3:0x0c
    v_and_b32 v125, 0xffff0000, v32
    v_lshlrev_b32 v126, 16, v33
    v_mul_f32 v122, v114, v122
    v_and_b32 v127, 0xffff0000, v33
    v_add_u32 v123, v123, v123
    v_pk_fma_f32 v[124:125], v[124:125], v[122:123], s[34:35] op_sel_hi:[1,0,1]
    v_pk_fma_f32 v[126:127], v[126:127], v[122:123], s[34:35] op_sel_hi:[1,0,1]
    v_lshl_add_u32 v124, v125, 16, v124
    v_lshl_add_u32 v125, v127, 16, v126
    s_waitcnt lgkmcnt(2)
    v_bitop3_b32 v115, v115, v118, v119 bitop3:0xfe
    v_lshl_add_u64 v[124:125], v[124:125], 0, s[36:37]
    v_cmpx_le_u32 vcc, 0x1000000, v64
    ds_add_rtn_u64 v[118:119], v123, v[124:125] offset:54272
    s_mov_b64 exec, -1
    v_ashrrev_i32 v122, 5, v65
    v_lshlrev_b16 v123, 2, v65
    v_lshlrev_b32 v124, 16, v34
    v_bitop3_b32 v122, v122, v113, v113 bitop3:0x0c
    v_and_b32 v125, 0xffff0000, v34
    v_lshlrev_b32 v126, 16, v35
    v_mul_f32 v122, v114, v122
    v_and_b32 v127, 0xffff0000, v35
    v_add_u32 v123, v123, v123
    v_pk_fma_f32 v[124:125], v[124:125], v[122:123], s[34:35] op_sel_hi:[1,0,1]
    v_pk_fma_f32 v[126:127], v[126:127], v[122:123], s[34:35] op_sel_hi:[1,0,1]
    v_lshl_add_u32 v124, v125, 16, v124
    v_lshl_add_u32 v125, v127, 16, v126
    s_waitcnt lgkmcnt(2)
    v_bitop3_b32 v115, v115, v120, v121 bitop3:0xfe
    v_lshl_add_u64 v[124:125], v[124:125], 0, s[36:37]
    v_cmpx_le_u32 vcc, 0x1000000, v65
    ds_add_rtn_u64 v[120:121], v123, v[124:125] offset:54272
    s_mov_b64 exec, -1
    s_waitcnt lgkmcnt(15)
    v_ashrrev_i32 v122, 5, v66
    v_lshlrev_b16 v123, 2, v66
    v_lshlrev_b32 v124, 16, v36
    v_bitop3_b32 v122, v122, v113, v113 bitop3:0x0c
    v_and_b32 v125, 0xffff0000, v36
    v_lshlrev_b32 v126, 16, v37
    v_mul_f32 v122, v114, v122
    v_and_b32 v127, 0xffff0000, v37
    v_add_u32 v123, v123, v123
    v_pk_fma_f32 v[124:125], v[124:125], v[122:123], s[34:35] op_sel_hi:[1,0,1]
    v_pk_fma_f32 v[126:127], v[126:127], v[122:123], s[34:35] op_sel_hi:[1,0,1]
    v_lshl_add_u32 v124, v125, 16, v124
    v_lshl_add_u32 v125, v127, 16, v126
    s_waitcnt lgkmcnt(2)
    v_bitop3_b32 v115, v115, v116, v117 bitop3:0xfe
    v_lshl_add_u64 v[124:125], v[124:125], 0, s[36:37]
    v_cmpx_le_u32 vcc, 0x1000000, v66
    ds_add_rtn_u64 v[116:117], v123, v[124:125] offset:54272
    s_mov_b64 exec, -1
    v_ashrrev_i32 v122, 5, v67
    v_lshlrev_b16 v123, 2, v67
    v_lshlrev_b32 v124, 16, v38
    v_bitop3_b32 v122, v122, v113, v113 bitop3:0x0c
    v_and_b32 v125, 0xffff0000, v38
    v_lshlrev_b32 v126, 16, v39
    v_mul_f32 v122, v114, v122
    v_and_b32 v127, 0xffff0000, v39
    v_add_u32 v123, v123, v123
    v_pk_fma_f32 v[124:125], v[124:125], v[122:123], s[34:35] op_sel_hi:[1,0,1]
    v_pk_fma_f32 v[126:127], v[126:127], v[122:123], s[34:35] op_sel_hi:[1,0,1]
    v_lshl_add_u32 v124, v125, 16, v124
    v_lshl_add_u32 v125, v127, 16, v126
    s_waitcnt lgkmcnt(2)
    v_bitop3_b32 v115, v115, v118, v119 bitop3:0xfe
    v_lshl_add_u64 v[124:125], v[124:125], 0, s[36:37]
    v_cmpx_le_u32 vcc, 0x1000000, v67
    ds_add_rtn_u64 v[118:119], v123, v[124:125] offset:54272
    s_mov_b64 exec, -1
    v_ashrrev_i32 v122, 5, v68
    v_lshlrev_b16 v123, 2, v68
    v_lshlrev_b32 v124, 16, v40
    v_bitop3_b32 v122, v122, v113, v113 bitop3:0x0c
    v_and_b32 v125, 0xffff0000, v40
    v_lshlrev_b32 v126, 16, v41
    v_mul_f32 v122, v114, v122
    v_and_b32 v127, 0xffff0000, v41
    v_add_u32 v123, v123, v123
    v_pk_fma_f32 v[124:125], v[124:125], v[122:123], s[34:35] op_sel_hi:[1,0,1]
    v_pk_fma_f32 v[126:127], v[126:127], v[122:123], s[34:35] op_sel_hi:[1,0,1]
    v_lshl_add_u32 v124, v125, 16, v124
    v_lshl_add_u32 v125, v127, 16, v126
    s_waitcnt lgkmcnt(2)
    v_bitop3_b32 v115, v115, v120, v121 bitop3:0xfe
    v_lshl_add_u64 v[124:125], v[124:125], 0, s[36:37]
    v_cmpx_le_u32 vcc, 0x1000000, v68
    ds_add_rtn_u64 v[120:121], v123, v[124:125] offset:54272
    s_mov_b64 exec, -1
    s_waitcnt lgkmcnt(15)
    v_ashrrev_i32 v122, 5, v69
    v_lshlrev_b16 v123, 2, v69
    v_lshlrev_b32 v124, 16, v42
    v_bitop3_b32 v122, v122, v113, v113 bitop3:0x0c
    v_and_b32 v125, 0xffff0000, v42
    v_lshlrev_b32 v126, 16, v43
    v_mul_f32 v122, v114, v122
    v_and_b32 v127, 0xffff0000, v43
    v_add_u32 v123, v123, v123
    v_pk_fma_f32 v[124:125], v[124:125], v[122:123], s[34:35] op_sel_hi:[1,0,1]
    v_pk_fma_f32 v[126:127], v[126:127], v[122:123], s[34:35] op_sel_hi:[1,0,1]
    v_lshl_add_u32 v124, v125, 16, v124
    v_lshl_add_u32 v125, v127, 16, v126
    s_waitcnt lgkmcnt(2)
    v_bitop3_b32 v115, v115, v116, v117 bitop3:0xfe
    v_lshl_add_u64 v[124:125], v[124:125], 0, s[36:37]
    v_cmpx_le_u32 vcc, 0x1000000, v69
    ds_add_rtn_u64 v[116:117], v123, v[124:125] offset:54272
    s_mov_b64 exec, -1
    v_ashrrev_i32 v122, 5, v70
    v_lshlrev_b16 v123, 2, v70
    v_lshlrev_b32 v124, 16, v44
    v_bitop3_b32 v122, v122, v113, v113 bitop3:0x0c
    v_and_b32 v125, 0xffff0000, v44
    v_lshlrev_b32 v126, 16, v45
    v_mul_f32 v122, v114, v122
    v_and_b32 v127, 0xffff0000, v45
    v_add_u32 v123, v123, v123
    v_pk_fma_f32 v[124:125], v[124:125], v[122:123], s[34:35] op_sel_hi:[1,0,1]
    v_pk_fma_f32 v[126:127], v[126:127], v[122:123], s[34:35] op_sel_hi:[1,0,1]
    v_lshl_add_u32 v124, v125, 16, v124
    v_lshl_add_u32 v125, v127, 16, v126
    s_waitcnt lgkmcnt(2)
    v_bitop3_b32 v115, v115, v118, v119 bitop3:0xfe
    v_lshl_add_u64 v[124:125], v[124:125], 0, s[36:37]
    v_cmpx_le_u32 vcc, 0x1000000, v70
    ds_add_rtn_u64 v[118:119], v123, v[124:125] offset:54272
    s_mov_b64 exec, -1
    v_ashrrev_i32 v122, 5, v71
    v_lshlrev_b16 v123, 2, v71
    v_lshlrev_b32 v124, 16, v46
    v_bitop3_b32 v122, v122, v113, v113 bitop3:0x0c
    v_and_b32 v125, 0xffff0000, v46
    v_lshlrev_b32 v126, 16, v47
    v_mul_f32 v122, v114, v122
    v_and_b32 v127, 0xffff0000, v47
    v_add_u32 v123, v123, v123
    v_pk_fma_f32 v[124:125], v[124:125], v[122:123], s[34:35] op_sel_hi:[1,0,1]
    v_pk_fma_f32 v[126:127], v[126:127], v[122:123], s[34:35] op_sel_hi:[1,0,1]
    v_lshl_add_u32 v124, v125, 16, v124
    v_lshl_add_u32 v125, v127, 16, v126
    s_waitcnt lgkmcnt(2)
    v_bitop3_b32 v115, v115, v120, v121 bitop3:0xfe
    v_lshl_add_u64 v[124:125], v[124:125], 0, s[36:37]
    v_cmpx_le_u32 vcc, 0x1000000, v71
    ds_add_rtn_u64 v[120:121], v123, v[124:125] offset:54272
    s_mov_b64 exec, -1
    s_branch p2_fin
p2_topf:
    s_cmp_eq_u32 s60, 10
    s_cbranch_scc1 p2_drain1
    s_setprio 3
    v_cmpx_gt_i16 vcc, 0, v48
    ds_read_b64 v[0:1], v0
    s_mov_b64 exec, -1
    v_cmpx_gt_i16 vcc, 0, v49
    ds_read_b64 v[2:3], v2
    s_mov_b64 exec, -1
    v_cmpx_gt_i16 vcc, 0, v50
    ds_read_b64 v[4:5], v4
    s_mov_b64 exec, -1
    v_cmpx_gt_i16 vcc, 0, v51
    ds_read_b64 v[6:7], v6
    s_mov_b64 exec, -1
    v_cmpx_gt_i16 vcc, 0, v52
    ds_read_b64 v[8:9], v8
    s_mov_b64 exec, -1
    v_cmpx_gt_i16 vcc, 0, v53
    ds_read_b64 v[10:11], v10
    s_mov_b64 exec, -1
    v_cmpx_gt_i16 vcc, 0, v54
    ds_read_b64 v[12:13], v12
    s_mov_b64 exec, -1
    v_cmpx_gt_i16 vcc, 0, v55
    ds_read_b64 v[14:15], v14
    s_mov_b64 exec, -1
    v_cmpx_gt_i16 vcc, 0, v56
    ds_read_b64 v[16:17], v16
    s_mov_b64 exec, -1
    s_cmp_lt_u32 s15, 8
    s_cbranch_scc1 p2_g1r23
    v_cmpx_gt_i16 vcc, 0, v57
    ds_read_b64 v[18:19], v18
    s_mov_b64 exec, -1
    v_cmpx_gt_i16 vcc, 0, v58
    ds_read_b64 v[20:21], v20
    s_mov_b64 exec, -1
    v_cmpx_gt_i16 vcc, 0, v59
    ds_read_b64 v[22:23], v22
    s_mov_b64 exec, -1
p2_g1r23:
    s_cmp_ge_u32 s10, 9
    s_cbranch_scc1 p2_nm1m0a
    v_lshrrev_b32 v84, 1, v112
    s_add_u32 s44, s20, s42
    buffer_load_dwordx2 v[84:85], v84, s[4:7], s44 offen
p2_nm1m0a:
    buffer_load_dwordx4 v[72:75], v112, s[4:7], s20 offen offset:0
    buffer_load_dwordx4 v[76:79], v112, s[4:7], s20 offen offset:1024
    buffer_load_dwordx4 v[80:83], v112, s[4:7], s20 offen offset:2048
    v_cmpx_gt_i16 vcc, 0, v60
    ds_read_b64 v[24:25], v24
    s_mov_b64 exec, -1
    v_cmpx_gt_i16 vcc, 0, v61
    ds_read_b64 v[26:27], v26
    s_mov_b64 exec, -1
    v_cmpx_gt_i16 vcc, 0, v62
    ds_read_b64 v[28:29], v28
    s_mov_b64 exec, -1
    v_cmpx_gt_i16 vcc, 0, v63
    ds_read_b64 v[30:31], v30
    s_mov_b64 exec, -1
    v_cmpx_gt_i16 vcc, 0, v64
    ds_read_b64 v[32:33], v32
    s_mov_b64 exec, -1
    v_cmpx_gt_i16 vcc, 0, v65
    ds_read_b64 v[34:35], v34
    s_mov_b64 exec, -1
    v_cmpx_gt_i16 vcc, 0, v66
    ds_read_b64 v[36:37], v36
    s_mov_b64 exec, -1
    v_cmpx_gt_i16 vcc, 0, v67
    ds_read_b64 v[38:39], v38
    s_mov_b64 exec, -1
    v_cmpx_gt_i16 vcc, 0, v68
    ds_read_b64 v[40:41], v40
    s_mov_b64 exec, -1
    v_cmpx_gt_i16 vcc, 0, v69
    ds_read_b64 v[42:43], v42
    s_mov_b64 exec, -1
    v_cmpx_gt_i16 vcc, 0, v70
    ds_read_b64 v[44:45], v44
    s_mov_b64 exec, -1
    v_cmpx_gt_i16 vcc, 0, v71
    ds_read_b64 v[46:47], v46
    s_mov_b64 exec, -1
    s_setprio 2
    s_waitcnt lgkmcnt(15)
    v_ashrrev_i32 v122, 5, v48
    v_lshlrev_b16 v123, 2, v48
    v_cndmask_b32 v126, v0, v1, s[66:67]
    v_bitop3_b32 v122, v122, v113, v113 bitop3:0x0c
    v_lshlrev_b32 v124, 16, v126
    v_mul_f32 v122, v114, v122
    v_and_b32 v125, 0xffff0000, v126
    v_add_u32 v123, v123, v123
    v_mul_f32 v124, v122, v124
    v_mul_f32 v125, v122, v125
    v_cmpx_le_u32 vcc, 0x1000000, v48
    ds_add_f32 v123, v124 offset:54272
    ds_add_f32 v123, v125 offset:54276
    s_mov_b64 exec, -1
    v_ashrrev_i32 v122, 5, v49
    v_lshlrev_b16 v123, 2, v49
    v_cndmask_b32 v126, v2, v3, s[66:67]
    v_bitop3_b32 v122, v122, v113, v113 bitop3:0x0c
    v_lshlrev_b32 v124, 16, v126
    v_mul_f32 v122, v114, v122
    v_and_b32 v125, 0xffff0000, v126
    v_add_u32 v123, v123, v123
    v_mul_f32 v124, v122, v124
    v_mul_f32 v125, v122, v125
    v_cmpx_le_u32 vcc, 0x1000000, v49
    ds_add_f32 v123, v124 offset:54272
    ds_add_f32 v123, v125 offset:54276
    s_mov_b64 exec, -1
    v_ashrrev_i32 v122, 5, v50
    v_lshlrev_b16 v123, 2, v50
    v_cndmask_b32 v126, v4, v5, s[66:67]
    v_bitop3_b32 v122, v122, v113, v113 bitop3:0x0c
    v_lshlrev_b32 v124, 16, v126
    v_mul_f32 v122, v114, v122
    v_and_b32 v125, 0xffff0000, v126
    v_add_u32 v123, v123, v123
    v_mul_f32 v124, v122, v124
    v_mul_f32 v125, v122, v125
    v_cmpx_le_u32 vcc, 0x1000000, v50
    ds_add_f32 v123, v124 offset:54272
    ds_add_f32 v123, v125 offset:54276
    s_mov_b64 exec, -1
    v_bfe_u32 v0, v102, 14, 4
    v_lshrrev_b32 v1, 18, v102
    v_and_b32 v102, 0x3fff, v102
    v_mad_u32_u24 v0, v0, s63, v1
    v_mad_u32_u24 v102, v0, s65, v102
    buffer_load_dwordx4 v[0:3], v102, s[68:71], 0 offen
    s_setprio 1
    s_waitcnt lgkmcnt(15)
    v_ashrrev_i32 v122, 5, v51
    v_lshlrev_b16 v123, 2, v51
    v_cndmask_b32 v126, v6, v7, s[66:67]
    v_bitop3_b32 v122, v122, v113, v113 bitop3:0x0c
    v_lshlrev_b32 v124, 16, v126
    v_mul_f32 v122, v114, v122
    v_and_b32 v125, 0xffff0000, v126
    v_add_u32 v123, v123, v123
    v_mul_f32 v124, v122, v124
    v_mul_f32 v125, v122, v125
    v_cmpx_le_u32 vcc, 0x1000000, v51
    ds_add_f32 v123, v124 offset:54272
    ds_add_f32 v123, v125 offset:54276
    s_mov_b64 exec, -1
    v_ashrrev_i32 v122, 5, v52
    v_lshlrev_b16 v123, 2, v52
    v_cndmask_b32 v126, v8, v9, s[66:67]
    v_bitop3_b32 v122, v122, v113, v113 bitop3:0x0c
    v_lshlrev_b32 v124, 16, v126
    v_mul_f32 v122, v114, v122
    v_and_b32 v125, 0xffff0000, v126
    v_add_u32 v123, v123, v123
    v_mul_f32 v124, v122, v124
    v_mul_f32 v125, v122, v125
    v_cmpx_le_u32 vcc, 0x1000000, v52
    ds_add_f32 v123, v124 offset:54272
    ds_add_f32 v123, v125 offset:54276
    s_mov_b64 exec, -1
    v_ashrrev_i32 v122, 5, v53
    v_lshlrev_b16 v123, 2, v53
    v_cndmask_b32 v126, v10, v11, s[66:67]
    v_bitop3_b32 v122, v122, v113, v113 bitop3:0x0c
    v_lshlrev_b32 v124, 16, v126
    v_mul_f32 v122, v114, v122
    v_and_b32 v125, 0xffff0000, v126
    v_add_u32 v123, v123, v123
    v_mul_f32 v124, v122, v124
    v_mul_f32 v125, v122, v125
    v_cmpx_le_u32 vcc, 0x1000000, v53
    ds_add_f32 v123, v124 offset:54272
    ds_add_f32 v123, v125 offset:54276
    s_mov_b64 exec, -1
    v_bfe_u32 v6, v103, 14, 4
    v_lshrrev_b32 v7, 18, v103
    v_and_b32 v103, 0x3fff, v103
    v_mad_u32_u24 v6, v6, s63, v7
    v_mad_u32_u24 v103, v6, s65, v103
    buffer_load_dwordx4 v[6:9], v103, s[68:71], 0 offen
    s_waitcnt lgkmcnt(12)
    s_barrier
    s_setprio 3
    s_waitcnt vmcnt(5)
    s_mov_b32 m0, s23
    v_mov_b32 v53, 0
    s_movk_i32 s44, 512
    v_sub_u32_sdwa v4, v111, v110 dst_sel:DWORD dst_unused:UNUSED_PAD src0_sel:WORD_0 src1_sel:WORD_0
    v_sub_u32_sdwa v5, v111, v110 dst_sel:DWORD dst_unused:UNUSED_PAD src0_sel:WORD_1 src1_sel:WORD_1
    v_med3_i32 v4, v4, 0, s44
    v_med3_i32 v5, v5, 0, s44
    v_add_u32 v48, v4, v5
    ds_write_addtid_b32 v53 offset:0
    ds_write_addtid_b32 v53 offset:256
    ds_write_addtid_b32 v53 offset:512
    ds_write_addtid_b32 v53 offset:768
    ds_write_addtid_b32 v53 offset:1024
    ds_write_addtid_b32 v53 offset:1280
    ds_write_addtid_b32 v53 offset:1536
    ds_write_addtid_b32 v53 offset:1792
    v_bfe_i32 v53, v112, 6, 1
    v_lshrrev_b32 v49, 6, v112
    v_bitop3_b32 v53, v53, 15, s10 bitop3:0x6a
    v_lshl_or_b32 v49, v49, 4, v53
    v_and_b32 v53, 0x30, v112
    v_lshl_or_b32 v53, v49, 6, v53
    v_lshlrev_b32 v53, 15, v53
    s_nop 1
    v_add_u32_dpp v48, v48, v48 row_shr:1 row_mask:0xf bank_mask:0xf bound_ctrl:0
    s_nop 1
    v_add_u32_dpp v48, v48, v48 row_shr:2 row_mask:0xf bank_mask:0xf bound_ctrl:0
    s_nop 1
    v_add_u32_dpp v48, v48, v48 row_shr:4 row_mask:0xf bank_mask:0xf bound_ctrl:0
    s_nop 1
    v_add_u32_dpp v48, v48, v48 row_shr:8 row_mask:0xf bank_mask:0xf bound_ctrl:0
    s_nop 1
    v_add_u32_dpp v48, v48, v48 row_bcast:15 row_mask:0xa bank_mask:0xf
    s_nop 1
    v_add_u32_dpp v48, v48, v48 row_bcast:31 row_mask:0xc bank_mask:0xf
    s_nop 1
    s_nop 0
    v_readlane_b32 s38, v48, 63
    v_sub_u32 v50, v48, v5
    v_sub_u32 v49, v50, v4
    v_writelane_b32 v5, 1, 63
    v_sub_u32 v10, 512, v49
    v_mad_u32_u16 v51, v110, 16, v53
    v_lshl_add_u32 v51, v10, 4, v51
    v_med3_i32 v10, v10, 0, v4
    v_lshl_add_u32 v49, v49, 2, s23
    v_sub_u32 v11, 512, v50
    v_mad_u32_u16 v52, v110, 16, v53 op_sel:[1,0,0,0]
    v_add_u32 v52, 262144, v52
    s_mov_b32 s44, 0x1fffc000
    v_writelane_b32 v52, s44, 63
    v_lshl_add_u32 v52, v11, 4, v52
    v_med3_i32 v11, v11, 0, v5
    v_lshl_add_u32 v50, v50, 2, s23
    v_lshl_add_u32 v48, v11, 16, v10
    v_add_u32 v110, v110, v48
    s_min_u32 s17, s38, 512
    s_add_u32 s17, s17, 63
    s_lshr_b32 s17, s17, 6
    v_cmpx_lt_i32 vcc, 0, v10
    ds_write_b32 v49, v51
    s_mov_b64 exec, -1
    v_cmpx_lt_i32 vcc, 0, v11
    ds_write_b32 v50, v52
    s_mov_b64 exec, -1
    s_cmp_lt_u32 s38, 512
    s_cbranch_scc1 p2_nomore1x
    v_cmp_lt_u32_sdwa s[44:45], v110, v111 src0_sel:WORD_0 src1_sel:WORD_0
    v_cmp_lt_u32_sdwa s[46:47], v110, v111 src0_sel:WORD_1 src1_sel:WORD_1
    s_nop 0
    s_or_b64 s[44:45], s[44:45], s[46:47]
    s_cbranch_scc0 p2_nomore1x
    v_mov_b32 v49, s19
    v_mov_b32 v50, 1
    ds_write_b32 v49, v50 offset:53760
p2_nomore1x:
    s_setprio 2
    s_waitcnt lgkmcnt(15)
    v_ashrrev_i32 v122, 5, v54
    v_lshlrev_b16 v123, 2, v54
    v_cndmask_b32 v126, v12, v13, s[66:67]
    v_bitop3_b32 v122, v122, v113, v113 bitop3:0x0c
    v_lshlrev_b32 v124, 16, v126
    v_mul_f32 v122, v114, v122
    v_and_b32 v125, 0xffff0000, v126
    v_add_u32 v123, v123, v123
    v_mul_f32 v124, v122, v124
    v_mul_f32 v125, v122, v125
    v_cmpx_le_u32 vcc, 0x1000000, v54
    ds_add_f32 v123, v124 offset:54272
    ds_add_f32 v123, v125 offset:54276
    s_mov_b64 exec, -1
    v_ashrrev_i32 v122, 5, v55
    v_lshlrev_b16 v123, 2, v55
    v_cndmask_b32 v126, v14, v15, s[66:67]
    v_bitop3_b32 v122, v122, v113, v113 bitop3:0x0c
    v_lshlrev_b32 v124, 16, v126
    v_mul_f32 v122, v114, v122
    v_and_b32 v125, 0xffff0000, v126
    v_add_u32 v123, v123, v123
    v_mul_f32 v124, v122, v124
    v_mul_f32 v125, v122, v125
    v_cmpx_le_u32 vcc, 0x1000000, v55
    ds_add_f32 v123, v124 offset:54272
    ds_add_f32 v123, v125 offset:54276
    s_mov_b64 exec, -1
    v_ashrrev_i32 v122, 5, v56
    v_lshlrev_b16 v123, 2, v56
    v_cndmask_b32 v126, v16, v17, s[66:67]
    v_bitop3_b32 v122, v122, v113, v113 bitop3:0x0c
    v_lshlrev_b32 v124, 16, v126
    v_mul_f32 v122, v114, v122
    v_and_b32 v125, 0xffff0000, v126
    v_add_u32 v123, v123, v123
    v_mul_f32 v124, v122, v124
    v_mul_f32 v125, v122, v125
    v_cmpx_le_u32 vcc, 0x1000000, v56
    ds_add_f32 v123, v124 offset:54272
    ds_add_f32 v123, v125 offset:54276
    s_mov_b64 exec, -1
    v_bfe_u32 v12, v104, 14, 4
    v_lshrrev_b32 v13, 18, v104
    v_and_b32 v104, 0x3fff, v104
    v_mad_u32_u24 v12, v12, s63, v13
    v_mad_u32_u24 v104, v12, s65, v104
    buffer_load_dwordx4 v[12:15], v104, s[68:71], 0 offen
    s_cmp_lt_u32 s15, 8
    s_cbranch_scc1 p2_na1a3
    s_waitcnt lgkmcnt(15)
    v_ashrrev_i32 v122, 5, v57
    v_lshlrev_b16 v123, 2, v57
    v_cndmask_b32 v126, v18, v19, s[66:67]
    v_bitop3_b32 v122, v122, v113, v113 bitop3:0x0c
    v_lshlrev_b32 v124, 16, v126
    v_mul_f32 v122, v114, v122
    v_and_b32 v125, 0xffff0000, v126
    v_add_u32 v123, v123, v123
    v_mul_f32 v124, v122, v124
    v_mul_f32 v125, v122, v125
    v_cmpx_le_u32 vcc, 0x1000000, v57
    ds_add_f32 v123, v124 offset:54272
    ds_add_f32 v123, v125 offset:54276
    s_mov_b64 exec, -1
    v_ashrrev_i32 v122, 5, v58
    v_lshlrev_b16 v123, 2, v58
    v_cndmask_b32 v126, v20, v21, s[66:67]
    v_bitop3_b32 v122, v122, v113, v113 bitop3:0x0c
    v_lshlrev_b32 v124, 16, v126
    v_mul_f32 v122, v114, v122
    v_and_b32 v125, 0xffff0000, v126
    v_add_u32 v123, v123, v123
    v_mul_f32 v124, v122, v124
    v_mul_f32 v125, v122, v125
    v_cmpx_le_u32 vcc, 0x1000000, v58
    ds_add_f32 v123, v124 offset:54272
    ds_add_f32 v123, v125 offset:54276
    s_mov_b64 exec, -1
    v_ashrrev_i32 v122, 5, v59
    v_lshlrev_b16 v123, 2, v59
    v_cndmask_b32 v126, v22, v23, s[66:67]
    v_bitop3_b32 v122, v122, v113, v113 bitop3:0x0c
    v_lshlrev_b32 v124, 16, v126
    v_mul_f32 v122, v114, v122
    v_and_b32 v125, 0xffff0000, v126
    v_add_u32 v123, v123, v123
    v_mul_f32 v124, v122, v124
    v_mul_f32 v125, v122, v125
    v_cmpx_le_u32 vcc, 0x1000000, v59
    ds_add_f32 v123, v124 offset:54272
    ds_add_f32 v123, v125 offset:54276
    s_mov_b64 exec, -1
p2_na1a3:
    v_bfe_u32 v18, v105, 14, 4
    v_lshrrev_b32 v19, 18, v105
    v_and_b32 v105, 0x3fff, v105
    v_mad_u32_u24 v18, v18, s63, v19
    v_mad_u32_u24 v105, v18, s65, v105
    buffer_load_dwordx4 v[18:21], v105, s[68:71], 0 offen
    s_mov_b32 m0, s23
    s_nop 0
    ds_read_addtid_b32 v102 offset:1024
    ds_read_addtid_b32 v103 offset:1280
    ds_read_addtid_b32 v104 offset:1536
    ds_read_addtid_b32 v105 offset:1792
    ds_read_addtid_b32 v106 offset:0
    ds_read_addtid_b32 v107 offset:256
    ds_read_addtid_b32 v108 offset:512
    ds_read_addtid_b32 v109 offset:768
    s_waitcnt vmcnt(4)
    s_mov_b32 m0, s24
    s_cmp_ge_u32 s10, 9
    s_cbranch_scc1 p2_st1s0
    ds_write_addtid_b32 v84 offset:49152
    ds_write_addtid_b32 v85 offset:49408
p2_st1s0:
    s_mov_b32 m0, s23
    s_add_u32 s20, s20, 53760
    ds_write_addtid_b32 v72 offset:0
    ds_write_addtid_b32 v73 offset:256
    ds_write_addtid_b32 v74 offset:512
    ds_write_addtid_b32 v75 offset:768
    ds_write_addtid_b32 v76 offset:1024
    ds_write_addtid_b32 v77 offset:1280
    ds_write_addtid_b32 v78 offset:1536
    ds_write_addtid_b32 v79 offset:1792
    ds_write_addtid_b32 v80 offset:2048
    ds_write_addtid_b32 v81 offset:2304
    ds_write_addtid_b32 v82 offset:2560
    ds_write_addtid_b32 v83 offset:2816
    s_setprio 1
    s_waitcnt lgkmcnt(15)
    v_ashrrev_i32 v122, 5, v60
    v_lshlrev_b16 v123, 2, v60
    v_cndmask_b32 v126, v24, v25, s[66:67]
    v_bitop3_b32 v122, v122, v113, v113 bitop3:0x0c
    v_lshlrev_b32 v124, 16, v126
    v_mul_f32 v122, v114, v122
    v_and_b32 v125, 0xffff0000, v126
    v_add_u32 v123, v123, v123
    v_mul_f32 v124, v122, v124
    v_mul_f32 v125, v122, v125
    v_cmpx_le_u32 vcc, 0x1000000, v60
    ds_add_f32 v123, v124 offset:54272
    ds_add_f32 v123, v125 offset:54276
    s_mov_b64 exec, -1
    v_ashrrev_i32 v122, 5, v61
    v_lshlrev_b16 v123, 2, v61
    v_cndmask_b32 v126, v26, v27, s[66:67]
    v_bitop3_b32 v122, v122, v113, v113 bitop3:0x0c
    v_lshlrev_b32 v124, 16, v126
    v_mul_f32 v122, v114, v122
    v_and_b32 v125, 0xffff0000, v126
    v_add_u32 v123, v123, v123
    v_mul_f32 v124, v122, v124
    v_mul_f32 v125, v122, v125
    v_cmpx_le_u32 vcc, 0x1000000, v61
    ds_add_f32 v123, v124 offset:54272
    ds_add_f32 v123, v125 offset:54276
    s_mov_b64 exec, -1
    v_ashrrev_i32 v122, 5, v62
    v_lshlrev_b16 v123, 2, v62
    v_cndmask_b32 v126, v28, v29, s[66:67]
    v_bitop3_b32 v122, v122, v113, v113 bitop3:0x0c
    v_lshlrev_b32 v124, 16, v126
    v_mul_f32 v122, v114, v122
    v_and_b32 v125, 0xffff0000, v126
    v_add_u32 v123, v123, v123
    v_mul_f32 v124, v122, v124
    v_mul_f32 v125, v122, v125
    v_cmpx_le_u32 vcc, 0x1000000, v62
    ds_add_f32 v123, v124 offset:54272
    ds_add_f32 v123, v125 offset:54276
    s_mov_b64 exec, -1
    s_waitcnt vmcnt(16)
    v_perm_b32 v60, v89, v86, s31
    v_perm_b32 v61, v89, v87, s32
    v_perm_b32 v62, v89, v88, s33
    v_lshlrev_b16 v28, 3, v88
    v_lshlrev_b16 v26, 3, v87
    v_lshlrev_b16 v24, 3, v86
    s_waitcnt lgkmcnt(15)
    s_nop 2
    s_nop 1
    v_max_u32_dpp v106, v106, v106 row_shr:1 row_mask:0xf bank_mask:0xf bound_ctrl:0
    v_max_u32_dpp v107, v107, v107 row_shr:1 row_mask:0xf bank_mask:0xf bound_ctrl:0
    s_nop 0
    v_max_u32_dpp v106, v106, v106 row_shr:2 row_mask:0xf bank_mask:0xf bound_ctrl:0
    v_max_u32_dpp v107, v107, v107 row_shr:2 row_mask:0xf bank_mask:0xf bound_ctrl:0
    s_nop 0
    v_max_u32_dpp v106, v106, v106 row_shr:4 row_mask:0xf bank_mask:0xf bound_ctrl:0
    v_max_u32_dpp v107, v107, v107 row_shr:4 row_mask:0xf bank_mask:0xf bound_ctrl:0
    s_nop 0
    v_max_u32_dpp v106, v106, v106 row_shr:8 row_mask:0xf bank_mask:0xf bound_ctrl:0
    v_max_u32_dpp v107, v107, v107 row_shr:8 row_mask:0xf bank_mask:0xf bound_ctrl:0
    s_nop 0
    v_max_u32_dpp v106, v106, v106 row_bcast:15 row_mask:0xa bank_mask:0xf
    v_max_u32_dpp v107, v107, v107 row_bcast:15 row_mask:0xa bank_mask:0xf
    s_nop 0
    v_max_u32_dpp v106, v106, v106 row_bcast:31 row_mask:0xc bank_mask:0xf
    v_max_u32_dpp v107, v107, v107 row_bcast:31 row_mask:0xc bank_mask:0xf
    s_nop 0
    s_nop 0
    v_readlane_b32 s41, v106, 63
    v_add_u32 v106, v106, v112
    v_add_u32 v106, 4294959104, v106
    v_max_u32 v107, s41, v107
    s_nop 0
    v_readlane_b32 s41, v107, 63
    v_add_u32 v107, v107, v112
    v_add_u32 v107, 4294960128, v107
    v_bfe_u32 v86, v106, 14, 4
    v_lshrrev_b32 v87, 18, v106
    v_and_b32 v106, 0x3fff, v106
    v_mad_u32_u24 v86, v86, s63, v87
    v_mad_u32_u24 v106, v86, s65, v106
    buffer_load_dwordx4 v[86:89], v106, s[68:71], 0 offen
    s_setprio 0
    s_waitcnt lgkmcnt(15)
    v_ashrrev_i32 v122, 5, v63
    v_lshlrev_b16 v123, 2, v63
    v_cndmask_b32 v126, v30, v31, s[66:67]
    v_bitop3_b32 v122, v122, v113, v113 bitop3:0x0c
    v_lshlrev_b32 v124, 16, v126
    v_mul_f32 v122, v114, v122
    v_and_b32 v125, 0xffff0000, v126
    v_add_u32 v123, v123, v123
    v_mul_f32 v124, v122, v124
    v_mul_f32 v125, v122, v125
    v_cmpx_le_u32 vcc, 0x1000000, v63
    ds_add_f32 v123, v124 offset:54272
    ds_add_f32 v123, v125 offset:54276
    s_mov_b64 exec, -1
    v_ashrrev_i32 v122, 5, v64
    v_lshlrev_b16 v123, 2, v64
    v_cndmask_b32 v126, v32, v33, s[66:67]
    v_bitop3_b32 v122, v122, v113, v113 bitop3:0x0c
    v_lshlrev_b32 v124, 16, v126
    v_mul_f32 v122, v114, v122
    v_and_b32 v125, 0xffff0000, v126
    v_add_u32 v123, v123, v123
    v_mul_f32 v124, v122, v124
    v_mul_f32 v125, v122, v125
    v_cmpx_le_u32 vcc, 0x1000000, v64
    ds_add_f32 v123, v124 offset:54272
    ds_add_f32 v123, v125 offset:54276
    s_mov_b64 exec, -1
    v_ashrrev_i32 v122, 5, v65
    v_lshlrev_b16 v123, 2, v65
    v_cndmask_b32 v126, v34, v35, s[66:67]
    v_bitop3_b32 v122, v122, v113, v113 bitop3:0x0c
    v_lshlrev_b32 v124, 16, v126
    v_mul_f32 v122, v114, v122
    v_and_b32 v125, 0xffff0000, v126
    v_add_u32 v123, v123, v123
    v_mul_f32 v124, v122, v124
    v_mul_f32 v125, v122, v125
    v_cmpx_le_u32 vcc, 0x1000000, v65
    ds_add_f32 v123, v124 offset:54272
    ds_add_f32 v123, v125 offset:54276
    s_mov_b64 exec, -1
    s_waitcnt vmcnt(13)
    v_perm_b32 v63, v93, v90, s31
    v_perm_b32 v64, v93, v91, s32
    v_perm_b32 v65, v93, v92, s33
    v_lshlrev_b16 v34, 3, v92
    v_lshlrev_b16 v32, 3, v91
    v_lshlrev_b16 v30, 3, v90
    s_waitcnt lgkmcnt(12)
    s_barrier
    s_setprio 3
    s_cmp_ge_u32 s10, 9
    s_cbranch_scc1 p2_nm1m1a
    v_lshrrev_b32 v84, 1, v112
    s_add_u32 s44, s20, s42
    buffer_load_dwordx2 v[84:85], v84, s[4:7], s44 offen
p2_nm1m1a:
    buffer_load_dwordx4 v[72:75], v112, s[4:7], s20 offen offset:0
    buffer_load_dwordx4 v[76:79], v112, s[4:7], s20 offen offset:1024
    buffer_load_dwordx4 v[80:83], v112, s[4:7], s20 offen offset:2048
    v_cmpx_ge_u16 vcc, 0x3fff, v60
    ds_read_b64 v[24:25], v24
    s_mov_b64 exec, -1
    v_cmpx_ge_u16 vcc, 0x3fff, v61
    ds_read_b64 v[26:27], v26
    s_mov_b64 exec, -1
    v_cmpx_ge_u16 vcc, 0x3fff, v62
    ds_read_b64 v[28:29], v28
    s_mov_b64 exec, -1
    v_cmpx_ge_u16 vcc, 0x3fff, v63
    ds_read_b64 v[30:31], v30
    s_mov_b64 exec, -1
    v_cmpx_ge_u16 vcc, 0x3fff, v64
    ds_read_b64 v[32:33], v32
    s_mov_b64 exec, -1
    v_cmpx_ge_u16 vcc, 0x3fff, v65
    ds_read_b64 v[34:35], v34
    s_mov_b64 exec, -1
    s_setprio 2
    s_waitcnt lgkmcnt(15)
    v_ashrrev_i32 v122, 5, v66
    v_lshlrev_b16 v123, 2, v66
    v_cndmask_b32 v126, v36, v37, s[66:67]
    v_bitop3_b32 v122, v122, v113, v113 bitop3:0x0c
    v_lshlrev_b32 v124, 16, v126
    v_mul_f32 v122, v114, v122
    v_and_b32 v125, 0xffff0000, v126
    v_add_u32 v123, v123, v123
    v_mul_f32 v124, v122, v124
    v_mul_f32 v125, v122, v125
    v_cmpx_le_u32 vcc, 0x1000000, v66
    ds_add_f32 v123, v124 offset:54272
    ds_add_f32 v123, v125 offset:54276
    s_mov_b64 exec, -1
    v_ashrrev_i32 v122, 5, v67
    v_lshlrev_b16 v123, 2, v67
    v_cndmask_b32 v126, v38, v39, s[66:67]
    v_bitop3_b32 v122, v122, v113, v113 bitop3:0x0c
    v_lshlrev_b32 v124, 16, v126
    v_mul_f32 v122, v114, v122
    v_and_b32 v125, 0xffff0000, v126
    v_add_u32 v123, v123, v123
    v_mul_f32 v124, v122, v124
    v_mul_f32 v125, v122, v125
    v_cmpx_le_u32 vcc, 0x1000000, v67
    ds_add_f32 v123, v124 offset:54272
    ds_add_f32 v123, v125 offset:54276
    s_mov_b64 exec, -1
    v_ashrrev_i32 v122, 5, v68
    v_lshlrev_b16 v123, 2, v68
    v_cndmask_b32 v126, v40, v41, s[66:67]
    v_bitop3_b32 v122, v122, v113, v113 bitop3:0x0c
    v_lshlrev_b32 v124, 16, v126
    v_mul_f32 v122, v114, v122
    v_and_b32 v125, 0xffff0000, v126
    v_add_u32 v123, v123, v123
    v_mul_f32 v124, v122, v124
    v_mul_f32 v125, v122, v125
    v_cmpx_le_u32 vcc, 0x1000000, v68
    ds_add_f32 v123, v124 offset:54272
    ds_add_f32 v123, v125 offset:54276
    s_mov_b64 exec, -1
    s_waitcnt vmcnt(15)
    v_perm_b32 v66, v97, v94, s31
    v_perm_b32 v67, v97, v95, s32
    v_perm_b32 v68, v97, v96, s33
    v_lshlrev_b16 v40, 3, v96
    v_lshlrev_b16 v38, 3, v95
    v_lshlrev_b16 v36, 3, v94
    v_cmpx_ge_u16 vcc, 0x3fff, v66
    ds_read_b64 v[36:37], v36
    s_mov_b64 exec, -1
    v_cmpx_ge_u16 vcc, 0x3fff, v67
    ds_read_b64 v[38:39], v38
    s_mov_b64 exec, -1
    v_cmpx_ge_u16 vcc, 0x3fff, v68
    ds_read_b64 v[40:41], v40
    s_mov_b64 exec, -1
    v_bfe_u32 v90, v107, 14, 4
    v_lshrrev_b32 v91, 18, v107
    v_and_b32 v107, 0x3fff, v107
    v_mad_u32_u24 v90, v90, s63, v91
    v_mad_u32_u24 v107, v90, s65, v107
    buffer_load_dwordx4 v[90:93], v107, s[68:71], 0 offen
    s_setprio 1
    s_waitcnt lgkmcnt(15)
    v_ashrrev_i32 v122, 5, v69
    v_lshlrev_b16 v123, 2, v69
    v_cndmask_b32 v126, v42, v43, s[66:67]
    v_bitop3_b32 v122, v122, v113, v113 bitop3:0x0c
    v_lshlrev_b32 v124, 16, v126
    v_mul_f32 v122, v114, v122
    v_and_b32 v125, 0xffff0000, v126
    v_add_u32 v123, v123, v123
    v_mul_f32 v124, v122, v124
    v_mul_f32 v125, v122, v125
    v_cmpx_le_u32 vcc, 0x1000000, v69
    ds_add_f32 v123, v124 offset:54272
    ds_add_f32 v123, v125 offset:54276
    s_mov_b64 exec, -1
    v_ashrrev_i32 v122, 5, v70
    v_lshlrev_b16 v123, 2, v70
    v_cndmask_b32 v126, v44, v45, s[66:67]
    v_bitop3_b32 v122, v122, v113, v113 bitop3:0x0c
    v_lshlrev_b32 v124, 16, v126
    v_mul_f32 v122, v114, v122
    v_and_b32 v125, 0xffff0000, v126
    v_add_u32 v123, v123, v123
    v_mul_f32 v124, v122, v124
    v_mul_f32 v125, v122, v125
    v_cmpx_le_u32 vcc, 0x1000000, v70
    ds_add_f32 v123, v124 offset:54272
    ds_add_f32 v123, v125 offset:54276
    s_mov_b64 exec, -1
    v_ashrrev_i32 v122, 5, v71
    v_lshlrev_b16 v123, 2, v71
    v_cndmask_b32 v126, v46, v47, s[66:67]
    v_bitop3_b32 v122, v122, v113, v113 bitop3:0x0c
    v_lshlrev_b32 v124, 16, v126
    v_mul_f32 v122, v114, v122
    v_and_b32 v125, 0xffff0000, v126
    v_add_u32 v123, v123, v123
    v_mul_f32 v124, v122, v124
    v_mul_f32 v125, v122, v125
    v_cmpx_le_u32 vcc, 0x1000000, v71
    ds_add_f32 v123, v124 offset:54272
    ds_add_f32 v123, v125 offset:54276
    s_mov_b64 exec, -1
    s_waitcnt vmcnt(12)
    v_perm_b32 v69, v101, v98, s31
    v_perm_b32 v70, v101, v99, s32
    v_perm_b32 v71, v101, v100, s33
    v_lshlrev_b16 v46, 3, v100
    v_lshlrev_b16 v44, 3, v99
    v_lshlrev_b16 v42, 3, v98
    v_cmpx_ge_u16 vcc, 0x3fff, v69
    ds_read_b64 v[42:43], v42
    s_mov_b64 exec, -1
    v_cmpx_ge_u16 vcc, 0x3fff, v70
    ds_read_b64 v[44:45], v44
    s_mov_b64 exec, -1
    v_cmpx_ge_u16 vcc, 0x3fff, v71
    ds_read_b64 v[46:47], v46
    s_mov_b64 exec, -1
    s_waitcnt lgkmcnt(15)
    s_nop 2
    s_nop 1
    v_max_u32_dpp v108, v108, v108 row_shr:1 row_mask:0xf bank_mask:0xf bound_ctrl:0
    v_max_u32_dpp v109, v109, v109 row_shr:1 row_mask:0xf bank_mask:0xf bound_ctrl:0
    s_nop 0
    v_max_u32_dpp v108, v108, v108 row_shr:2 row_mask:0xf bank_mask:0xf bound_ctrl:0
    v_max_u32_dpp v109, v109, v109 row_shr:2 row_mask:0xf bank_mask:0xf bound_ctrl:0
    s_nop 0
    v_max_u32_dpp v108, v108, v108 row_shr:4 row_mask:0xf bank_mask:0xf bound_ctrl:0
    v_max_u32_dpp v109, v109, v109 row_shr:4 row_mask:0xf bank_mask:0xf bound_ctrl:0
    s_nop 0
    v_max_u32_dpp v108, v108, v108 row_shr:8 row_mask:0xf bank_mask:0xf bound_ctrl:0
    v_max_u32_dpp v109, v109, v109 row_shr:8 row_mask:0xf bank_mask:0xf bound_ctrl:0
    s_nop 0
    v_max_u32_dpp v108, v108, v108 row_bcast:15 row_mask:0xa bank_mask:0xf
    v_max_u32_dpp v109, v109, v109 row_bcast:15 row_mask:0xa bank_mask:0xf
    s_nop 0
    v_max_u32_dpp v108, v108, v108 row_bcast:31 row_mask:0xc bank_mask:0xf
    v_max_u32_dpp v109, v109, v109 row_bcast:31 row_mask:0xc bank_mask:0xf
    s_nop 0
    s_nop 0
    v_max_u32 v108, s41, v108
    s_nop 0
    v_readlane_b32 s41, v108, 63
    v_add_u32 v108, v108, v112
    v_add_u32 v108, 4294961152, v108
    v_max_u32 v109, s41, v109
    s_nop 0
    v_readlane_b32 s41, v109, 63
    v_add_u32 v109, v109, v112
    v_add_u32 v109, 4294962176, v109
    v_bfe_u32 v94, v108, 14, 4
    v_lshrrev_b32 v95, 18, v108
    v_and_b32 v108, 0x3fff, v108
    v_mad_u32_u24 v94, v94, s63, v95
    v_mad_u32_u24 v108, v94, s65, v108
    buffer_load_dwordx4 v[94:97], v108, s[68:71], 0 offen
    s_setprio 0
    s_waitcnt vmcnt(9)
    v_perm_b32 v48, v3, v0, s31
    v_perm_b32 v49, v3, v1, s32
    v_perm_b32 v50, v3, v2, s33
    v_lshlrev_b16 v4, 3, v2
    v_lshlrev_b16 v2, 3, v1
    v_lshlrev_b16 v0, 3, v0
    v_cmpx_ge_u16 vcc, 0x3fff, v48
    ds_read_b64 v[0:1], v0
    s_mov_b64 exec, -1
    v_cmpx_ge_u16 vcc, 0x3fff, v49
    ds_read_b64 v[2:3], v2
    s_mov_b64 exec, -1
    v_cmpx_ge_u16 vcc, 0x3fff, v50
    ds_read_b64 v[4:5], v4
    s_mov_b64 exec, -1
    s_waitcnt vmcnt(8)
    v_perm_b32 v51, v9, v6, s31
    v_perm_b32 v52, v9, v7, s32
    v_perm_b32 v53, v9, v8, s33
    v_lshlrev_b16 v10, 3, v8
    v_lshlrev_b16 v8, 3, v7
    v_lshlrev_b16 v6, 3, v6
    v_cmpx_ge_u16 vcc, 0x3fff, v51
    ds_read_b64 v[6:7], v6
    s_mov_b64 exec, -1
    v_cmpx_ge_u16 vcc, 0x3fff, v52
    ds_read_b64 v[8:9], v8
    s_mov_b64 exec, -1
    v_cmpx_ge_u16 vcc, 0x3fff, v53
    ds_read_b64 v[10:11], v10
    s_mov_b64 exec, -1
    s_waitcnt vmcnt(7)
    v_perm_b32 v54, v15, v12, s31
    v_perm_b32 v55, v15, v13, s32
    v_perm_b32 v56, v15, v14, s33
    v_lshlrev_b16 v16, 3, v14
    v_lshlrev_b16 v14, 3, v13
    v_lshlrev_b16 v12, 3, v12
    v_cmpx_ge_u16 vcc, 0x3fff, v54
    ds_read_b64 v[12:13], v12
    s_mov_b64 exec, -1
    v_cmpx_ge_u16 vcc, 0x3fff, v55
    ds_read_b64 v[14:15], v14
    s_mov_b64 exec, -1
    v_cmpx_ge_u16 vcc, 0x3fff, v56
    ds_read_b64 v[16:17], v16
    s_mov_b64 exec, -1
    s_waitcnt vmcnt(6)
    v_perm_b32 v57, v21, v18, s31
    v_perm_b32 v58, v21, v19, s32
    v_perm_b32 v59, v21, v20, s33
    v_lshlrev_b16 v22, 3, v20
    v_lshlrev_b16 v20, 3, v19
    v_lshlrev_b16 v18, 3, v18
    s_cmp_lt_u32 s16, 8
    s_cbranch_scc1 p2_g1r03
    v_cmpx_ge_u16 vcc, 0x3fff, v57
    ds_read_b64 v[18:19], v18
    s_mov_b64 exec, -1
    v_cmpx_ge_u16 vcc, 0x3fff, v58
    ds_read_b64 v[20:21], v20
    s_mov_b64 exec, -1
    v_cmpx_ge_u16 vcc, 0x3fff, v59
    ds_read_b64 v[22:23], v22
    s_mov_b64 exec, -1
p2_g1r03:
    s_waitcnt lgkmcnt(0)
    s_barrier
    s_waitcnt lgkmcnt(15)
    s_branch p2_tail
p2_drain1:
    v_cmpx_gt_i16 vcc, 0, v48
    ds_read_b64 v[0:1], v0
    s_mov_b64 exec, -1
    v_cmpx_gt_i16 vcc, 0, v49
    ds_read_b64 v[2:3], v2
    s_mov_b64 exec, -1
    v_cmpx_gt_i16 vcc, 0, v50
    ds_read_b64 v[4:5], v4
    s_mov_b64 exec, -1
    v_cmpx_gt_i16 vcc, 0, v51
    ds_read_b64 v[6:7], v6
    s_mov_b64 exec, -1
    v_cmpx_gt_i16 vcc, 0, v52
    ds_read_b64 v[8:9], v8
    s_mov_b64 exec, -1
    v_cmpx_gt_i16 vcc, 0, v53
    ds_read_b64 v[10:11], v10
    s_mov_b64 exec, -1
    v_cmpx_gt_i16 vcc, 0, v54
    ds_read_b64 v[12:13], v12
    s_mov_b64 exec, -1
    v_cmpx_gt_i16 vcc, 0, v55
    ds_read_b64 v[14:15], v14
    s_mov_b64 exec, -1
    v_cmpx_gt_i16 vcc, 0, v56
    ds_read_b64 v[16:17], v16
    s_mov_b64 exec, -1
    s_cmp_lt_u32 s15, 8
    s_cbranch_scc1 p2_gd1
    v_cmpx_gt_i16 vcc, 0, v57
    ds_read_b64 v[18:19], v18
    s_mov_b64 exec, -1
    v_cmpx_gt_i16 vcc, 0, v58
    ds_read_b64 v[20:21], v20
    s_mov_b64 exec, -1
    v_cmpx_gt_i16 vcc, 0, v59
    ds_read_b64 v[22:23], v22
    s_mov_b64 exec, -1
p2_gd1:
    v_cmpx_gt_i16 vcc, 0, v60
    ds_read_b64 v[24:25], v24
    s_mov_b64 exec, -1
    v_cmpx_gt_i16 vcc, 0, v61
    ds_read_b64 v[26:27], v26
    s_mov_b64 exec, -1
    v_cmpx_gt_i16 vcc, 0, v62
    ds_read_b64 v[28:29], v28
    s_mov_b64 exec, -1
    v_cmpx_gt_i16 vcc, 0, v63
    ds_read_b64 v[30:31], v30
    s_mov_b64 exec, -1
    v_cmpx_gt_i16 vcc, 0, v64
    ds_read_b64 v[32:33], v32
    s_mov_b64 exec, -1
    v_cmpx_gt_i16 vcc, 0, v65
    ds_read_b64 v[34:35], v34
    s_mov_b64 exec, -1
    v_cmpx_gt_i16 vcc, 0, v66
    ds_read_b64 v[36:37], v36
    s_mov_b64 exec, -1
    v_cmpx_gt_i16 vcc, 0, v67
    ds_read_b64 v[38:39], v38
    s_mov_b64 exec, -1
    v_cmpx_gt_i16 vcc, 0, v68
    ds_read_b64 v[40:41], v40
    s_mov_b64 exec, -1
    v_cmpx_gt_i16 vcc, 0, v69
    ds_read_b64 v[42:43], v42
    s_mov_b64 exec, -1
    v_cmpx_gt_i16 vcc, 0, v70
    ds_read_b64 v[44:45], v44
    s_mov_b64 exec, -1
    v_cmpx_gt_i16 vcc, 0, v71
    ds_read_b64 v[46:47], v46
    s_mov_b64 exec, -1
    s_waitcnt lgkmcnt(15)
    v_ashrrev_i32 v122, 5, v48
    v_lshlrev_b16 v123, 2, v48
    v_cndmask_b32 v126, v0, v1, s[66:67]
    v_bitop3_b32 v122, v122, v113, v113 bitop3:0x0c
    v_lshlrev_b32 v124, 16, v126
    v_mul_f32 v122, v114, v122
    v_and_b32 v125, 0xffff0000, v126
    v_add_u32 v123, v123, v123
    v_mul_f32 v124, v122, v124
    v_mul_f32 v125, v122, v125
    v_cmpx_le_u32 vcc, 0x1000000, v48
    ds_add_f32 v123, v124 offset:54272
    ds_add_f32 v123, v125 offset:54276
    s_mov_b64 exec, -1
    v_ashrrev_i32 v122, 5, v49
    v_lshlrev_b16 v123, 2, v49
    v_cndmask_b32 v126, v2, v3, s[66:67]
    v_bitop3_b32 v122, v122, v113, v113 bitop3:0x0c
    v_lshlrev_b32 v124, 16, v126
    v_mul_f32 v122, v114, v122
    v_and_b32 v125, 0xffff0000, v126
    v_add_u32 v123, v123, v123
    v_mul_f32 v124, v122, v124
    v_mul_f32 v125, v122, v125
    v_cmpx_le_u32 vcc, 0x1000000, v49
    ds_add_f32 v123, v124 offset:54272
    ds_add_f32 v123, v125 offset:54276
    s_mov_b64 exec, -1
    v_ashrrev_i32 v122, 5, v50
    v_lshlrev_b16 v123, 2, v50
    v_cndmask_b32 v126, v4, v5, s[66:67]
    v_bitop3_b32 v122, v122, v113, v113 bitop3:0x0c
    v_lshlrev_b32 v124, 16, v126
    v_mul_f32 v122, v114, v122
    v_and_b32 v125, 0xffff0000, v126
    v_add_u32 v123, v123, v123
    v_mul_f32 v124, v122, v124
    v_mul_f32 v125, v122, v125
    v_cmpx_le_u32 vcc, 0x1000000, v50
    ds_add_f32 v123, v124 offset:54272
    ds_add_f32 v123, v125 offset:54276
    s_mov_b64 exec, -1
    s_waitcnt lgkmcnt(15)
    v_ashrrev_i32 v122, 5, v51
    v_lshlrev_b16 v123, 2, v51
    v_cndmask_b32 v126, v6, v7, s[66:67]
    v_bitop3_b32 v122, v122, v113, v113 bitop3:0x0c
    v_lshlrev_b32 v124, 16, v126
    v_mul_f32 v122, v114, v122
    v_and_b32 v125, 0xffff0000, v126
    v_add_u32 v123, v123, v123
    v_mul_f32 v124, v122, v124
    v_mul_f32 v125, v122, v125
    v_cmpx_le_u32 vcc, 0x1000000, v51
    ds_add_f32 v123, v124 offset:54272
    ds_add_f32 v123, v125 offset:54276
    s_mov_b64 exec, -1
    v_ashrrev_i32 v122, 5, v52
    v_lshlrev_b16 v123, 2, v52
    v_cndmask_b32 v126, v8, v9, s[66:67]
    v_bitop3_b32 v122, v122, v113, v113 bitop3:0x0c
    v_lshlrev_b32 v124, 16, v126
    v_mul_f32 v122, v114, v122
    v_and_b32 v125, 0xffff0000, v126
    v_add_u32 v123, v123, v123
    v_mul_f32 v124, v122, v124
    v_mul_f32 v125, v122, v125
    v_cmpx_le_u32 vcc, 0x1000000, v52
    ds_add_f32 v123, v124 offset:54272
    ds_add_f32 v123, v125 offset:54276
    s_mov_b64 exec, -1
    v_ashrrev_i32 v122, 5, v53
    v_lshlrev_b16 v123, 2, v53
    v_cndmask_b32 v126, v10, v11, s[66:67]
    v_bitop3_b32 v122, v122, v113, v113 bitop3:0x0c
    v_lshlrev_b32 v124, 16, v126
    v_mul_f32 v122, v114, v122
    v_and_b32 v125, 0xffff0000, v126
    v_add_u32 v123, v123, v123
    v_mul_f32 v124, v122, v124
    v_mul_f32 v125, v122, v125
    v_cmpx_le_u32 vcc, 0x1000000, v53
    ds_add_f32 v123, v124 offset:54272
    ds_add_f32 v123, v125 offset:54276
    s_mov_b64 exec, -1
    s_waitcnt lgkmcnt(15)
    v_ashrrev_i32 v122, 5, v54
    v_lshlrev_b16 v123, 2, v54
    v_cndmask_b32 v126, v12, v13, s[66:67]
    v_bitop3_b32 v122, v122, v113, v113 bitop3:0x0c
    v_lshlrev_b32 v124, 16, v126
    v_mul_f32 v122, v114, v122
    v_and_b32 v125, 0xffff0000, v126
    v_add_u32 v123, v123, v123
    v_mul_f32 v124, v122, v124
    v_mul_f32 v125, v122, v125
    v_cmpx_le_u32 vcc, 0x1000000, v54
    ds_add_f32 v123, v124 offset:54272
    ds_add_f32 v123, v125 offset:54276
    s_mov_b64 exec, -1
    v_ashrrev_i32 v122, 5, v55
    v_lshlrev_b16 v123, 2, v55
    v_cndmask_b32 v126, v14, v15, s[66:67]
    v_bitop3_b32 v122, v122, v113, v113 bitop3:0x0c
    v_lshlrev_b32 v124, 16, v126
    v_mul_f32 v122, v114, v122
    v_and_b32 v125, 0xffff0000, v126
    v_add_u32 v123, v123, v123
    v_mul_f32 v124, v122, v124
    v_mul_f32 v125, v122, v125
    v_cmpx_le_u32 vcc, 0x1000000, v55
    ds_add_f32 v123, v124 offset:54272
    ds_add_f32 v123, v125 offset:54276
    s_mov_b64 exec, -1
    v_ashrrev_i32 v122, 5, v56
    v_lshlrev_b16 v123, 2, v56
    v_cndmask_b32 v126, v16, v17, s[66:67]
    v_bitop3_b32 v122, v122, v113, v113 bitop3:0x0c
    v_lshlrev_b32 v124, 16, v126
    v_mul_f32 v122, v114, v122
    v_and_b32 v125, 0xffff0000, v126
    v_add_u32 v123, v123, v123
    v_mul_f32 v124, v122, v124
    v_mul_f32 v125, v122, v125
    v_cmpx_le_u32 vcc, 0x1000000, v56
    ds_add_f32 v123, v124 offset:54272
    ds_add_f32 v123, v125 offset:54276
    s_mov_b64 exec, -1
    s_cmp_lt_u32 s15, 8
    s_cbranch_scc1 p2_nad1
    s_waitcnt lgkmcnt(15)
    v_ashrrev_i32 v122, 5, v57
    v_lshlrev_b16 v123, 2, v57
    v_cndmask_b32 v126, v18, v19, s[66:67]
    v_bitop3_b32 v122, v122, v113, v113 bitop3:0x0c
    v_lshlrev_b32 v124, 16, v126
    v_mul_f32 v122, v114, v122
    v_and_b32 v125, 0xffff0000, v126
    v_add_u32 v123, v123, v123
    v_mul_f32 v124, v122, v124
    v_mul_f32 v125, v122, v125
    v_cmpx_le_u32 vcc, 0x1000000, v57
    ds_add_f32 v123, v124 offset:54272
    ds_add_f32 v123, v125 offset:54276
    s_mov_b64 exec, -1
    v_ashrrev_i32 v122, 5, v58
    v_lshlrev_b16 v123, 2, v58
    v_cndmask_b32 v126, v20, v21, s[66:67]
    v_bitop3_b32 v122, v122, v113, v113 bitop3:0x0c
    v_lshlrev_b32 v124, 16, v126
    v_mul_f32 v122, v114, v122
    v_and_b32 v125, 0xffff0000, v126
    v_add_u32 v123, v123, v123
    v_mul_f32 v124, v122, v124
    v_mul_f32 v125, v122, v125
    v_cmpx_le_u32 vcc, 0x1000000, v58
    ds_add_f32 v123, v124 offset:54272
    ds_add_f32 v123, v125 offset:54276
    s_mov_b64 exec, -1
    v_ashrrev_i32 v122, 5, v59
    v_lshlrev_b16 v123, 2, v59
    v_cndmask_b32 v126, v22, v23, s[66:67]
    v_bitop3_b32 v122, v122, v113, v113 bitop3:0x0c
    v_lshlrev_b32 v124, 16, v126
    v_mul_f32 v122, v114, v122
    v_and_b32 v125, 0xffff0000, v126
    v_add_u32 v123, v123, v123
    v_mul_f32 v124, v122, v124
    v_mul_f32 v125, v122, v125
    v_cmpx_le_u32 vcc, 0x1000000, v59
    ds_add_f32 v123, v124 offset:54272
    ds_add_f32 v123, v125 offset:54276
    s_mov_b64 exec, -1
p2_nad1:
    s_waitcnt lgkmcnt(15)
    v_ashrrev_i32 v122, 5, v60
    v_lshlrev_b16 v123, 2, v60
    v_cndmask_b32 v126, v24, v25, s[66:67]
    v_bitop3_b32 v122, v122, v113, v113 bitop3:0x0c
    v_lshlrev_b32 v124, 16, v126
    v_mul_f32 v122, v114, v122
    v_and_b32 v125, 0xffff0000, v126
    v_add_u32 v123, v123, v123
    v_mul_f32 v124, v122, v124
    v_mul_f32 v125, v122, v125
    v_cmpx_le_u32 vcc, 0x1000000, v60
    ds_add_f32 v123, v124 offset:54272
    ds_add_f32 v123, v125 offset:54276
    s_mov_b64 exec, -1
    v_ashrrev_i32 v122, 5, v61
    v_lshlrev_b16 v123, 2, v61
    v_cndmask_b32 v126, v26, v27, s[66:67]
    v_bitop3_b32 v122, v122, v113, v113 bitop3:0x0c
    v_lshlrev_b32 v124, 16, v126
    v_mul_f32 v122, v114, v122
    v_and_b32 v125, 0xffff0000, v126
    v_add_u32 v123, v123, v123
    v_mul_f32 v124, v122, v124
    v_mul_f32 v125, v122, v125
    v_cmpx_le_u32 vcc, 0x1000000, v61
    ds_add_f32 v123, v124 offset:54272
    ds_add_f32 v123, v125 offset:54276
    s_mov_b64 exec, -1
    v_ashrrev_i32 v122, 5, v62
    v_lshlrev_b16 v123, 2, v62
    v_cndmask_b32 v126, v28, v29, s[66:67]
    v_bitop3_b32 v122, v122, v113, v113 bitop3:0x0c
    v_lshlrev_b32 v124, 16, v126
    v_mul_f32 v122, v114, v122
    v_and_b32 v125, 0xffff0000, v126
    v_add_u32 v123, v123, v123
    v_mul_f32 v124, v122, v124
    v_mul_f32 v125, v122, v125
    v_cmpx_le_u32 vcc, 0x1000000, v62
    ds_add_f32 v123, v124 offset:54272
    ds_add_f32 v123, v125 offset:54276
    s_mov_b64 exec, -1
    s_waitcnt lgkmcnt(15)
    v_ashrrev_i32 v122, 5, v63
    v_lshlrev_b16 v123, 2, v63
    v_cndmask_b32 v126, v30, v31, s[66:67]
    v_bitop3_b32 v122, v122, v113, v113 bitop3:0x0c
    v_lshlrev_b32 v124, 16, v126
    v_mul_f32 v122, v114, v122
    v_and_b32 v125, 0xffff0000, v126
    v_add_u32 v123, v123, v123
    v_mul_f32 v124, v122, v124
    v_mul_f32 v125, v122, v125
    v_cmpx_le_u32 vcc, 0x1000000, v63
    ds_add_f32 v123, v124 offset:54272
    ds_add_f32 v123, v125 offset:54276
    s_mov_b64 exec, -1
    v_ashrrev_i32 v122, 5, v64
    v_lshlrev_b16 v123, 2, v64
    v_cndmask_b32 v126, v32, v33, s[66:67]
    v_bitop3_b32 v122, v122, v113, v113 bitop3:0x0c
    v_lshlrev_b32 v124, 16, v126
    v_mul_f32 v122, v114, v122
    v_and_b32 v125, 0xffff0000, v126
    v_add_u32 v123, v123, v123
    v_mul_f32 v124, v122, v124
    v_mul_f32 v125, v122, v125
    v_cmpx_le_u32 vcc, 0x1000000, v64
    ds_add_f32 v123, v124 offset:54272
    ds_add_f32 v123, v125 offset:54276
    s_mov_b64 exec, -1
    v_ashrrev_i32 v122, 5, v65
    v_lshlrev_b16 v123, 2, v65
    v_cndmask_b32 v126, v34, v35, s[66:67]
    v_bitop3_b32 v122, v122, v113, v113 bitop3:0x0c
    v_lshlrev_b32 v124, 16, v126
    v_mul_f32 v122, v114, v122
    v_and_b32 v125, 0xffff0000, v126
    v_add_u32 v123, v123, v123
    v_mul_f32 v124, v122, v124
    v_mul_f32 v125, v122, v125
    v_cmpx_le_u32 vcc, 0x1000000, v65
    ds_add_f32 v123, v124 offset:54272
    ds_add_f32 v123, v125 offset:54276
    s_mov_b64 exec, -1
    s_waitcnt lgkmcnt(15)
    v_ashrrev_i32 v122, 5, v66
    v_lshlrev_b16 v123, 2, v66
    v_cndmask_b32 v126, v36, v37, s[66:67]
    v_bitop3_b32 v122, v122, v113, v113 bitop3:0x0c
    v_lshlrev_b32 v124, 16, v126
    v_mul_f32 v122, v114, v122
    v_and_b32 v125, 0xffff0000, v126
    v_add_u32 v123, v123, v123
    v_mul_f32 v124, v122, v124
    v_mul_f32 v125, v122, v125
    v_cmpx_le_u32 vcc, 0x1000000, v66
    ds_add_f32 v123, v124 offset:54272
    ds_add_f32 v123, v125 offset:54276
    s_mov_b64 exec, -1
    v_ashrrev_i32 v122, 5, v67
    v_lshlrev_b16 v123, 2, v67
    v_cndmask_b32 v126, v38, v39, s[66:67]
    v_bitop3_b32 v122, v122, v113, v113 bitop3:0x0c
    v_lshlrev_b32 v124, 16, v126
    v_mul_f32 v122, v114, v122
    v_and_b32 v125, 0xffff0000, v126
    v_add_u32 v123, v123, v123
    v_mul_f32 v124, v122, v124
    v_mul_f32 v125, v122, v125
    v_cmpx_le_u32 vcc, 0x1000000, v67
    ds_add_f32 v123, v124 offset:54272
    ds_add_f32 v123, v125 offset:54276
    s_mov_b64 exec, -1
    v_ashrrev_i32 v122, 5, v68
    v_lshlrev_b16 v123, 2, v68
    v_cndmask_b32 v126, v40, v41, s[66:67]
    v_bitop3_b32 v122, v122, v113, v113 bitop3:0x0c
    v_lshlrev_b32 v124, 16, v126
    v_mul_f32 v122, v114, v122
    v_and_b32 v125, 0xffff0000, v126
    v_add_u32 v123, v123, v123
    v_mul_f32 v124, v122, v124
    v_mul_f32 v125, v122, v125
    v_cmpx_le_u32 vcc, 0x1000000, v68
    ds_add_f32 v123, v124 offset:54272
    ds_add_f32 v123, v125 offset:54276
    s_mov_b64 exec, -1
    s_waitcnt lgkmcnt(15)
    v_ashrrev_i32 v122, 5, v69
    v_lshlrev_b16 v123, 2, v69
    v_cndmask_b32 v126, v42, v43, s[66:67]
    v_bitop3_b32 v122, v122, v113, v113 bitop3:0x0c
    v_lshlrev_b32 v124, 16, v126
    v_mul_f32 v122, v114, v122
    v_and_b32 v125, 0xffff0000, v126
    v_add_u32 v123, v123, v123
    v_mul_f32 v124, v122, v124
    v_mul_f32 v125, v122, v125
    v_cmpx_le_u32 vcc, 0x1000000, v69
    ds_add_f32 v123, v124 offset:54272
    ds_add_f32 v123, v125 offset:54276
    s_mov_b64 exec, -1
    v_ashrrev_i32 v122, 5, v70
    v_lshlrev_b16 v123, 2, v70
    v_cndmask_b32 v126, v44, v45, s[66:67]
    v_bitop3_b32 v122, v122, v113, v113 bitop3:0x0c
    v_lshlrev_b32 v124, 16, v126
    v_mul_f32 v122, v114, v122
    v_and_b32 v125, 0xffff0000, v126
    v_add_u32 v123, v123, v123
    v_mul_f32 v124, v122, v124
    v_mul_f32 v125, v122, v125
    v_cmpx_le_u32 vcc, 0x1000000, v70
    ds_add_f32 v123, v124 offset:54272
    ds_add_f32 v123, v125 offset:54276
    s_mov_b64 exec, -1
    v_ashrrev_i32 v122, 5, v71
    v_lshlrev_b16 v123, 2, v71
    v_cndmask_b32 v126, v46, v47, s[66:67]
    v_bitop3_b32 v122, v122, v113, v113 bitop3:0x0c
    v_lshlrev_b32 v124, 16, v126
    v_mul_f32 v122, v114, v122
    v_and_b32 v125, 0xffff0000, v126
    v_add_u32 v123, v123, v123
    v_mul_f32 v124, v122, v124
    v_mul_f32 v125, v122, v125
    v_cmpx_le_u32 vcc, 0x1000000, v71
    ds_add_f32 v123, v124 offset:54272
    ds_add_f32 v123, v125 offset:54276
    s_mov_b64 exec, -1
    s_branch p2_fin
p2_tail:
    s_mov_b32 s60, s61
    s_mov_b32 s15, s16
    s_mov_b32 s16, s17
    v_mov_b32 v122, s19
    s_xor_b32 s19, s19, 4
    ds_read_b32 v125, v122 offset:53760
    v_mov_b32 v123, s19
    v_mov_b32 v124, 0
    ds_write_b32 v123, v124 offset:53760
    s_waitcnt vmcnt(2)
    s_mov_b32 m0, s24
    s_cmp_ge_u32 s10, 9
    s_cbranch_scc1 p2_st2s1
    ds_write_addtid_b32 v84 offset:49152
    ds_write_addtid_b32 v85 offset:49408
p2_st2s1:
    s_mov_b32 m0, s23
    s_add_u32 s20, s20, 53760
    ds_write_addtid_b32 v72 offset:0
    ds_write_addtid_b32 v73 offset:256
    ds_write_addtid_b32 v74 offset:512
    ds_write_addtid_b32 v75 offset:768
    ds_write_addtid_b32 v76 offset:1024
    ds_write_addtid_b32 v77 offset:1280
    ds_write_addtid_b32 v78 offset:1536
    ds_write_addtid_b32 v79 offset:1792
    ds_write_addtid_b32 v80 offset:2048
    ds_write_addtid_b32 v81 offset:2304
    ds_write_addtid_b32 v82 offset:2560
    ds_write_addtid_b32 v83 offset:2816
    s_cmp_ge_u32 s10, 9
    s_cbranch_scc1 p2_nm2m2a
    v_lshrrev_b32 v84, 1, v112
    s_add_u32 s44, s20, s42
    buffer_load_dwordx2 v[84:85], v84, s[4:7], s44 offen
p2_nm2m2a:
    buffer_load_dwordx4 v[72:75], v112, s[4:7], s20 offen offset:0
    buffer_load_dwordx4 v[76:79], v112, s[4:7], s20 offen offset:1024
    buffer_load_dwordx4 v[80:83], v112, s[4:7], s20 offen offset:2048
    s_waitcnt lgkmcnt(0)
    s_barrier
    s_setprio 3
    v_cmpx_lt_i16 vcc, 0x3fff, v48
    ds_read_b64 v[0:1], v0
    s_mov_b64 exec, -1
    v_cmpx_lt_i16 vcc, 0x3fff, v49
    ds_read_b64 v[2:3], v2
    s_mov_b64 exec, -1
    v_cmpx_lt_i16 vcc, 0x3fff, v50
    ds_read_b64 v[4:5], v4
    s_mov_b64 exec, -1
    v_cmpx_lt_i16 vcc, 0x3fff, v51
    ds_read_b64 v[6:7], v6
    s_mov_b64 exec, -1
    v_cmpx_lt_i16 vcc, 0x3fff, v52
    ds_read_b64 v[8:9], v8
    s_mov_b64 exec, -1
    v_cmpx_lt_i16 vcc, 0x3fff, v53
    ds_read_b64 v[10:11], v10
    s_mov_b64 exec, -1
    s_waitcnt lgkmcnt(15)
    s_nop 1
    v_readfirstlane_b32 s44, v125
    s_nop 0
    s_cmp_lg_u32 s44, 0
    s_cbranch_scc1 p2_advb
    s_add_u32 s61, s61, 1
    s_min_u32 s61, s61, 10
    v_mov_b32 v110, 0
    v_mov_b32 v111, 0
    s_cmp_eq_u32 s61, 10
    s_cbranch_scc1 p2_advb
    s_add_u32 s44, s61, s18
    s_cmp_ge_u32 s44, 10
    s_cselect_b32 s53, 10, 0
    s_sub_u32 s44, s44, s53
    s_mul_i32 s44, s44, 4160
    s_add_u32 s44, s44, s40
    v_bfe_i32 v111, v112, 6, 1
    v_lshrrev_b32 v110, 6, v112
    v_bitop3_b32 v111, v111, 15, s10 bitop3:0x6a
    v_lshl_or_b32 v110, v110, 4, v111
    v_bfe_u32 v111, v112, 2, 4
    v_mul_u32_u24 v110, 41600, v110
    v_add_u32 v111, v110, v111
    v_add_u32 v110, 256, v112
    v_and_b32 v110, 0x400, v110
    v_lshl_or_b32 v111, v110, 20, v111
    buffer_load_dword v110, v111, s[4:7], s44 offen
    buffer_load_dword v111, v111, s[4:7], s44 offen offset:16
p2_advb:
    s_cmp_lg_u32 s10, 15
    s_cbranch_scc1 p2_ntg
    s_lshr_b32 s44, s2, 3
    s_mul_i32 s44, s44, 5120
    s_add_u32 s45, s60, s18
    s_cmp_ge_u32 s45, 10
    s_cselect_b32 s53, 10, 0
    s_sub_u32 s45, s45, s53
    s_mul_i32 s45, s45, 645120
    s_add_u32 s44, s44, s45
    s_add_u32 s44, s44, s62
    s_sub_u32 s44, s44, s23
    v_lshlrev_b32 v84, 3, v112
    s_mov_b32 exec_hi, 0xff
    buffer_load_dword v85, v84, s[4:7], s44 offen
    s_mov_b64 exec, -1
p2_ntg:
    v_cmpx_lt_i16 vcc, 0x3fff, v54
    ds_read_b64 v[12:13], v12
    s_mov_b64 exec, -1
    v_cmpx_lt_i16 vcc, 0x3fff, v55
    ds_read_b64 v[14:15], v14
    s_mov_b64 exec, -1
    v_cmpx_lt_i16 vcc, 0x3fff, v56
    ds_read_b64 v[16:17], v16
    s_mov_b64 exec, -1
    s_cmp_lt_u32 s15, 8
    s_cbranch_scc1 p2_g2r13
    v_cmpx_lt_i16 vcc, 0x3fff, v57
    ds_read_b64 v[18:19], v18
    s_mov_b64 exec, -1
    v_cmpx_lt_i16 vcc, 0x3fff, v58
    ds_read_b64 v[20:21], v20
    s_mov_b64 exec, -1
    v_cmpx_lt_i16 vcc, 0x3fff, v59
    ds_read_b64 v[22:23], v22
    s_mov_b64 exec, -1
p2_g2r13:
    v_bfe_u32 v98, v109, 14, 4
    v_lshrrev_b32 v99, 18, v109
    v_and_b32 v109, 0x3fff, v109
    v_mad_u32_u24 v98, v98, s63, v99
    v_mad_u32_u24 v109, v98, s65, v109
    buffer_load_dwordx4 v[98:101], v109, s[68:71], 0 offen
    s_setprio 1
    v_cmpx_lt_i16 vcc, 0x3fff, v60
    ds_read_b64 v[24:25], v24
    s_mov_b64 exec, -1
    v_cmpx_lt_i16 vcc, 0x3fff, v61
    ds_read_b64 v[26:27], v26
    s_mov_b64 exec, -1
    v_cmpx_lt_i16 vcc, 0x3fff, v62
    ds_read_b64 v[28:29], v28
    s_mov_b64 exec, -1
    v_cmpx_lt_i16 vcc, 0x3fff, v63
    ds_read_b64 v[30:31], v30
    s_mov_b64 exec, -1
    v_cmpx_lt_i16 vcc, 0x3fff, v64
    ds_read_b64 v[32:33], v32
    s_mov_b64 exec, -1
    v_cmpx_lt_i16 vcc, 0x3fff, v65
    ds_read_b64 v[34:35], v34
    s_mov_b64 exec, -1
    s_nop 2
    s_nop 1
    v_max_u32_dpp v102, v102, v102 row_shr:1 row_mask:0xf bank_mask:0xf bound_ctrl:0
    v_max_u32_dpp v103, v103, v103 row_shr:1 row_mask:0xf bank_mask:0xf bound_ctrl:0
    s_nop 0
    v_max_u32_dpp v102, v102, v102 row_shr:2 row_mask:0xf bank_mask:0xf bound_ctrl:0
    v_max_u32_dpp v103, v103, v103 row_shr:2 row_mask:0xf bank_mask:0xf bound_ctrl:0
    s_nop 0
    v_max_u32_dpp v102, v102, v102 row_shr:4 row_mask:0xf bank_mask:0xf bound_ctrl:0
    v_max_u32_dpp v103, v103, v103 row_shr:4 row_mask:0xf bank_mask:0xf bound_ctrl:0
    s_nop 0
    v_max_u32_dpp v102, v102, v102 row_shr:8 row_mask:0xf bank_mask:0xf bound_ctrl:0
    v_max_u32_dpp v103, v103, v103 row_shr:8 row_mask:0xf bank_mask:0xf bound_ctrl:0
    s_nop 0
    v_max_u32_dpp v102, v102, v102 row_bcast:15 row_mask:0xa bank_mask:0xf
    v_max_u32_dpp v103, v103, v103 row_bcast:15 row_mask:0xa bank_mask:0xf
    s_nop 0
    v_max_u32_dpp v102, v102, v102 row_bcast:31 row_mask:0xc bank_mask:0xf
    v_max_u32_dpp v103, v103, v103 row_bcast:31 row_mask:0xc bank_mask:0xf
    s_nop 0
    s_nop 0
    v_max_u32 v102, s41, v102
    s_nop 0
    v_readlane_b32 s41, v102, 63
    v_add_u32 v102, v102, v112
    v_add_u32 v102, 4294963200, v102
    v_max_u32 v103, s41, v103
    s_nop 0
    v_readlane_b32 s41, v103, 63
    v_add_u32 v103, v103, v112
    v_add_u32 v103, 4294964224, v103
    v_cmpx_lt_i16 vcc, 0x3fff, v66
    ds_read_b64 v[36:37], v36
    s_mov_b64 exec, -1
    v_cmpx_lt_i16 vcc, 0x3fff, v67
    ds_read_b64 v[38:39], v38
    s_mov_b64 exec, -1
    v_cmpx_lt_i16 vcc, 0x3fff, v68
    ds_read_b64 v[40:41], v40
    s_mov_b64 exec, -1
    v_cmpx_lt_i16 vcc, 0x3fff, v69
    ds_read_b64 v[42:43], v42
    s_mov_b64 exec, -1
    v_cmpx_lt_i16 vcc, 0x3fff, v70
    ds_read_b64 v[44:45], v44
    s_mov_b64 exec, -1
    v_cmpx_lt_i16 vcc, 0x3fff, v71
    ds_read_b64 v[46:47], v46
    s_mov_b64 exec, -1
    s_waitcnt lgkmcnt(0)
    s_barrier
    s_waitcnt vmcnt(1)
    s_mov_b32 m0, s24
    s_cmp_ge_u32 s10, 9
    s_cbranch_scc1 p2_st2s2
    ds_write_addtid_b32 v84 offset:49152
    ds_write_addtid_b32 v85 offset:49408
p2_st2s2:
    s_mov_b32 m0, s23
    s_add_u32 s20, s60, s18
    s_cmp_ge_u32 s20, 10
    s_cselect_b32 s53, 10, 0
    s_sub_u32 s20, s20, s53
    s_mul_i32 s20, s20, 645120
    s_add_u32 s20, s20, s62
    ds_write_addtid_b32 v72 offset:0
    ds_write_addtid_b32 v73 offset:256
    ds_write_addtid_b32 v74 offset:512
    ds_write_addtid_b32 v75 offset:768
    ds_write_addtid_b32 v76 offset:1024
    ds_write_addtid_b32 v77 offset:1280
    ds_write_addtid_b32 v78 offset:1536
    ds_write_addtid_b32 v79 offset:1792
    ds_write_addtid_b32 v80 offset:2048
    ds_write_addtid_b32 v81 offset:2304
    ds_write_addtid_b32 v82 offset:2560
    ds_write_addtid_b32 v83 offset:2816
    s_nop 2
    s_nop 1
    v_max_u32_dpp v104, v104, v104 row_shr:1 row_mask:0xf bank_mask:0xf bound_ctrl:0
    v_max_u32_dpp v105, v105, v105 row_shr:1 row_mask:0xf bank_mask:0xf bound_ctrl:0
    s_nop 0
    v_max_u32_dpp v104, v104, v104 row_shr:2 row_mask:0xf bank_mask:0xf bound_ctrl:0
    v_max_u32_dpp v105, v105, v105 row_shr:2 row_mask:0xf bank_mask:0xf bound_ctrl:0
    s_nop 0
    v_max_u32_dpp v104, v104, v104 row_shr:4 row_mask:0xf bank_mask:0xf bound_ctrl:0
    v_max_u32_dpp v105, v105, v105 row_shr:4 row_mask:0xf bank_mask:0xf bound_ctrl:0
    s_nop 0
    v_max_u32_dpp v104, v104, v104 row_shr:8 row_mask:0xf bank_mask:0xf bound_ctrl:0
    v_max_u32_dpp v105, v105, v105 row_shr:8 row_mask:0xf bank_mask:0xf bound_ctrl:0
    s_nop 0
    v_max_u32_dpp v104, v104, v104 row_bcast:15 row_mask:0xa bank_mask:0xf
    v_max_u32_dpp v105, v105, v105 row_bcast:15 row_mask:0xa bank_mask:0xf
    s_nop 0
    v_max_u32_dpp v104, v104, v104 row_bcast:31 row_mask:0xc bank_mask:0xf
    v_max_u32_dpp v105, v105, v105 row_bcast:31 row_mask:0xc bank_mask:0xf
    s_nop 0
    s_nop 0
    v_max_u32 v104, s41, v104
    s_nop 0
    v_readlane_b32 s41, v104, 63
    v_add_u32 v104, v104, v112
    v_add_u32 v104, 4294965248, v104
    v_max_u32 v105, s41, v105
    s_nop 0
    v_readlane_b32 s41, v105, 63
    v_add_u32 v105, v105, v112
    v_add_u32 v105, 4294966272, v105
    s_waitcnt lgkmcnt(0)
    s_barrier
    s_branch p2_top
p2_fin:
    s_waitcnt vmcnt(0) lgkmcnt(0)
    s_barrier
    s_mov_b32 s48, s11
    s_mul_i32 s44, s48, 800768
    s_mul_i32 s45, s12, 12512
    s_add_u32 s49, s44, s45
    s_lshl_b32 s44, s49, 3
    s_add_u32 s44, s44, 492278784
    s_lshl_b32 s48, s48, 2
    s_lshl_b32 s45, s12, 4
    s_add_u32 s48, s48, s45
    s_add_u32 s48, s48, 492277760
    v_add_u32 v123, s64, v112
    v_add_u32 v122, s25, v123
    v_mov_b32 v24, 0
    v_mov_b32 v25, 0
    v_mov_b32 v26, 0
    v_mov_b32 v27, 0
    v_cmp_gt_u32 vcc, 1792, v123
    v_mov_b32 v124, 0x38000000
    v_mov_b32 v126, 0
    v_cndmask_b32 v124, v124, v123, vcc
    ds_read_b128 v[0:3], v122 offset:0
    ds_read_b128 v[4:7], v122 offset:16384
    ds_read_b128 v[8:11], v122 offset:32768
    v_add_u32 v122, 49152, v122
    ds_read_b128 v[12:15], v122 offset:0
    ds_read_b128 v[16:19], v122 offset:16384
    ds_read_b128 v[20:23], v122 offset:32768
    s_mov_b64 exec, vcc
    ds_read_b128 v[24:27], v122 offset:49152
    s_mov_b64 exec, -1
    s_cmp_lg_u32 s21, 0
    s_cbranch_scc1 p2_finf
    s_waitcnt lgkmcnt(6)
    buffer_store_dwordx4 v[0:3], v123, s[4:7], s44 offen nt
    s_add_u32 s44, s44, 16384
    s_waitcnt lgkmcnt(5)
    buffer_store_dwordx4 v[4:7], v123, s[4:7], s44 offen nt
    s_add_u32 s44, s44, 16384
    s_waitcnt lgkmcnt(4)
    buffer_store_dwordx4 v[8:11], v123, s[4:7], s44 offen nt
    s_add_u32 s44, s44, 16384
    s_waitcnt lgkmcnt(3)
    buffer_store_dwordx4 v[12:15], v123, s[4:7], s44 offen nt
    s_add_u32 s44, s44, 16384
    s_waitcnt lgkmcnt(2)
    buffer_store_dwordx4 v[16:19], v123, s[4:7], s44 offen nt
    s_add_u32 s44, s44, 16384
    s_waitcnt lgkmcnt(1)
    buffer_store_dwordx4 v[20:23], v123, s[4:7], s44 offen nt
    s_add_u32 s44, s44, 16384
    s_waitcnt lgkmcnt(0)
    buffer_store_dwordx4 v[24:27], v124, s[4:7], s44 offen nt
    s_add_u32 s44, s44, 16384
    v_bitop3_b32 v115, v115, v0, v1 bitop3:0xfe
    v_bitop3_b32 v115, v115, v2, v3 bitop3:0xfe
    v_bitop3_b32 v115, v115, v4, v5 bitop3:0xfe
    v_bitop3_b32 v115, v115, v6, v7 bitop3:0xfe
    v_bitop3_b32 v115, v115, v8, v9 bitop3:0xfe
    v_bitop3_b32 v115, v115, v10, v11 bitop3:0xfe
    v_bitop3_b32 v115, v115, v12, v13 bitop3:0xfe
    v_bitop3_b32 v115, v115, v14, v15 bitop3:0xfe
    v_bitop3_b32 v115, v115, v16, v17 bitop3:0xfe
    v_bitop3_b32 v115, v115, v18, v19 bitop3:0xfe
    v_bitop3_b32 v115, v115, v20, v21 bitop3:0xfe
    v_bitop3_b32 v115, v115, v22, v23 bitop3:0xfe
    v_bitop3_b32 v115, v115, v24, v25 bitop3:0xfe
    v_bitop3_b32 v115, v115, v26, v27 bitop3:0xfe
    v_bitop3_b32 v115, v115, v116, v117 bitop3:0xfe
    v_bitop3_b32 v115, v115, v118, v119 bitop3:0xfe
    v_bitop3_b32 v115, v115, v120, v121 bitop3:0xfe
    v_and_b32 v115, 0x80008000, v115
    v_cmpx_ne_u32 vcc, 0, v115
    ds_write_b32 v126, v115 offset:53768
    s_mov_b64 exec, -1
    s_waitcnt lgkmcnt(0)
    s_barrier
    ds_read_b32 v125, v126 offset:53768
    s_waitcnt lgkmcnt(0)
    v_readfirstlane_b32 s45, v125
    s_nop 0
    s_cmp_eq_u32 s45, 0
    s_cbranch_scc1 p2_done
    s_mov_b32 s21, 1
    s_waitcnt vmcnt(0)
    s_branch p2_restart
p2_finf:
    s_lshl_b32 s49, s49, 4
    s_lshl_b32 s45, s21, 3
    s_add_u32 s49, s49, s45
    s_add_u32 s49, s49, 517903352
    v_mov_b32 v28, 1073758208
    v_mov_b32 v29, 1073758208
    v_mov_b32 v30, 1073758208
    v_mov_b32 v31, 1073758208
    v_lshlrev_b32 v122, 1, v123
    v_lshlrev_b32 v125, 1, v124
    s_waitcnt lgkmcnt(0)
    buffer_store_dwordx4 v[28:31], v123, s[4:7], s44 offen
    s_add_u32 s44, s44, 16384
    buffer_store_dwordx2 v[0:1], v122, s[4:7], s49 offen offset:0
    buffer_store_dwordx2 v[2:3], v122, s[4:7], s49 offen offset:16
    s_add_u32 s49, s49, 32768
    buffer_store_dwordx4 v[28:31], v123, s[4:7], s44 offen
    s_add_u32 s44, s44, 16384
    buffer_store_dwordx2 v[4:5], v122, s[4:7], s49 offen offset:0
    buffer_store_dwordx2 v[6:7], v122, s[4:7], s49 offen offset:16
    s_add_u32 s49, s49, 32768
    buffer_store_dwordx4 v[28:31], v123, s[4:7], s44 offen
    s_add_u32 s44, s44, 16384
    buffer_store_dwordx2 v[8:9], v122, s[4:7], s49 offen offset:0
    buffer_store_dwordx2 v[10:11], v122, s[4:7], s49 offen offset:16
    s_add_u32 s49, s49, 32768
    buffer_store_dwordx4 v[28:31], v123, s[4:7], s44 offen
    s_add_u32 s44, s44, 16384
    buffer_store_dwordx2 v[12:13], v122, s[4:7], s49 offen offset:0
    buffer_store_dwordx2 v[14:15], v122, s[4:7], s49 offen offset:16
    s_add_u32 s49, s49, 32768
    buffer_store_dwordx4 v[28:31], v123, s[4:7], s44 offen
    s_add_u32 s44, s44, 16384
    buffer_store_dwordx2 v[16:17], v122, s[4:7], s49 offen offset:0
    buffer_store_dwordx2 v[18:19], v122, s[4:7], s49 offen offset:16
    s_add_u32 s49, s49, 32768
    buffer_store_dwordx4 v[28:31], v123, s[4:7], s44 offen
    s_add_u32 s44, s44, 16384
    buffer_store_dwordx2 v[20:21], v122, s[4:7], s49 offen offset:0
    buffer_store_dwordx2 v[22:23], v122, s[4:7], s49 offen offset:16
    s_add_u32 s49, s49, 32768
    buffer_store_dwordx4 v[28:31], v124, s[4:7], s44 offen
    s_add_u32 s44, s44, 16384
    buffer_store_dwordx2 v[24:25], v125, s[4:7], s49 offen offset:0
    buffer_store_dwordx2 v[26:27], v125, s[4:7], s49 offen offset:16
    s_add_u32 s49, s49, 32768
    s_add_u32 s21, s21, 1
    s_mov_b32 s30, 0
    s_waitcnt vmcnt(0)
    s_cmp_eq_u32 s21, 2
    s_cbranch_scc1 p2_restart
p2_done:
    v_mov_b32 v125, s30
    buffer_store_dword v125, v126, s[4:7], s48 offen
p2_end:
    s_endpgm
.globl p3_kernel
.p2align 8
.type p3_kernel,@function
p3_kernel:
    s_cmp_ge_u32 s2, 1563
    s_cbranch_scc1 p3_end
    s_load_dwordx2 s[4:5], s[0:1], 0
    s_load_dwordx2 s[6:7], s[0:1], 24
    s_load_dwordx2 s[8:9], s[0:1], 40
    s_load_dwordx8 s[12:19], s[0:1], 56
    s_load_dwordx2 s[10:11], s[0:1], 88
    s_load_dwordx2 s[20:21], s[0:1], 104
    s_lshl_b32 s3, s2, 8
    v_add_u32 v0, s3, v0
    v_lshlrev_b32 v2, 4, v0
    v_lshlrev_b32 v3, 2, v0
    v_add_u32 v0, v0, v0
    v_mul_hi_u32_u24 v1, 343268, v0
    v_lshlrev_b16 v1, 4, v1
    s_waitcnt lgkmcnt(0)
    s_load_dwordx4 s[32:35], s[8:9], 0
    s_load_dwordx16 s[36:51], s[12:13], 0
    s_load_dwordx16 s[52:67], s[14:15], 0
    s_load_dwordx8 s[68:75], s[16:17], 0
    s_load_dwordx8 s[76:83], s[18:19], 0
    s_mov_b32 s24, s6
    s_and_b32 s25, s7, 0xffff
    s_mov_b32 s26, 1600000
    s_mov_b32 s27, 0x20000
    buffer_load_dword v4, v3, s[24:27], 0 offen nt
    s_mov_b32 s28, s20
    s_and_b32 s29, s21, 0xffff
    s_mov_b32 s30, 819200000
    s_mov_b32 s31, 0x20000
    s_mov_b32 s22, 492278784
    buffer_load_dwordx4 v[40:43], v2, s[28:31], s22 offen nt
    s_mov_b32 s22, 498684928
    buffer_load_dwordx4 v[44:47], v2, s[28:31], s22 offen nt
    s_mov_b32 s22, 505091072
    buffer_load_dwordx4 v[48:51], v2, s[28:31], s22 offen nt
    s_mov_b32 s22, 511497216
    buffer_load_dwordx4 v[52:55], v2, s[28:31], s22 offen nt
    s_mov_b32 s22, 492277760
    buffer_load_dwordx4 v[56:59], v1, s[28:31], s22 offen
    s_mov_b32 s24, s4
    s_and_b32 s25, s5, 0xffff
    s_mov_b32 s26, 6400000
    s_mov_b32 s27, 0x20000
    buffer_load_dwordx4 v[60:63], v2, s[24:27], 0 offen nt
    s_mov_b32 s24, s10
    s_and_b32 s25, s11, 0xffff
    s_mov_b32 s26, 6400000
    s_mov_b32 s27, 0x20000
    s_waitcnt vmcnt(6) lgkmcnt(0)
    v_and_b32 v5, 0xffff0000, v4
    v_lshlrev_b32 v4, 16, v4
    s_lshl_b32 s14, s32, 16
    s_and_b32 s15, s32, 0xffff0000
    v_pk_add_f32 v[8:9], v[4:5], s[14:15] op_sel:[0,0] op_sel_hi:[0,1] neg_lo:[0,1] neg_hi:[0,1]
    v_pk_add_f32 v[16:17], v[4:5], s[14:15] op_sel:[1,0] op_sel_hi:[1,1] neg_lo:[0,1] neg_hi:[0,1]
    s_lshl_b32 s16, s33, 16
    s_and_b32 s17, s33, 0xffff0000
    v_pk_add_f32 v[10:11], v[4:5], s[16:17] op_sel:[0,0] op_sel_hi:[0,1] neg_lo:[0,1] neg_hi:[0,1]
    v_pk_add_f32 v[18:19], v[4:5], s[16:17] op_sel:[1,0] op_sel_hi:[1,1] neg_lo:[0,1] neg_hi:[0,1]
    s_lshl_b32 s18, s34, 16
    s_and_b32 s19, s34, 0xffff0000
    v_pk_add_f32 v[12:13], v[4:5], s[18:19] op_sel:[0,0] op_sel_hi:[0,1] neg_lo:[0,1] neg_hi:[0,1]
    v_pk_add_f32 v[20:21], v[4:5], s[18:19] op_sel:[1,0] op_sel_hi:[1,1] neg_lo:[0,1] neg_hi:[0,1]
    s_lshl_b32 s12, s35, 16
    s_and_b32 s13, s35, 0xffff0000
    v_pk_add_f32 v[14:15], v[4:5], s[12:13] op_sel:[0,0] op_sel_hi:[0,1] neg_lo:[0,1] neg_hi:[0,1]
    v_pk_add_f32 v[22:23], v[4:5], s[12:13] op_sel:[1,0] op_sel_hi:[1,1] neg_lo:[0,1] neg_hi:[0,1]
    v_cvt_pk_bf16_f32 v8, v8, v9
    v_cvt_pk_bf16_f32 v10, v10, v11
    v_cvt_pk_bf16_f32 v12, v12, v13
    v_cvt_pk_bf16_f32 v14, v14, v15
    v_cvt_pk_bf16_f32 v16, v16, v17
    v_cvt_pk_bf16_f32 v18, v18, v19
    v_cvt_pk_bf16_f32 v20, v20, v21
    v_cvt_pk_bf16_f32 v22, v22, v23
    v_and_b32 v9, 0xffff0000, v8
    v_lshlrev_b32 v8, 16, v8
    v_and_b32 v11, 0xffff0000, v10
    v_lshlrev_b32 v10, 16, v10
    v_and_b32 v13, 0xffff0000, v12
    v_lshlrev_b32 v12, 16, v12
    v_and_b32 v15, 0xffff0000, v14
    v_lshlrev_b32 v14, 16, v14
    v_and_b32 v17, 0xffff0000, v16
    v_lshlrev_b32 v16, 16, v16
    v_and_b32 v19, 0xffff0000, v18
    v_lshlrev_b32 v18, 16, v18
    v_and_b32 v21, 0xffff0000, v20
    v_lshlrev_b32 v20, 16, v20
    v_and_b32 v23, 0xffff0000, v22
    v_lshlrev_b32 v22, 16, v22
    v_mul_f32 v8, v8, v8
    v_mul_f32 v9, v9, v9
    v_mul_f32 v10, v10, v10
    v_mul_f32 v11, v11, v11
    v_mul_f32 v12, v12, v12
    v_mul_f32 v13, v13, v13
    v_mul_f32 v14, v14, v14
    v_mul_f32 v15, v15, v15
    v_mul_f32 v16, v16, v16
    v_mul_f32 v17, v17, v17
    v_mul_f32 v18, v18, v18
    v_mul_f32 v19, v19, v19
    v_mul_f32 v20, v20, v20
    v_mul_f32 v21, v21, v21
    v_mul_f32 v22, v22, v22
    v_mul_f32 v23, v23, v23
    v_cvt_pk_bf16_f32 v8, v8, v9
    v_cvt_pk_bf16_f32 v10, v10, v11
    v_cvt_pk_bf16_f32 v12, v12, v13
    v_cvt_pk_bf16_f32 v14, v14, v15
    v_cvt_pk_bf16_f32 v16, v16, v17
    v_cvt_pk_bf16_f32 v18, v18, v19
    v_cvt_pk_bf16_f32 v20, v20, v21
    v_cvt_pk_bf16_f32 v22, v22, v23
    v_and_b32 v9, 0xffff0000, v8
    v_lshlrev_b32 v8, 16, v8
    v_and_b32 v11, 0xffff0000, v10
    v_lshlrev_b32 v10, 16, v10
    v_and_b32 v13, 0xffff0000, v12
    v_lshlrev_b32 v12, 16, v12
    v_and_b32 v15, 0xffff0000, v14
    v_lshlrev_b32 v14, 16, v14
    v_and_b32 v17, 0xffff0000, v16
    v_lshlrev_b32 v16, 16, v16
    v_and_b32 v19, 0xffff0000, v18
    v_lshlrev_b32 v18, 16, v18
    v_and_b32 v21, 0xffff0000, v20
    v_lshlrev_b32 v20, 16, v20
    v_and_b32 v23, 0xffff0000, v22
    v_lshlrev_b32 v22, 16, v22
    v_mul_f32 v8, 0xc1200000, v8
    v_mul_f32 v9, 0xc1200000, v9
    v_mul_f32 v10, 0xc1200000, v10
    v_mul_f32 v11, 0xc1200000, v11
    v_mul_f32 v12, 0xc1200000, v12
    v_mul_f32 v13, 0xc1200000, v13
    v_mul_f32 v14, 0xc1200000, v14
    v_mul_f32 v15, 0xc1200000, v15
    v_mul_f32 v16, 0xc1200000, v16
    v_mul_f32 v17, 0xc1200000, v17
    v_mul_f32 v18, 0xc1200000, v18
    v_mul_f32 v19, 0xc1200000, v19
    v_mul_f32 v20, 0xc1200000, v20
    v_mul_f32 v21, 0xc1200000, v21
    v_mul_f32 v22, 0xc1200000, v22
    v_mul_f32 v23, 0xc1200000, v23
    v_cvt_pk_bf16_f32 v8, v8, v9
    v_cvt_pk_bf16_f32 v10, v10, v11
    v_cvt_pk_bf16_f32 v12, v12, v13
    v_cvt_pk_bf16_f32 v14, v14, v15
    v_cvt_pk_bf16_f32 v16, v16, v17
    v_cvt_pk_bf16_f32 v18, v18, v19
    v_cvt_pk_bf16_f32 v20, v20, v21
    v_cvt_pk_bf16_f32 v22, v22, v23
    v_and_b32 v9, 0xffff0000, v8
    v_lshlrev_b32 v8, 16, v8
    v_and_b32 v11, 0xffff0000, v10
    v_lshlrev_b32 v10, 16, v10
    v_and_b32 v13, 0xffff0000, v12
    v_lshlrev_b32 v12, 16, v12
    v_and_b32 v15, 0xffff0000, v14
    v_lshlrev_b32 v14, 16, v14
    v_and_b32 v17, 0xffff0000, v16
    v_lshlrev_b32 v16, 16, v16
    v_and_b32 v19, 0xffff0000, v18
    v_lshlrev_b32 v18, 16, v18
    v_and_b32 v21, 0xffff0000, v20
    v_lshlrev_b32 v20, 16, v20
    v_and_b32 v23, 0xffff0000, v22
    v_lshlrev_b32 v22, 16, v22
    v_mul_f32 v8, 0x3fb8aa3b, v8
    v_mul_f32 v9, 0x3fb8aa3b, v9
    v_mul_f32 v10, 0x3fb8aa3b, v10
    v_mul_f32 v11, 0x3fb8aa3b, v11
    v_mul_f32 v12, 0x3fb8aa3b, v12
    v_mul_f32 v13, 0x3fb8aa3b, v13
    v_mul_f32 v14, 0x3fb8aa3b, v14
    v_mul_f32 v15, 0x3fb8aa3b, v15
    v_mul_f32 v16, 0x3fb8aa3b, v16
    v_mul_f32 v17, 0x3fb8aa3b, v17
    v_mul_f32 v18, 0x3fb8aa3b, v18
    v_mul_f32 v19, 0x3fb8aa3b, v19
    v_mul_f32 v20, 0x3fb8aa3b, v20
    v_mul_f32 v21, 0x3fb8aa3b, v21
    v_mul_f32 v22, 0x3fb8aa3b, v22
    v_mul_f32 v23, 0x3fb8aa3b, v23
    v_exp_f32 v8, v8
    v_exp_f32 v9, v9
    v_exp_f32 v10, v10
    v_exp_f32 v11, v11
    v_exp_f32 v12, v12
    v_exp_f32 v13, v13
    v_exp_f32 v14, v14
    v_exp_f32 v15, v15
    v_exp_f32 v16, v16
    v_exp_f32 v17, v17
    v_exp_f32 v18, v18
    v_exp_f32 v19, v19
    v_exp_f32 v20, v20
    v_exp_f32 v21, v21
    v_exp_f32 v22, v22
    v_exp_f32 v23, v23
    s_nop 0
    v_cvt_pk_bf16_f32 v8, v8, v9
    v_cvt_pk_bf16_f32 v10, v10, v11
    v_cvt_pk_bf16_f32 v12, v12, v13
    v_cvt_pk_bf16_f32 v14, v14, v15
    v_cvt_pk_bf16_f32 v16, v16, v17
    v_cvt_pk_bf16_f32 v18, v18, v19
    v_cvt_pk_bf16_f32 v20, v20, v21
    v_cvt_pk_bf16_f32 v22, v22, v23
    v_and_b32 v9, 0xffff0000, v8
    v_lshlrev_b32 v8, 16, v8
    v_and_b32 v11, 0xffff0000, v10
    v_lshlrev_b32 v10, 16, v10
    v_and_b32 v13, 0xffff0000, v12
    v_lshlrev_b32 v12, 16, v12
    v_and_b32 v15, 0xffff0000, v14
    v_lshlrev_b32 v14, 16, v14
    v_and_b32 v17, 0xffff0000, v16
    v_lshlrev_b32 v16, 16, v16
    v_and_b32 v19, 0xffff0000, v18
    v_lshlrev_b32 v18, 16, v18
    v_and_b32 v21, 0xffff0000, v20
    v_lshlrev_b32 v20, 16, v20
    v_and_b32 v23, 0xffff0000, v22
    v_lshlrev_b32 v22, 16, v22
    s_lshl_b32 s14, s52, 16
    s_and_b32 s15, s52, 0xffff0000
    v_pk_mul_f32 v[24:25], v[8:9], s[14:15] op_sel:[0,0] op_sel_hi:[0,1]
    v_pk_mul_f32 v[28:29], v[16:17], s[14:15] op_sel:[0,0] op_sel_hi:[0,1]
    s_lshl_b32 s16, s53, 16
    s_and_b32 s17, s53, 0xffff0000
    v_pk_mul_f32 v[26:27], v[8:9], s[16:17] op_sel:[0,0] op_sel_hi:[0,1]
    v_pk_mul_f32 v[30:31], v[16:17], s[16:17] op_sel:[0,0] op_sel_hi:[0,1]
    s_lshl_b32 s18, s54, 16
    s_and_b32 s19, s54, 0xffff0000
    v_pk_fma_f32 v[24:25], v[8:9], s[18:19], v[24:25] op_sel:[1,0,0] op_sel_hi:[1,1,1]
    v_pk_fma_f32 v[28:29], v[16:17], s[18:19], v[28:29] op_sel:[1,0,0] op_sel_hi:[1,1,1]
    s_lshl_b32 s12, s55, 16
    s_and_b32 s13, s55, 0xffff0000
    v_pk_fma_f32 v[26:27], v[8:9], s[12:13], v[26:27] op_sel:[1,0,0] op_sel_hi:[1,1,1]
    v_pk_fma_f32 v[30:31], v[16:17], s[12:13], v[30:31] op_sel:[1,0,0] op_sel_hi:[1,1,1]
    s_lshl_b32 s14, s56, 16
    s_and_b32 s15, s56, 0xffff0000
    v_pk_fma_f32 v[24:25], v[10:11], s[14:15], v[24:25] op_sel:[0,0,0] op_sel_hi:[0,1,1]
    v_pk_fma_f32 v[28:29], v[18:19], s[14:15], v[28:29] op_sel:[0,0,0] op_sel_hi:[0,1,1]
    s_lshl_b32 s16, s57, 16
    s_and_b32 s17, s57, 0xffff0000
    v_pk_fma_f32 v[26:27], v[10:11], s[16:17], v[26:27] op_sel:[0,0,0] op_sel_hi:[0,1,1]
    v_pk_fma_f32 v[30:31], v[18:19], s[16:17], v[30:31] op_sel:[0,0,0] op_sel_hi:[0,1,1]
    s_lshl_b32 s18, s58, 16
    s_and_b32 s19, s58, 0xffff0000
    v_pk_fma_f32 v[24:25], v[10:11], s[18:19], v[24:25] op_sel:[1,0,0] op_sel_hi:[1,1,1]
    v_pk_fma_f32 v[28:29], v[18:19], s[18:19], v[28:29] op_sel:[1,0,0] op_sel_hi:[1,1,1]
    s_lshl_b32 s12, s59, 16
    s_and_b32 s13, s59, 0xffff0000
    v_pk_fma_f32 v[26:27], v[10:11], s[12:13], v[26:27] op_sel:[1,0,0] op_sel_hi:[1,1,1]
    v_pk_fma_f32 v[30:31], v[18:19], s[12:13], v[30:31] op_sel:[1,0,0] op_sel_hi:[1,1,1]
    s_lshl_b32 s14, s60, 16
    s_and_b32 s15, s60, 0xffff0000
    v_pk_fma_f32 v[24:25], v[12:13], s[14:15], v[24:25] op_sel:[0,0,0] op_sel_hi:[0,1,1]
    v_pk_fma_f32 v[28:29], v[20:21], s[14:15], v[28:29] op_sel:[0,0,0] op_sel_hi:[0,1,1]
    s_lshl_b32 s16, s61, 16
    s_and_b32 s17, s61, 0xffff0000
    v_pk_fma_f32 v[26:27], v[12:13], s[16:17], v[26:27] op_sel:[0,0,0] op_sel_hi:[0,1,1]
    v_pk_fma_f32 v[30:31], v[20:21], s[16:17], v[30:31] op_sel:[0,0,0] op_sel_hi:[0,1,1]
    s_lshl_b32 s18, s62, 16
    s_and_b32 s19, s62, 0xffff0000
    v_pk_fma_f32 v[24:25], v[12:13], s[18:19], v[24:25] op_sel:[1,0,0] op_sel_hi:[1,1,1]
    v_pk_fma_f32 v[28:29], v[20:21], s[18:19], v[28:29] op_sel:[1,0,0] op_sel_hi:[1,1,1]
    s_lshl_b32 s12, s63, 16
    s_and_b32 s13, s63, 0xffff0000
    v_pk_fma_f32 v[26:27], v[12:13], s[12:13], v[26:27] op_sel:[1,0,0] op_sel_hi:[1,1,1]
    v_pk_fma_f32 v[30:31], v[20:21], s[12:13], v[30:31] op_sel:[1,0,0] op_sel_hi:[1,1,1]
    s_lshl_b32 s14, s64, 16
    s_and_b32 s15, s64, 0xffff0000
    v_pk_fma_f32 v[24:25], v[14:15], s[14:15], v[24:25] op_sel:[0,0,0] op_sel_hi:[0,1,1]
    v_pk_fma_f32 v[28:29], v[22:23], s[14:15], v[28:29] op_sel:[0,0,0] op_sel_hi:[0,1,1]
    s_lshl_b32 s16, s65, 16
    s_and_b32 s17, s65, 0xffff0000
    v_pk_fma_f32 v[26:27], v[14:15], s[16:17], v[26:27] op_sel:[0,0,0] op_sel_hi:[0,1,1]
    v_pk_fma_f32 v[30:31], v[22:23], s[16:17], v[30:31] op_sel:[0,0,0] op_sel_hi:[0,1,1]
    s_lshl_b32 s18, s66, 16
    s_and_b32 s19, s66, 0xffff0000
    v_pk_fma_f32 v[24:25], v[14:15], s[18:19], v[24:25] op_sel:[1,0,0] op_sel_hi:[1,1,1]
    v_pk_fma_f32 v[28:29], v[22:23], s[18:19], v[28:29] op_sel:[1,0,0] op_sel_hi:[1,1,1]
    s_lshl_b32 s12, s67, 16
    s_and_b32 s13, s67, 0xffff0000
    v_pk_fma_f32 v[26:27], v[14:15], s[12:13], v[26:27] op_sel:[1,0,0] op_sel_hi:[1,1,1]
    v_pk_fma_f32 v[30:31], v[22:23], s[12:13], v[30:31] op_sel:[1,0,0] op_sel_hi:[1,1,1]
    s_lshl_b32 s14, s36, 16
    s_and_b32 s15, s36, 0xffff0000
    v_pk_mul_f32 v[32:33], v[8:9], s[14:15] op_sel:[0,0] op_sel_hi:[0,1]
    v_pk_mul_f32 v[36:37], v[16:17], s[14:15] op_sel:[0,0] op_sel_hi:[0,1]
    s_lshl_b32 s16, s37, 16
    s_and_b32 s17, s37, 0xffff0000
    v_pk_mul_f32 v[34:35], v[8:9], s[16:17] op_sel:[0,0] op_sel_hi:[0,1]
    v_pk_mul_f32 v[38:39], v[16:17], s[16:17] op_sel:[0,0] op_sel_hi:[0,1]
    s_lshl_b32 s18, s38, 16
    s_and_b32 s19, s38, 0xffff0000
    v_pk_fma_f32 v[32:33], v[8:9], s[18:19], v[32:33] op_sel:[1,0,0] op_sel_hi:[1,1,1]
    v_pk_fma_f32 v[36:37], v[16:17], s[18:19], v[36:37] op_sel:[1,0,0] op_sel_hi:[1,1,1]
    s_lshl_b32 s12, s39, 16
    s_and_b32 s13, s39, 0xffff0000
    v_pk_fma_f32 v[34:35], v[8:9], s[12:13], v[34:35] op_sel:[1,0,0] op_sel_hi:[1,1,1]
    v_pk_fma_f32 v[38:39], v[16:17], s[12:13], v[38:39] op_sel:[1,0,0] op_sel_hi:[1,1,1]
    s_lshl_b32 s14, s40, 16
    s_and_b32 s15, s40, 0xffff0000
    v_pk_fma_f32 v[32:33], v[10:11], s[14:15], v[32:33] op_sel:[0,0,0] op_sel_hi:[0,1,1]
    v_pk_fma_f32 v[36:37], v[18:19], s[14:15], v[36:37] op_sel:[0,0,0] op_sel_hi:[0,1,1]
    s_lshl_b32 s16, s41, 16
    s_and_b32 s17, s41, 0xffff0000
    v_pk_fma_f32 v[34:35], v[10:11], s[16:17], v[34:35] op_sel:[0,0,0] op_sel_hi:[0,1,1]
    v_pk_fma_f32 v[38:39], v[18:19], s[16:17], v[38:39] op_sel:[0,0,0] op_sel_hi:[0,1,1]
    s_lshl_b32 s18, s42, 16
    s_and_b32 s19, s42, 0xffff0000
    v_pk_fma_f32 v[32:33], v[10:11], s[18:19], v[32:33] op_sel:[1,0,0] op_sel_hi:[1,1,1]
    v_pk_fma_f32 v[36:37], v[18:19], s[18:19], v[36:37] op_sel:[1,0,0] op_sel_hi:[1,1,1]
    s_lshl_b32 s12, s43, 16
    s_and_b32 s13, s43, 0xffff0000
    v_pk_fma_f32 v[34:35], v[10:11], s[12:13], v[34:35] op_sel:[1,0,0] op_sel_hi:[1,1,1]
    v_pk_fma_f32 v[38:39], v[18:19], s[12:13], v[38:39] op_sel:[1,0,0] op_sel_hi:[1,1,1]
    s_lshl_b32 s14, s44, 16
    s_and_b32 s15, s44, 0xffff0000
    v_pk_fma_f32 v[32:33], v[12:13], s[14:15], v[32:33] op_sel:[0,0,0] op_sel_hi:[0,1,1]
    v_pk_fma_f32 v[36:37], v[20:21], s[14:15], v[36:37] op_sel:[0,0,0] op_sel_hi:[0,1,1]
    s_lshl_b32 s16, s45, 16
    s_and_b32 s17, s45, 0xffff0000
    v_pk_fma_f32 v[34:35], v[12:13], s[16:17], v[34:35] op_sel:[0,0,0] op_sel_hi:[0,1,1]
    v_pk_fma_f32 v[38:39], v[20:21], s[16:17], v[38:39] op_sel:[0,0,0] op_sel_hi:[0,1,1]
    s_lshl_b32 s18, s46, 16
    s_and_b32 s19, s46, 0xffff0000
    v_pk_fma_f32 v[32:33], v[12:13], s[18:19], v[32:33] op_sel:[1,0,0] op_sel_hi:[1,1,1]
    v_pk_fma_f32 v[36:37], v[20:21], s[18:19], v[36:37] op_sel:[1,0,0] op_sel_hi:[1,1,1]
    s_lshl_b32 s12, s47, 16
    s_and_b32 s13, s47, 0xffff0000
    v_pk_fma_f32 v[34:35], v[12:13], s[12:13], v[34:35] op_sel:[1,0,0] op_sel_hi:[1,1,1]
    v_pk_fma_f32 v[38:39], v[20:21], s[12:13], v[38:39] op_sel:[1,0,0] op_sel_hi:[1,1,1]
    s_lshl_b32 s14, s48, 16
    s_and_b32 s15, s48, 0xffff0000
    v_pk_fma_f32 v[32:33], v[14:15], s[14:15], v[32:33] op_sel:[0,0,0] op_sel_hi:[0,1,1]
    v_pk_fma_f32 v[36:37], v[22:23], s[14:15], v[36:37] op_sel:[0,0,0] op_sel_hi:[0,1,1]
    s_lshl_b32 s16, s49, 16
    s_and_b32 s17, s49, 0xffff0000
    v_pk_fma_f32 v[34:35], v[14:15], s[16:17], v[34:35] op_sel:[0,0,0] op_sel_hi:[0,1,1]
    v_pk_fma_f32 v[38:39], v[22:23], s[16:17], v[38:39] op_sel:[0,0,0] op_sel_hi:[0,1,1]
    s_lshl_b32 s18, s50, 16
    s_and_b32 s19, s50, 0xffff0000
    v_pk_fma_f32 v[32:33], v[14:15], s[18:19], v[32:33] op_sel:[1,0,0] op_sel_hi:[1,1,1]
    v_pk_fma_f32 v[36:37], v[22:23], s[18:19], v[36:37] op_sel:[1,0,0] op_sel_hi:[1,1,1]
    s_lshl_b32 s12, s51, 16
    s_and_b32 s13, s51, 0xffff0000
    v_pk_fma_f32 v[34:35], v[14:15], s[12:13], v[34:35] op_sel:[1,0,0] op_sel_hi:[1,1,1]
    v_pk_fma_f32 v[38:39], v[22:23], s[12:13], v[38:39] op_sel:[1,0,0] op_sel_hi:[1,1,1]
    v_cvt_pk_bf16_f32 v32, v32, v33
    v_cvt_pk_bf16_f32 v34, v34, v35
    v_cvt_pk_bf16_f32 v36, v36, v37
    v_cvt_pk_bf16_f32 v38, v38, v39
    v_and_b32 v33, 0xffff0000, v32
    v_lshlrev_b32 v32, 16, v32
    v_and_b32 v35, 0xffff0000, v34
    v_lshlrev_b32 v34, 16, v34
    v_and_b32 v37, 0xffff0000, v36
    v_lshlrev_b32 v36, 16, v36
    v_and_b32 v39, 0xffff0000, v38
    v_lshlrev_b32 v38, 16, v38
    s_waitcnt vmcnt(1)
    v_add_u32 v40, v40, v44
    v_add_u32 v48, v48, v52
    v_add_u32 v41, v41, v45
    v_add_u32 v49, v49, v53
    v_add_u32 v42, v42, v46
    v_add_u32 v50, v50, v54
    v_add_u32 v43, v43, v47
    v_add_u32 v51, v51, v55
    v_add_u32_sdwa v8, v40, v48 dst_sel:DWORD dst_unused:UNUSED_PAD src0_sel:WORD_0 src1_sel:WORD_0
    v_add_u32_sdwa v9, v40, v48 dst_sel:DWORD dst_unused:UNUSED_PAD src0_sel:WORD_1 src1_sel:WORD_1
    v_add_u32_sdwa v10, v41, v49 dst_sel:DWORD dst_unused:UNUSED_PAD src0_sel:WORD_0 src1_sel:WORD_0
    v_add_u32_sdwa v11, v41, v49 dst_sel:DWORD dst_unused:UNUSED_PAD src0_sel:WORD_1 src1_sel:WORD_1
    v_add_u32_sdwa v12, v42, v50 dst_sel:DWORD dst_unused:UNUSED_PAD src0_sel:WORD_0 src1_sel:WORD_0
    v_add_u32_sdwa v13, v42, v50 dst_sel:DWORD dst_unused:UNUSED_PAD src0_sel:WORD_1 src1_sel:WORD_1
    v_add_u32_sdwa v14, v43, v51 dst_sel:DWORD dst_unused:UNUSED_PAD src0_sel:WORD_0 src1_sel:WORD_0
    v_add_u32_sdwa v15, v43, v51 dst_sel:DWORD dst_unused:UNUSED_PAD src0_sel:WORD_1 src1_sel:WORD_1
    v_min3_u32 v5, v56, v57, v58
    v_bitop3_b32 v4, v56, v57, v58 bitop3:0xfe
    v_min_u32 v5, v5, v59
    v_or_b32 v4, v4, v59
    v_or_b32 v8, 0x4b000000, v8
    v_or_b32 v9, 0x4b000000, v9
    v_or_b32 v10, 0x4b000000, v10
    v_or_b32 v11, 0x4b000000, v11
    v_or_b32 v12, 0x4b000000, v12
    v_or_b32 v13, 0x4b000000, v13
    v_or_b32 v14, 0x4b000000, v14
    v_or_b32 v15, 0x4b000000, v15
    v_cmp_eq_u32 vcc, 0, v5
    v_add_f32 v8, 0xcb010000, v8
    v_add_f32 v9, 0xcb010000, v9
    v_add_f32 v10, 0xcb010000, v10
    v_add_f32 v11, 0xcb010000, v11
    v_add_f32 v12, 0xcb010000, v12
    v_add_f32 v13, 0xcb010000, v13
    v_add_f32 v14, 0xcb010000, v14
    v_add_f32 v15, 0xcb010000, v15
    v_mul_f32 v8, v4, v8
    v_mul_f32 v9, v4, v9
    v_mul_f32 v10, v4, v10
    v_mul_f32 v11, v4, v11
    v_mul_f32 v12, v4, v12
    v_mul_f32 v13, v4, v13
    v_mul_f32 v14, v4, v14
    v_mul_f32 v15, v4, v15
    s_cbranch_vccz p3_nof
    v_lshlrev_b32 v1, 4, v0
    v_mov_b32 v3, 0x70000000
    v_cmp_eq_u32 vcc, 0, v56
    s_mov_b32 s22, 517903360
    s_nop 0
    v_cndmask_b32 v5, v3, v1, vcc
    buffer_load_dwordx4 v[16:19], v5, s[28:31], s22 offen
    buffer_load_dwordx4 v[20:23], v5, s[28:31], s22 offen offset:16
    s_waitcnt vmcnt(0)
    v_add_f32 v8, v8, v16
    v_add_f32 v9, v9, v17
    v_add_f32 v10, v10, v18
    v_add_f32 v11, v11, v19
    v_add_f32 v12, v12, v20
    v_add_f32 v13, v13, v21
    v_add_f32 v14, v14, v22
    v_add_f32 v15, v15, v23
    v_cmp_eq_u32 vcc, 0, v57
    s_mov_b32 s22, 530715648
    s_nop 0
    v_cndmask_b32 v5, v3, v1, vcc
    buffer_load_dwordx4 v[16:19], v5, s[28:31], s22 offen
    buffer_load_dwordx4 v[20:23], v5, s[28:31], s22 offen offset:16
    s_waitcnt vmcnt(0)
    v_add_f32 v8, v8, v16
    v_add_f32 v9, v9, v17
    v_add_f32 v10, v10, v18
    v_add_f32 v11, v11, v19
    v_add_f32 v12, v12, v20
    v_add_f32 v13, v13, v21
    v_add_f32 v14, v14, v22
    v_add_f32 v15, v15, v23
    v_cmp_eq_u32 vcc, 0, v58
    s_mov_b32 s22, 543527936
    s_nop 0
    v_cndmask_b32 v5, v3, v1, vcc
    buffer_load_dwordx4 v[16:19], v5, s[28:31], s22 offen
    buffer_load_dwordx4 v[20:23], v5, s[28:31], s22 offen offset:16
    s_waitcnt vmcnt(0)
    v_add_f32 v8, v8, v16
    v_add_f32 v9, v9, v17
    v_add_f32 v10, v10, v18
    v_add_f32 v11, v11, v19
    v_add_f32 v12, v12, v20
    v_add_f32 v13, v13, v21
    v_add_f32 v14, v14, v22
    v_add_f32 v15, v15, v23
    v_cmp_eq_u32 vcc, 0, v59
    s_mov_b32 s22, 556340224
    s_nop 0
    v_cndmask_b32 v5, v3, v1, vcc
    buffer_load_dwordx4 v[16:19], v5, s[28:31], s22 offen
    buffer_load_dwordx4 v[20:23], v5, s[28:31], s22 offen offset:16
    s_waitcnt vmcnt(0)
    v_add_f32 v8, v8, v16
    v_add_f32 v9, v9, v17
    v_add_f32 v10, v10, v18
    v_add_f32 v11, v11, v19
    v_add_f32 v12, v12, v20
    v_add_f32 v13, v13, v21
    v_add_f32 v14, v14, v22
    v_add_f32 v15, v15, v23
p3_nof:
    s_lshl_b32 s14, s68, 16
    s_and_b32 s15, s68, 0xffff0000
    v_pk_mul_f32 v[16:17], v[8:9], s[14:15] op_sel:[0,0] op_sel_hi:[0,1]
    v_pk_mul_f32 v[20:21], v[12:13], s[14:15] op_sel:[0,0] op_sel_hi:[0,1]
    s_lshl_b32 s16, s69, 16
    s_and_b32 s17, s69, 0xffff0000
    v_pk_mul_f32 v[18:19], v[8:9], s[16:17] op_sel:[0,0] op_sel_hi:[0,1]
    v_pk_mul_f32 v[22:23], v[12:13], s[16:17] op_sel:[0,0] op_sel_hi:[0,1]
    s_lshl_b32 s18, s70, 16
    s_and_b32 s19, s70, 0xffff0000
    v_pk_fma_f32 v[16:17], v[8:9], s[18:19], v[16:17] op_sel:[1,0,0] op_sel_hi:[1,1,1]
    v_pk_fma_f32 v[20:21], v[12:13], s[18:19], v[20:21] op_sel:[1,0,0] op_sel_hi:[1,1,1]
    s_lshl_b32 s12, s71, 16
    s_and_b32 s13, s71, 0xffff0000
    v_pk_fma_f32 v[18:19], v[8:9], s[12:13], v[18:19] op_sel:[1,0,0] op_sel_hi:[1,1,1]
    v_pk_fma_f32 v[22:23], v[12:13], s[12:13], v[22:23] op_sel:[1,0,0] op_sel_hi:[1,1,1]
    s_lshl_b32 s14, s72, 16
    s_and_b32 s15, s72, 0xffff0000
    v_pk_fma_f32 v[16:17], v[10:11], s[14:15], v[16:17] op_sel:[0,0,0] op_sel_hi:[0,1,1]
    v_pk_fma_f32 v[20:21], v[14:15], s[14:15], v[20:21] op_sel:[0,0,0] op_sel_hi:[0,1,1]
    s_lshl_b32 s16, s73, 16
    s_and_b32 s17, s73, 0xffff0000
    v_pk_fma_f32 v[18:19], v[10:11], s[16:17], v[18:19] op_sel:[0,0,0] op_sel_hi:[0,1,1]
    v_pk_fma_f32 v[22:23], v[14:15], s[16:17], v[22:23] op_sel:[0,0,0] op_sel_hi:[0,1,1]
    s_lshl_b32 s18, s74, 16
    s_and_b32 s19, s74, 0xffff0000
    v_pk_fma_f32 v[16:17], v[10:11], s[18:19], v[16:17] op_sel:[1,0,0] op_sel_hi:[1,1,1]
    v_pk_fma_f32 v[20:21], v[14:15], s[18:19], v[20:21] op_sel:[1,0,0] op_sel_hi:[1,1,1]
    s_lshl_b32 s12, s75, 16
    s_and_b32 s13, s75, 0xffff0000
    v_pk_fma_f32 v[18:19], v[10:11], s[12:13], v[18:19] op_sel:[1,0,0] op_sel_hi:[1,1,1]
    v_pk_fma_f32 v[22:23], v[14:15], s[12:13], v[22:23] op_sel:[1,0,0] op_sel_hi:[1,1,1]
    v_mul_f32 v24, v24, v16
    v_mul_f32 v25, v25, v17
    v_mul_f32 v26, v26, v18
    v_mul_f32 v27, v27, v19
    v_mul_f32 v28, v28, v20
    v_mul_f32 v29, v29, v21
    v_mul_f32 v30, v30, v22
    v_mul_f32 v31, v31, v23
    v_cvt_pk_bf16_f32 v24, v24, v25
    v_cvt_pk_bf16_f32 v26, v26, v27
    v_cvt_pk_bf16_f32 v28, v28, v29
    v_cvt_pk_bf16_f32 v30, v30, v31
    v_and_b32 v25, 0xffff0000, v24
    v_lshlrev_b32 v24, 16, v24
    v_and_b32 v27, 0xffff0000, v26
    v_lshlrev_b32 v26, 16, v26
    v_and_b32 v29, 0xffff0000, v28
    v_lshlrev_b32 v28, 16, v28
    v_and_b32 v31, 0xffff0000, v30
    v_lshlrev_b32 v30, 16, v30
    s_lshl_b32 s14, s76, 16
    s_and_b32 s15, s76, 0xffff0000
    v_pk_mul_f32 v[16:17], v[24:25], s[14:15] op_sel:[0,0] op_sel_hi:[0,1]
    v_pk_mul_f32 v[20:21], v[28:29], s[14:15] op_sel:[0,0] op_sel_hi:[0,1]
    s_lshl_b32 s16, s77, 16
    s_and_b32 s17, s77, 0xffff0000
    v_pk_mul_f32 v[18:19], v[24:25], s[16:17] op_sel:[0,0] op_sel_hi:[0,1]
    v_pk_mul_f32 v[22:23], v[28:29], s[16:17] op_sel:[0,0] op_sel_hi:[0,1]
    s_lshl_b32 s18, s78, 16
    s_and_b32 s19, s78, 0xffff0000
    v_pk_fma_f32 v[16:17], v[24:25], s[18:19], v[16:17] op_sel:[1,0,0] op_sel_hi:[1,1,1]
    v_pk_fma_f32 v[20:21], v[28:29], s[18:19], v[20:21] op_sel:[1,0,0] op_sel_hi:[1,1,1]
    s_lshl_b32 s12, s79, 16
    s_and_b32 s13, s79, 0xffff0000
    v_pk_fma_f32 v[18:19], v[24:25], s[12:13], v[18:19] op_sel:[1,0,0] op_sel_hi:[1,1,1]
    v_pk_fma_f32 v[22:23], v[28:29], s[12:13], v[22:23] op_sel:[1,0,0] op_sel_hi:[1,1,1]
    s_lshl_b32 s14, s80, 16
    s_and_b32 s15, s80, 0xffff0000
    v_pk_fma_f32 v[16:17], v[26:27], s[14:15], v[16:17] op_sel:[0,0,0] op_sel_hi:[0,1,1]
    v_pk_fma_f32 v[20:21], v[30:31], s[14:15], v[20:21] op_sel:[0,0,0] op_sel_hi:[0,1,1]
    s_lshl_b32 s16, s81, 16
    s_and_b32 s17, s81, 0xffff0000
    v_pk_fma_f32 v[18:19], v[26:27], s[16:17], v[18:19] op_sel:[0,0,0] op_sel_hi:[0,1,1]
    v_pk_fma_f32 v[22:23], v[30:31], s[16:17], v[22:23] op_sel:[0,0,0] op_sel_hi:[0,1,1]
    s_lshl_b32 s18, s82, 16
    s_and_b32 s19, s82, 0xffff0000
    v_pk_fma_f32 v[16:17], v[26:27], s[18:19], v[16:17] op_sel:[1,0,0] op_sel_hi:[1,1,1]
    v_pk_fma_f32 v[20:21], v[30:31], s[18:19], v[20:21] op_sel:[1,0,0] op_sel_hi:[1,1,1]
    s_lshl_b32 s12, s83, 16
    s_and_b32 s13, s83, 0xffff0000
    v_pk_fma_f32 v[18:19], v[26:27], s[12:13], v[18:19] op_sel:[1,0,0] op_sel_hi:[1,1,1]
    v_pk_fma_f32 v[22:23], v[30:31], s[12:13], v[22:23] op_sel:[1,0,0] op_sel_hi:[1,1,1]
    v_cvt_pk_bf16_f32 v16, v16, v17
    v_cvt_pk_bf16_f32 v18, v18, v19
    v_cvt_pk_bf16_f32 v20, v20, v21
    v_cvt_pk_bf16_f32 v22, v22, v23
    v_and_b32 v17, 0xffff0000, v16
    v_lshlrev_b32 v16, 16, v16
    v_and_b32 v19, 0xffff0000, v18
    v_lshlrev_b32 v18, 16, v18
    v_and_b32 v21, 0xffff0000, v20
    v_lshlrev_b32 v20, 16, v20
    v_and_b32 v23, 0xffff0000, v22
    v_lshlrev_b32 v22, 16, v22
    v_mul_f32 v16, v16, v32
    v_mul_f32 v17, v17, v33
    v_mul_f32 v18, v18, v34
    v_mul_f32 v19, v19, v35
    v_mul_f32 v20, v20, v36
    v_mul_f32 v21, v21, v37
    v_mul_f32 v22, v22, v38
    v_mul_f32 v23, v23, v39
    v_cvt_pk_bf16_f32 v16, v16, v17
    v_cvt_pk_bf16_f32 v18, v18, v19
    v_cvt_pk_bf16_f32 v20, v20, v21
    v_cvt_pk_bf16_f32 v22, v22, v23
    v_and_b32 v17, 0xffff0000, v16
    v_lshlrev_b32 v16, 16, v16
    v_and_b32 v19, 0xffff0000, v18
    v_lshlrev_b32 v18, 16, v18
    v_and_b32 v21, 0xffff0000, v20
    v_lshlrev_b32 v20, 16, v20
    v_and_b32 v23, 0xffff0000, v22
    v_lshlrev_b32 v22, 16, v22
    s_waitcnt vmcnt(0)
    v_lshlrev_b32 v8, 16, v60
    v_and_b32 v9, 0xffff0000, v60
    v_lshlrev_b32 v10, 16, v61
    v_and_b32 v11, 0xffff0000, v61
    v_lshlrev_b32 v12, 16, v62
    v_and_b32 v13, 0xffff0000, v62
    v_lshlrev_b32 v14, 16, v63
    v_and_b32 v15, 0xffff0000, v63
    v_add_f32 v8, v8, v16
    v_add_f32 v9, v9, v17
    v_add_f32 v10, v10, v18
    v_add_f32 v11, v11, v19
    v_add_f32 v12, v12, v20
    v_add_f32 v13, v13, v21
    v_add_f32 v14, v14, v22
    v_add_f32 v15, v15, v23
    v_cvt_pk_bf16_f32 v4, v8, v9
    v_cvt_pk_bf16_f32 v5, v10, v11
    v_cvt_pk_bf16_f32 v6, v12, v13
    v_cvt_pk_bf16_f32 v7, v14, v15
    buffer_store_dwordx4 v[4:7], v2, s[24:27], 0 offen nt
p3_end:
    s_endpgm
.section .rodata,"a"
.p2align 6
.amdhsa_kernel p1_kernel
  .amdhsa_next_free_vgpr 128
  .amdhsa_next_free_sgpr 72
  .amdhsa_accum_offset 128
  .amdhsa_group_segment_fixed_size 0
  .amdhsa_kernarg_size 112
  .amdhsa_user_sgpr_count 2
  .amdhsa_user_sgpr_kernarg_segment_ptr 1
  .amdhsa_system_sgpr_workgroup_id_x 1
  .amdhsa_float_denorm_mode_32 3
.end_amdhsa_kernel
.p2align 6
.amdhsa_kernel p2_kernel
  .amdhsa_next_free_vgpr 128
  .amdhsa_next_free_sgpr 72
  .amdhsa_accum_offset 128
  .amdhsa_group_segment_fixed_size 0
  .amdhsa_kernarg_size 112
  .amdhsa_user_sgpr_count 2
  .amdhsa_user_sgpr_kernarg_segment_ptr 1
  .amdhsa_system_sgpr_workgroup_id_x 1
  .amdhsa_float_denorm_mode_32 3
.end_amdhsa_kernel
.p2align 6
.amdhsa_kernel p3_kernel
  .amdhsa_next_free_vgpr 64
  .amdhsa_next_free_sgpr 84
  .amdhsa_accum_offset 64
  .amdhsa_group_segment_fixed_size 0
  .amdhsa_kernarg_size 112
  .amdhsa_user_sgpr_count 2
  .amdhsa_user_sgpr_kernarg_segment_ptr 1
  .amdhsa_system_sgpr_workgroup_id_x 1
  .amdhsa_float_denorm_mode_32 3
.end_amdhsa_kernel
```

```asm
; @launch kernel=p1_kernel grid=(256,1,1) block=(1024,1,1) lds=163072
; @launch kernel=p2_kernel grid=(256,1,1) block=(1024,1,1) lds=154368
; @launch kernel=p3_kernel grid=(1563,1,1) block=(256,1,1) lds=0
.amdgcn_target "amdgcn-amd-amdhsa--gfx950"
.text
.globl p1_kernel
.p2align 8
.type p1_kernel,@function
p1_kernel:
    s_cmp_ge_u32 s2, 256
    s_cbranch_scc1 p1_end
    s_load_dwordx2 s[52:53], s[0:1], 0
    s_load_dwordx4 s[56:59], s[0:1], 8
    s_load_dwordx2 s[54:55], s[0:1], 32
    s_load_dwordx2 s[60:61], s[0:1], 48
    s_load_dwordx2 s[48:49], s[0:1], 104
    s_load_dwordx2 s[62:63], s[0:1], 96
    v_lshlrev_b32 v1, 4, v0
    v_lshlrev_b32 v2, 3, v0
    v_mov_b32 v3, 1
    v_lshrrev_b32 v117, 6, v0
    s_nop 0
    v_readfirstlane_b32 s28, v117
    s_waitcnt lgkmcnt(0)
    s_load_dword s45, s[60:61], 0
    s_mov_b32 s4, s56
    s_and_b32 s5, s57, 0xffff
    s_mov_b32 s6, 204800000
    s_mov_b32 s7, 0x20000
    s_mov_b32 s8, s58
    s_and_b32 s9, s59, 0xffff
    s_mov_b32 s10, 204800000
    s_mov_b32 s11, 0x20000
    s_mov_b32 s12, s54
    s_and_b32 s13, s55, 0xffff
    s_mov_b32 s14, 102400000
    s_mov_b32 s15, 0x20000
    s_mov_b32 s16, s48
    s_and_b32 s17, s49, 0xffff
    s_mov_b32 s18, 819200000
    s_mov_b32 s19, 0x20000
    s_mov_b32 s29, s2
    s_mul_i32 s31, s2, 73728
    s_lshl_b32 s30, s31, 1
    s_add_u32 s32, s30, 0
    buffer_load_dwordx4 v[94:97], v1, s[4:7], s32 offen nt
    buffer_load_dwordx4 v[102:105], v1, s[8:11], s32 offen nt
    s_add_u32 s32, s31, 0
    buffer_load_dwordx2 v[76:77], v2, s[12:15], s32 offen nt
    s_add_u32 s32, s30, 16384
    buffer_load_dwordx4 v[98:101], v1, s[4:7], s32 offen nt
    buffer_load_dwordx4 v[106:109], v1, s[8:11], s32 offen nt
    s_add_u32 s32, s31, 8192
    buffer_load_dwordx2 v[78:79], v2, s[12:15], s32 offen nt
    s_add_u32 s32, s30, 32768
    buffer_load_dwordx4 v[12:15], v1, s[4:7], s32 offen nt
    buffer_load_dwordx4 v[48:51], v1, s[8:11], s32 offen nt
    s_add_u32 s32, s31, 16384
    buffer_load_dwordx2 v[80:81], v2, s[12:15], s32 offen nt
    s_add_u32 s32, s31, 24576
    buffer_load_dwordx2 v[82:83], v2, s[12:15], s32 offen nt
    s_add_u32 s32, s31, 32768
    buffer_load_dwordx2 v[84:85], v2, s[12:15], s32 offen nt
    s_add_u32 s32, s31, 40960
    buffer_load_dwordx2 v[86:87], v2, s[12:15], s32 offen nt
    s_add_u32 s32, s31, 49152
    buffer_load_dwordx2 v[88:89], v2, s[12:15], s32 offen nt
    s_add_u32 s32, s31, 57344
    buffer_load_dwordx2 v[90:91], v2, s[12:15], s32 offen nt
    s_add_u32 s32, s31, 65536
    buffer_load_dwordx2 v[92:93], v2, s[12:15], s32 offen nt
    s_mov_b32 s24, s52
    s_and_b32 s25, s53, 0xffff
    s_mov_b32 s26, 6400000
    s_mov_b32 s27, 0x20000
    s_mov_b32 s20, s48
    s_and_b32 s21, s49, 0xffff
    s_mov_b32 s22, 0
    s_mov_b32 s23, 0x20000
    s_mov_b32 s40, s62
    s_and_b32 s41, s63, 0xffff
    s_mov_b32 s42, 256
    s_mov_b32 s43, 0x20000
    s_mov_b32 s36, 643827
    s_mov_b32 s37, 214609
    s_mov_b32 s38, 343268
    s_mov_b32 s39, -6671
    s_mov_b32 s44, -12512
    s_mov_b32 s34, 1
    v_mov_b32 v73, 0x40000000
    v_mov_b32 v122, 0
    v_mov_b32 v123, 0
    v_mov_b32 v124, 0
    v_mov_b32 v125, 0
    ds_write_b128 v1, v[122:125] offset:0
    s_waitcnt lgkmcnt(0)
    s_barrier
    s_lshl_b32 s45, s45, 16
p1_tile:
    v_mov_b32 v122, 0
    v_mov_b32 v123, 0
    v_mov_b32 v124, 0
    v_mov_b32 v125, 0
    ds_write_b128 v1, v[122:125] offset:10496
    ds_write_b128 v1, v[122:125] offset:26880
    ds_write_b128 v1, v[122:125] offset:43264
    s_cmp_lg_u32 s28, 15
    s_cbranch_scc1 p1_tk0
    v_mov_b32 v127, 1
    s_mov_b64 exec, 1
    buffer_atomic_add v127, off, s[40:43], 0 offset:128 sc0 sc1
    s_mov_b64 exec, -1
p1_tk0:
    v_mov_b32 v123, s45
    v_mov_b32 v124, 0x007f007f
    v_mov_b32 v125, 0xe000
    v_mov_b32 v126, 0xffff0000
    s_cmp_lt_u32 s29, 1426
    s_cselect_b32 s6, 204800000, 0
    s_cselect_b32 s10, 204800000, 0
    s_add_u32 s32, s30, 49152
    buffer_load_dwordx4 v[16:19], v1, s[4:7], s32 offen nt
    buffer_load_dwordx4 v[52:55], v1, s[8:11], s32 offen nt
    s_waitcnt vmcnt(14)
    v_lshlrev_b32 v117, 16, v76
    v_and_b32 v118, v126, v76
    v_mul_f32 v117, v123, v117
    v_mul_f32 v118, v123, v118
    v_cvt_pk_bf16_f32 v117, v117, v118
    v_and_b32 v118, v126, v117
    v_lshlrev_b32 v117, 16, v117
    v_mul_f32 v117, 0.15915494, v117
    v_mul_f32 v118, 0.15915494, v118
    v_fract_f32 v117, v117
    v_fract_f32 v118, v118
    v_cos_f32 v117, v117
    v_cos_f32 v118, v118
    v_mul_hi_u32_u24 v122, s38, v102
    v_mul_hi_u32_u24 v121, s37, v94
    v_mul_hi_u32_u24 v120, s36, v94
    v_mad_i32_i24 v110, v122, s44, v102
    v_mad_u32_u24 v40, v122, 40, v121
    v_mad_i32_i24 v4, v120, s39, v94
    v_lshlrev_b16 v40, 2, v40
    v_mad_i32_i24 v120, v121, -3, v120
    ds_add_u32 v40, v3 offset:0
    v_lshl_or_b32 v4, v110, 16, v4
    v_lshl_or_b32 v4, v120, 30, v4
    v_mul_f32 v117, 0x03800000, v117
    v_mul_f32 v118, 0x03800000, v118
    v_cvt_pk_bf16_f32 v117, v117, v118
    v_mul_hi_u32_u24 v122, s38, v103
    v_mul_hi_u32_u24 v121, s37, v95
    v_mul_hi_u32_u24 v120, s36, v95
    v_mad_i32_i24 v110, v122, s44, v103
    v_mad_u32_u24 v41, v122, 40, v121
    v_mad_i32_i24 v5, v120, s39, v95
    v_lshlrev_b16 v41, 2, v41
    v_mad_i32_i24 v120, v121, -3, v120
    ds_add_u32 v41, v3 offset:0
    v_lshl_or_b32 v5, v110, 16, v5
    v_lshl_or_b32 v5, v120, 30, v5
    v_lshrrev_b32 v118, 3, v117
    v_lshrrev_b32 v119, 8, v117
    v_lshlrev_b16 v117, 13, v117
    v_bitop3_b32 v119, v118, v119, v124 bitop3:0x1b
    v_bitop3_b32 v4, v117, v125, v4 bitop3:0xae
    v_lshl_or_b32 v40, v119, 16, v40
    v_bitop3_b32 v5, v118, v125, v5 bitop3:0xae
    v_bitop3_b32 v41, v119, v126, v41 bitop3:0xea
    v_lshlrev_b32 v117, 16, v77
    v_and_b32 v118, v126, v77
    v_mul_f32 v117, v123, v117
    v_mul_f32 v118, v123, v118
    v_cvt_pk_bf16_f32 v117, v117, v118
    v_and_b32 v118, v126, v117
    v_lshlrev_b32 v117, 16, v117
    v_mul_f32 v117, 0.15915494, v117
    v_mul_f32 v118, 0.15915494, v118
    v_fract_f32 v117, v117
    v_fract_f32 v118, v118
    v_cos_f32 v117, v117
    v_cos_f32 v118, v118
    v_mul_hi_u32_u24 v122, s38, v104
    v_mul_hi_u32_u24 v121, s37, v96
    v_mul_hi_u32_u24 v120, s36, v96
    v_mad_i32_i24 v110, v122, s44, v104
    v_mad_u32_u24 v42, v122, 40, v121
    v_mad_i32_i24 v6, v120, s39, v96
    v_lshlrev_b16 v42, 2, v42
    v_mad_i32_i24 v120, v121, -3, v120
    ds_add_u32 v42, v3 offset:0
    v_lshl_or_b32 v6, v110, 16, v6
    v_lshl_or_b32 v6, v120, 30, v6
    v_mul_f32 v117, 0x03800000, v117
    v_mul_f32 v118, 0x03800000, v118
    v_cvt_pk_bf16_f32 v117, v117, v118
    v_mul_hi_u32_u24 v122, s38, v105
    v_mul_hi_u32_u24 v121, s37, v97
    v_mul_hi_u32_u24 v120, s36, v97
    v_mad_i32_i24 v110, v122, s44, v105
    v_mad_u32_u24 v43, v122, 40, v121
    v_mad_i32_i24 v7, v120, s39, v97
    v_lshlrev_b16 v43, 2, v43
    v_mad_i32_i24 v120, v121, -3, v120
    ds_add_u32 v43, v3 offset:0
    v_lshl_or_b32 v7, v110, 16, v7
    v_lshl_or_b32 v7, v120, 30, v7
    v_lshrrev_b32 v118, 3, v117
    v_lshrrev_b32 v119, 8, v117
    v_lshlrev_b16 v117, 13, v117
    v_bitop3_b32 v119, v118, v119, v124 bitop3:0x1b
    v_bitop3_b32 v6, v117, v125, v6 bitop3:0xae
    v_lshl_or_b32 v42, v119, 16, v42
    v_bitop3_b32 v7, v118, v125, v7 bitop3:0xae
    v_bitop3_b32 v43, v119, v126, v43 bitop3:0xea
    s_cmp_lt_u32 s29, 1389
    s_cselect_b32 s6, 204800000, 0
    s_cselect_b32 s10, 204800000, 0
    s_add_u32 s32, s30, 65536
    buffer_load_dwordx4 v[20:23], v1, s[4:7], s32 offen nt
    buffer_load_dwordx4 v[56:59], v1, s[8:11], s32 offen nt
    s_cmp_ge_u32 s29, 1499
    s_cbranch_scc1 p1_k2
    s_cmp_lg_u32 s34, 0
    s_cbranch_scc1 p1_w3
    s_waitcnt vmcnt(10)
p1_w3:
    s_waitcnt vmcnt(13)
    v_lshlrev_b32 v117, 16, v78
    v_and_b32 v118, v126, v78
    v_mul_f32 v117, v123, v117
    v_mul_f32 v118, v123, v118
    v_cvt_pk_bf16_f32 v117, v117, v118
    v_and_b32 v118, v126, v117
    v_lshlrev_b32 v117, 16, v117
    v_mul_f32 v117, 0.15915494, v117
    v_mul_f32 v118, 0.15915494, v118
    v_fract_f32 v117, v117
    v_fract_f32 v118, v118
    v_cos_f32 v117, v117
    v_cos_f32 v118, v118
    v_mul_hi_u32_u24 v122, s38, v106
    v_mul_hi_u32_u24 v121, s37, v98
    v_mul_hi_u32_u24 v120, s36, v98
    v_mad_i32_i24 v110, v122, s44, v106
    v_mad_u32_u24 v44, v122, 40, v121
    v_mad_i32_i24 v8, v120, s39, v98
    v_lshlrev_b16 v44, 2, v44
    v_mad_i32_i24 v120, v121, -3, v120
    ds_add_u32 v44, v3 offset:0
    v_lshl_or_b32 v8, v110, 16, v8
    v_lshl_or_b32 v8, v120, 30, v8
    v_mul_f32 v117, 0x03800000, v117
    v_mul_f32 v118, 0x03800000, v118
    v_cvt_pk_bf16_f32 v117, v117, v118
    v_mul_hi_u32_u24 v122, s38, v107
    v_mul_hi_u32_u24 v121, s37, v99
    v_mul_hi_u32_u24 v120, s36, v99
    v_mad_i32_i24 v110, v122, s44, v107
    v_mad_u32_u24 v45, v122, 40, v121
    v_mad_i32_i24 v9, v120, s39, v99
    v_lshlrev_b16 v45, 2, v45
    v_mad_i32_i24 v120, v121, -3, v120
    ds_add_u32 v45, v3 offset:0
    v_lshl_or_b32 v9, v110, 16, v9
    v_lshl_or_b32 v9, v120, 30, v9
    v_lshrrev_b32 v118, 3, v117
    v_lshrrev_b32 v119, 8, v117
    v_lshlrev_b16 v117, 13, v117
    v_bitop3_b32 v119, v118, v119, v124 bitop3:0x1b
    v_bitop3_b32 v8, v117, v125, v8 bitop3:0xae
    v_lshl_or_b32 v44, v119, 16, v44
    v_bitop3_b32 v9, v118, v125, v9 bitop3:0xae
    v_bitop3_b32 v45, v119, v126, v45 bitop3:0xea
    v_lshlrev_b32 v117, 16, v79
    v_and_b32 v118, v126, v79
    v_mul_f32 v117, v123, v117
    v_mul_f32 v118, v123, v118
    v_cvt_pk_bf16_f32 v117, v117, v118
    v_and_b32 v118, v126, v117
    v_lshlrev_b32 v117, 16, v117
    v_mul_f32 v117, 0.15915494, v117
    v_mul_f32 v118, 0.15915494, v118
    v_fract_f32 v117, v117
    v_fract_f32 v118, v118
    v_cos_f32 v117, v117
    v_cos_f32 v118, v118
    v_mul_hi_u32_u24 v122, s38, v108
    v_mul_hi_u32_u24 v121, s37, v100
    v_mul_hi_u32_u24 v120, s36, v100
    v_mad_i32_i24 v110, v122, s44, v108
    v_mad_u32_u24 v46, v122, 40, v121
    v_mad_i32_i24 v10, v120, s39, v100
    v_lshlrev_b16 v46, 2, v46
    v_mad_i32_i24 v120, v121, -3, v120
    ds_add_u32 v46, v3 offset:0
    v_lshl_or_b32 v10, v110, 16, v10
    v_lshl_or_b32 v10, v120, 30, v10
    v_mul_f32 v117, 0x03800000, v117
    v_mul_f32 v118, 0x03800000, v118
    v_cvt_pk_bf16_f32 v117, v117, v118
    v_mul_hi_u32_u24 v122, s38, v109
    v_mul_hi_u32_u24 v121, s37, v101
    v_mul_hi_u32_u24 v120, s36, v101
    v_mad_i32_i24 v110, v122, s44, v109
    v_mad_u32_u24 v47, v122, 40, v121
    v_mad_i32_i24 v11, v120, s39, v101
    v_lshlrev_b16 v47, 2, v47
    v_mad_i32_i24 v120, v121, -3, v120
    ds_add_u32 v47, v3 offset:0
    v_lshl_or_b32 v11, v110, 16, v11
    v_lshl_or_b32 v11, v120, 30, v11
    v_lshrrev_b32 v118, 3, v117
    v_lshrrev_b32 v119, 8, v117
    v_lshlrev_b16 v117, 13, v117
    v_bitop3_b32 v119, v118, v119, v124 bitop3:0x1b
    v_bitop3_b32 v10, v117, v125, v10 bitop3:0xae
    v_lshl_or_b32 v46, v119, 16, v46
    v_bitop3_b32 v11, v118, v125, v11 bitop3:0xae
    v_bitop3_b32 v47, v119, v126, v47 bitop3:0xea
p1_k2:
    s_cmp_lt_u32 s29, 1352
    s_cselect_b32 s6, 204800000, 0
    s_cselect_b32 s10, 204800000, 0
    s_add_u32 s32, s30, 81920
    buffer_load_dwordx4 v[24:27], v1, s[4:7], s32 offen nt
    buffer_load_dwordx4 v[60:63], v1, s[8:11], s32 offen nt
    s_cmp_ge_u32 s29, 1462
    s_cbranch_scc1 p1_k4
    s_cmp_lg_u32 s34, 0
    s_cbranch_scc1 p1_w5
    s_waitcnt vmcnt(6)
p1_w5:
    s_waitcnt vmcnt(11)
    v_lshlrev_b32 v117, 16, v80
    v_and_b32 v118, v126, v80
    v_mul_f32 v117, v123, v117
    v_mul_f32 v118, v123, v118
    v_cvt_pk_bf16_f32 v117, v117, v118
    v_and_b32 v118, v126, v117
    v_lshlrev_b32 v117, 16, v117
    v_mul_f32 v117, 0.15915494, v117
    v_mul_f32 v118, 0.15915494, v118
    v_fract_f32 v117, v117
    v_fract_f32 v118, v118
    v_cos_f32 v117, v117
    v_cos_f32 v118, v118
    v_mul_hi_u32_u24 v122, s38, v48
    v_mul_hi_u32_u24 v121, s37, v12
    v_mul_hi_u32_u24 v120, s36, v12
    v_mad_i32_i24 v110, v122, s44, v48
    v_mad_u32_u24 v48, v122, 40, v121
    v_mad_i32_i24 v12, v120, s39, v12
    v_lshlrev_b16 v48, 2, v48
    v_mad_i32_i24 v120, v121, -3, v120
    ds_add_u32 v48, v3 offset:0
    v_lshl_or_b32 v12, v110, 16, v12
    v_lshl_or_b32 v12, v120, 30, v12
    v_mul_f32 v117, 0x03800000, v117
    v_mul_f32 v118, 0x03800000, v118
    v_cvt_pk_bf16_f32 v117, v117, v118
    v_mul_hi_u32_u24 v122, s38, v49
    v_mul_hi_u32_u24 v121, s37, v13
    v_mul_hi_u32_u24 v120, s36, v13
    v_mad_i32_i24 v110, v122, s44, v49
    v_mad_u32_u24 v49, v122, 40, v121
    v_mad_i32_i24 v13, v120, s39, v13
    v_lshlrev_b16 v49, 2, v49
    v_mad_i32_i24 v120, v121, -3, v120
    ds_add_u32 v49, v3 offset:0
    v_lshl_or_b32 v13, v110, 16, v13
    v_lshl_or_b32 v13, v120, 30, v13
    v_lshrrev_b32 v118, 3, v117
    v_lshrrev_b32 v119, 8, v117
    v_lshlrev_b16 v117, 13, v117
    v_bitop3_b32 v119, v118, v119, v124 bitop3:0x1b
    v_bitop3_b32 v12, v117, v125, v12 bitop3:0xae
    v_lshl_or_b32 v48, v119, 16, v48
    v_bitop3_b32 v13, v118, v125, v13 bitop3:0xae
    v_bitop3_b32 v49, v119, v126, v49 bitop3:0xea
    v_lshlrev_b32 v117, 16, v81
    v_and_b32 v118, v126, v81
    v_mul_f32 v117, v123, v117
    v_mul_f32 v118, v123, v118
    v_cvt_pk_bf16_f32 v117, v117, v118
    v_and_b32 v118, v126, v117
    v_lshlrev_b32 v117, 16, v117
    v_mul_f32 v117, 0.15915494, v117
    v_mul_f32 v118, 0.15915494, v118
    v_fract_f32 v117, v117
    v_fract_f32 v118, v118
    v_cos_f32 v117, v117
    v_cos_f32 v118, v118
    v_mul_hi_u32_u24 v122, s38, v50
    v_mul_hi_u32_u24 v121, s37, v14
    v_mul_hi_u32_u24 v120, s36, v14
    v_mad_i32_i24 v110, v122, s44, v50
    v_mad_u32_u24 v50, v122, 40, v121
    v_mad_i32_i24 v14, v120, s39, v14
    v_lshlrev_b16 v50, 2, v50
    v_mad_i32_i24 v120, v121, -3, v120
    ds_add_u32 v50, v3 offset:0
    v_lshl_or_b32 v14, v110, 16, v14
    v_lshl_or_b32 v14, v120, 30, v14
    v_mul_f32 v117, 0x03800000, v117
    v_mul_f32 v118, 0x03800000, v118
    v_cvt_pk_bf16_f32 v117, v117, v118
    v_mul_hi_u32_u24 v122, s38, v51
    v_mul_hi_u32_u24 v121, s37, v15
    v_mul_hi_u32_u24 v120, s36, v15
    v_mad_i32_i24 v110, v122, s44, v51
    v_mad_u32_u24 v51, v122, 40, v121
    v_mad_i32_i24 v15, v120, s39, v15
    v_lshlrev_b16 v51, 2, v51
    v_mad_i32_i24 v120, v121, -3, v120
    ds_add_u32 v51, v3 offset:0
    v_lshl_or_b32 v15, v110, 16, v15
    v_lshl_or_b32 v15, v120, 30, v15
    v_lshrrev_b32 v118, 3, v117
    v_lshrrev_b32 v119, 8, v117
    v_lshlrev_b16 v117, 13, v117
    v_bitop3_b32 v119, v118, v119, v124 bitop3:0x1b
    v_bitop3_b32 v14, v117, v125, v14 bitop3:0xae
    v_lshl_or_b32 v50, v119, 16, v50
    v_bitop3_b32 v15, v118, v125, v15 bitop3:0xae
    v_bitop3_b32 v51, v119, v126, v51 bitop3:0xea
p1_k4:
    s_cmp_lt_u32 s29, 1315
    s_cselect_b32 s6, 204800000, 0
    s_cselect_b32 s10, 204800000, 0
    s_add_u32 s32, s30, 98304
    buffer_load_dwordx4 v[28:31], v1, s[4:7], s32 offen nt
    buffer_load_dwordx4 v[64:67], v1, s[8:11], s32 offen nt
    s_cmp_ge_u32 s29, 1426
    s_cbranch_scc1 p1_k6
    s_waitcnt vmcnt(6)
    v_lshlrev_b32 v117, 16, v82
    v_and_b32 v118, v126, v82
    v_mul_f32 v117, v123, v117
    v_mul_f32 v118, v123, v118
    v_cvt_pk_bf16_f32 v117, v117, v118
    v_and_b32 v118, v126, v117
    v_lshlrev_b32 v117, 16, v117
    v_mul_f32 v117, 0.15915494, v117
    v_mul_f32 v118, 0.15915494, v118
    v_fract_f32 v117, v117
    v_fract_f32 v118, v118
    v_cos_f32 v117, v117
    v_cos_f32 v118, v118
    v_mul_hi_u32_u24 v122, s38, v52
    v_mul_hi_u32_u24 v121, s37, v16
    v_mul_hi_u32_u24 v120, s36, v16
    v_mad_i32_i24 v110, v122, s44, v52
    v_mad_u32_u24 v52, v122, 40, v121
    v_mad_i32_i24 v16, v120, s39, v16
    v_lshlrev_b16 v52, 2, v52
    v_mad_i32_i24 v120, v121, -3, v120
    ds_add_u32 v52, v3 offset:0
    v_lshl_or_b32 v16, v110, 16, v16
    v_lshl_or_b32 v16, v120, 30, v16
    v_mul_f32 v117, 0x03800000, v117
    v_mul_f32 v118, 0x03800000, v118
    v_cvt_pk_bf16_f32 v117, v117, v118
    v_mul_hi_u32_u24 v122, s38, v53
    v_mul_hi_u32_u24 v121, s37, v17
    v_mul_hi_u32_u24 v120, s36, v17
    v_mad_i32_i24 v110, v122, s44, v53
    v_mad_u32_u24 v53, v122, 40, v121
    v_mad_i32_i24 v17, v120, s39, v17
    v_lshlrev_b16 v53, 2, v53
    v_mad_i32_i24 v120, v121, -3, v120
    ds_add_u32 v53, v3 offset:0
    v_lshl_or_b32 v17, v110, 16, v17
    v_lshl_or_b32 v17, v120, 30, v17
    v_lshrrev_b32 v118, 3, v117
    v_lshrrev_b32 v119, 8, v117
    v_lshlrev_b16 v117, 13, v117
    v_bitop3_b32 v119, v118, v119, v124 bitop3:0x1b
    v_bitop3_b32 v16, v117, v125, v16 bitop3:0xae
    v_lshl_or_b32 v52, v119, 16, v52
    v_bitop3_b32 v17, v118, v125, v17 bitop3:0xae
    v_bitop3_b32 v53, v119, v126, v53 bitop3:0xea
    v_lshlrev_b32 v117, 16, v83
    v_and_b32 v118, v126, v83
    v_mul_f32 v117, v123, v117
    v_mul_f32 v118, v123, v118
    v_cvt_pk_bf16_f32 v117, v117, v118
    v_and_b32 v118, v126, v117
    v_lshlrev_b32 v117, 16, v117
    v_mul_f32 v117, 0.15915494, v117
    v_mul_f32 v118, 0.15915494, v118
    v_fract_f32 v117, v117
    v_fract_f32 v118, v118
    v_cos_f32 v117, v117
    v_cos_f32 v118, v118
    v_mul_hi_u32_u24 v122, s38, v54
    v_mul_hi_u32_u24 v121, s37, v18
    v_mul_hi_u32_u24 v120, s36, v18
    v_mad_i32_i24 v110, v122, s44, v54
    v_mad_u32_u24 v54, v122, 40, v121
    v_mad_i32_i24 v18, v120, s39, v18
    v_lshlrev_b16 v54, 2, v54
    v_mad_i32_i24 v120, v121, -3, v120
    ds_add_u32 v54, v3 offset:0
    v_lshl_or_b32 v18, v110, 16, v18
    v_lshl_or_b32 v18, v120, 30, v18
    v_mul_f32 v117, 0x03800000, v117
    v_mul_f32 v118, 0x03800000, v118
    v_cvt_pk_bf16_f32 v117, v117, v118
    v_mul_hi_u32_u24 v122, s38, v55
    v_mul_hi_u32_u24 v121, s37, v19
    v_mul_hi_u32_u24 v120, s36, v19
    v_mad_i32_i24 v110, v122, s44, v55
    v_mad_u32_u24 v55, v122, 40, v121
    v_mad_i32_i24 v19, v120, s39, v19
    v_lshlrev_b16 v55, 2, v55
    v_mad_i32_i24 v120, v121, -3, v120
    ds_add_u32 v55, v3 offset:0
    v_lshl_or_b32 v19, v110, 16, v19
    v_lshl_or_b32 v19, v120, 30, v19
    v_lshrrev_b32 v118, 3, v117
    v_lshrrev_b32 v119, 8, v117
    v_lshlrev_b16 v117, 13, v117
    v_bitop3_b32 v119, v118, v119, v124 bitop3:0x1b
    v_bitop3_b32 v18, v117, v125, v18 bitop3:0xae
    v_lshl_or_b32 v54, v119, 16, v54
    v_bitop3_b32 v19, v118, v125, v19 bitop3:0xae
    v_bitop3_b32 v55, v119, v126, v55 bitop3:0xea
p1_k6:
    s_cmp_lt_u32 s29, 1279
    s_cselect_b32 s6, 204800000, 0
    s_cselect_b32 s10, 204800000, 0
    s_add_u32 s32, s30, 114688
    buffer_load_dwordx4 v[32:35], v1, s[4:7], s32 offen nt
    buffer_load_dwordx4 v[68:71], v1, s[8:11], s32 offen nt
    s_cmp_ge_u32 s29, 1389
    s_cbranch_scc1 p1_k8
    s_waitcnt vmcnt(6)
    v_lshlrev_b32 v117, 16, v84
    v_and_b32 v118, v126, v84
    v_mul_f32 v117, v123, v117
    v_mul_f32 v118, v123, v118
    v_cvt_pk_bf16_f32 v117, v117, v118
    v_and_b32 v118, v126, v117
    v_lshlrev_b32 v117, 16, v117
    v_mul_f32 v117, 0.15915494, v117
    v_mul_f32 v118, 0.15915494, v118
    v_fract_f32 v117, v117
    v_fract_f32 v118, v118
    v_cos_f32 v117, v117
    v_cos_f32 v118, v118
    v_mul_hi_u32_u24 v122, s38, v56
    v_mul_hi_u32_u24 v121, s37, v20
    v_mul_hi_u32_u24 v120, s36, v20
    v_mad_i32_i24 v110, v122, s44, v56
    v_mad_u32_u24 v56, v122, 40, v121
    v_mad_i32_i24 v20, v120, s39, v20
    v_lshlrev_b16 v56, 2, v56
    v_mad_i32_i24 v120, v121, -3, v120
    ds_add_u32 v56, v3 offset:0
    v_lshl_or_b32 v20, v110, 16, v20
    v_lshl_or_b32 v20, v120, 30, v20
    v_mul_f32 v117, 0x03800000, v117
    v_mul_f32 v118, 0x03800000, v118
    v_cvt_pk_bf16_f32 v117, v117, v118
    v_mul_hi_u32_u24 v122, s38, v57
    v_mul_hi_u32_u24 v121, s37, v21
    v_mul_hi_u32_u24 v120, s36, v21
    v_mad_i32_i24 v110, v122, s44, v57
    v_mad_u32_u24 v57, v122, 40, v121
    v_mad_i32_i24 v21, v120, s39, v21
    v_lshlrev_b16 v57, 2, v57
    v_mad_i32_i24 v120, v121, -3, v120
    ds_add_u32 v57, v3 offset:0
    v_lshl_or_b32 v21, v110, 16, v21
    v_lshl_or_b32 v21, v120, 30, v21
    v_lshrrev_b32 v118, 3, v117
    v_lshrrev_b32 v119, 8, v117
    v_lshlrev_b16 v117, 13, v117
    v_bitop3_b32 v119, v118, v119, v124 bitop3:0x1b
    v_bitop3_b32 v20, v117, v125, v20 bitop3:0xae
    v_lshl_or_b32 v56, v119, 16, v56
    v_bitop3_b32 v21, v118, v125, v21 bitop3:0xae
    v_bitop3_b32 v57, v119, v126, v57 bitop3:0xea
    v_lshlrev_b32 v117, 16, v85
    v_and_b32 v118, v126, v85
    v_mul_f32 v117, v123, v117
    v_mul_f32 v118, v123, v118
    v_cvt_pk_bf16_f32 v117, v117, v118
    v_and_b32 v118, v126, v117
    v_lshlrev_b32 v117, 16, v117
    v_mul_f32 v117, 0.15915494, v117
    v_mul_f32 v118, 0.15915494, v118
    v_fract_f32 v117, v117
    v_fract_f32 v118, v118
    v_cos_f32 v117, v117
    v_cos_f32 v118, v118
    v_mul_hi_u32_u24 v122, s38, v58
    v_mul_hi_u32_u24 v121, s37, v22
    v_mul_hi_u32_u24 v120, s36, v22
    v_mad_i32_i24 v110, v122, s44, v58
    v_mad_u32_u24 v58, v122, 40, v121
    v_mad_i32_i24 v22, v120, s39, v22
    v_lshlrev_b16 v58, 2, v58
    v_mad_i32_i24 v120, v121, -3, v120
    ds_add_u32 v58, v3 offset:0
    v_lshl_or_b32 v22, v110, 16, v22
    v_lshl_or_b32 v22, v120, 30, v22
    v_mul_f32 v117, 0x03800000, v117
    v_mul_f32 v118, 0x03800000, v118
    v_cvt_pk_bf16_f32 v117, v117, v118
    v_mul_hi_u32_u24 v122, s38, v59
    v_mul_hi_u32_u24 v121, s37, v23
    v_mul_hi_u32_u24 v120, s36, v23
    v_mad_i32_i24 v110, v122, s44, v59
    v_mad_u32_u24 v59, v122, 40, v121
    v_mad_i32_i24 v23, v120, s39, v23
    v_lshlrev_b16 v59, 2, v59
    v_mad_i32_i24 v120, v121, -3, v120
    ds_add_u32 v59, v3 offset:0
    v_lshl_or_b32 v23, v110, 16, v23
    v_lshl_or_b32 v23, v120, 30, v23
    v_lshrrev_b32 v118, 3, v117
    v_lshrrev_b32 v119, 8, v117
    v_lshlrev_b16 v117, 13, v117
    v_bitop3_b32 v119, v118, v119, v124 bitop3:0x1b
    v_bitop3_b32 v22, v117, v125, v22 bitop3:0xae
    v_lshl_or_b32 v58, v119, 16, v58
    v_bitop3_b32 v23, v118, v125, v23 bitop3:0xae
    v_bitop3_b32 v59, v119, v126, v59 bitop3:0xea
p1_k8:
    s_cmp_lt_u32 s29, 1242
    s_cselect_b32 s6, 204800000, 0
    s_cselect_b32 s10, 204800000, 0
    s_add_u32 s32, s30, 131072
    buffer_load_dwordx4 v[36:39], v1, s[4:7], s32 offen nt
    buffer_load_dwordx4 v[72:75], v1, s[8:11], s32 offen nt
    s_cmp_ge_u32 s29, 1352
    s_cbranch_scc1 p1_k10
    s_waitcnt vmcnt(6)
    v_lshlrev_b32 v117, 16, v86
    v_and_b32 v118, v126, v86
    v_mul_f32 v117, v123, v117
    v_mul_f32 v118, v123, v118
    v_cvt_pk_bf16_f32 v117, v117, v118
    v_and_b32 v118, v126, v117
    v_lshlrev_b32 v117, 16, v117
    v_mul_f32 v117, 0.15915494, v117
    v_mul_f32 v118, 0.15915494, v118
    v_fract_f32 v117, v117
    v_fract_f32 v118, v118
    v_cos_f32 v117, v117
    v_cos_f32 v118, v118
    v_mul_hi_u32_u24 v122, s38, v60
    v_mul_hi_u32_u24 v121, s37, v24
    v_mul_hi_u32_u24 v120, s36, v24
    v_mad_i32_i24 v110, v122, s44, v60
    v_mad_u32_u24 v60, v122, 40, v121
    v_mad_i32_i24 v24, v120, s39, v24
    v_lshlrev_b16 v60, 2, v60
    v_mad_i32_i24 v120, v121, -3, v120
    ds_add_u32 v60, v3 offset:0
    v_lshl_or_b32 v24, v110, 16, v24
    v_lshl_or_b32 v24, v120, 30, v24
    v_mul_f32 v117, 0x03800000, v117
    v_mul_f32 v118, 0x03800000, v118
    v_cvt_pk_bf16_f32 v117, v117, v118
    v_mul_hi_u32_u24 v122, s38, v61
    v_mul_hi_u32_u24 v121, s37, v25
    v_mul_hi_u32_u24 v120, s36, v25
    v_mad_i32_i24 v110, v122, s44, v61
    v_mad_u32_u24 v61, v122, 40, v121
    v_mad_i32_i24 v25, v120, s39, v25
    v_lshlrev_b16 v61, 2, v61
    v_mad_i32_i24 v120, v121, -3, v120
    ds_add_u32 v61, v3 offset:0
    v_lshl_or_b32 v25, v110, 16, v25
    v_lshl_or_b32 v25, v120, 30, v25
    v_lshrrev_b32 v118, 3, v117
    v_lshrrev_b32 v119, 8, v117
    v_lshlrev_b16 v117, 13, v117
    v_bitop3_b32 v119, v118, v119, v124 bitop3:0x1b
    v_bitop3_b32 v24, v117, v125, v24 bitop3:0xae
    v_lshl_or_b32 v60, v119, 16, v60
    v_bitop3_b32 v25, v118, v125, v25 bitop3:0xae
    v_bitop3_b32 v61, v119, v126, v61 bitop3:0xea
    v_lshlrev_b32 v117, 16, v87
    v_and_b32 v118, v126, v87
    v_mul_f32 v117, v123, v117
    v_mul_f32 v118, v123, v118
    v_cvt_pk_bf16_f32 v117, v117, v118
    v_and_b32 v118, v126, v117
    v_lshlrev_b32 v117, 16, v117
    v_mul_f32 v117, 0.15915494, v117
    v_mul_f32 v118, 0.15915494, v118
    v_fract_f32 v117, v117
    v_fract_f32 v118, v118
    v_cos_f32 v117, v117
    v_cos_f32 v118, v118
    v_mul_hi_u32_u24 v122, s38, v62
    v_mul_hi_u32_u24 v121, s37, v26
    v_mul_hi_u32_u24 v120, s36, v26
    v_mad_i32_i24 v110, v122, s44, v62
    v_mad_u32_u24 v62, v122, 40, v121
    v_mad_i32_i24 v26, v120, s39, v26
    v_lshlrev_b16 v62, 2, v62
    v_mad_i32_i24 v120, v121, -3, v120
    ds_add_u32 v62, v3 offset:0
    v_lshl_or_b32 v26, v110, 16, v26
    v_lshl_or_b32 v26, v120, 30, v26
    v_mul_f32 v117, 0x03800000, v117
    v_mul_f32 v118, 0x03800000, v118
    v_cvt_pk_bf16_f32 v117, v117, v118
    v_mul_hi_u32_u24 v122, s38, v63
    v_mul_hi_u32_u24 v121, s37, v27
    v_mul_hi_u32_u24 v120, s36, v27
    v_mad_i32_i24 v110, v122, s44, v63
    v_mad_u32_u24 v63, v122, 40, v121
    v_mad_i32_i24 v27, v120, s39, v27
    v_lshlrev_b16 v63, 2, v63
    v_mad_i32_i24 v120, v121, -3, v120
    ds_add_u32 v63, v3 offset:0
    v_lshl_or_b32 v27, v110, 16, v27
    v_lshl_or_b32 v27, v120, 30, v27
    v_lshrrev_b32 v118, 3, v117
    v_lshrrev_b32 v119, 8, v117
    v_lshlrev_b16 v117, 13, v117
    v_bitop3_b32 v119, v118, v119, v124 bitop3:0x1b
    v_bitop3_b32 v26, v117, v125, v26 bitop3:0xae
    v_lshl_or_b32 v62, v119, 16, v62
    v_bitop3_b32 v27, v118, v125, v27 bitop3:0xae
    v_bitop3_b32 v63, v119, v126, v63 bitop3:0xea
p1_k10:
    s_cmp_ge_u32 s29, 1315
    s_cbranch_scc1 p1_k12
    s_waitcnt vmcnt(4)
    v_lshlrev_b32 v117, 16, v88
    v_and_b32 v118, v126, v88
    v_mul_f32 v117, v123, v117
    v_mul_f32 v118, v123, v118
    v_cvt_pk_bf16_f32 v117, v117, v118
    v_and_b32 v118, v126, v117
    v_lshlrev_b32 v117, 16, v117
    v_mul_f32 v117, 0.15915494, v117
    v_mul_f32 v118, 0.15915494, v118
    v_fract_f32 v117, v117
    v_fract_f32 v118, v118
    v_cos_f32 v117, v117
    v_cos_f32 v118, v118
    v_mul_hi_u32_u24 v122, s38, v64
    v_mul_hi_u32_u24 v121, s37, v28
    v_mul_hi_u32_u24 v120, s36, v28
    v_mad_i32_i24 v110, v122, s44, v64
    v_mad_u32_u24 v64, v122, 40, v121
    v_mad_i32_i24 v28, v120, s39, v28
    v_lshlrev_b16 v64, 2, v64
    v_mad_i32_i24 v120, v121, -3, v120
    ds_add_u32 v64, v3 offset:0
    v_lshl_or_b32 v28, v110, 16, v28
    v_lshl_or_b32 v28, v120, 30, v28
    v_mul_f32 v117, 0x03800000, v117
    v_mul_f32 v118, 0x03800000, v118
    v_cvt_pk_bf16_f32 v117, v117, v118
    v_mul_hi_u32_u24 v122, s38, v65
    v_mul_hi_u32_u24 v121, s37, v29
    v_mul_hi_u32_u24 v120, s36, v29
    v_mad_i32_i24 v110, v122, s44, v65
    v_mad_u32_u24 v65, v122, 40, v121
    v_mad_i32_i24 v29, v120, s39, v29
    v_lshlrev_b16 v65, 2, v65
    v_mad_i32_i24 v120, v121, -3, v120
    ds_add_u32 v65, v3 offset:0
    v_lshl_or_b32 v29, v110, 16, v29
    v_lshl_or_b32 v29, v120, 30, v29
    v_lshrrev_b32 v118, 3, v117
    v_lshrrev_b32 v119, 8, v117
    v_lshlrev_b16 v117, 13, v117
    v_bitop3_b32 v119, v118, v119, v124 bitop3:0x1b
    v_bitop3_b32 v28, v117, v125, v28 bitop3:0xae
    v_lshl_or_b32 v64, v119, 16, v64
    v_bitop3_b32 v29, v118, v125, v29 bitop3:0xae
    v_bitop3_b32 v65, v119, v126, v65 bitop3:0xea
    v_lshlrev_b32 v117, 16, v89
    v_and_b32 v118, v126, v89
    v_mul_f32 v117, v123, v117
    v_mul_f32 v118, v123, v118
    v_cvt_pk_bf16_f32 v117, v117, v118
    v_and_b32 v118, v126, v117
    v_lshlrev_b32 v117, 16, v117
    v_mul_f32 v117, 0.15915494, v117
    v_mul_f32 v118, 0.15915494, v118
    v_fract_f32 v117, v117
    v_fract_f32 v118, v118
    v_cos_f32 v117, v117
    v_cos_f32 v118, v118
    v_mul_hi_u32_u24 v122, s38, v66
    v_mul_hi_u32_u24 v121, s37, v30
    v_mul_hi_u32_u24 v120, s36, v30
    v_mad_i32_i24 v110, v122, s44, v66
    v_mad_u32_u24 v66, v122, 40, v121
    v_mad_i32_i24 v30, v120, s39, v30
    v_lshlrev_b16 v66, 2, v66
    v_mad_i32_i24 v120, v121, -3, v120
    ds_add_u32 v66, v3 offset:0
    v_lshl_or_b32 v30, v110, 16, v30
    v_lshl_or_b32 v30, v120, 30, v30
    v_mul_f32 v117, 0x03800000, v117
    v_mul_f32 v118, 0x03800000, v118
    v_cvt_pk_bf16_f32 v117, v117, v118
    v_mul_hi_u32_u24 v122, s38, v67
    v_mul_hi_u32_u24 v121, s37, v31
    v_mul_hi_u32_u24 v120, s36, v31
    v_mad_i32_i24 v110, v122, s44, v67
    v_mad_u32_u24 v67, v122, 40, v121
    v_mad_i32_i24 v31, v120, s39, v31
    v_lshlrev_b16 v67, 2, v67
    v_mad_i32_i24 v120, v121, -3, v120
    ds_add_u32 v67, v3 offset:0
    v_lshl_or_b32 v31, v110, 16, v31
    v_lshl_or_b32 v31, v120, 30, v31
    v_lshrrev_b32 v118, 3, v117
    v_lshrrev_b32 v119, 8, v117
    v_lshlrev_b16 v117, 13, v117
    v_bitop3_b32 v119, v118, v119, v124 bitop3:0x1b
    v_bitop3_b32 v30, v117, v125, v30 bitop3:0xae
    v_lshl_or_b32 v66, v119, 16, v66
    v_bitop3_b32 v31, v118, v125, v31 bitop3:0xae
    v_bitop3_b32 v67, v119, v126, v67 bitop3:0xea
p1_k12:
    s_cmp_ge_u32 s29, 1279
    s_cbranch_scc1 p1_k14
    s_waitcnt vmcnt(2)
    v_lshlrev_b32 v117, 16, v90
    v_and_b32 v118, v126, v90
    v_mul_f32 v117, v123, v117
    v_mul_f32 v118, v123, v118
    v_cvt_pk_bf16_f32 v117, v117, v118
    v_and_b32 v118, v126, v117
    v_lshlrev_b32 v117, 16, v117
    v_mul_f32 v117, 0.15915494, v117
    v_mul_f32 v118, 0.15915494, v118
    v_fract_f32 v117, v117
    v_fract_f32 v118, v118
    v_cos_f32 v117, v117
    v_cos_f32 v118, v118
    v_mul_hi_u32_u24 v122, s38, v68
    v_mul_hi_u32_u24 v121, s37, v32
    v_mul_hi_u32_u24 v120, s36, v32
    v_mad_i32_i24 v110, v122, s44, v68
    v_mad_u32_u24 v68, v122, 40, v121
    v_mad_i32_i24 v32, v120, s39, v32
    v_lshlrev_b16 v68, 2, v68
    v_mad_i32_i24 v120, v121, -3, v120
    ds_add_u32 v68, v3 offset:0
    v_lshl_or_b32 v32, v110, 16, v32
    v_lshl_or_b32 v32, v120, 30, v32
    v_mul_f32 v117, 0x03800000, v117
    v_mul_f32 v118, 0x03800000, v118
    v_cvt_pk_bf16_f32 v117, v117, v118
    v_mul_hi_u32_u24 v122, s38, v69
    v_mul_hi_u32_u24 v121, s37, v33
    v_mul_hi_u32_u24 v120, s36, v33
    v_mad_i32_i24 v110, v122, s44, v69
    v_mad_u32_u24 v69, v122, 40, v121
    v_mad_i32_i24 v33, v120, s39, v33
    v_lshlrev_b16 v69, 2, v69
    v_mad_i32_i24 v120, v121, -3, v120
    ds_add_u32 v69, v3 offset:0
    v_lshl_or_b32 v33, v110, 16, v33
    v_lshl_or_b32 v33, v120, 30, v33
    v_lshrrev_b32 v118, 3, v117
    v_lshrrev_b32 v119, 8, v117
    v_lshlrev_b16 v117, 13, v117
    v_bitop3_b32 v119, v118, v119, v124 bitop3:0x1b
    v_bitop3_b32 v32, v117, v125, v32 bitop3:0xae
    v_lshl_or_b32 v68, v119, 16, v68
    v_bitop3_b32 v33, v118, v125, v33 bitop3:0xae
    v_bitop3_b32 v69, v119, v126, v69 bitop3:0xea
    v_lshlrev_b32 v117, 16, v91
    v_and_b32 v118, v126, v91
    v_mul_f32 v117, v123, v117
    v_mul_f32 v118, v123, v118
    v_cvt_pk_bf16_f32 v117, v117, v118
    v_and_b32 v118, v126, v117
    v_lshlrev_b32 v117, 16, v117
    v_mul_f32 v117, 0.15915494, v117
    v_mul_f32 v118, 0.15915494, v118
    v_fract_f32 v117, v117
    v_fract_f32 v118, v118
    v_cos_f32 v117, v117
    v_cos_f32 v118, v118
    v_mul_hi_u32_u24 v122, s38, v70
    v_mul_hi_u32_u24 v121, s37, v34
    v_mul_hi_u32_u24 v120, s36, v34
    v_mad_i32_i24 v110, v122, s44, v70
    v_mad_u32_u24 v70, v122, 40, v121
    v_mad_i32_i24 v34, v120, s39, v34
    v_lshlrev_b16 v70, 2, v70
    v_mad_i32_i24 v120, v121, -3, v120
    ds_add_u32 v70, v3 offset:0
    v_lshl_or_b32 v34, v110, 16, v34
    v_lshl_or_b32 v34, v120, 30, v34
    v_mul_f32 v117, 0x03800000, v117
    v_mul_f32 v118, 0x03800000, v118
    v_cvt_pk_bf16_f32 v117, v117, v118
    v_mul_hi_u32_u24 v122, s38, v71
    v_mul_hi_u32_u24 v121, s37, v35
    v_mul_hi_u32_u24 v120, s36, v35
    v_mad_i32_i24 v110, v122, s44, v71
    v_mad_u32_u24 v71, v122, 40, v121
    v_mad_i32_i24 v35, v120, s39, v35
    v_lshlrev_b16 v71, 2, v71
    v_mad_i32_i24 v120, v121, -3, v120
    ds_add_u32 v71, v3 offset:0
    v_lshl_or_b32 v35, v110, 16, v35
    v_lshl_or_b32 v35, v120, 30, v35
    v_lshrrev_b32 v118, 3, v117
    v_lshrrev_b32 v119, 8, v117
    v_lshlrev_b16 v117, 13, v117
    v_bitop3_b32 v119, v118, v119, v124 bitop3:0x1b
    v_bitop3_b32 v34, v117, v125, v34 bitop3:0xae
    v_lshl_or_b32 v70, v119, 16, v70
    v_bitop3_b32 v35, v118, v125, v35 bitop3:0xae
    v_bitop3_b32 v71, v119, v126, v71 bitop3:0xea
p1_k14:
    s_cmp_ge_u32 s29, 1242
    s_cbranch_scc1 p1_k16
    s_waitcnt vmcnt(0)
    v_lshlrev_b32 v117, 16, v92
    v_and_b32 v118, v126, v92
    v_mul_f32 v117, v123, v117
    v_mul_f32 v118, v123, v118
    v_cvt_pk_bf16_f32 v117, v117, v118
    v_and_b32 v118, v126, v117
    v_lshlrev_b32 v117, 16, v117
    v_mul_f32 v117, 0.15915494, v117
    v_mul_f32 v118, 0.15915494, v118
    v_fract_f32 v117, v117
    v_fract_f32 v118, v118
    v_cos_f32 v117, v117
    v_cos_f32 v118, v118
    v_mul_hi_u32_u24 v122, s38, v72
    v_mul_hi_u32_u24 v121, s37, v36
    v_mul_hi_u32_u24 v120, s36, v36
    v_mad_i32_i24 v110, v122, s44, v72
    v_mad_u32_u24 v72, v122, 40, v121
    v_mad_i32_i24 v36, v120, s39, v36
    v_lshlrev_b16 v72, 2, v72
    v_mad_i32_i24 v120, v121, -3, v120
    ds_add_u32 v72, v3 offset:0
    v_lshl_or_b32 v36, v110, 16, v36
    v_lshl_or_b32 v36, v120, 30, v36
    v_mul_f32 v117, 0x03800000, v117
    v_mul_f32 v118, 0x03800000, v118
    v_cvt_pk_bf16_f32 v117, v117, v118
    v_mul_hi_u32_u24 v122, s38, v73
    v_mul_hi_u32_u24 v121, s37, v37
    v_mul_hi_u32_u24 v120, s36, v37
    v_mad_i32_i24 v110, v122, s44, v73
    v_mad_u32_u24 v73, v122, 40, v121
    v_mad_i32_i24 v37, v120, s39, v37
    v_lshlrev_b16 v73, 2, v73
    v_mad_i32_i24 v120, v121, -3, v120
    ds_add_u32 v73, v3 offset:0
    v_lshl_or_b32 v37, v110, 16, v37
    v_lshl_or_b32 v37, v120, 30, v37
    v_lshrrev_b32 v118, 3, v117
    v_lshrrev_b32 v119, 8, v117
    v_lshlrev_b16 v117, 13, v117
    v_bitop3_b32 v119, v118, v119, v124 bitop3:0x1b
    v_bitop3_b32 v36, v117, v125, v36 bitop3:0xae
    v_lshl_or_b32 v72, v119, 16, v72
    v_bitop3_b32 v37, v118, v125, v37 bitop3:0xae
    v_bitop3_b32 v73, v119, v126, v73 bitop3:0xea
    v_lshlrev_b32 v117, 16, v93
    v_and_b32 v118, v126, v93
    v_mul_f32 v117, v123, v117
    v_mul_f32 v118, v123, v118
    v_cvt_pk_bf16_f32 v117, v117, v118
    v_and_b32 v118, v126, v117
    v_lshlrev_b32 v117, 16, v117
    v_mul_f32 v117, 0.15915494, v117
    v_mul_f32 v118, 0.15915494, v118
    v_fract_f32 v117, v117
    v_fract_f32 v118, v118
    v_cos_f32 v117, v117
    v_cos_f32 v118, v118
    v_mul_hi_u32_u24 v122, s38, v74
    v_mul_hi_u32_u24 v121, s37, v38
    v_mul_hi_u32_u24 v120, s36, v38
    v_mad_i32_i24 v110, v122, s44, v74
    v_mad_u32_u24 v74, v122, 40, v121
    v_mad_i32_i24 v38, v120, s39, v38
    v_lshlrev_b16 v74, 2, v74
    v_mad_i32_i24 v120, v121, -3, v120
    ds_add_u32 v74, v3 offset:0
    v_lshl_or_b32 v38, v110, 16, v38
    v_lshl_or_b32 v38, v120, 30, v38
    v_mul_f32 v117, 0x03800000, v117
    v_mul_f32 v118, 0x03800000, v118
    v_cvt_pk_bf16_f32 v117, v117, v118
    v_mul_hi_u32_u24 v122, s38, v75
    v_mul_hi_u32_u24 v121, s37, v39
    v_mul_hi_u32_u24 v120, s36, v39
    v_mad_i32_i24 v110, v122, s44, v75
    v_mad_u32_u24 v75, v122, 40, v121
    v_mad_i32_i24 v39, v120, s39, v39
    v_lshlrev_b16 v75, 2, v75
    v_mad_i32_i24 v120, v121, -3, v120
    ds_add_u32 v75, v3 offset:0
    v_lshl_or_b32 v39, v110, 16, v39
    v_lshl_or_b32 v39, v120, 30, v39
    v_lshrrev_b32 v118, 3, v117
    v_lshrrev_b32 v119, 8, v117
    v_lshlrev_b16 v117, 13, v117
    v_bitop3_b32 v119, v118, v119, v124 bitop3:0x1b
    v_bitop3_b32 v38, v117, v125, v38 bitop3:0xae
    v_lshl_or_b32 v74, v119, 16, v74
    v_bitop3_b32 v39, v118, v125, v39 bitop3:0xae
    v_bitop3_b32 v75, v119, v126, v75 bitop3:0xea
p1_k16:
    s_waitcnt vmcnt(0)
    s_cmp_lg_u32 s28, 15
    s_cbranch_scc1 p1_tk1
    v_mov_b32 v126, 0
    s_mov_b64 exec, 1
    ds_write_b32 v126, v127 offset:10456
    s_mov_b64 exec, -1
p1_tk1:
    s_waitcnt lgkmcnt(0)
    s_barrier
    s_cmp_ge_u32 s28, 10
    s_cbranch_scc1 p1_s1_skip
    v_and_b32 v126, 63, v0
    s_lshl_b32 s54, s28, 4
    v_mul_u32_u24 v117, 160, v126
    v_add_u32 v117, s54, v117
    ds_read_b128 v[118:121], v117 offset:0
    s_waitcnt lgkmcnt(0)
    v_add_u32 v118, 2, v118
    v_add_u32 v119, 2, v119
    v_add_u32 v120, 2, v120
    v_add_u32 v121, 2, v121
    v_mul_u32_u24 v118, 43691, v118
    v_mul_u32_u24 v119, 43691, v119
    v_mul_u32_u24 v120, 43691, v120
    v_mul_u32_u24 v121, 43691, v121
    v_lshrrev_b32 v118, 17, v118
    v_lshrrev_b32 v119, 17, v119
    v_lshrrev_b32 v120, 17, v120
    v_lshrrev_b32 v121, 17, v121
    v_lshl_or_b32 v122, v119, 16, v118
    v_lshl_or_b32 v123, v121, 16, v120
    v_mov_b32 v124, v122
    v_mov_b32 v125, v123
    s_nop 1
    v_add_u32_dpp v124, v124, v124 row_shr:1 row_mask:0xf bank_mask:0xf bound_ctrl:0
    v_add_u32_dpp v125, v125, v125 row_shr:1 row_mask:0xf bank_mask:0xf bound_ctrl:0
    s_nop 0
    v_add_u32_dpp v124, v124, v124 row_shr:2 row_mask:0xf bank_mask:0xf bound_ctrl:0
    v_add_u32_dpp v125, v125, v125 row_shr:2 row_mask:0xf bank_mask:0xf bound_ctrl:0
    s_nop 0
    v_add_u32_dpp v124, v124, v124 row_shr:4 row_mask:0xf bank_mask:0xf bound_ctrl:0
    v_add_u32_dpp v125, v125, v125 row_shr:4 row_mask:0xf bank_mask:0xf bound_ctrl:0
    s_nop 0
    v_add_u32_dpp v124, v124, v124 row_shr:8 row_mask:0xf bank_mask:0xf bound_ctrl:0
    v_add_u32_dpp v125, v125, v125 row_shr:8 row_mask:0xf bank_mask:0xf bound_ctrl:0
    s_nop 0
    v_add_u32_dpp v124, v124, v124 row_bcast:15 row_mask:0xa bank_mask:0xf
    v_add_u32_dpp v125, v125, v125 row_bcast:15 row_mask:0xa bank_mask:0xf
    s_nop 0
    v_add_u32_dpp v124, v124, v124 row_bcast:31 row_mask:0xc bank_mask:0xf
    v_add_u32_dpp v125, v125, v125 row_bcast:31 row_mask:0xc bank_mask:0xf
    s_nop 0
    s_nop 0
    v_mov_b32 v127, s54
    v_and_b32 v118, 0xffff, v124
    v_lshrrev_b32 v119, 16, v124
    v_and_b32 v120, 0xffff, v125
    v_lshrrev_b32 v121, 16, v125
    s_mov_b64 exec, 1
    s_lshl_b64 exec, exec, 63
    ds_write_b128 v127, v[118:121] offset:10240
    s_mov_b64 exec, -1
p1_s1_skip:
    s_waitcnt lgkmcnt(0)
    s_barrier
    v_and_b32 v127, 63, v0
    v_lshlrev_b32 v118, 2, v127
    v_cmp_gt_u32 vcc, 40, v127
    ds_read_b32 v119, v118 offset:10240
    s_waitcnt lgkmcnt(0)
    v_readlane_b32 s33, v119, 54
    v_cndmask_b32 v119, 0, v119, vcc
    v_mov_b32 v120, v119
    s_nop 1
    v_add_u32_dpp v120, v120, v120 row_shr:1 row_mask:0xf bank_mask:0xf bound_ctrl:0
    s_nop 1
    v_add_u32_dpp v120, v120, v120 row_shr:2 row_mask:0xf bank_mask:0xf bound_ctrl:0
    s_nop 1
    v_add_u32_dpp v120, v120, v120 row_shr:4 row_mask:0xf bank_mask:0xf bound_ctrl:0
    s_nop 1
    v_add_u32_dpp v120, v120, v120 row_shr:8 row_mask:0xf bank_mask:0xf bound_ctrl:0
    s_nop 1
    v_add_u32_dpp v120, v120, v120 row_bcast:15 row_mask:0xa bank_mask:0xf
    s_nop 1
    v_add_u32_dpp v120, v120, v120 row_bcast:31 row_mask:0xc bank_mask:0xf
    s_nop 1
    s_nop 0
    v_sub_u32 v119, v120, v119
    v_readlane_b32 s35, v120, 63
    s_add_u32 s33, s33, 256
    s_mul_i32 s46, s33, 1
    s_min_u32 s47, s33, 1499
    s_add_u32 s46, s46, s47
    s_min_u32 s47, s33, 1462
    s_add_u32 s46, s46, s47
    s_min_u32 s47, s33, 1426
    s_add_u32 s46, s46, s47
    s_min_u32 s47, s33, 1389
    s_add_u32 s46, s46, s47
    s_min_u32 s47, s33, 1352
    s_add_u32 s46, s46, s47
    s_min_u32 s47, s33, 1315
    s_add_u32 s46, s46, s47
    s_min_u32 s47, s33, 1279
    s_add_u32 s46, s46, s47
    s_min_u32 s47, s33, 1242
    s_add_u32 s46, s46, s47
    s_lshl_b32 s30, s46, 14
    s_lshl_b32 s31, s46, 13
    s_cmp_ge_u32 s28, 10
    s_cbranch_scc1 p1_s2_skip
    s_lshl_b32 s54, s28, 2
    s_add_u32 s55, s54, 0
    v_readlane_b32 s56, v119, s55
    s_add_u32 s55, s54, 1
    v_readlane_b32 s57, v119, s55
    s_add_u32 s55, s54, 2
    v_readlane_b32 s58, v119, s55
    s_add_u32 s55, s54, 3
    v_readlane_b32 s59, v119, s55
    s_nop 0
    s_lshl_b32 s57, s57, 16
    s_or_b32 s56, s56, s57
    s_lshl_b32 s59, s59, 16
    s_or_b32 s58, s58, s59
    v_add_u32 v124, s56, v124
    v_add_u32 v125, s58, v125
    v_sub_u32 v122, v124, v122
    v_sub_u32 v123, v125, v123
    v_and_b32 v118, 0xffff, v122
    v_lshrrev_b32 v119, 16, v122
    v_and_b32 v120, 0xffff, v123
    v_lshrrev_b32 v121, 16, v123
    v_mul_u32_u24 v118, 3, v118
    v_mul_u32_u24 v119, 3, v119
    v_mul_u32_u24 v120, 3, v120
    v_mul_u32_u24 v121, 3, v121
    ds_write_b128 v117, v[118:121] offset:0
    s_mul_i32 s55, s29, 5248
    s_mul_i32 s56, s28, 520
    s_add_u32 s55, s55, s56
    s_add_u32 s55, s55, 469762048
    v_lshlrev_b32 v127, 3, v126
    buffer_store_dwordx2 v[122:123], v127, s[16:19], s55 offen sc1
    s_mov_b64 exec, 1
    s_lshl_b64 exec, exec, 63
    buffer_store_dwordx2 v[124:125], v127, s[16:19], s55 offen offset:8 sc1
    s_mov_b64 exec, -1
p1_s2_skip:
    s_mul_i32 s50, s29, 16384
    s_lshr_b32 s52, s35, 10
    s_mul_i32 s52, s52, 33554432
    s_and_b32 s53, s35, 1023
    s_lshl_b32 s53, s53, 4
    s_add_u32 s52, s52, s53
    s_add_u32 s52, s52, s50
    s_min_u32 s22, s52, 469762048
    s_mov_b32 s68, 0
    s_cmp_lt_u32 s28, 12
    s_cselect_b32 s71, 8, 7
    s_cmp_lt_u32 s29, 1242
    s_cselect_b32 s35, 13994, s35
    s_waitcnt lgkmcnt(0)
    s_barrier
    s_cmp_lt_u32 s33, 1536
    s_cbranch_scc1 p1_f0
    s_cmp_lg_u32 s28, 15
    s_cbranch_scc1 p1_hv0
    s_sub_u32 s52, s33, 1536
    s_and_b32 s52, s52, 255
    s_lshl_b32 s58, s52, 2
    s_and_b32 s58, s58, 28
    s_lshl_b32 s53, 1, s58
    v_mov_b32 v127, s53
    s_lshr_b32 s52, s52, 3
    s_lshl_b32 s52, s52, 2
    s_mov_b64 exec, 1
    buffer_atomic_add v127, off, s[40:43], s52 sc0 sc1
    s_mov_b64 exec, -1
p1_hv0:
    s_cmp_ge_u32 s33, 1656
    s_cbranch_scc1 p1_f0
    s_sub_u32 s52, s33, 1536
    s_mul_i32 s52, s52, 53368
    s_mul_i32 s53, s28, 3072
    s_add_u32 s53, s53, s52
    v_and_b32 v92, 63, v0
    v_lshl_add_u32 v93, v92, 2, s53
    s_lshl_b32 s53, s28, 9
    s_add_u32 s53, s53, s52
    s_add_u32 s53, s53, 49152
    s_cmp_lt_u32 s28, 9
    s_cselect_b32 s53, s53, 0x40000000
    v_lshl_add_u32 v94, v92, 2, s53
    buffer_load_dword v76, v93, s[24:27], 0 offen offset:0
    buffer_load_dword v77, v93, s[24:27], 0 offen offset:256
    buffer_load_dword v78, v93, s[24:27], 0 offen offset:512
    buffer_load_dword v79, v93, s[24:27], 0 offen offset:768
    buffer_load_dword v80, v93, s[24:27], 0 offen offset:1024
    buffer_load_dword v81, v93, s[24:27], 0 offen offset:1280
    buffer_load_dword v82, v93, s[24:27], 0 offen offset:1536
    buffer_load_dword v83, v93, s[24:27], 0 offen offset:1792
    buffer_load_dword v84, v93, s[24:27], 0 offen offset:2048
    buffer_load_dword v85, v93, s[24:27], 0 offen offset:2304
    buffer_load_dword v86, v93, s[24:27], 0 offen offset:2560
    buffer_load_dword v87, v93, s[24:27], 0 offen offset:2816
    buffer_load_dword v88, v94, s[24:27], 0 offen offset:0
    buffer_load_dword v89, v94, s[24:27], 0 offen offset:256
p1_f0:
    v_and_b32 v117, 0xffff, v40
    ds_add_rtn_u32 v117, v117, v3 offset:0
    v_and_b32 v118, 0xffff, v41
    ds_add_rtn_u32 v118, v118, v3 offset:0
    v_and_b32 v119, 0xffff, v42
    ds_add_rtn_u32 v119, v119, v3 offset:0
    v_and_b32 v120, 0xffff, v43
    ds_add_rtn_u32 v120, v120, v3 offset:0
    s_cmp_ge_u32 s33, 1536
    s_cbranch_scc1 p1_k18
    s_cmp_lt_u32 s33, 1536
    s_cselect_b32 s14, 102400000, 0
    s_add_u32 s32, s31, 0
    buffer_load_dwordx2 v[76:77], v2, s[12:15], s32 offen nt
p1_k18:
    s_cmp_ge_u32 s33, 1536
    s_cbranch_scc1 p1_k19
    s_cmp_lt_u32 s33, 1536
    s_cselect_b32 s6, 204800000, 0
    s_cselect_b32 s10, 204800000, 0
    s_add_u32 s32, s30, 0
    buffer_load_dwordx4 v[94:97], v1, s[4:7], s32 offen nt
    buffer_load_dwordx4 v[102:105], v1, s[8:11], s32 offen nt
p1_k19:
    s_cmp_lt_u32 s29, 1499
    s_cbranch_scc1 p1_pa0
    s_waitcnt lgkmcnt(0)
    s_branch p1_pb0
p1_pa0:
    v_and_b32 v121, 0xffff, v44
    ds_add_rtn_u32 v121, v121, v3 offset:0
    v_and_b32 v122, 0xffff, v45
    ds_add_rtn_u32 v122, v122, v3 offset:0
    v_and_b32 v123, 0xffff, v46
    ds_add_rtn_u32 v123, v123, v3 offset:0
    v_and_b32 v124, 0xffff, v47
    ds_add_rtn_u32 v124, v124, v3 offset:0
    s_waitcnt lgkmcnt(4)
p1_pb0:
    ds_write_b8_d16_hi v117, v40 offset:10496
    v_lshlrev_b32 v40, 2, v117
    ds_write_b32 v40, v4 offset:52480
    ds_write_b8_d16_hi v118, v41 offset:10496
    v_lshlrev_b32 v41, 2, v118
    ds_write_b32 v41, v5 offset:52480
    ds_write_b8_d16_hi v119, v42 offset:10496
    v_lshlrev_b32 v42, 2, v119
    ds_write_b32 v42, v6 offset:52480
    ds_write_b8_d16_hi v120, v43 offset:10496
    v_lshlrev_b32 v43, 2, v120
    ds_write_b32 v43, v7 offset:52480
    s_cmp_ge_u32 s33, 1536
    s_cbranch_scc1 p1_k20
    s_cmp_lt_u32 s33, 1499
    s_cselect_b32 s14, 102400000, 0
    s_add_u32 s32, s31, 8192
    buffer_load_dwordx2 v[78:79], v2, s[12:15], s32 offen nt
p1_k20:
    s_cmp_lt_u32 s29, 1462
    s_cbranch_scc1 p1_pa1
    s_waitcnt lgkmcnt(0)
    s_branch p1_pb1
p1_pa1:
    v_and_b32 v117, 0xffff, v48
    ds_add_rtn_u32 v117, v117, v3 offset:0
    v_and_b32 v118, 0xffff, v49
    ds_add_rtn_u32 v118, v118, v3 offset:0
    v_and_b32 v119, 0xffff, v50
    ds_add_rtn_u32 v119, v119, v3 offset:0
    v_and_b32 v120, 0xffff, v51
    ds_add_rtn_u32 v120, v120, v3 offset:0
    s_waitcnt lgkmcnt(4)
p1_pb1:
    s_cmp_ge_u32 s29, 1499
    s_cbranch_scc1 p1_k21
    ds_write_b8_d16_hi v121, v44 offset:10496
    v_lshlrev_b32 v44, 2, v121
    ds_write_b32 v44, v8 offset:52480
    ds_write_b8_d16_hi v122, v45 offset:10496
    v_lshlrev_b32 v45, 2, v122
    ds_write_b32 v45, v9 offset:52480
    ds_write_b8_d16_hi v123, v46 offset:10496
    v_lshlrev_b32 v46, 2, v123
    ds_write_b32 v46, v10 offset:52480
    ds_write_b8_d16_hi v124, v47 offset:10496
    v_lshlrev_b32 v47, 2, v124
    ds_write_b32 v47, v11 offset:52480
p1_k21:
    s_cmp_ge_u32 s33, 1536
    s_cbranch_scc1 p1_k22
    s_cmp_lt_u32 s33, 1462
    s_cselect_b32 s14, 102400000, 0
    s_add_u32 s32, s31, 16384
    buffer_load_dwordx2 v[80:81], v2, s[12:15], s32 offen nt
p1_k22:
    s_cmp_lt_u32 s29, 1426
    s_cbranch_scc1 p1_pa2
    s_waitcnt lgkmcnt(0)
    s_branch p1_pb2
p1_pa2:
    v_and_b32 v121, 0xffff, v52
    ds_add_rtn_u32 v121, v121, v3 offset:0
    v_and_b32 v122, 0xffff, v53
    ds_add_rtn_u32 v122, v122, v3 offset:0
    v_and_b32 v123, 0xffff, v54
    ds_add_rtn_u32 v123, v123, v3 offset:0
    v_and_b32 v124, 0xffff, v55
    ds_add_rtn_u32 v124, v124, v3 offset:0
    s_waitcnt lgkmcnt(4)
p1_pb2:
    s_cmp_ge_u32 s29, 1462
    s_cbranch_scc1 p1_k23
    ds_write_b8_d16_hi v117, v48 offset:10496
    v_lshlrev_b32 v48, 2, v117
    ds_write_b32 v48, v12 offset:52480
    ds_write_b8_d16_hi v118, v49 offset:10496
    v_lshlrev_b32 v49, 2, v118
    ds_write_b32 v49, v13 offset:52480
    ds_write_b8_d16_hi v119, v50 offset:10496
    v_lshlrev_b32 v50, 2, v119
    ds_write_b32 v50, v14 offset:52480
    ds_write_b8_d16_hi v120, v51 offset:10496
    v_lshlrev_b32 v51, 2, v120
    ds_write_b32 v51, v15 offset:52480
p1_k23:
    s_cmp_ge_u32 s28, 10
    s_cbranch_scc1 p1_jn
    s_waitcnt vmcnt(0)
    v_mov_b32 v125, 0
    s_mov_b64 exec, 1
    ds_add_rtn_u32 v125, v125, v3 offset:10432
    s_waitcnt lgkmcnt(0)
    v_readfirstlane_b32 s52, v125
    s_lshr_b32 s53, s29, 1
    s_and_b32 s53, s53, 28
    s_cmp_lg_u32 s52, 9
    s_cbranch_scc1 p1_jn1
    s_lshl_b32 s54, 1, s53
    v_mov_b32 v127, s54
    s_lshr_b32 s54, s29, 6
    s_lshl_b32 s54, s54, 2
    s_mov_b32 s68, 1
    buffer_atomic_add v127, off, s[40:43], s54 sc0 sc1
p1_jn1:
    s_mov_b64 exec, -1
p1_jn:
    s_cmp_ge_u32 s33, 1536
    s_cbranch_scc1 p1_k24
    s_cmp_lt_u32 s33, 1426
    s_cselect_b32 s14, 102400000, 0
    s_add_u32 s32, s31, 24576
    buffer_load_dwordx2 v[82:83], v2, s[12:15], s32 offen nt
p1_k24:
    s_cmp_lt_u32 s29, 1389
    s_cbranch_scc1 p1_pa3
    s_waitcnt lgkmcnt(0)
    s_branch p1_pb3
p1_pa3:
    v_and_b32 v117, 0xffff, v56
    ds_add_rtn_u32 v117, v117, v3 offset:0
    v_and_b32 v118, 0xffff, v57
    ds_add_rtn_u32 v118, v118, v3 offset:0
    v_and_b32 v119, 0xffff, v58
    ds_add_rtn_u32 v119, v119, v3 offset:0
    v_and_b32 v120, 0xffff, v59
    ds_add_rtn_u32 v120, v120, v3 offset:0
    s_waitcnt lgkmcnt(4)
p1_pb3:
    s_cmp_ge_u32 s29, 1426
    s_cbranch_scc1 p1_k25
    ds_write_b8_d16_hi v121, v52 offset:10496
    v_lshlrev_b32 v52, 2, v121
    ds_write_b32 v52, v16 offset:52480
    ds_write_b8_d16_hi v122, v53 offset:10496
    v_lshlrev_b32 v53, 2, v122
    ds_write_b32 v53, v17 offset:52480
    ds_write_b8_d16_hi v123, v54 offset:10496
    v_lshlrev_b32 v54, 2, v123
    ds_write_b32 v54, v18 offset:52480
    ds_write_b8_d16_hi v124, v55 offset:10496
    v_lshlrev_b32 v55, 2, v124
    ds_write_b32 v55, v19 offset:52480
p1_k25:
    s_cmp_ge_u32 s33, 1536
    s_cbranch_scc1 p1_k26
    s_cmp_lt_u32 s33, 1389
    s_cselect_b32 s14, 102400000, 0
    s_add_u32 s32, s31, 32768
    buffer_load_dwordx2 v[84:85], v2, s[12:15], s32 offen nt
p1_k26:
    s_cmp_ge_u32 s33, 1536
    s_cbranch_scc1 p1_k27
    s_cmp_lt_u32 s33, 1499
    s_cselect_b32 s6, 204800000, 0
    s_cselect_b32 s10, 204800000, 0
    s_add_u32 s32, s30, 16384
    buffer_load_dwordx4 v[98:101], v1, s[4:7], s32 offen nt
    buffer_load_dwordx4 v[106:109], v1, s[8:11], s32 offen nt
p1_k27:
    s_cmp_lt_u32 s29, 1352
    s_cbranch_scc1 p1_pa4
    s_waitcnt lgkmcnt(0)
    s_branch p1_pb4
p1_pa4:
    v_and_b32 v121, 0xffff, v60
    ds_add_rtn_u32 v121, v121, v3 offset:0
    v_and_b32 v122, 0xffff, v61
    ds_add_rtn_u32 v122, v122, v3 offset:0
    v_and_b32 v123, 0xffff, v62
    ds_add_rtn_u32 v123, v123, v3 offset:0
    v_and_b32 v124, 0xffff, v63
    ds_add_rtn_u32 v124, v124, v3 offset:0
    s_waitcnt lgkmcnt(4)
p1_pb4:
    s_cmp_ge_u32 s29, 1389
    s_cbranch_scc1 p1_k28
    ds_write_b8_d16_hi v117, v56 offset:10496
    v_lshlrev_b32 v56, 2, v117
    ds_write_b32 v56, v20 offset:52480
    ds_write_b8_d16_hi v118, v57 offset:10496
    v_lshlrev_b32 v57, 2, v118
    ds_write_b32 v57, v21 offset:52480
    ds_write_b8_d16_hi v119, v58 offset:10496
    v_lshlrev_b32 v58, 2, v119
    ds_write_b32 v58, v22 offset:52480
    ds_write_b8_d16_hi v120, v59 offset:10496
    v_lshlrev_b32 v59, 2, v120
    ds_write_b32 v59, v23 offset:52480
p1_k28:
    s_cmp_ge_u32 s33, 1536
    s_cbranch_scc1 p1_k29
    s_cmp_lt_u32 s33, 1352
    s_cselect_b32 s14, 102400000, 0
    s_add_u32 s32, s31, 40960
    buffer_load_dwordx2 v[86:87], v2, s[12:15], s32 offen nt
p1_k29:
    s_cmp_lt_u32 s29, 1315
    s_cbranch_scc1 p1_pa5
    s_waitcnt lgkmcnt(0)
    s_branch p1_pb5
p1_pa5:
    v_and_b32 v117, 0xffff, v64
    ds_add_rtn_u32 v117, v117, v3 offset:0
    v_and_b32 v118, 0xffff, v65
    ds_add_rtn_u32 v118, v118, v3 offset:0
    v_and_b32 v119, 0xffff, v66
    ds_add_rtn_u32 v119, v119, v3 offset:0
    v_and_b32 v120, 0xffff, v67
    ds_add_rtn_u32 v120, v120, v3 offset:0
    s_waitcnt lgkmcnt(4)
p1_pb5:
    s_cmp_ge_u32 s29, 1352
    s_cbranch_scc1 p1_k30
    ds_write_b8_d16_hi v121, v60 offset:10496
    v_lshlrev_b32 v60, 2, v121
    ds_write_b32 v60, v24 offset:52480
    ds_write_b8_d16_hi v122, v61 offset:10496
    v_lshlrev_b32 v61, 2, v122
    ds_write_b32 v61, v25 offset:52480
    ds_write_b8_d16_hi v123, v62 offset:10496
    v_lshlrev_b32 v62, 2, v123
    ds_write_b32 v62, v26 offset:52480
    ds_write_b8_d16_hi v124, v63 offset:10496
    v_lshlrev_b32 v63, 2, v124
    ds_write_b32 v63, v27 offset:52480
p1_k30:
    s_cmp_ge_u32 s33, 1536
    s_cbranch_scc1 p1_k31
    s_cmp_lt_u32 s33, 1315
    s_cselect_b32 s14, 102400000, 0
    s_add_u32 s32, s31, 49152
    buffer_load_dwordx2 v[88:89], v2, s[12:15], s32 offen nt
p1_k31:
    s_cmp_lt_u32 s29, 1279
    s_cbranch_scc1 p1_pa6
    s_waitcnt lgkmcnt(0)
    s_branch p1_pb6
p1_pa6:
    v_and_b32 v121, 0xffff, v68
    ds_add_rtn_u32 v121, v121, v3 offset:0
    v_and_b32 v122, 0xffff, v69
    ds_add_rtn_u32 v122, v122, v3 offset:0
    v_and_b32 v123, 0xffff, v70
    ds_add_rtn_u32 v123, v123, v3 offset:0
    v_and_b32 v124, 0xffff, v71
    ds_add_rtn_u32 v124, v124, v3 offset:0
    s_waitcnt lgkmcnt(4)
p1_pb6:
    s_cmp_ge_u32 s29, 1315
    s_cbranch_scc1 p1_k32
    ds_write_b8_d16_hi v117, v64 offset:10496
    v_lshlrev_b32 v64, 2, v117
    ds_write_b32 v64, v28 offset:52480
    ds_write_b8_d16_hi v118, v65 offset:10496
    v_lshlrev_b32 v65, 2, v118
    ds_write_b32 v65, v29 offset:52480
    ds_write_b8_d16_hi v119, v66 offset:10496
    v_lshlrev_b32 v66, 2, v119
    ds_write_b32 v66, v30 offset:52480
    ds_write_b8_d16_hi v120, v67 offset:10496
    v_lshlrev_b32 v67, 2, v120
    ds_write_b32 v67, v31 offset:52480
p1_k32:
    s_cmp_ge_u32 s33, 1536
    s_cbranch_scc1 p1_k33
    s_cmp_lt_u32 s33, 1279
    s_cselect_b32 s14, 102400000, 0
    s_add_u32 s32, s31, 57344
    buffer_load_dwordx2 v[90:91], v2, s[12:15], s32 offen nt
p1_k33:
    s_cmp_lt_u32 s29, 1242
    s_cbranch_scc1 p1_pa7
    s_waitcnt lgkmcnt(0)
    s_branch p1_pb7
p1_pa7:
    v_and_b32 v117, 0xffff, v72
    ds_add_rtn_u32 v117, v117, v3 offset:0
    v_and_b32 v118, 0xffff, v73
    ds_add_rtn_u32 v118, v118, v3 offset:0
    v_and_b32 v119, 0xffff, v74
    ds_add_rtn_u32 v119, v119, v3 offset:0
    v_and_b32 v120, 0xffff, v75
    ds_add_rtn_u32 v120, v120, v3 offset:0
    s_waitcnt lgkmcnt(4)
p1_pb7:
    s_cmp_ge_u32 s29, 1279
    s_cbranch_scc1 p1_k34
    ds_write_b8_d16_hi v121, v68 offset:10496
    v_lshlrev_b32 v68, 2, v121
    ds_write_b32 v68, v32 offset:52480
    ds_write_b8_d16_hi v122, v69 offset:10496
    v_lshlrev_b32 v69, 2, v122
    ds_write_b32 v69, v33 offset:52480
    ds_write_b8_d16_hi v123, v70 offset:10496
    v_lshlrev_b32 v70, 2, v123
    ds_write_b32 v70, v34 offset:52480
    ds_write_b8_d16_hi v124, v71 offset:10496
    v_lshlrev_b32 v71, 2, v124
    ds_write_b32 v71, v35 offset:52480
p1_k34:
    s_cmp_ge_u32 s33, 1536
    s_cbranch_scc1 p1_k35
    s_cmp_lt_u32 s33, 1242
    s_cselect_b32 s14, 102400000, 0
    s_add_u32 s32, s31, 65536
    buffer_load_dwordx2 v[92:93], v2, s[12:15], s32 offen nt
p1_k35:
    s_waitcnt lgkmcnt(0)
    s_cmp_ge_u32 s29, 1242
    s_cbranch_scc1 p1_k36
    ds_write_b8_d16_hi v117, v72 offset:10496
    v_lshlrev_b32 v72, 2, v117
    ds_write_b32 v72, v36 offset:52480
    ds_write_b8_d16_hi v118, v73 offset:10496
    v_lshlrev_b32 v73, 2, v118
    ds_write_b32 v73, v37 offset:52480
    ds_write_b8_d16_hi v119, v74 offset:10496
    v_lshlrev_b32 v74, 2, v119
    ds_write_b32 v74, v38 offset:52480
    ds_write_b8_d16_hi v120, v75 offset:10496
    v_lshlrev_b32 v75, 2, v120
    ds_write_b32 v75, v39 offset:52480
p1_k36:
    s_cmp_eq_u32 s68, 0
    s_cbranch_scc1 p1_sg
    s_cmp_lt_u32 s33, 1536
    s_cbranch_scc1 p1_w37
    s_waitcnt vmcnt(0)
p1_w37:
    s_waitcnt vmcnt(8)
    v_bfe_u32 v127, v127, s53, 4
    v_mov_b32 v125, 0
    s_mov_b64 exec, 1
    ds_write_b32 v125, v127 offset:10452
    s_mov_b64 exec, -1
p1_sg:
    s_cmp_lt_u32 s33, 1536
    s_cbranch_scc1 p1_f1
    s_cmp_lg_u32 s28, 15
    s_cbranch_scc1 p1_hv1
    s_waitcnt vmcnt(0)
    v_bfe_u32 v127, v127, s58, 4
    v_mov_b32 v125, 0
    s_mov_b64 exec, 1
    ds_write_b32 v125, v127 offset:10448
    s_mov_b64 exec, -1
p1_hv1:
    s_cmp_ge_u32 s33, 1656
    s_cbranch_scc1 p1_f1
    s_sub_u32 s52, s33, 1536
    s_mul_i32 s53, s52, 53760
    s_add_u32 s53, s53, 485810176
    s_mul_i32 s54, s28, 3072
    v_lshl_add_u32 v93, v92, 4, s54
    s_lshl_b32 s54, s28, 9
    s_add_u32 s54, s54, 49152
    s_cmp_lt_u32 s28, 9
    s_cselect_b32 s54, s54, 0x40000000
    v_lshl_add_u32 v94, v92, 3, s54
    v_mov_b32 v96, 0
    v_mov_b32 v97, 0
    s_waitcnt vmcnt(0)
    buffer_store_dwordx4 v[76:79], v93, s[16:19], s53 offen offset:0
    buffer_store_dwordx4 v[80:83], v93, s[16:19], s53 offen offset:1024
    buffer_store_dwordx4 v[84:87], v93, s[16:19], s53 offen offset:2048
    buffer_store_dwordx2 v[88:89], v94, s[16:19], s53 offen
    v_and_b32 v98, 0x7fff7fff, v76
    v_pk_max_u16 v96, v96, v98
    v_lshlrev_b32 v99, 16, v98
    v_and_b32 v98, 0xffff0000, v98
    v_fmac_f32 v97, v99, v99
    v_fmac_f32 v97, v98, v98
    v_and_b32 v98, 0x7fff7fff, v77
    v_pk_max_u16 v96, v96, v98
    v_lshlrev_b32 v99, 16, v98
    v_and_b32 v98, 0xffff0000, v98
    v_fmac_f32 v97, v99, v99
    v_fmac_f32 v97, v98, v98
    v_and_b32 v98, 0x7fff7fff, v78
    v_pk_max_u16 v96, v96, v98
    v_lshlrev_b32 v99, 16, v98
    v_and_b32 v98, 0xffff0000, v98
    v_fmac_f32 v97, v99, v99
    v_fmac_f32 v97, v98, v98
    v_and_b32 v98, 0x7fff7fff, v79
    v_pk_max_u16 v96, v96, v98
    v_lshlrev_b32 v99, 16, v98
    v_and_b32 v98, 0xffff0000, v98
    v_fmac_f32 v97, v99, v99
    v_fmac_f32 v97, v98, v98
    v_and_b32 v98, 0x7fff7fff, v80
    v_pk_max_u16 v96, v96, v98
    v_lshlrev_b32 v99, 16, v98
    v_and_b32 v98, 0xffff0000, v98
    v_fmac_f32 v97, v99, v99
    v_fmac_f32 v97, v98, v98
    v_and_b32 v98, 0x7fff7fff, v81
    v_pk_max_u16 v96, v96, v98
    v_lshlrev_b32 v99, 16, v98
    v_and_b32 v98, 0xffff0000, v98
    v_fmac_f32 v97, v99, v99
    v_fmac_f32 v97, v98, v98
    v_and_b32 v98, 0x7fff7fff, v82
    v_pk_max_u16 v96, v96, v98
    v_lshlrev_b32 v99, 16, v98
    v_and_b32 v98, 0xffff0000, v98
    v_fmac_f32 v97, v99, v99
    v_fmac_f32 v97, v98, v98
    v_and_b32 v98, 0x7fff7fff, v83
    v_pk_max_u16 v96, v96, v98
    v_lshlrev_b32 v99, 16, v98
    v_and_b32 v98, 0xffff0000, v98
    v_fmac_f32 v97, v99, v99
    v_fmac_f32 v97, v98, v98
    v_and_b32 v98, 0x7fff7fff, v84
    v_pk_max_u16 v96, v96, v98
    v_lshlrev_b32 v99, 16, v98
    v_and_b32 v98, 0xffff0000, v98
    v_fmac_f32 v97, v99, v99
    v_fmac_f32 v97, v98, v98
    v_and_b32 v98, 0x7fff7fff, v85
    v_pk_max_u16 v96, v96, v98
    v_lshlrev_b32 v99, 16, v98
    v_and_b32 v98, 0xffff0000, v98
    v_fmac_f32 v97, v99, v99
    v_fmac_f32 v97, v98, v98
    v_and_b32 v98, 0x7fff7fff, v86
    v_pk_max_u16 v96, v96, v98
    v_lshlrev_b32 v99, 16, v98
    v_and_b32 v98, 0xffff0000, v98
    v_fmac_f32 v97, v99, v99
    v_fmac_f32 v97, v98, v98
    v_and_b32 v98, 0x7fff7fff, v87
    v_pk_max_u16 v96, v96, v98
    v_lshlrev_b32 v99, 16, v98
    v_and_b32 v98, 0xffff0000, v98
    v_fmac_f32 v97, v99, v99
    v_fmac_f32 v97, v98, v98
    v_and_b32 v98, 0x7fff7fff, v88
    v_pk_max_u16 v96, v96, v98
    v_lshlrev_b32 v99, 16, v98
    v_and_b32 v98, 0xffff0000, v98
    v_fmac_f32 v97, v99, v99
    v_fmac_f32 v97, v98, v98
    v_and_b32 v98, 0x7fff7fff, v89
    v_pk_max_u16 v96, v96, v98
    v_lshlrev_b32 v99, 16, v98
    v_and_b32 v98, 0xffff0000, v98
    v_fmac_f32 v97, v99, v99
    v_fmac_f32 v97, v98, v98
    v_lshrrev_b32 v98, 16, v96
    v_and_b32 v96, 0xffff, v96
    v_max_u32 v96, v96, v98
    s_nop 1
    v_max_u32_dpp v96, v96, v96 row_shr:1 row_mask:0xf bank_mask:0xf bound_ctrl:0
    v_add_f32_dpp v97, v97, v97 row_shr:1 row_mask:0xf bank_mask:0xf bound_ctrl:0
    s_nop 0
    v_max_u32_dpp v96, v96, v96 row_shr:2 row_mask:0xf bank_mask:0xf bound_ctrl:0
    v_add_f32_dpp v97, v97, v97 row_shr:2 row_mask:0xf bank_mask:0xf bound_ctrl:0
    s_nop 0
    v_max_u32_dpp v96, v96, v96 row_shr:4 row_mask:0xf bank_mask:0xf bound_ctrl:0
    v_add_f32_dpp v97, v97, v97 row_shr:4 row_mask:0xf bank_mask:0xf bound_ctrl:0
    s_nop 0
    v_max_u32_dpp v96, v96, v96 row_shr:8 row_mask:0xf bank_mask:0xf bound_ctrl:0
    v_add_f32_dpp v97, v97, v97 row_shr:8 row_mask:0xf bank_mask:0xf bound_ctrl:0
    s_nop 0
    v_max_u32_dpp v96, v96, v96 row_bcast:15 row_mask:0xa bank_mask:0xf
    v_add_f32_dpp v97, v97, v97 row_bcast:15 row_mask:0xa bank_mask:0xf
    s_nop 0
    v_max_u32_dpp v96, v96, v96 row_bcast:31 row_mask:0xc bank_mask:0xf
    v_add_f32_dpp v97, v97, v97 row_bcast:31 row_mask:0xc bank_mask:0xf
    s_nop 0
    s_nop 0
    s_lshl_b32 s52, s52, 4
    s_add_u32 s52, s52, s28
    s_lshl_b32 s52, s52, 3
    s_add_u32 s52, s52, 492261376
    s_mov_b64 exec, 1
    s_lshl_b64 exec, exec, 63
    buffer_store_dwordx2 v[96:97], off, s[16:19], s52
    s_mov_b64 exec, -1
p1_f1:
    s_waitcnt lgkmcnt(0)
    s_barrier
    v_mul_u32_u24 v119, 3, v0
    v_and_b32 v118, -4, v119
    v_add_u32 v120, s50, v1
    v_mov_b32 v122, 0
    v_mov_b32 v123, 0
    v_mov_b32 v124, 0
    v_mov_b32 v125, 0
    ds_read_b64 v[126:127], v122 offset:10448
    ds_write_b32 v122, v122 offset:10432
    v_cmp_gt_u32 vcc, 640, v0
    s_and_saveexec_b64 s[52:53], vcc
    ds_write_b128 v1, v[122:125] offset:0
    s_mov_b64 exec, -1
    s_waitcnt lgkmcnt(2)
    v_readfirstlane_b32 s70, v126
    v_readfirstlane_b32 s69, v127
    s_cmp_ge_u32 s33, 1536
    s_cselect_b32 s70, s70, 0
    s_cmp_gt_u32 s28, 10
    s_cselect_b32 s69, 0, s69
    s_cselect_b32 s70, 0, s70
    s_cmp_lg_u32 s70, 8
    s_cbranch_scc1 p1_h0
    s_sub_u32 s52, s33, 1536
    v_and_b32 v102, 63, v0
    s_cmp_eq_u32 s28, 10
    s_cbranch_scc1 p1_tr10
    s_mul_i32 s53, s28, 520
    v_lshl_add_u32 v100, v102, 3, s53
    s_mul_i32 s53, s28, 4160
    v_lshl_add_u32 v101, v102, 4, s53
    s_branch p1_tr20
p1_tr10:
    v_mul_u32_u24 v100, 520, v102
    v_add_u32 v100, 512, v100
    v_mul_u32_u24 v101, 4160, v102
    v_add_u32 v101, 1024, v101
    v_cmp_gt_u32 vcc, 10, v102
    v_mov_b32 v102, 0x40000000
    s_nop 0
    v_cndmask_b32 v100, v102, v100, vcc
    v_cndmask_b32 v101, v102, v101, vcc
p1_tr20:
    s_mul_i32 s52, s52, 41984
    s_add_u32 s52, s52, 469762048
    buffer_load_dwordx2 v[76:77], v100, s[16:19], s52 offen sc1
    s_add_u32 s52, s52, 5248
    buffer_load_dwordx2 v[78:79], v100, s[16:19], s52 offen sc1
    s_add_u32 s52, s52, 5248
    buffer_load_dwordx2 v[80:81], v100, s[16:19], s52 offen sc1
    s_add_u32 s52, s52, 5248
    buffer_load_dwordx2 v[82:83], v100, s[16:19], s52 offen sc1
    s_add_u32 s52, s52, 5248
    buffer_load_dwordx2 v[84:85], v100, s[16:19], s52 offen sc1
    s_add_u32 s52, s52, 5248
    buffer_load_dwordx2 v[86:87], v100, s[16:19], s52 offen sc1
    s_add_u32 s52, s52, 5248
    buffer_load_dwordx2 v[88:89], v100, s[16:19], s52 offen sc1
    s_add_u32 s52, s52, 5248
    buffer_load_dwordx2 v[90:91], v100, s[16:19], s52 offen sc1
    s_add_u32 s52, s52, 5248
p1_h0:
    v_lshlrev_b32 v117, 2, v119
    v_add_u32 v117, 52480, v117
    ds_read_b32 v110, v117 offset:0
    ds_read_b32 v111, v117 offset:4
    ds_read_b32 v112, v117 offset:8
    ds_read_b32 v113, v118 offset:10496
    ds_read_b32 v114, v118 offset:10500
    ds_read_b32 v122, v117 offset:12288
    ds_read_b32 v123, v117 offset:12292
    ds_read_b32 v124, v117 offset:12296
    ds_read_b32 v125, v118 offset:13568
    ds_read_b32 v121, v118 offset:13572
    s_waitcnt lgkmcnt(5)
    v_alignbyte_b32 v113, v114, v113, v119
    buffer_store_dwordx4 v[110:113], v120, s[20:23], 0 offen
    v_add_u32 v120, 33554432, v120
    s_nop 0
    ds_read_b32 v110, v117 offset:24576
    ds_read_b32 v111, v117 offset:24580
    ds_read_b32 v112, v117 offset:24584
    ds_read_b32 v113, v118 offset:16640
    ds_read_b32 v114, v118 offset:16644
    s_cmp_le_u32 s35, 1024
    s_cbranch_scc1 p1_ce0
    s_waitcnt lgkmcnt(5)
    v_alignbyte_b32 v125, v121, v125, v119
    buffer_store_dwordx4 v[122:125], v120, s[20:23], 0 offen
    v_add_u32 v120, 33554432, v120
    s_nop 0
    ds_read_b32 v122, v117 offset:36864
    ds_read_b32 v123, v117 offset:36868
    ds_read_b32 v124, v117 offset:36872
    ds_read_b32 v125, v118 offset:19712
    ds_read_b32 v121, v118 offset:19716
    s_cmp_le_u32 s35, 2048
    s_cbranch_scc1 p1_ce0
    s_waitcnt lgkmcnt(5)
    v_alignbyte_b32 v113, v114, v113, v119
    buffer_store_dwordx4 v[110:113], v120, s[20:23], 0 offen
    v_add_u32 v120, 33554432, v120
    s_nop 0
    ds_read_b32 v110, v117 offset:49152
    ds_read_b32 v111, v117 offset:49156
    ds_read_b32 v112, v117 offset:49160
    ds_read_b32 v113, v118 offset:22784
    ds_read_b32 v114, v118 offset:22788
    s_cmp_le_u32 s35, 3072
    s_cbranch_scc1 p1_ce0
    s_waitcnt lgkmcnt(5)
    v_alignbyte_b32 v125, v121, v125, v119
    buffer_store_dwordx4 v[122:125], v120, s[20:23], 0 offen
    v_add_u32 v120, 33554432, v120
    s_nop 0
    v_lshlrev_b32 v117, 2, v119
    v_add_u32 v117, 113920, v117
    ds_read_b32 v122, v117 offset:0
    ds_read_b32 v123, v117 offset:4
    ds_read_b32 v124, v117 offset:8
    ds_read_b32 v125, v118 offset:25856
    ds_read_b32 v121, v118 offset:25860
    s_cmp_le_u32 s35, 4096
    s_cbranch_scc1 p1_ce0
    s_waitcnt lgkmcnt(5)
    v_alignbyte_b32 v113, v114, v113, v119
    buffer_store_dwordx4 v[110:113], v120, s[20:23], 0 offen
    v_add_u32 v120, 33554432, v120
    s_nop 0
    ds_read_b32 v110, v117 offset:12288
    ds_read_b32 v111, v117 offset:12292
    ds_read_b32 v112, v117 offset:12296
    ds_read_b32 v113, v118 offset:28928
    ds_read_b32 v114, v118 offset:28932
    s_cmp_le_u32 s35, 5120
    s_cbranch_scc1 p1_ce0
    s_waitcnt lgkmcnt(5)
    v_alignbyte_b32 v125, v121, v125, v119
    buffer_store_dwordx4 v[122:125], v120, s[20:23], 0 offen
    v_add_u32 v120, 33554432, v120
    s_nop 0
    ds_read_b32 v122, v117 offset:24576
    ds_read_b32 v123, v117 offset:24580
    ds_read_b32 v124, v117 offset:24584
    ds_read_b32 v125, v118 offset:32000
    ds_read_b32 v121, v118 offset:32004
    s_cmp_le_u32 s35, 6144
    s_cbranch_scc1 p1_ce0
    s_waitcnt lgkmcnt(5)
    v_alignbyte_b32 v113, v114, v113, v119
    buffer_store_dwordx4 v[110:113], v120, s[20:23], 0 offen
    v_add_u32 v120, 33554432, v120
    s_nop 0
    ds_read_b32 v110, v117 offset:36864
    ds_read_b32 v111, v117 offset:36868
    ds_read_b32 v112, v117 offset:36872
    ds_read_b32 v113, v118 offset:35072
    ds_read_b32 v114, v118 offset:35076
    s_cmp_le_u32 s35, 7168
    s_cbranch_scc1 p1_ce0
    s_waitcnt lgkmcnt(5)
    v_alignbyte_b32 v125, v121, v125, v119
    s_cmp_le_u32 s71, 7
    s_cbranch_scc1 p1_pw7
    buffer_store_dwordx4 v[122:125], v120, s[20:23], 0 offen
    s_branch p1_px7
p1_pw7:
    buffer_store_dwordx4 v[122:125], v120, s[20:23], 0 offen nt
p1_px7:
    v_add_u32 v120, 33554432, v120
    s_nop 0
    s_cmp_le_u32 s35, 8192
    s_cbranch_scc1 p1_ce0
    s_waitcnt lgkmcnt(0)
    v_alignbyte_b32 v113, v114, v113, v119
    buffer_store_dwordx4 v[110:113], v120, s[20:23], 0 offen nt
    v_add_u32 v120, 33554432, v120
    s_nop 0
p1_ce0:
    s_waitcnt lgkmcnt(0)
    s_cmp_lg_u32 s70, 8
    s_cbranch_scc1 p1_h1
    s_sub_u32 s52, s33, 1536
    s_mul_i32 s52, s52, 41600
    s_add_u32 s52, s52, 477822976
    s_mov_b32 s54, 0x05040100
    s_mov_b32 s55, 0x07060302
    s_waitcnt vmcnt(1)
    v_perm_b32 v92, v78, v76, s54
    v_perm_b32 v93, v82, v80, s54
    v_perm_b32 v94, v86, v84, s54
    v_perm_b32 v95, v90, v88, s54
    buffer_store_dwordx4 v[92:95], v101, s[16:19], s52 offen offset:0
    v_perm_b32 v96, v78, v76, s55
    v_perm_b32 v97, v82, v80, s55
    v_perm_b32 v98, v86, v84, s55
    v_perm_b32 v99, v90, v88, s55
    buffer_store_dwordx4 v[96:99], v101, s[16:19], s52 offen offset:1040
    v_perm_b32 v92, v79, v77, s54
    v_perm_b32 v93, v83, v81, s54
    v_perm_b32 v94, v87, v85, s54
    v_perm_b32 v95, v91, v89, s54
    buffer_store_dwordx4 v[92:95], v101, s[16:19], s52 offen offset:2080
    v_perm_b32 v96, v79, v77, s55
    v_perm_b32 v97, v83, v81, s55
    v_perm_b32 v98, v87, v85, s55
    v_perm_b32 v99, v91, v89, s55
    buffer_store_dwordx4 v[96:99], v101, s[16:19], s52 offen offset:3120
p1_h1:
    s_barrier
    s_cmp_ge_u32 s29, 1462
    s_cbranch_scc1 p1_k38
    s_cmp_le_u32 s35, 9216
    s_cbranch_scc1 p1_s1k2
    v_sub_u32 v48, 221180, v48
    ds_write_b32 v48, v12 offset:52480
    v_sub_u32 v49, 221180, v49
    ds_write_b32 v49, v13 offset:52480
    v_sub_u32 v50, 221180, v50
    ds_write_b32 v50, v14 offset:52480
    v_sub_u32 v51, 221180, v51
    ds_write_b32 v51, v15 offset:52480
p1_s1k2:
p1_k38:
    s_cmp_ge_u32 s33, 1536
    s_cbranch_scc1 p1_k39
    s_cmp_lt_u32 s33, 1462
    s_cselect_b32 s6, 204800000, 0
    s_cselect_b32 s10, 204800000, 0
    s_add_u32 s32, s30, 32768
    buffer_load_dwordx4 v[12:15], v1, s[4:7], s32 offen nt
    buffer_load_dwordx4 v[48:51], v1, s[8:11], s32 offen nt
p1_k39:
    s_cmp_ge_u32 s29, 1426
    s_cbranch_scc1 p1_k40
    s_cmp_le_u32 s35, 9216
    s_cbranch_scc1 p1_s1k3
    v_sub_u32 v52, 221180, v52
    ds_write_b32 v52, v16 offset:52480
    v_sub_u32 v53, 221180, v53
    ds_write_b32 v53, v17 offset:52480
    v_sub_u32 v54, 221180, v54
    ds_write_b32 v54, v18 offset:52480
    v_sub_u32 v55, 221180, v55
    ds_write_b32 v55, v19 offset:52480
p1_s1k3:
p1_k40:
    s_cmp_ge_u32 s29, 1389
    s_cbranch_scc1 p1_k41
    s_cmp_le_u32 s35, 9216
    s_cbranch_scc1 p1_s1k4
    v_sub_u32 v56, 221180, v56
    ds_write_b32 v56, v20 offset:52480
    v_sub_u32 v57, 221180, v57
    ds_write_b32 v57, v21 offset:52480
    v_sub_u32 v58, 221180, v58
    ds_write_b32 v58, v22 offset:52480
    v_sub_u32 v59, 221180, v59
    ds_write_b32 v59, v23 offset:52480
p1_s1k4:
p1_k41:
    s_cmp_ge_u32 s29, 1352
    s_cbranch_scc1 p1_k42
    s_cmp_le_u32 s35, 9216
    s_cbranch_scc1 p1_s1k5
    v_sub_u32 v60, 221180, v60
    ds_write_b32 v60, v24 offset:52480
    v_sub_u32 v61, 221180, v61
    ds_write_b32 v61, v25 offset:52480
    v_sub_u32 v62, 221180, v62
    ds_write_b32 v62, v26 offset:52480
    v_sub_u32 v63, 221180, v63
    ds_write_b32 v63, v27 offset:52480
p1_s1k5:
p1_k42:
    s_cmp_ge_u32 s29, 1315
    s_cbranch_scc1 p1_k43
    s_cmp_le_u32 s35, 9216
    s_cbranch_scc1 p1_s1k6
    v_sub_u32 v64, 221180, v64
    ds_write_b32 v64, v28 offset:52480
    v_sub_u32 v65, 221180, v65
    ds_write_b32 v65, v29 offset:52480
    v_sub_u32 v66, 221180, v66
    ds_write_b32 v66, v30 offset:52480
    v_sub_u32 v67, 221180, v67
    ds_write_b32 v67, v31 offset:52480
p1_s1k6:
p1_k43:
    s_cmp_ge_u32 s29, 1279
    s_cbranch_scc1 p1_k44
    s_cmp_le_u32 s35, 9216
    s_cbranch_scc1 p1_s1k7
    v_sub_u32 v68, 221180, v68
    ds_write_b32 v68, v32 offset:52480
    v_sub_u32 v69, 221180, v69
    ds_write_b32 v69, v33 offset:52480
    v_sub_u32 v70, 221180, v70
    ds_write_b32 v70, v34 offset:52480
    v_sub_u32 v71, 221180, v71
    ds_write_b32 v71, v35 offset:52480
p1_s1k7:
p1_k44:
    s_cmp_ge_u32 s29, 1242
    s_cbranch_scc1 p1_k45
    s_cmp_le_u32 s35, 9216
    s_cbranch_scc1 p1_s1k8
    v_sub_u32 v72, 221180, v72
    ds_write_b32 v72, v36 offset:52480
    v_sub_u32 v73, 221180, v73
    ds_write_b32 v73, v37 offset:52480
    v_sub_u32 v74, 221180, v74
    ds_write_b32 v74, v38 offset:52480
    v_sub_u32 v75, 221180, v75
    ds_write_b32 v75, v39 offset:52480
p1_s1k8:
p1_k45:
    s_cmp_le_u32 s35, 9216
    s_cbranch_scc1 p1_s1k0
    v_sub_u32 v40, 221180, v40
    ds_write_b32 v40, v4 offset:52480
    v_sub_u32 v41, 221180, v41
    ds_write_b32 v41, v5 offset:52480
    v_sub_u32 v42, 221180, v42
    ds_write_b32 v42, v6 offset:52480
    v_sub_u32 v43, 221180, v43
    ds_write_b32 v43, v7 offset:52480
p1_s1k0:
    s_cmp_ge_u32 s29, 1499
    s_cbranch_scc1 p1_k46
    s_cmp_le_u32 s35, 9216
    s_cbranch_scc1 p1_s1k1
    v_sub_u32 v44, 221180, v44
    ds_write_b32 v44, v8 offset:52480
    v_sub_u32 v45, 221180, v45
    ds_write_b32 v45, v9 offset:52480
    v_sub_u32 v46, 221180, v46
    ds_write_b32 v46, v10 offset:52480
    v_sub_u32 v47, 221180, v47
    ds_write_b32 v47, v11 offset:52480
p1_s1k1:
p1_k46:
    s_cmp_lg_u32 s69, 8
    s_cbranch_scc1 p1_o1
    s_lshr_b32 s52, s29, 3
    v_and_b32 v74, 63, v0
    s_cmp_eq_u32 s28, 10
    s_cbranch_scc1 p1_tr11
    s_mul_i32 s53, s28, 520
    v_lshl_add_u32 v72, v74, 3, s53
    s_mul_i32 s53, s28, 4160
    v_lshl_add_u32 v73, v74, 4, s53
    s_branch p1_tr21
p1_tr11:
    v_mul_u32_u24 v72, 520, v74
    v_add_u32 v72, 512, v72
    v_mul_u32_u24 v73, 4160, v74
    v_add_u32 v73, 1024, v73
    v_cmp_gt_u32 vcc, 10, v74
    v_mov_b32 v74, 0x40000000
    s_nop 0
    v_cndmask_b32 v72, v74, v72, vcc
    v_cndmask_b32 v73, v74, v73, vcc
p1_tr21:
    s_mul_i32 s52, s52, 41984
    s_add_u32 s52, s52, 469762048
    buffer_load_dwordx2 v[24:25], v72, s[16:19], s52 offen sc1
    s_add_u32 s52, s52, 5248
    buffer_load_dwordx2 v[26:27], v72, s[16:19], s52 offen sc1
    s_add_u32 s52, s52, 5248
    buffer_load_dwordx2 v[28:29], v72, s[16:19], s52 offen sc1
    s_add_u32 s52, s52, 5248
    buffer_load_dwordx2 v[30:31], v72, s[16:19], s52 offen sc1
    s_add_u32 s52, s52, 5248
    buffer_load_dwordx2 v[32:33], v72, s[16:19], s52 offen sc1
    s_add_u32 s52, s52, 5248
    buffer_load_dwordx2 v[34:35], v72, s[16:19], s52 offen sc1
    s_add_u32 s52, s52, 5248
    buffer_load_dwordx2 v[36:37], v72, s[16:19], s52 offen sc1
    s_add_u32 s52, s52, 5248
    buffer_load_dwordx2 v[38:39], v72, s[16:19], s52 offen sc1
    s_add_u32 s52, s52, 5248
    s_cmp_ge_u32 s33, 1536
    s_cbranch_scc1 p1_o1
    s_lshr_b32 s52, s29, 3
    s_mul_i32 s52, s52, 41600
    s_add_u32 s52, s52, 477822976
    s_mov_b32 s54, 0x05040100
    s_mov_b32 s55, 0x07060302
    s_waitcnt vmcnt(0)
    v_perm_b32 v64, v26, v24, s54
    v_perm_b32 v65, v30, v28, s54
    v_perm_b32 v66, v34, v32, s54
    v_perm_b32 v67, v38, v36, s54
    buffer_store_dwordx4 v[64:67], v73, s[16:19], s52 offen offset:0
    v_perm_b32 v68, v26, v24, s55
    v_perm_b32 v69, v30, v28, s55
    v_perm_b32 v70, v34, v32, s55
    v_perm_b32 v71, v38, v36, s55
    buffer_store_dwordx4 v[68:71], v73, s[16:19], s52 offen offset:1040
    v_perm_b32 v64, v27, v25, s54
    v_perm_b32 v65, v31, v29, s54
    v_perm_b32 v66, v35, v33, s54
    v_perm_b32 v67, v39, v37, s54
    buffer_store_dwordx4 v[64:67], v73, s[16:19], s52 offen offset:2080
    v_perm_b32 v68, v27, v25, s55
    v_perm_b32 v69, v31, v29, s55
    v_perm_b32 v70, v35, v33, s55
    v_perm_b32 v71, v39, v37, s55
    buffer_store_dwordx4 v[68:71], v73, s[16:19], s52 offen offset:3120
    s_mov_b32 s69, 0
p1_o1:
    s_waitcnt lgkmcnt(0)
    s_barrier
    s_cmp_le_u32 s35, 9216
    s_cbranch_scc1 p1_ce1
    v_lshlrev_b32 v117, 2, v119
    v_sub_u32 v117, 113908, v117
    ds_read_b32 v122, v117 offset:49160
    ds_read_b32 v123, v117 offset:49156
    ds_read_b32 v124, v117 offset:49152
    ds_read_b32 v125, v118 offset:38144
    ds_read_b32 v121, v118 offset:38148
    ds_read_b32 v110, v117 offset:36872
    ds_read_b32 v111, v117 offset:36868
    ds_read_b32 v112, v117 offset:36864
    ds_read_b32 v113, v118 offset:41216
    ds_read_b32 v114, v118 offset:41220
    s_waitcnt lgkmcnt(5)
    v_alignbyte_b32 v125, v121, v125, v119
    buffer_store_dwordx4 v[122:125], v120, s[20:23], 0 offen nt
    v_add_u32 v120, 33554432, v120
    s_nop 0
    ds_read_b32 v122, v117 offset:24584
    ds_read_b32 v123, v117 offset:24580
    ds_read_b32 v124, v117 offset:24576
    ds_read_b32 v125, v118 offset:44288
    ds_read_b32 v121, v118 offset:44292
    s_cmp_le_u32 s35, 10240
    s_cbranch_scc1 p1_ce1
    s_waitcnt lgkmcnt(5)
    v_alignbyte_b32 v113, v114, v113, v119
    buffer_store_dwordx4 v[110:113], v120, s[20:23], 0 offen nt
    v_add_u32 v120, 33554432, v120
    s_nop 0
    ds_read_b32 v110, v117 offset:12296
    ds_read_b32 v111, v117 offset:12292
    ds_read_b32 v112, v117 offset:12288
    ds_read_b32 v113, v118 offset:47360
    ds_read_b32 v114, v118 offset:47364
    s_cmp_le_u32 s35, 11264
    s_cbranch_scc1 p1_ce1
    s_waitcnt lgkmcnt(5)
    v_alignbyte_b32 v125, v121, v125, v119
    buffer_store_dwordx4 v[122:125], v120, s[20:23], 0 offen nt
    v_add_u32 v120, 33554432, v120
    s_nop 0
    ds_read_b32 v122, v117 offset:8
    ds_read_b32 v123, v117 offset:4
    ds_read_b32 v124, v117 offset:0
    ds_read_b32 v125, v118 offset:50432
    ds_read_b32 v121, v118 offset:50436
    s_cmp_le_u32 s35, 12288
    s_cbranch_scc1 p1_ce1
    s_waitcnt lgkmcnt(5)
    v_alignbyte_b32 v113, v114, v113, v119
    buffer_store_dwordx4 v[110:113], v120, s[20:23], 0 offen nt
    v_add_u32 v120, 33554432, v120
    s_nop 0
    s_cmp_le_u32 s35, 13312
    s_cbranch_scc1 p1_ce1
    s_waitcnt lgkmcnt(0)
    v_alignbyte_b32 v125, v121, v125, v119
    buffer_store_dwordx4 v[122:125], v120, s[20:23], 0 offen nt
    v_add_u32 v120, 33554432, v120
    s_nop 0
p1_ce1:
    s_waitcnt lgkmcnt(0)
    s_cmp_lg_u32 s69, 8
    s_cbranch_scc1 p1_o2
    s_lshr_b32 s52, s29, 3
    s_mul_i32 s52, s52, 41600
    s_add_u32 s52, s52, 477822976
    s_mov_b32 s54, 0x05040100
    s_mov_b32 s55, 0x07060302
    s_waitcnt vmcnt(0)
    v_perm_b32 v64, v26, v24, s54
    v_perm_b32 v65, v30, v28, s54
    v_perm_b32 v66, v34, v32, s54
    v_perm_b32 v67, v38, v36, s54
    buffer_store_dwordx4 v[64:67], v73, s[16:19], s52 offen offset:0
    v_perm_b32 v68, v26, v24, s55
    v_perm_b32 v69, v30, v28, s55
    v_perm_b32 v70, v34, v32, s55
    v_perm_b32 v71, v38, v36, s55
    buffer_store_dwordx4 v[68:71], v73, s[16:19], s52 offen offset:1040
    v_perm_b32 v64, v27, v25, s54
    v_perm_b32 v65, v31, v29, s54
    v_perm_b32 v66, v35, v33, s54
    v_perm_b32 v67, v39, v37, s54
    buffer_store_dwordx4 v[64:67], v73, s[16:19], s52 offen offset:2080
    v_perm_b32 v68, v27, v25, s55
    v_perm_b32 v69, v31, v29, s55
    v_perm_b32 v70, v35, v33, s55
    v_perm_b32 v71, v39, v37, s55
    buffer_store_dwordx4 v[68:71], v73, s[16:19], s52 offen offset:3120
p1_o2:
    s_barrier
    s_mov_b32 s29, s33
    s_cmp_lt_u32 s29, 1242
    s_cselect_b32 s34, 1, 0
    s_cmp_lt_u32 s29, 1536
    s_cbranch_scc1 p1_tile
p1_end:
    s_endpgm
.globl p2_kernel
.p2align 8
.type p2_kernel,@function
p2_kernel:
    s_cmp_ge_u32 s2, 256
    s_cbranch_scc1 p2_end
    s_load_dwordx2 s[8:9], s[0:1], 104
    v_and_b32 v112, 63, v0
    v_lshrrev_b32 v122, 6, v0
    v_lshlrev_b32 v112, 4, v112
    v_readfirstlane_b32 s10, v122
    v_mov_b32 v113, 0x83ff0000
    s_and_b32 s44, s2, 7
    s_lshr_b32 s11, s44, 1
    s_and_b32 s44, s44, 1
    s_lshl_b32 s12, s44, 5
    s_lshr_b32 s44, s2, 3
    s_add_u32 s12, s12, s44
    s_mov_b32 s25, 54272
    s_mov_b32 s31, 67175170
    s_mov_b32 s32, 83952386
    s_mov_b32 s33, 100729602
    s_mov_b32 s21, 0
    s_mul_i32 s23, s10, 3072
    s_lshl_b32 s24, s10, 9
    s_lshl_b32 s64, s10, 10
    s_sub_u32 s42, s24, s23
    s_add_u32 s42, s42, 49152
    s_movk_i32 s63, 2048
    s_movk_i32 s65, 16384
    s_mul_i32 s62, s11, 161280
    s_add_u32 s62, s62, 485810176
    s_add_u32 s62, s62, s23
    s_mov_b32 s40, 477822976
    s_mul_i32 s44, s11, 1040
    s_add_u32 s40, s40, s44
    s_lshl_b32 s44, s12, 4
    s_add_u32 s40, s40, s44
    s_waitcnt lgkmcnt(0)
    s_mov_b32 s4, s8
    s_and_b32 s5, s9, 0xffff
    s_mov_b32 s6, 819200000
    s_mov_b32 s7, 0x20000
    s_mov_b32 s68, s8
    s_and_b32 s69, s9, 0xffff
    s_mov_b32 s70, 469762048
    s_mov_b32 s71, 0x20000
    s_and_b32 s44, s2, 7
    s_lshl_b32 s44, s44, 2
    s_lshr_b32 s18, 0x00000000, s44
    s_and_b32 s18, s18, 15
p2_restart:
    s_mov_b32 s61, 0
    s_add_u32 s44, s61, s18
    s_cmp_ge_u32 s44, 10
    s_cselect_b32 s53, 10, 0
    s_sub_u32 s44, s44, s53
    s_mul_i32 s44, s44, 4160
    s_add_u32 s44, s44, s40
    v_bfe_i32 v111, v112, 6, 1
    v_lshrrev_b32 v110, 6, v112
    v_bitop3_b32 v111, v111, 15, s10 bitop3:0x6a
    v_lshl_or_b32 v110, v110, 4, v111
    v_bfe_u32 v111, v112, 2, 4
    v_mul_u32_u24 v110, 41600, v110
    v_add_u32 v111, v110, v111
    v_add_u32 v110, 256, v112
    v_and_b32 v110, 0x400, v110
    v_lshl_or_b32 v111, v110, 20, v111
    buffer_load_dword v110, v111, s[4:7], s44 offen
    buffer_load_dword v111, v111, s[4:7], s44 offen offset:16
    s_mov_b32 s61, 1
    s_add_u32 s44, s61, s18
    s_cmp_ge_u32 s44, 10
    s_cselect_b32 s53, 10, 0
    s_sub_u32 s44, s44, s53
    s_mul_i32 s44, s44, 4160
    s_add_u32 s44, s44, s40
    v_bfe_i32 v69, v112, 6, 1
    v_lshrrev_b32 v68, 6, v112
    v_bitop3_b32 v69, v69, 15, s10 bitop3:0x6a
    v_lshl_or_b32 v68, v68, 4, v69
    v_bfe_u32 v69, v112, 2, 4
    v_mul_u32_u24 v68, 41600, v68
    v_add_u32 v69, v68, v69
    v_add_u32 v68, 256, v112
    v_and_b32 v68, 0x400, v68
    v_lshl_or_b32 v69, v68, 20, v69
    buffer_load_dword v68, v69, s[4:7], s44 offen
    buffer_load_dword v69, v69, s[4:7], s44 offen offset:16
    s_mov_b32 s61, 0
    s_cmp_lt_u32 s10, 15
    s_cselect_b32 s44, s64, 0x40000000
    v_add_u32 v60, s44, v112
    s_mov_b32 s44, 492261376
    buffer_load_dwordx4 v[60:63], v60, s[4:7], s44 offen
    s_mul_i32 s20, s18, 645120
    s_add_u32 s20, s20, s62
    s_cmp_ge_u32 s10, 9
    s_cbranch_scc1 p2_nmp
    v_lshrrev_b32 v84, 1, v112
    s_add_u32 s44, s20, s42
    buffer_load_dwordx2 v[84:85], v84, s[4:7], s44 offen
p2_nmp:
    buffer_load_dwordx4 v[72:75], v112, s[4:7], s20 offen offset:0
    buffer_load_dwordx4 v[76:79], v112, s[4:7], s20 offen offset:1024
    buffer_load_dwordx4 v[80:83], v112, s[4:7], s20 offen offset:2048
    s_barrier
    v_mov_b32 v115, 0
    v_mov_b32 v116, 0
    v_mov_b32 v117, 0
    v_mov_b32 v118, 0
    v_mov_b32 v119, 0
    v_mov_b32 v120, 0
    v_mov_b32 v121, 0
    ds_write_b128 v115, v[116:119] offset:53760
    s_mov_b32 s19, 0
    s_cmp_eq_u32 s21, 2
    s_cselect_b64 s[66:67], -1, 0
    s_waitcnt lgkmcnt(0)
    s_barrier
    s_waitcnt vmcnt(6)
    s_mov_b32 m0, s23
    v_mov_b32 v53, 0
    s_movk_i32 s44, 512
    v_sub_u32_sdwa v4, v111, v110 dst_sel:DWORD dst_unused:UNUSED_PAD src0_sel:WORD_0 src1_sel:WORD_0
    v_sub_u32_sdwa v5, v111, v110 dst_sel:DWORD dst_unused:UNUSED_PAD src0_sel:WORD_1 src1_sel:WORD_1
    v_med3_i32 v4, v4, 0, s44
    v_med3_i32 v5, v5, 0, s44
    v_add_u32 v48, v4, v5
    ds_write_addtid_b32 v53 offset:0
    ds_write_addtid_b32 v53 offset:256
    ds_write_addtid_b32 v53 offset:512
    ds_write_addtid_b32 v53 offset:768
    ds_write_addtid_b32 v53 offset:1024
    ds_write_addtid_b32 v53 offset:1280
    ds_write_addtid_b32 v53 offset:1536
    ds_write_addtid_b32 v53 offset:1792
    v_bfe_i32 v53, v112, 6, 1
    v_lshrrev_b32 v49, 6, v112
    v_bitop3_b32 v53, v53, 15, s10 bitop3:0x6a
    v_lshl_or_b32 v49, v49, 4, v53
    v_and_b32 v53, 0x30, v112
    v_lshl_or_b32 v53, v49, 6, v53
    v_lshlrev_b32 v53, 15, v53
    s_nop 1
    v_add_u32_dpp v48, v48, v48 row_shr:1 row_mask:0xf bank_mask:0xf bound_ctrl:0
    s_nop 1
    v_add_u32_dpp v48, v48, v48 row_shr:2 row_mask:0xf bank_mask:0xf bound_ctrl:0
    s_nop 1
    v_add_u32_dpp v48, v48, v48 row_shr:4 row_mask:0xf bank_mask:0xf bound_ctrl:0
    s_nop 1
    v_add_u32_dpp v48, v48, v48 row_shr:8 row_mask:0xf bank_mask:0xf bound_ctrl:0
    s_nop 1
    v_add_u32_dpp v48, v48, v48 row_bcast:15 row_mask:0xa bank_mask:0xf
    s_nop 1
    v_add_u32_dpp v48, v48, v48 row_bcast:31 row_mask:0xc bank_mask:0xf
    s_nop 1
    s_nop 0
    v_readlane_b32 s38, v48, 63
    v_sub_u32 v50, v48, v5
    v_sub_u32 v49, v50, v4
    v_writelane_b32 v5, 1, 63
    v_sub_u32 v10, 512, v49
    v_mad_u32_u16 v51, v110, 16, v53
    v_lshl_add_u32 v51, v10, 4, v51
    v_med3_i32 v10, v10, 0, v4
    v_lshl_add_u32 v49, v49, 2, s23
    v_sub_u32 v11, 512, v50
    v_mad_u32_u16 v52, v110, 16, v53 op_sel:[1,0,0,0]
    v_add_u32 v52, 262144, v52
    s_mov_b32 s44, 0x1fffc000
    v_writelane_b32 v52, s44, 63
    v_lshl_add_u32 v52, v11, 4, v52
    v_med3_i32 v11, v11, 0, v5
    v_lshl_add_u32 v50, v50, 2, s23
    v_lshl_add_u32 v48, v11, 16, v10
    v_add_u32 v110, v110, v48
    s_min_u32 s17, s38, 512
    s_add_u32 s17, s17, 63
    s_lshr_b32 s17, s17, 6
    v_cmpx_lt_i32 vcc, 0, v10
    ds_write_b32 v49, v51
    s_mov_b64 exec, -1
    v_cmpx_lt_i32 vcc, 0, v11
    ds_write_b32 v50, v52
    s_mov_b64 exec, -1
    s_cmp_lt_u32 s38, 512
    s_cbranch_scc1 p2_nomorea
    v_cmp_lt_u32_sdwa s[44:45], v110, v111 src0_sel:WORD_0 src1_sel:WORD_0
    v_cmp_lt_u32_sdwa s[46:47], v110, v111 src0_sel:WORD_1 src1_sel:WORD_1
    s_nop 0
    s_or_b64 s[44:45], s[44:45], s[46:47]
    s_cbranch_scc0 p2_nomorea
    v_mov_b32 v49, s19
    v_mov_b32 v50, 1
    ds_write_b32 v49, v50 offset:53760
p2_nomorea:
    s_mov_b32 m0, s23
    s_nop 0
    ds_read_addtid_b32 v2 offset:1024
    ds_read_addtid_b32 v8 offset:1280
    ds_read_addtid_b32 v14 offset:1536
    ds_read_addtid_b32 v20 offset:1792
    ds_read_addtid_b32 v88 offset:0
    ds_read_addtid_b32 v92 offset:256
    ds_read_addtid_b32 v96 offset:512
    ds_read_addtid_b32 v100 offset:768
    s_waitcnt lgkmcnt(0)
    s_nop 2
    s_nop 1
    v_max_u32_dpp v88, v88, v88 row_shr:1 row_mask:0xf bank_mask:0xf bound_ctrl:0
    v_max_u32_dpp v92, v92, v92 row_shr:1 row_mask:0xf bank_mask:0xf bound_ctrl:0
    v_max_u32_dpp v96, v96, v96 row_shr:1 row_mask:0xf bank_mask:0xf bound_ctrl:0
    v_max_u32_dpp v100, v100, v100 row_shr:1 row_mask:0xf bank_mask:0xf bound_ctrl:0
    v_max_u32_dpp v2, v2, v2 row_shr:1 row_mask:0xf bank_mask:0xf bound_ctrl:0
    v_max_u32_dpp v8, v8, v8 row_shr:1 row_mask:0xf bank_mask:0xf bound_ctrl:0
    v_max_u32_dpp v14, v14, v14 row_shr:1 row_mask:0xf bank_mask:0xf bound_ctrl:0
    v_max_u32_dpp v20, v20, v20 row_shr:1 row_mask:0xf bank_mask:0xf bound_ctrl:0
    v_max_u32_dpp v88, v88, v88 row_shr:2 row_mask:0xf bank_mask:0xf bound_ctrl:0
    v_max_u32_dpp v92, v92, v92 row_shr:2 row_mask:0xf bank_mask:0xf bound_ctrl:0
    v_max_u32_dpp v96, v96, v96 row_shr:2 row_mask:0xf bank_mask:0xf bound_ctrl:0
    v_max_u32_dpp v100, v100, v100 row_shr:2 row_mask:0xf bank_mask:0xf bound_ctrl:0
    v_max_u32_dpp v2, v2, v2 row_shr:2 row_mask:0xf bank_mask:0xf bound_ctrl:0
    v_max_u32_dpp v8, v8, v8 row_shr:2 row_mask:0xf bank_mask:0xf bound_ctrl:0
    v_max_u32_dpp v14, v14, v14 row_shr:2 row_mask:0xf bank_mask:0xf bound_ctrl:0
    v_max_u32_dpp v20, v20, v20 row_shr:2 row_mask:0xf bank_mask:0xf bound_ctrl:0
    v_max_u32_dpp v88, v88, v88 row_shr:4 row_mask:0xf bank_mask:0xf bound_ctrl:0
    v_max_u32_dpp v92, v92, v92 row_shr:4 row_mask:0xf bank_mask:0xf bound_ctrl:0
    v_max_u32_dpp v96, v96, v96 row_shr:4 row_mask:0xf bank_mask:0xf bound_ctrl:0
    v_max_u32_dpp v100, v100, v100 row_shr:4 row_mask:0xf bank_mask:0xf bound_ctrl:0
    v_max_u32_dpp v2, v2, v2 row_shr:4 row_mask:0xf bank_mask:0xf bound_ctrl:0
    v_max_u32_dpp v8, v8, v8 row_shr:4 row_mask:0xf bank_mask:0xf bound_ctrl:0
    v_max_u32_dpp v14, v14, v14 row_shr:4 row_mask:0xf bank_mask:0xf bound_ctrl:0
    v_max_u32_dpp v20, v20, v20 row_shr:4 row_mask:0xf bank_mask:0xf bound_ctrl:0
    v_max_u32_dpp v88, v88, v88 row_shr:8 row_mask:0xf bank_mask:0xf bound_ctrl:0
    v_max_u32_dpp v92, v92, v92 row_shr:8 row_mask:0xf bank_mask:0xf bound_ctrl:0
    v_max_u32_dpp v96, v96, v96 row_shr:8 row_mask:0xf bank_mask:0xf bound_ctrl:0
    v_max_u32_dpp v100, v100, v100 row_shr:8 row_mask:0xf bank_mask:0xf bound_ctrl:0
    v_max_u32_dpp v2, v2, v2 row_shr:8 row_mask:0xf bank_mask:0xf bound_ctrl:0
    v_max_u32_dpp v8, v8, v8 row_shr:8 row_mask:0xf bank_mask:0xf bound_ctrl:0
    v_max_u32_dpp v14, v14, v14 row_shr:8 row_mask:0xf bank_mask:0xf bound_ctrl:0
    v_max_u32_dpp v20, v20, v20 row_shr:8 row_mask:0xf bank_mask:0xf bound_ctrl:0
    v_max_u32_dpp v88, v88, v88 row_bcast:15 row_mask:0xa bank_mask:0xf
    v_max_u32_dpp v92, v92, v92 row_bcast:15 row_mask:0xa bank_mask:0xf
    v_max_u32_dpp v96, v96, v96 row_bcast:15 row_mask:0xa bank_mask:0xf
    v_max_u32_dpp v100, v100, v100 row_bcast:15 row_mask:0xa bank_mask:0xf
    v_max_u32_dpp v2, v2, v2 row_bcast:15 row_mask:0xa bank_mask:0xf
    v_max_u32_dpp v8, v8, v8 row_bcast:15 row_mask:0xa bank_mask:0xf
    v_max_u32_dpp v14, v14, v14 row_bcast:15 row_mask:0xa bank_mask:0xf
    v_max_u32_dpp v20, v20, v20 row_bcast:15 row_mask:0xa bank_mask:0xf
    v_max_u32_dpp v88, v88, v88 row_bcast:31 row_mask:0xc bank_mask:0xf
    v_max_u32_dpp v92, v92, v92 row_bcast:31 row_mask:0xc bank_mask:0xf
    v_max_u32_dpp v96, v96, v96 row_bcast:31 row_mask:0xc bank_mask:0xf
    v_max_u32_dpp v100, v100, v100 row_bcast:31 row_mask:0xc bank_mask:0xf
    v_max_u32_dpp v2, v2, v2 row_bcast:31 row_mask:0xc bank_mask:0xf
    v_max_u32_dpp v8, v8, v8 row_bcast:31 row_mask:0xc bank_mask:0xf
    v_max_u32_dpp v14, v14, v14 row_bcast:31 row_mask:0xc bank_mask:0xf
    v_max_u32_dpp v20, v20, v20 row_bcast:31 row_mask:0xc bank_mask:0xf
    s_nop 0
    v_readlane_b32 s41, v88, 63
    v_add_u32 v88, v88, v112
    v_add_u32 v88, 4294959104, v88
    v_max_u32 v92, s41, v92
    s_nop 0
    v_readlane_b32 s41, v92, 63
    v_add_u32 v92, v92, v112
    v_add_u32 v92, 4294960128, v92
    v_max_u32 v96, s41, v96
    s_nop 0
    v_readlane_b32 s41, v96, 63
    v_add_u32 v96, v96, v112
    v_add_u32 v96, 4294961152, v96
    v_max_u32 v100, s41, v100
    s_nop 0
    v_readlane_b32 s41, v100, 63
    v_add_u32 v100, v100, v112
    v_add_u32 v100, 4294962176, v100
    v_max_u32 v2, s41, v2
    s_nop 0
    v_readlane_b32 s41, v2, 63
    v_add_u32 v2, v2, v112
    v_add_u32 v2, 4294963200, v2
    v_max_u32 v8, s41, v8
    s_nop 0
    v_readlane_b32 s41, v8, 63
    v_add_u32 v8, v8, v112
    v_add_u32 v8, 4294964224, v8
    v_max_u32 v14, s41, v14
    s_nop 0
    v_readlane_b32 s41, v14, 63
    v_add_u32 v14, v14, v112
    v_add_u32 v14, 4294965248, v14
    v_max_u32 v20, s41, v20
    s_nop 0
    v_readlane_b32 s41, v20, 63
    v_add_u32 v20, v20, v112
    v_add_u32 v20, 4294966272, v20
    v_bfe_u32 v0, v2, 14, 4
    v_lshrrev_b32 v1, 18, v2
    v_and_b32 v2, 0x3fff, v2
    v_mad_u32_u24 v0, v0, s63, v1
    v_mad_u32_u24 v2, v0, s65, v2
    buffer_load_dwordx4 v[0:3], v2, s[68:71], 0 offen
    v_bfe_u32 v6, v8, 14, 4
    v_lshrrev_b32 v7, 18, v8
    v_and_b32 v8, 0x3fff, v8
    v_mad_u32_u24 v6, v6, s63, v7
    v_mad_u32_u24 v8, v6, s65, v8
    buffer_load_dwordx4 v[6:9], v8, s[68:71], 0 offen
    s_cmp_eq_u32 s21, 0
    s_cselect_b32 s44, 1073758208, 0
    v_mov_b32 v124, s44
    v_mov_b32 v125, s44
    v_mov_b32 v126, s44
    v_mov_b32 v127, s44
    v_add_u32 v123, s64, v112
    v_add_u32 v122, s25, v123
    ds_write_b128 v122, v[124:127] offset:0
    ds_write_b128 v122, v[124:127] offset:16384
    ds_write_b128 v122, v[124:127] offset:32768
    v_add_u32 v122, 49152, v122
    ds_write_b128 v122, v[124:127] offset:0
    ds_write_b128 v122, v[124:127] offset:16384
    ds_write_b128 v122, v[124:127] offset:32768
    v_cmpx_gt_u32 vcc, 1792, v123
    ds_write_b128 v122, v[124:127] offset:49152
    s_mov_b64 exec, -1
    v_bfe_u32 v12, v14, 14, 4
    v_lshrrev_b32 v13, 18, v14
    v_and_b32 v14, 0x3fff, v14
    v_mad_u32_u24 v12, v12, s63, v13
    v_mad_u32_u24 v14, v12, s65, v14
    buffer_load_dwordx4 v[12:15], v14, s[68:71], 0 offen
    s_mov_b32 s16, s17
    s_waitcnt vmcnt(6)
    s_cmp_lg_u32 s21, 0
    s_cbranch_scc1 p2_nostat1
    v_max_u32 v60, v60, v62
    v_add_f32 v61, v61, v63
    s_nop 1
    v_max_u32_dpp v60, v60, v60 row_shr:1 row_mask:0xf bank_mask:0xf bound_ctrl:0
    v_add_f32_dpp v61, v61, v61 row_shr:1 row_mask:0xf bank_mask:0xf bound_ctrl:0
    s_nop 0
    v_max_u32_dpp v60, v60, v60 row_shr:2 row_mask:0xf bank_mask:0xf bound_ctrl:0
    v_add_f32_dpp v61, v61, v61 row_shr:2 row_mask:0xf bank_mask:0xf bound_ctrl:0
    s_nop 0
    v_max_u32_dpp v60, v60, v60 row_shr:4 row_mask:0xf bank_mask:0xf bound_ctrl:0
    v_add_f32_dpp v61, v61, v61 row_shr:4 row_mask:0xf bank_mask:0xf bound_ctrl:0
    s_nop 0
    v_max_u32_dpp v60, v60, v60 row_shr:8 row_mask:0xf bank_mask:0xf bound_ctrl:0
    v_add_f32_dpp v61, v61, v61 row_shr:8 row_mask:0xf bank_mask:0xf bound_ctrl:0
    s_nop 0
    v_max_u32_dpp v60, v60, v60 row_bcast:15 row_mask:0xa bank_mask:0xf
    v_add_f32_dpp v61, v61, v61 row_bcast:15 row_mask:0xa bank_mask:0xf
    s_nop 0
    v_max_u32_dpp v60, v60, v60 row_bcast:31 row_mask:0xc bank_mask:0xf
    v_add_f32_dpp v61, v61, v61 row_bcast:31 row_mask:0xc bank_mask:0xf
    s_nop 0
    s_nop 0
    s_lshl_b32 s44, s10, 3
    v_mov_b32 v62, s44
    s_mov_b64 exec, 1
    s_lshl_b64 exec, exec, 63
    ds_write_b64 v62, v[60:61] offset:53824
    s_mov_b64 exec, -1
p2_nostat1:
    s_waitcnt lgkmcnt(0)
    s_barrier
    v_bfe_u32 v18, v20, 14, 4
    v_lshrrev_b32 v19, 18, v20
    v_and_b32 v20, 0x3fff, v20
    v_mad_u32_u24 v18, v18, s63, v19
    v_mad_u32_u24 v20, v18, s65, v20
    buffer_load_dwordx4 v[18:21], v20, s[68:71], 0 offen
    v_mov_b32 v122, s19
    s_xor_b32 s19, s19, 4
    ds_read_b32 v125, v122 offset:53760
    s_cmp_lg_u32 s21, 0
    s_cbranch_scc1 p2_nostat2
    v_bfe_u32 v62, v112, 1, 7
    ds_read_b64 v[60:61], v62 offset:53824
    s_waitcnt lgkmcnt(0)
    s_nop 1
    v_max_u32_dpp v60, v60, v60 row_shr:1 row_mask:0xf bank_mask:0xf bound_ctrl:0
    v_add_f32_dpp v61, v61, v61 row_shr:1 row_mask:0xf bank_mask:0xf bound_ctrl:0
    s_nop 0
    v_max_u32_dpp v60, v60, v60 row_shr:2 row_mask:0xf bank_mask:0xf bound_ctrl:0
    v_add_f32_dpp v61, v61, v61 row_shr:2 row_mask:0xf bank_mask:0xf bound_ctrl:0
    s_nop 0
    v_max_u32_dpp v60, v60, v60 row_shr:4 row_mask:0xf bank_mask:0xf bound_ctrl:0
    v_add_f32_dpp v61, v61, v61 row_shr:4 row_mask:0xf bank_mask:0xf bound_ctrl:0
    s_nop 0
    v_max_u32_dpp v60, v60, v60 row_shr:8 row_mask:0xf bank_mask:0xf bound_ctrl:0
    v_add_f32_dpp v61, v61, v61 row_shr:8 row_mask:0xf bank_mask:0xf bound_ctrl:0
    s_nop 0
    v_max_u32_dpp v60, v60, v60 row_bcast:15 row_mask:0xa bank_mask:0xf
    v_add_f32_dpp v61, v61, v61 row_bcast:15 row_mask:0xa bank_mask:0xf
    s_nop 0
    v_max_u32_dpp v60, v60, v60 row_bcast:31 row_mask:0xc bank_mask:0xf
    v_add_f32_dpp v61, v61, v61 row_bcast:31 row_mask:0xc bank_mask:0xf
    s_nop 0
    s_nop 0
    v_readlane_b32 s44, v60, 15
    v_readlane_b32 s45, v61, 15
    s_nop 1
    s_lshl_b32 s44, s44, 16
    s_lshr_b32 s46, s44, 23
    s_sub_u32 s47, s46, 80
    s_cmp_lt_u32 s47, 100
    s_cselect_b32 s21, 0, 1
    v_mov_b32 v60, s45
    v_mul_f32 v60, 0x34a7c5ac, v60
    v_sqrt_f32 v60, v60
    v_mov_b32 v61, s44
    v_mul_f32 v62, 0x41800000, v60
    v_cmp_nle_f32 vcc, v61, v62
    v_mul_f32 v60, 0x3ac00000, v60
    v_mul_f32 v61, 0x3901742e, v61
    v_max_f32 v60, v60, v61
    s_cmp_lg_u64 vcc, 0
    s_cselect_b32 s21, 1, s21
    v_readfirstlane_b32 s44, v60
    s_nop 0
    s_and_b32 s47, s44, 0x7fffff
    s_or_b32 s47, s47, 0x3f000000
    s_and_b32 s48, s44, 0x7f800000
    s_add_u32 s48, s48, 0x800000
    v_rcp_f32 v60, s47
    s_nop 0
    v_rcp_f32 v61, v60
    v_mul_f32 v60, 0x7b800000, v60
    v_mul_f32 v61, s48, v61
    s_nop 0
    v_readfirstlane_b32 s26, v60
    v_readfirstlane_b32 s30, v61
    s_add_u32 s34, s48, 197132288
    s_mov_b32 s35, s34
    s_sub_u32 s36, 0, s34
    s_subb_u32 s37, 0, s34
    s_cmp_eq_u32 s21, 0
    s_cbranch_scc1 p2_nostat2
    s_waitcnt vmcnt(0) lgkmcnt(0)
    s_branch p2_restart
p2_nostat2:
    s_cmp_eq_u32 s21, 0
    s_cselect_b32 s26, s26, 0x7b800000
    v_mov_b32 v114, s26
    s_waitcnt lgkmcnt(0)
    v_readfirstlane_b32 s44, v125
    s_nop 0
    s_cmp_lg_u32 s44, 0
    s_cbranch_scc1 p2_adva
    s_mov_b32 s61, 1
    v_mov_b32 v110, v68
    v_mov_b32 v111, v69
p2_adva:
    v_bfe_u32 v86, v88, 14, 4
    v_lshrrev_b32 v87, 18, v88
    v_and_b32 v88, 0x3fff, v88
    v_mad_u32_u24 v86, v86, s63, v87
    v_mad_u32_u24 v88, v86, s65, v88
    buffer_load_dwordx4 v[86:89], v88, s[68:71], 0 offen
    s_mov_b32 m0, s23
    v_mov_b32 v53, 0
    s_movk_i32 s44, 512
    v_sub_u32_sdwa v4, v111, v110 dst_sel:DWORD dst_unused:UNUSED_PAD src0_sel:WORD_0 src1_sel:WORD_0
    v_sub_u32_sdwa v5, v111, v110 dst_sel:DWORD dst_unused:UNUSED_PAD src0_sel:WORD_1 src1_sel:WORD_1
    v_med3_i32 v4, v4, 0, s44
    v_med3_i32 v5, v5, 0, s44
    v_add_u32 v48, v4, v5
    ds_write_addtid_b32 v53 offset:0
    ds_write_addtid_b32 v53 offset:256
    ds_write_addtid_b32 v53 offset:512
    ds_write_addtid_b32 v53 offset:768
    ds_write_addtid_b32 v53 offset:1024
    ds_write_addtid_b32 v53 offset:1280
    ds_write_addtid_b32 v53 offset:1536
    ds_write_addtid_b32 v53 offset:1792
    v_bfe_i32 v53, v112, 6, 1
    v_lshrrev_b32 v49, 6, v112
    v_bitop3_b32 v53, v53, 15, s10 bitop3:0x6a
    v_lshl_or_b32 v49, v49, 4, v53
    v_and_b32 v53, 0x30, v112
    v_lshl_or_b32 v53, v49, 6, v53
    v_lshlrev_b32 v53, 15, v53
    s_nop 1
    v_add_u32_dpp v48, v48, v48 row_shr:1 row_mask:0xf bank_mask:0xf bound_ctrl:0
    s_nop 1
    v_add_u32_dpp v48, v48, v48 row_shr:2 row_mask:0xf bank_mask:0xf bound_ctrl:0
    s_nop 1
    v_add_u32_dpp v48, v48, v48 row_shr:4 row_mask:0xf bank_mask:0xf bound_ctrl:0
    s_nop 1
    v_add_u32_dpp v48, v48, v48 row_shr:8 row_mask:0xf bank_mask:0xf bound_ctrl:0
    s_nop 1
    v_add_u32_dpp v48, v48, v48 row_bcast:15 row_mask:0xa bank_mask:0xf
    s_nop 1
    v_add_u32_dpp v48, v48, v48 row_bcast:31 row_mask:0xc bank_mask:0xf
    s_nop 1
    s_nop 0
    v_readlane_b32 s38, v48, 63
    v_sub_u32 v50, v48, v5
    v_sub_u32 v49, v50, v4
    v_writelane_b32 v5, 1, 63
    v_sub_u32 v10, 512, v49
    v_mad_u32_u16 v51, v110, 16, v53
    v_lshl_add_u32 v51, v10, 4, v51
    v_med3_i32 v10, v10, 0, v4
    v_lshl_add_u32 v49, v49, 2, s23
    v_sub_u32 v11, 512, v50
    v_mad_u32_u16 v52, v110, 16, v53 op_sel:[1,0,0,0]
    v_add_u32 v52, 262144, v52
    s_mov_b32 s44, 0x1fffc000
    v_writelane_b32 v52, s44, 63
    v_lshl_add_u32 v52, v11, 4, v52
    v_med3_i32 v11, v11, 0, v5
    v_lshl_add_u32 v50, v50, 2, s23
    v_lshl_add_u32 v48, v11, 16, v10
    v_add_u32 v110, v110, v48
    s_min_u32 s17, s38, 512
    s_add_u32 s17, s17, 63
    s_lshr_b32 s17, s17, 6
    v_cmpx_lt_i32 vcc, 0, v10
    ds_write_b32 v49, v51
    s_mov_b64 exec, -1
    v_cmpx_lt_i32 vcc, 0, v11
    ds_write_b32 v50, v52
    s_mov_b64 exec, -1
    s_cmp_lt_u32 s38, 512
    s_cbranch_scc1 p2_nomoreb
    v_cmp_lt_u32_sdwa s[44:45], v110, v111 src0_sel:WORD_0 src1_sel:WORD_0
    v_cmp_lt_u32_sdwa s[46:47], v110, v111 src0_sel:WORD_1 src1_sel:WORD_1
    s_nop 0
    s_or_b64 s[44:45], s[44:45], s[46:47]
    s_cbranch_scc0 p2_nomoreb
    v_mov_b32 v49, s19
    v_mov_b32 v50, 1
    ds_write_b32 v49, v50 offset:53760
p2_nomoreb:
    s_mov_b32 m0, s23
    s_nop 0
    ds_read_addtid_b32 v102 offset:1024
    ds_read_addtid_b32 v103 offset:1280
    ds_read_addtid_b32 v104 offset:1536
    ds_read_addtid_b32 v105 offset:1792
    ds_read_addtid_b32 v106 offset:0
    ds_read_addtid_b32 v107 offset:256
    ds_read_addtid_b32 v108 offset:512
    ds_read_addtid_b32 v109 offset:768
    v_bfe_u32 v90, v92, 14, 4
    v_lshrrev_b32 v91, 18, v92
    v_and_b32 v92, 0x3fff, v92
    v_mad_u32_u24 v90, v90, s63, v91
    v_mad_u32_u24 v92, v90, s65, v92
    buffer_load_dwordx4 v[90:93], v92, s[68:71], 0 offen
    s_waitcnt vmcnt(6)
    s_mov_b32 m0, s24
    s_cmp_ge_u32 s10, 9
    s_cbranch_scc1 p2_stp
    ds_write_addtid_b32 v84 offset:49152
    ds_write_addtid_b32 v85 offset:49408
p2_stp:
    s_mov_b32 m0, s23
    s_add_u32 s20, s20, 53760
    ds_write_addtid_b32 v72 offset:0
    ds_write_addtid_b32 v73 offset:256
    ds_write_addtid_b32 v74 offset:512
    ds_write_addtid_b32 v75 offset:768
    ds_write_addtid_b32 v76 offset:1024
    ds_write_addtid_b32 v77 offset:1280
    ds_write_addtid_b32 v78 offset:1536
    ds_write_addtid_b32 v79 offset:1792
    ds_write_addtid_b32 v80 offset:2048
    ds_write_addtid_b32 v81 offset:2304
    ds_write_addtid_b32 v82 offset:2560
    ds_write_addtid_b32 v83 offset:2816
    s_waitcnt lgkmcnt(0)
    s_barrier
    v_bfe_u32 v94, v96, 14, 4
    v_lshrrev_b32 v95, 18, v96
    v_and_b32 v96, 0x3fff, v96
    v_mad_u32_u24 v94, v94, s63, v95
    v_mad_u32_u24 v96, v94, s65, v96
    buffer_load_dwordx4 v[94:97], v96, s[68:71], 0 offen
    v_bfe_u32 v98, v100, 14, 4
    v_lshrrev_b32 v99, 18, v100
    v_and_b32 v100, 0x3fff, v100
    v_mad_u32_u24 v98, v98, s63, v99
    v_mad_u32_u24 v100, v98, s65, v100
    buffer_load_dwordx4 v[98:101], v100, s[68:71], 0 offen
    s_nop 2
    s_nop 1
    v_max_u32_dpp v106, v106, v106 row_shr:1 row_mask:0xf bank_mask:0xf bound_ctrl:0
    v_max_u32_dpp v107, v107, v107 row_shr:1 row_mask:0xf bank_mask:0xf bound_ctrl:0
    v_max_u32_dpp v108, v108, v108 row_shr:1 row_mask:0xf bank_mask:0xf bound_ctrl:0
    v_max_u32_dpp v109, v109, v109 row_shr:1 row_mask:0xf bank_mask:0xf bound_ctrl:0
    v_max_u32_dpp v106, v106, v106 row_shr:2 row_mask:0xf bank_mask:0xf bound_ctrl:0
    v_max_u32_dpp v107, v107, v107 row_shr:2 row_mask:0xf bank_mask:0xf bound_ctrl:0
    v_max_u32_dpp v108, v108, v108 row_shr:2 row_mask:0xf bank_mask:0xf bound_ctrl:0
    v_max_u32_dpp v109, v109, v109 row_shr:2 row_mask:0xf bank_mask:0xf bound_ctrl:0
    v_max_u32_dpp v106, v106, v106 row_shr:4 row_mask:0xf bank_mask:0xf bound_ctrl:0
    v_max_u32_dpp v107, v107, v107 row_shr:4 row_mask:0xf bank_mask:0xf bound_ctrl:0
    v_max_u32_dpp v108, v108, v108 row_shr:4 row_mask:0xf bank_mask:0xf bound_ctrl:0
    v_max_u32_dpp v109, v109, v109 row_shr:4 row_mask:0xf bank_mask:0xf bound_ctrl:0
    v_max_u32_dpp v106, v106, v106 row_shr:8 row_mask:0xf bank_mask:0xf bound_ctrl:0
    v_max_u32_dpp v107, v107, v107 row_shr:8 row_mask:0xf bank_mask:0xf bound_ctrl:0
    v_max_u32_dpp v108, v108, v108 row_shr:8 row_mask:0xf bank_mask:0xf bound_ctrl:0
    v_max_u32_dpp v109, v109, v109 row_shr:8 row_mask:0xf bank_mask:0xf bound_ctrl:0
    v_max_u32_dpp v106, v106, v106 row_bcast:15 row_mask:0xa bank_mask:0xf
    v_max_u32_dpp v107, v107, v107 row_bcast:15 row_mask:0xa bank_mask:0xf
    v_max_u32_dpp v108, v108, v108 row_bcast:15 row_mask:0xa bank_mask:0xf
    v_max_u32_dpp v109, v109, v109 row_bcast:15 row_mask:0xa bank_mask:0xf
    v_max_u32_dpp v106, v106, v106 row_bcast:31 row_mask:0xc bank_mask:0xf
    v_max_u32_dpp v107, v107, v107 row_bcast:31 row_mask:0xc bank_mask:0xf
    v_max_u32_dpp v108, v108, v108 row_bcast:31 row_mask:0xc bank_mask:0xf
    v_max_u32_dpp v109, v109, v109 row_bcast:31 row_mask:0xc bank_mask:0xf
    s_nop 0
    v_readlane_b32 s41, v106, 63
    v_add_u32 v106, v106, v112
    v_add_u32 v106, 4294959104, v106
    v_max_u32 v107, s41, v107
    s_nop 0
    v_readlane_b32 s41, v107, 63
    v_add_u32 v107, v107, v112
    v_add_u32 v107, 4294960128, v107
    v_max_u32 v108, s41, v108
    s_nop 0
    v_readlane_b32 s41, v108, 63
    v_add_u32 v108, v108, v112
    v_add_u32 v108, 4294961152, v108
    v_max_u32 v109, s41, v109
    s_nop 0
    v_readlane_b32 s41, v109, 63
    v_add_u32 v109, v109, v112
    v_add_u32 v109, 4294962176, v109
    s_waitcnt vmcnt(7)
    v_perm_b32 v48, v3, v0, s31
    v_perm_b32 v49, v3, v1, s32
    v_perm_b32 v50, v3, v2, s33
    v_lshlrev_b16 v4, 3, v2
    v_lshlrev_b16 v2, 3, v1
    v_lshlrev_b16 v0, 3, v0
    v_cmpx_ge_u16 vcc, 0x3fff, v48
    ds_read_b64 v[0:1], v0
    s_mov_b64 exec, -1
    v_cmpx_ge_u16 vcc, 0x3fff, v49
    ds_read_b64 v[2:3], v2
    s_mov_b64 exec, -1
    v_cmpx_ge_u16 vcc, 0x3fff, v50
    ds_read_b64 v[4:5], v4
    s_mov_b64 exec, -1
    s_waitcnt vmcnt(6)
    v_perm_b32 v51, v9, v6, s31
    v_perm_b32 v52, v9, v7, s32
    v_perm_b32 v53, v9, v8, s33
    v_lshlrev_b16 v10, 3, v8
    v_lshlrev_b16 v8, 3, v7
    v_lshlrev_b16 v6, 3, v6
    v_cmpx_ge_u16 vcc, 0x3fff, v51
    ds_read_b64 v[6:7], v6
    s_mov_b64 exec, -1
    v_cmpx_ge_u16 vcc, 0x3fff, v52
    ds_read_b64 v[8:9], v8
    s_mov_b64 exec, -1
    v_cmpx_ge_u16 vcc, 0x3fff, v53
    ds_read_b64 v[10:11], v10
    s_mov_b64 exec, -1
    s_waitcnt vmcnt(5)
    v_perm_b32 v54, v15, v12, s31
    v_perm_b32 v55, v15, v13, s32
    v_perm_b32 v56, v15, v14, s33
    v_lshlrev_b16 v16, 3, v14
    v_lshlrev_b16 v14, 3, v13
    v_lshlrev_b16 v12, 3, v12
    v_cmpx_ge_u16 vcc, 0x3fff, v54
    ds_read_b64 v[12:13], v12
    s_mov_b64 exec, -1
    v_cmpx_ge_u16 vcc, 0x3fff, v55
    ds_read_b64 v[14:15], v14
    s_mov_b64 exec, -1
    v_cmpx_ge_u16 vcc, 0x3fff, v56
    ds_read_b64 v[16:17], v16
    s_mov_b64 exec, -1
    s_waitcnt vmcnt(4)
    v_perm_b32 v57, v21, v18, s31
    v_perm_b32 v58, v21, v19, s32
    v_perm_b32 v59, v21, v20, s33
    v_lshlrev_b16 v22, 3, v20
    v_lshlrev_b16 v20, 3, v19
    v_lshlrev_b16 v18, 3, v18
    s_cmp_lt_u32 s16, 8
    s_cbranch_scc1 p2_gp
    v_cmpx_ge_u16 vcc, 0x3fff, v57
    ds_read_b64 v[18:19], v18
    s_mov_b64 exec, -1
    v_cmpx_ge_u16 vcc, 0x3fff, v58
    ds_read_b64 v[20:21], v20
    s_mov_b64 exec, -1
    v_cmpx_ge_u16 vcc, 0x3fff, v59
    ds_read_b64 v[22:23], v22
    s_mov_b64 exec, -1
p2_gp:
    s_waitcnt vmcnt(3)
    v_perm_b32 v60, v89, v86, s31
    v_perm_b32 v61, v89, v87, s32
    v_perm_b32 v62, v89, v88, s33
    v_lshlrev_b16 v28, 3, v88
    v_lshlrev_b16 v26, 3, v87
    v_lshlrev_b16 v24, 3, v86
    v_cmpx_ge_u16 vcc, 0x3fff, v60
    ds_read_b64 v[24:25], v24
    s_mov_b64 exec, -1
    v_cmpx_ge_u16 vcc, 0x3fff, v61
    ds_read_b64 v[26:27], v26
    s_mov_b64 exec, -1
    v_cmpx_ge_u16 vcc, 0x3fff, v62
    ds_read_b64 v[28:29], v28
    s_mov_b64 exec, -1
    v_bfe_u32 v86, v106, 14, 4
    v_lshrrev_b32 v87, 18, v106
    v_and_b32 v106, 0x3fff, v106
    v_mad_u32_u24 v86, v86, s63, v87
    v_mad_u32_u24 v106, v86, s65, v106
    buffer_load_dwordx4 v[86:89], v106, s[68:71], 0 offen
    s_cmp_ge_u32 s10, 9
    s_cbranch_scc1 p2_nmq
    v_lshrrev_b32 v84, 1, v112
    s_add_u32 s44, s20, s42
    buffer_load_dwordx2 v[84:85], v84, s[4:7], s44 offen
p2_nmq:
    buffer_load_dwordx4 v[72:75], v112, s[4:7], s20 offen offset:0
    buffer_load_dwordx4 v[76:79], v112, s[4:7], s20 offen offset:1024
    buffer_load_dwordx4 v[80:83], v112, s[4:7], s20 offen offset:2048
    s_waitcnt vmcnt(6)
    v_perm_b32 v63, v93, v90, s31
    v_perm_b32 v64, v93, v91, s32
    v_perm_b32 v65, v93, v92, s33
    v_lshlrev_b16 v34, 3, v92
    v_lshlrev_b16 v32, 3, v91
    v_lshlrev_b16 v30, 3, v90
    v_cmpx_ge_u16 vcc, 0x3fff, v63
    ds_read_b64 v[30:31], v30
    s_mov_b64 exec, -1
    v_cmpx_ge_u16 vcc, 0x3fff, v64
    ds_read_b64 v[32:33], v32
    s_mov_b64 exec, -1
    v_cmpx_ge_u16 vcc, 0x3fff, v65
    ds_read_b64 v[34:35], v34
    s_mov_b64 exec, -1
    v_bfe_u32 v90, v107, 14, 4
    v_lshrrev_b32 v91, 18, v107
    v_and_b32 v107, 0x3fff, v107
    v_mad_u32_u24 v90, v90, s63, v91
    v_mad_u32_u24 v107, v90, s65, v107
    buffer_load_dwordx4 v[90:93], v107, s[68:71], 0 offen
    s_waitcnt vmcnt(6)
    v_perm_b32 v66, v97, v94, s31
    v_perm_b32 v67, v97, v95, s32
    v_perm_b32 v68, v97, v96, s33
    v_lshlrev_b16 v40, 3, v96
    v_lshlrev_b16 v38, 3, v95
    v_lshlrev_b16 v36, 3, v94
    v_cmpx_ge_u16 vcc, 0x3fff, v66
    ds_read_b64 v[36:37], v36
    s_mov_b64 exec, -1
    v_cmpx_ge_u16 vcc, 0x3fff, v67
    ds_read_b64 v[38:39], v38
    s_mov_b64 exec, -1
    v_cmpx_ge_u16 vcc, 0x3fff, v68
    ds_read_b64 v[40:41], v40
    s_mov_b64 exec, -1
    v_bfe_u32 v94, v108, 14, 4
    v_lshrrev_b32 v95, 18, v108
    v_and_b32 v108, 0x3fff, v108
    v_mad_u32_u24 v94, v94, s63, v95
    v_mad_u32_u24 v108, v94, s65, v108
    buffer_load_dwordx4 v[94:97], v108, s[68:71], 0 offen
    s_waitcnt vmcnt(6)
    v_perm_b32 v69, v101, v98, s31
    v_perm_b32 v70, v101, v99, s32
    v_perm_b32 v71, v101, v100, s33
    v_lshlrev_b16 v46, 3, v100
    v_lshlrev_b16 v44, 3, v99
    v_lshlrev_b16 v42, 3, v98
    v_cmpx_ge_u16 vcc, 0x3fff, v69
    ds_read_b64 v[42:43], v42
    s_mov_b64 exec, -1
    v_cmpx_ge_u16 vcc, 0x3fff, v70
    ds_read_b64 v[44:45], v44
    s_mov_b64 exec, -1
    v_cmpx_ge_u16 vcc, 0x3fff, v71
    ds_read_b64 v[46:47], v46
    s_mov_b64 exec, -1
    s_waitcnt lgkmcnt(0)
    s_barrier
    s_branch p2_tail
p2_top:
    s_cmp_lg_u32 s21, 0
    s_cbranch_scc1 p2_topf
    s_cmp_eq_u32 s60, 10
    s_cbranch_scc1 p2_drain0
    s_setprio 3
    v_cmpx_gt_i16 vcc, 0, v48
    ds_read_b64 v[0:1], v0
    s_mov_b64 exec, -1
    v_cmpx_gt_i16 vcc, 0, v49
    ds_read_b64 v[2:3], v2
    s_mov_b64 exec, -1
    v_cmpx_gt_i16 vcc, 0, v50
    ds_read_b64 v[4:5], v4
    s_mov_b64 exec, -1
    v_cmpx_gt_i16 vcc, 0, v51
    ds_read_b64 v[6:7], v6
    s_mov_b64 exec, -1
    v_cmpx_gt_i16 vcc, 0, v52
    ds_read_b64 v[8:9], v8
    s_mov_b64 exec, -1
    v_cmpx_gt_i16 vcc, 0, v53
    ds_read_b64 v[10:11], v10
    s_mov_b64 exec, -1
    v_cmpx_gt_i16 vcc, 0, v54
    ds_read_b64 v[12:13], v12
    s_mov_b64 exec, -1
    v_cmpx_gt_i16 vcc, 0, v55
    ds_read_b64 v[14:15], v14
    s_mov_b64 exec, -1
    v_cmpx_gt_i16 vcc, 0, v56
    ds_read_b64 v[16:17], v16
    s_mov_b64 exec, -1
    s_cmp_lt_u32 s15, 8
    s_cbranch_scc1 p2_g0r23
    v_cmpx_gt_i16 vcc, 0, v57
    ds_read_b64 v[18:19], v18
    s_mov_b64 exec, -1
    v_cmpx_gt_i16 vcc, 0, v58
    ds_read_b64 v[20:21], v20
    s_mov_b64 exec, -1
    v_cmpx_gt_i16 vcc, 0, v59
    ds_read_b64 v[22:23], v22
    s_mov_b64 exec, -1
p2_g0r23:
    s_cmp_ge_u32 s10, 9
    s_cbranch_scc1 p2_nm0m0a
    v_lshrrev_b32 v84, 1, v112
    s_add_u32 s44, s20, s42
    buffer_load_dwordx2 v[84:85], v84, s[4:7], s44 offen
p2_nm0m0a:
    buffer_load_dwordx4 v[72:75], v112, s[4:7], s20 offen offset:0
    buffer_load_dwordx4 v[76:79], v112, s[4:7], s20 offen offset:1024
    buffer_load_dwordx4 v[80:83], v112, s[4:7], s20 offen offset:2048
    v_cmpx_gt_i16 vcc, 0, v60
    ds_read_b64 v[24:25], v24
    s_mov_b64 exec, -1
    v_cmpx_gt_i16 vcc, 0, v61
    ds_read_b64 v[26:27], v26
    s_mov_b64 exec, -1
    v_cmpx_gt_i16 vcc, 0, v62
    ds_read_b64 v[28:29], v28
    s_mov_b64 exec, -1
    v_cmpx_gt_i16 vcc, 0, v63
    ds_read_b64 v[30:31], v30
    s_mov_b64 exec, -1
    v_cmpx_gt_i16 vcc, 0, v64
    ds_read_b64 v[32:33], v32
    s_mov_b64 exec, -1
    v_cmpx_gt_i16 vcc, 0, v65
    ds_read_b64 v[34:35], v34
    s_mov_b64 exec, -1
    v_cmpx_gt_i16 vcc, 0, v66
    ds_read_b64 v[36:37], v36
    s_mov_b64 exec, -1
    v_cmpx_gt_i16 vcc, 0, v67
    ds_read_b64 v[38:39], v38
    s_mov_b64 exec, -1
    v_cmpx_gt_i16 vcc, 0, v68
    ds_read_b64 v[40:41], v40
    s_mov_b64 exec, -1
    v_cmpx_gt_i16 vcc, 0, v69
    ds_read_b64 v[42:43], v42
    s_mov_b64 exec, -1
    v_cmpx_gt_i16 vcc, 0, v70
    ds_read_b64 v[44:45], v44
    s_mov_b64 exec, -1
    v_cmpx_gt_i16 vcc, 0, v71
    ds_read_b64 v[46:47], v46
    s_mov_b64 exec, -1
    s_setprio 2
    s_waitcnt lgkmcnt(15)
    v_ashrrev_i32 v122, 5, v48
    v_lshlrev_b16 v123, 2, v48
    v_lshlrev_b32 v124, 16, v0
    v_bitop3_b32 v122, v122, v113, v113 bitop3:0x0c
    v_and_b32 v125, 0xffff0000, v0
    v_lshlrev_b32 v126, 16, v1
    v_mul_f32 v122, v114, v122
    v_and_b32 v127, 0xffff0000, v1
    v_add_u32 v123, v123, v123
    v_pk_fma_f32 v[124:125], v[124:125], v[122:123], s[34:35] op_sel_hi:[1,0,1]
    v_pk_fma_f32 v[126:127], v[126:127], v[122:123], s[34:35] op_sel_hi:[1,0,1]
    v_lshl_add_u32 v124, v125, 16, v124
    v_lshl_add_u32 v125, v127, 16, v126
    s_waitcnt lgkmcnt(15)
    v_bitop3_b32 v115, v115, v116, v117 bitop3:0xfe
    v_lshl_add_u64 v[124:125], v[124:125], 0, s[36:37]
    v_cmpx_le_u32 vcc, 0x1000000, v48
    ds_add_rtn_u64 v[116:117], v123, v[124:125] offset:54272
    s_mov_b64 exec, -1
    v_ashrrev_i32 v122, 5, v49
    v_lshlrev_b16 v123, 2, v49
    v_lshlrev_b32 v124, 16, v2
    v_bitop3_b32 v122, v122, v113, v113 bitop3:0x0c
    v_and_b32 v125, 0xffff0000, v2
    v_lshlrev_b32 v126, 16, v3
    v_mul_f32 v122, v114, v122
    v_and_b32 v127, 0xffff0000, v3
    v_add_u32 v123, v123, v123
    v_pk_fma_f32 v[124:125], v[124:125], v[122:123], s[34:35] op_sel_hi:[1,0,1]
    v_pk_fma_f32 v[126:127], v[126:127], v[122:123], s[34:35] op_sel_hi:[1,0,1]
    v_lshl_add_u32 v124, v125, 16, v124
    v_lshl_add_u32 v125, v127, 16, v126
    s_waitcnt lgkmcnt(15)
    v_bitop3_b32 v115, v115, v118, v119 bitop3:0xfe
    v_lshl_add_u64 v[124:125], v[124:125], 0, s[36:37]
    v_cmpx_le_u32 vcc, 0x1000000, v49
    ds_add_rtn_u64 v[118:119], v123, v[124:125] offset:54272
    s_mov_b64 exec, -1
    v_ashrrev_i32 v122, 5, v50
    v_lshlrev_b16 v123, 2, v50
    v_lshlrev_b32 v124, 16, v4
    v_bitop3_b32 v122, v122, v113, v113 bitop3:0x0c
    v_and_b32 v125, 0xffff0000, v4
    v_lshlrev_b32 v126, 16, v5
    v_mul_f32 v122, v114, v122
    v_and_b32 v127, 0xffff0000, v5
    v_add_u32 v123, v123, v123
    v_pk_fma_f32 v[124:125], v[124:125], v[122:123], s[34:35] op_sel_hi:[1,0,1]
    v_pk_fma_f32 v[126:127], v[126:127], v[122:123], s[34:35] op_sel_hi:[1,0,1]
    v_lshl_add_u32 v124, v125, 16, v124
    v_lshl_add_u32 v125, v127, 16, v126
    s_waitcnt lgkmcnt(15)
    v_bitop3_b32 v115, v115, v120, v121 bitop3:0xfe
    v_lshl_add_u64 v[124:125], v[124:125], 0, s[36:37]
    v_cmpx_le_u32 vcc, 0x1000000, v50
    ds_add_rtn_u64 v[120:121], v123, v[124:125] offset:54272
    s_mov_b64 exec, -1
    v_bfe_u32 v0, v102, 14, 4
    v_lshrrev_b32 v1, 18, v102
    v_and_b32 v102, 0x3fff, v102
    v_mad_u32_u24 v0, v0, s63, v1
    v_mad_u32_u24 v102, v0, s65, v102
    buffer_load_dwordx4 v[0:3], v102, s[68:71], 0 offen
    s_setprio 1
    s_waitcnt lgkmcnt(15)
    v_ashrrev_i32 v122, 5, v51
    v_lshlrev_b16 v123, 2, v51
    v_lshlrev_b32 v124, 16, v6
    v_bitop3_b32 v122, v122, v113, v113 bitop3:0x0c
    v_and_b32 v125, 0xffff0000, v6
    v_lshlrev_b32 v126, 16, v7
    v_mul_f32 v122, v114, v122
    v_and_b32 v127, 0xffff0000, v7
    v_add_u32 v123, v123, v123
    v_pk_fma_f32 v[124:125], v[124:125], v[122:123], s[34:35] op_sel_hi:[1,0,1]
    v_pk_fma_f32 v[126:127], v[126:127], v[122:123], s[34:35] op_sel_hi:[1,0,1]
    v_lshl_add_u32 v124, v125, 16, v124
    v_lshl_add_u32 v125, v127, 16, v126
    s_waitcnt lgkmcnt(2)
    v_bitop3_b32 v115, v115, v116, v117 bitop3:0xfe
    v_lshl_add_u64 v[124:125], v[124:125], 0, s[36:37]
    v_cmpx_le_u32 vcc, 0x1000000, v51
    ds_add_rtn_u64 v[116:117], v123, v[124:125] offset:54272
    s_mov_b64 exec, -1
    v_ashrrev_i32 v122, 5, v52
    v_lshlrev_b16 v123, 2, v52
    v_lshlrev_b32 v124, 16, v8
    v_bitop3_b32 v122, v122, v113, v113 bitop3:0x0c
    v_and_b32 v125, 0xffff0000, v8
    v_lshlrev_b32 v126, 16, v9
    v_mul_f32 v122, v114, v122
    v_and_b32 v127, 0xffff0000, v9
    v_add_u32 v123, v123, v123
    v_pk_fma_f32 v[124:125], v[124:125], v[122:123], s[34:35] op_sel_hi:[1,0,1]
    v_pk_fma_f32 v[126:127], v[126:127], v[122:123], s[34:35] op_sel_hi:[1,0,1]
    v_lshl_add_u32 v124, v125, 16, v124
    v_lshl_add_u32 v125, v127, 16, v126
    s_waitcnt lgkmcnt(2)
    v_bitop3_b32 v115, v115, v118, v119 bitop3:0xfe
    v_lshl_add_u64 v[124:125], v[124:125], 0, s[36:37]
    v_cmpx_le_u32 vcc, 0x1000000, v52
    ds_add_rtn_u64 v[118:119], v123, v[124:125] offset:54272
    s_mov_b64 exec, -1
    v_ashrrev_i32 v122, 5, v53
    v_lshlrev_b16 v123, 2, v53
    v_lshlrev_b32 v124, 16, v10
    v_bitop3_b32 v122, v122, v113, v113 bitop3:0x0c
    v_and_b32 v125, 0xffff0000, v10
    v_lshlrev_b32 v126, 16, v11
    v_mul_f32 v122, v114, v122
    v_and_b32 v127, 0xffff0000, v11
    v_add_u32 v123, v123, v123
    v_pk_fma_f32 v[124:125], v[124:125], v[122:123], s[34:35] op_sel_hi:[1,0,1]
    v_pk_fma_f32 v[126:127], v[126:127], v[122:123], s[34:35] op_sel_hi:[1,0,1]
    v_lshl_add_u32 v124, v125, 16, v124
    v_lshl_add_u32 v125, v127, 16, v126
    s_waitcnt lgkmcnt(2)
    v_bitop3_b32 v115, v115, v120, v121 bitop3:0xfe
    v_lshl_add_u64 v[124:125], v[124:125], 0, s[36:37]
    v_cmpx_le_u32 vcc, 0x1000000, v53
    ds_add_rtn_u64 v[120:121], v123, v[124:125] offset:54272
    s_mov_b64 exec, -1
    v_bfe_u32 v6, v103, 14, 4
    v_lshrrev_b32 v7, 18, v103
    v_and_b32 v103, 0x3fff, v103
    v_mad_u32_u24 v6, v6, s63, v7
    v_mad_u32_u24 v103, v6, s65, v103
    buffer_load_dwordx4 v[6:9], v103, s[68:71], 0 offen
    s_waitcnt lgkmcnt(6)
    s_barrier
    s_setprio 3
    s_waitcnt vmcnt(5)
    s_mov_b32 m0, s23
    v_mov_b32 v53, 0
    s_movk_i32 s44, 512
    v_sub_u32_sdwa v4, v111, v110 dst_sel:DWORD dst_unused:UNUSED_PAD src0_sel:WORD_0 src1_sel:WORD_0
    v_sub_u32_sdwa v5, v111, v110 dst_sel:DWORD dst_unused:UNUSED_PAD src0_sel:WORD_1 src1_sel:WORD_1
    v_med3_i32 v4, v4, 0, s44
    v_med3_i32 v5, v5, 0, s44
    v_add_u32 v48, v4, v5
    ds_write_addtid_b32 v53 offset:0
    ds_write_addtid_b32 v53 offset:256
    ds_write_addtid_b32 v53 offset:512
    ds_write_addtid_b32 v53 offset:768
    ds_write_addtid_b32 v53 offset:1024
    ds_write_addtid_b32 v53 offset:1280
    ds_write_addtid_b32 v53 offset:1536
    ds_write_addtid_b32 v53 offset:1792
    v_bfe_i32 v53, v112, 6, 1
    v_lshrrev_b32 v49, 6, v112
    v_bitop3_b32 v53, v53, 15, s10 bitop3:0x6a
    v_lshl_or_b32 v49, v49, 4, v53
    v_and_b32 v53, 0x30, v112
    v_lshl_or_b32 v53, v49, 6, v53
    v_lshlrev_b32 v53, 15, v53
    s_nop 1
    v_add_u32_dpp v48, v48, v48 row_shr:1 row_mask:0xf bank_mask:0xf bound_ctrl:0
    s_nop 1
    v_add_u32_dpp v48, v48, v48 row_shr:2 row_mask:0xf bank_mask:0xf bound_ctrl:0
    s_nop 1
    v_add_u32_dpp v48, v48, v48 row_shr:4 row_mask:0xf bank_mask:0xf bound_ctrl:0
    s_nop 1
    v_add_u32_dpp v48, v48, v48 row_shr:8 row_mask:0xf bank_mask:0xf bound_ctrl:0
    s_nop 1
    v_add_u32_dpp v48, v48, v48 row_bcast:15 row_mask:0xa bank_mask:0xf
    s_nop 1
    v_add_u32_dpp v48, v48, v48 row_bcast:31 row_mask:0xc bank_mask:0xf
    s_nop 1
    s_nop 0
    v_readlane_b32 s38, v48, 63
    v_sub_u32 v50, v48, v5
    v_sub_u32 v49, v50, v4
    v_writelane_b32 v5, 1, 63
    v_sub_u32 v10, 512, v49
    v_mad_u32_u16 v51, v110, 16, v53
    v_lshl_add_u32 v51, v10, 4, v51
    v_med3_i32 v10, v10, 0, v4
    v_lshl_add_u32 v49, v49, 2, s23
    v_sub_u32 v11, 512, v50
    v_mad_u32_u16 v52, v110, 16, v53 op_sel:[1,0,0,0]
    v_add_u32 v52, 262144, v52
    s_mov_b32 s44, 0x1fffc000
    v_writelane_b32 v52, s44, 63
    v_lshl_add_u32 v52, v11, 4, v52
    v_med3_i32 v11, v11, 0, v5
    v_lshl_add_u32 v50, v50, 2, s23
    v_lshl_add_u32 v48, v11, 16, v10
    v_add_u32 v110, v110, v48
    s_min_u32 s17, s38, 512
    s_add_u32 s17, s17, 63
    s_lshr_b32 s17, s17, 6
    v_cmpx_lt_i32 vcc, 0, v10
    ds_write_b32 v49, v51
    s_mov_b64 exec, -1
    v_cmpx_lt_i32 vcc, 0, v11
    ds_write_b32 v50, v52
    s_mov_b64 exec, -1
    s_cmp_lt_u32 s38, 512
    s_cbranch_scc1 p2_nomore0x
    v_cmp_lt_u32_sdwa s[44:45], v110, v111 src0_sel:WORD_0 src1_sel:WORD_0
    v_cmp_lt_u32_sdwa s[46:47], v110, v111 src0_sel:WORD_1 src1_sel:WORD_1
    s_nop 0
    s_or_b64 s[44:45], s[44:45], s[46:47]
    s_cbranch_scc0 p2_nomore0x
    v_mov_b32 v49, s19
    v_mov_b32 v50, 1
    ds_write_b32 v49, v50 offset:53760
p2_nomore0x:
    s_setprio 2
    s_waitcnt lgkmcnt(15)
    v_ashrrev_i32 v122, 5, v54
    v_lshlrev_b16 v123, 2, v54
    v_lshlrev_b32 v124, 16, v12
    v_bitop3_b32 v122, v122, v113, v113 bitop3:0x0c
    v_and_b32 v125, 0xffff0000, v12
    v_lshlrev_b32 v126, 16, v13
    v_mul_f32 v122, v114, v122
    v_and_b32 v127, 0xffff0000, v13
    v_add_u32 v123, v123, v123
    v_pk_fma_f32 v[124:125], v[124:125], v[122:123], s[34:35] op_sel_hi:[1,0,1]
    v_pk_fma_f32 v[126:127], v[126:127], v[122:123], s[34:35] op_sel_hi:[1,0,1]
    v_lshl_add_u32 v124, v125, 16, v124
    v_lshl_add_u32 v125, v127, 16, v126
    s_waitcnt lgkmcnt(12)
    v_bitop3_b32 v115, v115, v116, v117 bitop3:0xfe
    v_lshl_add_u64 v[124:125], v[124:125], 0, s[36:37]
    v_cmpx_le_u32 vcc, 0x1000000, v54
    ds_add_rtn_u64 v[116:117], v123, v[124:125] offset:54272
    s_mov_b64 exec, -1
    v_ashrrev_i32 v122, 5, v55
    v_lshlrev_b16 v123, 2, v55
    v_lshlrev_b32 v124, 16, v14
    v_bitop3_b32 v122, v122, v113, v113 bitop3:0x0c
    v_and_b32 v125, 0xffff0000, v14
    v_lshlrev_b32 v126, 16, v15
    v_mul_f32 v122, v114, v122
    v_and_b32 v127, 0xffff0000, v15
    v_add_u32 v123, v123, v123
    v_pk_fma_f32 v[124:125], v[124:125], v[122:123], s[34:35] op_sel_hi:[1,0,1]
    v_pk_fma_f32 v[126:127], v[126:127], v[122:123], s[34:35] op_sel_hi:[1,0,1]
    v_lshl_add_u32 v124, v125, 16, v124
    v_lshl_add_u32 v125, v127, 16, v126
    s_waitcnt lgkmcnt(12)
    v_bitop3_b32 v115, v115, v118, v119 bitop3:0xfe
    v_lshl_add_u64 v[124:125], v[124:125], 0, s[36:37]
    v_cmpx_le_u32 vcc, 0x1000000, v55
    ds_add_rtn_u64 v[118:119], v123, v[124:125] offset:54272
    s_mov_b64 exec, -1
    v_ashrrev_i32 v122, 5, v56
    v_lshlrev_b16 v123, 2, v56
    v_lshlrev_b32 v124, 16, v16
    v_bitop3_b32 v122, v122, v113, v113 bitop3:0x0c
    v_and_b32 v125, 0xffff0000, v16
    v_lshlrev_b32 v126, 16, v17
    v_mul_f32 v122, v114, v122
    v_and_b32 v127, 0xffff0000, v17
    v_add_u32 v123, v123, v123
    v_pk_fma_f32 v[124:125], v[124:125], v[122:123], s[34:35] op_sel_hi:[1,0,1]
    v_pk_fma_f32 v[126:127], v[126:127], v[122:123], s[34:35] op_sel_hi:[1,0,1]
    v_lshl_add_u32 v124, v125, 16, v124
    v_lshl_add_u32 v125, v127, 16, v126
    s_waitcnt lgkmcnt(12)
    v_bitop3_b32 v115, v115, v120, v121 bitop3:0xfe
    v_lshl_add_u64 v[124:125], v[124:125], 0, s[36:37]
    v_cmpx_le_u32 vcc, 0x1000000, v56
    ds_add_rtn_u64 v[120:121], v123, v[124:125] offset:54272
    s_mov_b64 exec, -1
    v_bfe_u32 v12, v104, 14, 4
    v_lshrrev_b32 v13, 18, v104
    v_and_b32 v104, 0x3fff, v104
    v_mad_u32_u24 v12, v12, s63, v13
    v_mad_u32_u24 v104, v12, s65, v104
    buffer_load_dwordx4 v[12:15], v104, s[68:71], 0 offen
    s_cmp_lt_u32 s15, 8
    s_cbranch_scc1 p2_na0a3
    s_waitcnt lgkmcnt(15)
    v_ashrrev_i32 v122, 5, v57
    v_lshlrev_b16 v123, 2, v57
    v_lshlrev_b32 v124, 16, v18
    v_bitop3_b32 v122, v122, v113, v113 bitop3:0x0c
    v_and_b32 v125, 0xffff0000, v18
    v_lshlrev_b32 v126, 16, v19
    v_mul_f32 v122, v114, v122
    v_and_b32 v127, 0xffff0000, v19
    v_add_u32 v123, v123, v123
    v_pk_fma_f32 v[124:125], v[124:125], v[122:123], s[34:35] op_sel_hi:[1,0,1]
    v_pk_fma_f32 v[126:127], v[126:127], v[122:123], s[34:35] op_sel_hi:[1,0,1]
    v_lshl_add_u32 v124, v125, 16, v124
    v_lshl_add_u32 v125, v127, 16, v126
    s_waitcnt lgkmcnt(2)
    v_bitop3_b32 v115, v115, v116, v117 bitop3:0xfe
    v_lshl_add_u64 v[124:125], v[124:125], 0, s[36:37]
    v_cmpx_le_u32 vcc, 0x1000000, v57
    ds_add_rtn_u64 v[116:117], v123, v[124:125] offset:54272
    s_mov_b64 exec, -1
    v_ashrrev_i32 v122, 5, v58
    v_lshlrev_b16 v123, 2, v58
    v_lshlrev_b32 v124, 16, v20
    v_bitop3_b32 v122, v122, v113, v113 bitop3:0x0c
    v_and_b32 v125, 0xffff0000, v20
    v_lshlrev_b32 v126, 16, v21
    v_mul_f32 v122, v114, v122
    v_and_b32 v127, 0xffff0000, v21
    v_add_u32 v123, v123, v123
    v_pk_fma_f32 v[124:125], v[124:125], v[122:123], s[34:35] op_sel_hi:[1,0,1]
    v_pk_fma_f32 v[126:127], v[126:127], v[122:123], s[34:35] op_sel_hi:[1,0,1]
    v_lshl_add_u32 v124, v125, 16, v124
    v_lshl_add_u32 v125, v127, 16, v126
    s_waitcnt lgkmcnt(2)
    v_bitop3_b32 v115, v115, v118, v119 bitop3:0xfe
    v_lshl_add_u64 v[124:125], v[124:125], 0, s[36:37]
    v_cmpx_le_u32 vcc, 0x1000000, v58
    ds_add_rtn_u64 v[118:119], v123, v[124:125] offset:54272
    s_mov_b64 exec, -1
    v_ashrrev_i32 v122, 5, v59
    v_lshlrev_b16 v123, 2, v59
    v_lshlrev_b32 v124, 16, v22
    v_bitop3_b32 v122, v122, v113, v113 bitop3:0x0c
    v_and_b32 v125, 0xffff0000, v22
    v_lshlrev_b32 v126, 16, v23
    v_mul_f32 v122, v114, v122
    v_and_b32 v127, 0xffff0000, v23
    v_add_u32 v123, v123, v123
    v_pk_fma_f32 v[124:125], v[124:125], v[122:123], s[34:35] op_sel_hi:[1,0,1]
    v_pk_fma_f32 v[126:127], v[126:127], v[122:123], s[34:35] op_sel_hi:[1,0,1]
    v_lshl_add_u32 v124, v125, 16, v124
    v_lshl_add_u32 v125, v127, 16, v126
    s_waitcnt lgkmcnt(2)
    v_bitop3_b32 v115, v115, v120, v121 bitop3:0xfe
    v_lshl_add_u64 v[124:125], v[124:125], 0, s[36:37]
    v_cmpx_le_u32 vcc, 0x1000000, v59
    ds_add_rtn_u64 v[120:121], v123, v[124:125] offset:54272
    s_mov_b64 exec, -1
p2_na0a3:
    v_bfe_u32 v18, v105, 14, 4
    v_lshrrev_b32 v19, 18, v105
    v_and_b32 v105, 0x3fff, v105
    v_mad_u32_u24 v18, v18, s63, v19
    v_mad_u32_u24 v105, v18, s65, v105
    buffer_load_dwordx4 v[18:21], v105, s[68:71], 0 offen
    s_mov_b32 m0, s23
    s_nop 0
    ds_read_addtid_b32 v102 offset:1024
    ds_read_addtid_b32 v103 offset:1280
    ds_read_addtid_b32 v104 offset:1536
    ds_read_addtid_b32 v105 offset:1792
    ds_read_addtid_b32 v106 offset:0
    ds_read_addtid_b32 v107 offset:256
    ds_read_addtid_b32 v108 offset:512
    ds_read_addtid_b32 v109 offset:768
    s_waitcnt vmcnt(4)
    s_mov_b32 m0, s24
    s_cmp_ge_u32 s10, 9
    s_cbranch_scc1 p2_st0s0
    ds_write_addtid_b32 v84 offset:49152
    ds_write_addtid_b32 v85 offset:49408
p2_st0s0:
    s_mov_b32 m0, s23
    s_add_u32 s20, s20, 53760
    ds_write_addtid_b32 v72 offset:0
    ds_write_addtid_b32 v73 offset:256
    ds_write_addtid_b32 v74 offset:512
    ds_write_addtid_b32 v75 offset:768
    ds_write_addtid_b32 v76 offset:1024
    ds_write_addtid_b32 v77 offset:1280
    ds_write_addtid_b32 v78 offset:1536
    ds_write_addtid_b32 v79 offset:1792
    ds_write_addtid_b32 v80 offset:2048
    ds_write_addtid_b32 v81 offset:2304
    ds_write_addtid_b32 v82 offset:2560
    ds_write_addtid_b32 v83 offset:2816
    s_setprio 1
    s_waitcnt lgkmcnt(15)
    v_ashrrev_i32 v122, 5, v60
    v_lshlrev_b16 v123, 2, v60
    v_lshlrev_b32 v124, 16, v24
    v_bitop3_b32 v122, v122, v113, v113 bitop3:0x0c
    v_and_b32 v125, 0xffff0000, v24
    v_lshlrev_b32 v126, 16, v25
    v_mul_f32 v122, v114, v122
    v_and_b32 v127, 0xffff0000, v25
    v_add_u32 v123, v123, v123
    v_pk_fma_f32 v[124:125], v[124:125], v[122:123], s[34:35] op_sel_hi:[1,0,1]
    v_pk_fma_f32 v[126:127], v[126:127], v[122:123], s[34:35] op_sel_hi:[1,0,1]
    v_lshl_add_u32 v124, v125, 16, v124
    v_lshl_add_u32 v125, v127, 16, v126
    s_waitcnt lgkmcnt(15)
    v_bitop3_b32 v115, v115, v116, v117 bitop3:0xfe
    v_lshl_add_u64 v[124:125], v[124:125], 0, s[36:37]
    v_cmpx_le_u32 vcc, 0x1000000, v60
    ds_add_rtn_u64 v[116:117], v123, v[124:125] offset:54272
    s_mov_b64 exec, -1
    v_ashrrev_i32 v122, 5, v61
    v_lshlrev_b16 v123, 2, v61
    v_lshlrev_b32 v124, 16, v26
    v_bitop3_b32 v122, v122, v113, v113 bitop3:0x0c
    v_and_b32 v125, 0xffff0000, v26
    v_lshlrev_b32 v126, 16, v27
    v_mul_f32 v122, v114, v122
    v_and_b32 v127, 0xffff0000, v27
    v_add_u32 v123, v123, v123
    v_pk_fma_f32 v[124:125], v[124:125], v[122:123], s[34:35] op_sel_hi:[1,0,1]
    v_pk_fma_f32 v[126:127], v[126:127], v[122:123], s[34:35] op_sel_hi:[1,0,1]
    v_lshl_add_u32 v124, v125, 16, v124
    v_lshl_add_u32 v125, v127, 16, v126
    s_waitcnt lgkmcnt(15)
    v_bitop3_b32 v115, v115, v118, v119 bitop3:0xfe
    v_lshl_add_u64 v[124:125], v[124:125], 0, s[36:37]
    v_cmpx_le_u32 vcc, 0x1000000, v61
    ds_add_rtn_u64 v[118:119], v123, v[124:125] offset:54272
    s_mov_b64 exec, -1
    v_ashrrev_i32 v122, 5, v62
    v_lshlrev_b16 v123, 2, v62
    v_lshlrev_b32 v124, 16, v28
    v_bitop3_b32 v122, v122, v113, v113 bitop3:0x0c
    v_and_b32 v125, 0xffff0000, v28
    v_lshlrev_b32 v126, 16, v29
    v_mul_f32 v122, v114, v122
    v_and_b32 v127, 0xffff0000, v29
    v_add_u32 v123, v123, v123
    v_pk_fma_f32 v[124:125], v[124:125], v[122:123], s[34:35] op_sel_hi:[1,0,1]
    v_pk_fma_f32 v[126:127], v[126:127], v[122:123], s[34:35] op_sel_hi:[1,0,1]
    v_lshl_add_u32 v124, v125, 16, v124
    v_lshl_add_u32 v125, v127, 16, v126
    s_waitcnt lgkmcnt(15)
    v_bitop3_b32 v115, v115, v120, v121 bitop3:0xfe
    v_lshl_add_u64 v[124:125], v[124:125], 0, s[36:37]
    v_cmpx_le_u32 vcc, 0x1000000, v62
    ds_add_rtn_u64 v[120:121], v123, v[124:125] offset:54272
    s_mov_b64 exec, -1
    s_waitcnt vmcnt(16)
    v_perm_b32 v60, v89, v86, s31
    v_perm_b32 v61, v89, v87, s32
    v_perm_b32 v62, v89, v88, s33
    v_lshlrev_b16 v28, 3, v88
    v_lshlrev_b16 v26, 3, v87
    v_lshlrev_b16 v24, 3, v86
    s_waitcnt lgkmcnt(15)
    s_nop 2
    s_nop 1
    v_max_u32_dpp v106, v106, v106 row_shr:1 row_mask:0xf bank_mask:0xf bound_ctrl:0
    v_max_u32_dpp v107, v107, v107 row_shr:1 row_mask:0xf bank_mask:0xf bound_ctrl:0
    s_nop 0
    v_max_u32_dpp v106, v106, v106 row_shr:2 row_mask:0xf bank_mask:0xf bound_ctrl:0
    v_max_u32_dpp v107, v107, v107 row_shr:2 row_mask:0xf bank_mask:0xf bound_ctrl:0
    s_nop 0
    v_max_u32_dpp v106, v106, v106 row_shr:4 row_mask:0xf bank_mask:0xf bound_ctrl:0
    v_max_u32_dpp v107, v107, v107 row_shr:4 row_mask:0xf bank_mask:0xf bound_ctrl:0
    s_nop 0
    v_max_u32_dpp v106, v106, v106 row_shr:8 row_mask:0xf bank_mask:0xf bound_ctrl:0
    v_max_u32_dpp v107, v107, v107 row_shr:8 row_mask:0xf bank_mask:0xf bound_ctrl:0
    s_nop 0
    v_max_u32_dpp v106, v106, v106 row_bcast:15 row_mask:0xa bank_mask:0xf
    v_max_u32_dpp v107, v107, v107 row_bcast:15 row_mask:0xa bank_mask:0xf
    s_nop 0
    v_max_u32_dpp v106, v106, v106 row_bcast:31 row_mask:0xc bank_mask:0xf
    v_max_u32_dpp v107, v107, v107 row_bcast:31 row_mask:0xc bank_mask:0xf
    s_nop 0
    s_nop 0
    v_readlane_b32 s41, v106, 63
    v_add_u32 v106, v106, v112
    v_add_u32 v106, 4294959104, v106
    v_max_u32 v107, s41, v107
    s_nop 0
    v_readlane_b32 s41, v107, 63
    v_add_u32 v107, v107, v112
    v_add_u32 v107, 4294960128, v107
    v_bfe_u32 v86, v106, 14, 4
    v_lshrrev_b32 v87, 18, v106
    v_and_b32 v106, 0x3fff, v106
    v_mad_u32_u24 v86, v86, s63, v87
    v_mad_u32_u24 v106, v86, s65, v106
    buffer_load_dwordx4 v[86:89], v106, s[68:71], 0 offen
    s_setprio 0
    s_waitcnt lgkmcnt(15)
    v_ashrrev_i32 v122, 5, v63
    v_lshlrev_b16 v123, 2, v63
    v_lshlrev_b32 v124, 16, v30
    v_bitop3_b32 v122, v122, v113, v113 bitop3:0x0c
    v_and_b32 v125, 0xffff0000, v30
    v_lshlrev_b32 v126, 16, v31
    v_mul_f32 v122, v114, v122
    v_and_b32 v127, 0xffff0000, v31
    v_add_u32 v123, v123, v123
    v_pk_fma_f32 v[124:125], v[124:125], v[122:123], s[34:35] op_sel_hi:[1,0,1]
    v_pk_fma_f32 v[126:127], v[126:127], v[122:123], s[34:35] op_sel_hi:[1,0,1]
    v_lshl_add_u32 v124, v125, 16, v124
    v_lshl_add_u32 v125, v127, 16, v126
    s_waitcnt lgkmcnt(2)
    v_bitop3_b32 v115, v115, v116, v117 bitop3:0xfe
    v_lshl_add_u64 v[124:125], v[124:125], 0, s[36:37]
    v_cmpx_le_u32 vcc, 0x1000000, v63
    ds_add_rtn_u64 v[116:117], v123, v[124:125] offset:54272
    s_mov_b64 exec, -1
    v_ashrrev_i32 v122, 5, v64
    v_lshlrev_b16 v123, 2, v64
    v_lshlrev_b32 v124, 16, v32
    v_bitop3_b32 v122, v122, v113, v113 bitop3:0x0c
    v_and_b32 v125, 0xffff0000, v32
    v_lshlrev_b32 v126, 16, v33
    v_mul_f32 v122, v114, v122
    v_and_b32 v127, 0xffff0000, v33
    v_add_u32 v123, v123, v123
    v_pk_fma_f32 v[124:125], v[124:125], v[122:123], s[34:35] op_sel_hi:[1,0,1]
    v_pk_fma_f32 v[126:127], v[126:127], v[122:123], s[34:35] op_sel_hi:[1,0,1]
    v_lshl_add_u32 v124, v125, 16, v124
    v_lshl_add_u32 v125, v127, 16, v126
    s_waitcnt lgkmcnt(2)
    v_bitop3_b32 v115, v115, v118, v119 bitop3:0xfe
    v_lshl_add_u64 v[124:125], v[124:125], 0, s[36:37]
    v_cmpx_le_u32 vcc, 0x1000000, v64
    ds_add_rtn_u64 v[118:119], v123, v[124:125] offset:54272
    s_mov_b64 exec, -1
    v_ashrrev_i32 v122, 5, v65
    v_lshlrev_b16 v123, 2, v65
    v_lshlrev_b32 v124, 16, v34
    v_bitop3_b32 v122, v122, v113, v113 bitop3:0x0c
    v_and_b32 v125, 0xffff0000, v34
    v_lshlrev_b32 v126, 16, v35
    v_mul_f32 v122, v114, v122
    v_and_b32 v127, 0xffff0000, v35
    v_add_u32 v123, v123, v123
    v_pk_fma_f32 v[124:125], v[124:125], v[122:123], s[34:35] op_sel_hi:[1,0,1]
    v_pk_fma_f32 v[126:127], v[126:127], v[122:123], s[34:35] op_sel_hi:[1,0,1]
    v_lshl_add_u32 v124, v125, 16, v124
    v_lshl_add_u32 v125, v127, 16, v126
    s_waitcnt lgkmcnt(2)
    v_bitop3_b32 v115, v115, v120, v121 bitop3:0xfe
    v_lshl_add_u64 v[124:125], v[124:125], 0, s[36:37]
    v_cmpx_le_u32 vcc, 0x1000000, v65
    ds_add_rtn_u64 v[120:121], v123, v[124:125] offset:54272
    s_mov_b64 exec, -1
    s_waitcnt vmcnt(13)
    v_perm_b32 v63, v93, v90, s31
    v_perm_b32 v64, v93, v91, s32
    v_perm_b32 v65, v93, v92, s33
    v_lshlrev_b16 v34, 3, v92
    v_lshlrev_b16 v32, 3, v91
    v_lshlrev_b16 v30, 3, v90
    s_waitcnt lgkmcnt(6)
    s_barrier
    s_setprio 3
    s_cmp_ge_u32 s10, 9
    s_cbranch_scc1 p2_nm0m1a
    v_lshrrev_b32 v84, 1, v112
    s_add_u32 s44, s20, s42
    buffer_load_dwordx2 v[84:85], v84, s[4:7], s44 offen
p2_nm0m1a:
    buffer_load_dwordx4 v[72:75], v112, s[4:7], s20 offen offset:0
    buffer_load_dwordx4 v[76:79], v112, s[4:7], s20 offen offset:1024
    buffer_load_dwordx4 v[80:83], v112, s[4:7], s20 offen offset:2048
    v_cmpx_ge_u16 vcc, 0x3fff, v60
    ds_read_b64 v[24:25], v24
    s_mov_b64 exec, -1
    v_cmpx_ge_u16 vcc, 0x3fff, v61
    ds_read_b64 v[26:27], v26
    s_mov_b64 exec, -1
    v_cmpx_ge_u16 vcc, 0x3fff, v62
    ds_read_b64 v[28:29], v28
    s_mov_b64 exec, -1
    v_cmpx_ge_u16 vcc, 0x3fff, v63
    ds_read_b64 v[30:31], v30
    s_mov_b64 exec, -1
    v_cmpx_ge_u16 vcc, 0x3fff, v64
    ds_read_b64 v[32:33], v32
    s_mov_b64 exec, -1
    v_cmpx_ge_u16 vcc, 0x3fff, v65
    ds_read_b64 v[34:35], v34
    s_mov_b64 exec, -1
    s_setprio 2
    s_waitcnt lgkmcnt(15)
    v_ashrrev_i32 v122, 5, v66
    v_lshlrev_b16 v123, 2, v66
    v_lshlrev_b32 v124, 16, v36
    v_bitop3_b32 v122, v122, v113, v113 bitop3:0x0c
    v_and_b32 v125, 0xffff0000, v36
    v_lshlrev_b32 v126, 16, v37
    v_mul_f32 v122, v114, v122
    v_and_b32 v127, 0xffff0000, v37
    v_add_u32 v123, v123, v123
    v_pk_fma_f32 v[124:125], v[124:125], v[122:123], s[34:35] op_sel_hi:[1,0,1]
    v_pk_fma_f32 v[126:127], v[126:127], v[122:123], s[34:35] op_sel_hi:[1,0,1]
    v_lshl_add_u32 v124, v125, 16, v124
    v_lshl_add_u32 v125, v127, 16, v126
    s_waitcnt lgkmcnt(8)
    v_bitop3_b32 v115, v115, v116, v117 bitop3:0xfe
    v_lshl_add_u64 v[124:125], v[124:125], 0, s[36:37]
    v_cmpx_le_u32 vcc, 0x1000000, v66
    ds_add_rtn_u64 v[116:117], v123, v[124:125] offset:54272
    s_mov_b64 exec, -1
    v_ashrrev_i32 v122, 5, v67
    v_lshlrev_b16 v123, 2, v67
    v_lshlrev_b32 v124, 16, v38
    v_bitop3_b32 v122, v122, v113, v113 bitop3:0x0c
    v_and_b32 v125, 0xffff0000, v38
    v_lshlrev_b32 v126, 16, v39
    v_mul_f32 v122, v114, v122
    v_and_b32 v127, 0xffff0000, v39
    v_add_u32 v123, v123, v123
    v_pk_fma_f32 v[124:125], v[124:125], v[122:123], s[34:35] op_sel_hi:[1,0,1]
    v_pk_fma_f32 v[126:127], v[126:127], v[122:123], s[34:35] op_sel_hi:[1,0,1]
    v_lshl_add_u32 v124, v125, 16, v124
    v_lshl_add_u32 v125, v127, 16, v126
    s_waitcnt lgkmcnt(8)
    v_bitop3_b32 v115, v115, v118, v119 bitop3:0xfe
    v_lshl_add_u64 v[124:125], v[124:125], 0, s[36:37]
    v_cmpx_le_u32 vcc, 0x1000000, v67
    ds_add_rtn_u64 v[118:119], v123, v[124:125] offset:54272
    s_mov_b64 exec, -1
    v_ashrrev_i32 v122, 5, v68
    v_lshlrev_b16 v123, 2, v68
    v_lshlrev_b32 v124, 16, v40
    v_bitop3_b32 v122, v122, v113, v113 bitop3:0x0c
    v_and_b32 v125, 0xffff0000, v40
    v_lshlrev_b32 v126, 16, v41
    v_mul_f32 v122, v114, v122
    v_and_b32 v127, 0xffff0000, v41
    v_add_u32 v123, v123, v123
    v_pk_fma_f32 v[124:125], v[124:125], v[122:123], s[34:35] op_sel_hi:[1,0,1]
    v_pk_fma_f32 v[126:127], v[126:127], v[122:123], s[34:35] op_sel_hi:[1,0,1]
    v_lshl_add_u32 v124, v125, 16, v124
    v_lshl_add_u32 v125, v127, 16, v126
    s_waitcnt lgkmcnt(8)
    v_bitop3_b32 v115, v115, v120, v121 bitop3:0xfe
    v_lshl_add_u64 v[124:125], v[124:125], 0, s[36:37]
    v_cmpx_le_u32 vcc, 0x1000000, v68
    ds_add_rtn_u64 v[120:121], v123, v[124:125] offset:54272
    s_mov_b64 exec, -1
    s_waitcnt vmcnt(15)
    v_perm_b32 v66, v97, v94, s31
    v_perm_b32 v67, v97, v95, s32
    v_perm_b32 v68, v97, v96, s33
    v_lshlrev_b16 v40, 3, v96
    v_lshlrev_b16 v38, 3, v95
    v_lshlrev_b16 v36, 3, v94
    v_cmpx_ge_u16 vcc, 0x3fff, v66
    ds_read_b64 v[36:37], v36
    s_mov_b64 exec, -1
    v_cmpx_ge_u16 vcc, 0x3fff, v67
    ds_read_b64 v[38:39], v38
    s_mov_b64 exec, -1
    v_cmpx_ge_u16 vcc, 0x3fff, v68
    ds_read_b64 v[40:41], v40
    s_mov_b64 exec, -1
    v_bfe_u32 v90, v107, 14, 4
    v_lshrrev_b32 v91, 18, v107
    v_and_b32 v107, 0x3fff, v107
    v_mad_u32_u24 v90, v90, s63, v91
    v_mad_u32_u24 v107, v90, s65, v107
    buffer_load_dwordx4 v[90:93], v107, s[68:71], 0 offen
    s_setprio 1
    s_waitcnt lgkmcnt(15)
    v_ashrrev_i32 v122, 5, v69
    v_lshlrev_b16 v123, 2, v69
    v_lshlrev_b32 v124, 16, v42
    v_bitop3_b32 v122, v122, v113, v113 bitop3:0x0c
    v_and_b32 v125, 0xffff0000, v42
    v_lshlrev_b32 v126, 16, v43
    v_mul_f32 v122, v114, v122
    v_and_b32 v127, 0xffff0000, v43
    v_add_u32 v123, v123, v123
    v_pk_fma_f32 v[124:125], v[124:125], v[122:123], s[34:35] op_sel_hi:[1,0,1]
    v_pk_fma_f32 v[126:127], v[126:127], v[122:123], s[34:35] op_sel_hi:[1,0,1]
    v_lshl_add_u32 v124, v125, 16, v124
    v_lshl_add_u32 v125, v127, 16, v126
    s_waitcnt lgkmcnt(5)
    v_bitop3_b32 v115, v115, v116, v117 bitop3:0xfe
    v_lshl_add_u64 v[124:125], v[124:125], 0, s[36:37]
    v_cmpx_le_u32 vcc, 0x1000000, v69
    ds_add_rtn_u64 v[116:117], v123, v[124:125] offset:54272
    s_mov_b64 exec, -1
    v_ashrrev_i32 v122, 5, v70
    v_lshlrev_b16 v123, 2, v70
    v_lshlrev_b32 v124, 16, v44
    v_bitop3_b32 v122, v122, v113, v113 bitop3:0x0c
    v_and_b32 v125, 0xffff0000, v44
    v_lshlrev_b32 v126, 16, v45
    v_mul_f32 v122, v114, v122
    v_and_b32 v127, 0xffff0000, v45
    v_add_u32 v123, v123, v123
    v_pk_fma_f32 v[124:125], v[124:125], v[122:123], s[34:35] op_sel_hi:[1,0,1]
    v_pk_fma_f32 v[126:127], v[126:127], v[122:123], s[34:35] op_sel_hi:[1,0,1]
    v_lshl_add_u32 v124, v125, 16, v124
    v_lshl_add_u32 v125, v127, 16, v126
    s_waitcnt lgkmcnt(5)
    v_bitop3_b32 v115, v115, v118, v119 bitop3:0xfe
    v_lshl_add_u64 v[124:125], v[124:125], 0, s[36:37]
    v_cmpx_le_u32 vcc, 0x1000000, v70
    ds_add_rtn_u64 v[118:119], v123, v[124:125] offset:54272
    s_mov_b64 exec, -1
    v_ashrrev_i32 v122, 5, v71
    v_lshlrev_b16 v123, 2, v71
    v_lshlrev_b32 v124, 16, v46
    v_bitop3_b32 v122, v122, v113, v113 bitop3:0x0c
    v_and_b32 v125, 0xffff0000, v46
    v_lshlrev_b32 v126, 16, v47
    v_mul_f32 v122, v114, v122
    v_and_b32 v127, 0xffff0000, v47
    v_add_u32 v123, v123, v123
    v_pk_fma_f32 v[124:125], v[124:125], v[122:123], s[34:35] op_sel_hi:[1,0,1]
    v_pk_fma_f32 v[126:127], v[126:127], v[122:123], s[34:35] op_sel_hi:[1,0,1]
    v_lshl_add_u32 v124, v125, 16, v124
    v_lshl_add_u32 v125, v127, 16, v126
    s_waitcnt lgkmcnt(5)
    v_bitop3_b32 v115, v115, v120, v121 bitop3:0xfe
    v_lshl_add_u64 v[124:125], v[124:125], 0, s[36:37]
    v_cmpx_le_u32 vcc, 0x1000000, v71
    ds_add_rtn_u64 v[120:121], v123, v[124:125] offset:54272
    s_mov_b64 exec, -1
    s_waitcnt vmcnt(12)
    v_perm_b32 v69, v101, v98, s31
    v_perm_b32 v70, v101, v99, s32
    v_perm_b32 v71, v101, v100, s33
    v_lshlrev_b16 v46, 3, v100
    v_lshlrev_b16 v44, 3, v99
    v_lshlrev_b16 v42, 3, v98
    v_cmpx_ge_u16 vcc, 0x3fff, v69
    ds_read_b64 v[42:43], v42
    s_mov_b64 exec, -1
    v_cmpx_ge_u16 vcc, 0x3fff, v70
    ds_read_b64 v[44:45], v44
    s_mov_b64 exec, -1
    v_cmpx_ge_u16 vcc, 0x3fff, v71
    ds_read_b64 v[46:47], v46
    s_mov_b64 exec, -1
    s_waitcnt lgkmcnt(15)
    s_nop 2
    s_nop 1
    v_max_u32_dpp v108, v108, v108 row_shr:1 row_mask:0xf bank_mask:0xf bound_ctrl:0
    v_max_u32_dpp v109, v109, v109 row_shr:1 row_mask:0xf bank_mask:0xf bound_ctrl:0
    s_nop 0
    v_max_u32_dpp v108, v108, v108 row_shr:2 row_mask:0xf bank_mask:0xf bound_ctrl:0
    v_max_u32_dpp v109, v109, v109 row_shr:2 row_mask:0xf bank_mask:0xf bound_ctrl:0
    s_nop 0
    v_max_u32_dpp v108, v108, v108 row_shr:4 row_mask:0xf bank_mask:0xf bound_ctrl:0
    v_max_u32_dpp v109, v109, v109 row_shr:4 row_mask:0xf bank_mask:0xf bound_ctrl:0
    s_nop 0
    v_max_u32_dpp v108, v108, v108 row_shr:8 row_mask:0xf bank_mask:0xf bound_ctrl:0
    v_max_u32_dpp v109, v109, v109 row_shr:8 row_mask:0xf bank_mask:0xf bound_ctrl:0
    s_nop 0
    v_max_u32_dpp v108, v108, v108 row_bcast:15 row_mask:0xa bank_mask:0xf
    v_max_u32_dpp v109, v109, v109 row_bcast:15 row_mask:0xa bank_mask:0xf
    s_nop 0
    v_max_u32_dpp v108, v108, v108 row_bcast:31 row_mask:0xc bank_mask:0xf
    v_max_u32_dpp v109, v109, v109 row_bcast:31 row_mask:0xc bank_mask:0xf
    s_nop 0
    s_nop 0
    v_max_u32 v108, s41, v108
    s_nop 0
    v_readlane_b32 s41, v108, 63
    v_add_u32 v108, v108, v112
    v_add_u32 v108, 4294961152, v108
    v_max_u32 v109, s41, v109
    s_nop 0
    v_readlane_b32 s41, v109, 63
    v_add_u32 v109, v109, v112
    v_add_u32 v109, 4294962176, v109
    v_bfe_u32 v94, v108, 14, 4
    v_lshrrev_b32 v95, 18, v108
    v_and_b32 v108, 0x3fff, v108
    v_mad_u32_u24 v94, v94, s63, v95
    v_mad_u32_u24 v108, v94, s65, v108
    buffer_load_dwordx4 v[94:97], v108, s[68:71], 0 offen
    s_setprio 0
    s_waitcnt vmcnt(9)
    v_perm_b32 v48, v3, v0, s31
    v_perm_b32 v49, v3, v1, s32
    v_perm_b32 v50, v3, v2, s33
    v_lshlrev_b16 v4, 3, v2
    v_lshlrev_b16 v2, 3, v1
    v_lshlrev_b16 v0, 3, v0
    v_cmpx_ge_u16 vcc, 0x3fff, v48
    ds_read_b64 v[0:1], v0
    s_mov_b64 exec, -1
    v_cmpx_ge_u16 vcc, 0x3fff, v49
    ds_read_b64 v[2:3], v2
    s_mov_b64 exec, -1
    v_cmpx_ge_u16 vcc, 0x3fff, v50
    ds_read_b64 v[4:5], v4
    s_mov_b64 exec, -1
    s_waitcnt vmcnt(8)
    v_perm_b32 v51, v9, v6, s31
    v_perm_b32 v52, v9, v7, s32
    v_perm_b32 v53, v9, v8, s33
    v_lshlrev_b16 v10, 3, v8
    v_lshlrev_b16 v8, 3, v7
    v_lshlrev_b16 v6, 3, v6
    v_cmpx_ge_u16 vcc, 0x3fff, v51
    ds_read_b64 v[6:7], v6
    s_mov_b64 exec, -1
    v_cmpx_ge_u16 vcc, 0x3fff, v52
    ds_read_b64 v[8:9], v8
    s_mov_b64 exec, -1
    v_cmpx_ge_u16 vcc, 0x3fff, v53
    ds_read_b64 v[10:11], v10
    s_mov_b64 exec, -1
    s_waitcnt vmcnt(7)
    v_perm_b32 v54, v15, v12, s31
    v_perm_b32 v55, v15, v13, s32
    v_perm_b32 v56, v15, v14, s33
    v_lshlrev_b16 v16, 3, v14
    v_lshlrev_b16 v14, 3, v13
    v_lshlrev_b16 v12, 3, v12
    v_cmpx_ge_u16 vcc, 0x3fff, v54
    ds_read_b64 v[12:13], v12
    s_mov_b64 exec, -1
    v_cmpx_ge_u16 vcc, 0x3fff, v55
    ds_read_b64 v[14:15], v14
    s_mov_b64 exec, -1
    v_cmpx_ge_u16 vcc, 0x3fff, v56
    ds_read_b64 v[16:17], v16
    s_mov_b64 exec, -1
    s_waitcnt vmcnt(6)
    v_perm_b32 v57, v21, v18, s31
    v_perm_b32 v58, v21, v19, s32
    v_perm_b32 v59, v21, v20, s33
    v_lshlrev_b16 v22, 3, v20
    v_lshlrev_b16 v20, 3, v19
    v_lshlrev_b16 v18, 3, v18
    s_cmp_lt_u32 s16, 8
    s_cbranch_scc1 p2_g0r03
    v_cmpx_ge_u16 vcc, 0x3fff, v57
    ds_read_b64 v[18:19], v18
    s_mov_b64 exec, -1
    v_cmpx_ge_u16 vcc, 0x3fff, v58
    ds_read_b64 v[20:21], v20
    s_mov_b64 exec, -1
    v_cmpx_ge_u16 vcc, 0x3fff, v59
    ds_read_b64 v[22:23], v22
    s_mov_b64 exec, -1
p2_g0r03:
    s_waitcnt lgkmcnt(0)
    s_barrier
    s_waitcnt lgkmcnt(15)
    s_branch p2_tail
p2_drain0:
    v_cmpx_gt_i16 vcc, 0, v48
    ds_read_b64 v[0:1], v0
    s_mov_b64 exec, -1
    v_cmpx_gt_i16 vcc, 0, v49
    ds_read_b64 v[2:3], v2
    s_mov_b64 exec, -1
    v_cmpx_gt_i16 vcc, 0, v50
    ds_read_b64 v[4:5], v4
    s_mov_b64 exec, -1
    v_cmpx_gt_i16 vcc, 0, v51
    ds_read_b64 v[6:7], v6
    s_mov_b64 exec, -1
    v_cmpx_gt_i16 vcc, 0, v52
    ds_read_b64 v[8:9], v8
    s_mov_b64 exec, -1
    v_cmpx_gt_i16 vcc, 0, v53
    ds_read_b64 v[10:11], v10
    s_mov_b64 exec, -1
    v_cmpx_gt_i16 vcc, 0, v54
    ds_read_b64 v[12:13], v12
    s_mov_b64 exec, -1
    v_cmpx_gt_i16 vcc, 0, v55
    ds_read_b64 v[14:15], v14
    s_mov_b64 exec, -1
    v_cmpx_gt_i16 vcc, 0, v56
    ds_read_b64 v[16:17], v16
    s_mov_b64 exec, -1
    s_cmp_lt_u32 s15, 8
    s_cbranch_scc1 p2_gd0
    v_cmpx_gt_i16 vcc, 0, v57
    ds_read_b64 v[18:19], v18
    s_mov_b64 exec, -1
    v_cmpx_gt_i16 vcc, 0, v58
    ds_read_b64 v[20:21], v20
    s_mov_b64 exec, -1
    v_cmpx_gt_i16 vcc, 0, v59
    ds_read_b64 v[22:23], v22
    s_mov_b64 exec, -1
p2_gd0:
    v_cmpx_gt_i16 vcc, 0, v60
    ds_read_b64 v[24:25], v24
    s_mov_b64 exec, -1
    v_cmpx_gt_i16 vcc, 0, v61
    ds_read_b64 v[26:27], v26
    s_mov_b64 exec, -1
    v_cmpx_gt_i16 vcc, 0, v62
    ds_read_b64 v[28:29], v28
    s_mov_b64 exec, -1
    v_cmpx_gt_i16 vcc, 0, v63
    ds_read_b64 v[30:31], v30
    s_mov_b64 exec, -1
    v_cmpx_gt_i16 vcc, 0, v64
    ds_read_b64 v[32:33], v32
    s_mov_b64 exec, -1
    v_cmpx_gt_i16 vcc, 0, v65
    ds_read_b64 v[34:35], v34
    s_mov_b64 exec, -1
    v_cmpx_gt_i16 vcc, 0, v66
    ds_read_b64 v[36:37], v36
    s_mov_b64 exec, -1
    v_cmpx_gt_i16 vcc, 0, v67
    ds_read_b64 v[38:39], v38
    s_mov_b64 exec, -1
    v_cmpx_gt_i16 vcc, 0, v68
    ds_read_b64 v[40:41], v40
    s_mov_b64 exec, -1
    v_cmpx_gt_i16 vcc, 0, v69
    ds_read_b64 v[42:43], v42
    s_mov_b64 exec, -1
    v_cmpx_gt_i16 vcc, 0, v70
    ds_read_b64 v[44:45], v44
    s_mov_b64 exec, -1
    v_cmpx_gt_i16 vcc, 0, v71
    ds_read_b64 v[46:47], v46
    s_mov_b64 exec, -1
    s_waitcnt lgkmcnt(15)
    v_ashrrev_i32 v122, 5, v48
    v_lshlrev_b16 v123, 2, v48
    v_lshlrev_b32 v124, 16, v0
    v_bitop3_b32 v122, v122, v113, v113 bitop3:0x0c
    v_and_b32 v125, 0xffff0000, v0
    v_lshlrev_b32 v126, 16, v1
    v_mul_f32 v122, v114, v122
    v_and_b32 v127, 0xffff0000, v1
    v_add_u32 v123, v123, v123
    v_pk_fma_f32 v[124:125], v[124:125], v[122:123], s[34:35] op_sel_hi:[1,0,1]
    v_pk_fma_f32 v[126:127], v[126:127], v[122:123], s[34:35] op_sel_hi:[1,0,1]
    v_lshl_add_u32 v124, v125, 16, v124
    v_lshl_add_u32 v125, v127, 16, v126
    s_waitcnt lgkmcnt(15)
    v_bitop3_b32 v115, v115, v116, v117 bitop3:0xfe
    v_lshl_add_u64 v[124:125], v[124:125], 0, s[36:37]
    v_cmpx_le_u32 vcc, 0x1000000, v48
    ds_add_rtn_u64 v[116:117], v123, v[124:125] offset:54272
    s_mov_b64 exec, -1
    v_ashrrev_i32 v122, 5, v49
    v_lshlrev_b16 v123, 2, v49
    v_lshlrev_b32 v124, 16, v2
    v_bitop3_b32 v122, v122, v113, v113 bitop3:0x0c
    v_and_b32 v125, 0xffff0000, v2
    v_lshlrev_b32 v126, 16, v3
    v_mul_f32 v122, v114, v122
    v_and_b32 v127, 0xffff0000, v3
    v_add_u32 v123, v123, v123
    v_pk_fma_f32 v[124:125], v[124:125], v[122:123], s[34:35] op_sel_hi:[1,0,1]
    v_pk_fma_f32 v[126:127], v[126:127], v[122:123], s[34:35] op_sel_hi:[1,0,1]
    v_lshl_add_u32 v124, v125, 16, v124
    v_lshl_add_u32 v125, v127, 16, v126
    s_waitcnt lgkmcnt(15)
    v_bitop3_b32 v115, v115, v118, v119 bitop3:0xfe
    v_lshl_add_u64 v[124:125], v[124:125], 0, s[36:37]
    v_cmpx_le_u32 vcc, 0x1000000, v49
    ds_add_rtn_u64 v[118:119], v123, v[124:125] offset:54272
    s_mov_b64 exec, -1
    v_ashrrev_i32 v122, 5, v50
    v_lshlrev_b16 v123, 2, v50
    v_lshlrev_b32 v124, 16, v4
    v_bitop3_b32 v122, v122, v113, v113 bitop3:0x0c
    v_and_b32 v125, 0xffff0000, v4
    v_lshlrev_b32 v126, 16, v5
    v_mul_f32 v122, v114, v122
    v_and_b32 v127, 0xffff0000, v5
    v_add_u32 v123, v123, v123
    v_pk_fma_f32 v[124:125], v[124:125], v[122:123], s[34:35] op_sel_hi:[1,0,1]
    v_pk_fma_f32 v[126:127], v[126:127], v[122:123], s[34:35] op_sel_hi:[1,0,1]
    v_lshl_add_u32 v124, v125, 16, v124
    v_lshl_add_u32 v125, v127, 16, v126
    s_waitcnt lgkmcnt(15)
    v_bitop3_b32 v115, v115, v120, v121 bitop3:0xfe
    v_lshl_add_u64 v[124:125], v[124:125], 0, s[36:37]
    v_cmpx_le_u32 vcc, 0x1000000, v50
    ds_add_rtn_u64 v[120:121], v123, v[124:125] offset:54272
    s_mov_b64 exec, -1
    s_waitcnt lgkmcnt(15)
    v_ashrrev_i32 v122, 5, v51
    v_lshlrev_b16 v123, 2, v51
    v_lshlrev_b32 v124, 16, v6
    v_bitop3_b32 v122, v122, v113, v113 bitop3:0x0c
    v_and_b32 v125, 0xffff0000, v6
    v_lshlrev_b32 v126, 16, v7
    v_mul_f32 v122, v114, v122
    v_and_b32 v127, 0xffff0000, v7
    v_add_u32 v123, v123, v123
    v_pk_fma_f32 v[124:125], v[124:125], v[122:123], s[34:35] op_sel_hi:[1,0,1]
    v_pk_fma_f32 v[126:127], v[126:127], v[122:123], s[34:35] op_sel_hi:[1,0,1]
    v_lshl_add_u32 v124, v125, 16, v124
    v_lshl_add_u32 v125, v127, 16, v126
    s_waitcnt lgkmcnt(2)
    v_bitop3_b32 v115, v115, v116, v117 bitop3:0xfe
    v_lshl_add_u64 v[124:125], v[124:125], 0, s[36:37]
    v_cmpx_le_u32 vcc, 0x1000000, v51
    ds_add_rtn_u64 v[116:117], v123, v[124:125] offset:54272
    s_mov_b64 exec, -1
    v_ashrrev_i32 v122, 5, v52
    v_lshlrev_b16 v123, 2, v52
    v_lshlrev_b32 v124, 16, v8
    v_bitop3_b32 v122, v122, v113, v113 bitop3:0x0c
    v_and_b32 v125, 0xffff0000, v8
    v_lshlrev_b32 v126, 16, v9
    v_mul_f32 v122, v114, v122
    v_and_b32 v127, 0xffff0000, v9
    v_add_u32 v123, v123, v123
    v_pk_fma_f32 v[124:125], v[124:125], v[122:123], s[34:35] op_sel_hi:[1,0,1]
    v_pk_fma_f32 v[126:127], v[126:127], v[122:123], s[34:35] op_sel_hi:[1,0,1]
    v_lshl_add_u32 v124, v125, 16, v124
    v_lshl_add_u32 v125, v127, 16, v126
    s_waitcnt lgkmcnt(2)
    v_bitop3_b32 v115, v115, v118, v119 bitop3:0xfe
    v_lshl_add_u64 v[124:125], v[124:125], 0, s[36:37]
    v_cmpx_le_u32 vcc, 0x1000000, v52
    ds_add_rtn_u64 v[118:119], v123, v[124:125] offset:54272
    s_mov_b64 exec, -1
    v_ashrrev_i32 v122, 5, v53
    v_lshlrev_b16 v123, 2, v53
    v_lshlrev_b32 v124, 16, v10
    v_bitop3_b32 v122, v122, v113, v113 bitop3:0x0c
    v_and_b32 v125, 0xffff0000, v10
    v_lshlrev_b32 v126, 16, v11
    v_mul_f32 v122, v114, v122
    v_and_b32 v127, 0xffff0000, v11
    v_add_u32 v123, v123, v123
    v_pk_fma_f32 v[124:125], v[124:125], v[122:123], s[34:35] op_sel_hi:[1,0,1]
    v_pk_fma_f32 v[126:127], v[126:127], v[122:123], s[34:35] op_sel_hi:[1,0,1]
    v_lshl_add_u32 v124, v125, 16, v124
    v_lshl_add_u32 v125, v127, 16, v126
    s_waitcnt lgkmcnt(2)
    v_bitop3_b32 v115, v115, v120, v121 bitop3:0xfe
    v_lshl_add_u64 v[124:125], v[124:125], 0, s[36:37]
    v_cmpx_le_u32 vcc, 0x1000000, v53
    ds_add_rtn_u64 v[120:121], v123, v[124:125] offset:54272
    s_mov_b64 exec, -1
    s_waitcnt lgkmcnt(15)
    v_ashrrev_i32 v122, 5, v54
    v_lshlrev_b16 v123, 2, v54
    v_lshlrev_b32 v124, 16, v12
    v_bitop3_b32 v122, v122, v113, v113 bitop3:0x0c
    v_and_b32 v125, 0xffff0000, v12
    v_lshlrev_b32 v126, 16, v13
    v_mul_f32 v122, v114, v122
    v_and_b32 v127, 0xffff0000, v13
    v_add_u32 v123, v123, v123
    v_pk_fma_f32 v[124:125], v[124:125], v[122:123], s[34:35] op_sel_hi:[1,0,1]
    v_pk_fma_f32 v[126:127], v[126:127], v[122:123], s[34:35] op_sel_hi:[1,0,1]
    v_lshl_add_u32 v124, v125, 16, v124
    v_lshl_add_u32 v125, v127, 16, v126
    s_waitcnt lgkmcnt(2)
    v_bitop3_b32 v115, v115, v116, v117 bitop3:0xfe
    v_lshl_add_u64 v[124:125], v[124:125], 0, s[36:37]
    v_cmpx_le_u32 vcc, 0x1000000, v54
    ds_add_rtn_u64 v[116:117], v123, v[124:125] offset:54272
    s_mov_b64 exec, -1
    v_ashrrev_i32 v122, 5, v55
    v_lshlrev_b16 v123, 2, v55
    v_lshlrev_b32 v124, 16, v14
    v_bitop3_b32 v122, v122, v113, v113 bitop3:0x0c
    v_and_b32 v125, 0xffff0000, v14
    v_lshlrev_b32 v126, 16, v15
    v_mul_f32 v122, v114, v122
    v_and_b32 v127, 0xffff0000, v15
    v_add_u32 v123, v123, v123
    v_pk_fma_f32 v[124:125], v[124:125], v[122:123], s[34:35] op_sel_hi:[1,0,1]
    v_pk_fma_f32 v[126:127], v[126:127], v[122:123], s[34:35] op_sel_hi:[1,0,1]
    v_lshl_add_u32 v124, v125, 16, v124
    v_lshl_add_u32 v125, v127, 16, v126
    s_waitcnt lgkmcnt(2)
    v_bitop3_b32 v115, v115, v118, v119 bitop3:0xfe
    v_lshl_add_u64 v[124:125], v[124:125], 0, s[36:37]
    v_cmpx_le_u32 vcc, 0x1000000, v55
    ds_add_rtn_u64 v[118:119], v123, v[124:125] offset:54272
    s_mov_b64 exec, -1
    v_ashrrev_i32 v122, 5, v56
    v_lshlrev_b16 v123, 2, v56
    v_lshlrev_b32 v124, 16, v16
    v_bitop3_b32 v122, v122, v113, v113 bitop3:0x0c
    v_and_b32 v125, 0xffff0000, v16
    v_lshlrev_b32 v126, 16, v17
    v_mul_f32 v122, v114, v122
    v_and_b32 v127, 0xffff0000, v17
    v_add_u32 v123, v123, v123
    v_pk_fma_f32 v[124:125], v[124:125], v[122:123], s[34:35] op_sel_hi:[1,0,1]
    v_pk_fma_f32 v[126:127], v[126:127], v[122:123], s[34:35] op_sel_hi:[1,0,1]
    v_lshl_add_u32 v124, v125, 16, v124
    v_lshl_add_u32 v125, v127, 16, v126
    s_waitcnt lgkmcnt(2)
    v_bitop3_b32 v115, v115, v120, v121 bitop3:0xfe
    v_lshl_add_u64 v[124:125], v[124:125], 0, s[36:37]
    v_cmpx_le_u32 vcc, 0x1000000, v56
    ds_add_rtn_u64 v[120:121], v123, v[124:125] offset:54272
    s_mov_b64 exec, -1
    s_cmp_lt_u32 s15, 8
    s_cbranch_scc1 p2_nad0
    s_waitcnt lgkmcnt(15)
    v_ashrrev_i32 v122, 5, v57
    v_lshlrev_b16 v123, 2, v57
    v_lshlrev_b32 v124, 16, v18
    v_bitop3_b32 v122, v122, v113, v113 bitop3:0x0c
    v_and_b32 v125, 0xffff0000, v18
    v_lshlrev_b32 v126, 16, v19
    v_mul_f32 v122, v114, v122
    v_and_b32 v127, 0xffff0000, v19
    v_add_u32 v123, v123, v123
    v_pk_fma_f32 v[124:125], v[124:125], v[122:123], s[34:35] op_sel_hi:[1,0,1]
    v_pk_fma_f32 v[126:127], v[126:127], v[122:123], s[34:35] op_sel_hi:[1,0,1]
    v_lshl_add_u32 v124, v125, 16, v124
    v_lshl_add_u32 v125, v127, 16, v126
    s_waitcnt lgkmcnt(2)
    v_bitop3_b32 v115, v115, v116, v117 bitop3:0xfe
    v_lshl_add_u64 v[124:125], v[124:125], 0, s[36:37]
    v_cmpx_le_u32 vcc, 0x1000000, v57
    ds_add_rtn_u64 v[116:117], v123, v[124:125] offset:54272
    s_mov_b64 exec, -1
    v_ashrrev_i32 v122, 5, v58
    v_lshlrev_b16 v123, 2, v58
    v_lshlrev_b32 v124, 16, v20
    v_bitop3_b32 v122, v122, v113, v113 bitop3:0x0c
    v_and_b32 v125, 0xffff0000, v20
    v_lshlrev_b32 v126, 16, v21
    v_mul_f32 v122, v114, v122
    v_and_b32 v127, 0xffff0000, v21
    v_add_u32 v123, v123, v123
    v_pk_fma_f32 v[124:125], v[124:125], v[122:123], s[34:35] op_sel_hi:[1,0,1]
    v_pk_fma_f32 v[126:127], v[126:127], v[122:123], s[34:35] op_sel_hi:[1,0,1]
    v_lshl_add_u32 v124, v125, 16, v124
    v_lshl_add_u32 v125, v127, 16, v126
    s_waitcnt lgkmcnt(2)
    v_bitop3_b32 v115, v115, v118, v119 bitop3:0xfe
    v_lshl_add_u64 v[124:125], v[124:125], 0, s[36:37]
    v_cmpx_le_u32 vcc, 0x1000000, v58
    ds_add_rtn_u64 v[118:119], v123, v[124:125] offset:54272
    s_mov_b64 exec, -1
    v_ashrrev_i32 v122, 5, v59
    v_lshlrev_b16 v123, 2, v59
    v_lshlrev_b32 v124, 16, v22
    v_bitop3_b32 v122, v122, v113, v113 bitop3:0x0c
    v_and_b32 v125, 0xffff0000, v22
    v_lshlrev_b32 v126, 16, v23
    v_mul_f32 v122, v114, v122
    v_and_b32 v127, 0xffff0000, v23
    v_add_u32 v123, v123, v123
    v_pk_fma_f32 v[124:125], v[124:125], v[122:123], s[34:35] op_sel_hi:[1,0,1]
    v_pk_fma_f32 v[126:127], v[126:127], v[122:123], s[34:35] op_sel_hi:[1,0,1]
    v_lshl_add_u32 v124, v125, 16, v124
    v_lshl_add_u32 v125, v127, 16, v126
    s_waitcnt lgkmcnt(2)
    v_bitop3_b32 v115, v115, v120, v121 bitop3:0xfe
    v_lshl_add_u64 v[124:125], v[124:125], 0, s[36:37]
    v_cmpx_le_u32 vcc, 0x1000000, v59
    ds_add_rtn_u64 v[120:121], v123, v[124:125] offset:54272
    s_mov_b64 exec, -1
p2_nad0:
    s_waitcnt lgkmcnt(15)
    v_ashrrev_i32 v122, 5, v60
    v_lshlrev_b16 v123, 2, v60
    v_lshlrev_b32 v124, 16, v24
    v_bitop3_b32 v122, v122, v113, v113 bitop3:0x0c
    v_and_b32 v125, 0xffff0000, v24
    v_lshlrev_b32 v126, 16, v25
    v_mul_f32 v122, v114, v122
    v_and_b32 v127, 0xffff0000, v25
    v_add_u32 v123, v123, v123
    v_pk_fma_f32 v[124:125], v[124:125], v[122:123], s[34:35] op_sel_hi:[1,0,1]
    v_pk_fma_f32 v[126:127], v[126:127], v[122:123], s[34:35] op_sel_hi:[1,0,1]
    v_lshl_add_u32 v124, v125, 16, v124
    v_lshl_add_u32 v125, v127, 16, v126
    s_waitcnt lgkmcnt(2)
    v_bitop3_b32 v115, v115, v116, v117 bitop3:0xfe
    v_lshl_add_u64 v[124:125], v[124:125], 0, s[36:37]
    v_cmpx_le_u32 vcc, 0x1000000, v60
    ds_add_rtn_u64 v[116:117], v123, v[124:125] offset:54272
    s_mov_b64 exec, -1
    v_ashrrev_i32 v122, 5, v61
    v_lshlrev_b16 v123, 2, v61
    v_lshlrev_b32 v124, 16, v26
    v_bitop3_b32 v122, v122, v113, v113 bitop3:0x0c
    v_and_b32 v125, 0xffff0000, v26
    v_lshlrev_b32 v126, 16, v27
    v_mul_f32 v122, v114, v122
    v_and_b32 v127, 0xffff0000, v27
    v_add_u32 v123, v123, v123
    v_pk_fma_f32 v[124:125], v[124:125], v[122:123], s[34:35] op_sel_hi:[1,0,1]
    v_pk_fma_f32 v[126:127], v[126:127], v[122:123], s[34:35] op_sel_hi:[1,0,1]
    v_lshl_add_u32 v124, v125, 16, v124
    v_lshl_add_u32 v125, v127, 16, v126
    s_waitcnt lgkmcnt(2)
    v_bitop3_b32 v115, v115, v118, v119 bitop3:0xfe
    v_lshl_add_u64 v[124:125], v[124:125], 0, s[36:37]
    v_cmpx_le_u32 vcc, 0x1000000, v61
    ds_add_rtn_u64 v[118:119], v123, v[124:125] offset:54272
    s_mov_b64 exec, -1
    v_ashrrev_i32 v122, 5, v62
    v_lshlrev_b16 v123, 2, v62
    v_lshlrev_b32 v124, 16, v28
    v_bitop3_b32 v122, v122, v113, v113 bitop3:0x0c
    v_and_b32 v125, 0xffff0000, v28
    v_lshlrev_b32 v126, 16, v29
    v_mul_f32 v122, v114, v122
    v_and_b32 v127, 0xffff0000, v29
    v_add_u32 v123, v123, v123
    v_pk_fma_f32 v[124:125], v[124:125], v[122:123], s[34:35] op_sel_hi:[1,0,1]
    v_pk_fma_f32 v[126:127], v[126:127], v[122:123], s[34:35] op_sel_hi:[1,0,1]
    v_lshl_add_u32 v124, v125, 16, v124
    v_lshl_add_u32 v125, v127, 16, v126
    s_waitcnt lgkmcnt(2)
    v_bitop3_b32 v115, v115, v120, v121 bitop3:0xfe
    v_lshl_add_u64 v[124:125], v[124:125], 0, s[36:37]
    v_cmpx_le_u32 vcc, 0x1000000, v62
    ds_add_rtn_u64 v[120:121], v123, v[124:125] offset:54272
    s_mov_b64 exec, -1
    s_waitcnt lgkmcnt(15)
    v_ashrrev_i32 v122, 5, v63
    v_lshlrev_b16 v123, 2, v63
    v_lshlrev_b32 v124, 16, v30
    v_bitop3_b32 v122, v122, v113, v113 bitop3:0x0c
    v_and_b32 v125, 0xffff0000, v30
    v_lshlrev_b32 v126, 16, v31
    v_mul_f32 v122, v114, v122
    v_and_b32 v127, 0xffff0000, v31
    v_add_u32 v123, v123, v123
    v_pk_fma_f32 v[124:125], v[124:125], v[122:123], s[34:35] op_sel_hi:[1,0,1]
    v_pk_fma_f32 v[126:127], v[126:127], v[122:123], s[34:35] op_sel_hi:[1,0,1]
    v_lshl_add_u32 v124, v125, 16, v124
    v_lshl_add_u32 v125, v127, 16, v126
    s_waitcnt lgkmcnt(2)
    v_bitop3_b32 v115, v115, v116, v117 bitop3:0xfe
    v_lshl_add_u64 v[124:125], v[124:125], 0, s[36:37]
    v_cmpx_le_u32 vcc, 0x1000000, v63
    ds_add_rtn_u64 v[116:117], v123, v[124:125] offset:54272
    s_mov_b64 exec, -1
    v_ashrrev_i32 v122, 5, v64
    v_lshlrev_b16 v123, 2, v64
    v_lshlrev_b32 v124, 16, v32
    v_bitop3_b32 v122, v122, v113, v113 bitop3:0x0c
    v_and_b32 v125, 0xffff0000, v32
    v_lshlrev_b32 v126, 16, v33
    v_mul_f32 v122, v114, v122
    v_and_b32 v127, 0xffff0000, v33
    v_add_u32 v123, v123, v123
    v_pk_fma_f32 v[124:125], v[124:125], v[122:123], s[34:35] op_sel_hi:[1,0,1]
    v_pk_fma_f32 v[126:127], v[126:127], v[122:123], s[34:35] op_sel_hi:[1,0,1]
    v_lshl_add_u32 v124, v125, 16, v124
    v_lshl_add_u32 v125, v127, 16, v126
    s_waitcnt lgkmcnt(2)
    v_bitop3_b32 v115, v115, v118, v119 bitop3:0xfe
    v_lshl_add_u64 v[124:125], v[124:125], 0, s[36:37]
    v_cmpx_le_u32 vcc, 0x1000000, v64
    ds_add_rtn_u64 v[118:119], v123, v[124:125] offset:54272
    s_mov_b64 exec, -1
    v_ashrrev_i32 v122, 5, v65
    v_lshlrev_b16 v123, 2, v65
    v_lshlrev_b32 v124, 16, v34
    v_bitop3_b32 v122, v122, v113, v113 bitop3:0x0c
    v_and_b32 v125, 0xffff0000, v34
    v_lshlrev_b32 v126, 16, v35
    v_mul_f32 v122, v114, v122
    v_and_b32 v127, 0xffff0000, v35
    v_add_u32 v123, v123, v123
    v_pk_fma_f32 v[124:125], v[124:125], v[122:123], s[34:35] op_sel_hi:[1,0,1]
    v_pk_fma_f32 v[126:127], v[126:127], v[122:123], s[34:35] op_sel_hi:[1,0,1]
    v_lshl_add_u32 v124, v125, 16, v124
    v_lshl_add_u32 v125, v127, 16, v126
    s_waitcnt lgkmcnt(2)
    v_bitop3_b32 v115, v115, v120, v121 bitop3:0xfe
    v_lshl_add_u64 v[124:125], v[124:125], 0, s[36:37]
    v_cmpx_le_u32 vcc, 0x1000000, v65
    ds_add_rtn_u64 v[120:121], v123, v[124:125] offset:54272
    s_mov_b64 exec, -1
    s_waitcnt lgkmcnt(15)
    v_ashrrev_i32 v122, 5, v66
    v_lshlrev_b16 v123, 2, v66
    v_lshlrev_b32 v124, 16, v36
    v_bitop3_b32 v122, v122, v113, v113 bitop3:0x0c
    v_and_b32 v125, 0xffff0000, v36
    v_lshlrev_b32 v126, 16, v37
    v_mul_f32 v122, v114, v122
    v_and_b32 v127, 0xffff0000, v37
    v_add_u32 v123, v123, v123
    v_pk_fma_f32 v[124:125], v[124:125], v[122:123], s[34:35] op_sel_hi:[1,0,1]
    v_pk_fma_f32 v[126:127], v[126:127], v[122:123], s[34:35] op_sel_hi:[1,0,1]
    v_lshl_add_u32 v124, v125, 16, v124
    v_lshl_add_u32 v125, v127, 16, v126
    s_waitcnt lgkmcnt(2)
    v_bitop3_b32 v115, v115, v116, v117 bitop3:0xfe
    v_lshl_add_u64 v[124:125], v[124:125], 0, s[36:37]
    v_cmpx_le_u32 vcc, 0x1000000, v66
    ds_add_rtn_u64 v[116:117], v123, v[124:125] offset:54272
    s_mov_b64 exec, -1
    v_ashrrev_i32 v122, 5, v67
    v_lshlrev_b16 v123, 2, v67
    v_lshlrev_b32 v124, 16, v38
    v_bitop3_b32 v122, v122, v113, v113 bitop3:0x0c
    v_and_b32 v125, 0xffff0000, v38
    v_lshlrev_b32 v126, 16, v39
    v_mul_f32 v122, v114, v122
    v_and_b32 v127, 0xffff0000, v39
    v_add_u32 v123, v123, v123
    v_pk_fma_f32 v[124:125], v[124:125], v[122:123], s[34:35] op_sel_hi:[1,0,1]
    v_pk_fma_f32 v[126:127], v[126:127], v[122:123], s[34:35] op_sel_hi:[1,0,1]
    v_lshl_add_u32 v124, v125, 16, v124
    v_lshl_add_u32 v125, v127, 16, v126
    s_waitcnt lgkmcnt(2)
    v_bitop3_b32 v115, v115, v118, v119 bitop3:0xfe
    v_lshl_add_u64 v[124:125], v[124:125], 0, s[36:37]
    v_cmpx_le_u32 vcc, 0x1000000, v67
    ds_add_rtn_u64 v[118:119], v123, v[124:125] offset:54272
    s_mov_b64 exec, -1
    v_ashrrev_i32 v122, 5, v68
    v_lshlrev_b16 v123, 2, v68
    v_lshlrev_b32 v124, 16, v40
    v_bitop3_b32 v122, v122, v113, v113 bitop3:0x0c
    v_and_b32 v125, 0xffff0000, v40
    v_lshlrev_b32 v126, 16, v41
    v_mul_f32 v122, v114, v122
    v_and_b32 v127, 0xffff0000, v41
    v_add_u32 v123, v123, v123
    v_pk_fma_f32 v[124:125], v[124:125], v[122:123], s[34:35] op_sel_hi:[1,0,1]
    v_pk_fma_f32 v[126:127], v[126:127], v[122:123], s[34:35] op_sel_hi:[1,0,1]
    v_lshl_add_u32 v124, v125, 16, v124
    v_lshl_add_u32 v125, v127, 16, v126
    s_waitcnt lgkmcnt(2)
    v_bitop3_b32 v115, v115, v120, v121 bitop3:0xfe
    v_lshl_add_u64 v[124:125], v[124:125], 0, s[36:37]
    v_cmpx_le_u32 vcc, 0x1000000, v68
    ds_add_rtn_u64 v[120:121], v123, v[124:125] offset:54272
    s_mov_b64 exec, -1
    s_waitcnt lgkmcnt(15)
    v_ashrrev_i32 v122, 5, v69
    v_lshlrev_b16 v123, 2, v69
    v_lshlrev_b32 v124, 16, v42
    v_bitop3_b32 v122, v122, v113, v113 bitop3:0x0c
    v_and_b32 v125, 0xffff0000, v42
    v_lshlrev_b32 v126, 16, v43
    v_mul_f32 v122, v114, v122
    v_and_b32 v127, 0xffff0000, v43
    v_add_u32 v123, v123, v123
    v_pk_fma_f32 v[124:125], v[124:125], v[122:123], s[34:35] op_sel_hi:[1,0,1]
    v_pk_fma_f32 v[126:127], v[126:127], v[122:123], s[34:35] op_sel_hi:[1,0,1]
    v_lshl_add_u32 v124, v125, 16, v124
    v_lshl_add_u32 v125, v127, 16, v126
    s_waitcnt lgkmcnt(2)
    v_bitop3_b32 v115, v115, v116, v117 bitop3:0xfe
    v_lshl_add_u64 v[124:125], v[124:125], 0, s[36:37]
    v_cmpx_le_u32 vcc, 0x1000000, v69
    ds_add_rtn_u64 v[116:117], v123, v[124:125] offset:54272
    s_mov_b64 exec, -1
    v_ashrrev_i32 v122, 5, v70
    v_lshlrev_b16 v123, 2, v70
    v_lshlrev_b32 v124, 16, v44
    v_bitop3_b32 v122, v122, v113, v113 bitop3:0x0c
    v_and_b32 v125, 0xffff0000, v44
    v_lshlrev_b32 v126, 16, v45
    v_mul_f32 v122, v114, v122
    v_and_b32 v127, 0xffff0000, v45
    v_add_u32 v123, v123, v123
    v_pk_fma_f32 v[124:125], v[124:125], v[122:123], s[34:35] op_sel_hi:[1,0,1]
    v_pk_fma_f32 v[126:127], v[126:127], v[122:123], s[34:35] op_sel_hi:[1,0,1]
    v_lshl_add_u32 v124, v125, 16, v124
    v_lshl_add_u32 v125, v127, 16, v126
    s_waitcnt lgkmcnt(2)
    v_bitop3_b32 v115, v115, v118, v119 bitop3:0xfe
    v_lshl_add_u64 v[124:125], v[124:125], 0, s[36:37]
    v_cmpx_le_u32 vcc, 0x1000000, v70
    ds_add_rtn_u64 v[118:119], v123, v[124:125] offset:54272
    s_mov_b64 exec, -1
    v_ashrrev_i32 v122, 5, v71
    v_lshlrev_b16 v123, 2, v71
    v_lshlrev_b32 v124, 16, v46
    v_bitop3_b32 v122, v122, v113, v113 bitop3:0x0c
    v_and_b32 v125, 0xffff0000, v46
    v_lshlrev_b32 v126, 16, v47
    v_mul_f32 v122, v114, v122
    v_and_b32 v127, 0xffff0000, v47
    v_add_u32 v123, v123, v123
    v_pk_fma_f32 v[124:125], v[124:125], v[122:123], s[34:35] op_sel_hi:[1,0,1]
    v_pk_fma_f32 v[126:127], v[126:127], v[122:123], s[34:35] op_sel_hi:[1,0,1]
    v_lshl_add_u32 v124, v125, 16, v124
    v_lshl_add_u32 v125, v127, 16, v126
    s_waitcnt lgkmcnt(2)
    v_bitop3_b32 v115, v115, v120, v121 bitop3:0xfe
    v_lshl_add_u64 v[124:125], v[124:125], 0, s[36:37]
    v_cmpx_le_u32 vcc, 0x1000000, v71
    ds_add_rtn_u64 v[120:121], v123, v[124:125] offset:54272
    s_mov_b64 exec, -1
    s_branch p2_fin
p2_topf:
    s_cmp_eq_u32 s60, 10
    s_cbranch_scc1 p2_drain1
    s_setprio 3
    v_cmpx_gt_i16 vcc, 0, v48
    ds_read_b64 v[0:1], v0
    s_mov_b64 exec, -1
    v_cmpx_gt_i16 vcc, 0, v49
    ds_read_b64 v[2:3], v2
    s_mov_b64 exec, -1
    v_cmpx_gt_i16 vcc, 0, v50
    ds_read_b64 v[4:5], v4
    s_mov_b64 exec, -1
    v_cmpx_gt_i16 vcc, 0, v51
    ds_read_b64 v[6:7], v6
    s_mov_b64 exec, -1
    v_cmpx_gt_i16 vcc, 0, v52
    ds_read_b64 v[8:9], v8
    s_mov_b64 exec, -1
    v_cmpx_gt_i16 vcc, 0, v53
    ds_read_b64 v[10:11], v10
    s_mov_b64 exec, -1
    v_cmpx_gt_i16 vcc, 0, v54
    ds_read_b64 v[12:13], v12
    s_mov_b64 exec, -1
    v_cmpx_gt_i16 vcc, 0, v55
    ds_read_b64 v[14:15], v14
    s_mov_b64 exec, -1
    v_cmpx_gt_i16 vcc, 0, v56
    ds_read_b64 v[16:17], v16
    s_mov_b64 exec, -1
    s_cmp_lt_u32 s15, 8
    s_cbranch_scc1 p2_g1r23
    v_cmpx_gt_i16 vcc, 0, v57
    ds_read_b64 v[18:19], v18
    s_mov_b64 exec, -1
    v_cmpx_gt_i16 vcc, 0, v58
    ds_read_b64 v[20:21], v20
    s_mov_b64 exec, -1
    v_cmpx_gt_i16 vcc, 0, v59
    ds_read_b64 v[22:23], v22
    s_mov_b64 exec, -1
p2_g1r23:
    s_cmp_ge_u32 s10, 9
    s_cbranch_scc1 p2_nm1m0a
    v_lshrrev_b32 v84, 1, v112
    s_add_u32 s44, s20, s42
    buffer_load_dwordx2 v[84:85], v84, s[4:7], s44 offen
p2_nm1m0a:
    buffer_load_dwordx4 v[72:75], v112, s[4:7], s20 offen offset:0
    buffer_load_dwordx4 v[76:79], v112, s[4:7], s20 offen offset:1024
    buffer_load_dwordx4 v[80:83], v112, s[4:7], s20 offen offset:2048
    v_cmpx_gt_i16 vcc, 0, v60
    ds_read_b64 v[24:25], v24
    s_mov_b64 exec, -1
    v_cmpx_gt_i16 vcc, 0, v61
    ds_read_b64 v[26:27], v26
    s_mov_b64 exec, -1
    v_cmpx_gt_i16 vcc, 0, v62
    ds_read_b64 v[28:29], v28
    s_mov_b64 exec, -1
    v_cmpx_gt_i16 vcc, 0, v63
    ds_read_b64 v[30:31], v30
    s_mov_b64 exec, -1
    v_cmpx_gt_i16 vcc, 0, v64
    ds_read_b64 v[32:33], v32
    s_mov_b64 exec, -1
    v_cmpx_gt_i16 vcc, 0, v65
    ds_read_b64 v[34:35], v34
    s_mov_b64 exec, -1
    v_cmpx_gt_i16 vcc, 0, v66
    ds_read_b64 v[36:37], v36
    s_mov_b64 exec, -1
    v_cmpx_gt_i16 vcc, 0, v67
    ds_read_b64 v[38:39], v38
    s_mov_b64 exec, -1
    v_cmpx_gt_i16 vcc, 0, v68
    ds_read_b64 v[40:41], v40
    s_mov_b64 exec, -1
    v_cmpx_gt_i16 vcc, 0, v69
    ds_read_b64 v[42:43], v42
    s_mov_b64 exec, -1
    v_cmpx_gt_i16 vcc, 0, v70
    ds_read_b64 v[44:45], v44
    s_mov_b64 exec, -1
    v_cmpx_gt_i16 vcc, 0, v71
    ds_read_b64 v[46:47], v46
    s_mov_b64 exec, -1
    s_setprio 2
    s_waitcnt lgkmcnt(15)
    v_ashrrev_i32 v122, 5, v48
    v_lshlrev_b16 v123, 2, v48
    v_cndmask_b32 v126, v0, v1, s[66:67]
    v_bitop3_b32 v122, v122, v113, v113 bitop3:0x0c
    v_lshlrev_b32 v124, 16, v126
    v_mul_f32 v122, v114, v122
    v_and_b32 v125, 0xffff0000, v126
    v_add_u32 v123, v123, v123
    v_mul_f32 v124, v122, v124
    v_mul_f32 v125, v122, v125
    v_cmpx_le_u32 vcc, 0x1000000, v48
    ds_add_f32 v123, v124 offset:54272
    ds_add_f32 v123, v125 offset:54276
    s_mov_b64 exec, -1
    v_ashrrev_i32 v122, 5, v49
    v_lshlrev_b16 v123, 2, v49
    v_cndmask_b32 v126, v2, v3, s[66:67]
    v_bitop3_b32 v122, v122, v113, v113 bitop3:0x0c
    v_lshlrev_b32 v124, 16, v126
    v_mul_f32 v122, v114, v122
    v_and_b32 v125, 0xffff0000, v126
    v_add_u32 v123, v123, v123
    v_mul_f32 v124, v122, v124
    v_mul_f32 v125, v122, v125
    v_cmpx_le_u32 vcc, 0x1000000, v49
    ds_add_f32 v123, v124 offset:54272
    ds_add_f32 v123, v125 offset:54276
    s_mov_b64 exec, -1
    v_ashrrev_i32 v122, 5, v50
    v_lshlrev_b16 v123, 2, v50
    v_cndmask_b32 v126, v4, v5, s[66:67]
    v_bitop3_b32 v122, v122, v113, v113 bitop3:0x0c
    v_lshlrev_b32 v124, 16, v126
    v_mul_f32 v122, v114, v122
    v_and_b32 v125, 0xffff0000, v126
    v_add_u32 v123, v123, v123
    v_mul_f32 v124, v122, v124
    v_mul_f32 v125, v122, v125
    v_cmpx_le_u32 vcc, 0x1000000, v50
    ds_add_f32 v123, v124 offset:54272
    ds_add_f32 v123, v125 offset:54276
    s_mov_b64 exec, -1
    v_bfe_u32 v0, v102, 14, 4
    v_lshrrev_b32 v1, 18, v102
    v_and_b32 v102, 0x3fff, v102
    v_mad_u32_u24 v0, v0, s63, v1
    v_mad_u32_u24 v102, v0, s65, v102
    buffer_load_dwordx4 v[0:3], v102, s[68:71], 0 offen
    s_setprio 1
    s_waitcnt lgkmcnt(15)
    v_ashrrev_i32 v122, 5, v51
    v_lshlrev_b16 v123, 2, v51
    v_cndmask_b32 v126, v6, v7, s[66:67]
    v_bitop3_b32 v122, v122, v113, v113 bitop3:0x0c
    v_lshlrev_b32 v124, 16, v126
    v_mul_f32 v122, v114, v122
    v_and_b32 v125, 0xffff0000, v126
    v_add_u32 v123, v123, v123
    v_mul_f32 v124, v122, v124
    v_mul_f32 v125, v122, v125
    v_cmpx_le_u32 vcc, 0x1000000, v51
    ds_add_f32 v123, v124 offset:54272
    ds_add_f32 v123, v125 offset:54276
    s_mov_b64 exec, -1
    v_ashrrev_i32 v122, 5, v52
    v_lshlrev_b16 v123, 2, v52
    v_cndmask_b32 v126, v8, v9, s[66:67]
    v_bitop3_b32 v122, v122, v113, v113 bitop3:0x0c
    v_lshlrev_b32 v124, 16, v126
    v_mul_f32 v122, v114, v122
    v_and_b32 v125, 0xffff0000, v126
    v_add_u32 v123, v123, v123
    v_mul_f32 v124, v122, v124
    v_mul_f32 v125, v122, v125
    v_cmpx_le_u32 vcc, 0x1000000, v52
    ds_add_f32 v123, v124 offset:54272
    ds_add_f32 v123, v125 offset:54276
    s_mov_b64 exec, -1
    v_ashrrev_i32 v122, 5, v53
    v_lshlrev_b16 v123, 2, v53
    v_cndmask_b32 v126, v10, v11, s[66:67]
    v_bitop3_b32 v122, v122, v113, v113 bitop3:0x0c
    v_lshlrev_b32 v124, 16, v126
    v_mul_f32 v122, v114, v122
    v_and_b32 v125, 0xffff0000, v126
    v_add_u32 v123, v123, v123
    v_mul_f32 v124, v122, v124
    v_mul_f32 v125, v122, v125
    v_cmpx_le_u32 vcc, 0x1000000, v53
    ds_add_f32 v123, v124 offset:54272
    ds_add_f32 v123, v125 offset:54276
    s_mov_b64 exec, -1
    v_bfe_u32 v6, v103, 14, 4
    v_lshrrev_b32 v7, 18, v103
    v_and_b32 v103, 0x3fff, v103
    v_mad_u32_u24 v6, v6, s63, v7
    v_mad_u32_u24 v103, v6, s65, v103
    buffer_load_dwordx4 v[6:9], v103, s[68:71], 0 offen
    s_waitcnt lgkmcnt(12)
    s_barrier
    s_setprio 3
    s_waitcnt vmcnt(5)
    s_mov_b32 m0, s23
    v_mov_b32 v53, 0
    s_movk_i32 s44, 512
    v_sub_u32_sdwa v4, v111, v110 dst_sel:DWORD dst_unused:UNUSED_PAD src0_sel:WORD_0 src1_sel:WORD_0
    v_sub_u32_sdwa v5, v111, v110 dst_sel:DWORD dst_unused:UNUSED_PAD src0_sel:WORD_1 src1_sel:WORD_1
    v_med3_i32 v4, v4, 0, s44
    v_med3_i32 v5, v5, 0, s44
    v_add_u32 v48, v4, v5
    ds_write_addtid_b32 v53 offset:0
    ds_write_addtid_b32 v53 offset:256
    ds_write_addtid_b32 v53 offset:512
    ds_write_addtid_b32 v53 offset:768
    ds_write_addtid_b32 v53 offset:1024
    ds_write_addtid_b32 v53 offset:1280
    ds_write_addtid_b32 v53 offset:1536
    ds_write_addtid_b32 v53 offset:1792
    v_bfe_i32 v53, v112, 6, 1
    v_lshrrev_b32 v49, 6, v112
    v_bitop3_b32 v53, v53, 15, s10 bitop3:0x6a
    v_lshl_or_b32 v49, v49, 4, v53
    v_and_b32 v53, 0x30, v112
    v_lshl_or_b32 v53, v49, 6, v53
    v_lshlrev_b32 v53, 15, v53
    s_nop 1
    v_add_u32_dpp v48, v48, v48 row_shr:1 row_mask:0xf bank_mask:0xf bound_ctrl:0
    s_nop 1
    v_add_u32_dpp v48, v48, v48 row_shr:2 row_mask:0xf bank_mask:0xf bound_ctrl:0
    s_nop 1
    v_add_u32_dpp v48, v48, v48 row_shr:4 row_mask:0xf bank_mask:0xf bound_ctrl:0
    s_nop 1
    v_add_u32_dpp v48, v48, v48 row_shr:8 row_mask:0xf bank_mask:0xf bound_ctrl:0
    s_nop 1
    v_add_u32_dpp v48, v48, v48 row_bcast:15 row_mask:0xa bank_mask:0xf
    s_nop 1
    v_add_u32_dpp v48, v48, v48 row_bcast:31 row_mask:0xc bank_mask:0xf
    s_nop 1
    s_nop 0
    v_readlane_b32 s38, v48, 63
    v_sub_u32 v50, v48, v5
    v_sub_u32 v49, v50, v4
    v_writelane_b32 v5, 1, 63
    v_sub_u32 v10, 512, v49
    v_mad_u32_u16 v51, v110, 16, v53
    v_lshl_add_u32 v51, v10, 4, v51
    v_med3_i32 v10, v10, 0, v4
    v_lshl_add_u32 v49, v49, 2, s23
    v_sub_u32 v11, 512, v50
    v_mad_u32_u16 v52, v110, 16, v53 op_sel:[1,0,0,0]
    v_add_u32 v52, 262144, v52
    s_mov_b32 s44, 0x1fffc000
    v_writelane_b32 v52, s44, 63
    v_lshl_add_u32 v52, v11, 4, v52
    v_med3_i32 v11, v11, 0, v5
    v_lshl_add_u32 v50, v50, 2, s23
    v_lshl_add_u32 v48, v11, 16, v10
    v_add_u32 v110, v110, v48
    s_min_u32 s17, s38, 512
    s_add_u32 s17, s17, 63
    s_lshr_b32 s17, s17, 6
    v_cmpx_lt_i32 vcc, 0, v10
    ds_write_b32 v49, v51
    s_mov_b64 exec, -1
    v_cmpx_lt_i32 vcc, 0, v11
    ds_write_b32 v50, v52
    s_mov_b64 exec, -1
    s_cmp_lt_u32 s38, 512
    s_cbranch_scc1 p2_nomore1x
    v_cmp_lt_u32_sdwa s[44:45], v110, v111 src0_sel:WORD_0 src1_sel:WORD_0
    v_cmp_lt_u32_sdwa s[46:47], v110, v111 src0_sel:WORD_1 src1_sel:WORD_1
    s_nop 0
    s_or_b64 s[44:45], s[44:45], s[46:47]
    s_cbranch_scc0 p2_nomore1x
    v_mov_b32 v49, s19
    v_mov_b32 v50, 1
    ds_write_b32 v49, v50 offset:53760
p2_nomore1x:
    s_setprio 2
    s_waitcnt lgkmcnt(15)
    v_ashrrev_i32 v122, 5, v54
    v_lshlrev_b16 v123, 2, v54
    v_cndmask_b32 v126, v12, v13, s[66:67]
    v_bitop3_b32 v122, v122, v113, v113 bitop3:0x0c
    v_lshlrev_b32 v124, 16, v126
    v_mul_f32 v122, v114, v122
    v_and_b32 v125, 0xffff0000, v126
    v_add_u32 v123, v123, v123
    v_mul_f32 v124, v122, v124
    v_mul_f32 v125, v122, v125
    v_cmpx_le_u32 vcc, 0x1000000, v54
    ds_add_f32 v123, v124 offset:54272
    ds_add_f32 v123, v125 offset:54276
    s_mov_b64 exec, -1
    v_ashrrev_i32 v122, 5, v55
    v_lshlrev_b16 v123, 2, v55
    v_cndmask_b32 v126, v14, v15, s[66:67]
    v_bitop3_b32 v122, v122, v113, v113 bitop3:0x0c
    v_lshlrev_b32 v124, 16, v126
    v_mul_f32 v122, v114, v122
    v_and_b32 v125, 0xffff0000, v126
    v_add_u32 v123, v123, v123
    v_mul_f32 v124, v122, v124
    v_mul_f32 v125, v122, v125
    v_cmpx_le_u32 vcc, 0x1000000, v55
    ds_add_f32 v123, v124 offset:54272
    ds_add_f32 v123, v125 offset:54276
    s_mov_b64 exec, -1
    v_ashrrev_i32 v122, 5, v56
    v_lshlrev_b16 v123, 2, v56
    v_cndmask_b32 v126, v16, v17, s[66:67]
    v_bitop3_b32 v122, v122, v113, v113 bitop3:0x0c
    v_lshlrev_b32 v124, 16, v126
    v_mul_f32 v122, v114, v122
    v_and_b32 v125, 0xffff0000, v126
    v_add_u32 v123, v123, v123
    v_mul_f32 v124, v122, v124
    v_mul_f32 v125, v122, v125
    v_cmpx_le_u32 vcc, 0x1000000, v56
    ds_add_f32 v123, v124 offset:54272
    ds_add_f32 v123, v125 offset:54276
    s_mov_b64 exec, -1
    v_bfe_u32 v12, v104, 14, 4
    v_lshrrev_b32 v13, 18, v104
    v_and_b32 v104, 0x3fff, v104
    v_mad_u32_u24 v12, v12, s63, v13
    v_mad_u32_u24 v104, v12, s65, v104
    buffer_load_dwordx4 v[12:15], v104, s[68:71], 0 offen
    s_cmp_lt_u32 s15, 8
    s_cbranch_scc1 p2_na1a3
    s_waitcnt lgkmcnt(15)
    v_ashrrev_i32 v122, 5, v57
    v_lshlrev_b16 v123, 2, v57
    v_cndmask_b32 v126, v18, v19, s[66:67]
    v_bitop3_b32 v122, v122, v113, v113 bitop3:0x0c
    v_lshlrev_b32 v124, 16, v126
    v_mul_f32 v122, v114, v122
    v_and_b32 v125, 0xffff0000, v126
    v_add_u32 v123, v123, v123
    v_mul_f32 v124, v122, v124
    v_mul_f32 v125, v122, v125
    v_cmpx_le_u32 vcc, 0x1000000, v57
    ds_add_f32 v123, v124 offset:54272
    ds_add_f32 v123, v125 offset:54276
    s_mov_b64 exec, -1
    v_ashrrev_i32 v122, 5, v58
    v_lshlrev_b16 v123, 2, v58
    v_cndmask_b32 v126, v20, v21, s[66:67]
    v_bitop3_b32 v122, v122, v113, v113 bitop3:0x0c
    v_lshlrev_b32 v124, 16, v126
    v_mul_f32 v122, v114, v122
    v_and_b32 v125, 0xffff0000, v126
    v_add_u32 v123, v123, v123
    v_mul_f32 v124, v122, v124
    v_mul_f32 v125, v122, v125
    v_cmpx_le_u32 vcc, 0x1000000, v58
    ds_add_f32 v123, v124 offset:54272
    ds_add_f32 v123, v125 offset:54276
    s_mov_b64 exec, -1
    v_ashrrev_i32 v122, 5, v59
    v_lshlrev_b16 v123, 2, v59
    v_cndmask_b32 v126, v22, v23, s[66:67]
    v_bitop3_b32 v122, v122, v113, v113 bitop3:0x0c
    v_lshlrev_b32 v124, 16, v126
    v_mul_f32 v122, v114, v122
    v_and_b32 v125, 0xffff0000, v126
    v_add_u32 v123, v123, v123
    v_mul_f32 v124, v122, v124
    v_mul_f32 v125, v122, v125
    v_cmpx_le_u32 vcc, 0x1000000, v59
    ds_add_f32 v123, v124 offset:54272
    ds_add_f32 v123, v125 offset:54276
    s_mov_b64 exec, -1
p2_na1a3:
    v_bfe_u32 v18, v105, 14, 4
    v_lshrrev_b32 v19, 18, v105
    v_and_b32 v105, 0x3fff, v105
    v_mad_u32_u24 v18, v18, s63, v19
    v_mad_u32_u24 v105, v18, s65, v105
    buffer_load_dwordx4 v[18:21], v105, s[68:71], 0 offen
    s_mov_b32 m0, s23
    s_nop 0
    ds_read_addtid_b32 v102 offset:1024
    ds_read_addtid_b32 v103 offset:1280
    ds_read_addtid_b32 v104 offset:1536
    ds_read_addtid_b32 v105 offset:1792
    ds_read_addtid_b32 v106 offset:0
    ds_read_addtid_b32 v107 offset:256
    ds_read_addtid_b32 v108 offset:512
    ds_read_addtid_b32 v109 offset:768
    s_waitcnt vmcnt(4)
    s_mov_b32 m0, s24
    s_cmp_ge_u32 s10, 9
    s_cbranch_scc1 p2_st1s0
    ds_write_addtid_b32 v84 offset:49152
    ds_write_addtid_b32 v85 offset:49408
p2_st1s0:
    s_mov_b32 m0, s23
    s_add_u32 s20, s20, 53760
    ds_write_addtid_b32 v72 offset:0
    ds_write_addtid_b32 v73 offset:256
    ds_write_addtid_b32 v74 offset:512
    ds_write_addtid_b32 v75 offset:768
    ds_write_addtid_b32 v76 offset:1024
    ds_write_addtid_b32 v77 offset:1280
    ds_write_addtid_b32 v78 offset:1536
    ds_write_addtid_b32 v79 offset:1792
    ds_write_addtid_b32 v80 offset:2048
    ds_write_addtid_b32 v81 offset:2304
    ds_write_addtid_b32 v82 offset:2560
    ds_write_addtid_b32 v83 offset:2816
    s_setprio 1
    s_waitcnt lgkmcnt(15)
    v_ashrrev_i32 v122, 5, v60
    v_lshlrev_b16 v123, 2, v60
    v_cndmask_b32 v126, v24, v25, s[66:67]
    v_bitop3_b32 v122, v122, v113, v113 bitop3:0x0c
    v_lshlrev_b32 v124, 16, v126
    v_mul_f32 v122, v114, v122
    v_and_b32 v125, 0xffff0000, v126
    v_add_u32 v123, v123, v123
    v_mul_f32 v124, v122, v124
    v_mul_f32 v125, v122, v125
    v_cmpx_le_u32 vcc, 0x1000000, v60
    ds_add_f32 v123, v124 offset:54272
    ds_add_f32 v123, v125 offset:54276
    s_mov_b64 exec, -1
    v_ashrrev_i32 v122, 5, v61
    v_lshlrev_b16 v123, 2, v61
    v_cndmask_b32 v126, v26, v27, s[66:67]
    v_bitop3_b32 v122, v122, v113, v113 bitop3:0x0c
    v_lshlrev_b32 v124, 16, v126
    v_mul_f32 v122, v114, v122
    v_and_b32 v125, 0xffff0000, v126
    v_add_u32 v123, v123, v123
    v_mul_f32 v124, v122, v124
    v_mul_f32 v125, v122, v125
    v_cmpx_le_u32 vcc, 0x1000000, v61
    ds_add_f32 v123, v124 offset:54272
    ds_add_f32 v123, v125 offset:54276
    s_mov_b64 exec, -1
    v_ashrrev_i32 v122, 5, v62
    v_lshlrev_b16 v123, 2, v62
    v_cndmask_b32 v126, v28, v29, s[66:67]
    v_bitop3_b32 v122, v122, v113, v113 bitop3:0x0c
    v_lshlrev_b32 v124, 16, v126
    v_mul_f32 v122, v114, v122
    v_and_b32 v125, 0xffff0000, v126
    v_add_u32 v123, v123, v123
    v_mul_f32 v124, v122, v124
    v_mul_f32 v125, v122, v125
    v_cmpx_le_u32 vcc, 0x1000000, v62
    ds_add_f32 v123, v124 offset:54272
    ds_add_f32 v123, v125 offset:54276
    s_mov_b64 exec, -1
    s_waitcnt vmcnt(16)
    v_perm_b32 v60, v89, v86, s31
    v_perm_b32 v61, v89, v87, s32
    v_perm_b32 v62, v89, v88, s33
    v_lshlrev_b16 v28, 3, v88
    v_lshlrev_b16 v26, 3, v87
    v_lshlrev_b16 v24, 3, v86
    s_waitcnt lgkmcnt(15)
    s_nop 2
    s_nop 1
    v_max_u32_dpp v106, v106, v106 row_shr:1 row_mask:0xf bank_mask:0xf bound_ctrl:0
    v_max_u32_dpp v107, v107, v107 row_shr:1 row_mask:0xf bank_mask:0xf bound_ctrl:0
    s_nop 0
    v_max_u32_dpp v106, v106, v106 row_shr:2 row_mask:0xf bank_mask:0xf bound_ctrl:0
    v_max_u32_dpp v107, v107, v107 row_shr:2 row_mask:0xf bank_mask:0xf bound_ctrl:0
    s_nop 0
    v_max_u32_dpp v106, v106, v106 row_shr:4 row_mask:0xf bank_mask:0xf bound_ctrl:0
    v_max_u32_dpp v107, v107, v107 row_shr:4 row_mask:0xf bank_mask:0xf bound_ctrl:0
    s_nop 0
    v_max_u32_dpp v106, v106, v106 row_shr:8 row_mask:0xf bank_mask:0xf bound_ctrl:0
    v_max_u32_dpp v107, v107, v107 row_shr:8 row_mask:0xf bank_mask:0xf bound_ctrl:0
    s_nop 0
    v_max_u32_dpp v106, v106, v106 row_bcast:15 row_mask:0xa bank_mask:0xf
    v_max_u32_dpp v107, v107, v107 row_bcast:15 row_mask:0xa bank_mask:0xf
    s_nop 0
    v_max_u32_dpp v106, v106, v106 row_bcast:31 row_mask:0xc bank_mask:0xf
    v_max_u32_dpp v107, v107, v107 row_bcast:31 row_mask:0xc bank_mask:0xf
    s_nop 0
    s_nop 0
    v_readlane_b32 s41, v106, 63
    v_add_u32 v106, v106, v112
    v_add_u32 v106, 4294959104, v106
    v_max_u32 v107, s41, v107
    s_nop 0
    v_readlane_b32 s41, v107, 63
    v_add_u32 v107, v107, v112
    v_add_u32 v107, 4294960128, v107
    v_bfe_u32 v86, v106, 14, 4
    v_lshrrev_b32 v87, 18, v106
    v_and_b32 v106, 0x3fff, v106
    v_mad_u32_u24 v86, v86, s63, v87
    v_mad_u32_u24 v106, v86, s65, v106
    buffer_load_dwordx4 v[86:89], v106, s[68:71], 0 offen
    s_setprio 0
    s_waitcnt lgkmcnt(15)
    v_ashrrev_i32 v122, 5, v63
    v_lshlrev_b16 v123, 2, v63
    v_cndmask_b32 v126, v30, v31, s[66:67]
    v_bitop3_b32 v122, v122, v113, v113 bitop3:0x0c
    v_lshlrev_b32 v124, 16, v126
    v_mul_f32 v122, v114, v122
    v_and_b32 v125, 0xffff0000, v126
    v_add_u32 v123, v123, v123
    v_mul_f32 v124, v122, v124
    v_mul_f32 v125, v122, v125
    v_cmpx_le_u32 vcc, 0x1000000, v63
    ds_add_f32 v123, v124 offset:54272
    ds_add_f32 v123, v125 offset:54276
    s_mov_b64 exec, -1
    v_ashrrev_i32 v122, 5, v64
    v_lshlrev_b16 v123, 2, v64
    v_cndmask_b32 v126, v32, v33, s[66:67]
    v_bitop3_b32 v122, v122, v113, v113 bitop3:0x0c
    v_lshlrev_b32 v124, 16, v126
    v_mul_f32 v122, v114, v122
    v_and_b32 v125, 0xffff0000, v126
    v_add_u32 v123, v123, v123
    v_mul_f32 v124, v122, v124
    v_mul_f32 v125, v122, v125
    v_cmpx_le_u32 vcc, 0x1000000, v64
    ds_add_f32 v123, v124 offset:54272
    ds_add_f32 v123, v125 offset:54276
    s_mov_b64 exec, -1
    v_ashrrev_i32 v122, 5, v65
    v_lshlrev_b16 v123, 2, v65
    v_cndmask_b32 v126, v34, v35, s[66:67]
    v_bitop3_b32 v122, v122, v113, v113 bitop3:0x0c
    v_lshlrev_b32 v124, 16, v126
    v_mul_f32 v122, v114, v122
    v_and_b32 v125, 0xffff0000, v126
    v_add_u32 v123, v123, v123
    v_mul_f32 v124, v122, v124
    v_mul_f32 v125, v122, v125
    v_cmpx_le_u32 vcc, 0x1000000, v65
    ds_add_f32 v123, v124 offset:54272
    ds_add_f32 v123, v125 offset:54276
    s_mov_b64 exec, -1
    s_waitcnt vmcnt(13)
    v_perm_b32 v63, v93, v90, s31
    v_perm_b32 v64, v93, v91, s32
    v_perm_b32 v65, v93, v92, s33
    v_lshlrev_b16 v34, 3, v92
    v_lshlrev_b16 v32, 3, v91
    v_lshlrev_b16 v30, 3, v90
    s_waitcnt lgkmcnt(12)
    s_barrier
    s_setprio 3
    s_cmp_ge_u32 s10, 9
    s_cbranch_scc1 p2_nm1m1a
    v_lshrrev_b32 v84, 1, v112
    s_add_u32 s44, s20, s42
    buffer_load_dwordx2 v[84:85], v84, s[4:7], s44 offen
p2_nm1m1a:
    buffer_load_dwordx4 v[72:75], v112, s[4:7], s20 offen offset:0
    buffer_load_dwordx4 v[76:79], v112, s[4:7], s20 offen offset:1024
    buffer_load_dwordx4 v[80:83], v112, s[4:7], s20 offen offset:2048
    v_cmpx_ge_u16 vcc, 0x3fff, v60
    ds_read_b64 v[24:25], v24
    s_mov_b64 exec, -1
    v_cmpx_ge_u16 vcc, 0x3fff, v61
    ds_read_b64 v[26:27], v26
    s_mov_b64 exec, -1
    v_cmpx_ge_u16 vcc, 0x3fff, v62
    ds_read_b64 v[28:29], v28
    s_mov_b64 exec, -1
    v_cmpx_ge_u16 vcc, 0x3fff, v63
    ds_read_b64 v[30:31], v30
    s_mov_b64 exec, -1
    v_cmpx_ge_u16 vcc, 0x3fff, v64
    ds_read_b64 v[32:33], v32
    s_mov_b64 exec, -1
    v_cmpx_ge_u16 vcc, 0x3fff, v65
    ds_read_b64 v[34:35], v34
    s_mov_b64 exec, -1
    s_setprio 2
    s_waitcnt lgkmcnt(15)
    v_ashrrev_i32 v122, 5, v66
    v_lshlrev_b16 v123, 2, v66
    v_cndmask_b32 v126, v36, v37, s[66:67]
    v_bitop3_b32 v122, v122, v113, v113 bitop3:0x0c
    v_lshlrev_b32 v124, 16, v126
    v_mul_f32 v122, v114, v122
    v_and_b32 v125, 0xffff0000, v126
    v_add_u32 v123, v123, v123
    v_mul_f32 v124, v122, v124
    v_mul_f32 v125, v122, v125
    v_cmpx_le_u32 vcc, 0x1000000, v66
    ds_add_f32 v123, v124 offset:54272
    ds_add_f32 v123, v125 offset:54276
    s_mov_b64 exec, -1
    v_ashrrev_i32 v122, 5, v67
    v_lshlrev_b16 v123, 2, v67
    v_cndmask_b32 v126, v38, v39, s[66:67]
    v_bitop3_b32 v122, v122, v113, v113 bitop3:0x0c
    v_lshlrev_b32 v124, 16, v126
    v_mul_f32 v122, v114, v122
    v_and_b32 v125, 0xffff0000, v126
    v_add_u32 v123, v123, v123
    v_mul_f32 v124, v122, v124
    v_mul_f32 v125, v122, v125
    v_cmpx_le_u32 vcc, 0x1000000, v67
    ds_add_f32 v123, v124 offset:54272
    ds_add_f32 v123, v125 offset:54276
    s_mov_b64 exec, -1
    v_ashrrev_i32 v122, 5, v68
    v_lshlrev_b16 v123, 2, v68
    v_cndmask_b32 v126, v40, v41, s[66:67]
    v_bitop3_b32 v122, v122, v113, v113 bitop3:0x0c
    v_lshlrev_b32 v124, 16, v126
    v_mul_f32 v122, v114, v122
    v_and_b32 v125, 0xffff0000, v126
    v_add_u32 v123, v123, v123
    v_mul_f32 v124, v122, v124
    v_mul_f32 v125, v122, v125
    v_cmpx_le_u32 vcc, 0x1000000, v68
    ds_add_f32 v123, v124 offset:54272
    ds_add_f32 v123, v125 offset:54276
    s_mov_b64 exec, -1
    s_waitcnt vmcnt(15)
    v_perm_b32 v66, v97, v94, s31
    v_perm_b32 v67, v97, v95, s32
    v_perm_b32 v68, v97, v96, s33
    v_lshlrev_b16 v40, 3, v96
    v_lshlrev_b16 v38, 3, v95
    v_lshlrev_b16 v36, 3, v94
    v_cmpx_ge_u16 vcc, 0x3fff, v66
    ds_read_b64 v[36:37], v36
    s_mov_b64 exec, -1
    v_cmpx_ge_u16 vcc, 0x3fff, v67
    ds_read_b64 v[38:39], v38
    s_mov_b64 exec, -1
    v_cmpx_ge_u16 vcc, 0x3fff, v68
    ds_read_b64 v[40:41], v40
    s_mov_b64 exec, -1
    v_bfe_u32 v90, v107, 14, 4
    v_lshrrev_b32 v91, 18, v107
    v_and_b32 v107, 0x3fff, v107
    v_mad_u32_u24 v90, v90, s63, v91
    v_mad_u32_u24 v107, v90, s65, v107
    buffer_load_dwordx4 v[90:93], v107, s[68:71], 0 offen
    s_setprio 1
    s_waitcnt lgkmcnt(15)
    v_ashrrev_i32 v122, 5, v69
    v_lshlrev_b16 v123, 2, v69
    v_cndmask_b32 v126, v42, v43, s[66:67]
    v_bitop3_b32 v122, v122, v113, v113 bitop3:0x0c
    v_lshlrev_b32 v124, 16, v126
    v_mul_f32 v122, v114, v122
    v_and_b32 v125, 0xffff0000, v126
    v_add_u32 v123, v123, v123
    v_mul_f32 v124, v122, v124
    v_mul_f32 v125, v122, v125
    v_cmpx_le_u32 vcc, 0x1000000, v69
    ds_add_f32 v123, v124 offset:54272
    ds_add_f32 v123, v125 offset:54276
    s_mov_b64 exec, -1
    v_ashrrev_i32 v122, 5, v70
    v_lshlrev_b16 v123, 2, v70
    v_cndmask_b32 v126, v44, v45, s[66:67]
    v_bitop3_b32 v122, v122, v113, v113 bitop3:0x0c
    v_lshlrev_b32 v124, 16, v126
    v_mul_f32 v122, v114, v122
    v_and_b32 v125, 0xffff0000, v126
    v_add_u32 v123, v123, v123
    v_mul_f32 v124, v122, v124
    v_mul_f32 v125, v122, v125
    v_cmpx_le_u32 vcc, 0x1000000, v70
    ds_add_f32 v123, v124 offset:54272
    ds_add_f32 v123, v125 offset:54276
    s_mov_b64 exec, -1
    v_ashrrev_i32 v122, 5, v71
    v_lshlrev_b16 v123, 2, v71
    v_cndmask_b32 v126, v46, v47, s[66:67]
    v_bitop3_b32 v122, v122, v113, v113 bitop3:0x0c
    v_lshlrev_b32 v124, 16, v126
    v_mul_f32 v122, v114, v122
    v_and_b32 v125, 0xffff0000, v126
    v_add_u32 v123, v123, v123
    v_mul_f32 v124, v122, v124
    v_mul_f32 v125, v122, v125
    v_cmpx_le_u32 vcc, 0x1000000, v71
    ds_add_f32 v123, v124 offset:54272
    ds_add_f32 v123, v125 offset:54276
    s_mov_b64 exec, -1
    s_waitcnt vmcnt(12)
    v_perm_b32 v69, v101, v98, s31
    v_perm_b32 v70, v101, v99, s32
    v_perm_b32 v71, v101, v100, s33
    v_lshlrev_b16 v46, 3, v100
    v_lshlrev_b16 v44, 3, v99
    v_lshlrev_b16 v42, 3, v98
    v_cmpx_ge_u16 vcc, 0x3fff, v69
    ds_read_b64 v[42:43], v42
    s_mov_b64 exec, -1
    v_cmpx_ge_u16 vcc, 0x3fff, v70
    ds_read_b64 v[44:45], v44
    s_mov_b64 exec, -1
    v_cmpx_ge_u16 vcc, 0x3fff, v71
    ds_read_b64 v[46:47], v46
    s_mov_b64 exec, -1
    s_waitcnt lgkmcnt(15)
    s_nop 2
    s_nop 1
    v_max_u32_dpp v108, v108, v108 row_shr:1 row_mask:0xf bank_mask:0xf bound_ctrl:0
    v_max_u32_dpp v109, v109, v109 row_shr:1 row_mask:0xf bank_mask:0xf bound_ctrl:0
    s_nop 0
    v_max_u32_dpp v108, v108, v108 row_shr:2 row_mask:0xf bank_mask:0xf bound_ctrl:0
    v_max_u32_dpp v109, v109, v109 row_shr:2 row_mask:0xf bank_mask:0xf bound_ctrl:0
    s_nop 0
    v_max_u32_dpp v108, v108, v108 row_shr:4 row_mask:0xf bank_mask:0xf bound_ctrl:0
    v_max_u32_dpp v109, v109, v109 row_shr:4 row_mask:0xf bank_mask:0xf bound_ctrl:0
    s_nop 0
    v_max_u32_dpp v108, v108, v108 row_shr:8 row_mask:0xf bank_mask:0xf bound_ctrl:0
    v_max_u32_dpp v109, v109, v109 row_shr:8 row_mask:0xf bank_mask:0xf bound_ctrl:0
    s_nop 0
    v_max_u32_dpp v108, v108, v108 row_bcast:15 row_mask:0xa bank_mask:0xf
    v_max_u32_dpp v109, v109, v109 row_bcast:15 row_mask:0xa bank_mask:0xf
    s_nop 0
    v_max_u32_dpp v108, v108, v108 row_bcast:31 row_mask:0xc bank_mask:0xf
    v_max_u32_dpp v109, v109, v109 row_bcast:31 row_mask:0xc bank_mask:0xf
    s_nop 0
    s_nop 0
    v_max_u32 v108, s41, v108
    s_nop 0
    v_readlane_b32 s41, v108, 63
    v_add_u32 v108, v108, v112
    v_add_u32 v108, 4294961152, v108
    v_max_u32 v109, s41, v109
    s_nop 0
    v_readlane_b32 s41, v109, 63
    v_add_u32 v109, v109, v112
    v_add_u32 v109, 4294962176, v109
    v_bfe_u32 v94, v108, 14, 4
    v_lshrrev_b32 v95, 18, v108
    v_and_b32 v108, 0x3fff, v108
    v_mad_u32_u24 v94, v94, s63, v95
    v_mad_u32_u24 v108, v94, s65, v108
    buffer_load_dwordx4 v[94:97], v108, s[68:71], 0 offen
    s_setprio 0
    s_waitcnt vmcnt(9)
    v_perm_b32 v48, v3, v0, s31
    v_perm_b32 v49, v3, v1, s32
    v_perm_b32 v50, v3, v2, s33
    v_lshlrev_b16 v4, 3, v2
    v_lshlrev_b16 v2, 3, v1
    v_lshlrev_b16 v0, 3, v0
    v_cmpx_ge_u16 vcc, 0x3fff, v48
    ds_read_b64 v[0:1], v0
    s_mov_b64 exec, -1
    v_cmpx_ge_u16 vcc, 0x3fff, v49
    ds_read_b64 v[2:3], v2
    s_mov_b64 exec, -1
    v_cmpx_ge_u16 vcc, 0x3fff, v50
    ds_read_b64 v[4:5], v4
    s_mov_b64 exec, -1
    s_waitcnt vmcnt(8)
    v_perm_b32 v51, v9, v6, s31
    v_perm_b32 v52, v9, v7, s32
    v_perm_b32 v53, v9, v8, s33
    v_lshlrev_b16 v10, 3, v8
    v_lshlrev_b16 v8, 3, v7
    v_lshlrev_b16 v6, 3, v6
    v_cmpx_ge_u16 vcc, 0x3fff, v51
    ds_read_b64 v[6:7], v6
    s_mov_b64 exec, -1
    v_cmpx_ge_u16 vcc, 0x3fff, v52
    ds_read_b64 v[8:9], v8
    s_mov_b64 exec, -1
    v_cmpx_ge_u16 vcc, 0x3fff, v53
    ds_read_b64 v[10:11], v10
    s_mov_b64 exec, -1
    s_waitcnt vmcnt(7)
    v_perm_b32 v54, v15, v12, s31
    v_perm_b32 v55, v15, v13, s32
    v_perm_b32 v56, v15, v14, s33
    v_lshlrev_b16 v16, 3, v14
    v_lshlrev_b16 v14, 3, v13
    v_lshlrev_b16 v12, 3, v12
    v_cmpx_ge_u16 vcc, 0x3fff, v54
    ds_read_b64 v[12:13], v12
    s_mov_b64 exec, -1
    v_cmpx_ge_u16 vcc, 0x3fff, v55
    ds_read_b64 v[14:15], v14
    s_mov_b64 exec, -1
    v_cmpx_ge_u16 vcc, 0x3fff, v56
    ds_read_b64 v[16:17], v16
    s_mov_b64 exec, -1
    s_waitcnt vmcnt(6)
    v_perm_b32 v57, v21, v18, s31
    v_perm_b32 v58, v21, v19, s32
    v_perm_b32 v59, v21, v20, s33
    v_lshlrev_b16 v22, 3, v20
    v_lshlrev_b16 v20, 3, v19
    v_lshlrev_b16 v18, 3, v18
    s_cmp_lt_u32 s16, 8
    s_cbranch_scc1 p2_g1r03
    v_cmpx_ge_u16 vcc, 0x3fff, v57
    ds_read_b64 v[18:19], v18
    s_mov_b64 exec, -1
    v_cmpx_ge_u16 vcc, 0x3fff, v58
    ds_read_b64 v[20:21], v20
    s_mov_b64 exec, -1
    v_cmpx_ge_u16 vcc, 0x3fff, v59
    ds_read_b64 v[22:23], v22
    s_mov_b64 exec, -1
p2_g1r03:
    s_waitcnt lgkmcnt(0)
    s_barrier
    s_waitcnt lgkmcnt(15)
    s_branch p2_tail
p2_drain1:
    v_cmpx_gt_i16 vcc, 0, v48
    ds_read_b64 v[0:1], v0
    s_mov_b64 exec, -1
    v_cmpx_gt_i16 vcc, 0, v49
    ds_read_b64 v[2:3], v2
    s_mov_b64 exec, -1
    v_cmpx_gt_i16 vcc, 0, v50
    ds_read_b64 v[4:5], v4
    s_mov_b64 exec, -1
    v_cmpx_gt_i16 vcc, 0, v51
    ds_read_b64 v[6:7], v6
    s_mov_b64 exec, -1
    v_cmpx_gt_i16 vcc, 0, v52
    ds_read_b64 v[8:9], v8
    s_mov_b64 exec, -1
    v_cmpx_gt_i16 vcc, 0, v53
    ds_read_b64 v[10:11], v10
    s_mov_b64 exec, -1
    v_cmpx_gt_i16 vcc, 0, v54
    ds_read_b64 v[12:13], v12
    s_mov_b64 exec, -1
    v_cmpx_gt_i16 vcc, 0, v55
    ds_read_b64 v[14:15], v14
    s_mov_b64 exec, -1
    v_cmpx_gt_i16 vcc, 0, v56
    ds_read_b64 v[16:17], v16
    s_mov_b64 exec, -1
    s_cmp_lt_u32 s15, 8
    s_cbranch_scc1 p2_gd1
    v_cmpx_gt_i16 vcc, 0, v57
    ds_read_b64 v[18:19], v18
    s_mov_b64 exec, -1
    v_cmpx_gt_i16 vcc, 0, v58
    ds_read_b64 v[20:21], v20
    s_mov_b64 exec, -1
    v_cmpx_gt_i16 vcc, 0, v59
    ds_read_b64 v[22:23], v22
    s_mov_b64 exec, -1
p2_gd1:
    v_cmpx_gt_i16 vcc, 0, v60
    ds_read_b64 v[24:25], v24
    s_mov_b64 exec, -1
    v_cmpx_gt_i16 vcc, 0, v61
    ds_read_b64 v[26:27], v26
    s_mov_b64 exec, -1
    v_cmpx_gt_i16 vcc, 0, v62
    ds_read_b64 v[28:29], v28
    s_mov_b64 exec, -1
    v_cmpx_gt_i16 vcc, 0, v63
    ds_read_b64 v[30:31], v30
    s_mov_b64 exec, -1
    v_cmpx_gt_i16 vcc, 0, v64
    ds_read_b64 v[32:33], v32
    s_mov_b64 exec, -1
    v_cmpx_gt_i16 vcc, 0, v65
    ds_read_b64 v[34:35], v34
    s_mov_b64 exec, -1
    v_cmpx_gt_i16 vcc, 0, v66
    ds_read_b64 v[36:37], v36
    s_mov_b64 exec, -1
    v_cmpx_gt_i16 vcc, 0, v67
    ds_read_b64 v[38:39], v38
    s_mov_b64 exec, -1
    v_cmpx_gt_i16 vcc, 0, v68
    ds_read_b64 v[40:41], v40
    s_mov_b64 exec, -1
    v_cmpx_gt_i16 vcc, 0, v69
    ds_read_b64 v[42:43], v42
    s_mov_b64 exec, -1
    v_cmpx_gt_i16 vcc, 0, v70
    ds_read_b64 v[44:45], v44
    s_mov_b64 exec, -1
    v_cmpx_gt_i16 vcc, 0, v71
    ds_read_b64 v[46:47], v46
    s_mov_b64 exec, -1
    s_waitcnt lgkmcnt(15)
    v_ashrrev_i32 v122, 5, v48
    v_lshlrev_b16 v123, 2, v48
    v_cndmask_b32 v126, v0, v1, s[66:67]
    v_bitop3_b32 v122, v122, v113, v113 bitop3:0x0c
    v_lshlrev_b32 v124, 16, v126
    v_mul_f32 v122, v114, v122
    v_and_b32 v125, 0xffff0000, v126
    v_add_u32 v123, v123, v123
    v_mul_f32 v124, v122, v124
    v_mul_f32 v125, v122, v125
    v_cmpx_le_u32 vcc, 0x1000000, v48
    ds_add_f32 v123, v124 offset:54272
    ds_add_f32 v123, v125 offset:54276
    s_mov_b64 exec, -1
    v_ashrrev_i32 v122, 5, v49
    v_lshlrev_b16 v123, 2, v49
    v_cndmask_b32 v126, v2, v3, s[66:67]
    v_bitop3_b32 v122, v122, v113, v113 bitop3:0x0c
    v_lshlrev_b32 v124, 16, v126
    v_mul_f32 v122, v114, v122
    v_and_b32 v125, 0xffff0000, v126
    v_add_u32 v123, v123, v123
    v_mul_f32 v124, v122, v124
    v_mul_f32 v125, v122, v125
    v_cmpx_le_u32 vcc, 0x1000000, v49
    ds_add_f32 v123, v124 offset:54272
    ds_add_f32 v123, v125 offset:54276
    s_mov_b64 exec, -1
    v_ashrrev_i32 v122, 5, v50
    v_lshlrev_b16 v123, 2, v50
    v_cndmask_b32 v126, v4, v5, s[66:67]
    v_bitop3_b32 v122, v122, v113, v113 bitop3:0x0c
    v_lshlrev_b32 v124, 16, v126
    v_mul_f32 v122, v114, v122
    v_and_b32 v125, 0xffff0000, v126
    v_add_u32 v123, v123, v123
    v_mul_f32 v124, v122, v124
    v_mul_f32 v125, v122, v125
    v_cmpx_le_u32 vcc, 0x1000000, v50
    ds_add_f32 v123, v124 offset:54272
    ds_add_f32 v123, v125 offset:54276
    s_mov_b64 exec, -1
    s_waitcnt lgkmcnt(15)
    v_ashrrev_i32 v122, 5, v51
    v_lshlrev_b16 v123, 2, v51
    v_cndmask_b32 v126, v6, v7, s[66:67]
    v_bitop3_b32 v122, v122, v113, v113 bitop3:0x0c
    v_lshlrev_b32 v124, 16, v126
    v_mul_f32 v122, v114, v122
    v_and_b32 v125, 0xffff0000, v126
    v_add_u32 v123, v123, v123
    v_mul_f32 v124, v122, v124
    v_mul_f32 v125, v122, v125
    v_cmpx_le_u32 vcc, 0x1000000, v51
    ds_add_f32 v123, v124 offset:54272
    ds_add_f32 v123, v125 offset:54276
    s_mov_b64 exec, -1
    v_ashrrev_i32 v122, 5, v52
    v_lshlrev_b16 v123, 2, v52
    v_cndmask_b32 v126, v8, v9, s[66:67]
    v_bitop3_b32 v122, v122, v113, v113 bitop3:0x0c
    v_lshlrev_b32 v124, 16, v126
    v_mul_f32 v122, v114, v122
    v_and_b32 v125, 0xffff0000, v126
    v_add_u32 v123, v123, v123
    v_mul_f32 v124, v122, v124
    v_mul_f32 v125, v122, v125
    v_cmpx_le_u32 vcc, 0x1000000, v52
    ds_add_f32 v123, v124 offset:54272
    ds_add_f32 v123, v125 offset:54276
    s_mov_b64 exec, -1
    v_ashrrev_i32 v122, 5, v53
    v_lshlrev_b16 v123, 2, v53
    v_cndmask_b32 v126, v10, v11, s[66:67]
    v_bitop3_b32 v122, v122, v113, v113 bitop3:0x0c
    v_lshlrev_b32 v124, 16, v126
    v_mul_f32 v122, v114, v122
    v_and_b32 v125, 0xffff0000, v126
    v_add_u32 v123, v123, v123
    v_mul_f32 v124, v122, v124
    v_mul_f32 v125, v122, v125
    v_cmpx_le_u32 vcc, 0x1000000, v53
    ds_add_f32 v123, v124 offset:54272
    ds_add_f32 v123, v125 offset:54276
    s_mov_b64 exec, -1
    s_waitcnt lgkmcnt(15)
    v_ashrrev_i32 v122, 5, v54
    v_lshlrev_b16 v123, 2, v54
    v_cndmask_b32 v126, v12, v13, s[66:67]
    v_bitop3_b32 v122, v122, v113, v113 bitop3:0x0c
    v_lshlrev_b32 v124, 16, v126
    v_mul_f32 v122, v114, v122
    v_and_b32 v125, 0xffff0000, v126
    v_add_u32 v123, v123, v123
    v_mul_f32 v124, v122, v124
    v_mul_f32 v125, v122, v125
    v_cmpx_le_u32 vcc, 0x1000000, v54
    ds_add_f32 v123, v124 offset:54272
    ds_add_f32 v123, v125 offset:54276
    s_mov_b64 exec, -1
    v_ashrrev_i32 v122, 5, v55
    v_lshlrev_b16 v123, 2, v55
    v_cndmask_b32 v126, v14, v15, s[66:67]
    v_bitop3_b32 v122, v122, v113, v113 bitop3:0x0c
    v_lshlrev_b32 v124, 16, v126
    v_mul_f32 v122, v114, v122
    v_and_b32 v125, 0xffff0000, v126
    v_add_u32 v123, v123, v123
    v_mul_f32 v124, v122, v124
    v_mul_f32 v125, v122, v125
    v_cmpx_le_u32 vcc, 0x1000000, v55
    ds_add_f32 v123, v124 offset:54272
    ds_add_f32 v123, v125 offset:54276
    s_mov_b64 exec, -1
    v_ashrrev_i32 v122, 5, v56
    v_lshlrev_b16 v123, 2, v56
    v_cndmask_b32 v126, v16, v17, s[66:67]
    v_bitop3_b32 v122, v122, v113, v113 bitop3:0x0c
    v_lshlrev_b32 v124, 16, v126
    v_mul_f32 v122, v114, v122
    v_and_b32 v125, 0xffff0000, v126
    v_add_u32 v123, v123, v123
    v_mul_f32 v124, v122, v124
    v_mul_f32 v125, v122, v125
    v_cmpx_le_u32 vcc, 0x1000000, v56
    ds_add_f32 v123, v124 offset:54272
    ds_add_f32 v123, v125 offset:54276
    s_mov_b64 exec, -1
    s_cmp_lt_u32 s15, 8
    s_cbranch_scc1 p2_nad1
    s_waitcnt lgkmcnt(15)
    v_ashrrev_i32 v122, 5, v57
    v_lshlrev_b16 v123, 2, v57
    v_cndmask_b32 v126, v18, v19, s[66:67]
    v_bitop3_b32 v122, v122, v113, v113 bitop3:0x0c
    v_lshlrev_b32 v124, 16, v126
    v_mul_f32 v122, v114, v122
    v_and_b32 v125, 0xffff0000, v126
    v_add_u32 v123, v123, v123
    v_mul_f32 v124, v122, v124
    v_mul_f32 v125, v122, v125
    v_cmpx_le_u32 vcc, 0x1000000, v57
    ds_add_f32 v123, v124 offset:54272
    ds_add_f32 v123, v125 offset:54276
    s_mov_b64 exec, -1
    v_ashrrev_i32 v122, 5, v58
    v_lshlrev_b16 v123, 2, v58
    v_cndmask_b32 v126, v20, v21, s[66:67]
    v_bitop3_b32 v122, v122, v113, v113 bitop3:0x0c
    v_lshlrev_b32 v124, 16, v126
    v_mul_f32 v122, v114, v122
    v_and_b32 v125, 0xffff0000, v126
    v_add_u32 v123, v123, v123
    v_mul_f32 v124, v122, v124
    v_mul_f32 v125, v122, v125
    v_cmpx_le_u32 vcc, 0x1000000, v58
    ds_add_f32 v123, v124 offset:54272
    ds_add_f32 v123, v125 offset:54276
    s_mov_b64 exec, -1
    v_ashrrev_i32 v122, 5, v59
    v_lshlrev_b16 v123, 2, v59
    v_cndmask_b32 v126, v22, v23, s[66:67]
    v_bitop3_b32 v122, v122, v113, v113 bitop3:0x0c
    v_lshlrev_b32 v124, 16, v126
    v_mul_f32 v122, v114, v122
    v_and_b32 v125, 0xffff0000, v126
    v_add_u32 v123, v123, v123
    v_mul_f32 v124, v122, v124
    v_mul_f32 v125, v122, v125
    v_cmpx_le_u32 vcc, 0x1000000, v59
    ds_add_f32 v123, v124 offset:54272
    ds_add_f32 v123, v125 offset:54276
    s_mov_b64 exec, -1
p2_nad1:
    s_waitcnt lgkmcnt(15)
    v_ashrrev_i32 v122, 5, v60
    v_lshlrev_b16 v123, 2, v60
    v_cndmask_b32 v126, v24, v25, s[66:67]
    v_bitop3_b32 v122, v122, v113, v113 bitop3:0x0c
    v_lshlrev_b32 v124, 16, v126
    v_mul_f32 v122, v114, v122
    v_and_b32 v125, 0xffff0000, v126
    v_add_u32 v123, v123, v123
    v_mul_f32 v124, v122, v124
    v_mul_f32 v125, v122, v125
    v_cmpx_le_u32 vcc, 0x1000000, v60
    ds_add_f32 v123, v124 offset:54272
    ds_add_f32 v123, v125 offset:54276
    s_mov_b64 exec, -1
    v_ashrrev_i32 v122, 5, v61
    v_lshlrev_b16 v123, 2, v61
    v_cndmask_b32 v126, v26, v27, s[66:67]
    v_bitop3_b32 v122, v122, v113, v113 bitop3:0x0c
    v_lshlrev_b32 v124, 16, v126
    v_mul_f32 v122, v114, v122
    v_and_b32 v125, 0xffff0000, v126
    v_add_u32 v123, v123, v123
    v_mul_f32 v124, v122, v124
    v_mul_f32 v125, v122, v125
    v_cmpx_le_u32 vcc, 0x1000000, v61
    ds_add_f32 v123, v124 offset:54272
    ds_add_f32 v123, v125 offset:54276
    s_mov_b64 exec, -1
    v_ashrrev_i32 v122, 5, v62
    v_lshlrev_b16 v123, 2, v62
    v_cndmask_b32 v126, v28, v29, s[66:67]
    v_bitop3_b32 v122, v122, v113, v113 bitop3:0x0c
    v_lshlrev_b32 v124, 16, v126
    v_mul_f32 v122, v114, v122
    v_and_b32 v125, 0xffff0000, v126
    v_add_u32 v123, v123, v123
    v_mul_f32 v124, v122, v124
    v_mul_f32 v125, v122, v125
    v_cmpx_le_u32 vcc, 0x1000000, v62
    ds_add_f32 v123, v124 offset:54272
    ds_add_f32 v123, v125 offset:54276
    s_mov_b64 exec, -1
    s_waitcnt lgkmcnt(15)
    v_ashrrev_i32 v122, 5, v63
    v_lshlrev_b16 v123, 2, v63
    v_cndmask_b32 v126, v30, v31, s[66:67]
    v_bitop3_b32 v122, v122, v113, v113 bitop3:0x0c
    v_lshlrev_b32 v124, 16, v126
    v_mul_f32 v122, v114, v122
    v_and_b32 v125, 0xffff0000, v126
    v_add_u32 v123, v123, v123
    v_mul_f32 v124, v122, v124
    v_mul_f32 v125, v122, v125
    v_cmpx_le_u32 vcc, 0x1000000, v63
    ds_add_f32 v123, v124 offset:54272
    ds_add_f32 v123, v125 offset:54276
    s_mov_b64 exec, -1
    v_ashrrev_i32 v122, 5, v64
    v_lshlrev_b16 v123, 2, v64
    v_cndmask_b32 v126, v32, v33, s[66:67]
    v_bitop3_b32 v122, v122, v113, v113 bitop3:0x0c
    v_lshlrev_b32 v124, 16, v126
    v_mul_f32 v122, v114, v122
    v_and_b32 v125, 0xffff0000, v126
    v_add_u32 v123, v123, v123
    v_mul_f32 v124, v122, v124
    v_mul_f32 v125, v122, v125
    v_cmpx_le_u32 vcc, 0x1000000, v64
    ds_add_f32 v123, v124 offset:54272
    ds_add_f32 v123, v125 offset:54276
    s_mov_b64 exec, -1
    v_ashrrev_i32 v122, 5, v65
    v_lshlrev_b16 v123, 2, v65
    v_cndmask_b32 v126, v34, v35, s[66:67]
    v_bitop3_b32 v122, v122, v113, v113 bitop3:0x0c
    v_lshlrev_b32 v124, 16, v126
    v_mul_f32 v122, v114, v122
    v_and_b32 v125, 0xffff0000, v126
    v_add_u32 v123, v123, v123
    v_mul_f32 v124, v122, v124
    v_mul_f32 v125, v122, v125
    v_cmpx_le_u32 vcc, 0x1000000, v65
    ds_add_f32 v123, v124 offset:54272
    ds_add_f32 v123, v125 offset:54276
    s_mov_b64 exec, -1
    s_waitcnt lgkmcnt(15)
    v_ashrrev_i32 v122, 5, v66
    v_lshlrev_b16 v123, 2, v66
    v_cndmask_b32 v126, v36, v37, s[66:67]
    v_bitop3_b32 v122, v122, v113, v113 bitop3:0x0c
    v_lshlrev_b32 v124, 16, v126
    v_mul_f32 v122, v114, v122
    v_and_b32 v125, 0xffff0000, v126
    v_add_u32 v123, v123, v123
    v_mul_f32 v124, v122, v124
    v_mul_f32 v125, v122, v125
    v_cmpx_le_u32 vcc, 0x1000000, v66
    ds_add_f32 v123, v124 offset:54272
    ds_add_f32 v123, v125 offset:54276
    s_mov_b64 exec, -1
    v_ashrrev_i32 v122, 5, v67
    v_lshlrev_b16 v123, 2, v67
    v_cndmask_b32 v126, v38, v39, s[66:67]
    v_bitop3_b32 v122, v122, v113, v113 bitop3:0x0c
    v_lshlrev_b32 v124, 16, v126
    v_mul_f32 v122, v114, v122
    v_and_b32 v125, 0xffff0000, v126
    v_add_u32 v123, v123, v123
    v_mul_f32 v124, v122, v124
    v_mul_f32 v125, v122, v125
    v_cmpx_le_u32 vcc, 0x1000000, v67
    ds_add_f32 v123, v124 offset:54272
    ds_add_f32 v123, v125 offset:54276
    s_mov_b64 exec, -1
    v_ashrrev_i32 v122, 5, v68
    v_lshlrev_b16 v123, 2, v68
    v_cndmask_b32 v126, v40, v41, s[66:67]
    v_bitop3_b32 v122, v122, v113, v113 bitop3:0x0c
    v_lshlrev_b32 v124, 16, v126
    v_mul_f32 v122, v114, v122
    v_and_b32 v125, 0xffff0000, v126
    v_add_u32 v123, v123, v123
    v_mul_f32 v124, v122, v124
    v_mul_f32 v125, v122, v125
    v_cmpx_le_u32 vcc, 0x1000000, v68
    ds_add_f32 v123, v124 offset:54272
    ds_add_f32 v123, v125 offset:54276
    s_mov_b64 exec, -1
    s_waitcnt lgkmcnt(15)
    v_ashrrev_i32 v122, 5, v69
    v_lshlrev_b16 v123, 2, v69
    v_cndmask_b32 v126, v42, v43, s[66:67]
    v_bitop3_b32 v122, v122, v113, v113 bitop3:0x0c
    v_lshlrev_b32 v124, 16, v126
    v_mul_f32 v122, v114, v122
    v_and_b32 v125, 0xffff0000, v126
    v_add_u32 v123, v123, v123
    v_mul_f32 v124, v122, v124
    v_mul_f32 v125, v122, v125
    v_cmpx_le_u32 vcc, 0x1000000, v69
    ds_add_f32 v123, v124 offset:54272
    ds_add_f32 v123, v125 offset:54276
    s_mov_b64 exec, -1
    v_ashrrev_i32 v122, 5, v70
    v_lshlrev_b16 v123, 2, v70
    v_cndmask_b32 v126, v44, v45, s[66:67]
    v_bitop3_b32 v122, v122, v113, v113 bitop3:0x0c
    v_lshlrev_b32 v124, 16, v126
    v_mul_f32 v122, v114, v122
    v_and_b32 v125, 0xffff0000, v126
    v_add_u32 v123, v123, v123
    v_mul_f32 v124, v122, v124
    v_mul_f32 v125, v122, v125
    v_cmpx_le_u32 vcc, 0x1000000, v70
    ds_add_f32 v123, v124 offset:54272
    ds_add_f32 v123, v125 offset:54276
    s_mov_b64 exec, -1
    v_ashrrev_i32 v122, 5, v71
    v_lshlrev_b16 v123, 2, v71
    v_cndmask_b32 v126, v46, v47, s[66:67]
    v_bitop3_b32 v122, v122, v113, v113 bitop3:0x0c
    v_lshlrev_b32 v124, 16, v126
    v_mul_f32 v122, v114, v122
    v_and_b32 v125, 0xffff0000, v126
    v_add_u32 v123, v123, v123
    v_mul_f32 v124, v122, v124
    v_mul_f32 v125, v122, v125
    v_cmpx_le_u32 vcc, 0x1000000, v71
    ds_add_f32 v123, v124 offset:54272
    ds_add_f32 v123, v125 offset:54276
    s_mov_b64 exec, -1
    s_branch p2_fin
p2_tail:
    s_mov_b32 s60, s61
    s_mov_b32 s15, s16
    s_mov_b32 s16, s17
    v_mov_b32 v122, s19
    s_xor_b32 s19, s19, 4
    ds_read_b32 v125, v122 offset:53760
    v_mov_b32 v123, s19
    v_mov_b32 v124, 0
    ds_write_b32 v123, v124 offset:53760
    s_waitcnt vmcnt(2)
    s_mov_b32 m0, s24
    s_cmp_ge_u32 s10, 9
    s_cbranch_scc1 p2_st2s1
    ds_write_addtid_b32 v84 offset:49152
    ds_write_addtid_b32 v85 offset:49408
p2_st2s1:
    s_mov_b32 m0, s23
    s_add_u32 s20, s20, 53760
    ds_write_addtid_b32 v72 offset:0
    ds_write_addtid_b32 v73 offset:256
    ds_write_addtid_b32 v74 offset:512
    ds_write_addtid_b32 v75 offset:768
    ds_write_addtid_b32 v76 offset:1024
    ds_write_addtid_b32 v77 offset:1280
    ds_write_addtid_b32 v78 offset:1536
    ds_write_addtid_b32 v79 offset:1792
    ds_write_addtid_b32 v80 offset:2048
    ds_write_addtid_b32 v81 offset:2304
    ds_write_addtid_b32 v82 offset:2560
    ds_write_addtid_b32 v83 offset:2816
    s_cmp_ge_u32 s10, 9
    s_cbranch_scc1 p2_nm2m2a
    v_lshrrev_b32 v84, 1, v112
    s_add_u32 s44, s20, s42
    buffer_load_dwordx2 v[84:85], v84, s[4:7], s44 offen
p2_nm2m2a:
    buffer_load_dwordx4 v[72:75], v112, s[4:7], s20 offen offset:0
    buffer_load_dwordx4 v[76:79], v112, s[4:7], s20 offen offset:1024
    buffer_load_dwordx4 v[80:83], v112, s[4:7], s20 offen offset:2048
    s_waitcnt lgkmcnt(0)
    s_barrier
    s_setprio 3
    v_cmpx_lt_i16 vcc, 0x3fff, v48
    ds_read_b64 v[0:1], v0
    s_mov_b64 exec, -1
    v_cmpx_lt_i16 vcc, 0x3fff, v49
    ds_read_b64 v[2:3], v2
    s_mov_b64 exec, -1
    v_cmpx_lt_i16 vcc, 0x3fff, v50
    ds_read_b64 v[4:5], v4
    s_mov_b64 exec, -1
    v_cmpx_lt_i16 vcc, 0x3fff, v51
    ds_read_b64 v[6:7], v6
    s_mov_b64 exec, -1
    v_cmpx_lt_i16 vcc, 0x3fff, v52
    ds_read_b64 v[8:9], v8
    s_mov_b64 exec, -1
    v_cmpx_lt_i16 vcc, 0x3fff, v53
    ds_read_b64 v[10:11], v10
    s_mov_b64 exec, -1
    s_waitcnt lgkmcnt(15)
    s_nop 1
    v_readfirstlane_b32 s44, v125
    s_nop 0
    s_cmp_lg_u32 s44, 0
    s_cbranch_scc1 p2_advb
    s_add_u32 s61, s61, 1
    s_min_u32 s61, s61, 10
    v_mov_b32 v110, 0
    v_mov_b32 v111, 0
    s_cmp_eq_u32 s61, 10
    s_cbranch_scc1 p2_advb
    s_add_u32 s44, s61, s18
    s_cmp_ge_u32 s44, 10
    s_cselect_b32 s53, 10, 0
    s_sub_u32 s44, s44, s53
    s_mul_i32 s44, s44, 4160
    s_add_u32 s44, s44, s40
    v_bfe_i32 v111, v112, 6, 1
    v_lshrrev_b32 v110, 6, v112
    v_bitop3_b32 v111, v111, 15, s10 bitop3:0x6a
    v_lshl_or_b32 v110, v110, 4, v111
    v_bfe_u32 v111, v112, 2, 4
    v_mul_u32_u24 v110, 41600, v110
    v_add_u32 v111, v110, v111
    v_add_u32 v110, 256, v112
    v_and_b32 v110, 0x400, v110
    v_lshl_or_b32 v111, v110, 20, v111
    buffer_load_dword v110, v111, s[4:7], s44 offen
    buffer_load_dword v111, v111, s[4:7], s44 offen offset:16
p2_advb:
    s_cmp_lg_u32 s10, 15
    s_cbranch_scc1 p2_ntg
    s_lshr_b32 s44, s2, 3
    s_mul_i32 s44, s44, 5120
    s_add_u32 s45, s60, s18
    s_cmp_ge_u32 s45, 10
    s_cselect_b32 s53, 10, 0
    s_sub_u32 s45, s45, s53
    s_mul_i32 s45, s45, 645120
    s_add_u32 s44, s44, s45
    s_add_u32 s44, s44, s62
    s_sub_u32 s44, s44, s23
    v_lshlrev_b32 v84, 3, v112
    s_mov_b32 exec_hi, 0xff
    buffer_load_dword v85, v84, s[4:7], s44 offen
    s_mov_b64 exec, -1
p2_ntg:
    v_cmpx_lt_i16 vcc, 0x3fff, v54
    ds_read_b64 v[12:13], v12
    s_mov_b64 exec, -1
    v_cmpx_lt_i16 vcc, 0x3fff, v55
    ds_read_b64 v[14:15], v14
    s_mov_b64 exec, -1
    v_cmpx_lt_i16 vcc, 0x3fff, v56
    ds_read_b64 v[16:17], v16
    s_mov_b64 exec, -1
    s_cmp_lt_u32 s15, 8
    s_cbranch_scc1 p2_g2r13
    v_cmpx_lt_i16 vcc, 0x3fff, v57
    ds_read_b64 v[18:19], v18
    s_mov_b64 exec, -1
    v_cmpx_lt_i16 vcc, 0x3fff, v58
    ds_read_b64 v[20:21], v20
    s_mov_b64 exec, -1
    v_cmpx_lt_i16 vcc, 0x3fff, v59
    ds_read_b64 v[22:23], v22
    s_mov_b64 exec, -1
p2_g2r13:
    v_bfe_u32 v98, v109, 14, 4
    v_lshrrev_b32 v99, 18, v109
    v_and_b32 v109, 0x3fff, v109
    v_mad_u32_u24 v98, v98, s63, v99
    v_mad_u32_u24 v109, v98, s65, v109
    buffer_load_dwordx4 v[98:101], v109, s[68:71], 0 offen
    s_setprio 1
    v_cmpx_lt_i16 vcc, 0x3fff, v60
    ds_read_b64 v[24:25], v24
    s_mov_b64 exec, -1
    v_cmpx_lt_i16 vcc, 0x3fff, v61
    ds_read_b64 v[26:27], v26
    s_mov_b64 exec, -1
    v_cmpx_lt_i16 vcc, 0x3fff, v62
    ds_read_b64 v[28:29], v28
    s_mov_b64 exec, -1
    v_cmpx_lt_i16 vcc, 0x3fff, v63
    ds_read_b64 v[30:31], v30
    s_mov_b64 exec, -1
    v_cmpx_lt_i16 vcc, 0x3fff, v64
    ds_read_b64 v[32:33], v32
    s_mov_b64 exec, -1
    v_cmpx_lt_i16 vcc, 0x3fff, v65
    ds_read_b64 v[34:35], v34
    s_mov_b64 exec, -1
    s_nop 2
    s_nop 1
    v_max_u32_dpp v102, v102, v102 row_shr:1 row_mask:0xf bank_mask:0xf bound_ctrl:0
    v_max_u32_dpp v103, v103, v103 row_shr:1 row_mask:0xf bank_mask:0xf bound_ctrl:0
    s_nop 0
    v_max_u32_dpp v102, v102, v102 row_shr:2 row_mask:0xf bank_mask:0xf bound_ctrl:0
    v_max_u32_dpp v103, v103, v103 row_shr:2 row_mask:0xf bank_mask:0xf bound_ctrl:0
    s_nop 0
    v_max_u32_dpp v102, v102, v102 row_shr:4 row_mask:0xf bank_mask:0xf bound_ctrl:0
    v_max_u32_dpp v103, v103, v103 row_shr:4 row_mask:0xf bank_mask:0xf bound_ctrl:0
    s_nop 0
    v_max_u32_dpp v102, v102, v102 row_shr:8 row_mask:0xf bank_mask:0xf bound_ctrl:0
    v_max_u32_dpp v103, v103, v103 row_shr:8 row_mask:0xf bank_mask:0xf bound_ctrl:0
    s_nop 0
    v_max_u32_dpp v102, v102, v102 row_bcast:15 row_mask:0xa bank_mask:0xf
    v_max_u32_dpp v103, v103, v103 row_bcast:15 row_mask:0xa bank_mask:0xf
    s_nop 0
    v_max_u32_dpp v102, v102, v102 row_bcast:31 row_mask:0xc bank_mask:0xf
    v_max_u32_dpp v103, v103, v103 row_bcast:31 row_mask:0xc bank_mask:0xf
    s_nop 0
    s_nop 0
    v_max_u32 v102, s41, v102
    s_nop 0
    v_readlane_b32 s41, v102, 63
    v_add_u32 v102, v102, v112
    v_add_u32 v102, 4294963200, v102
    v_max_u32 v103, s41, v103
    s_nop 0
    v_readlane_b32 s41, v103, 63
    v_add_u32 v103, v103, v112
    v_add_u32 v103, 4294964224, v103
    v_cmpx_lt_i16 vcc, 0x3fff, v66
    ds_read_b64 v[36:37], v36
    s_mov_b64 exec, -1
    v_cmpx_lt_i16 vcc, 0x3fff, v67
    ds_read_b64 v[38:39], v38
    s_mov_b64 exec, -1
    v_cmpx_lt_i16 vcc, 0x3fff, v68
    ds_read_b64 v[40:41], v40
    s_mov_b64 exec, -1
    v_cmpx_lt_i16 vcc, 0x3fff, v69
    ds_read_b64 v[42:43], v42
    s_mov_b64 exec, -1
    v_cmpx_lt_i16 vcc, 0x3fff, v70
    ds_read_b64 v[44:45], v44
    s_mov_b64 exec, -1
    v_cmpx_lt_i16 vcc, 0x3fff, v71
    ds_read_b64 v[46:47], v46
    s_mov_b64 exec, -1
    s_waitcnt lgkmcnt(0)
    s_barrier
    s_waitcnt vmcnt(1)
    s_mov_b32 m0, s24
    s_cmp_ge_u32 s10, 9
    s_cbranch_scc1 p2_st2s2
    ds_write_addtid_b32 v84 offset:49152
    ds_write_addtid_b32 v85 offset:49408
p2_st2s2:
    s_mov_b32 m0, s23
    s_add_u32 s20, s60, s18
    s_cmp_ge_u32 s20, 10
    s_cselect_b32 s53, 10, 0
    s_sub_u32 s20, s20, s53
    s_mul_i32 s20, s20, 645120
    s_add_u32 s20, s20, s62
    ds_write_addtid_b32 v72 offset:0
    ds_write_addtid_b32 v73 offset:256
    ds_write_addtid_b32 v74 offset:512
    ds_write_addtid_b32 v75 offset:768
    ds_write_addtid_b32 v76 offset:1024
    ds_write_addtid_b32 v77 offset:1280
    ds_write_addtid_b32 v78 offset:1536
    ds_write_addtid_b32 v79 offset:1792
    ds_write_addtid_b32 v80 offset:2048
    ds_write_addtid_b32 v81 offset:2304
    ds_write_addtid_b32 v82 offset:2560
    ds_write_addtid_b32 v83 offset:2816
    s_nop 2
    s_nop 1
    v_max_u32_dpp v104, v104, v104 row_shr:1 row_mask:0xf bank_mask:0xf bound_ctrl:0
    v_max_u32_dpp v105, v105, v105 row_shr:1 row_mask:0xf bank_mask:0xf bound_ctrl:0
    s_nop 0
    v_max_u32_dpp v104, v104, v104 row_shr:2 row_mask:0xf bank_mask:0xf bound_ctrl:0
    v_max_u32_dpp v105, v105, v105 row_shr:2 row_mask:0xf bank_mask:0xf bound_ctrl:0
    s_nop 0
    v_max_u32_dpp v104, v104, v104 row_shr:4 row_mask:0xf bank_mask:0xf bound_ctrl:0
    v_max_u32_dpp v105, v105, v105 row_shr:4 row_mask:0xf bank_mask:0xf bound_ctrl:0
    s_nop 0
    v_max_u32_dpp v104, v104, v104 row_shr:8 row_mask:0xf bank_mask:0xf bound_ctrl:0
    v_max_u32_dpp v105, v105, v105 row_shr:8 row_mask:0xf bank_mask:0xf bound_ctrl:0
    s_nop 0
    v_max_u32_dpp v104, v104, v104 row_bcast:15 row_mask:0xa bank_mask:0xf
    v_max_u32_dpp v105, v105, v105 row_bcast:15 row_mask:0xa bank_mask:0xf
    s_nop 0
    v_max_u32_dpp v104, v104, v104 row_bcast:31 row_mask:0xc bank_mask:0xf
    v_max_u32_dpp v105, v105, v105 row_bcast:31 row_mask:0xc bank_mask:0xf
    s_nop 0
    s_nop 0
    v_max_u32 v104, s41, v104
    s_nop 0
    v_readlane_b32 s41, v104, 63
    v_add_u32 v104, v104, v112
    v_add_u32 v104, 4294965248, v104
    v_max_u32 v105, s41, v105
    s_nop 0
    v_readlane_b32 s41, v105, 63
    v_add_u32 v105, v105, v112
    v_add_u32 v105, 4294966272, v105
    s_waitcnt lgkmcnt(0)
    s_barrier
    s_branch p2_top
p2_fin:
    s_waitcnt vmcnt(0) lgkmcnt(0)
    s_barrier
    s_mov_b32 s48, s11
    s_mul_i32 s44, s48, 800768
    s_mul_i32 s45, s12, 12512
    s_add_u32 s49, s44, s45
    s_lshl_b32 s44, s49, 3
    s_add_u32 s44, s44, 492278784
    s_lshl_b32 s48, s48, 2
    s_lshl_b32 s45, s12, 4
    s_add_u32 s48, s48, s45
    s_add_u32 s48, s48, 492277760
    v_add_u32 v123, s64, v112
    v_add_u32 v122, s25, v123
    v_mov_b32 v24, 0
    v_mov_b32 v25, 0
    v_mov_b32 v26, 0
    v_mov_b32 v27, 0
    v_cmp_gt_u32 vcc, 1792, v123
    v_mov_b32 v124, 0x38000000
    v_mov_b32 v126, 0
    v_cndmask_b32 v124, v124, v123, vcc
    ds_read_b128 v[0:3], v122 offset:0
    ds_read_b128 v[4:7], v122 offset:16384
    ds_read_b128 v[8:11], v122 offset:32768
    v_add_u32 v122, 49152, v122
    ds_read_b128 v[12:15], v122 offset:0
    ds_read_b128 v[16:19], v122 offset:16384
    ds_read_b128 v[20:23], v122 offset:32768
    s_mov_b64 exec, vcc
    ds_read_b128 v[24:27], v122 offset:49152
    s_mov_b64 exec, -1
    s_cmp_lg_u32 s21, 0
    s_cbranch_scc1 p2_finf
    s_waitcnt lgkmcnt(6)
    buffer_store_dwordx4 v[0:3], v123, s[4:7], s44 offen nt
    s_add_u32 s44, s44, 16384
    s_waitcnt lgkmcnt(5)
    buffer_store_dwordx4 v[4:7], v123, s[4:7], s44 offen nt
    s_add_u32 s44, s44, 16384
    s_waitcnt lgkmcnt(4)
    buffer_store_dwordx4 v[8:11], v123, s[4:7], s44 offen nt
    s_add_u32 s44, s44, 16384
    s_waitcnt lgkmcnt(3)
    buffer_store_dwordx4 v[12:15], v123, s[4:7], s44 offen nt
    s_add_u32 s44, s44, 16384
    s_waitcnt lgkmcnt(2)
    buffer_store_dwordx4 v[16:19], v123, s[4:7], s44 offen nt
    s_add_u32 s44, s44, 16384
    s_waitcnt lgkmcnt(1)
    buffer_store_dwordx4 v[20:23], v123, s[4:7], s44 offen nt
    s_add_u32 s44, s44, 16384
    s_waitcnt lgkmcnt(0)
    buffer_store_dwordx4 v[24:27], v124, s[4:7], s44 offen nt
    s_add_u32 s44, s44, 16384
    v_bitop3_b32 v115, v115, v0, v1 bitop3:0xfe
    v_bitop3_b32 v115, v115, v2, v3 bitop3:0xfe
    v_bitop3_b32 v115, v115, v4, v5 bitop3:0xfe
    v_bitop3_b32 v115, v115, v6, v7 bitop3:0xfe
    v_bitop3_b32 v115, v115, v8, v9 bitop3:0xfe
    v_bitop3_b32 v115, v115, v10, v11 bitop3:0xfe
    v_bitop3_b32 v115, v115, v12, v13 bitop3:0xfe
    v_bitop3_b32 v115, v115, v14, v15 bitop3:0xfe
    v_bitop3_b32 v115, v115, v16, v17 bitop3:0xfe
    v_bitop3_b32 v115, v115, v18, v19 bitop3:0xfe
    v_bitop3_b32 v115, v115, v20, v21 bitop3:0xfe
    v_bitop3_b32 v115, v115, v22, v23 bitop3:0xfe
    v_bitop3_b32 v115, v115, v24, v25 bitop3:0xfe
    v_bitop3_b32 v115, v115, v26, v27 bitop3:0xfe
    v_bitop3_b32 v115, v115, v116, v117 bitop3:0xfe
    v_bitop3_b32 v115, v115, v118, v119 bitop3:0xfe
    v_bitop3_b32 v115, v115, v120, v121 bitop3:0xfe
    v_and_b32 v115, 0x80008000, v115
    v_cmpx_ne_u32 vcc, 0, v115
    ds_write_b32 v126, v115 offset:53768
    s_mov_b64 exec, -1
    s_waitcnt lgkmcnt(0)
    s_barrier
    ds_read_b32 v125, v126 offset:53768
    s_waitcnt lgkmcnt(0)
    v_readfirstlane_b32 s45, v125
    s_nop 0
    s_cmp_eq_u32 s45, 0
    s_cbranch_scc1 p2_done
    s_mov_b32 s21, 1
    s_waitcnt vmcnt(0)
    s_branch p2_restart
p2_finf:
    s_lshl_b32 s49, s49, 4
    s_lshl_b32 s45, s21, 3
    s_add_u32 s49, s49, s45
    s_add_u32 s49, s49, 517903352
    v_mov_b32 v28, 1073758208
    v_mov_b32 v29, 1073758208
    v_mov_b32 v30, 1073758208
    v_mov_b32 v31, 1073758208
    v_lshlrev_b32 v122, 1, v123
    v_lshlrev_b32 v125, 1, v124
    s_waitcnt lgkmcnt(0)
    buffer_store_dwordx4 v[28:31], v123, s[4:7], s44 offen
    s_add_u32 s44, s44, 16384
    buffer_store_dwordx2 v[0:1], v122, s[4:7], s49 offen offset:0
    buffer_store_dwordx2 v[2:3], v122, s[4:7], s49 offen offset:16
    s_add_u32 s49, s49, 32768
    buffer_store_dwordx4 v[28:31], v123, s[4:7], s44 offen
    s_add_u32 s44, s44, 16384
    buffer_store_dwordx2 v[4:5], v122, s[4:7], s49 offen offset:0
    buffer_store_dwordx2 v[6:7], v122, s[4:7], s49 offen offset:16
    s_add_u32 s49, s49, 32768
    buffer_store_dwordx4 v[28:31], v123, s[4:7], s44 offen
    s_add_u32 s44, s44, 16384
    buffer_store_dwordx2 v[8:9], v122, s[4:7], s49 offen offset:0
    buffer_store_dwordx2 v[10:11], v122, s[4:7], s49 offen offset:16
    s_add_u32 s49, s49, 32768
    buffer_store_dwordx4 v[28:31], v123, s[4:7], s44 offen
    s_add_u32 s44, s44, 16384
    buffer_store_dwordx2 v[12:13], v122, s[4:7], s49 offen offset:0
    buffer_store_dwordx2 v[14:15], v122, s[4:7], s49 offen offset:16
    s_add_u32 s49, s49, 32768
    buffer_store_dwordx4 v[28:31], v123, s[4:7], s44 offen
    s_add_u32 s44, s44, 16384
    buffer_store_dwordx2 v[16:17], v122, s[4:7], s49 offen offset:0
    buffer_store_dwordx2 v[18:19], v122, s[4:7], s49 offen offset:16
    s_add_u32 s49, s49, 32768
    buffer_store_dwordx4 v[28:31], v123, s[4:7], s44 offen
    s_add_u32 s44, s44, 16384
    buffer_store_dwordx2 v[20:21], v122, s[4:7], s49 offen offset:0
    buffer_store_dwordx2 v[22:23], v122, s[4:7], s49 offen offset:16
    s_add_u32 s49, s49, 32768
    buffer_store_dwordx4 v[28:31], v124, s[4:7], s44 offen
    s_add_u32 s44, s44, 16384
    buffer_store_dwordx2 v[24:25], v125, s[4:7], s49 offen offset:0
    buffer_store_dwordx2 v[26:27], v125, s[4:7], s49 offen offset:16
    s_add_u32 s49, s49, 32768
    s_add_u32 s21, s21, 1
    s_mov_b32 s30, 0
    s_waitcnt vmcnt(0)
    s_cmp_eq_u32 s21, 2
    s_cbranch_scc1 p2_restart
p2_done:
    v_mov_b32 v125, s30
    buffer_store_dword v125, v126, s[4:7], s48 offen
p2_end:
    s_endpgm
.globl p3_kernel
.p2align 8
.type p3_kernel,@function
p3_kernel:
    s_cmp_ge_u32 s2, 1563
    s_cbranch_scc1 p3_end
    s_load_dwordx2 s[4:5], s[0:1], 0
    s_load_dwordx2 s[6:7], s[0:1], 24
    s_load_dwordx2 s[8:9], s[0:1], 40
    s_load_dwordx8 s[12:19], s[0:1], 56
    s_load_dwordx2 s[10:11], s[0:1], 88
    s_load_dwordx2 s[20:21], s[0:1], 104
    s_lshl_b32 s3, s2, 8
    v_add_u32 v0, s3, v0
    v_lshlrev_b32 v2, 4, v0
    v_lshlrev_b32 v3, 2, v0
    v_add_u32 v0, v0, v0
    v_mul_hi_u32_u24 v1, 343268, v0
    v_lshlrev_b16 v1, 4, v1
    s_waitcnt lgkmcnt(0)
    s_load_dwordx4 s[32:35], s[8:9], 0
    s_load_dwordx16 s[36:51], s[12:13], 0
    s_load_dwordx16 s[52:67], s[14:15], 0
    s_load_dwordx8 s[68:75], s[16:17], 0
    s_load_dwordx8 s[76:83], s[18:19], 0
    s_mov_b32 s24, s6
    s_and_b32 s25, s7, 0xffff
    s_mov_b32 s26, 1600000
    s_mov_b32 s27, 0x20000
    buffer_load_dword v4, v3, s[24:27], 0 offen nt
    s_mov_b32 s28, s20
    s_and_b32 s29, s21, 0xffff
    s_mov_b32 s30, 819200000
    s_mov_b32 s31, 0x20000
    s_mov_b32 s22, 492278784
    buffer_load_dwordx4 v[40:43], v2, s[28:31], s22 offen nt
    s_mov_b32 s22, 498684928
    buffer_load_dwordx4 v[44:47], v2, s[28:31], s22 offen nt
    s_mov_b32 s22, 505091072
    buffer_load_dwordx4 v[48:51], v2, s[28:31], s22 offen nt
    s_mov_b32 s22, 511497216
    buffer_load_dwordx4 v[52:55], v2, s[28:31], s22 offen nt
    s_mov_b32 s22, 492277760
    buffer_load_dwordx4 v[56:59], v1, s[28:31], s22 offen
    s_mov_b32 s24, s4
    s_and_b32 s25, s5, 0xffff
    s_mov_b32 s26, 6400000
    s_mov_b32 s27, 0x20000
    buffer_load_dwordx4 v[60:63], v2, s[24:27], 0 offen nt
    s_mov_b32 s24, s10
    s_and_b32 s25, s11, 0xffff
    s_mov_b32 s26, 6400000
    s_mov_b32 s27, 0x20000
    s_waitcnt vmcnt(6) lgkmcnt(0)
    v_and_b32 v5, 0xffff0000, v4
    v_lshlrev_b32 v4, 16, v4
    s_lshl_b32 s14, s32, 16
    s_and_b32 s15, s32, 0xffff0000
    v_pk_add_f32 v[8:9], v[4:5], s[14:15] op_sel:[0,0] op_sel_hi:[0,1] neg_lo:[0,1] neg_hi:[0,1]
    v_pk_add_f32 v[16:17], v[4:5], s[14:15] op_sel:[1,0] op_sel_hi:[1,1] neg_lo:[0,1] neg_hi:[0,1]
    s_lshl_b32 s16, s33, 16
    s_and_b32 s17, s33, 0xffff0000
    v_pk_add_f32 v[10:11], v[4:5], s[16:17] op_sel:[0,0] op_sel_hi:[0,1] neg_lo:[0,1] neg_hi:[0,1]
    v_pk_add_f32 v[18:19], v[4:5], s[16:17] op_sel:[1,0] op_sel_hi:[1,1] neg_lo:[0,1] neg_hi:[0,1]
    s_lshl_b32 s18, s34, 16
    s_and_b32 s19, s34, 0xffff0000
    v_pk_add_f32 v[12:13], v[4:5], s[18:19] op_sel:[0,0] op_sel_hi:[0,1] neg_lo:[0,1] neg_hi:[0,1]
    v_pk_add_f32 v[20:21], v[4:5], s[18:19] op_sel:[1,0] op_sel_hi:[1,1] neg_lo:[0,1] neg_hi:[0,1]
    s_lshl_b32 s12, s35, 16
    s_and_b32 s13, s35, 0xffff0000
    v_pk_add_f32 v[14:15], v[4:5], s[12:13] op_sel:[0,0] op_sel_hi:[0,1] neg_lo:[0,1] neg_hi:[0,1]
    v_pk_add_f32 v[22:23], v[4:5], s[12:13] op_sel:[1,0] op_sel_hi:[1,1] neg_lo:[0,1] neg_hi:[0,1]
    v_cvt_pk_bf16_f32 v8, v8, v9
    v_cvt_pk_bf16_f32 v10, v10, v11
    v_cvt_pk_bf16_f32 v12, v12, v13
    v_cvt_pk_bf16_f32 v14, v14, v15
    v_cvt_pk_bf16_f32 v16, v16, v17
    v_cvt_pk_bf16_f32 v18, v18, v19
    v_cvt_pk_bf16_f32 v20, v20, v21
    v_cvt_pk_bf16_f32 v22, v22, v23
    v_and_b32 v9, 0xffff0000, v8
    v_lshlrev_b32 v8, 16, v8
    v_and_b32 v11, 0xffff0000, v10
    v_lshlrev_b32 v10, 16, v10
    v_and_b32 v13, 0xffff0000, v12
    v_lshlrev_b32 v12, 16, v12
    v_and_b32 v15, 0xffff0000, v14
    v_lshlrev_b32 v14, 16, v14
    v_and_b32 v17, 0xffff0000, v16
    v_lshlrev_b32 v16, 16, v16
    v_and_b32 v19, 0xffff0000, v18
    v_lshlrev_b32 v18, 16, v18
    v_and_b32 v21, 0xffff0000, v20
    v_lshlrev_b32 v20, 16, v20
    v_and_b32 v23, 0xffff0000, v22
    v_lshlrev_b32 v22, 16, v22
    v_mul_f32 v8, v8, v8
    v_mul_f32 v9, v9, v9
    v_mul_f32 v10, v10, v10
    v_mul_f32 v11, v11, v11
    v_mul_f32 v12, v12, v12
    v_mul_f32 v13, v13, v13
    v_mul_f32 v14, v14, v14
    v_mul_f32 v15, v15, v15
    v_mul_f32 v16, v16, v16
    v_mul_f32 v17, v17, v17
    v_mul_f32 v18, v18, v18
    v_mul_f32 v19, v19, v19
    v_mul_f32 v20, v20, v20
    v_mul_f32 v21, v21, v21
    v_mul_f32 v22, v22, v22
    v_mul_f32 v23, v23, v23
    v_cvt_pk_bf16_f32 v8, v8, v9
    v_cvt_pk_bf16_f32 v10, v10, v11
    v_cvt_pk_bf16_f32 v12, v12, v13
    v_cvt_pk_bf16_f32 v14, v14, v15
    v_cvt_pk_bf16_f32 v16, v16, v17
    v_cvt_pk_bf16_f32 v18, v18, v19
    v_cvt_pk_bf16_f32 v20, v20, v21
    v_cvt_pk_bf16_f32 v22, v22, v23
    v_and_b32 v9, 0xffff0000, v8
    v_lshlrev_b32 v8, 16, v8
    v_and_b32 v11, 0xffff0000, v10
    v_lshlrev_b32 v10, 16, v10
    v_and_b32 v13, 0xffff0000, v12
    v_lshlrev_b32 v12, 16, v12
    v_and_b32 v15, 0xffff0000, v14
    v_lshlrev_b32 v14, 16, v14
    v_and_b32 v17, 0xffff0000, v16
    v_lshlrev_b32 v16, 16, v16
    v_and_b32 v19, 0xffff0000, v18
    v_lshlrev_b32 v18, 16, v18
    v_and_b32 v21, 0xffff0000, v20
    v_lshlrev_b32 v20, 16, v20
    v_and_b32 v23, 0xffff0000, v22
    v_lshlrev_b32 v22, 16, v22
    v_mul_f32 v8, 0xc1200000, v8
    v_mul_f32 v9, 0xc1200000, v9
    v_mul_f32 v10, 0xc1200000, v10
    v_mul_f32 v11, 0xc1200000, v11
    v_mul_f32 v12, 0xc1200000, v12
    v_mul_f32 v13, 0xc1200000, v13
    v_mul_f32 v14, 0xc1200000, v14
    v_mul_f32 v15, 0xc1200000, v15
    v_mul_f32 v16, 0xc1200000, v16
    v_mul_f32 v17, 0xc1200000, v17
    v_mul_f32 v18, 0xc1200000, v18
    v_mul_f32 v19, 0xc1200000, v19
    v_mul_f32 v20, 0xc1200000, v20
    v_mul_f32 v21, 0xc1200000, v21
    v_mul_f32 v22, 0xc1200000, v22
    v_mul_f32 v23, 0xc1200000, v23
    v_cvt_pk_bf16_f32 v8, v8, v9
    v_cvt_pk_bf16_f32 v10, v10, v11
    v_cvt_pk_bf16_f32 v12, v12, v13
    v_cvt_pk_bf16_f32 v14, v14, v15
    v_cvt_pk_bf16_f32 v16, v16, v17
    v_cvt_pk_bf16_f32 v18, v18, v19
    v_cvt_pk_bf16_f32 v20, v20, v21
    v_cvt_pk_bf16_f32 v22, v22, v23
    v_and_b32 v9, 0xffff0000, v8
    v_lshlrev_b32 v8, 16, v8
    v_and_b32 v11, 0xffff0000, v10
    v_lshlrev_b32 v10, 16, v10
    v_and_b32 v13, 0xffff0000, v12
    v_lshlrev_b32 v12, 16, v12
    v_and_b32 v15, 0xffff0000, v14
    v_lshlrev_b32 v14, 16, v14
    v_and_b32 v17, 0xffff0000, v16
    v_lshlrev_b32 v16, 16, v16
    v_and_b32 v19, 0xffff0000, v18
    v_lshlrev_b32 v18, 16, v18
    v_and_b32 v21, 0xffff0000, v20
    v_lshlrev_b32 v20, 16, v20
    v_and_b32 v23, 0xffff0000, v22
    v_lshlrev_b32 v22, 16, v22
    v_mul_f32 v8, 0x3fb8aa3b, v8
    v_mul_f32 v9, 0x3fb8aa3b, v9
    v_mul_f32 v10, 0x3fb8aa3b, v10
    v_mul_f32 v11, 0x3fb8aa3b, v11
    v_mul_f32 v12, 0x3fb8aa3b, v12
    v_mul_f32 v13, 0x3fb8aa3b, v13
    v_mul_f32 v14, 0x3fb8aa3b, v14
    v_mul_f32 v15, 0x3fb8aa3b, v15
    v_mul_f32 v16, 0x3fb8aa3b, v16
    v_mul_f32 v17, 0x3fb8aa3b, v17
    v_mul_f32 v18, 0x3fb8aa3b, v18
    v_mul_f32 v19, 0x3fb8aa3b, v19
    v_mul_f32 v20, 0x3fb8aa3b, v20
    v_mul_f32 v21, 0x3fb8aa3b, v21
    v_mul_f32 v22, 0x3fb8aa3b, v22
    v_mul_f32 v23, 0x3fb8aa3b, v23
    v_exp_f32 v8, v8
    v_exp_f32 v9, v9
    v_exp_f32 v10, v10
    v_exp_f32 v11, v11
    v_exp_f32 v12, v12
    v_exp_f32 v13, v13
    v_exp_f32 v14, v14
    v_exp_f32 v15, v15
    v_exp_f32 v16, v16
    v_exp_f32 v17, v17
    v_exp_f32 v18, v18
    v_exp_f32 v19, v19
    v_exp_f32 v20, v20
    v_exp_f32 v21, v21
    v_exp_f32 v22, v22
    v_exp_f32 v23, v23
    s_nop 0
    v_cvt_pk_bf16_f32 v8, v8, v9
    v_cvt_pk_bf16_f32 v10, v10, v11
    v_cvt_pk_bf16_f32 v12, v12, v13
    v_cvt_pk_bf16_f32 v14, v14, v15
    v_cvt_pk_bf16_f32 v16, v16, v17
    v_cvt_pk_bf16_f32 v18, v18, v19
    v_cvt_pk_bf16_f32 v20, v20, v21
    v_cvt_pk_bf16_f32 v22, v22, v23
    v_and_b32 v9, 0xffff0000, v8
    v_lshlrev_b32 v8, 16, v8
    v_and_b32 v11, 0xffff0000, v10
    v_lshlrev_b32 v10, 16, v10
    v_and_b32 v13, 0xffff0000, v12
    v_lshlrev_b32 v12, 16, v12
    v_and_b32 v15, 0xffff0000, v14
    v_lshlrev_b32 v14, 16, v14
    v_and_b32 v17, 0xffff0000, v16
    v_lshlrev_b32 v16, 16, v16
    v_and_b32 v19, 0xffff0000, v18
    v_lshlrev_b32 v18, 16, v18
    v_and_b32 v21, 0xffff0000, v20
    v_lshlrev_b32 v20, 16, v20
    v_and_b32 v23, 0xffff0000, v22
    v_lshlrev_b32 v22, 16, v22
    s_lshl_b32 s14, s52, 16
    s_and_b32 s15, s52, 0xffff0000
    v_pk_mul_f32 v[24:25], v[8:9], s[14:15] op_sel:[0,0] op_sel_hi:[0,1]
    v_pk_mul_f32 v[28:29], v[16:17], s[14:15] op_sel:[0,0] op_sel_hi:[0,1]
    s_lshl_b32 s16, s53, 16
    s_and_b32 s17, s53, 0xffff0000
    v_pk_mul_f32 v[26:27], v[8:9], s[16:17] op_sel:[0,0] op_sel_hi:[0,1]
    v_pk_mul_f32 v[30:31], v[16:17], s[16:17] op_sel:[0,0] op_sel_hi:[0,1]
    s_lshl_b32 s18, s54, 16
    s_and_b32 s19, s54, 0xffff0000
    v_pk_fma_f32 v[24:25], v[8:9], s[18:19], v[24:25] op_sel:[1,0,0] op_sel_hi:[1,1,1]
    v_pk_fma_f32 v[28:29], v[16:17], s[18:19], v[28:29] op_sel:[1,0,0] op_sel_hi:[1,1,1]
    s_lshl_b32 s12, s55, 16
    s_and_b32 s13, s55, 0xffff0000
    v_pk_fma_f32 v[26:27], v[8:9], s[12:13], v[26:27] op_sel:[1,0,0] op_sel_hi:[1,1,1]
    v_pk_fma_f32 v[30:31], v[16:17], s[12:13], v[30:31] op_sel:[1,0,0] op_sel_hi:[1,1,1]
    s_lshl_b32 s14, s56, 16
    s_and_b32 s15, s56, 0xffff0000
    v_pk_fma_f32 v[24:25], v[10:11], s[14:15], v[24:25] op_sel:[0,0,0] op_sel_hi:[0,1,1]
    v_pk_fma_f32 v[28:29], v[18:19], s[14:15], v[28:29] op_sel:[0,0,0] op_sel_hi:[0,1,1]
    s_lshl_b32 s16, s57, 16
    s_and_b32 s17, s57, 0xffff0000
    v_pk_fma_f32 v[26:27], v[10:11], s[16:17], v[26:27] op_sel:[0,0,0] op_sel_hi:[0,1,1]
    v_pk_fma_f32 v[30:31], v[18:19], s[16:17], v[30:31] op_sel:[0,0,0] op_sel_hi:[0,1,1]
    s_lshl_b32 s18, s58, 16
    s_and_b32 s19, s58, 0xffff0000
    v_pk_fma_f32 v[24:25], v[10:11], s[18:19], v[24:25] op_sel:[1,0,0] op_sel_hi:[1,1,1]
    v_pk_fma_f32 v[28:29], v[18:19], s[18:19], v[28:29] op_sel:[1,0,0] op_sel_hi:[1,1,1]
    s_lshl_b32 s12, s59, 16
    s_and_b32 s13, s59, 0xffff0000
    v_pk_fma_f32 v[26:27], v[10:11], s[12:13], v[26:27] op_sel:[1,0,0] op_sel_hi:[1,1,1]
    v_pk_fma_f32 v[30:31], v[18:19], s[12:13], v[30:31] op_sel:[1,0,0] op_sel_hi:[1,1,1]
    s_lshl_b32 s14, s60, 16
    s_and_b32 s15, s60, 0xffff0000
    v_pk_fma_f32 v[24:25], v[12:13], s[14:15], v[24:25] op_sel:[0,0,0] op_sel_hi:[0,1,1]
    v_pk_fma_f32 v[28:29], v[20:21], s[14:15], v[28:29] op_sel:[0,0,0] op_sel_hi:[0,1,1]
    s_lshl_b32 s16, s61, 16
    s_and_b32 s17, s61, 0xffff0000
    v_pk_fma_f32 v[26:27], v[12:13], s[16:17], v[26:27] op_sel:[0,0,0] op_sel_hi:[0,1,1]
    v_pk_fma_f32 v[30:31], v[20:21], s[16:17], v[30:31] op_sel:[0,0,0] op_sel_hi:[0,1,1]
    s_lshl_b32 s18, s62, 16
    s_and_b32 s19, s62, 0xffff0000
    v_pk_fma_f32 v[24:25], v[12:13], s[18:19], v[24:25] op_sel:[1,0,0] op_sel_hi:[1,1,1]
    v_pk_fma_f32 v[28:29], v[20:21], s[18:19], v[28:29] op_sel:[1,0,0] op_sel_hi:[1,1,1]
    s_lshl_b32 s12, s63, 16
    s_and_b32 s13, s63, 0xffff0000
    v_pk_fma_f32 v[26:27], v[12:13], s[12:13], v[26:27] op_sel:[1,0,0] op_sel_hi:[1,1,1]
    v_pk_fma_f32 v[30:31], v[20:21], s[12:13], v[30:31] op_sel:[1,0,0] op_sel_hi:[1,1,1]
    s_lshl_b32 s14, s64, 16
    s_and_b32 s15, s64, 0xffff0000
    v_pk_fma_f32 v[24:25], v[14:15], s[14:15], v[24:25] op_sel:[0,0,0] op_sel_hi:[0,1,1]
    v_pk_fma_f32 v[28:29], v[22:23], s[14:15], v[28:29] op_sel:[0,0,0] op_sel_hi:[0,1,1]
    s_lshl_b32 s16, s65, 16
    s_and_b32 s17, s65, 0xffff0000
    v_pk_fma_f32 v[26:27], v[14:15], s[16:17], v[26:27] op_sel:[0,0,0] op_sel_hi:[0,1,1]
    v_pk_fma_f32 v[30:31], v[22:23], s[16:17], v[30:31] op_sel:[0,0,0] op_sel_hi:[0,1,1]
    s_lshl_b32 s18, s66, 16
    s_and_b32 s19, s66, 0xffff0000
    v_pk_fma_f32 v[24:25], v[14:15], s[18:19], v[24:25] op_sel:[1,0,0] op_sel_hi:[1,1,1]
    v_pk_fma_f32 v[28:29], v[22:23], s[18:19], v[28:29] op_sel:[1,0,0] op_sel_hi:[1,1,1]
    s_lshl_b32 s12, s67, 16
    s_and_b32 s13, s67, 0xffff0000
    v_pk_fma_f32 v[26:27], v[14:15], s[12:13], v[26:27] op_sel:[1,0,0] op_sel_hi:[1,1,1]
    v_pk_fma_f32 v[30:31], v[22:23], s[12:13], v[30:31] op_sel:[1,0,0] op_sel_hi:[1,1,1]
    s_lshl_b32 s14, s36, 16
    s_and_b32 s15, s36, 0xffff0000
    v_pk_mul_f32 v[32:33], v[8:9], s[14:15] op_sel:[0,0] op_sel_hi:[0,1]
    v_pk_mul_f32 v[36:37], v[16:17], s[14:15] op_sel:[0,0] op_sel_hi:[0,1]
    s_lshl_b32 s16, s37, 16
    s_and_b32 s17, s37, 0xffff0000
    v_pk_mul_f32 v[34:35], v[8:9], s[16:17] op_sel:[0,0] op_sel_hi:[0,1]
    v_pk_mul_f32 v[38:39], v[16:17], s[16:17] op_sel:[0,0] op_sel_hi:[0,1]
    s_lshl_b32 s18, s38, 16
    s_and_b32 s19, s38, 0xffff0000
    v_pk_fma_f32 v[32:33], v[8:9], s[18:19], v[32:33] op_sel:[1,0,0] op_sel_hi:[1,1,1]
    v_pk_fma_f32 v[36:37], v[16:17], s[18:19], v[36:37] op_sel:[1,0,0] op_sel_hi:[1,1,1]
    s_lshl_b32 s12, s39, 16
    s_and_b32 s13, s39, 0xffff0000
    v_pk_fma_f32 v[34:35], v[8:9], s[12:13], v[34:35] op_sel:[1,0,0] op_sel_hi:[1,1,1]
    v_pk_fma_f32 v[38:39], v[16:17], s[12:13], v[38:39] op_sel:[1,0,0] op_sel_hi:[1,1,1]
    s_lshl_b32 s14, s40, 16
    s_and_b32 s15, s40, 0xffff0000
    v_pk_fma_f32 v[32:33], v[10:11], s[14:15], v[32:33] op_sel:[0,0,0] op_sel_hi:[0,1,1]
    v_pk_fma_f32 v[36:37], v[18:19], s[14:15], v[36:37] op_sel:[0,0,0] op_sel_hi:[0,1,1]
    s_lshl_b32 s16, s41, 16
    s_and_b32 s17, s41, 0xffff0000
    v_pk_fma_f32 v[34:35], v[10:11], s[16:17], v[34:35] op_sel:[0,0,0] op_sel_hi:[0,1,1]
    v_pk_fma_f32 v[38:39], v[18:19], s[16:17], v[38:39] op_sel:[0,0,0] op_sel_hi:[0,1,1]
    s_lshl_b32 s18, s42, 16
    s_and_b32 s19, s42, 0xffff0000
    v_pk_fma_f32 v[32:33], v[10:11], s[18:19], v[32:33] op_sel:[1,0,0] op_sel_hi:[1,1,1]
    v_pk_fma_f32 v[36:37], v[18:19], s[18:19], v[36:37] op_sel:[1,0,0] op_sel_hi:[1,1,1]
    s_lshl_b32 s12, s43, 16
    s_and_b32 s13, s43, 0xffff0000
    v_pk_fma_f32 v[34:35], v[10:11], s[12:13], v[34:35] op_sel:[1,0,0] op_sel_hi:[1,1,1]
    v_pk_fma_f32 v[38:39], v[18:19], s[12:13], v[38:39] op_sel:[1,0,0] op_sel_hi:[1,1,1]
    s_lshl_b32 s14, s44, 16
    s_and_b32 s15, s44, 0xffff0000
    v_pk_fma_f32 v[32:33], v[12:13], s[14:15], v[32:33] op_sel:[0,0,0] op_sel_hi:[0,1,1]
    v_pk_fma_f32 v[36:37], v[20:21], s[14:15], v[36:37] op_sel:[0,0,0] op_sel_hi:[0,1,1]
    s_lshl_b32 s16, s45, 16
    s_and_b32 s17, s45, 0xffff0000
    v_pk_fma_f32 v[34:35], v[12:13], s[16:17], v[34:35] op_sel:[0,0,0] op_sel_hi:[0,1,1]
    v_pk_fma_f32 v[38:39], v[20:21], s[16:17], v[38:39] op_sel:[0,0,0] op_sel_hi:[0,1,1]
    s_lshl_b32 s18, s46, 16
    s_and_b32 s19, s46, 0xffff0000
    v_pk_fma_f32 v[32:33], v[12:13], s[18:19], v[32:33] op_sel:[1,0,0] op_sel_hi:[1,1,1]
    v_pk_fma_f32 v[36:37], v[20:21], s[18:19], v[36:37] op_sel:[1,0,0] op_sel_hi:[1,1,1]
    s_lshl_b32 s12, s47, 16
    s_and_b32 s13, s47, 0xffff0000
    v_pk_fma_f32 v[34:35], v[12:13], s[12:13], v[34:35] op_sel:[1,0,0] op_sel_hi:[1,1,1]
    v_pk_fma_f32 v[38:39], v[20:21], s[12:13], v[38:39] op_sel:[1,0,0] op_sel_hi:[1,1,1]
    s_lshl_b32 s14, s48, 16
    s_and_b32 s15, s48, 0xffff0000
    v_pk_fma_f32 v[32:33], v[14:15], s[14:15], v[32:33] op_sel:[0,0,0] op_sel_hi:[0,1,1]
    v_pk_fma_f32 v[36:37], v[22:23], s[14:15], v[36:37] op_sel:[0,0,0] op_sel_hi:[0,1,1]
    s_lshl_b32 s16, s49, 16
    s_and_b32 s17, s49, 0xffff0000
    v_pk_fma_f32 v[34:35], v[14:15], s[16:17], v[34:35] op_sel:[0,0,0] op_sel_hi:[0,1,1]
    v_pk_fma_f32 v[38:39], v[22:23], s[16:17], v[38:39] op_sel:[0,0,0] op_sel_hi:[0,1,1]
    s_lshl_b32 s18, s50, 16
    s_and_b32 s19, s50, 0xffff0000
    v_pk_fma_f32 v[32:33], v[14:15], s[18:19], v[32:33] op_sel:[1,0,0] op_sel_hi:[1,1,1]
    v_pk_fma_f32 v[36:37], v[22:23], s[18:19], v[36:37] op_sel:[1,0,0] op_sel_hi:[1,1,1]
    s_lshl_b32 s12, s51, 16
    s_and_b32 s13, s51, 0xffff0000
    v_pk_fma_f32 v[34:35], v[14:15], s[12:13], v[34:35] op_sel:[1,0,0] op_sel_hi:[1,1,1]
    v_pk_fma_f32 v[38:39], v[22:23], s[12:13], v[38:39] op_sel:[1,0,0] op_sel_hi:[1,1,1]
    v_cvt_pk_bf16_f32 v32, v32, v33
    v_cvt_pk_bf16_f32 v34, v34, v35
    v_cvt_pk_bf16_f32 v36, v36, v37
    v_cvt_pk_bf16_f32 v38, v38, v39
    v_and_b32 v33, 0xffff0000, v32
    v_lshlrev_b32 v32, 16, v32
    v_and_b32 v35, 0xffff0000, v34
    v_lshlrev_b32 v34, 16, v34
    v_and_b32 v37, 0xffff0000, v36
    v_lshlrev_b32 v36, 16, v36
    v_and_b32 v39, 0xffff0000, v38
    v_lshlrev_b32 v38, 16, v38
    s_waitcnt vmcnt(1)
    v_add_u32 v40, v40, v44
    v_add_u32 v48, v48, v52
    v_add_u32 v41, v41, v45
    v_add_u32 v49, v49, v53
    v_add_u32 v42, v42, v46
    v_add_u32 v50, v50, v54
    v_add_u32 v43, v43, v47
    v_add_u32 v51, v51, v55
    v_add_u32_sdwa v8, v40, v48 dst_sel:DWORD dst_unused:UNUSED_PAD src0_sel:WORD_0 src1_sel:WORD_0
    v_add_u32_sdwa v9, v40, v48 dst_sel:DWORD dst_unused:UNUSED_PAD src0_sel:WORD_1 src1_sel:WORD_1
    v_add_u32_sdwa v10, v41, v49 dst_sel:DWORD dst_unused:UNUSED_PAD src0_sel:WORD_0 src1_sel:WORD_0
    v_add_u32_sdwa v11, v41, v49 dst_sel:DWORD dst_unused:UNUSED_PAD src0_sel:WORD_1 src1_sel:WORD_1
    v_add_u32_sdwa v12, v42, v50 dst_sel:DWORD dst_unused:UNUSED_PAD src0_sel:WORD_0 src1_sel:WORD_0
    v_add_u32_sdwa v13, v42, v50 dst_sel:DWORD dst_unused:UNUSED_PAD src0_sel:WORD_1 src1_sel:WORD_1
    v_add_u32_sdwa v14, v43, v51 dst_sel:DWORD dst_unused:UNUSED_PAD src0_sel:WORD_0 src1_sel:WORD_0
    v_add_u32_sdwa v15, v43, v51 dst_sel:DWORD dst_unused:UNUSED_PAD src0_sel:WORD_1 src1_sel:WORD_1
    v_min3_u32 v5, v56, v57, v58
    v_bitop3_b32 v4, v56, v57, v58 bitop3:0xfe
    v_min_u32 v5, v5, v59
    v_or_b32 v4, v4, v59
    v_or_b32 v8, 0x4b000000, v8
    v_or_b32 v9, 0x4b000000, v9
    v_or_b32 v10, 0x4b000000, v10
    v_or_b32 v11, 0x4b000000, v11
    v_or_b32 v12, 0x4b000000, v12
    v_or_b32 v13, 0x4b000000, v13
    v_or_b32 v14, 0x4b000000, v14
    v_or_b32 v15, 0x4b000000, v15
    v_cmp_eq_u32 vcc, 0, v5
    v_add_f32 v8, 0xcb010000, v8
    v_add_f32 v9, 0xcb010000, v9
    v_add_f32 v10, 0xcb010000, v10
    v_add_f32 v11, 0xcb010000, v11
    v_add_f32 v12, 0xcb010000, v12
    v_add_f32 v13, 0xcb010000, v13
    v_add_f32 v14, 0xcb010000, v14
    v_add_f32 v15, 0xcb010000, v15
    v_mul_f32 v8, v4, v8
    v_mul_f32 v9, v4, v9
    v_mul_f32 v10, v4, v10
    v_mul_f32 v11, v4, v11
    v_mul_f32 v12, v4, v12
    v_mul_f32 v13, v4, v13
    v_mul_f32 v14, v4, v14
    v_mul_f32 v15, v4, v15
    s_cbranch_vccz p3_nof
    v_lshlrev_b32 v1, 4, v0
    v_mov_b32 v3, 0x70000000
    v_cmp_eq_u32 vcc, 0, v56
    s_mov_b32 s22, 517903360
    s_nop 0
    v_cndmask_b32 v5, v3, v1, vcc
    buffer_load_dwordx4 v[16:19], v5, s[28:31], s22 offen
    buffer_load_dwordx4 v[20:23], v5, s[28:31], s22 offen offset:16
    s_waitcnt vmcnt(0)
    v_add_f32 v8, v8, v16
    v_add_f32 v9, v9, v17
    v_add_f32 v10, v10, v18
    v_add_f32 v11, v11, v19
    v_add_f32 v12, v12, v20
    v_add_f32 v13, v13, v21
    v_add_f32 v14, v14, v22
    v_add_f32 v15, v15, v23
    v_cmp_eq_u32 vcc, 0, v57
    s_mov_b32 s22, 530715648
    s_nop 0
    v_cndmask_b32 v5, v3, v1, vcc
    buffer_load_dwordx4 v[16:19], v5, s[28:31], s22 offen
    buffer_load_dwordx4 v[20:23], v5, s[28:31], s22 offen offset:16
    s_waitcnt vmcnt(0)
    v_add_f32 v8, v8, v16
    v_add_f32 v9, v9, v17
    v_add_f32 v10, v10, v18
    v_add_f32 v11, v11, v19
    v_add_f32 v12, v12, v20
    v_add_f32 v13, v13, v21
    v_add_f32 v14, v14, v22
    v_add_f32 v15, v15, v23
    v_cmp_eq_u32 vcc, 0, v58
    s_mov_b32 s22, 543527936
    s_nop 0
    v_cndmask_b32 v5, v3, v1, vcc
    buffer_load_dwordx4 v[16:19], v5, s[28:31], s22 offen
    buffer_load_dwordx4 v[20:23], v5, s[28:31], s22 offen offset:16
    s_waitcnt vmcnt(0)
    v_add_f32 v8, v8, v16
    v_add_f32 v9, v9, v17
    v_add_f32 v10, v10, v18
    v_add_f32 v11, v11, v19
    v_add_f32 v12, v12, v20
    v_add_f32 v13, v13, v21
    v_add_f32 v14, v14, v22
    v_add_f32 v15, v15, v23
    v_cmp_eq_u32 vcc, 0, v59
    s_mov_b32 s22, 556340224
    s_nop 0
    v_cndmask_b32 v5, v3, v1, vcc
    buffer_load_dwordx4 v[16:19], v5, s[28:31], s22 offen
    buffer_load_dwordx4 v[20:23], v5, s[28:31], s22 offen offset:16
    s_waitcnt vmcnt(0)
    v_add_f32 v8, v8, v16
    v_add_f32 v9, v9, v17
    v_add_f32 v10, v10, v18
    v_add_f32 v11, v11, v19
    v_add_f32 v12, v12, v20
    v_add_f32 v13, v13, v21
    v_add_f32 v14, v14, v22
    v_add_f32 v15, v15, v23
p3_nof:
    s_lshl_b32 s14, s68, 16
    s_and_b32 s15, s68, 0xffff0000
    v_pk_mul_f32 v[16:17], v[8:9], s[14:15] op_sel:[0,0] op_sel_hi:[0,1]
    v_pk_mul_f32 v[20:21], v[12:13], s[14:15] op_sel:[0,0] op_sel_hi:[0,1]
    s_lshl_b32 s16, s69, 16
    s_and_b32 s17, s69, 0xffff0000
    v_pk_mul_f32 v[18:19], v[8:9], s[16:17] op_sel:[0,0] op_sel_hi:[0,1]
    v_pk_mul_f32 v[22:23], v[12:13], s[16:17] op_sel:[0,0] op_sel_hi:[0,1]
    s_lshl_b32 s18, s70, 16
    s_and_b32 s19, s70, 0xffff0000
    v_pk_fma_f32 v[16:17], v[8:9], s[18:19], v[16:17] op_sel:[1,0,0] op_sel_hi:[1,1,1]
    v_pk_fma_f32 v[20:21], v[12:13], s[18:19], v[20:21] op_sel:[1,0,0] op_sel_hi:[1,1,1]
    s_lshl_b32 s12, s71, 16
    s_and_b32 s13, s71, 0xffff0000
    v_pk_fma_f32 v[18:19], v[8:9], s[12:13], v[18:19] op_sel:[1,0,0] op_sel_hi:[1,1,1]
    v_pk_fma_f32 v[22:23], v[12:13], s[12:13], v[22:23] op_sel:[1,0,0] op_sel_hi:[1,1,1]
    s_lshl_b32 s14, s72, 16
    s_and_b32 s15, s72, 0xffff0000
    v_pk_fma_f32 v[16:17], v[10:11], s[14:15], v[16:17] op_sel:[0,0,0] op_sel_hi:[0,1,1]
    v_pk_fma_f32 v[20:21], v[14:15], s[14:15], v[20:21] op_sel:[0,0,0] op_sel_hi:[0,1,1]
    s_lshl_b32 s16, s73, 16
    s_and_b32 s17, s73, 0xffff0000
    v_pk_fma_f32 v[18:19], v[10:11], s[16:17], v[18:19] op_sel:[0,0,0] op_sel_hi:[0,1,1]
    v_pk_fma_f32 v[22:23], v[14:15], s[16:17], v[22:23] op_sel:[0,0,0] op_sel_hi:[0,1,1]
    s_lshl_b32 s18, s74, 16
    s_and_b32 s19, s74, 0xffff0000
    v_pk_fma_f32 v[16:17], v[10:11], s[18:19], v[16:17] op_sel:[1,0,0] op_sel_hi:[1,1,1]
    v_pk_fma_f32 v[20:21], v[14:15], s[18:19], v[20:21] op_sel:[1,0,0] op_sel_hi:[1,1,1]
    s_lshl_b32 s12, s75, 16
    s_and_b32 s13, s75, 0xffff0000
    v_pk_fma_f32 v[18:19], v[10:11], s[12:13], v[18:19] op_sel:[1,0,0] op_sel_hi:[1,1,1]
    v_pk_fma_f32 v[22:23], v[14:15], s[12:13], v[22:23] op_sel:[1,0,0] op_sel_hi:[1,1,1]
    v_mul_f32 v24, v24, v16
    v_mul_f32 v25, v25, v17
    v_mul_f32 v26, v26, v18
    v_mul_f32 v27, v27, v19
    v_mul_f32 v28, v28, v20
    v_mul_f32 v29, v29, v21
    v_mul_f32 v30, v30, v22
    v_mul_f32 v31, v31, v23
    v_cvt_pk_bf16_f32 v24, v24, v25
    v_cvt_pk_bf16_f32 v26, v26, v27
    v_cvt_pk_bf16_f32 v28, v28, v29
    v_cvt_pk_bf16_f32 v30, v30, v31
    v_and_b32 v25, 0xffff0000, v24
    v_lshlrev_b32 v24, 16, v24
    v_and_b32 v27, 0xffff0000, v26
    v_lshlrev_b32 v26, 16, v26
    v_and_b32 v29, 0xffff0000, v28
    v_lshlrev_b32 v28, 16, v28
    v_and_b32 v31, 0xffff0000, v30
    v_lshlrev_b32 v30, 16, v30
    s_lshl_b32 s14, s76, 16
    s_and_b32 s15, s76, 0xffff0000
    v_pk_mul_f32 v[16:17], v[24:25], s[14:15] op_sel:[0,0] op_sel_hi:[0,1]
    v_pk_mul_f32 v[20:21], v[28:29], s[14:15] op_sel:[0,0] op_sel_hi:[0,1]
    s_lshl_b32 s16, s77, 16
    s_and_b32 s17, s77, 0xffff0000
    v_pk_mul_f32 v[18:19], v[24:25], s[16:17] op_sel:[0,0] op_sel_hi:[0,1]
    v_pk_mul_f32 v[22:23], v[28:29], s[16:17] op_sel:[0,0] op_sel_hi:[0,1]
    s_lshl_b32 s18, s78, 16
    s_and_b32 s19, s78, 0xffff0000
    v_pk_fma_f32 v[16:17], v[24:25], s[18:19], v[16:17] op_sel:[1,0,0] op_sel_hi:[1,1,1]
    v_pk_fma_f32 v[20:21], v[28:29], s[18:19], v[20:21] op_sel:[1,0,0] op_sel_hi:[1,1,1]
    s_lshl_b32 s12, s79, 16
    s_and_b32 s13, s79, 0xffff0000
    v_pk_fma_f32 v[18:19], v[24:25], s[12:13], v[18:19] op_sel:[1,0,0] op_sel_hi:[1,1,1]
    v_pk_fma_f32 v[22:23], v[28:29], s[12:13], v[22:23] op_sel:[1,0,0] op_sel_hi:[1,1,1]
    s_lshl_b32 s14, s80, 16
    s_and_b32 s15, s80, 0xffff0000
    v_pk_fma_f32 v[16:17], v[26:27], s[14:15], v[16:17] op_sel:[0,0,0] op_sel_hi:[0,1,1]
    v_pk_fma_f32 v[20:21], v[30:31], s[14:15], v[20:21] op_sel:[0,0,0] op_sel_hi:[0,1,1]
    s_lshl_b32 s16, s81, 16
    s_and_b32 s17, s81, 0xffff0000
    v_pk_fma_f32 v[18:19], v[26:27], s[16:17], v[18:19] op_sel:[0,0,0] op_sel_hi:[0,1,1]
    v_pk_fma_f32 v[22:23], v[30:31], s[16:17], v[22:23] op_sel:[0,0,0] op_sel_hi:[0,1,1]
    s_lshl_b32 s18, s82, 16
    s_and_b32 s19, s82, 0xffff0000
    v_pk_fma_f32 v[16:17], v[26:27], s[18:19], v[16:17] op_sel:[1,0,0] op_sel_hi:[1,1,1]
    v_pk_fma_f32 v[20:21], v[30:31], s[18:19], v[20:21] op_sel:[1,0,0] op_sel_hi:[1,1,1]
    s_lshl_b32 s12, s83, 16
    s_and_b32 s13, s83, 0xffff0000
    v_pk_fma_f32 v[18:19], v[26:27], s[12:13], v[18:19] op_sel:[1,0,0] op_sel_hi:[1,1,1]
    v_pk_fma_f32 v[22:23], v[30:31], s[12:13], v[22:23] op_sel:[1,0,0] op_sel_hi:[1,1,1]
    v_cvt_pk_bf16_f32 v16, v16, v17
    v_cvt_pk_bf16_f32 v18, v18, v19
    v_cvt_pk_bf16_f32 v20, v20, v21
    v_cvt_pk_bf16_f32 v22, v22, v23
    v_and_b32 v17, 0xffff0000, v16
    v_lshlrev_b32 v16, 16, v16
    v_and_b32 v19, 0xffff0000, v18
    v_lshlrev_b32 v18, 16, v18
    v_and_b32 v21, 0xffff0000, v20
    v_lshlrev_b32 v20, 16, v20
    v_and_b32 v23, 0xffff0000, v22
    v_lshlrev_b32 v22, 16, v22
    v_mul_f32 v16, v16, v32
    v_mul_f32 v17, v17, v33
    v_mul_f32 v18, v18, v34
    v_mul_f32 v19, v19, v35
    v_mul_f32 v20, v20, v36
    v_mul_f32 v21, v21, v37
    v_mul_f32 v22, v22, v38
    v_mul_f32 v23, v23, v39
    v_cvt_pk_bf16_f32 v16, v16, v17
    v_cvt_pk_bf16_f32 v18, v18, v19
    v_cvt_pk_bf16_f32 v20, v20, v21
    v_cvt_pk_bf16_f32 v22, v22, v23
    v_and_b32 v17, 0xffff0000, v16
    v_lshlrev_b32 v16, 16, v16
    v_and_b32 v19, 0xffff0000, v18
    v_lshlrev_b32 v18, 16, v18
    v_and_b32 v21, 0xffff0000, v20
    v_lshlrev_b32 v20, 16, v20
    v_and_b32 v23, 0xffff0000, v22
    v_lshlrev_b32 v22, 16, v22
    s_waitcnt vmcnt(0)
    v_lshlrev_b32 v8, 16, v60
    v_and_b32 v9, 0xffff0000, v60
    v_lshlrev_b32 v10, 16, v61
    v_and_b32 v11, 0xffff0000, v61
    v_lshlrev_b32 v12, 16, v62
    v_and_b32 v13, 0xffff0000, v62
    v_lshlrev_b32 v14, 16, v63
    v_and_b32 v15, 0xffff0000, v63
    v_add_f32 v8, v8, v16
    v_add_f32 v9, v9, v17
    v_add_f32 v10, v10, v18
    v_add_f32 v11, v11, v19
    v_add_f32 v12, v12, v20
    v_add_f32 v13, v13, v21
    v_add_f32 v14, v14, v22
    v_add_f32 v15, v15, v23
    v_cvt_pk_bf16_f32 v4, v8, v9
    v_cvt_pk_bf16_f32 v5, v10, v11
    v_cvt_pk_bf16_f32 v6, v12, v13
    v_cvt_pk_bf16_f32 v7, v14, v15
    buffer_store_dwordx4 v[4:7], v2, s[24:27], 0 offen nt
p3_end:
    s_endpgm
.section .rodata,"a"
.p2align 6
.amdhsa_kernel p1_kernel
  .amdhsa_next_free_vgpr 128
  .amdhsa_next_free_sgpr 72
  .amdhsa_accum_offset 128
  .amdhsa_group_segment_fixed_size 0
  .amdhsa_kernarg_size 112
  .amdhsa_user_sgpr_count 2
  .amdhsa_user_sgpr_kernarg_segment_ptr 1
  .amdhsa_system_sgpr_workgroup_id_x 1
  .amdhsa_float_denorm_mode_32 3
.end_amdhsa_kernel
.p2align 6
.amdhsa_kernel p2_kernel
  .amdhsa_next_free_vgpr 128
  .amdhsa_next_free_sgpr 72
  .amdhsa_accum_offset 128
  .amdhsa_group_segment_fixed_size 0
  .amdhsa_kernarg_size 112
  .amdhsa_user_sgpr_count 2
  .amdhsa_user_sgpr_kernarg_segment_ptr 1
  .amdhsa_system_sgpr_workgroup_id_x 1
  .amdhsa_float_denorm_mode_32 3
.end_amdhsa_kernel
.p2align 6
.amdhsa_kernel p3_kernel
  .amdhsa_next_free_vgpr 64
  .amdhsa_next_free_sgpr 84
  .amdhsa_accum_offset 64
  .amdhsa_group_segment_fixed_size 0
  .amdhsa_kernarg_size 112
  .amdhsa_user_sgpr_count 2
  .amdhsa_user_sgpr_kernarg_segment_ptr 1
  .amdhsa_system_sgpr_workgroup_id_x 1
  .amdhsa_float_denorm_mode_32 3
.end_amdhsa_kernel
```

```asm
; @launch kernel=p1_kernel grid=(256,1,1) block=(1024,1,1) lds=163072
; @launch kernel=p2_kernel grid=(256,1,1) block=(1024,1,1) lds=154368
; @launch kernel=p3_kernel grid=(1563,1,1) block=(256,1,1) lds=0
.amdgcn_target "amdgcn-amd-amdhsa--gfx950"
.text
.globl p1_kernel
.p2align 8
.type p1_kernel,@function
p1_kernel:
    s_cmp_ge_u32 s2, 256
    s_cbranch_scc1 p1_end
    s_load_dwordx2 s[52:53], s[0:1], 0
    s_load_dwordx4 s[56:59], s[0:1], 8
    s_load_dwordx2 s[54:55], s[0:1], 32
    s_load_dwordx2 s[60:61], s[0:1], 48
    s_load_dwordx2 s[48:49], s[0:1], 104
    s_load_dwordx2 s[62:63], s[0:1], 96
    v_lshlrev_b32 v1, 4, v0
    v_lshlrev_b32 v2, 3, v0
    v_mov_b32 v3, 1
    v_lshrrev_b32 v117, 6, v0
    s_nop 0
    v_readfirstlane_b32 s28, v117
    s_waitcnt lgkmcnt(0)
    s_load_dword s45, s[60:61], 0
    s_mov_b32 s4, s56
    s_and_b32 s5, s57, 0xffff
    s_mov_b32 s6, 204800000
    s_mov_b32 s7, 0x20000
    s_mov_b32 s8, s58
    s_and_b32 s9, s59, 0xffff
    s_mov_b32 s10, 204800000
    s_mov_b32 s11, 0x20000
    s_mov_b32 s12, s54
    s_and_b32 s13, s55, 0xffff
    s_mov_b32 s14, 102400000
    s_mov_b32 s15, 0x20000
    s_mov_b32 s16, s48
    s_and_b32 s17, s49, 0xffff
    s_mov_b32 s18, 819200000
    s_mov_b32 s19, 0x20000
    s_mov_b32 s29, s2
    s_mul_i32 s31, s2, 73728
    s_lshl_b32 s30, s31, 1
    s_add_u32 s32, s30, 0
    buffer_load_dwordx4 v[94:97], v1, s[4:7], s32 offen nt
    buffer_load_dwordx4 v[102:105], v1, s[8:11], s32 offen nt
    s_add_u32 s32, s31, 0
    buffer_load_dwordx2 v[76:77], v2, s[12:15], s32 offen nt
    s_add_u32 s32, s30, 16384
    buffer_load_dwordx4 v[98:101], v1, s[4:7], s32 offen nt
    buffer_load_dwordx4 v[106:109], v1, s[8:11], s32 offen nt
    s_add_u32 s32, s31, 8192
    buffer_load_dwordx2 v[78:79], v2, s[12:15], s32 offen nt
    s_add_u32 s32, s30, 32768
    buffer_load_dwordx4 v[12:15], v1, s[4:7], s32 offen nt
    buffer_load_dwordx4 v[48:51], v1, s[8:11], s32 offen nt
    s_add_u32 s32, s31, 16384
    buffer_load_dwordx2 v[80:81], v2, s[12:15], s32 offen nt
    s_add_u32 s32, s31, 24576
    buffer_load_dwordx2 v[82:83], v2, s[12:15], s32 offen nt
    s_add_u32 s32, s31, 32768
    buffer_load_dwordx2 v[84:85], v2, s[12:15], s32 offen nt
    s_add_u32 s32, s31, 40960
    buffer_load_dwordx2 v[86:87], v2, s[12:15], s32 offen nt
    s_add_u32 s32, s31, 49152
    buffer_load_dwordx2 v[88:89], v2, s[12:15], s32 offen nt
    s_add_u32 s32, s31, 57344
    buffer_load_dwordx2 v[90:91], v2, s[12:15], s32 offen nt
    s_add_u32 s32, s31, 65536
    buffer_load_dwordx2 v[92:93], v2, s[12:15], s32 offen nt
    s_mov_b32 s24, s52
    s_and_b32 s25, s53, 0xffff
    s_mov_b32 s26, 6400000
    s_mov_b32 s27, 0x20000
    s_mov_b32 s20, s48
    s_and_b32 s21, s49, 0xffff
    s_mov_b32 s22, 0
    s_mov_b32 s23, 0x20000
    s_mov_b32 s40, s62
    s_and_b32 s41, s63, 0xffff
    s_mov_b32 s42, 256
    s_mov_b32 s43, 0x20000
    s_mov_b32 s36, 643827
    s_mov_b32 s37, 214609
    s_mov_b32 s38, 343268
    s_mov_b32 s39, -6671
    s_mov_b32 s44, -12512
    s_mov_b32 s34, 1
    v_mov_b32 v73, 0x40000000
    v_mov_b32 v122, 0
    v_mov_b32 v123, 0
    v_mov_b32 v124, 0
    v_mov_b32 v125, 0
    ds_write_b128 v1, v[122:125] offset:0
    s_waitcnt lgkmcnt(0)
    s_barrier
    s_lshl_b32 s45, s45, 16
p1_tile:
    v_mov_b32 v122, 0
    v_mov_b32 v123, 0
    v_mov_b32 v124, 0
    v_mov_b32 v125, 0
    ds_write_b128 v1, v[122:125] offset:10496
    ds_write_b128 v1, v[122:125] offset:26880
    ds_write_b128 v1, v[122:125] offset:43264
    s_cmp_lg_u32 s28, 15
    s_cbranch_scc1 p1_tk0
    v_mov_b32 v127, 1
    s_mov_b64 exec, 1
    buffer_atomic_add v127, off, s[40:43], 0 offset:128 sc0 sc1
    s_mov_b64 exec, -1
p1_tk0:
    v_mov_b32 v123, s45
    v_mov_b32 v124, 0x007f007f
    v_mov_b32 v125, 0xe000
    v_mov_b32 v126, 0xffff0000
    s_cmp_lt_u32 s29, 1426
    s_cselect_b32 s6, 204800000, 0
    s_cselect_b32 s10, 204800000, 0
    s_add_u32 s32, s30, 49152
    buffer_load_dwordx4 v[16:19], v1, s[4:7], s32 offen nt
    buffer_load_dwordx4 v[52:55], v1, s[8:11], s32 offen nt
    s_waitcnt vmcnt(14)
    v_lshlrev_b32 v117, 16, v76
    v_and_b32 v118, v126, v76
    v_mul_f32 v117, v123, v117
    v_mul_f32 v118, v123, v118
    v_cvt_pk_bf16_f32 v117, v117, v118
    v_and_b32 v118, v126, v117
    v_lshlrev_b32 v117, 16, v117
    v_mul_f32 v117, 0.15915494, v117
    v_mul_f32 v118, 0.15915494, v118
    v_fract_f32 v117, v117
    v_fract_f32 v118, v118
    v_cos_f32 v117, v117
    v_cos_f32 v118, v118
    v_mul_hi_u32_u24 v122, s38, v102
    v_mul_hi_u32_u24 v121, s37, v94
    v_mul_hi_u32_u24 v120, s36, v94
    v_mad_i32_i24 v110, v122, s44, v102
    v_mad_u32_u24 v40, v122, 40, v121
    v_mad_i32_i24 v4, v120, s39, v94
    v_lshlrev_b16 v40, 2, v40
    v_mad_i32_i24 v120, v121, -3, v120
    ds_add_u32 v40, v3 offset:0
    v_lshl_or_b32 v4, v110, 16, v4
    v_lshl_or_b32 v4, v120, 30, v4
    v_mul_f32 v117, 0x03800000, v117
    v_mul_f32 v118, 0x03800000, v118
    v_cvt_pk_bf16_f32 v117, v117, v118
    v_mul_hi_u32_u24 v122, s38, v103
    v_mul_hi_u32_u24 v121, s37, v95
    v_mul_hi_u32_u24 v120, s36, v95
    v_mad_i32_i24 v110, v122, s44, v103
    v_mad_u32_u24 v41, v122, 40, v121
    v_mad_i32_i24 v5, v120, s39, v95
    v_lshlrev_b16 v41, 2, v41
    v_mad_i32_i24 v120, v121, -3, v120
    ds_add_u32 v41, v3 offset:0
    v_lshl_or_b32 v5, v110, 16, v5
    v_lshl_or_b32 v5, v120, 30, v5
    v_lshrrev_b32 v118, 3, v117
    v_lshrrev_b32 v119, 8, v117
    v_lshlrev_b16 v117, 13, v117
    v_bitop3_b32 v119, v118, v119, v124 bitop3:0x1b
    v_bitop3_b32 v4, v117, v125, v4 bitop3:0xae
    v_lshl_or_b32 v40, v119, 16, v40
    v_bitop3_b32 v5, v118, v125, v5 bitop3:0xae
    v_bitop3_b32 v41, v119, v126, v41 bitop3:0xea
    v_lshlrev_b32 v117, 16, v77
    v_and_b32 v118, v126, v77
    v_mul_f32 v117, v123, v117
    v_mul_f32 v118, v123, v118
    v_cvt_pk_bf16_f32 v117, v117, v118
    v_and_b32 v118, v126, v117
    v_lshlrev_b32 v117, 16, v117
    v_mul_f32 v117, 0.15915494, v117
    v_mul_f32 v118, 0.15915494, v118
    v_fract_f32 v117, v117
    v_fract_f32 v118, v118
    v_cos_f32 v117, v117
    v_cos_f32 v118, v118
    v_mul_hi_u32_u24 v122, s38, v104
    v_mul_hi_u32_u24 v121, s37, v96
    v_mul_hi_u32_u24 v120, s36, v96
    v_mad_i32_i24 v110, v122, s44, v104
    v_mad_u32_u24 v42, v122, 40, v121
    v_mad_i32_i24 v6, v120, s39, v96
    v_lshlrev_b16 v42, 2, v42
    v_mad_i32_i24 v120, v121, -3, v120
    ds_add_u32 v42, v3 offset:0
    v_lshl_or_b32 v6, v110, 16, v6
    v_lshl_or_b32 v6, v120, 30, v6
    v_mul_f32 v117, 0x03800000, v117
    v_mul_f32 v118, 0x03800000, v118
    v_cvt_pk_bf16_f32 v117, v117, v118
    v_mul_hi_u32_u24 v122, s38, v105
    v_mul_hi_u32_u24 v121, s37, v97
    v_mul_hi_u32_u24 v120, s36, v97
    v_mad_i32_i24 v110, v122, s44, v105
    v_mad_u32_u24 v43, v122, 40, v121
    v_mad_i32_i24 v7, v120, s39, v97
    v_lshlrev_b16 v43, 2, v43
    v_mad_i32_i24 v120, v121, -3, v120
    ds_add_u32 v43, v3 offset:0
    v_lshl_or_b32 v7, v110, 16, v7
    v_lshl_or_b32 v7, v120, 30, v7
    v_lshrrev_b32 v118, 3, v117
    v_lshrrev_b32 v119, 8, v117
    v_lshlrev_b16 v117, 13, v117
    v_bitop3_b32 v119, v118, v119, v124 bitop3:0x1b
    v_bitop3_b32 v6, v117, v125, v6 bitop3:0xae
    v_lshl_or_b32 v42, v119, 16, v42
    v_bitop3_b32 v7, v118, v125, v7 bitop3:0xae
    v_bitop3_b32 v43, v119, v126, v43 bitop3:0xea
    s_cmp_lt_u32 s29, 1389
    s_cselect_b32 s6, 204800000, 0
    s_cselect_b32 s10, 204800000, 0
    s_add_u32 s32, s30, 65536
    buffer_load_dwordx4 v[20:23], v1, s[4:7], s32 offen nt
    buffer_load_dwordx4 v[56:59], v1, s[8:11], s32 offen nt
    s_cmp_ge_u32 s29, 1499
    s_cbranch_scc1 p1_k2
    s_cmp_lg_u32 s34, 0
    s_cbranch_scc1 p1_w3
    s_waitcnt vmcnt(10)
p1_w3:
    s_waitcnt vmcnt(13)
    v_lshlrev_b32 v117, 16, v78
    v_and_b32 v118, v126, v78
    v_mul_f32 v117, v123, v117
    v_mul_f32 v118, v123, v118
    v_cvt_pk_bf16_f32 v117, v117, v118
    v_and_b32 v118, v126, v117
    v_lshlrev_b32 v117, 16, v117
    v_mul_f32 v117, 0.15915494, v117
    v_mul_f32 v118, 0.15915494, v118
    v_fract_f32 v117, v117
    v_fract_f32 v118, v118
    v_cos_f32 v117, v117
    v_cos_f32 v118, v118
    v_mul_hi_u32_u24 v122, s38, v106
    v_mul_hi_u32_u24 v121, s37, v98
    v_mul_hi_u32_u24 v120, s36, v98
    v_mad_i32_i24 v110, v122, s44, v106
    v_mad_u32_u24 v44, v122, 40, v121
    v_mad_i32_i24 v8, v120, s39, v98
    v_lshlrev_b16 v44, 2, v44
    v_mad_i32_i24 v120, v121, -3, v120
    ds_add_u32 v44, v3 offset:0
    v_lshl_or_b32 v8, v110, 16, v8
    v_lshl_or_b32 v8, v120, 30, v8
    v_mul_f32 v117, 0x03800000, v117
    v_mul_f32 v118, 0x03800000, v118
    v_cvt_pk_bf16_f32 v117, v117, v118
    v_mul_hi_u32_u24 v122, s38, v107
    v_mul_hi_u32_u24 v121, s37, v99
    v_mul_hi_u32_u24 v120, s36, v99
    v_mad_i32_i24 v110, v122, s44, v107
    v_mad_u32_u24 v45, v122, 40, v121
    v_mad_i32_i24 v9, v120, s39, v99
    v_lshlrev_b16 v45, 2, v45
    v_mad_i32_i24 v120, v121, -3, v120
    ds_add_u32 v45, v3 offset:0
    v_lshl_or_b32 v9, v110, 16, v9
    v_lshl_or_b32 v9, v120, 30, v9
    v_lshrrev_b32 v118, 3, v117
    v_lshrrev_b32 v119, 8, v117
    v_lshlrev_b16 v117, 13, v117
    v_bitop3_b32 v119, v118, v119, v124 bitop3:0x1b
    v_bitop3_b32 v8, v117, v125, v8 bitop3:0xae
    v_lshl_or_b32 v44, v119, 16, v44
    v_bitop3_b32 v9, v118, v125, v9 bitop3:0xae
    v_bitop3_b32 v45, v119, v126, v45 bitop3:0xea
    v_lshlrev_b32 v117, 16, v79
    v_and_b32 v118, v126, v79
    v_mul_f32 v117, v123, v117
    v_mul_f32 v118, v123, v118
    v_cvt_pk_bf16_f32 v117, v117, v118
    v_and_b32 v118, v126, v117
    v_lshlrev_b32 v117, 16, v117
    v_mul_f32 v117, 0.15915494, v117
    v_mul_f32 v118, 0.15915494, v118
    v_fract_f32 v117, v117
    v_fract_f32 v118, v118
    v_cos_f32 v117, v117
    v_cos_f32 v118, v118
    v_mul_hi_u32_u24 v122, s38, v108
    v_mul_hi_u32_u24 v121, s37, v100
    v_mul_hi_u32_u24 v120, s36, v100
    v_mad_i32_i24 v110, v122, s44, v108
    v_mad_u32_u24 v46, v122, 40, v121
    v_mad_i32_i24 v10, v120, s39, v100
    v_lshlrev_b16 v46, 2, v46
    v_mad_i32_i24 v120, v121, -3, v120
    ds_add_u32 v46, v3 offset:0
    v_lshl_or_b32 v10, v110, 16, v10
    v_lshl_or_b32 v10, v120, 30, v10
    v_mul_f32 v117, 0x03800000, v117
    v_mul_f32 v118, 0x03800000, v118
    v_cvt_pk_bf16_f32 v117, v117, v118
    v_mul_hi_u32_u24 v122, s38, v109
    v_mul_hi_u32_u24 v121, s37, v101
    v_mul_hi_u32_u24 v120, s36, v101
    v_mad_i32_i24 v110, v122, s44, v109
    v_mad_u32_u24 v47, v122, 40, v121
    v_mad_i32_i24 v11, v120, s39, v101
    v_lshlrev_b16 v47, 2, v47
    v_mad_i32_i24 v120, v121, -3, v120
    ds_add_u32 v47, v3 offset:0
    v_lshl_or_b32 v11, v110, 16, v11
    v_lshl_or_b32 v11, v120, 30, v11
    v_lshrrev_b32 v118, 3, v117
    v_lshrrev_b32 v119, 8, v117
    v_lshlrev_b16 v117, 13, v117
    v_bitop3_b32 v119, v118, v119, v124 bitop3:0x1b
    v_bitop3_b32 v10, v117, v125, v10 bitop3:0xae
    v_lshl_or_b32 v46, v119, 16, v46
    v_bitop3_b32 v11, v118, v125, v11 bitop3:0xae
    v_bitop3_b32 v47, v119, v126, v47 bitop3:0xea
p1_k2:
    s_cmp_lt_u32 s29, 1352
    s_cselect_b32 s6, 204800000, 0
    s_cselect_b32 s10, 204800000, 0
    s_add_u32 s32, s30, 81920
    buffer_load_dwordx4 v[24:27], v1, s[4:7], s32 offen nt
    buffer_load_dwordx4 v[60:63], v1, s[8:11], s32 offen nt
    s_cmp_ge_u32 s29, 1462
    s_cbranch_scc1 p1_k4
    s_cmp_lg_u32 s34, 0
    s_cbranch_scc1 p1_w5
    s_waitcnt vmcnt(6)
p1_w5:
    s_waitcnt vmcnt(11)
    v_lshlrev_b32 v117, 16, v80
    v_and_b32 v118, v126, v80
    v_mul_f32 v117, v123, v117
    v_mul_f32 v118, v123, v118
    v_cvt_pk_bf16_f32 v117, v117, v118
    v_and_b32 v118, v126, v117
    v_lshlrev_b32 v117, 16, v117
    v_mul_f32 v117, 0.15915494, v117
    v_mul_f32 v118, 0.15915494, v118
    v_fract_f32 v117, v117
    v_fract_f32 v118, v118
    v_cos_f32 v117, v117
    v_cos_f32 v118, v118
    v_mul_hi_u32_u24 v122, s38, v48
    v_mul_hi_u32_u24 v121, s37, v12
    v_mul_hi_u32_u24 v120, s36, v12
    v_mad_i32_i24 v110, v122, s44, v48
    v_mad_u32_u24 v48, v122, 40, v121
    v_mad_i32_i24 v12, v120, s39, v12
    v_lshlrev_b16 v48, 2, v48
    v_mad_i32_i24 v120, v121, -3, v120
    ds_add_u32 v48, v3 offset:0
    v_lshl_or_b32 v12, v110, 16, v12
    v_lshl_or_b32 v12, v120, 30, v12
    v_mul_f32 v117, 0x03800000, v117
    v_mul_f32 v118, 0x03800000, v118
    v_cvt_pk_bf16_f32 v117, v117, v118
    v_mul_hi_u32_u24 v122, s38, v49
    v_mul_hi_u32_u24 v121, s37, v13
    v_mul_hi_u32_u24 v120, s36, v13
    v_mad_i32_i24 v110, v122, s44, v49
    v_mad_u32_u24 v49, v122, 40, v121
    v_mad_i32_i24 v13, v120, s39, v13
    v_lshlrev_b16 v49, 2, v49
    v_mad_i32_i24 v120, v121, -3, v120
    ds_add_u32 v49, v3 offset:0
    v_lshl_or_b32 v13, v110, 16, v13
    v_lshl_or_b32 v13, v120, 30, v13
    v_lshrrev_b32 v118, 3, v117
    v_lshrrev_b32 v119, 8, v117
    v_lshlrev_b16 v117, 13, v117
    v_bitop3_b32 v119, v118, v119, v124 bitop3:0x1b
    v_bitop3_b32 v12, v117, v125, v12 bitop3:0xae
    v_lshl_or_b32 v48, v119, 16, v48
    v_bitop3_b32 v13, v118, v125, v13 bitop3:0xae
    v_bitop3_b32 v49, v119, v126, v49 bitop3:0xea
    v_lshlrev_b32 v117, 16, v81
    v_and_b32 v118, v126, v81
    v_mul_f32 v117, v123, v117
    v_mul_f32 v118, v123, v118
    v_cvt_pk_bf16_f32 v117, v117, v118
    v_and_b32 v118, v126, v117
    v_lshlrev_b32 v117, 16, v117
    v_mul_f32 v117, 0.15915494, v117
    v_mul_f32 v118, 0.15915494, v118
    v_fract_f32 v117, v117
    v_fract_f32 v118, v118
    v_cos_f32 v117, v117
    v_cos_f32 v118, v118
    v_mul_hi_u32_u24 v122, s38, v50
    v_mul_hi_u32_u24 v121, s37, v14
    v_mul_hi_u32_u24 v120, s36, v14
    v_mad_i32_i24 v110, v122, s44, v50
    v_mad_u32_u24 v50, v122, 40, v121
    v_mad_i32_i24 v14, v120, s39, v14
    v_lshlrev_b16 v50, 2, v50
    v_mad_i32_i24 v120, v121, -3, v120
    ds_add_u32 v50, v3 offset:0
    v_lshl_or_b32 v14, v110, 16, v14
    v_lshl_or_b32 v14, v120, 30, v14
    v_mul_f32 v117, 0x03800000, v117
    v_mul_f32 v118, 0x03800000, v118
    v_cvt_pk_bf16_f32 v117, v117, v118
    v_mul_hi_u32_u24 v122, s38, v51
    v_mul_hi_u32_u24 v121, s37, v15
    v_mul_hi_u32_u24 v120, s36, v15
    v_mad_i32_i24 v110, v122, s44, v51
    v_mad_u32_u24 v51, v122, 40, v121
    v_mad_i32_i24 v15, v120, s39, v15
    v_lshlrev_b16 v51, 2, v51
    v_mad_i32_i24 v120, v121, -3, v120
    ds_add_u32 v51, v3 offset:0
    v_lshl_or_b32 v15, v110, 16, v15
    v_lshl_or_b32 v15, v120, 30, v15
    v_lshrrev_b32 v118, 3, v117
    v_lshrrev_b32 v119, 8, v117
    v_lshlrev_b16 v117, 13, v117
    v_bitop3_b32 v119, v118, v119, v124 bitop3:0x1b
    v_bitop3_b32 v14, v117, v125, v14 bitop3:0xae
    v_lshl_or_b32 v50, v119, 16, v50
    v_bitop3_b32 v15, v118, v125, v15 bitop3:0xae
    v_bitop3_b32 v51, v119, v126, v51 bitop3:0xea
p1_k4:
    s_cmp_lt_u32 s29, 1315
    s_cselect_b32 s6, 204800000, 0
    s_cselect_b32 s10, 204800000, 0
    s_add_u32 s32, s30, 98304
    buffer_load_dwordx4 v[28:31], v1, s[4:7], s32 offen nt
    buffer_load_dwordx4 v[64:67], v1, s[8:11], s32 offen nt
    s_cmp_ge_u32 s29, 1426
    s_cbranch_scc1 p1_k6
    s_waitcnt vmcnt(6)
    v_lshlrev_b32 v117, 16, v82
    v_and_b32 v118, v126, v82
    v_mul_f32 v117, v123, v117
    v_mul_f32 v118, v123, v118
    v_cvt_pk_bf16_f32 v117, v117, v118
    v_and_b32 v118, v126, v117
    v_lshlrev_b32 v117, 16, v117
    v_mul_f32 v117, 0.15915494, v117
    v_mul_f32 v118, 0.15915494, v118
    v_fract_f32 v117, v117
    v_fract_f32 v118, v118
    v_cos_f32 v117, v117
    v_cos_f32 v118, v118
    v_mul_hi_u32_u24 v122, s38, v52
    v_mul_hi_u32_u24 v121, s37, v16
    v_mul_hi_u32_u24 v120, s36, v16
    v_mad_i32_i24 v110, v122, s44, v52
    v_mad_u32_u24 v52, v122, 40, v121
    v_mad_i32_i24 v16, v120, s39, v16
    v_lshlrev_b16 v52, 2, v52
    v_mad_i32_i24 v120, v121, -3, v120
    ds_add_u32 v52, v3 offset:0
    v_lshl_or_b32 v16, v110, 16, v16
    v_lshl_or_b32 v16, v120, 30, v16
    v_mul_f32 v117, 0x03800000, v117
    v_mul_f32 v118, 0x03800000, v118
    v_cvt_pk_bf16_f32 v117, v117, v118
    v_mul_hi_u32_u24 v122, s38, v53
    v_mul_hi_u32_u24 v121, s37, v17
    v_mul_hi_u32_u24 v120, s36, v17
    v_mad_i32_i24 v110, v122, s44, v53
    v_mad_u32_u24 v53, v122, 40, v121
    v_mad_i32_i24 v17, v120, s39, v17
    v_lshlrev_b16 v53, 2, v53
    v_mad_i32_i24 v120, v121, -3, v120
    ds_add_u32 v53, v3 offset:0
    v_lshl_or_b32 v17, v110, 16, v17
    v_lshl_or_b32 v17, v120, 30, v17
    v_lshrrev_b32 v118, 3, v117
    v_lshrrev_b32 v119, 8, v117
    v_lshlrev_b16 v117, 13, v117
    v_bitop3_b32 v119, v118, v119, v124 bitop3:0x1b
    v_bitop3_b32 v16, v117, v125, v16 bitop3:0xae
    v_lshl_or_b32 v52, v119, 16, v52
    v_bitop3_b32 v17, v118, v125, v17 bitop3:0xae
    v_bitop3_b32 v53, v119, v126, v53 bitop3:0xea
    v_lshlrev_b32 v117, 16, v83
    v_and_b32 v118, v126, v83
    v_mul_f32 v117, v123, v117
    v_mul_f32 v118, v123, v118
    v_cvt_pk_bf16_f32 v117, v117, v118
    v_and_b32 v118, v126, v117
    v_lshlrev_b32 v117, 16, v117
    v_mul_f32 v117, 0.15915494, v117
    v_mul_f32 v118, 0.15915494, v118
    v_fract_f32 v117, v117
    v_fract_f32 v118, v118
    v_cos_f32 v117, v117
    v_cos_f32 v118, v118
    v_mul_hi_u32_u24 v122, s38, v54
    v_mul_hi_u32_u24 v121, s37, v18
    v_mul_hi_u32_u24 v120, s36, v18
    v_mad_i32_i24 v110, v122, s44, v54
    v_mad_u32_u24 v54, v122, 40, v121
    v_mad_i32_i24 v18, v120, s39, v18
    v_lshlrev_b16 v54, 2, v54
    v_mad_i32_i24 v120, v121, -3, v120
    ds_add_u32 v54, v3 offset:0
    v_lshl_or_b32 v18, v110, 16, v18
    v_lshl_or_b32 v18, v120, 30, v18
    v_mul_f32 v117, 0x03800000, v117
    v_mul_f32 v118, 0x03800000, v118
    v_cvt_pk_bf16_f32 v117, v117, v118
    v_mul_hi_u32_u24 v122, s38, v55
    v_mul_hi_u32_u24 v121, s37, v19
    v_mul_hi_u32_u24 v120, s36, v19
    v_mad_i32_i24 v110, v122, s44, v55
    v_mad_u32_u24 v55, v122, 40, v121
    v_mad_i32_i24 v19, v120, s39, v19
    v_lshlrev_b16 v55, 2, v55
    v_mad_i32_i24 v120, v121, -3, v120
    ds_add_u32 v55, v3 offset:0
    v_lshl_or_b32 v19, v110, 16, v19
    v_lshl_or_b32 v19, v120, 30, v19
    v_lshrrev_b32 v118, 3, v117
    v_lshrrev_b32 v119, 8, v117
    v_lshlrev_b16 v117, 13, v117
    v_bitop3_b32 v119, v118, v119, v124 bitop3:0x1b
    v_bitop3_b32 v18, v117, v125, v18 bitop3:0xae
    v_lshl_or_b32 v54, v119, 16, v54
    v_bitop3_b32 v19, v118, v125, v19 bitop3:0xae
    v_bitop3_b32 v55, v119, v126, v55 bitop3:0xea
p1_k6:
    s_cmp_lt_u32 s29, 1279
    s_cselect_b32 s6, 204800000, 0
    s_cselect_b32 s10, 204800000, 0
    s_add_u32 s32, s30, 114688
    buffer_load_dwordx4 v[32:35], v1, s[4:7], s32 offen nt
    buffer_load_dwordx4 v[68:71], v1, s[8:11], s32 offen nt
    s_cmp_ge_u32 s29, 1389
    s_cbranch_scc1 p1_k8
    s_waitcnt vmcnt(6)
    v_lshlrev_b32 v117, 16, v84
    v_and_b32 v118, v126, v84
    v_mul_f32 v117, v123, v117
    v_mul_f32 v118, v123, v118
    v_cvt_pk_bf16_f32 v117, v117, v118
    v_and_b32 v118, v126, v117
    v_lshlrev_b32 v117, 16, v117
    v_mul_f32 v117, 0.15915494, v117
    v_mul_f32 v118, 0.15915494, v118
    v_fract_f32 v117, v117
    v_fract_f32 v118, v118
    v_cos_f32 v117, v117
    v_cos_f32 v118, v118
    v_mul_hi_u32_u24 v122, s38, v56
    v_mul_hi_u32_u24 v121, s37, v20
    v_mul_hi_u32_u24 v120, s36, v20
    v_mad_i32_i24 v110, v122, s44, v56
    v_mad_u32_u24 v56, v122, 40, v121
    v_mad_i32_i24 v20, v120, s39, v20
    v_lshlrev_b16 v56, 2, v56
    v_mad_i32_i24 v120, v121, -3, v120
    ds_add_u32 v56, v3 offset:0
    v_lshl_or_b32 v20, v110, 16, v20
    v_lshl_or_b32 v20, v120, 30, v20
    v_mul_f32 v117, 0x03800000, v117
    v_mul_f32 v118, 0x03800000, v118
    v_cvt_pk_bf16_f32 v117, v117, v118
    v_mul_hi_u32_u24 v122, s38, v57
    v_mul_hi_u32_u24 v121, s37, v21
    v_mul_hi_u32_u24 v120, s36, v21
    v_mad_i32_i24 v110, v122, s44, v57
    v_mad_u32_u24 v57, v122, 40, v121
    v_mad_i32_i24 v21, v120, s39, v21
    v_lshlrev_b16 v57, 2, v57
    v_mad_i32_i24 v120, v121, -3, v120
    ds_add_u32 v57, v3 offset:0
    v_lshl_or_b32 v21, v110, 16, v21
    v_lshl_or_b32 v21, v120, 30, v21
    v_lshrrev_b32 v118, 3, v117
    v_lshrrev_b32 v119, 8, v117
    v_lshlrev_b16 v117, 13, v117
    v_bitop3_b32 v119, v118, v119, v124 bitop3:0x1b
    v_bitop3_b32 v20, v117, v125, v20 bitop3:0xae
    v_lshl_or_b32 v56, v119, 16, v56
    v_bitop3_b32 v21, v118, v125, v21 bitop3:0xae
    v_bitop3_b32 v57, v119, v126, v57 bitop3:0xea
    v_lshlrev_b32 v117, 16, v85
    v_and_b32 v118, v126, v85
    v_mul_f32 v117, v123, v117
    v_mul_f32 v118, v123, v118
    v_cvt_pk_bf16_f32 v117, v117, v118
    v_and_b32 v118, v126, v117
    v_lshlrev_b32 v117, 16, v117
    v_mul_f32 v117, 0.15915494, v117
    v_mul_f32 v118, 0.15915494, v118
    v_fract_f32 v117, v117
    v_fract_f32 v118, v118
    v_cos_f32 v117, v117
    v_cos_f32 v118, v118
    v_mul_hi_u32_u24 v122, s38, v58
    v_mul_hi_u32_u24 v121, s37, v22
    v_mul_hi_u32_u24 v120, s36, v22
    v_mad_i32_i24 v110, v122, s44, v58
    v_mad_u32_u24 v58, v122, 40, v121
    v_mad_i32_i24 v22, v120, s39, v22
    v_lshlrev_b16 v58, 2, v58
    v_mad_i32_i24 v120, v121, -3, v120
    ds_add_u32 v58, v3 offset:0
    v_lshl_or_b32 v22, v110, 16, v22
    v_lshl_or_b32 v22, v120, 30, v22
    v_mul_f32 v117, 0x03800000, v117
    v_mul_f32 v118, 0x03800000, v118
    v_cvt_pk_bf16_f32 v117, v117, v118
    v_mul_hi_u32_u24 v122, s38, v59
    v_mul_hi_u32_u24 v121, s37, v23
    v_mul_hi_u32_u24 v120, s36, v23
    v_mad_i32_i24 v110, v122, s44, v59
    v_mad_u32_u24 v59, v122, 40, v121
    v_mad_i32_i24 v23, v120, s39, v23
    v_lshlrev_b16 v59, 2, v59
    v_mad_i32_i24 v120, v121, -3, v120
    ds_add_u32 v59, v3 offset:0
    v_lshl_or_b32 v23, v110, 16, v23
    v_lshl_or_b32 v23, v120, 30, v23
    v_lshrrev_b32 v118, 3, v117
    v_lshrrev_b32 v119, 8, v117
    v_lshlrev_b16 v117, 13, v117
    v_bitop3_b32 v119, v118, v119, v124 bitop3:0x1b
    v_bitop3_b32 v22, v117, v125, v22 bitop3:0xae
    v_lshl_or_b32 v58, v119, 16, v58
    v_bitop3_b32 v23, v118, v125, v23 bitop3:0xae
    v_bitop3_b32 v59, v119, v126, v59 bitop3:0xea
p1_k8:
    s_cmp_lt_u32 s29, 1242
    s_cselect_b32 s6, 204800000, 0
    s_cselect_b32 s10, 204800000, 0
    s_add_u32 s32, s30, 131072
    buffer_load_dwordx4 v[36:39], v1, s[4:7], s32 offen nt
    buffer_load_dwordx4 v[72:75], v1, s[8:11], s32 offen nt
    s_cmp_ge_u32 s29, 1352
    s_cbranch_scc1 p1_k10
    s_waitcnt vmcnt(6)
    v_lshlrev_b32 v117, 16, v86
    v_and_b32 v118, v126, v86
    v_mul_f32 v117, v123, v117
    v_mul_f32 v118, v123, v118
    v_cvt_pk_bf16_f32 v117, v117, v118
    v_and_b32 v118, v126, v117
    v_lshlrev_b32 v117, 16, v117
    v_mul_f32 v117, 0.15915494, v117
    v_mul_f32 v118, 0.15915494, v118
    v_fract_f32 v117, v117
    v_fract_f32 v118, v118
    v_cos_f32 v117, v117
    v_cos_f32 v118, v118
    v_mul_hi_u32_u24 v122, s38, v60
    v_mul_hi_u32_u24 v121, s37, v24
    v_mul_hi_u32_u24 v120, s36, v24
    v_mad_i32_i24 v110, v122, s44, v60
    v_mad_u32_u24 v60, v122, 40, v121
    v_mad_i32_i24 v24, v120, s39, v24
    v_lshlrev_b16 v60, 2, v60
    v_mad_i32_i24 v120, v121, -3, v120
    ds_add_u32 v60, v3 offset:0
    v_lshl_or_b32 v24, v110, 16, v24
    v_lshl_or_b32 v24, v120, 30, v24
    v_mul_f32 v117, 0x03800000, v117
    v_mul_f32 v118, 0x03800000, v118
    v_cvt_pk_bf16_f32 v117, v117, v118
    v_mul_hi_u32_u24 v122, s38, v61
    v_mul_hi_u32_u24 v121, s37, v25
    v_mul_hi_u32_u24 v120, s36, v25
    v_mad_i32_i24 v110, v122, s44, v61
    v_mad_u32_u24 v61, v122, 40, v121
    v_mad_i32_i24 v25, v120, s39, v25
    v_lshlrev_b16 v61, 2, v61
    v_mad_i32_i24 v120, v121, -3, v120
    ds_add_u32 v61, v3 offset:0
    v_lshl_or_b32 v25, v110, 16, v25
    v_lshl_or_b32 v25, v120, 30, v25
    v_lshrrev_b32 v118, 3, v117
    v_lshrrev_b32 v119, 8, v117
    v_lshlrev_b16 v117, 13, v117
    v_bitop3_b32 v119, v118, v119, v124 bitop3:0x1b
    v_bitop3_b32 v24, v117, v125, v24 bitop3:0xae
    v_lshl_or_b32 v60, v119, 16, v60
    v_bitop3_b32 v25, v118, v125, v25 bitop3:0xae
    v_bitop3_b32 v61, v119, v126, v61 bitop3:0xea
    v_lshlrev_b32 v117, 16, v87
    v_and_b32 v118, v126, v87
    v_mul_f32 v117, v123, v117
    v_mul_f32 v118, v123, v118
    v_cvt_pk_bf16_f32 v117, v117, v118
    v_and_b32 v118, v126, v117
    v_lshlrev_b32 v117, 16, v117
    v_mul_f32 v117, 0.15915494, v117
    v_mul_f32 v118, 0.15915494, v118
    v_fract_f32 v117, v117
    v_fract_f32 v118, v118
    v_cos_f32 v117, v117
    v_cos_f32 v118, v118
    v_mul_hi_u32_u24 v122, s38, v62
    v_mul_hi_u32_u24 v121, s37, v26
    v_mul_hi_u32_u24 v120, s36, v26
    v_mad_i32_i24 v110, v122, s44, v62
    v_mad_u32_u24 v62, v122, 40, v121
    v_mad_i32_i24 v26, v120, s39, v26
    v_lshlrev_b16 v62, 2, v62
    v_mad_i32_i24 v120, v121, -3, v120
    ds_add_u32 v62, v3 offset:0
    v_lshl_or_b32 v26, v110, 16, v26
    v_lshl_or_b32 v26, v120, 30, v26
    v_mul_f32 v117, 0x03800000, v117
    v_mul_f32 v118, 0x03800000, v118
    v_cvt_pk_bf16_f32 v117, v117, v118
    v_mul_hi_u32_u24 v122, s38, v63
    v_mul_hi_u32_u24 v121, s37, v27
    v_mul_hi_u32_u24 v120, s36, v27
    v_mad_i32_i24 v110, v122, s44, v63
    v_mad_u32_u24 v63, v122, 40, v121
    v_mad_i32_i24 v27, v120, s39, v27
    v_lshlrev_b16 v63, 2, v63
    v_mad_i32_i24 v120, v121, -3, v120
    ds_add_u32 v63, v3 offset:0
    v_lshl_or_b32 v27, v110, 16, v27
    v_lshl_or_b32 v27, v120, 30, v27
    v_lshrrev_b32 v118, 3, v117
    v_lshrrev_b32 v119, 8, v117
    v_lshlrev_b16 v117, 13, v117
    v_bitop3_b32 v119, v118, v119, v124 bitop3:0x1b
    v_bitop3_b32 v26, v117, v125, v26 bitop3:0xae
    v_lshl_or_b32 v62, v119, 16, v62
    v_bitop3_b32 v27, v118, v125, v27 bitop3:0xae
    v_bitop3_b32 v63, v119, v126, v63 bitop3:0xea
p1_k10:
    s_cmp_ge_u32 s29, 1315
    s_cbranch_scc1 p1_k12
    s_waitcnt vmcnt(4)
    v_lshlrev_b32 v117, 16, v88
    v_and_b32 v118, v126, v88
    v_mul_f32 v117, v123, v117
    v_mul_f32 v118, v123, v118
    v_cvt_pk_bf16_f32 v117, v117, v118
    v_and_b32 v118, v126, v117
    v_lshlrev_b32 v117, 16, v117
    v_mul_f32 v117, 0.15915494, v117
    v_mul_f32 v118, 0.15915494, v118
    v_fract_f32 v117, v117
    v_fract_f32 v118, v118
    v_cos_f32 v117, v117
    v_cos_f32 v118, v118
    v_mul_hi_u32_u24 v122, s38, v64
    v_mul_hi_u32_u24 v121, s37, v28
    v_mul_hi_u32_u24 v120, s36, v28
    v_mad_i32_i24 v110, v122, s44, v64
    v_mad_u32_u24 v64, v122, 40, v121
    v_mad_i32_i24 v28, v120, s39, v28
    v_lshlrev_b16 v64, 2, v64
    v_mad_i32_i24 v120, v121, -3, v120
    ds_add_u32 v64, v3 offset:0
    v_lshl_or_b32 v28, v110, 16, v28
    v_lshl_or_b32 v28, v120, 30, v28
    v_mul_f32 v117, 0x03800000, v117
    v_mul_f32 v118, 0x03800000, v118
    v_cvt_pk_bf16_f32 v117, v117, v118
    v_mul_hi_u32_u24 v122, s38, v65
    v_mul_hi_u32_u24 v121, s37, v29
    v_mul_hi_u32_u24 v120, s36, v29
    v_mad_i32_i24 v110, v122, s44, v65
    v_mad_u32_u24 v65, v122, 40, v121
    v_mad_i32_i24 v29, v120, s39, v29
    v_lshlrev_b16 v65, 2, v65
    v_mad_i32_i24 v120, v121, -3, v120
    ds_add_u32 v65, v3 offset:0
    v_lshl_or_b32 v29, v110, 16, v29
    v_lshl_or_b32 v29, v120, 30, v29
    v_lshrrev_b32 v118, 3, v117
    v_lshrrev_b32 v119, 8, v117
    v_lshlrev_b16 v117, 13, v117
    v_bitop3_b32 v119, v118, v119, v124 bitop3:0x1b
    v_bitop3_b32 v28, v117, v125, v28 bitop3:0xae
    v_lshl_or_b32 v64, v119, 16, v64
    v_bitop3_b32 v29, v118, v125, v29 bitop3:0xae
    v_bitop3_b32 v65, v119, v126, v65 bitop3:0xea
    v_lshlrev_b32 v117, 16, v89
    v_and_b32 v118, v126, v89
    v_mul_f32 v117, v123, v117
    v_mul_f32 v118, v123, v118
    v_cvt_pk_bf16_f32 v117, v117, v118
    v_and_b32 v118, v126, v117
    v_lshlrev_b32 v117, 16, v117
    v_mul_f32 v117, 0.15915494, v117
    v_mul_f32 v118, 0.15915494, v118
    v_fract_f32 v117, v117
    v_fract_f32 v118, v118
    v_cos_f32 v117, v117
    v_cos_f32 v118, v118
    v_mul_hi_u32_u24 v122, s38, v66
    v_mul_hi_u32_u24 v121, s37, v30
    v_mul_hi_u32_u24 v120, s36, v30
    v_mad_i32_i24 v110, v122, s44, v66
    v_mad_u32_u24 v66, v122, 40, v121
    v_mad_i32_i24 v30, v120, s39, v30
    v_lshlrev_b16 v66, 2, v66
    v_mad_i32_i24 v120, v121, -3, v120
    ds_add_u32 v66, v3 offset:0
    v_lshl_or_b32 v30, v110, 16, v30
    v_lshl_or_b32 v30, v120, 30, v30
    v_mul_f32 v117, 0x03800000, v117
    v_mul_f32 v118, 0x03800000, v118
    v_cvt_pk_bf16_f32 v117, v117, v118
    v_mul_hi_u32_u24 v122, s38, v67
    v_mul_hi_u32_u24 v121, s37, v31
    v_mul_hi_u32_u24 v120, s36, v31
    v_mad_i32_i24 v110, v122, s44, v67
    v_mad_u32_u24 v67, v122, 40, v121
    v_mad_i32_i24 v31, v120, s39, v31
    v_lshlrev_b16 v67, 2, v67
    v_mad_i32_i24 v120, v121, -3, v120
    ds_add_u32 v67, v3 offset:0
    v_lshl_or_b32 v31, v110, 16, v31
    v_lshl_or_b32 v31, v120, 30, v31
    v_lshrrev_b32 v118, 3, v117
    v_lshrrev_b32 v119, 8, v117
    v_lshlrev_b16 v117, 13, v117
    v_bitop3_b32 v119, v118, v119, v124 bitop3:0x1b
    v_bitop3_b32 v30, v117, v125, v30 bitop3:0xae
    v_lshl_or_b32 v66, v119, 16, v66
    v_bitop3_b32 v31, v118, v125, v31 bitop3:0xae
    v_bitop3_b32 v67, v119, v126, v67 bitop3:0xea
p1_k12:
    s_cmp_ge_u32 s29, 1279
    s_cbranch_scc1 p1_k14
    s_waitcnt vmcnt(2)
    v_lshlrev_b32 v117, 16, v90
    v_and_b32 v118, v126, v90
    v_mul_f32 v117, v123, v117
    v_mul_f32 v118, v123, v118
    v_cvt_pk_bf16_f32 v117, v117, v118
    v_and_b32 v118, v126, v117
    v_lshlrev_b32 v117, 16, v117
    v_mul_f32 v117, 0.15915494, v117
    v_mul_f32 v118, 0.15915494, v118
    v_fract_f32 v117, v117
    v_fract_f32 v118, v118
    v_cos_f32 v117, v117
    v_cos_f32 v118, v118
    v_mul_hi_u32_u24 v122, s38, v68
    v_mul_hi_u32_u24 v121, s37, v32
    v_mul_hi_u32_u24 v120, s36, v32
    v_mad_i32_i24 v110, v122, s44, v68
    v_mad_u32_u24 v68, v122, 40, v121
    v_mad_i32_i24 v32, v120, s39, v32
    v_lshlrev_b16 v68, 2, v68
    v_mad_i32_i24 v120, v121, -3, v120
    ds_add_u32 v68, v3 offset:0
    v_lshl_or_b32 v32, v110, 16, v32
    v_lshl_or_b32 v32, v120, 30, v32
    v_mul_f32 v117, 0x03800000, v117
    v_mul_f32 v118, 0x03800000, v118
    v_cvt_pk_bf16_f32 v117, v117, v118
    v_mul_hi_u32_u24 v122, s38, v69
    v_mul_hi_u32_u24 v121, s37, v33
    v_mul_hi_u32_u24 v120, s36, v33
    v_mad_i32_i24 v110, v122, s44, v69
    v_mad_u32_u24 v69, v122, 40, v121
    v_mad_i32_i24 v33, v120, s39, v33
    v_lshlrev_b16 v69, 2, v69
    v_mad_i32_i24 v120, v121, -3, v120
    ds_add_u32 v69, v3 offset:0
    v_lshl_or_b32 v33, v110, 16, v33
    v_lshl_or_b32 v33, v120, 30, v33
    v_lshrrev_b32 v118, 3, v117
    v_lshrrev_b32 v119, 8, v117
    v_lshlrev_b16 v117, 13, v117
    v_bitop3_b32 v119, v118, v119, v124 bitop3:0x1b
    v_bitop3_b32 v32, v117, v125, v32 bitop3:0xae
    v_lshl_or_b32 v68, v119, 16, v68
    v_bitop3_b32 v33, v118, v125, v33 bitop3:0xae
    v_bitop3_b32 v69, v119, v126, v69 bitop3:0xea
    v_lshlrev_b32 v117, 16, v91
    v_and_b32 v118, v126, v91
    v_mul_f32 v117, v123, v117
    v_mul_f32 v118, v123, v118
    v_cvt_pk_bf16_f32 v117, v117, v118
    v_and_b32 v118, v126, v117
    v_lshlrev_b32 v117, 16, v117
    v_mul_f32 v117, 0.15915494, v117
    v_mul_f32 v118, 0.15915494, v118
    v_fract_f32 v117, v117
    v_fract_f32 v118, v118
    v_cos_f32 v117, v117
    v_cos_f32 v118, v118
    v_mul_hi_u32_u24 v122, s38, v70
    v_mul_hi_u32_u24 v121, s37, v34
    v_mul_hi_u32_u24 v120, s36, v34
    v_mad_i32_i24 v110, v122, s44, v70
    v_mad_u32_u24 v70, v122, 40, v121
    v_mad_i32_i24 v34, v120, s39, v34
    v_lshlrev_b16 v70, 2, v70
    v_mad_i32_i24 v120, v121, -3, v120
    ds_add_u32 v70, v3 offset:0
    v_lshl_or_b32 v34, v110, 16, v34
    v_lshl_or_b32 v34, v120, 30, v34
    v_mul_f32 v117, 0x03800000, v117
    v_mul_f32 v118, 0x03800000, v118
    v_cvt_pk_bf16_f32 v117, v117, v118
    v_mul_hi_u32_u24 v122, s38, v71
    v_mul_hi_u32_u24 v121, s37, v35
    v_mul_hi_u32_u24 v120, s36, v35
    v_mad_i32_i24 v110, v122, s44, v71
    v_mad_u32_u24 v71, v122, 40, v121
    v_mad_i32_i24 v35, v120, s39, v35
    v_lshlrev_b16 v71, 2, v71
    v_mad_i32_i24 v120, v121, -3, v120
    ds_add_u32 v71, v3 offset:0
    v_lshl_or_b32 v35, v110, 16, v35
    v_lshl_or_b32 v35, v120, 30, v35
    v_lshrrev_b32 v118, 3, v117
    v_lshrrev_b32 v119, 8, v117
    v_lshlrev_b16 v117, 13, v117
    v_bitop3_b32 v119, v118, v119, v124 bitop3:0x1b
    v_bitop3_b32 v34, v117, v125, v34 bitop3:0xae
    v_lshl_or_b32 v70, v119, 16, v70
    v_bitop3_b32 v35, v118, v125, v35 bitop3:0xae
    v_bitop3_b32 v71, v119, v126, v71 bitop3:0xea
p1_k14:
    s_cmp_ge_u32 s29, 1242
    s_cbranch_scc1 p1_k16
    s_waitcnt vmcnt(0)
    v_lshlrev_b32 v117, 16, v92
    v_and_b32 v118, v126, v92
    v_mul_f32 v117, v123, v117
    v_mul_f32 v118, v123, v118
    v_cvt_pk_bf16_f32 v117, v117, v118
    v_and_b32 v118, v126, v117
    v_lshlrev_b32 v117, 16, v117
    v_mul_f32 v117, 0.15915494, v117
    v_mul_f32 v118, 0.15915494, v118
    v_fract_f32 v117, v117
    v_fract_f32 v118, v118
    v_cos_f32 v117, v117
    v_cos_f32 v118, v118
    v_mul_hi_u32_u24 v122, s38, v72
    v_mul_hi_u32_u24 v121, s37, v36
    v_mul_hi_u32_u24 v120, s36, v36
    v_mad_i32_i24 v110, v122, s44, v72
    v_mad_u32_u24 v72, v122, 40, v121
    v_mad_i32_i24 v36, v120, s39, v36
    v_lshlrev_b16 v72, 2, v72
    v_mad_i32_i24 v120, v121, -3, v120
    ds_add_u32 v72, v3 offset:0
    v_lshl_or_b32 v36, v110, 16, v36
    v_lshl_or_b32 v36, v120, 30, v36
    v_mul_f32 v117, 0x03800000, v117
    v_mul_f32 v118, 0x03800000, v118
    v_cvt_pk_bf16_f32 v117, v117, v118
    v_mul_hi_u32_u24 v122, s38, v73
    v_mul_hi_u32_u24 v121, s37, v37
    v_mul_hi_u32_u24 v120, s36, v37
    v_mad_i32_i24 v110, v122, s44, v73
    v_mad_u32_u24 v73, v122, 40, v121
    v_mad_i32_i24 v37, v120, s39, v37
    v_lshlrev_b16 v73, 2, v73
    v_mad_i32_i24 v120, v121, -3, v120
    ds_add_u32 v73, v3 offset:0
    v_lshl_or_b32 v37, v110, 16, v37
    v_lshl_or_b32 v37, v120, 30, v37
    v_lshrrev_b32 v118, 3, v117
    v_lshrrev_b32 v119, 8, v117
    v_lshlrev_b16 v117, 13, v117
    v_bitop3_b32 v119, v118, v119, v124 bitop3:0x1b
    v_bitop3_b32 v36, v117, v125, v36 bitop3:0xae
    v_lshl_or_b32 v72, v119, 16, v72
    v_bitop3_b32 v37, v118, v125, v37 bitop3:0xae
    v_bitop3_b32 v73, v119, v126, v73 bitop3:0xea
    v_lshlrev_b32 v117, 16, v93
    v_and_b32 v118, v126, v93
    v_mul_f32 v117, v123, v117
    v_mul_f32 v118, v123, v118
    v_cvt_pk_bf16_f32 v117, v117, v118
    v_and_b32 v118, v126, v117
    v_lshlrev_b32 v117, 16, v117
    v_mul_f32 v117, 0.15915494, v117
    v_mul_f32 v118, 0.15915494, v118
    v_fract_f32 v117, v117
    v_fract_f32 v118, v118
    v_cos_f32 v117, v117
    v_cos_f32 v118, v118
    v_mul_hi_u32_u24 v122, s38, v74
    v_mul_hi_u32_u24 v121, s37, v38
    v_mul_hi_u32_u24 v120, s36, v38
    v_mad_i32_i24 v110, v122, s44, v74
    v_mad_u32_u24 v74, v122, 40, v121
    v_mad_i32_i24 v38, v120, s39, v38
    v_lshlrev_b16 v74, 2, v74
    v_mad_i32_i24 v120, v121, -3, v120
    ds_add_u32 v74, v3 offset:0
    v_lshl_or_b32 v38, v110, 16, v38
    v_lshl_or_b32 v38, v120, 30, v38
    v_mul_f32 v117, 0x03800000, v117
    v_mul_f32 v118, 0x03800000, v118
    v_cvt_pk_bf16_f32 v117, v117, v118
    v_mul_hi_u32_u24 v122, s38, v75
    v_mul_hi_u32_u24 v121, s37, v39
    v_mul_hi_u32_u24 v120, s36, v39
    v_mad_i32_i24 v110, v122, s44, v75
    v_mad_u32_u24 v75, v122, 40, v121
    v_mad_i32_i24 v39, v120, s39, v39
    v_lshlrev_b16 v75, 2, v75
    v_mad_i32_i24 v120, v121, -3, v120
    ds_add_u32 v75, v3 offset:0
    v_lshl_or_b32 v39, v110, 16, v39
    v_lshl_or_b32 v39, v120, 30, v39
    v_lshrrev_b32 v118, 3, v117
    v_lshrrev_b32 v119, 8, v117
    v_lshlrev_b16 v117, 13, v117
    v_bitop3_b32 v119, v118, v119, v124 bitop3:0x1b
    v_bitop3_b32 v38, v117, v125, v38 bitop3:0xae
    v_lshl_or_b32 v74, v119, 16, v74
    v_bitop3_b32 v39, v118, v125, v39 bitop3:0xae
    v_bitop3_b32 v75, v119, v126, v75 bitop3:0xea
p1_k16:
    s_waitcnt vmcnt(0)
    s_cmp_lg_u32 s28, 15
    s_cbranch_scc1 p1_tk1
    v_mov_b32 v126, 0
    s_mov_b64 exec, 1
    ds_write_b32 v126, v127 offset:10456
    s_mov_b64 exec, -1
p1_tk1:
    s_waitcnt lgkmcnt(0)
    s_barrier
    s_cmp_ge_u32 s28, 10
    s_cbranch_scc1 p1_s1_skip
    v_and_b32 v126, 63, v0
    s_lshl_b32 s54, s28, 4
    v_mul_u32_u24 v117, 160, v126
    v_add_u32 v117, s54, v117
    ds_read_b128 v[118:121], v117 offset:0
    s_waitcnt lgkmcnt(0)
    v_add_u32 v118, 2, v118
    v_add_u32 v119, 2, v119
    v_add_u32 v120, 2, v120
    v_add_u32 v121, 2, v121
    v_mul_u32_u24 v118, 43691, v118
    v_mul_u32_u24 v119, 43691, v119
    v_mul_u32_u24 v120, 43691, v120
    v_mul_u32_u24 v121, 43691, v121
    v_lshrrev_b32 v118, 17, v118
    v_lshrrev_b32 v119, 17, v119
    v_lshrrev_b32 v120, 17, v120
    v_lshrrev_b32 v121, 17, v121
    v_lshl_or_b32 v122, v119, 16, v118
    v_lshl_or_b32 v123, v121, 16, v120
    v_mov_b32 v124, v122
    v_mov_b32 v125, v123
    s_nop 1
    v_add_u32_dpp v124, v124, v124 row_shr:1 row_mask:0xf bank_mask:0xf bound_ctrl:0
    v_add_u32_dpp v125, v125, v125 row_shr:1 row_mask:0xf bank_mask:0xf bound_ctrl:0
    s_nop 0
    v_add_u32_dpp v124, v124, v124 row_shr:2 row_mask:0xf bank_mask:0xf bound_ctrl:0
    v_add_u32_dpp v125, v125, v125 row_shr:2 row_mask:0xf bank_mask:0xf bound_ctrl:0
    s_nop 0
    v_add_u32_dpp v124, v124, v124 row_shr:4 row_mask:0xf bank_mask:0xf bound_ctrl:0
    v_add_u32_dpp v125, v125, v125 row_shr:4 row_mask:0xf bank_mask:0xf bound_ctrl:0
    s_nop 0
    v_add_u32_dpp v124, v124, v124 row_shr:8 row_mask:0xf bank_mask:0xf bound_ctrl:0
    v_add_u32_dpp v125, v125, v125 row_shr:8 row_mask:0xf bank_mask:0xf bound_ctrl:0
    s_nop 0
    v_add_u32_dpp v124, v124, v124 row_bcast:15 row_mask:0xa bank_mask:0xf
    v_add_u32_dpp v125, v125, v125 row_bcast:15 row_mask:0xa bank_mask:0xf
    s_nop 0
    v_add_u32_dpp v124, v124, v124 row_bcast:31 row_mask:0xc bank_mask:0xf
    v_add_u32_dpp v125, v125, v125 row_bcast:31 row_mask:0xc bank_mask:0xf
    s_nop 0
    s_nop 0
    v_mov_b32 v127, s54
    v_and_b32 v118, 0xffff, v124
    v_lshrrev_b32 v119, 16, v124
    v_and_b32 v120, 0xffff, v125
    v_lshrrev_b32 v121, 16, v125
    s_mov_b64 exec, 1
    s_lshl_b64 exec, exec, 63
    ds_write_b128 v127, v[118:121] offset:10240
    s_mov_b64 exec, -1
p1_s1_skip:
    s_waitcnt lgkmcnt(0)
    s_barrier
    v_and_b32 v127, 63, v0
    v_lshlrev_b32 v118, 2, v127
    v_cmp_gt_u32 vcc, 40, v127
    ds_read_b32 v119, v118 offset:10240
    s_waitcnt lgkmcnt(0)
    v_readlane_b32 s33, v119, 54
    v_cndmask_b32 v119, 0, v119, vcc
    v_mov_b32 v120, v119
    s_nop 1
    v_add_u32_dpp v120, v120, v120 row_shr:1 row_mask:0xf bank_mask:0xf bound_ctrl:0
    s_nop 1
    v_add_u32_dpp v120, v120, v120 row_shr:2 row_mask:0xf bank_mask:0xf bound_ctrl:0
    s_nop 1
    v_add_u32_dpp v120, v120, v120 row_shr:4 row_mask:0xf bank_mask:0xf bound_ctrl:0
    s_nop 1
    v_add_u32_dpp v120, v120, v120 row_shr:8 row_mask:0xf bank_mask:0xf bound_ctrl:0
    s_nop 1
    v_add_u32_dpp v120, v120, v120 row_bcast:15 row_mask:0xa bank_mask:0xf
    s_nop 1
    v_add_u32_dpp v120, v120, v120 row_bcast:31 row_mask:0xc bank_mask:0xf
    s_nop 1
    s_nop 0
    v_sub_u32 v119, v120, v119
    v_readlane_b32 s35, v120, 63
    s_add_u32 s33, s33, 256
    s_mul_i32 s46, s33, 1
    s_min_u32 s47, s33, 1499
    s_add_u32 s46, s46, s47
    s_min_u32 s47, s33, 1462
    s_add_u32 s46, s46, s47
    s_min_u32 s47, s33, 1426
    s_add_u32 s46, s46, s47
    s_min_u32 s47, s33, 1389
    s_add_u32 s46, s46, s47
    s_min_u32 s47, s33, 1352
    s_add_u32 s46, s46, s47
    s_min_u32 s47, s33, 1315
    s_add_u32 s46, s46, s47
    s_min_u32 s47, s33, 1279
    s_add_u32 s46, s46, s47
    s_min_u32 s47, s33, 1242
    s_add_u32 s46, s46, s47
    s_lshl_b32 s30, s46, 14
    s_lshl_b32 s31, s46, 13
    s_cmp_ge_u32 s28, 10
    s_cbranch_scc1 p1_s2_skip
    s_lshl_b32 s54, s28, 2
    s_add_u32 s55, s54, 0
    v_readlane_b32 s56, v119, s55
    s_add_u32 s55, s54, 1
    v_readlane_b32 s57, v119, s55
    s_add_u32 s55, s54, 2
    v_readlane_b32 s58, v119, s55
    s_add_u32 s55, s54, 3
    v_readlane_b32 s59, v119, s55
    s_nop 0
    s_lshl_b32 s57, s57, 16
    s_or_b32 s56, s56, s57
    s_lshl_b32 s59, s59, 16
    s_or_b32 s58, s58, s59
    v_add_u32 v124, s56, v124
    v_add_u32 v125, s58, v125
    v_sub_u32 v122, v124, v122
    v_sub_u32 v123, v125, v123
    v_and_b32 v118, 0xffff, v122
    v_lshrrev_b32 v119, 16, v122
    v_and_b32 v120, 0xffff, v123
    v_lshrrev_b32 v121, 16, v123
    v_mul_u32_u24 v118, 3, v118
    v_mul_u32_u24 v119, 3, v119
    v_mul_u32_u24 v120, 3, v120
    v_mul_u32_u24 v121, 3, v121
    ds_write_b128 v117, v[118:121] offset:0
    s_mul_i32 s55, s29, 5248
    s_mul_i32 s56, s28, 520
    s_add_u32 s55, s55, s56
    s_add_u32 s55, s55, 469762048
    v_lshlrev_b32 v127, 3, v126
    buffer_store_dwordx2 v[122:123], v127, s[16:19], s55 offen sc1
    s_mov_b64 exec, 1
    s_lshl_b64 exec, exec, 63
    buffer_store_dwordx2 v[124:125], v127, s[16:19], s55 offen offset:8 sc1
    s_mov_b64 exec, -1
p1_s2_skip:
    s_mul_i32 s50, s29, 16384
    s_lshr_b32 s52, s35, 10
    s_mul_i32 s52, s52, 33554432
    s_and_b32 s53, s35, 1023
    s_lshl_b32 s53, s53, 4
    s_add_u32 s52, s52, s53
    s_add_u32 s52, s52, s50
    s_min_u32 s22, s52, 469762048
    s_mov_b32 s68, 0
    s_cmp_lt_u32 s28, 12
    s_cselect_b32 s71, 8, 7
    s_cmp_lt_u32 s29, 1242
    s_cselect_b32 s35, 13994, s35
    s_waitcnt lgkmcnt(0)
    s_barrier
    s_cmp_lt_u32 s33, 1536
    s_cbranch_scc1 p1_f0
    s_cmp_lg_u32 s28, 15
    s_cbranch_scc1 p1_hv0
    s_sub_u32 s52, s33, 1536
    s_and_b32 s52, s52, 255
    s_lshl_b32 s58, s52, 2
    s_and_b32 s58, s58, 28
    s_lshl_b32 s53, 1, s58
    v_mov_b32 v127, s53
    s_lshr_b32 s52, s52, 3
    s_lshl_b32 s52, s52, 2
    s_mov_b64 exec, 1
    buffer_atomic_add v127, off, s[40:43], s52 sc0 sc1
    s_mov_b64 exec, -1
p1_hv0:
    s_cmp_ge_u32 s33, 1656
    s_cbranch_scc1 p1_f0
    s_sub_u32 s52, s33, 1536
    s_mul_i32 s52, s52, 53368
    s_mul_i32 s53, s28, 3072
    s_add_u32 s53, s53, s52
    v_and_b32 v92, 63, v0
    v_lshl_add_u32 v93, v92, 2, s53
    s_lshl_b32 s53, s28, 9
    s_add_u32 s53, s53, s52
    s_add_u32 s53, s53, 49152
    s_cmp_lt_u32 s28, 9
    s_cselect_b32 s53, s53, 0x40000000
    v_lshl_add_u32 v94, v92, 2, s53
    buffer_load_dword v76, v93, s[24:27], 0 offen offset:0
    buffer_load_dword v77, v93, s[24:27], 0 offen offset:256
    buffer_load_dword v78, v93, s[24:27], 0 offen offset:512
    buffer_load_dword v79, v93, s[24:27], 0 offen offset:768
    buffer_load_dword v80, v93, s[24:27], 0 offen offset:1024
    buffer_load_dword v81, v93, s[24:27], 0 offen offset:1280
    buffer_load_dword v82, v93, s[24:27], 0 offen offset:1536
    buffer_load_dword v83, v93, s[24:27], 0 offen offset:1792
    buffer_load_dword v84, v93, s[24:27], 0 offen offset:2048
    buffer_load_dword v85, v93, s[24:27], 0 offen offset:2304
    buffer_load_dword v86, v93, s[24:27], 0 offen offset:2560
    buffer_load_dword v87, v93, s[24:27], 0 offen offset:2816
    buffer_load_dword v88, v94, s[24:27], 0 offen offset:0
    buffer_load_dword v89, v94, s[24:27], 0 offen offset:256
p1_f0:
    v_and_b32 v117, 0xffff, v40
    ds_add_rtn_u32 v117, v117, v3 offset:0
    v_and_b32 v118, 0xffff, v41
    ds_add_rtn_u32 v118, v118, v3 offset:0
    v_and_b32 v119, 0xffff, v42
    ds_add_rtn_u32 v119, v119, v3 offset:0
    v_and_b32 v120, 0xffff, v43
    ds_add_rtn_u32 v120, v120, v3 offset:0
    s_cmp_ge_u32 s33, 1536
    s_cbranch_scc1 p1_k18
    s_cmp_lt_u32 s33, 1536
    s_cselect_b32 s14, 102400000, 0
    s_add_u32 s32, s31, 0
    buffer_load_dwordx2 v[76:77], v2, s[12:15], s32 offen nt
p1_k18:
    s_cmp_ge_u32 s33, 1536
    s_cbranch_scc1 p1_k19
    s_cmp_lt_u32 s33, 1536
    s_cselect_b32 s6, 204800000, 0
    s_cselect_b32 s10, 204800000, 0
    s_add_u32 s32, s30, 0
    buffer_load_dwordx4 v[94:97], v1, s[4:7], s32 offen nt
    buffer_load_dwordx4 v[102:105], v1, s[8:11], s32 offen nt
p1_k19:
    s_cmp_lt_u32 s29, 1499
    s_cbranch_scc1 p1_pa0
    s_waitcnt lgkmcnt(0)
    s_branch p1_pb0
p1_pa0:
    v_and_b32 v121, 0xffff, v44
    ds_add_rtn_u32 v121, v121, v3 offset:0
    v_and_b32 v122, 0xffff, v45
    ds_add_rtn_u32 v122, v122, v3 offset:0
    v_and_b32 v123, 0xffff, v46
    ds_add_rtn_u32 v123, v123, v3 offset:0
    v_and_b32 v124, 0xffff, v47
    ds_add_rtn_u32 v124, v124, v3 offset:0
    s_waitcnt lgkmcnt(4)
p1_pb0:
    ds_write_b8_d16_hi v117, v40 offset:10496
    v_lshlrev_b32 v40, 2, v117
    ds_write_b32 v40, v4 offset:52480
    ds_write_b8_d16_hi v118, v41 offset:10496
    v_lshlrev_b32 v41, 2, v118
    ds_write_b32 v41, v5 offset:52480
    ds_write_b8_d16_hi v119, v42 offset:10496
    v_lshlrev_b32 v42, 2, v119
    ds_write_b32 v42, v6 offset:52480
    ds_write_b8_d16_hi v120, v43 offset:10496
    v_lshlrev_b32 v43, 2, v120
    ds_write_b32 v43, v7 offset:52480
    s_cmp_ge_u32 s33, 1536
    s_cbranch_scc1 p1_k20
    s_cmp_lt_u32 s33, 1499
    s_cselect_b32 s14, 102400000, 0
    s_add_u32 s32, s31, 8192
    buffer_load_dwordx2 v[78:79], v2, s[12:15], s32 offen nt
p1_k20:
    s_cmp_lt_u32 s29, 1462
    s_cbranch_scc1 p1_pa1
    s_waitcnt lgkmcnt(0)
    s_branch p1_pb1
p1_pa1:
    v_and_b32 v117, 0xffff, v48
    ds_add_rtn_u32 v117, v117, v3 offset:0
    v_and_b32 v118, 0xffff, v49
    ds_add_rtn_u32 v118, v118, v3 offset:0
    v_and_b32 v119, 0xffff, v50
    ds_add_rtn_u32 v119, v119, v3 offset:0
    v_and_b32 v120, 0xffff, v51
    ds_add_rtn_u32 v120, v120, v3 offset:0
    s_waitcnt lgkmcnt(4)
p1_pb1:
    s_cmp_ge_u32 s29, 1499
    s_cbranch_scc1 p1_k21
    ds_write_b8_d16_hi v121, v44 offset:10496
    v_lshlrev_b32 v44, 2, v121
    ds_write_b32 v44, v8 offset:52480
    ds_write_b8_d16_hi v122, v45 offset:10496
    v_lshlrev_b32 v45, 2, v122
    ds_write_b32 v45, v9 offset:52480
    ds_write_b8_d16_hi v123, v46 offset:10496
    v_lshlrev_b32 v46, 2, v123
    ds_write_b32 v46, v10 offset:52480
    ds_write_b8_d16_hi v124, v47 offset:10496
    v_lshlrev_b32 v47, 2, v124
    ds_write_b32 v47, v11 offset:52480
p1_k21:
    s_cmp_ge_u32 s33, 1536
    s_cbranch_scc1 p1_k22
    s_cmp_lt_u32 s33, 1462
    s_cselect_b32 s14, 102400000, 0
    s_add_u32 s32, s31, 16384
    buffer_load_dwordx2 v[80:81], v2, s[12:15], s32 offen nt
p1_k22:
    s_cmp_lt_u32 s29, 1426
    s_cbranch_scc1 p1_pa2
    s_waitcnt lgkmcnt(0)
    s_branch p1_pb2
p1_pa2:
    v_and_b32 v121, 0xffff, v52
    ds_add_rtn_u32 v121, v121, v3 offset:0
    v_and_b32 v122, 0xffff, v53
    ds_add_rtn_u32 v122, v122, v3 offset:0
    v_and_b32 v123, 0xffff, v54
    ds_add_rtn_u32 v123, v123, v3 offset:0
    v_and_b32 v124, 0xffff, v55
    ds_add_rtn_u32 v124, v124, v3 offset:0
    s_waitcnt lgkmcnt(4)
p1_pb2:
    s_cmp_ge_u32 s29, 1462
    s_cbranch_scc1 p1_k23
    ds_write_b8_d16_hi v117, v48 offset:10496
    v_lshlrev_b32 v48, 2, v117
    ds_write_b32 v48, v12 offset:52480
    ds_write_b8_d16_hi v118, v49 offset:10496
    v_lshlrev_b32 v49, 2, v118
    ds_write_b32 v49, v13 offset:52480
    ds_write_b8_d16_hi v119, v50 offset:10496
    v_lshlrev_b32 v50, 2, v119
    ds_write_b32 v50, v14 offset:52480
    ds_write_b8_d16_hi v120, v51 offset:10496
    v_lshlrev_b32 v51, 2, v120
    ds_write_b32 v51, v15 offset:52480
p1_k23:
    s_cmp_ge_u32 s28, 10
    s_cbranch_scc1 p1_jn
    s_waitcnt vmcnt(0)
    v_mov_b32 v125, 0
    s_mov_b64 exec, 1
    ds_add_rtn_u32 v125, v125, v3 offset:10432
    s_waitcnt lgkmcnt(0)
    v_readfirstlane_b32 s52, v125
    s_lshr_b32 s53, s29, 1
    s_and_b32 s53, s53, 28
    s_cmp_lg_u32 s52, 9
    s_cbranch_scc1 p1_jn1
    s_lshl_b32 s54, 1, s53
    v_mov_b32 v127, s54
    s_lshr_b32 s54, s29, 6
    s_lshl_b32 s54, s54, 2
    s_mov_b32 s68, 1
    buffer_atomic_add v127, off, s[40:43], s54 sc0 sc1
p1_jn1:
    s_mov_b64 exec, -1
p1_jn:
    s_cmp_ge_u32 s33, 1536
    s_cbranch_scc1 p1_k24
    s_cmp_lt_u32 s33, 1426
    s_cselect_b32 s14, 102400000, 0
    s_add_u32 s32, s31, 24576
    buffer_load_dwordx2 v[82:83], v2, s[12:15], s32 offen nt
p1_k24:
    s_cmp_lt_u32 s29, 1389
    s_cbranch_scc1 p1_pa3
    s_waitcnt lgkmcnt(0)
    s_branch p1_pb3
p1_pa3:
    v_and_b32 v117, 0xffff, v56
    ds_add_rtn_u32 v117, v117, v3 offset:0
    v_and_b32 v118, 0xffff, v57
    ds_add_rtn_u32 v118, v118, v3 offset:0
    v_and_b32 v119, 0xffff, v58
    ds_add_rtn_u32 v119, v119, v3 offset:0
    v_and_b32 v120, 0xffff, v59
    ds_add_rtn_u32 v120, v120, v3 offset:0
    s_waitcnt lgkmcnt(4)
p1_pb3:
    s_cmp_ge_u32 s29, 1426
    s_cbranch_scc1 p1_k25
    ds_write_b8_d16_hi v121, v52 offset:10496
    v_lshlrev_b32 v52, 2, v121
    ds_write_b32 v52, v16 offset:52480
    ds_write_b8_d16_hi v122, v53 offset:10496
    v_lshlrev_b32 v53, 2, v122
    ds_write_b32 v53, v17 offset:52480
    ds_write_b8_d16_hi v123, v54 offset:10496
    v_lshlrev_b32 v54, 2, v123
    ds_write_b32 v54, v18 offset:52480
    ds_write_b8_d16_hi v124, v55 offset:10496
    v_lshlrev_b32 v55, 2, v124
    ds_write_b32 v55, v19 offset:52480
p1_k25:
    s_cmp_ge_u32 s33, 1536
    s_cbranch_scc1 p1_k26
    s_cmp_lt_u32 s33, 1389
    s_cselect_b32 s14, 102400000, 0
    s_add_u32 s32, s31, 32768
    buffer_load_dwordx2 v[84:85], v2, s[12:15], s32 offen nt
p1_k26:
    s_cmp_ge_u32 s33, 1536
    s_cbranch_scc1 p1_k27
    s_cmp_lt_u32 s33, 1499
    s_cselect_b32 s6, 204800000, 0
    s_cselect_b32 s10, 204800000, 0
    s_add_u32 s32, s30, 16384
    buffer_load_dwordx4 v[98:101], v1, s[4:7], s32 offen nt
    buffer_load_dwordx4 v[106:109], v1, s[8:11], s32 offen nt
p1_k27:
    s_cmp_lt_u32 s29, 1352
    s_cbranch_scc1 p1_pa4
    s_waitcnt lgkmcnt(0)
    s_branch p1_pb4
p1_pa4:
    v_and_b32 v121, 0xffff, v60
    ds_add_rtn_u32 v121, v121, v3 offset:0
    v_and_b32 v122, 0xffff, v61
    ds_add_rtn_u32 v122, v122, v3 offset:0
    v_and_b32 v123, 0xffff, v62
    ds_add_rtn_u32 v123, v123, v3 offset:0
    v_and_b32 v124, 0xffff, v63
    ds_add_rtn_u32 v124, v124, v3 offset:0
    s_waitcnt lgkmcnt(4)
p1_pb4:
    s_cmp_ge_u32 s29, 1389
    s_cbranch_scc1 p1_k28
    ds_write_b8_d16_hi v117, v56 offset:10496
    v_lshlrev_b32 v56, 2, v117
    ds_write_b32 v56, v20 offset:52480
    ds_write_b8_d16_hi v118, v57 offset:10496
    v_lshlrev_b32 v57, 2, v118
    ds_write_b32 v57, v21 offset:52480
    ds_write_b8_d16_hi v119, v58 offset:10496
    v_lshlrev_b32 v58, 2, v119
    ds_write_b32 v58, v22 offset:52480
    ds_write_b8_d16_hi v120, v59 offset:10496
    v_lshlrev_b32 v59, 2, v120
    ds_write_b32 v59, v23 offset:52480
p1_k28:
    s_cmp_ge_u32 s33, 1536
    s_cbranch_scc1 p1_k29
    s_cmp_lt_u32 s33, 1352
    s_cselect_b32 s14, 102400000, 0
    s_add_u32 s32, s31, 40960
    buffer_load_dwordx2 v[86:87], v2, s[12:15], s32 offen nt
p1_k29:
    s_cmp_lt_u32 s29, 1315
    s_cbranch_scc1 p1_pa5
    s_waitcnt lgkmcnt(0)
    s_branch p1_pb5
p1_pa5:
    v_and_b32 v117, 0xffff, v64
    ds_add_rtn_u32 v117, v117, v3 offset:0
    v_and_b32 v118, 0xffff, v65
    ds_add_rtn_u32 v118, v118, v3 offset:0
    v_and_b32 v119, 0xffff, v66
    ds_add_rtn_u32 v119, v119, v3 offset:0
    v_and_b32 v120, 0xffff, v67
    ds_add_rtn_u32 v120, v120, v3 offset:0
    s_waitcnt lgkmcnt(4)
p1_pb5:
    s_cmp_ge_u32 s29, 1352
    s_cbranch_scc1 p1_k30
    ds_write_b8_d16_hi v121, v60 offset:10496
    v_lshlrev_b32 v60, 2, v121
    ds_write_b32 v60, v24 offset:52480
    ds_write_b8_d16_hi v122, v61 offset:10496
    v_lshlrev_b32 v61, 2, v122
    ds_write_b32 v61, v25 offset:52480
    ds_write_b8_d16_hi v123, v62 offset:10496
    v_lshlrev_b32 v62, 2, v123
    ds_write_b32 v62, v26 offset:52480
    ds_write_b8_d16_hi v124, v63 offset:10496
    v_lshlrev_b32 v63, 2, v124
    ds_write_b32 v63, v27 offset:52480
p1_k30:
    s_cmp_ge_u32 s33, 1536
    s_cbranch_scc1 p1_k31
    s_cmp_lt_u32 s33, 1315
    s_cselect_b32 s14, 102400000, 0
    s_add_u32 s32, s31, 49152
    buffer_load_dwordx2 v[88:89], v2, s[12:15], s32 offen nt
p1_k31:
    s_cmp_lt_u32 s29, 1279
    s_cbranch_scc1 p1_pa6
    s_waitcnt lgkmcnt(0)
    s_branch p1_pb6
p1_pa6:
    v_and_b32 v121, 0xffff, v68
    ds_add_rtn_u32 v121, v121, v3 offset:0
    v_and_b32 v122, 0xffff, v69
    ds_add_rtn_u32 v122, v122, v3 offset:0
    v_and_b32 v123, 0xffff, v70
    ds_add_rtn_u32 v123, v123, v3 offset:0
    v_and_b32 v124, 0xffff, v71
    ds_add_rtn_u32 v124, v124, v3 offset:0
    s_waitcnt lgkmcnt(4)
p1_pb6:
    s_cmp_ge_u32 s29, 1315
    s_cbranch_scc1 p1_k32
    ds_write_b8_d16_hi v117, v64 offset:10496
    v_lshlrev_b32 v64, 2, v117
    ds_write_b32 v64, v28 offset:52480
    ds_write_b8_d16_hi v118, v65 offset:10496
    v_lshlrev_b32 v65, 2, v118
    ds_write_b32 v65, v29 offset:52480
    ds_write_b8_d16_hi v119, v66 offset:10496
    v_lshlrev_b32 v66, 2, v119
    ds_write_b32 v66, v30 offset:52480
    ds_write_b8_d16_hi v120, v67 offset:10496
    v_lshlrev_b32 v67, 2, v120
    ds_write_b32 v67, v31 offset:52480
p1_k32:
    s_cmp_ge_u32 s33, 1536
    s_cbranch_scc1 p1_k33
    s_cmp_lt_u32 s33, 1279
    s_cselect_b32 s14, 102400000, 0
    s_add_u32 s32, s31, 57344
    buffer_load_dwordx2 v[90:91], v2, s[12:15], s32 offen nt
p1_k33:
    s_cmp_lt_u32 s29, 1242
    s_cbranch_scc1 p1_pa7
    s_waitcnt lgkmcnt(0)
    s_branch p1_pb7
p1_pa7:
    v_and_b32 v117, 0xffff, v72
    ds_add_rtn_u32 v117, v117, v3 offset:0
    v_and_b32 v118, 0xffff, v73
    ds_add_rtn_u32 v118, v118, v3 offset:0
    v_and_b32 v119, 0xffff, v74
    ds_add_rtn_u32 v119, v119, v3 offset:0
    v_and_b32 v120, 0xffff, v75
    ds_add_rtn_u32 v120, v120, v3 offset:0
    s_waitcnt lgkmcnt(4)
p1_pb7:
    s_cmp_ge_u32 s29, 1279
    s_cbranch_scc1 p1_k34
    ds_write_b8_d16_hi v121, v68 offset:10496
    v_lshlrev_b32 v68, 2, v121
    ds_write_b32 v68, v32 offset:52480
    ds_write_b8_d16_hi v122, v69 offset:10496
    v_lshlrev_b32 v69, 2, v122
    ds_write_b32 v69, v33 offset:52480
    ds_write_b8_d16_hi v123, v70 offset:10496
    v_lshlrev_b32 v70, 2, v123
    ds_write_b32 v70, v34 offset:52480
    ds_write_b8_d16_hi v124, v71 offset:10496
    v_lshlrev_b32 v71, 2, v124
    ds_write_b32 v71, v35 offset:52480
p1_k34:
    s_cmp_ge_u32 s33, 1536
    s_cbranch_scc1 p1_k35
    s_cmp_lt_u32 s33, 1242
    s_cselect_b32 s14, 102400000, 0
    s_add_u32 s32, s31, 65536
    buffer_load_dwordx2 v[92:93], v2, s[12:15], s32 offen nt
p1_k35:
    s_waitcnt lgkmcnt(0)
    s_cmp_ge_u32 s29, 1242
    s_cbranch_scc1 p1_k36
    ds_write_b8_d16_hi v117, v72 offset:10496
    v_lshlrev_b32 v72, 2, v117
    ds_write_b32 v72, v36 offset:52480
    ds_write_b8_d16_hi v118, v73 offset:10496
    v_lshlrev_b32 v73, 2, v118
    ds_write_b32 v73, v37 offset:52480
    ds_write_b8_d16_hi v119, v74 offset:10496
    v_lshlrev_b32 v74, 2, v119
    ds_write_b32 v74, v38 offset:52480
    ds_write_b8_d16_hi v120, v75 offset:10496
    v_lshlrev_b32 v75, 2, v120
    ds_write_b32 v75, v39 offset:52480
p1_k36:
    s_cmp_eq_u32 s68, 0
    s_cbranch_scc1 p1_sg
    s_cmp_lt_u32 s33, 1536
    s_cbranch_scc1 p1_w37
    s_waitcnt vmcnt(0)
p1_w37:
    s_waitcnt vmcnt(8)
    v_bfe_u32 v127, v127, s53, 4
    v_mov_b32 v125, 0
    s_mov_b64 exec, 1
    ds_write_b32 v125, v127 offset:10452
    s_mov_b64 exec, -1
p1_sg:
    s_cmp_lt_u32 s33, 1536
    s_cbranch_scc1 p1_f1
    s_cmp_lg_u32 s28, 15
    s_cbranch_scc1 p1_hv1
    s_waitcnt vmcnt(0)
    v_bfe_u32 v127, v127, s58, 4
    v_mov_b32 v125, 0
    s_mov_b64 exec, 1
    ds_write_b32 v125, v127 offset:10448
    s_mov_b64 exec, -1
p1_hv1:
    s_cmp_ge_u32 s33, 1656
    s_cbranch_scc1 p1_f1
    s_sub_u32 s52, s33, 1536
    s_mul_i32 s53, s52, 53760
    s_add_u32 s53, s53, 485810176
    s_mul_i32 s54, s28, 3072
    v_lshl_add_u32 v93, v92, 4, s54
    s_lshl_b32 s54, s28, 9
    s_add_u32 s54, s54, 49152
    s_cmp_lt_u32 s28, 9
    s_cselect_b32 s54, s54, 0x40000000
    v_lshl_add_u32 v94, v92, 3, s54
    v_mov_b32 v96, 0
    v_mov_b32 v97, 0
    s_waitcnt vmcnt(0)
    buffer_store_dwordx4 v[76:79], v93, s[16:19], s53 offen offset:0
    buffer_store_dwordx4 v[80:83], v93, s[16:19], s53 offen offset:1024
    buffer_store_dwordx4 v[84:87], v93, s[16:19], s53 offen offset:2048
    buffer_store_dwordx2 v[88:89], v94, s[16:19], s53 offen
    v_and_b32 v98, 0x7fff7fff, v76
    v_pk_max_u16 v96, v96, v98
    v_lshlrev_b32 v99, 16, v98
    v_and_b32 v98, 0xffff0000, v98
    v_fmac_f32 v97, v99, v99
    v_fmac_f32 v97, v98, v98
    v_and_b32 v98, 0x7fff7fff, v77
    v_pk_max_u16 v96, v96, v98
    v_lshlrev_b32 v99, 16, v98
    v_and_b32 v98, 0xffff0000, v98
    v_fmac_f32 v97, v99, v99
    v_fmac_f32 v97, v98, v98
    v_and_b32 v98, 0x7fff7fff, v78
    v_pk_max_u16 v96, v96, v98
    v_lshlrev_b32 v99, 16, v98
    v_and_b32 v98, 0xffff0000, v98
    v_fmac_f32 v97, v99, v99
    v_fmac_f32 v97, v98, v98
    v_and_b32 v98, 0x7fff7fff, v79
    v_pk_max_u16 v96, v96, v98
    v_lshlrev_b32 v99, 16, v98
    v_and_b32 v98, 0xffff0000, v98
    v_fmac_f32 v97, v99, v99
    v_fmac_f32 v97, v98, v98
    v_and_b32 v98, 0x7fff7fff, v80
    v_pk_max_u16 v96, v96, v98
    v_lshlrev_b32 v99, 16, v98
    v_and_b32 v98, 0xffff0000, v98
    v_fmac_f32 v97, v99, v99
    v_fmac_f32 v97, v98, v98
    v_and_b32 v98, 0x7fff7fff, v81
    v_pk_max_u16 v96, v96, v98
    v_lshlrev_b32 v99, 16, v98
    v_and_b32 v98, 0xffff0000, v98
    v_fmac_f32 v97, v99, v99
    v_fmac_f32 v97, v98, v98
    v_and_b32 v98, 0x7fff7fff, v82
    v_pk_max_u16 v96, v96, v98
    v_lshlrev_b32 v99, 16, v98
    v_and_b32 v98, 0xffff0000, v98
    v_fmac_f32 v97, v99, v99
    v_fmac_f32 v97, v98, v98
    v_and_b32 v98, 0x7fff7fff, v83
    v_pk_max_u16 v96, v96, v98
    v_lshlrev_b32 v99, 16, v98
    v_and_b32 v98, 0xffff0000, v98
    v_fmac_f32 v97, v99, v99
    v_fmac_f32 v97, v98, v98
    v_and_b32 v98, 0x7fff7fff, v84
    v_pk_max_u16 v96, v96, v98
    v_lshlrev_b32 v99, 16, v98
    v_and_b32 v98, 0xffff0000, v98
    v_fmac_f32 v97, v99, v99
    v_fmac_f32 v97, v98, v98
    v_and_b32 v98, 0x7fff7fff, v85
    v_pk_max_u16 v96, v96, v98
    v_lshlrev_b32 v99, 16, v98
    v_and_b32 v98, 0xffff0000, v98
    v_fmac_f32 v97, v99, v99
    v_fmac_f32 v97, v98, v98
    v_and_b32 v98, 0x7fff7fff, v86
    v_pk_max_u16 v96, v96, v98
    v_lshlrev_b32 v99, 16, v98
    v_and_b32 v98, 0xffff0000, v98
    v_fmac_f32 v97, v99, v99
    v_fmac_f32 v97, v98, v98
    v_and_b32 v98, 0x7fff7fff, v87
    v_pk_max_u16 v96, v96, v98
    v_lshlrev_b32 v99, 16, v98
    v_and_b32 v98, 0xffff0000, v98
    v_fmac_f32 v97, v99, v99
    v_fmac_f32 v97, v98, v98
    v_and_b32 v98, 0x7fff7fff, v88
    v_pk_max_u16 v96, v96, v98
    v_lshlrev_b32 v99, 16, v98
    v_and_b32 v98, 0xffff0000, v98
    v_fmac_f32 v97, v99, v99
    v_fmac_f32 v97, v98, v98
    v_and_b32 v98, 0x7fff7fff, v89
    v_pk_max_u16 v96, v96, v98
    v_lshlrev_b32 v99, 16, v98
    v_and_b32 v98, 0xffff0000, v98
    v_fmac_f32 v97, v99, v99
    v_fmac_f32 v97, v98, v98
    v_lshrrev_b32 v98, 16, v96
    v_and_b32 v96, 0xffff, v96
    v_max_u32 v96, v96, v98
    s_nop 1
    v_max_u32_dpp v96, v96, v96 row_shr:1 row_mask:0xf bank_mask:0xf bound_ctrl:0
    v_add_f32_dpp v97, v97, v97 row_shr:1 row_mask:0xf bank_mask:0xf bound_ctrl:0
    s_nop 0
    v_max_u32_dpp v96, v96, v96 row_shr:2 row_mask:0xf bank_mask:0xf bound_ctrl:0
    v_add_f32_dpp v97, v97, v97 row_shr:2 row_mask:0xf bank_mask:0xf bound_ctrl:0
    s_nop 0
    v_max_u32_dpp v96, v96, v96 row_shr:4 row_mask:0xf bank_mask:0xf bound_ctrl:0
    v_add_f32_dpp v97, v97, v97 row_shr:4 row_mask:0xf bank_mask:0xf bound_ctrl:0
    s_nop 0
    v_max_u32_dpp v96, v96, v96 row_shr:8 row_mask:0xf bank_mask:0xf bound_ctrl:0
    v_add_f32_dpp v97, v97, v97 row_shr:8 row_mask:0xf bank_mask:0xf bound_ctrl:0
    s_nop 0
    v_max_u32_dpp v96, v96, v96 row_bcast:15 row_mask:0xa bank_mask:0xf
    v_add_f32_dpp v97, v97, v97 row_bcast:15 row_mask:0xa bank_mask:0xf
    s_nop 0
    v_max_u32_dpp v96, v96, v96 row_bcast:31 row_mask:0xc bank_mask:0xf
    v_add_f32_dpp v97, v97, v97 row_bcast:31 row_mask:0xc bank_mask:0xf
    s_nop 0
    s_nop 0
    s_lshl_b32 s52, s52, 4
    s_add_u32 s52, s52, s28
    s_lshl_b32 s52, s52, 3
    s_add_u32 s52, s52, 492261376
    s_mov_b64 exec, 1
    s_lshl_b64 exec, exec, 63
    buffer_store_dwordx2 v[96:97], off, s[16:19], s52
    s_mov_b64 exec, -1
p1_f1:
    s_waitcnt lgkmcnt(0)
    s_barrier
    v_mul_u32_u24 v119, 3, v0
    v_and_b32 v118, -4, v119
    v_add_u32 v120, s50, v1
    v_mov_b32 v122, 0
    v_mov_b32 v123, 0
    v_mov_b32 v124, 0
    v_mov_b32 v125, 0
    ds_read_b64 v[126:127], v122 offset:10448
    ds_write_b32 v122, v122 offset:10432
    v_cmp_gt_u32 vcc, 640, v0
    s_and_saveexec_b64 s[52:53], vcc
    ds_write_b128 v1, v[122:125] offset:0
    s_mov_b64 exec, -1
    s_waitcnt lgkmcnt(2)
    v_readfirstlane_b32 s70, v126
    v_readfirstlane_b32 s69, v127
    s_cmp_ge_u32 s33, 1536
    s_cselect_b32 s70, s70, 0
    s_cmp_gt_u32 s28, 10
    s_cselect_b32 s69, 0, s69
    s_cselect_b32 s70, 0, s70
    s_cmp_lg_u32 s70, 8
    s_cbranch_scc1 p1_h0
    s_sub_u32 s52, s33, 1536
    v_and_b32 v102, 63, v0
    s_cmp_eq_u32 s28, 10
    s_cbranch_scc1 p1_tr10
    s_mul_i32 s53, s28, 520
    v_lshl_add_u32 v100, v102, 3, s53
    s_mul_i32 s53, s28, 4160
    v_lshl_add_u32 v101, v102, 4, s53
    s_branch p1_tr20
p1_tr10:
    v_mul_u32_u24 v100, 520, v102
    v_add_u32 v100, 512, v100
    v_mul_u32_u24 v101, 4160, v102
    v_add_u32 v101, 1024, v101
    v_cmp_gt_u32 vcc, 10, v102
    v_mov_b32 v102, 0x40000000
    s_nop 0
    v_cndmask_b32 v100, v102, v100, vcc
    v_cndmask_b32 v101, v102, v101, vcc
p1_tr20:
    s_mul_i32 s52, s52, 41984
    s_add_u32 s52, s52, 469762048
    buffer_load_dwordx2 v[76:77], v100, s[16:19], s52 offen sc1
    s_add_u32 s52, s52, 5248
    buffer_load_dwordx2 v[78:79], v100, s[16:19], s52 offen sc1
    s_add_u32 s52, s52, 5248
    buffer_load_dwordx2 v[80:81], v100, s[16:19], s52 offen sc1
    s_add_u32 s52, s52, 5248
    buffer_load_dwordx2 v[82:83], v100, s[16:19], s52 offen sc1
    s_add_u32 s52, s52, 5248
    buffer_load_dwordx2 v[84:85], v100, s[16:19], s52 offen sc1
    s_add_u32 s52, s52, 5248
    buffer_load_dwordx2 v[86:87], v100, s[16:19], s52 offen sc1
    s_add_u32 s52, s52, 5248
    buffer_load_dwordx2 v[88:89], v100, s[16:19], s52 offen sc1
    s_add_u32 s52, s52, 5248
    buffer_load_dwordx2 v[90:91], v100, s[16:19], s52 offen sc1
    s_add_u32 s52, s52, 5248
p1_h0:
    v_lshlrev_b32 v117, 2, v119
    v_add_u32 v117, 52480, v117
    ds_read_b32 v110, v117 offset:0
    ds_read_b32 v111, v117 offset:4
    ds_read_b32 v112, v117 offset:8
    ds_read_b32 v113, v118 offset:10496
    ds_read_b32 v114, v118 offset:10500
    ds_read_b32 v122, v117 offset:12288
    ds_read_b32 v123, v117 offset:12292
    ds_read_b32 v124, v117 offset:12296
    ds_read_b32 v125, v118 offset:13568
    ds_read_b32 v121, v118 offset:13572
    s_waitcnt lgkmcnt(5)
    v_alignbyte_b32 v113, v114, v113, v119
    buffer_store_dwordx4 v[110:113], v120, s[20:23], 0 offen
    v_add_u32 v120, 33554432, v120
    s_nop 0
    ds_read_b32 v110, v117 offset:24576
    ds_read_b32 v111, v117 offset:24580
    ds_read_b32 v112, v117 offset:24584
    ds_read_b32 v113, v118 offset:16640
    ds_read_b32 v114, v118 offset:16644
    s_cmp_le_u32 s35, 1024
    s_cbranch_scc1 p1_ce0
    s_waitcnt lgkmcnt(5)
    v_alignbyte_b32 v125, v121, v125, v119
    buffer_store_dwordx4 v[122:125], v120, s[20:23], 0 offen
    v_add_u32 v120, 33554432, v120
    s_nop 0
    ds_read_b32 v122, v117 offset:36864
    ds_read_b32 v123, v117 offset:36868
    ds_read_b32 v124, v117 offset:36872
    ds_read_b32 v125, v118 offset:19712
    ds_read_b32 v121, v118 offset:19716
    s_cmp_le_u32 s35, 2048
    s_cbranch_scc1 p1_ce0
    s_waitcnt lgkmcnt(5)
    v_alignbyte_b32 v113, v114, v113, v119
    buffer_store_dwordx4 v[110:113], v120, s[20:23], 0 offen
    v_add_u32 v120, 33554432, v120
    s_nop 0
    ds_read_b32 v110, v117 offset:49152
    ds_read_b32 v111, v117 offset:49156
    ds_read_b32 v112, v117 offset:49160
    ds_read_b32 v113, v118 offset:22784
    ds_read_b32 v114, v118 offset:22788
    s_cmp_le_u32 s35, 3072
    s_cbranch_scc1 p1_ce0
    s_waitcnt lgkmcnt(5)
    v_alignbyte_b32 v125, v121, v125, v119
    buffer_store_dwordx4 v[122:125], v120, s[20:23], 0 offen
    v_add_u32 v120, 33554432, v120
    s_nop 0
    v_lshlrev_b32 v117, 2, v119
    v_add_u32 v117, 113920, v117
    ds_read_b32 v122, v117 offset:0
    ds_read_b32 v123, v117 offset:4
    ds_read_b32 v124, v117 offset:8
    ds_read_b32 v125, v118 offset:25856
    ds_read_b32 v121, v118 offset:25860
    s_cmp_le_u32 s35, 4096
    s_cbranch_scc1 p1_ce0
    s_waitcnt lgkmcnt(5)
    v_alignbyte_b32 v113, v114, v113, v119
    buffer_store_dwordx4 v[110:113], v120, s[20:23], 0 offen
    v_add_u32 v120, 33554432, v120
    s_nop 0
    ds_read_b32 v110, v117 offset:12288
    ds_read_b32 v111, v117 offset:12292
    ds_read_b32 v112, v117 offset:12296
    ds_read_b32 v113, v118 offset:28928
    ds_read_b32 v114, v118 offset:28932
    s_cmp_le_u32 s35, 5120
    s_cbranch_scc1 p1_ce0
    s_waitcnt lgkmcnt(5)
    v_alignbyte_b32 v125, v121, v125, v119
    buffer_store_dwordx4 v[122:125], v120, s[20:23], 0 offen
    v_add_u32 v120, 33554432, v120
    s_nop 0
    ds_read_b32 v122, v117 offset:24576
    ds_read_b32 v123, v117 offset:24580
    ds_read_b32 v124, v117 offset:24584
    ds_read_b32 v125, v118 offset:32000
    ds_read_b32 v121, v118 offset:32004
    s_cmp_le_u32 s35, 6144
    s_cbranch_scc1 p1_ce0
    s_waitcnt lgkmcnt(5)
    v_alignbyte_b32 v113, v114, v113, v119
    buffer_store_dwordx4 v[110:113], v120, s[20:23], 0 offen
    v_add_u32 v120, 33554432, v120
    s_nop 0
    ds_read_b32 v110, v117 offset:36864
    ds_read_b32 v111, v117 offset:36868
    ds_read_b32 v112, v117 offset:36872
    ds_read_b32 v113, v118 offset:35072
    ds_read_b32 v114, v118 offset:35076
    s_cmp_le_u32 s35, 7168
    s_cbranch_scc1 p1_ce0
    s_waitcnt lgkmcnt(5)
    v_alignbyte_b32 v125, v121, v125, v119
    s_cmp_le_u32 s71, 7
    s_cbranch_scc1 p1_pw7
    buffer_store_dwordx4 v[122:125], v120, s[20:23], 0 offen
    s_branch p1_px7
p1_pw7:
    buffer_store_dwordx4 v[122:125], v120, s[20:23], 0 offen nt
p1_px7:
    v_add_u32 v120, 33554432, v120
    s_nop 0
    s_cmp_le_u32 s35, 8192
    s_cbranch_scc1 p1_ce0
    s_waitcnt lgkmcnt(0)
    v_alignbyte_b32 v113, v114, v113, v119
    buffer_store_dwordx4 v[110:113], v120, s[20:23], 0 offen nt
    v_add_u32 v120, 33554432, v120
    s_nop 0
p1_ce0:
    s_waitcnt lgkmcnt(0)
    s_cmp_lg_u32 s70, 8
    s_cbranch_scc1 p1_h1
    s_sub_u32 s52, s33, 1536
    s_mul_i32 s52, s52, 41600
    s_add_u32 s52, s52, 477822976
    s_mov_b32 s54, 0x05040100
    s_mov_b32 s55, 0x07060302
    s_waitcnt vmcnt(1)
    v_perm_b32 v92, v78, v76, s54
    v_perm_b32 v93, v82, v80, s54
    v_perm_b32 v94, v86, v84, s54
    v_perm_b32 v95, v90, v88, s54
    buffer_store_dwordx4 v[92:95], v101, s[16:19], s52 offen offset:0
    v_perm_b32 v96, v78, v76, s55
    v_perm_b32 v97, v82, v80, s55
    v_perm_b32 v98, v86, v84, s55
    v_perm_b32 v99, v90, v88, s55
    buffer_store_dwordx4 v[96:99], v101, s[16:19], s52 offen offset:1040
    v_perm_b32 v92, v79, v77, s54
    v_perm_b32 v93, v83, v81, s54
    v_perm_b32 v94, v87, v85, s54
    v_perm_b32 v95, v91, v89, s54
    buffer_store_dwordx4 v[92:95], v101, s[16:19], s52 offen offset:2080
    v_perm_b32 v96, v79, v77, s55
    v_perm_b32 v97, v83, v81, s55
    v_perm_b32 v98, v87, v85, s55
    v_perm_b32 v99, v91, v89, s55
    buffer_store_dwordx4 v[96:99], v101, s[16:19], s52 offen offset:3120
p1_h1:
    s_barrier
    s_cmp_ge_u32 s29, 1462
    s_cbranch_scc1 p1_k38
    s_cmp_le_u32 s35, 9216
    s_cbranch_scc1 p1_s1k2
    v_sub_u32 v48, 221180, v48
    ds_write_b32 v48, v12 offset:52480
    v_sub_u32 v49, 221180, v49
    ds_write_b32 v49, v13 offset:52480
    v_sub_u32 v50, 221180, v50
    ds_write_b32 v50, v14 offset:52480
    v_sub_u32 v51, 221180, v51
    ds_write_b32 v51, v15 offset:52480
p1_s1k2:
p1_k38:
    s_cmp_ge_u32 s33, 1536
    s_cbranch_scc1 p1_k39
    s_cmp_lt_u32 s33, 1462
    s_cselect_b32 s6, 204800000, 0
    s_cselect_b32 s10, 204800000, 0
    s_add_u32 s32, s30, 32768
    buffer_load_dwordx4 v[12:15], v1, s[4:7], s32 offen nt
    buffer_load_dwordx4 v[48:51], v1, s[8:11], s32 offen nt
p1_k39:
    s_cmp_ge_u32 s29, 1426
    s_cbranch_scc1 p1_k40
    s_cmp_le_u32 s35, 9216
    s_cbranch_scc1 p1_s1k3
    v_sub_u32 v52, 221180, v52
    ds_write_b32 v52, v16 offset:52480
    v_sub_u32 v53, 221180, v53
    ds_write_b32 v53, v17 offset:52480
    v_sub_u32 v54, 221180, v54
    ds_write_b32 v54, v18 offset:52480
    v_sub_u32 v55, 221180, v55
    ds_write_b32 v55, v19 offset:52480
p1_s1k3:
p1_k40:
    s_cmp_ge_u32 s29, 1389
    s_cbranch_scc1 p1_k41
    s_cmp_le_u32 s35, 9216
    s_cbranch_scc1 p1_s1k4
    v_sub_u32 v56, 221180, v56
    ds_write_b32 v56, v20 offset:52480
    v_sub_u32 v57, 221180, v57
    ds_write_b32 v57, v21 offset:52480
    v_sub_u32 v58, 221180, v58
    ds_write_b32 v58, v22 offset:52480
    v_sub_u32 v59, 221180, v59
    ds_write_b32 v59, v23 offset:52480
p1_s1k4:
p1_k41:
    s_cmp_ge_u32 s29, 1352
    s_cbranch_scc1 p1_k42
    s_cmp_le_u32 s35, 9216
    s_cbranch_scc1 p1_s1k5
    v_sub_u32 v60, 221180, v60
    ds_write_b32 v60, v24 offset:52480
    v_sub_u32 v61, 221180, v61
    ds_write_b32 v61, v25 offset:52480
    v_sub_u32 v62, 221180, v62
    ds_write_b32 v62, v26 offset:52480
    v_sub_u32 v63, 221180, v63
    ds_write_b32 v63, v27 offset:52480
p1_s1k5:
p1_k42:
    s_cmp_ge_u32 s29, 1315
    s_cbranch_scc1 p1_k43
    s_cmp_le_u32 s35, 9216
    s_cbranch_scc1 p1_s1k6
    v_sub_u32 v64, 221180, v64
    ds_write_b32 v64, v28 offset:52480
    v_sub_u32 v65, 221180, v65
    ds_write_b32 v65, v29 offset:52480
    v_sub_u32 v66, 221180, v66
    ds_write_b32 v66, v30 offset:52480
    v_sub_u32 v67, 221180, v67
    ds_write_b32 v67, v31 offset:52480
p1_s1k6:
p1_k43:
    s_cmp_ge_u32 s29, 1279
    s_cbranch_scc1 p1_k44
    s_cmp_le_u32 s35, 9216
    s_cbranch_scc1 p1_s1k7
    v_sub_u32 v68, 221180, v68
    ds_write_b32 v68, v32 offset:52480
    v_sub_u32 v69, 221180, v69
    ds_write_b32 v69, v33 offset:52480
    v_sub_u32 v70, 221180, v70
    ds_write_b32 v70, v34 offset:52480
    v_sub_u32 v71, 221180, v71
    ds_write_b32 v71, v35 offset:52480
p1_s1k7:
p1_k44:
    s_cmp_ge_u32 s29, 1242
    s_cbranch_scc1 p1_k45
    s_cmp_le_u32 s35, 9216
    s_cbranch_scc1 p1_s1k8
    v_sub_u32 v72, 221180, v72
    ds_write_b32 v72, v36 offset:52480
    v_sub_u32 v73, 221180, v73
    ds_write_b32 v73, v37 offset:52480
    v_sub_u32 v74, 221180, v74
    ds_write_b32 v74, v38 offset:52480
    v_sub_u32 v75, 221180, v75
    ds_write_b32 v75, v39 offset:52480
p1_s1k8:
p1_k45:
    s_cmp_le_u32 s35, 9216
    s_cbranch_scc1 p1_s1k0
    v_sub_u32 v40, 221180, v40
    ds_write_b32 v40, v4 offset:52480
    v_sub_u32 v41, 221180, v41
    ds_write_b32 v41, v5 offset:52480
    v_sub_u32 v42, 221180, v42
    ds_write_b32 v42, v6 offset:52480
    v_sub_u32 v43, 221180, v43
    ds_write_b32 v43, v7 offset:52480
p1_s1k0:
    s_cmp_ge_u32 s29, 1499
    s_cbranch_scc1 p1_k46
    s_cmp_le_u32 s35, 9216
    s_cbranch_scc1 p1_s1k1
    v_sub_u32 v44, 221180, v44
    ds_write_b32 v44, v8 offset:52480
    v_sub_u32 v45, 221180, v45
    ds_write_b32 v45, v9 offset:52480
    v_sub_u32 v46, 221180, v46
    ds_write_b32 v46, v10 offset:52480
    v_sub_u32 v47, 221180, v47
    ds_write_b32 v47, v11 offset:52480
p1_s1k1:
p1_k46:
    s_cmp_lg_u32 s69, 8
    s_cbranch_scc1 p1_o1
    s_lshr_b32 s52, s29, 3
    v_and_b32 v74, 63, v0
    s_cmp_eq_u32 s28, 10
    s_cbranch_scc1 p1_tr11
    s_mul_i32 s53, s28, 520
    v_lshl_add_u32 v72, v74, 3, s53
    s_mul_i32 s53, s28, 4160
    v_lshl_add_u32 v73, v74, 4, s53
    s_branch p1_tr21
p1_tr11:
    v_mul_u32_u24 v72, 520, v74
    v_add_u32 v72, 512, v72
    v_mul_u32_u24 v73, 4160, v74
    v_add_u32 v73, 1024, v73
    v_cmp_gt_u32 vcc, 10, v74
    v_mov_b32 v74, 0x40000000
    s_nop 0
    v_cndmask_b32 v72, v74, v72, vcc
    v_cndmask_b32 v73, v74, v73, vcc
p1_tr21:
    s_mul_i32 s52, s52, 41984
    s_add_u32 s52, s52, 469762048
    buffer_load_dwordx2 v[24:25], v72, s[16:19], s52 offen sc1
    s_add_u32 s52, s52, 5248
    buffer_load_dwordx2 v[26:27], v72, s[16:19], s52 offen sc1
    s_add_u32 s52, s52, 5248
    buffer_load_dwordx2 v[28:29], v72, s[16:19], s52 offen sc1
    s_add_u32 s52, s52, 5248
    buffer_load_dwordx2 v[30:31], v72, s[16:19], s52 offen sc1
    s_add_u32 s52, s52, 5248
    buffer_load_dwordx2 v[32:33], v72, s[16:19], s52 offen sc1
    s_add_u32 s52, s52, 5248
    buffer_load_dwordx2 v[34:35], v72, s[16:19], s52 offen sc1
    s_add_u32 s52, s52, 5248
    buffer_load_dwordx2 v[36:37], v72, s[16:19], s52 offen sc1
    s_add_u32 s52, s52, 5248
    buffer_load_dwordx2 v[38:39], v72, s[16:19], s52 offen sc1
    s_add_u32 s52, s52, 5248
    s_cmp_ge_u32 s33, 1536
    s_cbranch_scc1 p1_o1
    s_lshr_b32 s52, s29, 3
    s_mul_i32 s52, s52, 41600
    s_add_u32 s52, s52, 477822976
    s_mov_b32 s54, 0x05040100
    s_mov_b32 s55, 0x07060302
    s_waitcnt vmcnt(0)
    v_perm_b32 v64, v26, v24, s54
    v_perm_b32 v65, v30, v28, s54
    v_perm_b32 v66, v34, v32, s54
    v_perm_b32 v67, v38, v36, s54
    buffer_store_dwordx4 v[64:67], v73, s[16:19], s52 offen offset:0
    v_perm_b32 v68, v26, v24, s55
    v_perm_b32 v69, v30, v28, s55
    v_perm_b32 v70, v34, v32, s55
    v_perm_b32 v71, v38, v36, s55
    buffer_store_dwordx4 v[68:71], v73, s[16:19], s52 offen offset:1040
    v_perm_b32 v64, v27, v25, s54
    v_perm_b32 v65, v31, v29, s54
    v_perm_b32 v66, v35, v33, s54
    v_perm_b32 v67, v39, v37, s54
    buffer_store_dwordx4 v[64:67], v73, s[16:19], s52 offen offset:2080
    v_perm_b32 v68, v27, v25, s55
    v_perm_b32 v69, v31, v29, s55
    v_perm_b32 v70, v35, v33, s55
    v_perm_b32 v71, v39, v37, s55
    buffer_store_dwordx4 v[68:71], v73, s[16:19], s52 offen offset:3120
    s_mov_b32 s69, 0
p1_o1:
    s_waitcnt lgkmcnt(0)
    s_barrier
    s_cmp_le_u32 s35, 9216
    s_cbranch_scc1 p1_ce1
    v_lshlrev_b32 v117, 2, v119
    v_sub_u32 v117, 113908, v117
    ds_read_b32 v122, v117 offset:49160
    ds_read_b32 v123, v117 offset:49156
    ds_read_b32 v124, v117 offset:49152
    ds_read_b32 v125, v118 offset:38144
    ds_read_b32 v121, v118 offset:38148
    ds_read_b32 v110, v117 offset:36872
    ds_read_b32 v111, v117 offset:36868
    ds_read_b32 v112, v117 offset:36864
    ds_read_b32 v113, v118 offset:41216
    ds_read_b32 v114, v118 offset:41220
    s_waitcnt lgkmcnt(5)
    v_alignbyte_b32 v125, v121, v125, v119
    buffer_store_dwordx4 v[122:125], v120, s[20:23], 0 offen nt
    v_add_u32 v120, 33554432, v120
    s_nop 0
    ds_read_b32 v122, v117 offset:24584
    ds_read_b32 v123, v117 offset:24580
    ds_read_b32 v124, v117 offset:24576
    ds_read_b32 v125, v118 offset:44288
    ds_read_b32 v121, v118 offset:44292
    s_cmp_le_u32 s35, 10240
    s_cbranch_scc1 p1_ce1
    s_waitcnt lgkmcnt(5)
    v_alignbyte_b32 v113, v114, v113, v119
    buffer_store_dwordx4 v[110:113], v120, s[20:23], 0 offen nt
    v_add_u32 v120, 33554432, v120
    s_nop 0
    ds_read_b32 v110, v117 offset:12296
    ds_read_b32 v111, v117 offset:12292
    ds_read_b32 v112, v117 offset:12288
    ds_read_b32 v113, v118 offset:47360
    ds_read_b32 v114, v118 offset:47364
    s_cmp_le_u32 s35, 11264
    s_cbranch_scc1 p1_ce1
    s_waitcnt lgkmcnt(5)
    v_alignbyte_b32 v125, v121, v125, v119
    buffer_store_dwordx4 v[122:125], v120, s[20:23], 0 offen nt
    v_add_u32 v120, 33554432, v120
    s_nop 0
    ds_read_b32 v122, v117 offset:8
    ds_read_b32 v123, v117 offset:4
    ds_read_b32 v124, v117 offset:0
    ds_read_b32 v125, v118 offset:50432
    ds_read_b32 v121, v118 offset:50436
    s_cmp_le_u32 s35, 12288
    s_cbranch_scc1 p1_ce1
    s_waitcnt lgkmcnt(5)
    v_alignbyte_b32 v113, v114, v113, v119
    buffer_store_dwordx4 v[110:113], v120, s[20:23], 0 offen nt
    v_add_u32 v120, 33554432, v120
    s_nop 0
    s_cmp_le_u32 s35, 13312
    s_cbranch_scc1 p1_ce1
    s_waitcnt lgkmcnt(0)
    v_alignbyte_b32 v125, v121, v125, v119
    buffer_store_dwordx4 v[122:125], v120, s[20:23], 0 offen nt
    v_add_u32 v120, 33554432, v120
    s_nop 0
p1_ce1:
    s_waitcnt lgkmcnt(0)
    s_cmp_lg_u32 s69, 8
    s_cbranch_scc1 p1_o2
    s_lshr_b32 s52, s29, 3
    s_mul_i32 s52, s52, 41600
    s_add_u32 s52, s52, 477822976
    s_mov_b32 s54, 0x05040100
    s_mov_b32 s55, 0x07060302
    s_waitcnt vmcnt(0)
    v_perm_b32 v64, v26, v24, s54
    v_perm_b32 v65, v30, v28, s54
    v_perm_b32 v66, v34, v32, s54
    v_perm_b32 v67, v38, v36, s54
    buffer_store_dwordx4 v[64:67], v73, s[16:19], s52 offen offset:0
    v_perm_b32 v68, v26, v24, s55
    v_perm_b32 v69, v30, v28, s55
    v_perm_b32 v70, v34, v32, s55
    v_perm_b32 v71, v38, v36, s55
    buffer_store_dwordx4 v[68:71], v73, s[16:19], s52 offen offset:1040
    v_perm_b32 v64, v27, v25, s54
    v_perm_b32 v65, v31, v29, s54
    v_perm_b32 v66, v35, v33, s54
    v_perm_b32 v67, v39, v37, s54
    buffer_store_dwordx4 v[64:67], v73, s[16:19], s52 offen offset:2080
    v_perm_b32 v68, v27, v25, s55
    v_perm_b32 v69, v31, v29, s55
    v_perm_b32 v70, v35, v33, s55
    v_perm_b32 v71, v39, v37, s55
    buffer_store_dwordx4 v[68:71], v73, s[16:19], s52 offen offset:3120
p1_o2:
    s_barrier
    s_mov_b32 s29, s33
    s_cmp_lt_u32 s29, 1242
    s_cselect_b32 s34, 1, 0
    s_cmp_lt_u32 s29, 1536
    s_cbranch_scc1 p1_tile
p1_end:
    s_endpgm
.globl p2_kernel
.p2align 8
.type p2_kernel,@function
p2_kernel:
    s_cmp_ge_u32 s2, 256
    s_cbranch_scc1 p2_end
    s_load_dwordx2 s[8:9], s[0:1], 104
    v_and_b32 v112, 63, v0
    v_lshrrev_b32 v122, 6, v0
    v_lshlrev_b32 v112, 4, v112
    v_readfirstlane_b32 s10, v122
    v_mov_b32 v113, 0x83ff0000
    s_and_b32 s44, s2, 7
    s_lshr_b32 s11, s44, 1
    s_and_b32 s44, s44, 1
    s_lshl_b32 s12, s44, 5
    s_lshr_b32 s44, s2, 3
    s_add_u32 s12, s12, s44
    s_mov_b32 s25, 54272
    s_mov_b32 s31, 67175170
    s_mov_b32 s32, 83952386
    s_mov_b32 s33, 100729602
    s_mov_b32 s21, 0
    s_mul_i32 s23, s10, 3072
    s_lshl_b32 s24, s10, 9
    s_lshl_b32 s64, s10, 10
    s_sub_u32 s42, s24, s23
    s_add_u32 s42, s42, 49152
    s_movk_i32 s63, 2048
    s_movk_i32 s65, 16384
    s_mul_i32 s62, s11, 161280
    s_add_u32 s62, s62, 485810176
    s_add_u32 s62, s62, s23
    s_mov_b32 s40, 477822976
    s_mul_i32 s44, s11, 1040
    s_add_u32 s40, s40, s44
    s_lshl_b32 s44, s12, 4
    s_add_u32 s40, s40, s44
    s_waitcnt lgkmcnt(0)
    s_mov_b32 s4, s8
    s_and_b32 s5, s9, 0xffff
    s_mov_b32 s6, 819200000
    s_mov_b32 s7, 0x20000
    s_mov_b32 s68, s8
    s_and_b32 s69, s9, 0xffff
    s_mov_b32 s70, 469762048
    s_mov_b32 s71, 0x20000
    s_and_b32 s44, s2, 7
    s_lshl_b32 s44, s44, 2
    s_lshr_b32 s18, 0x00000000, s44
    s_and_b32 s18, s18, 15
p2_restart:
    s_mov_b32 s61, 0
    s_add_u32 s44, s61, s18
    s_cmp_ge_u32 s44, 10
    s_cselect_b32 s53, 10, 0
    s_sub_u32 s44, s44, s53
    s_mul_i32 s44, s44, 4160
    s_add_u32 s44, s44, s40
    v_bfe_i32 v111, v112, 6, 1
    v_lshrrev_b32 v110, 6, v112
    v_bitop3_b32 v111, v111, 15, s10 bitop3:0x6a
    v_lshl_or_b32 v110, v110, 4, v111
    v_bfe_u32 v111, v112, 2, 4
    v_mul_u32_u24 v110, 41600, v110
    v_add_u32 v111, v110, v111
    v_add_u32 v110, 256, v112
    v_and_b32 v110, 0x400, v110
    v_lshl_or_b32 v111, v110, 20, v111
    buffer_load_dword v110, v111, s[4:7], s44 offen
    buffer_load_dword v111, v111, s[4:7], s44 offen offset:16
    s_mov_b32 s61, 1
    s_add_u32 s44, s61, s18
    s_cmp_ge_u32 s44, 10
    s_cselect_b32 s53, 10, 0
    s_sub_u32 s44, s44, s53
    s_mul_i32 s44, s44, 4160
    s_add_u32 s44, s44, s40
    v_bfe_i32 v69, v112, 6, 1
    v_lshrrev_b32 v68, 6, v112
    v_bitop3_b32 v69, v69, 15, s10 bitop3:0x6a
    v_lshl_or_b32 v68, v68, 4, v69
    v_bfe_u32 v69, v112, 2, 4
    v_mul_u32_u24 v68, 41600, v68
    v_add_u32 v69, v68, v69
    v_add_u32 v68, 256, v112
    v_and_b32 v68, 0x400, v68
    v_lshl_or_b32 v69, v68, 20, v69
    buffer_load_dword v68, v69, s[4:7], s44 offen
    buffer_load_dword v69, v69, s[4:7], s44 offen offset:16
    s_mov_b32 s61, 0
    s_cmp_lt_u32 s10, 15
    s_cselect_b32 s44, s64, 0x40000000
    v_add_u32 v60, s44, v112
    s_mov_b32 s44, 492261376
    buffer_load_dwordx4 v[60:63], v60, s[4:7], s44 offen
    s_mul_i32 s20, s18, 645120
    s_add_u32 s20, s20, s62
    s_cmp_ge_u32 s10, 9
    s_cbranch_scc1 p2_nmp
    v_lshrrev_b32 v84, 1, v112
    s_add_u32 s44, s20, s42
    buffer_load_dwordx2 v[84:85], v84, s[4:7], s44 offen
p2_nmp:
    buffer_load_dwordx4 v[72:75], v112, s[4:7], s20 offen offset:0
    buffer_load_dwordx4 v[76:79], v112, s[4:7], s20 offen offset:1024
    buffer_load_dwordx4 v[80:83], v112, s[4:7], s20 offen offset:2048
    s_barrier
    v_mov_b32 v115, 0
    v_mov_b32 v116, 0
    v_mov_b32 v117, 0
    v_mov_b32 v118, 0
    v_mov_b32 v119, 0
    v_mov_b32 v120, 0
    v_mov_b32 v121, 0
    ds_write_b128 v115, v[116:119] offset:53760
    s_mov_b32 s19, 0
    s_cmp_eq_u32 s21, 2
    s_cselect_b64 s[66:67], -1, 0
    s_waitcnt lgkmcnt(0)
    s_barrier
    s_waitcnt vmcnt(6)
    s_mov_b32 m0, s23
    v_mov_b32 v53, 0
    s_movk_i32 s44, 512
    v_sub_u32_sdwa v4, v111, v110 dst_sel:DWORD dst_unused:UNUSED_PAD src0_sel:WORD_0 src1_sel:WORD_0
    v_sub_u32_sdwa v5, v111, v110 dst_sel:DWORD dst_unused:UNUSED_PAD src0_sel:WORD_1 src1_sel:WORD_1
    v_med3_i32 v4, v4, 0, s44
    v_med3_i32 v5, v5, 0, s44
    v_add_u32 v48, v4, v5
    ds_write_addtid_b32 v53 offset:0
    ds_write_addtid_b32 v53 offset:256
    ds_write_addtid_b32 v53 offset:512
    ds_write_addtid_b32 v53 offset:768
    ds_write_addtid_b32 v53 offset:1024
    ds_write_addtid_b32 v53 offset:1280
    ds_write_addtid_b32 v53 offset:1536
    ds_write_addtid_b32 v53 offset:1792
    v_bfe_i32 v53, v112, 6, 1
    v_lshrrev_b32 v49, 6, v112
    v_bitop3_b32 v53, v53, 15, s10 bitop3:0x6a
    v_lshl_or_b32 v49, v49, 4, v53
    v_and_b32 v53, 0x30, v112
    v_lshl_or_b32 v53, v49, 6, v53
    v_lshlrev_b32 v53, 15, v53
    s_nop 1
    v_add_u32_dpp v48, v48, v48 row_shr:1 row_mask:0xf bank_mask:0xf bound_ctrl:0
    s_nop 1
    v_add_u32_dpp v48, v48, v48 row_shr:2 row_mask:0xf bank_mask:0xf bound_ctrl:0
    s_nop 1
    v_add_u32_dpp v48, v48, v48 row_shr:4 row_mask:0xf bank_mask:0xf bound_ctrl:0
    s_nop 1
    v_add_u32_dpp v48, v48, v48 row_shr:8 row_mask:0xf bank_mask:0xf bound_ctrl:0
    s_nop 1
    v_add_u32_dpp v48, v48, v48 row_bcast:15 row_mask:0xa bank_mask:0xf
    s_nop 1
    v_add_u32_dpp v48, v48, v48 row_bcast:31 row_mask:0xc bank_mask:0xf
    s_nop 1
    s_nop 0
    v_readlane_b32 s38, v48, 63
    v_sub_u32 v50, v48, v5
    v_sub_u32 v49, v50, v4
    v_writelane_b32 v5, 1, 63
    v_sub_u32 v10, 512, v49
    v_mad_u32_u16 v51, v110, 16, v53
    v_lshl_add_u32 v51, v10, 4, v51
    v_med3_i32 v10, v10, 0, v4
    v_lshl_add_u32 v49, v49, 2, s23
    v_sub_u32 v11, 512, v50
    v_mad_u32_u16 v52, v110, 16, v53 op_sel:[1,0,0,0]
    v_add_u32 v52, 262144, v52
    s_mov_b32 s44, 0x1fffc000
    v_writelane_b32 v52, s44, 63
    v_lshl_add_u32 v52, v11, 4, v52
    v_med3_i32 v11, v11, 0, v5
    v_lshl_add_u32 v50, v50, 2, s23
    v_lshl_add_u32 v48, v11, 16, v10
    v_add_u32 v110, v110, v48
    s_min_u32 s17, s38, 512
    s_add_u32 s17, s17, 63
    s_lshr_b32 s17, s17, 6
    v_cmpx_lt_i32 vcc, 0, v10
    ds_write_b32 v49, v51
    s_mov_b64 exec, -1
    v_cmpx_lt_i32 vcc, 0, v11
    ds_write_b32 v50, v52
    s_mov_b64 exec, -1
    s_cmp_lt_u32 s38, 512
    s_cbranch_scc1 p2_nomorea
    v_cmp_lt_u32_sdwa s[44:45], v110, v111 src0_sel:WORD_0 src1_sel:WORD_0
    v_cmp_lt_u32_sdwa s[46:47], v110, v111 src0_sel:WORD_1 src1_sel:WORD_1
    s_nop 0
    s_or_b64 s[44:45], s[44:45], s[46:47]
    s_cbranch_scc0 p2_nomorea
    v_mov_b32 v49, s19
    v_mov_b32 v50, 1
    ds_write_b32 v49, v50 offset:53760
p2_nomorea:
    s_mov_b32 m0, s23
    s_nop 0
    ds_read_addtid_b32 v2 offset:1024
    ds_read_addtid_b32 v8 offset:1280
    ds_read_addtid_b32 v14 offset:1536
    ds_read_addtid_b32 v20 offset:1792
    ds_read_addtid_b32 v88 offset:0
    ds_read_addtid_b32 v92 offset:256
    ds_read_addtid_b32 v96 offset:512
    ds_read_addtid_b32 v100 offset:768
    s_waitcnt lgkmcnt(0)
    s_nop 2
    s_nop 1
    v_max_u32_dpp v88, v88, v88 row_shr:1 row_mask:0xf bank_mask:0xf bound_ctrl:0
    v_max_u32_dpp v92, v92, v92 row_shr:1 row_mask:0xf bank_mask:0xf bound_ctrl:0
    v_max_u32_dpp v96, v96, v96 row_shr:1 row_mask:0xf bank_mask:0xf bound_ctrl:0
    v_max_u32_dpp v100, v100, v100 row_shr:1 row_mask:0xf bank_mask:0xf bound_ctrl:0
    v_max_u32_dpp v2, v2, v2 row_shr:1 row_mask:0xf bank_mask:0xf bound_ctrl:0
    v_max_u32_dpp v8, v8, v8 row_shr:1 row_mask:0xf bank_mask:0xf bound_ctrl:0
    v_max_u32_dpp v14, v14, v14 row_shr:1 row_mask:0xf bank_mask:0xf bound_ctrl:0
    v_max_u32_dpp v20, v20, v20 row_shr:1 row_mask:0xf bank_mask:0xf bound_ctrl:0
    v_max_u32_dpp v88, v88, v88 row_shr:2 row_mask:0xf bank_mask:0xf bound_ctrl:0
    v_max_u32_dpp v92, v92, v92 row_shr:2 row_mask:0xf bank_mask:0xf bound_ctrl:0
    v_max_u32_dpp v96, v96, v96 row_shr:2 row_mask:0xf bank_mask:0xf bound_ctrl:0
    v_max_u32_dpp v100, v100, v100 row_shr:2 row_mask:0xf bank_mask:0xf bound_ctrl:0
    v_max_u32_dpp v2, v2, v2 row_shr:2 row_mask:0xf bank_mask:0xf bound_ctrl:0
    v_max_u32_dpp v8, v8, v8 row_shr:2 row_mask:0xf bank_mask:0xf bound_ctrl:0
    v_max_u32_dpp v14, v14, v14 row_shr:2 row_mask:0xf bank_mask:0xf bound_ctrl:0
    v_max_u32_dpp v20, v20, v20 row_shr:2 row_mask:0xf bank_mask:0xf bound_ctrl:0
    v_max_u32_dpp v88, v88, v88 row_shr:4 row_mask:0xf bank_mask:0xf bound_ctrl:0
    v_max_u32_dpp v92, v92, v92 row_shr:4 row_mask:0xf bank_mask:0xf bound_ctrl:0
    v_max_u32_dpp v96, v96, v96 row_shr:4 row_mask:0xf bank_mask:0xf bound_ctrl:0
    v_max_u32_dpp v100, v100, v100 row_shr:4 row_mask:0xf bank_mask:0xf bound_ctrl:0
    v_max_u32_dpp v2, v2, v2 row_shr:4 row_mask:0xf bank_mask:0xf bound_ctrl:0
    v_max_u32_dpp v8, v8, v8 row_shr:4 row_mask:0xf bank_mask:0xf bound_ctrl:0
    v_max_u32_dpp v14, v14, v14 row_shr:4 row_mask:0xf bank_mask:0xf bound_ctrl:0
    v_max_u32_dpp v20, v20, v20 row_shr:4 row_mask:0xf bank_mask:0xf bound_ctrl:0
    v_max_u32_dpp v88, v88, v88 row_shr:8 row_mask:0xf bank_mask:0xf bound_ctrl:0
    v_max_u32_dpp v92, v92, v92 row_shr:8 row_mask:0xf bank_mask:0xf bound_ctrl:0
    v_max_u32_dpp v96, v96, v96 row_shr:8 row_mask:0xf bank_mask:0xf bound_ctrl:0
    v_max_u32_dpp v100, v100, v100 row_shr:8 row_mask:0xf bank_mask:0xf bound_ctrl:0
    v_max_u32_dpp v2, v2, v2 row_shr:8 row_mask:0xf bank_mask:0xf bound_ctrl:0
    v_max_u32_dpp v8, v8, v8 row_shr:8 row_mask:0xf bank_mask:0xf bound_ctrl:0
    v_max_u32_dpp v14, v14, v14 row_shr:8 row_mask:0xf bank_mask:0xf bound_ctrl:0
    v_max_u32_dpp v20, v20, v20 row_shr:8 row_mask:0xf bank_mask:0xf bound_ctrl:0
    v_max_u32_dpp v88, v88, v88 row_bcast:15 row_mask:0xa bank_mask:0xf
    v_max_u32_dpp v92, v92, v92 row_bcast:15 row_mask:0xa bank_mask:0xf
    v_max_u32_dpp v96, v96, v96 row_bcast:15 row_mask:0xa bank_mask:0xf
    v_max_u32_dpp v100, v100, v100 row_bcast:15 row_mask:0xa bank_mask:0xf
    v_max_u32_dpp v2, v2, v2 row_bcast:15 row_mask:0xa bank_mask:0xf
    v_max_u32_dpp v8, v8, v8 row_bcast:15 row_mask:0xa bank_mask:0xf
    v_max_u32_dpp v14, v14, v14 row_bcast:15 row_mask:0xa bank_mask:0xf
    v_max_u32_dpp v20, v20, v20 row_bcast:15 row_mask:0xa bank_mask:0xf
    v_max_u32_dpp v88, v88, v88 row_bcast:31 row_mask:0xc bank_mask:0xf
    v_max_u32_dpp v92, v92, v92 row_bcast:31 row_mask:0xc bank_mask:0xf
    v_max_u32_dpp v96, v96, v96 row_bcast:31 row_mask:0xc bank_mask:0xf
    v_max_u32_dpp v100, v100, v100 row_bcast:31 row_mask:0xc bank_mask:0xf
    v_max_u32_dpp v2, v2, v2 row_bcast:31 row_mask:0xc bank_mask:0xf
    v_max_u32_dpp v8, v8, v8 row_bcast:31 row_mask:0xc bank_mask:0xf
    v_max_u32_dpp v14, v14, v14 row_bcast:31 row_mask:0xc bank_mask:0xf
    v_max_u32_dpp v20, v20, v20 row_bcast:31 row_mask:0xc bank_mask:0xf
    s_nop 0
    v_readlane_b32 s41, v88, 63
    v_add_u32 v88, v88, v112
    v_add_u32 v88, 4294959104, v88
    v_max_u32 v92, s41, v92
    s_nop 0
    v_readlane_b32 s41, v92, 63
    v_add_u32 v92, v92, v112
    v_add_u32 v92, 4294960128, v92
    v_max_u32 v96, s41, v96
    s_nop 0
    v_readlane_b32 s41, v96, 63
    v_add_u32 v96, v96, v112
    v_add_u32 v96, 4294961152, v96
    v_max_u32 v100, s41, v100
    s_nop 0
    v_readlane_b32 s41, v100, 63
    v_add_u32 v100, v100, v112
    v_add_u32 v100, 4294962176, v100
    v_max_u32 v2, s41, v2
    s_nop 0
    v_readlane_b32 s41, v2, 63
    v_add_u32 v2, v2, v112
    v_add_u32 v2, 4294963200, v2
    v_max_u32 v8, s41, v8
    s_nop 0
    v_readlane_b32 s41, v8, 63
    v_add_u32 v8, v8, v112
    v_add_u32 v8, 4294964224, v8
    v_max_u32 v14, s41, v14
    s_nop 0
    v_readlane_b32 s41, v14, 63
    v_add_u32 v14, v14, v112
    v_add_u32 v14, 4294965248, v14
    v_max_u32 v20, s41, v20
    s_nop 0
    v_readlane_b32 s41, v20, 63
    v_add_u32 v20, v20, v112
    v_add_u32 v20, 4294966272, v20
    v_bfe_u32 v0, v2, 14, 4
    v_lshrrev_b32 v1, 18, v2
    v_and_b32 v2, 0x3fff, v2
    v_mad_u32_u24 v0, v0, s63, v1
    v_mad_u32_u24 v2, v0, s65, v2
    buffer_load_dwordx4 v[0:3], v2, s[68:71], 0 offen
    v_bfe_u32 v6, v8, 14, 4
    v_lshrrev_b32 v7, 18, v8
    v_and_b32 v8, 0x3fff, v8
    v_mad_u32_u24 v6, v6, s63, v7
    v_mad_u32_u24 v8, v6, s65, v8
    buffer_load_dwordx4 v[6:9], v8, s[68:71], 0 offen
    s_cmp_eq_u32 s21, 0
    s_cselect_b32 s44, 1073758208, 0
    v_mov_b32 v124, s44
    v_mov_b32 v125, s44
    v_mov_b32 v126, s44
    v_mov_b32 v127, s44
    v_add_u32 v123, s64, v112
    v_add_u32 v122, s25, v123
    ds_write_b128 v122, v[124:127] offset:0
    ds_write_b128 v122, v[124:127] offset:16384
    ds_write_b128 v122, v[124:127] offset:32768
    v_add_u32 v122, 49152, v122
    ds_write_b128 v122, v[124:127] offset:0
    ds_write_b128 v122, v[124:127] offset:16384
    ds_write_b128 v122, v[124:127] offset:32768
    v_cmpx_gt_u32 vcc, 1792, v123
    ds_write_b128 v122, v[124:127] offset:49152
    s_mov_b64 exec, -1
    v_bfe_u32 v12, v14, 14, 4
    v_lshrrev_b32 v13, 18, v14
    v_and_b32 v14, 0x3fff, v14
    v_mad_u32_u24 v12, v12, s63, v13
    v_mad_u32_u24 v14, v12, s65, v14
    buffer_load_dwordx4 v[12:15], v14, s[68:71], 0 offen
    s_mov_b32 s16, s17
    s_waitcnt vmcnt(6)
    s_cmp_lg_u32 s21, 0
    s_cbranch_scc1 p2_nostat1
    v_max_u32 v60, v60, v62
    v_add_f32 v61, v61, v63
    s_nop 1
    v_max_u32_dpp v60, v60, v60 row_shr:1 row_mask:0xf bank_mask:0xf bound_ctrl:0
    v_add_f32_dpp v61, v61, v61 row_shr:1 row_mask:0xf bank_mask:0xf bound_ctrl:0
    s_nop 0
    v_max_u32_dpp v60, v60, v60 row_shr:2 row_mask:0xf bank_mask:0xf bound_ctrl:0
    v_add_f32_dpp v61, v61, v61 row_shr:2 row_mask:0xf bank_mask:0xf bound_ctrl:0
    s_nop 0
    v_max_u32_dpp v60, v60, v60 row_shr:4 row_mask:0xf bank_mask:0xf bound_ctrl:0
    v_add_f32_dpp v61, v61, v61 row_shr:4 row_mask:0xf bank_mask:0xf bound_ctrl:0
    s_nop 0
    v_max_u32_dpp v60, v60, v60 row_shr:8 row_mask:0xf bank_mask:0xf bound_ctrl:0
    v_add_f32_dpp v61, v61, v61 row_shr:8 row_mask:0xf bank_mask:0xf bound_ctrl:0
    s_nop 0
    v_max_u32_dpp v60, v60, v60 row_bcast:15 row_mask:0xa bank_mask:0xf
    v_add_f32_dpp v61, v61, v61 row_bcast:15 row_mask:0xa bank_mask:0xf
    s_nop 0
    v_max_u32_dpp v60, v60, v60 row_bcast:31 row_mask:0xc bank_mask:0xf
    v_add_f32_dpp v61, v61, v61 row_bcast:31 row_mask:0xc bank_mask:0xf
    s_nop 0
    s_nop 0
    s_lshl_b32 s44, s10, 3
    v_mov_b32 v62, s44
    s_mov_b64 exec, 1
    s_lshl_b64 exec, exec, 63
    ds_write_b64 v62, v[60:61] offset:53824
    s_mov_b64 exec, -1
p2_nostat1:
    s_waitcnt lgkmcnt(0)
    s_barrier
    v_bfe_u32 v18, v20, 14, 4
    v_lshrrev_b32 v19, 18, v20
    v_and_b32 v20, 0x3fff, v20
    v_mad_u32_u24 v18, v18, s63, v19
    v_mad_u32_u24 v20, v18, s65, v20
    buffer_load_dwordx4 v[18:21], v20, s[68:71], 0 offen
    v_mov_b32 v122, s19
    s_xor_b32 s19, s19, 4
    ds_read_b32 v125, v122 offset:53760
    s_cmp_lg_u32 s21, 0
    s_cbranch_scc1 p2_nostat2
    v_bfe_u32 v62, v112, 1, 7
    ds_read_b64 v[60:61], v62 offset:53824
    s_waitcnt lgkmcnt(0)
    s_nop 1
    v_max_u32_dpp v60, v60, v60 row_shr:1 row_mask:0xf bank_mask:0xf bound_ctrl:0
    v_add_f32_dpp v61, v61, v61 row_shr:1 row_mask:0xf bank_mask:0xf bound_ctrl:0
    s_nop 0
    v_max_u32_dpp v60, v60, v60 row_shr:2 row_mask:0xf bank_mask:0xf bound_ctrl:0
    v_add_f32_dpp v61, v61, v61 row_shr:2 row_mask:0xf bank_mask:0xf bound_ctrl:0
    s_nop 0
    v_max_u32_dpp v60, v60, v60 row_shr:4 row_mask:0xf bank_mask:0xf bound_ctrl:0
    v_add_f32_dpp v61, v61, v61 row_shr:4 row_mask:0xf bank_mask:0xf bound_ctrl:0
    s_nop 0
    v_max_u32_dpp v60, v60, v60 row_shr:8 row_mask:0xf bank_mask:0xf bound_ctrl:0
    v_add_f32_dpp v61, v61, v61 row_shr:8 row_mask:0xf bank_mask:0xf bound_ctrl:0
    s_nop 0
    v_max_u32_dpp v60, v60, v60 row_bcast:15 row_mask:0xa bank_mask:0xf
    v_add_f32_dpp v61, v61, v61 row_bcast:15 row_mask:0xa bank_mask:0xf
    s_nop 0
    v_max_u32_dpp v60, v60, v60 row_bcast:31 row_mask:0xc bank_mask:0xf
    v_add_f32_dpp v61, v61, v61 row_bcast:31 row_mask:0xc bank_mask:0xf
    s_nop 0
    s_nop 0
    v_readlane_b32 s44, v60, 15
    v_readlane_b32 s45, v61, 15
    s_nop 1
    s_lshl_b32 s44, s44, 16
    s_lshr_b32 s46, s44, 23
    s_sub_u32 s47, s46, 80
    s_cmp_lt_u32 s47, 100
    s_cselect_b32 s21, 0, 1
    v_mov_b32 v60, s45
    v_mul_f32 v60, 0x34a7c5ac, v60
    v_sqrt_f32 v60, v60
    v_mov_b32 v61, s44
    v_mul_f32 v62, 0x41800000, v60
    v_cmp_nle_f32 vcc, v61, v62
    v_mul_f32 v60, 0x3ac00000, v60
    v_mul_f32 v61, 0x3901742e, v61
    v_max_f32 v60, v60, v61
    s_cmp_lg_u64 vcc, 0
    s_cselect_b32 s21, 1, s21
    v_readfirstlane_b32 s44, v60
    s_nop 0
    s_and_b32 s47, s44, 0x7fffff
    s_or_b32 s47, s47, 0x3f000000
    s_and_b32 s48, s44, 0x7f800000
    s_add_u32 s48, s48, 0x800000
    v_rcp_f32 v60, s47
    s_nop 0
    v_rcp_f32 v61, v60
    v_mul_f32 v60, 0x7b800000, v60
    v_mul_f32 v61, s48, v61
    s_nop 0
    v_readfirstlane_b32 s26, v60
    v_readfirstlane_b32 s30, v61
    s_add_u32 s34, s48, 197132288
    s_mov_b32 s35, s34
    s_sub_u32 s36, 0, s34
    s_subb_u32 s37, 0, s34
    s_cmp_eq_u32 s21, 0
    s_cbranch_scc1 p2_nostat2
    s_waitcnt vmcnt(0) lgkmcnt(0)
    s_branch p2_restart
p2_nostat2:
    s_cmp_eq_u32 s21, 0
    s_cselect_b32 s26, s26, 0x7b800000
    v_mov_b32 v114, s26
    s_waitcnt lgkmcnt(0)
    v_readfirstlane_b32 s44, v125
    s_nop 0
    s_cmp_lg_u32 s44, 0
    s_cbranch_scc1 p2_adva
    s_mov_b32 s61, 1
    v_mov_b32 v110, v68
    v_mov_b32 v111, v69
p2_adva:
    v_bfe_u32 v86, v88, 14, 4
    v_lshrrev_b32 v87, 18, v88
    v_and_b32 v88, 0x3fff, v88
    v_mad_u32_u24 v86, v86, s63, v87
    v_mad_u32_u24 v88, v86, s65, v88
    buffer_load_dwordx4 v[86:89], v88, s[68:71], 0 offen
    s_mov_b32 m0, s23
    v_mov_b32 v53, 0
    s_movk_i32 s44, 512
    v_sub_u32_sdwa v4, v111, v110 dst_sel:DWORD dst_unused:UNUSED_PAD src0_sel:WORD_0 src1_sel:WORD_0
    v_sub_u32_sdwa v5, v111, v110 dst_sel:DWORD dst_unused:UNUSED_PAD src0_sel:WORD_1 src1_sel:WORD_1
    v_med3_i32 v4, v4, 0, s44
    v_med3_i32 v5, v5, 0, s44
    v_add_u32 v48, v4, v5
    ds_write_addtid_b32 v53 offset:0
    ds_write_addtid_b32 v53 offset:256
    ds_write_addtid_b32 v53 offset:512
    ds_write_addtid_b32 v53 offset:768
    ds_write_addtid_b32 v53 offset:1024
    ds_write_addtid_b32 v53 offset:1280
    ds_write_addtid_b32 v53 offset:1536
    ds_write_addtid_b32 v53 offset:1792
    v_bfe_i32 v53, v112, 6, 1
    v_lshrrev_b32 v49, 6, v112
    v_bitop3_b32 v53, v53, 15, s10 bitop3:0x6a
    v_lshl_or_b32 v49, v49, 4, v53
    v_and_b32 v53, 0x30, v112
    v_lshl_or_b32 v53, v49, 6, v53
    v_lshlrev_b32 v53, 15, v53
    s_nop 1
    v_add_u32_dpp v48, v48, v48 row_shr:1 row_mask:0xf bank_mask:0xf bound_ctrl:0
    s_nop 1
    v_add_u32_dpp v48, v48, v48 row_shr:2 row_mask:0xf bank_mask:0xf bound_ctrl:0
    s_nop 1
    v_add_u32_dpp v48, v48, v48 row_shr:4 row_mask:0xf bank_mask:0xf bound_ctrl:0
    s_nop 1
    v_add_u32_dpp v48, v48, v48 row_shr:8 row_mask:0xf bank_mask:0xf bound_ctrl:0
    s_nop 1
    v_add_u32_dpp v48, v48, v48 row_bcast:15 row_mask:0xa bank_mask:0xf
    s_nop 1
    v_add_u32_dpp v48, v48, v48 row_bcast:31 row_mask:0xc bank_mask:0xf
    s_nop 1
    s_nop 0
    v_readlane_b32 s38, v48, 63
    v_sub_u32 v50, v48, v5
    v_sub_u32 v49, v50, v4
    v_writelane_b32 v5, 1, 63
    v_sub_u32 v10, 512, v49
    v_mad_u32_u16 v51, v110, 16, v53
    v_lshl_add_u32 v51, v10, 4, v51
    v_med3_i32 v10, v10, 0, v4
    v_lshl_add_u32 v49, v49, 2, s23
    v_sub_u32 v11, 512, v50
    v_mad_u32_u16 v52, v110, 16, v53 op_sel:[1,0,0,0]
    v_add_u32 v52, 262144, v52
    s_mov_b32 s44, 0x1fffc000
    v_writelane_b32 v52, s44, 63
    v_lshl_add_u32 v52, v11, 4, v52
    v_med3_i32 v11, v11, 0, v5
    v_lshl_add_u32 v50, v50, 2, s23
    v_lshl_add_u32 v48, v11, 16, v10
    v_add_u32 v110, v110, v48
    s_min_u32 s17, s38, 512
    s_add_u32 s17, s17, 63
    s_lshr_b32 s17, s17, 6
    v_cmpx_lt_i32 vcc, 0, v10
    ds_write_b32 v49, v51
    s_mov_b64 exec, -1
    v_cmpx_lt_i32 vcc, 0, v11
    ds_write_b32 v50, v52
    s_mov_b64 exec, -1
    s_cmp_lt_u32 s38, 512
    s_cbranch_scc1 p2_nomoreb
    v_cmp_lt_u32_sdwa s[44:45], v110, v111 src0_sel:WORD_0 src1_sel:WORD_0
    v_cmp_lt_u32_sdwa s[46:47], v110, v111 src0_sel:WORD_1 src1_sel:WORD_1
    s_nop 0
    s_or_b64 s[44:45], s[44:45], s[46:47]
    s_cbranch_scc0 p2_nomoreb
    v_mov_b32 v49, s19
    v_mov_b32 v50, 1
    ds_write_b32 v49, v50 offset:53760
p2_nomoreb:
    s_mov_b32 m0, s23
    s_nop 0
    ds_read_addtid_b32 v102 offset:1024
    ds_read_addtid_b32 v103 offset:1280
    ds_read_addtid_b32 v104 offset:1536
    ds_read_addtid_b32 v105 offset:1792
    ds_read_addtid_b32 v106 offset:0
    ds_read_addtid_b32 v107 offset:256
    ds_read_addtid_b32 v108 offset:512
    ds_read_addtid_b32 v109 offset:768
    v_bfe_u32 v90, v92, 14, 4
    v_lshrrev_b32 v91, 18, v92
    v_and_b32 v92, 0x3fff, v92
    v_mad_u32_u24 v90, v90, s63, v91
    v_mad_u32_u24 v92, v90, s65, v92
    buffer_load_dwordx4 v[90:93], v92, s[68:71], 0 offen
    s_waitcnt vmcnt(6)
    s_mov_b32 m0, s24
    s_cmp_ge_u32 s10, 9
    s_cbranch_scc1 p2_stp
    ds_write_addtid_b32 v84 offset:49152
    ds_write_addtid_b32 v85 offset:49408
p2_stp:
    s_mov_b32 m0, s23
    s_add_u32 s20, s20, 53760
    ds_write_addtid_b32 v72 offset:0
    ds_write_addtid_b32 v73 offset:256
    ds_write_addtid_b32 v74 offset:512
    ds_write_addtid_b32 v75 offset:768
    ds_write_addtid_b32 v76 offset:1024
    ds_write_addtid_b32 v77 offset:1280
    ds_write_addtid_b32 v78 offset:1536
    ds_write_addtid_b32 v79 offset:1792
    ds_write_addtid_b32 v80 offset:2048
    ds_write_addtid_b32 v81 offset:2304
    ds_write_addtid_b32 v82 offset:2560
    ds_write_addtid_b32 v83 offset:2816
    s_waitcnt lgkmcnt(0)
    s_barrier
    v_bfe_u32 v94, v96, 14, 4
    v_lshrrev_b32 v95, 18, v96
    v_and_b32 v96, 0x3fff, v96
    v_mad_u32_u24 v94, v94, s63, v95
    v_mad_u32_u24 v96, v94, s65, v96
    buffer_load_dwordx4 v[94:97], v96, s[68:71], 0 offen
    v_bfe_u32 v98, v100, 14, 4
    v_lshrrev_b32 v99, 18, v100
    v_and_b32 v100, 0x3fff, v100
    v_mad_u32_u24 v98, v98, s63, v99
    v_mad_u32_u24 v100, v98, s65, v100
    buffer_load_dwordx4 v[98:101], v100, s[68:71], 0 offen
    s_nop 2
    s_nop 1
    v_max_u32_dpp v106, v106, v106 row_shr:1 row_mask:0xf bank_mask:0xf bound_ctrl:0
    v_max_u32_dpp v107, v107, v107 row_shr:1 row_mask:0xf bank_mask:0xf bound_ctrl:0
    v_max_u32_dpp v108, v108, v108 row_shr:1 row_mask:0xf bank_mask:0xf bound_ctrl:0
    v_max_u32_dpp v109, v109, v109 row_shr:1 row_mask:0xf bank_mask:0xf bound_ctrl:0
    v_max_u32_dpp v106, v106, v106 row_shr:2 row_mask:0xf bank_mask:0xf bound_ctrl:0
    v_max_u32_dpp v107, v107, v107 row_shr:2 row_mask:0xf bank_mask:0xf bound_ctrl:0
    v_max_u32_dpp v108, v108, v108 row_shr:2 row_mask:0xf bank_mask:0xf bound_ctrl:0
    v_max_u32_dpp v109, v109, v109 row_shr:2 row_mask:0xf bank_mask:0xf bound_ctrl:0
    v_max_u32_dpp v106, v106, v106 row_shr:4 row_mask:0xf bank_mask:0xf bound_ctrl:0
    v_max_u32_dpp v107, v107, v107 row_shr:4 row_mask:0xf bank_mask:0xf bound_ctrl:0
    v_max_u32_dpp v108, v108, v108 row_shr:4 row_mask:0xf bank_mask:0xf bound_ctrl:0
    v_max_u32_dpp v109, v109, v109 row_shr:4 row_mask:0xf bank_mask:0xf bound_ctrl:0
    v_max_u32_dpp v106, v106, v106 row_shr:8 row_mask:0xf bank_mask:0xf bound_ctrl:0
    v_max_u32_dpp v107, v107, v107 row_shr:8 row_mask:0xf bank_mask:0xf bound_ctrl:0
    v_max_u32_dpp v108, v108, v108 row_shr:8 row_mask:0xf bank_mask:0xf bound_ctrl:0
    v_max_u32_dpp v109, v109, v109 row_shr:8 row_mask:0xf bank_mask:0xf bound_ctrl:0
    v_max_u32_dpp v106, v106, v106 row_bcast:15 row_mask:0xa bank_mask:0xf
    v_max_u32_dpp v107, v107, v107 row_bcast:15 row_mask:0xa bank_mask:0xf
    v_max_u32_dpp v108, v108, v108 row_bcast:15 row_mask:0xa bank_mask:0xf
    v_max_u32_dpp v109, v109, v109 row_bcast:15 row_mask:0xa bank_mask:0xf
    v_max_u32_dpp v106, v106, v106 row_bcast:31 row_mask:0xc bank_mask:0xf
    v_max_u32_dpp v107, v107, v107 row_bcast:31 row_mask:0xc bank_mask:0xf
    v_max_u32_dpp v108, v108, v108 row_bcast:31 row_mask:0xc bank_mask:0xf
    v_max_u32_dpp v109, v109, v109 row_bcast:31 row_mask:0xc bank_mask:0xf
    s_nop 0
    v_readlane_b32 s41, v106, 63
    v_add_u32 v106, v106, v112
    v_add_u32 v106, 4294959104, v106
    v_max_u32 v107, s41, v107
    s_nop 0
    v_readlane_b32 s41, v107, 63
    v_add_u32 v107, v107, v112
    v_add_u32 v107, 4294960128, v107
    v_max_u32 v108, s41, v108
    s_nop 0
    v_readlane_b32 s41, v108, 63
    v_add_u32 v108, v108, v112
    v_add_u32 v108, 4294961152, v108
    v_max_u32 v109, s41, v109
    s_nop 0
    v_readlane_b32 s41, v109, 63
    v_add_u32 v109, v109, v112
    v_add_u32 v109, 4294962176, v109
    s_waitcnt vmcnt(7)
    v_perm_b32 v48, v3, v0, s31
    v_perm_b32 v49, v3, v1, s32
    v_perm_b32 v50, v3, v2, s33
    v_lshlrev_b16 v4, 3, v2
    v_lshlrev_b16 v2, 3, v1
    v_lshlrev_b16 v0, 3, v0
    v_cmpx_ge_u16 vcc, 0x3fff, v48
    ds_read_b64 v[0:1], v0
    s_mov_b64 exec, -1
    v_cmpx_ge_u16 vcc, 0x3fff, v49
    ds_read_b64 v[2:3], v2
    s_mov_b64 exec, -1
    v_cmpx_ge_u16 vcc, 0x3fff, v50
    ds_read_b64 v[4:5], v4
    s_mov_b64 exec, -1
    s_waitcnt vmcnt(6)
    v_perm_b32 v51, v9, v6, s31
    v_perm_b32 v52, v9, v7, s32
    v_perm_b32 v53, v9, v8, s33
    v_lshlrev_b16 v10, 3, v8
    v_lshlrev_b16 v8, 3, v7
    v_lshlrev_b16 v6, 3, v6
    v_cmpx_ge_u16 vcc, 0x3fff, v51
    ds_read_b64 v[6:7], v6
    s_mov_b64 exec, -1
    v_cmpx_ge_u16 vcc, 0x3fff, v52
    ds_read_b64 v[8:9], v8
    s_mov_b64 exec, -1
    v_cmpx_ge_u16 vcc, 0x3fff, v53
    ds_read_b64 v[10:11], v10
    s_mov_b64 exec, -1
    s_waitcnt vmcnt(5)
    v_perm_b32 v54, v15, v12, s31
    v_perm_b32 v55, v15, v13, s32
    v_perm_b32 v56, v15, v14, s33
    v_lshlrev_b16 v16, 3, v14
    v_lshlrev_b16 v14, 3, v13
    v_lshlrev_b16 v12, 3, v12
    v_cmpx_ge_u16 vcc, 0x3fff, v54
    ds_read_b64 v[12:13], v12
    s_mov_b64 exec, -1
    v_cmpx_ge_u16 vcc, 0x3fff, v55
    ds_read_b64 v[14:15], v14
    s_mov_b64 exec, -1
    v_cmpx_ge_u16 vcc, 0x3fff, v56
    ds_read_b64 v[16:17], v16
    s_mov_b64 exec, -1
    s_waitcnt vmcnt(4)
    v_perm_b32 v57, v21, v18, s31
    v_perm_b32 v58, v21, v19, s32
    v_perm_b32 v59, v21, v20, s33
    v_lshlrev_b16 v22, 3, v20
    v_lshlrev_b16 v20, 3, v19
    v_lshlrev_b16 v18, 3, v18
    s_cmp_lt_u32 s16, 8
    s_cbranch_scc1 p2_gp
    v_cmpx_ge_u16 vcc, 0x3fff, v57
    ds_read_b64 v[18:19], v18
    s_mov_b64 exec, -1
    v_cmpx_ge_u16 vcc, 0x3fff, v58
    ds_read_b64 v[20:21], v20
    s_mov_b64 exec, -1
    v_cmpx_ge_u16 vcc, 0x3fff, v59
    ds_read_b64 v[22:23], v22
    s_mov_b64 exec, -1
p2_gp:
    s_waitcnt vmcnt(3)
    v_perm_b32 v60, v89, v86, s31
    v_perm_b32 v61, v89, v87, s32
    v_perm_b32 v62, v89, v88, s33
    v_lshlrev_b16 v28, 3, v88
    v_lshlrev_b16 v26, 3, v87
    v_lshlrev_b16 v24, 3, v86
    v_cmpx_ge_u16 vcc, 0x3fff, v60
    ds_read_b64 v[24:25], v24
    s_mov_b64 exec, -1
    v_cmpx_ge_u16 vcc, 0x3fff, v61
    ds_read_b64 v[26:27], v26
    s_mov_b64 exec, -1
    v_cmpx_ge_u16 vcc, 0x3fff, v62
    ds_read_b64 v[28:29], v28
    s_mov_b64 exec, -1
    v_bfe_u32 v86, v106, 14, 4
    v_lshrrev_b32 v87, 18, v106
    v_and_b32 v106, 0x3fff, v106
    v_mad_u32_u24 v86, v86, s63, v87
    v_mad_u32_u24 v106, v86, s65, v106
    buffer_load_dwordx4 v[86:89], v106, s[68:71], 0 offen
    s_cmp_ge_u32 s10, 9
    s_cbranch_scc1 p2_nmq
    v_lshrrev_b32 v84, 1, v112
    s_add_u32 s44, s20, s42
    buffer_load_dwordx2 v[84:85], v84, s[4:7], s44 offen
p2_nmq:
    buffer_load_dwordx4 v[72:75], v112, s[4:7], s20 offen offset:0
    buffer_load_dwordx4 v[76:79], v112, s[4:7], s20 offen offset:1024
    buffer_load_dwordx4 v[80:83], v112, s[4:7], s20 offen offset:2048
    s_waitcnt vmcnt(6)
    v_perm_b32 v63, v93, v90, s31
    v_perm_b32 v64, v93, v91, s32
    v_perm_b32 v65, v93, v92, s33
    v_lshlrev_b16 v34, 3, v92
    v_lshlrev_b16 v32, 3, v91
    v_lshlrev_b16 v30, 3, v90
    v_cmpx_ge_u16 vcc, 0x3fff, v63
    ds_read_b64 v[30:31], v30
    s_mov_b64 exec, -1
    v_cmpx_ge_u16 vcc, 0x3fff, v64
    ds_read_b64 v[32:33], v32
    s_mov_b64 exec, -1
    v_cmpx_ge_u16 vcc, 0x3fff, v65
    ds_read_b64 v[34:35], v34
    s_mov_b64 exec, -1
    v_bfe_u32 v90, v107, 14, 4
    v_lshrrev_b32 v91, 18, v107
    v_and_b32 v107, 0x3fff, v107
    v_mad_u32_u24 v90, v90, s63, v91
    v_mad_u32_u24 v107, v90, s65, v107
    buffer_load_dwordx4 v[90:93], v107, s[68:71], 0 offen
    s_waitcnt vmcnt(6)
    v_perm_b32 v66, v97, v94, s31
    v_perm_b32 v67, v97, v95, s32
    v_perm_b32 v68, v97, v96, s33
    v_lshlrev_b16 v40, 3, v96
    v_lshlrev_b16 v38, 3, v95
    v_lshlrev_b16 v36, 3, v94
    v_cmpx_ge_u16 vcc, 0x3fff, v66
    ds_read_b64 v[36:37], v36
    s_mov_b64 exec, -1
    v_cmpx_ge_u16 vcc, 0x3fff, v67
    ds_read_b64 v[38:39], v38
    s_mov_b64 exec, -1
    v_cmpx_ge_u16 vcc, 0x3fff, v68
    ds_read_b64 v[40:41], v40
    s_mov_b64 exec, -1
    v_bfe_u32 v94, v108, 14, 4
    v_lshrrev_b32 v95, 18, v108
    v_and_b32 v108, 0x3fff, v108
    v_mad_u32_u24 v94, v94, s63, v95
    v_mad_u32_u24 v108, v94, s65, v108
    buffer_load_dwordx4 v[94:97], v108, s[68:71], 0 offen
    s_waitcnt vmcnt(6)
    v_perm_b32 v69, v101, v98, s31
    v_perm_b32 v70, v101, v99, s32
    v_perm_b32 v71, v101, v100, s33
    v_lshlrev_b16 v46, 3, v100
    v_lshlrev_b16 v44, 3, v99
    v_lshlrev_b16 v42, 3, v98
    v_cmpx_ge_u16 vcc, 0x3fff, v69
    ds_read_b64 v[42:43], v42
    s_mov_b64 exec, -1
    v_cmpx_ge_u16 vcc, 0x3fff, v70
    ds_read_b64 v[44:45], v44
    s_mov_b64 exec, -1
    v_cmpx_ge_u16 vcc, 0x3fff, v71
    ds_read_b64 v[46:47], v46
    s_mov_b64 exec, -1
    s_waitcnt lgkmcnt(0)
    s_barrier
    s_branch p2_tail
p2_top:
    s_cmp_lg_u32 s21, 0
    s_cbranch_scc1 p2_topf
    s_cmp_eq_u32 s60, 10
    s_cbranch_scc1 p2_drain0
    s_setprio 3
    v_cmpx_gt_i16 vcc, 0, v48
    ds_read_b64 v[0:1], v0
    s_mov_b64 exec, -1
    v_cmpx_gt_i16 vcc, 0, v49
    ds_read_b64 v[2:3], v2
    s_mov_b64 exec, -1
    v_cmpx_gt_i16 vcc, 0, v50
    ds_read_b64 v[4:5], v4
    s_mov_b64 exec, -1
    v_cmpx_gt_i16 vcc, 0, v51
    ds_read_b64 v[6:7], v6
    s_mov_b64 exec, -1
    v_cmpx_gt_i16 vcc, 0, v52
    ds_read_b64 v[8:9], v8
    s_mov_b64 exec, -1
    v_cmpx_gt_i16 vcc, 0, v53
    ds_read_b64 v[10:11], v10
    s_mov_b64 exec, -1
    v_cmpx_gt_i16 vcc, 0, v54
    ds_read_b64 v[12:13], v12
    s_mov_b64 exec, -1
    v_cmpx_gt_i16 vcc, 0, v55
    ds_read_b64 v[14:15], v14
    s_mov_b64 exec, -1
    v_cmpx_gt_i16 vcc, 0, v56
    ds_read_b64 v[16:17], v16
    s_mov_b64 exec, -1
    s_cmp_lt_u32 s15, 8
    s_cbranch_scc1 p2_g0r23
    v_cmpx_gt_i16 vcc, 0, v57
    ds_read_b64 v[18:19], v18
    s_mov_b64 exec, -1
    v_cmpx_gt_i16 vcc, 0, v58
    ds_read_b64 v[20:21], v20
    s_mov_b64 exec, -1
    v_cmpx_gt_i16 vcc, 0, v59
    ds_read_b64 v[22:23], v22
    s_mov_b64 exec, -1
p2_g0r23:
    s_cmp_ge_u32 s10, 9
    s_cbranch_scc1 p2_nm0m0a
    v_lshrrev_b32 v84, 1, v112
    s_add_u32 s44, s20, s42
    buffer_load_dwordx2 v[84:85], v84, s[4:7], s44 offen
p2_nm0m0a:
    buffer_load_dwordx4 v[72:75], v112, s[4:7], s20 offen offset:0
    buffer_load_dwordx4 v[76:79], v112, s[4:7], s20 offen offset:1024
    buffer_load_dwordx4 v[80:83], v112, s[4:7], s20 offen offset:2048
    v_cmpx_gt_i16 vcc, 0, v60
    ds_read_b64 v[24:25], v24
    s_mov_b64 exec, -1
    v_cmpx_gt_i16 vcc, 0, v61
    ds_read_b64 v[26:27], v26
    s_mov_b64 exec, -1
    v_cmpx_gt_i16 vcc, 0, v62
    ds_read_b64 v[28:29], v28
    s_mov_b64 exec, -1
    v_cmpx_gt_i16 vcc, 0, v63
    ds_read_b64 v[30:31], v30
    s_mov_b64 exec, -1
    v_cmpx_gt_i16 vcc, 0, v64
    ds_read_b64 v[32:33], v32
    s_mov_b64 exec, -1
    v_cmpx_gt_i16 vcc, 0, v65
    ds_read_b64 v[34:35], v34
    s_mov_b64 exec, -1
    v_cmpx_gt_i16 vcc, 0, v66
    ds_read_b64 v[36:37], v36
    s_mov_b64 exec, -1
    v_cmpx_gt_i16 vcc, 0, v67
    ds_read_b64 v[38:39], v38
    s_mov_b64 exec, -1
    v_cmpx_gt_i16 vcc, 0, v68
    ds_read_b64 v[40:41], v40
    s_mov_b64 exec, -1
    v_cmpx_gt_i16 vcc, 0, v69
    ds_read_b64 v[42:43], v42
    s_mov_b64 exec, -1
    v_cmpx_gt_i16 vcc, 0, v70
    ds_read_b64 v[44:45], v44
    s_mov_b64 exec, -1
    v_cmpx_gt_i16 vcc, 0, v71
    ds_read_b64 v[46:47], v46
    s_mov_b64 exec, -1
    s_setprio 2
    s_waitcnt lgkmcnt(15)
    v_ashrrev_i32 v122, 5, v48
    v_lshlrev_b16 v123, 2, v48
    v_lshlrev_b32 v124, 16, v0
    v_bitop3_b32 v122, v122, v113, v113 bitop3:0x0c
    v_and_b32 v125, 0xffff0000, v0
    v_lshlrev_b32 v126, 16, v1
    v_mul_f32 v122, v114, v122
    v_and_b32 v127, 0xffff0000, v1
    v_add_u32 v123, v123, v123
    v_pk_fma_f32 v[124:125], v[124:125], v[122:123], s[34:35] op_sel_hi:[1,0,1]
    v_pk_fma_f32 v[126:127], v[126:127], v[122:123], s[34:35] op_sel_hi:[1,0,1]
    v_lshl_add_u32 v124, v125, 16, v124
    v_lshl_add_u32 v125, v127, 16, v126
    s_waitcnt lgkmcnt(15)
    v_bitop3_b32 v115, v115, v116, v117 bitop3:0xfe
    v_lshl_add_u64 v[124:125], v[124:125], 0, s[36:37]
    v_cmpx_le_u32 vcc, 0x1000000, v48
    ds_add_rtn_u64 v[116:117], v123, v[124:125] offset:54272
    s_mov_b64 exec, -1
    v_ashrrev_i32 v122, 5, v49
    v_lshlrev_b16 v123, 2, v49
    v_lshlrev_b32 v124, 16, v2
    v_bitop3_b32 v122, v122, v113, v113 bitop3:0x0c
    v_and_b32 v125, 0xffff0000, v2
    v_lshlrev_b32 v126, 16, v3
    v_mul_f32 v122, v114, v122
    v_and_b32 v127, 0xffff0000, v3
    v_add_u32 v123, v123, v123
    v_pk_fma_f32 v[124:125], v[124:125], v[122:123], s[34:35] op_sel_hi:[1,0,1]
    v_pk_fma_f32 v[126:127], v[126:127], v[122:123], s[34:35] op_sel_hi:[1,0,1]
    v_lshl_add_u32 v124, v125, 16, v124
    v_lshl_add_u32 v125, v127, 16, v126
    s_waitcnt lgkmcnt(15)
    v_bitop3_b32 v115, v115, v118, v119 bitop3:0xfe
    v_lshl_add_u64 v[124:125], v[124:125], 0, s[36:37]
    v_cmpx_le_u32 vcc, 0x1000000, v49
    ds_add_rtn_u64 v[118:119], v123, v[124:125] offset:54272
    s_mov_b64 exec, -1
    v_ashrrev_i32 v122, 5, v50
    v_lshlrev_b16 v123, 2, v50
    v_lshlrev_b32 v124, 16, v4
    v_bitop3_b32 v122, v122, v113, v113 bitop3:0x0c
    v_and_b32 v125, 0xffff0000, v4
    v_lshlrev_b32 v126, 16, v5
    v_mul_f32 v122, v114, v122
    v_and_b32 v127, 0xffff0000, v5
    v_add_u32 v123, v123, v123
    v_pk_fma_f32 v[124:125], v[124:125], v[122:123], s[34:35] op_sel_hi:[1,0,1]
    v_pk_fma_f32 v[126:127], v[126:127], v[122:123], s[34:35] op_sel_hi:[1,0,1]
    v_lshl_add_u32 v124, v125, 16, v124
    v_lshl_add_u32 v125, v127, 16, v126
    s_waitcnt lgkmcnt(15)
    v_bitop3_b32 v115, v115, v120, v121 bitop3:0xfe
    v_lshl_add_u64 v[124:125], v[124:125], 0, s[36:37]
    v_cmpx_le_u32 vcc, 0x1000000, v50
    ds_add_rtn_u64 v[120:121], v123, v[124:125] offset:54272
    s_mov_b64 exec, -1
    v_bfe_u32 v0, v102, 14, 4
    v_lshrrev_b32 v1, 18, v102
    v_and_b32 v102, 0x3fff, v102
    v_mad_u32_u24 v0, v0, s63, v1
    v_mad_u32_u24 v102, v0, s65, v102
    buffer_load_dwordx4 v[0:3], v102, s[68:71], 0 offen
    s_setprio 1
    s_waitcnt lgkmcnt(15)
    v_ashrrev_i32 v122, 5, v51
    v_lshlrev_b16 v123, 2, v51
    v_lshlrev_b32 v124, 16, v6
    v_bitop3_b32 v122, v122, v113, v113 bitop3:0x0c
    v_and_b32 v125, 0xffff0000, v6
    v_lshlrev_b32 v126, 16, v7
    v_mul_f32 v122, v114, v122
    v_and_b32 v127, 0xffff0000, v7
    v_add_u32 v123, v123, v123
    v_pk_fma_f32 v[124:125], v[124:125], v[122:123], s[34:35] op_sel_hi:[1,0,1]
    v_pk_fma_f32 v[126:127], v[126:127], v[122:123], s[34:35] op_sel_hi:[1,0,1]
    v_lshl_add_u32 v124, v125, 16, v124
    v_lshl_add_u32 v125, v127, 16, v126
    s_waitcnt lgkmcnt(2)
    v_bitop3_b32 v115, v115, v116, v117 bitop3:0xfe
    v_lshl_add_u64 v[124:125], v[124:125], 0, s[36:37]
    v_cmpx_le_u32 vcc, 0x1000000, v51
    ds_add_rtn_u64 v[116:117], v123, v[124:125] offset:54272
    s_mov_b64 exec, -1
    v_ashrrev_i32 v122, 5, v52
    v_lshlrev_b16 v123, 2, v52
    v_lshlrev_b32 v124, 16, v8
    v_bitop3_b32 v122, v122, v113, v113 bitop3:0x0c
    v_and_b32 v125, 0xffff0000, v8
    v_lshlrev_b32 v126, 16, v9
    v_mul_f32 v122, v114, v122
    v_and_b32 v127, 0xffff0000, v9
    v_add_u32 v123, v123, v123
    v_pk_fma_f32 v[124:125], v[124:125], v[122:123], s[34:35] op_sel_hi:[1,0,1]
    v_pk_fma_f32 v[126:127], v[126:127], v[122:123], s[34:35] op_sel_hi:[1,0,1]
    v_lshl_add_u32 v124, v125, 16, v124
    v_lshl_add_u32 v125, v127, 16, v126
    s_waitcnt lgkmcnt(2)
    v_bitop3_b32 v115, v115, v118, v119 bitop3:0xfe
    v_lshl_add_u64 v[124:125], v[124:125], 0, s[36:37]
    v_cmpx_le_u32 vcc, 0x1000000, v52
    ds_add_rtn_u64 v[118:119], v123, v[124:125] offset:54272
    s_mov_b64 exec, -1
    v_ashrrev_i32 v122, 5, v53
    v_lshlrev_b16 v123, 2, v53
    v_lshlrev_b32 v124, 16, v10
    v_bitop3_b32 v122, v122, v113, v113 bitop3:0x0c
    v_and_b32 v125, 0xffff0000, v10
    v_lshlrev_b32 v126, 16, v11
    v_mul_f32 v122, v114, v122
    v_and_b32 v127, 0xffff0000, v11
    v_add_u32 v123, v123, v123
    v_pk_fma_f32 v[124:125], v[124:125], v[122:123], s[34:35] op_sel_hi:[1,0,1]
    v_pk_fma_f32 v[126:127], v[126:127], v[122:123], s[34:35] op_sel_hi:[1,0,1]
    v_lshl_add_u32 v124, v125, 16, v124
    v_lshl_add_u32 v125, v127, 16, v126
    s_waitcnt lgkmcnt(2)
    v_bitop3_b32 v115, v115, v120, v121 bitop3:0xfe
    v_lshl_add_u64 v[124:125], v[124:125], 0, s[36:37]
    v_cmpx_le_u32 vcc, 0x1000000, v53
    ds_add_rtn_u64 v[120:121], v123, v[124:125] offset:54272
    s_mov_b64 exec, -1
    v_bfe_u32 v6, v103, 14, 4
    v_lshrrev_b32 v7, 18, v103
    v_and_b32 v103, 0x3fff, v103
    v_mad_u32_u24 v6, v6, s63, v7
    v_mad_u32_u24 v103, v6, s65, v103
    buffer_load_dwordx4 v[6:9], v103, s[68:71], 0 offen
    s_waitcnt lgkmcnt(6)
    s_barrier
    s_setprio 3
    s_waitcnt vmcnt(5)
    s_mov_b32 m0, s23
    v_mov_b32 v53, 0
    s_movk_i32 s44, 512
    v_sub_u32_sdwa v4, v111, v110 dst_sel:DWORD dst_unused:UNUSED_PAD src0_sel:WORD_0 src1_sel:WORD_0
    v_sub_u32_sdwa v5, v111, v110 dst_sel:DWORD dst_unused:UNUSED_PAD src0_sel:WORD_1 src1_sel:WORD_1
    v_med3_i32 v4, v4, 0, s44
    v_med3_i32 v5, v5, 0, s44
    v_add_u32 v48, v4, v5
    ds_write_addtid_b32 v53 offset:0
    ds_write_addtid_b32 v53 offset:256
    ds_write_addtid_b32 v53 offset:512
    ds_write_addtid_b32 v53 offset:768
    ds_write_addtid_b32 v53 offset:1024
    ds_write_addtid_b32 v53 offset:1280
    ds_write_addtid_b32 v53 offset:1536
    ds_write_addtid_b32 v53 offset:1792
    v_bfe_i32 v53, v112, 6, 1
    v_lshrrev_b32 v49, 6, v112
    v_bitop3_b32 v53, v53, 15, s10 bitop3:0x6a
    v_lshl_or_b32 v49, v49, 4, v53
    v_and_b32 v53, 0x30, v112
    v_lshl_or_b32 v53, v49, 6, v53
    v_lshlrev_b32 v53, 15, v53
    s_nop 1
    v_add_u32_dpp v48, v48, v48 row_shr:1 row_mask:0xf bank_mask:0xf bound_ctrl:0
    s_nop 1
    v_add_u32_dpp v48, v48, v48 row_shr:2 row_mask:0xf bank_mask:0xf bound_ctrl:0
    s_nop 1
    v_add_u32_dpp v48, v48, v48 row_shr:4 row_mask:0xf bank_mask:0xf bound_ctrl:0
    s_nop 1
    v_add_u32_dpp v48, v48, v48 row_shr:8 row_mask:0xf bank_mask:0xf bound_ctrl:0
    s_nop 1
    v_add_u32_dpp v48, v48, v48 row_bcast:15 row_mask:0xa bank_mask:0xf
    s_nop 1
    v_add_u32_dpp v48, v48, v48 row_bcast:31 row_mask:0xc bank_mask:0xf
    s_nop 1
    s_nop 0
    v_readlane_b32 s38, v48, 63
    v_sub_u32 v50, v48, v5
    v_sub_u32 v49, v50, v4
    v_writelane_b32 v5, 1, 63
    v_sub_u32 v10, 512, v49
    v_mad_u32_u16 v51, v110, 16, v53
    v_lshl_add_u32 v51, v10, 4, v51
    v_med3_i32 v10, v10, 0, v4
    v_lshl_add_u32 v49, v49, 2, s23
    v_sub_u32 v11, 512, v50
    v_mad_u32_u16 v52, v110, 16, v53 op_sel:[1,0,0,0]
    v_add_u32 v52, 262144, v52
    s_mov_b32 s44, 0x1fffc000
    v_writelane_b32 v52, s44, 63
    v_lshl_add_u32 v52, v11, 4, v52
    v_med3_i32 v11, v11, 0, v5
    v_lshl_add_u32 v50, v50, 2, s23
    v_lshl_add_u32 v48, v11, 16, v10
    v_add_u32 v110, v110, v48
    s_min_u32 s17, s38, 512
    s_add_u32 s17, s17, 63
    s_lshr_b32 s17, s17, 6
    v_cmpx_lt_i32 vcc, 0, v10
    ds_write_b32 v49, v51
    s_mov_b64 exec, -1
    v_cmpx_lt_i32 vcc, 0, v11
    ds_write_b32 v50, v52
    s_mov_b64 exec, -1
    s_cmp_lt_u32 s38, 512
    s_cbranch_scc1 p2_nomore0x
    v_cmp_lt_u32_sdwa s[44:45], v110, v111 src0_sel:WORD_0 src1_sel:WORD_0
    v_cmp_lt_u32_sdwa s[46:47], v110, v111 src0_sel:WORD_1 src1_sel:WORD_1
    s_nop 0
    s_or_b64 s[44:45], s[44:45], s[46:47]
    s_cbranch_scc0 p2_nomore0x
    v_mov_b32 v49, s19
    v_mov_b32 v50, 1
    ds_write_b32 v49, v50 offset:53760
p2_nomore0x:
    s_setprio 2
    s_waitcnt lgkmcnt(15)
    v_ashrrev_i32 v122, 5, v54
    v_lshlrev_b16 v123, 2, v54
    v_lshlrev_b32 v124, 16, v12
    v_bitop3_b32 v122, v122, v113, v113 bitop3:0x0c
    v_and_b32 v125, 0xffff0000, v12
    v_lshlrev_b32 v126, 16, v13
    v_mul_f32 v122, v114, v122
    v_and_b32 v127, 0xffff0000, v13
    v_add_u32 v123, v123, v123
    v_pk_fma_f32 v[124:125], v[124:125], v[122:123], s[34:35] op_sel_hi:[1,0,1]
    v_pk_fma_f32 v[126:127], v[126:127], v[122:123], s[34:35] op_sel_hi:[1,0,1]
    v_lshl_add_u32 v124, v125, 16, v124
    v_lshl_add_u32 v125, v127, 16, v126
    s_waitcnt lgkmcnt(12)
    v_bitop3_b32 v115, v115, v116, v117 bitop3:0xfe
    v_lshl_add_u64 v[124:125], v[124:125], 0, s[36:37]
    v_cmpx_le_u32 vcc, 0x1000000, v54
    ds_add_rtn_u64 v[116:117], v123, v[124:125] offset:54272
    s_mov_b64 exec, -1
    v_ashrrev_i32 v122, 5, v55
    v_lshlrev_b16 v123, 2, v55
    v_lshlrev_b32 v124, 16, v14
    v_bitop3_b32 v122, v122, v113, v113 bitop3:0x0c
    v_and_b32 v125, 0xffff0000, v14
    v_lshlrev_b32 v126, 16, v15
    v_mul_f32 v122, v114, v122
    v_and_b32 v127, 0xffff0000, v15
    v_add_u32 v123, v123, v123
    v_pk_fma_f32 v[124:125], v[124:125], v[122:123], s[34:35] op_sel_hi:[1,0,1]
    v_pk_fma_f32 v[126:127], v[126:127], v[122:123], s[34:35] op_sel_hi:[1,0,1]
    v_lshl_add_u32 v124, v125, 16, v124
    v_lshl_add_u32 v125, v127, 16, v126
    s_waitcnt lgkmcnt(12)
    v_bitop3_b32 v115, v115, v118, v119 bitop3:0xfe
    v_lshl_add_u64 v[124:125], v[124:125], 0, s[36:37]
    v_cmpx_le_u32 vcc, 0x1000000, v55
    ds_add_rtn_u64 v[118:119], v123, v[124:125] offset:54272
    s_mov_b64 exec, -1
    v_ashrrev_i32 v122, 5, v56
    v_lshlrev_b16 v123, 2, v56
    v_lshlrev_b32 v124, 16, v16
    v_bitop3_b32 v122, v122, v113, v113 bitop3:0x0c
    v_and_b32 v125, 0xffff0000, v16
    v_lshlrev_b32 v126, 16, v17
    v_mul_f32 v122, v114, v122
    v_and_b32 v127, 0xffff0000, v17
    v_add_u32 v123, v123, v123
    v_pk_fma_f32 v[124:125], v[124:125], v[122:123], s[34:35] op_sel_hi:[1,0,1]
    v_pk_fma_f32 v[126:127], v[126:127], v[122:123], s[34:35] op_sel_hi:[1,0,1]
    v_lshl_add_u32 v124, v125, 16, v124
    v_lshl_add_u32 v125, v127, 16, v126
    s_waitcnt lgkmcnt(12)
    v_bitop3_b32 v115, v115, v120, v121 bitop3:0xfe
    v_lshl_add_u64 v[124:125], v[124:125], 0, s[36:37]
    v_cmpx_le_u32 vcc, 0x1000000, v56
    ds_add_rtn_u64 v[120:121], v123, v[124:125] offset:54272
    s_mov_b64 exec, -1
    v_bfe_u32 v12, v104, 14, 4
    v_lshrrev_b32 v13, 18, v104
    v_and_b32 v104, 0x3fff, v104
    v_mad_u32_u24 v12, v12, s63, v13
    v_mad_u32_u24 v104, v12, s65, v104
    buffer_load_dwordx4 v[12:15], v104, s[68:71], 0 offen
    s_cmp_lt_u32 s15, 8
    s_cbranch_scc1 p2_na0a3
    s_waitcnt lgkmcnt(15)
    v_ashrrev_i32 v122, 5, v57
    v_lshlrev_b16 v123, 2, v57
    v_lshlrev_b32 v124, 16, v18
    v_bitop3_b32 v122, v122, v113, v113 bitop3:0x0c
    v_and_b32 v125, 0xffff0000, v18
    v_lshlrev_b32 v126, 16, v19
    v_mul_f32 v122, v114, v122
    v_and_b32 v127, 0xffff0000, v19
    v_add_u32 v123, v123, v123
    v_pk_fma_f32 v[124:125], v[124:125], v[122:123], s[34:35] op_sel_hi:[1,0,1]
    v_pk_fma_f32 v[126:127], v[126:127], v[122:123], s[34:35] op_sel_hi:[1,0,1]
    v_lshl_add_u32 v124, v125, 16, v124
    v_lshl_add_u32 v125, v127, 16, v126
    s_waitcnt lgkmcnt(2)
    v_bitop3_b32 v115, v115, v116, v117 bitop3:0xfe
    v_lshl_add_u64 v[124:125], v[124:125], 0, s[36:37]
    v_cmpx_le_u32 vcc, 0x1000000, v57
    ds_add_rtn_u64 v[116:117], v123, v[124:125] offset:54272
    s_mov_b64 exec, -1
    v_ashrrev_i32 v122, 5, v58
    v_lshlrev_b16 v123, 2, v58
    v_lshlrev_b32 v124, 16, v20
    v_bitop3_b32 v122, v122, v113, v113 bitop3:0x0c
    v_and_b32 v125, 0xffff0000, v20
    v_lshlrev_b32 v126, 16, v21
    v_mul_f32 v122, v114, v122
    v_and_b32 v127, 0xffff0000, v21
    v_add_u32 v123, v123, v123
    v_pk_fma_f32 v[124:125], v[124:125], v[122:123], s[34:35] op_sel_hi:[1,0,1]
    v_pk_fma_f32 v[126:127], v[126:127], v[122:123], s[34:35] op_sel_hi:[1,0,1]
    v_lshl_add_u32 v124, v125, 16, v124
    v_lshl_add_u32 v125, v127, 16, v126
    s_waitcnt lgkmcnt(2)
    v_bitop3_b32 v115, v115, v118, v119 bitop3:0xfe
    v_lshl_add_u64 v[124:125], v[124:125], 0, s[36:37]
    v_cmpx_le_u32 vcc, 0x1000000, v58
    ds_add_rtn_u64 v[118:119], v123, v[124:125] offset:54272
    s_mov_b64 exec, -1
    v_ashrrev_i32 v122, 5, v59
    v_lshlrev_b16 v123, 2, v59
    v_lshlrev_b32 v124, 16, v22
    v_bitop3_b32 v122, v122, v113, v113 bitop3:0x0c
    v_and_b32 v125, 0xffff0000, v22
    v_lshlrev_b32 v126, 16, v23
    v_mul_f32 v122, v114, v122
    v_and_b32 v127, 0xffff0000, v23
    v_add_u32 v123, v123, v123
    v_pk_fma_f32 v[124:125], v[124:125], v[122:123], s[34:35] op_sel_hi:[1,0,1]
    v_pk_fma_f32 v[126:127], v[126:127], v[122:123], s[34:35] op_sel_hi:[1,0,1]
    v_lshl_add_u32 v124, v125, 16, v124
    v_lshl_add_u32 v125, v127, 16, v126
    s_waitcnt lgkmcnt(2)
    v_bitop3_b32 v115, v115, v120, v121 bitop3:0xfe
    v_lshl_add_u64 v[124:125], v[124:125], 0, s[36:37]
    v_cmpx_le_u32 vcc, 0x1000000, v59
    ds_add_rtn_u64 v[120:121], v123, v[124:125] offset:54272
    s_mov_b64 exec, -1
p2_na0a3:
    v_bfe_u32 v18, v105, 14, 4
    v_lshrrev_b32 v19, 18, v105
    v_and_b32 v105, 0x3fff, v105
    v_mad_u32_u24 v18, v18, s63, v19
    v_mad_u32_u24 v105, v18, s65, v105
    buffer_load_dwordx4 v[18:21], v105, s[68:71], 0 offen
    s_mov_b32 m0, s23
    s_nop 0
    ds_read_addtid_b32 v102 offset:1024
    ds_read_addtid_b32 v103 offset:1280
    ds_read_addtid_b32 v104 offset:1536
    ds_read_addtid_b32 v105 offset:1792
    ds_read_addtid_b32 v106 offset:0
    ds_read_addtid_b32 v107 offset:256
    ds_read_addtid_b32 v108 offset:512
    ds_read_addtid_b32 v109 offset:768
    s_waitcnt vmcnt(4)
    s_mov_b32 m0, s24
    s_cmp_ge_u32 s10, 9
    s_cbranch_scc1 p2_st0s0
    ds_write_addtid_b32 v84 offset:49152
    ds_write_addtid_b32 v85 offset:49408
p2_st0s0:
    s_mov_b32 m0, s23
    s_add_u32 s20, s20, 53760
    ds_write_addtid_b32 v72 offset:0
    ds_write_addtid_b32 v73 offset:256
    ds_write_addtid_b32 v74 offset:512
    ds_write_addtid_b32 v75 offset:768
    ds_write_addtid_b32 v76 offset:1024
    ds_write_addtid_b32 v77 offset:1280
    ds_write_addtid_b32 v78 offset:1536
    ds_write_addtid_b32 v79 offset:1792
    ds_write_addtid_b32 v80 offset:2048
    ds_write_addtid_b32 v81 offset:2304
    ds_write_addtid_b32 v82 offset:2560
    ds_write_addtid_b32 v83 offset:2816
    s_setprio 1
    s_waitcnt lgkmcnt(15)
    v_ashrrev_i32 v122, 5, v60
    v_lshlrev_b16 v123, 2, v60
    v_lshlrev_b32 v124, 16, v24
    v_bitop3_b32 v122, v122, v113, v113 bitop3:0x0c
    v_and_b32 v125, 0xffff0000, v24
    v_lshlrev_b32 v126, 16, v25
    v_mul_f32 v122, v114, v122
    v_and_b32 v127, 0xffff0000, v25
    v_add_u32 v123, v123, v123
    v_pk_fma_f32 v[124:125], v[124:125], v[122:123], s[34:35] op_sel_hi:[1,0,1]
    v_pk_fma_f32 v[126:127], v[126:127], v[122:123], s[34:35] op_sel_hi:[1,0,1]
    v_lshl_add_u32 v124, v125, 16, v124
    v_lshl_add_u32 v125, v127, 16, v126
    s_waitcnt lgkmcnt(15)
    v_bitop3_b32 v115, v115, v116, v117 bitop3:0xfe
    v_lshl_add_u64 v[124:125], v[124:125], 0, s[36:37]
    v_cmpx_le_u32 vcc, 0x1000000, v60
    ds_add_rtn_u64 v[116:117], v123, v[124:125] offset:54272
    s_mov_b64 exec, -1
    v_ashrrev_i32 v122, 5, v61
    v_lshlrev_b16 v123, 2, v61
    v_lshlrev_b32 v124, 16, v26
    v_bitop3_b32 v122, v122, v113, v113 bitop3:0x0c
    v_and_b32 v125, 0xffff0000, v26
    v_lshlrev_b32 v126, 16, v27
    v_mul_f32 v122, v114, v122
    v_and_b32 v127, 0xffff0000, v27
    v_add_u32 v123, v123, v123
    v_pk_fma_f32 v[124:125], v[124:125], v[122:123], s[34:35] op_sel_hi:[1,0,1]
    v_pk_fma_f32 v[126:127], v[126:127], v[122:123], s[34:35] op_sel_hi:[1,0,1]
    v_lshl_add_u32 v124, v125, 16, v124
    v_lshl_add_u32 v125, v127, 16, v126
    s_waitcnt lgkmcnt(15)
    v_bitop3_b32 v115, v115, v118, v119 bitop3:0xfe
    v_lshl_add_u64 v[124:125], v[124:125], 0, s[36:37]
    v_cmpx_le_u32 vcc, 0x1000000, v61
    ds_add_rtn_u64 v[118:119], v123, v[124:125] offset:54272
    s_mov_b64 exec, -1
    v_ashrrev_i32 v122, 5, v62
    v_lshlrev_b16 v123, 2, v62
    v_lshlrev_b32 v124, 16, v28
    v_bitop3_b32 v122, v122, v113, v113 bitop3:0x0c
    v_and_b32 v125, 0xffff0000, v28
    v_lshlrev_b32 v126, 16, v29
    v_mul_f32 v122, v114, v122
    v_and_b32 v127, 0xffff0000, v29
    v_add_u32 v123, v123, v123
    v_pk_fma_f32 v[124:125], v[124:125], v[122:123], s[34:35] op_sel_hi:[1,0,1]
    v_pk_fma_f32 v[126:127], v[126:127], v[122:123], s[34:35] op_sel_hi:[1,0,1]
    v_lshl_add_u32 v124, v125, 16, v124
    v_lshl_add_u32 v125, v127, 16, v126
    s_waitcnt lgkmcnt(15)
    v_bitop3_b32 v115, v115, v120, v121 bitop3:0xfe
    v_lshl_add_u64 v[124:125], v[124:125], 0, s[36:37]
    v_cmpx_le_u32 vcc, 0x1000000, v62
    ds_add_rtn_u64 v[120:121], v123, v[124:125] offset:54272
    s_mov_b64 exec, -1
    s_waitcnt vmcnt(16)
    v_perm_b32 v60, v89, v86, s31
    v_perm_b32 v61, v89, v87, s32
    v_perm_b32 v62, v89, v88, s33
    v_lshlrev_b16 v28, 3, v88
    v_lshlrev_b16 v26, 3, v87
    v_lshlrev_b16 v24, 3, v86
    s_waitcnt lgkmcnt(15)
    s_nop 2
    s_nop 1
    v_max_u32_dpp v106, v106, v106 row_shr:1 row_mask:0xf bank_mask:0xf bound_ctrl:0
    v_max_u32_dpp v107, v107, v107 row_shr:1 row_mask:0xf bank_mask:0xf bound_ctrl:0
    s_nop 0
    v_max_u32_dpp v106, v106, v106 row_shr:2 row_mask:0xf bank_mask:0xf bound_ctrl:0
    v_max_u32_dpp v107, v107, v107 row_shr:2 row_mask:0xf bank_mask:0xf bound_ctrl:0
    s_nop 0
    v_max_u32_dpp v106, v106, v106 row_shr:4 row_mask:0xf bank_mask:0xf bound_ctrl:0
    v_max_u32_dpp v107, v107, v107 row_shr:4 row_mask:0xf bank_mask:0xf bound_ctrl:0
    s_nop 0
    v_max_u32_dpp v106, v106, v106 row_shr:8 row_mask:0xf bank_mask:0xf bound_ctrl:0
    v_max_u32_dpp v107, v107, v107 row_shr:8 row_mask:0xf bank_mask:0xf bound_ctrl:0
    s_nop 0
    v_max_u32_dpp v106, v106, v106 row_bcast:15 row_mask:0xa bank_mask:0xf
    v_max_u32_dpp v107, v107, v107 row_bcast:15 row_mask:0xa bank_mask:0xf
    s_nop 0
    v_max_u32_dpp v106, v106, v106 row_bcast:31 row_mask:0xc bank_mask:0xf
    v_max_u32_dpp v107, v107, v107 row_bcast:31 row_mask:0xc bank_mask:0xf
    s_nop 0
    s_nop 0
    v_readlane_b32 s41, v106, 63
    v_add_u32 v106, v106, v112
    v_add_u32 v106, 4294959104, v106
    v_max_u32 v107, s41, v107
    s_nop 0
    v_readlane_b32 s41, v107, 63
    v_add_u32 v107, v107, v112
    v_add_u32 v107, 4294960128, v107
    v_bfe_u32 v86, v106, 14, 4
    v_lshrrev_b32 v87, 18, v106
    v_and_b32 v106, 0x3fff, v106
    v_mad_u32_u24 v86, v86, s63, v87
    v_mad_u32_u24 v106, v86, s65, v106
    buffer_load_dwordx4 v[86:89], v106, s[68:71], 0 offen
    s_setprio 0
    s_waitcnt lgkmcnt(15)
    v_ashrrev_i32 v122, 5, v63
    v_lshlrev_b16 v123, 2, v63
    v_lshlrev_b32 v124, 16, v30
    v_bitop3_b32 v122, v122, v113, v113 bitop3:0x0c
    v_and_b32 v125, 0xffff0000, v30
    v_lshlrev_b32 v126, 16, v31
    v_mul_f32 v122, v114, v122
    v_and_b32 v127, 0xffff0000, v31
    v_add_u32 v123, v123, v123
    v_pk_fma_f32 v[124:125], v[124:125], v[122:123], s[34:35] op_sel_hi:[1,0,1]
    v_pk_fma_f32 v[126:127], v[126:127], v[122:123], s[34:35] op_sel_hi:[1,0,1]
    v_lshl_add_u32 v124, v125, 16, v124
    v_lshl_add_u32 v125, v127, 16, v126
    s_waitcnt lgkmcnt(2)
    v_bitop3_b32 v115, v115, v116, v117 bitop3:0xfe
    v_lshl_add_u64 v[124:125], v[124:125], 0, s[36:37]
    v_cmpx_le_u32 vcc, 0x1000000, v63
    ds_add_rtn_u64 v[116:117], v123, v[124:125] offset:54272
    s_mov_b64 exec, -1
    v_ashrrev_i32 v122, 5, v64
    v_lshlrev_b16 v123, 2, v64
    v_lshlrev_b32 v124, 16, v32
    v_bitop3_b32 v122, v122, v113, v113 bitop3:0x0c
    v_and_b32 v125, 0xffff0000, v32
    v_lshlrev_b32 v126, 16, v33
    v_mul_f32 v122, v114, v122
    v_and_b32 v127, 0xffff0000, v33
    v_add_u32 v123, v123, v123
    v_pk_fma_f32 v[124:125], v[124:125], v[122:123], s[34:35] op_sel_hi:[1,0,1]
    v_pk_fma_f32 v[126:127], v[126:127], v[122:123], s[34:35] op_sel_hi:[1,0,1]
    v_lshl_add_u32 v124, v125, 16, v124
    v_lshl_add_u32 v125, v127, 16, v126
    s_waitcnt lgkmcnt(2)
    v_bitop3_b32 v115, v115, v118, v119 bitop3:0xfe
    v_lshl_add_u64 v[124:125], v[124:125], 0, s[36:37]
    v_cmpx_le_u32 vcc, 0x1000000, v64
    ds_add_rtn_u64 v[118:119], v123, v[124:125] offset:54272
    s_mov_b64 exec, -1
    v_ashrrev_i32 v122, 5, v65
    v_lshlrev_b16 v123, 2, v65
    v_lshlrev_b32 v124, 16, v34
    v_bitop3_b32 v122, v122, v113, v113 bitop3:0x0c
    v_and_b32 v125, 0xffff0000, v34
    v_lshlrev_b32 v126, 16, v35
    v_mul_f32 v122, v114, v122
    v_and_b32 v127, 0xffff0000, v35
    v_add_u32 v123, v123, v123
    v_pk_fma_f32 v[124:125], v[124:125], v[122:123], s[34:35] op_sel_hi:[1,0,1]
    v_pk_fma_f32 v[126:127], v[126:127], v[122:123], s[34:35] op_sel_hi:[1,0,1]
    v_lshl_add_u32 v124, v125, 16, v124
    v_lshl_add_u32 v125, v127, 16, v126
    s_waitcnt lgkmcnt(2)
    v_bitop3_b32 v115, v115, v120, v121 bitop3:0xfe
    v_lshl_add_u64 v[124:125], v[124:125], 0, s[36:37]
    v_cmpx_le_u32 vcc, 0x1000000, v65
    ds_add_rtn_u64 v[120:121], v123, v[124:125] offset:54272
    s_mov_b64 exec, -1
    s_waitcnt vmcnt(13)
    v_perm_b32 v63, v93, v90, s31
    v_perm_b32 v64, v93, v91, s32
    v_perm_b32 v65, v93, v92, s33
    v_lshlrev_b16 v34, 3, v92
    v_lshlrev_b16 v32, 3, v91
    v_lshlrev_b16 v30, 3, v90
    s_waitcnt lgkmcnt(6)
    s_barrier
    s_setprio 3
    s_cmp_ge_u32 s10, 9
    s_cbranch_scc1 p2_nm0m1a
    v_lshrrev_b32 v84, 1, v112
    s_add_u32 s44, s20, s42
    buffer_load_dwordx2 v[84:85], v84, s[4:7], s44 offen
p2_nm0m1a:
    buffer_load_dwordx4 v[72:75], v112, s[4:7], s20 offen offset:0
    buffer_load_dwordx4 v[76:79], v112, s[4:7], s20 offen offset:1024
    buffer_load_dwordx4 v[80:83], v112, s[4:7], s20 offen offset:2048
    v_cmpx_ge_u16 vcc, 0x3fff, v60
    ds_read_b64 v[24:25], v24
    s_mov_b64 exec, -1
    v_cmpx_ge_u16 vcc, 0x3fff, v61
    ds_read_b64 v[26:27], v26
    s_mov_b64 exec, -1
    v_cmpx_ge_u16 vcc, 0x3fff, v62
    ds_read_b64 v[28:29], v28
    s_mov_b64 exec, -1
    v_cmpx_ge_u16 vcc, 0x3fff, v63
    ds_read_b64 v[30:31], v30
    s_mov_b64 exec, -1
    v_cmpx_ge_u16 vcc, 0x3fff, v64
    ds_read_b64 v[32:33], v32
    s_mov_b64 exec, -1
    v_cmpx_ge_u16 vcc, 0x3fff, v65
    ds_read_b64 v[34:35], v34
    s_mov_b64 exec, -1
    s_setprio 2
    s_waitcnt lgkmcnt(15)
    v_ashrrev_i32 v122, 5, v66
    v_lshlrev_b16 v123, 2, v66
    v_lshlrev_b32 v124, 16, v36
    v_bitop3_b32 v122, v122, v113, v113 bitop3:0x0c
    v_and_b32 v125, 0xffff0000, v36
    v_lshlrev_b32 v126, 16, v37
    v_mul_f32 v122, v114, v122
    v_and_b32 v127, 0xffff0000, v37
    v_add_u32 v123, v123, v123
    v_pk_fma_f32 v[124:125], v[124:125], v[122:123], s[34:35] op_sel_hi:[1,0,1]
    v_pk_fma_f32 v[126:127], v[126:127], v[122:123], s[34:35] op_sel_hi:[1,0,1]
    v_lshl_add_u32 v124, v125, 16, v124
    v_lshl_add_u32 v125, v127, 16, v126
    s_waitcnt lgkmcnt(8)
    v_bitop3_b32 v115, v115, v116, v117 bitop3:0xfe
    v_lshl_add_u64 v[124:125], v[124:125], 0, s[36:37]
    v_cmpx_le_u32 vcc, 0x1000000, v66
    ds_add_rtn_u64 v[116:117], v123, v[124:125] offset:54272
    s_mov_b64 exec, -1
    v_ashrrev_i32 v122, 5, v67
    v_lshlrev_b16 v123, 2, v67
    v_lshlrev_b32 v124, 16, v38
    v_bitop3_b32 v122, v122, v113, v113 bitop3:0x0c
    v_and_b32 v125, 0xffff0000, v38
    v_lshlrev_b32 v126, 16, v39
    v_mul_f32 v122, v114, v122
    v_and_b32 v127, 0xffff0000, v39
    v_add_u32 v123, v123, v123
    v_pk_fma_f32 v[124:125], v[124:125], v[122:123], s[34:35] op_sel_hi:[1,0,1]
    v_pk_fma_f32 v[126:127], v[126:127], v[122:123], s[34:35] op_sel_hi:[1,0,1]
    v_lshl_add_u32 v124, v125, 16, v124
    v_lshl_add_u32 v125, v127, 16, v126
    s_waitcnt lgkmcnt(8)
    v_bitop3_b32 v115, v115, v118, v119 bitop3:0xfe
    v_lshl_add_u64 v[124:125], v[124:125], 0, s[36:37]
    v_cmpx_le_u32 vcc, 0x1000000, v67
    ds_add_rtn_u64 v[118:119], v123, v[124:125] offset:54272
    s_mov_b64 exec, -1
    v_ashrrev_i32 v122, 5, v68
    v_lshlrev_b16 v123, 2, v68
    v_lshlrev_b32 v124, 16, v40
    v_bitop3_b32 v122, v122, v113, v113 bitop3:0x0c
    v_and_b32 v125, 0xffff0000, v40
    v_lshlrev_b32 v126, 16, v41
    v_mul_f32 v122, v114, v122
    v_and_b32 v127, 0xffff0000, v41
    v_add_u32 v123, v123, v123
    v_pk_fma_f32 v[124:125], v[124:125], v[122:123], s[34:35] op_sel_hi:[1,0,1]
    v_pk_fma_f32 v[126:127], v[126:127], v[122:123], s[34:35] op_sel_hi:[1,0,1]
    v_lshl_add_u32 v124, v125, 16, v124
    v_lshl_add_u32 v125, v127, 16, v126
    s_waitcnt lgkmcnt(8)
    v_bitop3_b32 v115, v115, v120, v121 bitop3:0xfe
    v_lshl_add_u64 v[124:125], v[124:125], 0, s[36:37]
    v_cmpx_le_u32 vcc, 0x1000000, v68
    ds_add_rtn_u64 v[120:121], v123, v[124:125] offset:54272
    s_mov_b64 exec, -1
    s_waitcnt vmcnt(15)
    v_perm_b32 v66, v97, v94, s31
    v_perm_b32 v67, v97, v95, s32
    v_perm_b32 v68, v97, v96, s33
    v_lshlrev_b16 v40, 3, v96
    v_lshlrev_b16 v38, 3, v95
    v_lshlrev_b16 v36, 3, v94
    v_cmpx_ge_u16 vcc, 0x3fff, v66
    ds_read_b64 v[36:37], v36
    s_mov_b64 exec, -1
    v_cmpx_ge_u16 vcc, 0x3fff, v67
    ds_read_b64 v[38:39], v38
    s_mov_b64 exec, -1
    v_cmpx_ge_u16 vcc, 0x3fff, v68
    ds_read_b64 v[40:41], v40
    s_mov_b64 exec, -1
    v_bfe_u32 v90, v107, 14, 4
    v_lshrrev_b32 v91, 18, v107
    v_and_b32 v107, 0x3fff, v107
    v_mad_u32_u24 v90, v90, s63, v91
    v_mad_u32_u24 v107, v90, s65, v107
    buffer_load_dwordx4 v[90:93], v107, s[68:71], 0 offen
    s_setprio 1
    s_waitcnt lgkmcnt(15)
    v_ashrrev_i32 v122, 5, v69
    v_lshlrev_b16 v123, 2, v69
    v_lshlrev_b32 v124, 16, v42
    v_bitop3_b32 v122, v122, v113, v113 bitop3:0x0c
    v_and_b32 v125, 0xffff0000, v42
    v_lshlrev_b32 v126, 16, v43
    v_mul_f32 v122, v114, v122
    v_and_b32 v127, 0xffff0000, v43
    v_add_u32 v123, v123, v123
    v_pk_fma_f32 v[124:125], v[124:125], v[122:123], s[34:35] op_sel_hi:[1,0,1]
    v_pk_fma_f32 v[126:127], v[126:127], v[122:123], s[34:35] op_sel_hi:[1,0,1]
    v_lshl_add_u32 v124, v125, 16, v124
    v_lshl_add_u32 v125, v127, 16, v126
    s_waitcnt lgkmcnt(5)
    v_bitop3_b32 v115, v115, v116, v117 bitop3:0xfe
    v_lshl_add_u64 v[124:125], v[124:125], 0, s[36:37]
    v_cmpx_le_u32 vcc, 0x1000000, v69
    ds_add_rtn_u64 v[116:117], v123, v[124:125] offset:54272
    s_mov_b64 exec, -1
    v_ashrrev_i32 v122, 5, v70
    v_lshlrev_b16 v123, 2, v70
    v_lshlrev_b32 v124, 16, v44
    v_bitop3_b32 v122, v122, v113, v113 bitop3:0x0c
    v_and_b32 v125, 0xffff0000, v44
    v_lshlrev_b32 v126, 16, v45
    v_mul_f32 v122, v114, v122
    v_and_b32 v127, 0xffff0000, v45
    v_add_u32 v123, v123, v123
    v_pk_fma_f32 v[124:125], v[124:125], v[122:123], s[34:35] op_sel_hi:[1,0,1]
    v_pk_fma_f32 v[126:127], v[126:127], v[122:123], s[34:35] op_sel_hi:[1,0,1]
    v_lshl_add_u32 v124, v125, 16, v124
    v_lshl_add_u32 v125, v127, 16, v126
    s_waitcnt lgkmcnt(5)
    v_bitop3_b32 v115, v115, v118, v119 bitop3:0xfe
    v_lshl_add_u64 v[124:125], v[124:125], 0, s[36:37]
    v_cmpx_le_u32 vcc, 0x1000000, v70
    ds_add_rtn_u64 v[118:119], v123, v[124:125] offset:54272
    s_mov_b64 exec, -1
    v_ashrrev_i32 v122, 5, v71
    v_lshlrev_b16 v123, 2, v71
    v_lshlrev_b32 v124, 16, v46
    v_bitop3_b32 v122, v122, v113, v113 bitop3:0x0c
    v_and_b32 v125, 0xffff0000, v46
    v_lshlrev_b32 v126, 16, v47
    v_mul_f32 v122, v114, v122
    v_and_b32 v127, 0xffff0000, v47
    v_add_u32 v123, v123, v123
    v_pk_fma_f32 v[124:125], v[124:125], v[122:123], s[34:35] op_sel_hi:[1,0,1]
    v_pk_fma_f32 v[126:127], v[126:127], v[122:123], s[34:35] op_sel_hi:[1,0,1]
    v_lshl_add_u32 v124, v125, 16, v124
    v_lshl_add_u32 v125, v127, 16, v126
    s_waitcnt lgkmcnt(5)
    v_bitop3_b32 v115, v115, v120, v121 bitop3:0xfe
    v_lshl_add_u64 v[124:125], v[124:125], 0, s[36:37]
    v_cmpx_le_u32 vcc, 0x1000000, v71
    ds_add_rtn_u64 v[120:121], v123, v[124:125] offset:54272
    s_mov_b64 exec, -1
    s_waitcnt vmcnt(12)
    v_perm_b32 v69, v101, v98, s31
    v_perm_b32 v70, v101, v99, s32
    v_perm_b32 v71, v101, v100, s33
    v_lshlrev_b16 v46, 3, v100
    v_lshlrev_b16 v44, 3, v99
    v_lshlrev_b16 v42, 3, v98
    v_cmpx_ge_u16 vcc, 0x3fff, v69
    ds_read_b64 v[42:43], v42
    s_mov_b64 exec, -1
    v_cmpx_ge_u16 vcc, 0x3fff, v70
    ds_read_b64 v[44:45], v44
    s_mov_b64 exec, -1
    v_cmpx_ge_u16 vcc, 0x3fff, v71
    ds_read_b64 v[46:47], v46
    s_mov_b64 exec, -1
    s_waitcnt lgkmcnt(15)
    s_nop 2
    s_nop 1
    v_max_u32_dpp v108, v108, v108 row_shr:1 row_mask:0xf bank_mask:0xf bound_ctrl:0
    v_max_u32_dpp v109, v109, v109 row_shr:1 row_mask:0xf bank_mask:0xf bound_ctrl:0
    s_nop 0
    v_max_u32_dpp v108, v108, v108 row_shr:2 row_mask:0xf bank_mask:0xf bound_ctrl:0
    v_max_u32_dpp v109, v109, v109 row_shr:2 row_mask:0xf bank_mask:0xf bound_ctrl:0
    s_nop 0
    v_max_u32_dpp v108, v108, v108 row_shr:4 row_mask:0xf bank_mask:0xf bound_ctrl:0
    v_max_u32_dpp v109, v109, v109 row_shr:4 row_mask:0xf bank_mask:0xf bound_ctrl:0
    s_nop 0
    v_max_u32_dpp v108, v108, v108 row_shr:8 row_mask:0xf bank_mask:0xf bound_ctrl:0
    v_max_u32_dpp v109, v109, v109 row_shr:8 row_mask:0xf bank_mask:0xf bound_ctrl:0
    s_nop 0
    v_max_u32_dpp v108, v108, v108 row_bcast:15 row_mask:0xa bank_mask:0xf
    v_max_u32_dpp v109, v109, v109 row_bcast:15 row_mask:0xa bank_mask:0xf
    s_nop 0
    v_max_u32_dpp v108, v108, v108 row_bcast:31 row_mask:0xc bank_mask:0xf
    v_max_u32_dpp v109, v109, v109 row_bcast:31 row_mask:0xc bank_mask:0xf
    s_nop 0
    s_nop 0
    v_max_u32 v108, s41, v108
    s_nop 0
    v_readlane_b32 s41, v108, 63
    v_add_u32 v108, v108, v112
    v_add_u32 v108, 4294961152, v108
    v_max_u32 v109, s41, v109
    s_nop 0
    v_readlane_b32 s41, v109, 63
    v_add_u32 v109, v109, v112
    v_add_u32 v109, 4294962176, v109
    v_bfe_u32 v94, v108, 14, 4
    v_lshrrev_b32 v95, 18, v108
    v_and_b32 v108, 0x3fff, v108
    v_mad_u32_u24 v94, v94, s63, v95
    v_mad_u32_u24 v108, v94, s65, v108
    buffer_load_dwordx4 v[94:97], v108, s[68:71], 0 offen
    s_setprio 0
    s_waitcnt vmcnt(9)
    v_perm_b32 v48, v3, v0, s31
    v_perm_b32 v49, v3, v1, s32
    v_perm_b32 v50, v3, v2, s33
    v_lshlrev_b16 v4, 3, v2
    v_lshlrev_b16 v2, 3, v1
    v_lshlrev_b16 v0, 3, v0
    v_cmpx_ge_u16 vcc, 0x3fff, v48
    ds_read_b64 v[0:1], v0
    s_mov_b64 exec, -1
    v_cmpx_ge_u16 vcc, 0x3fff, v49
    ds_read_b64 v[2:3], v2
    s_mov_b64 exec, -1
    v_cmpx_ge_u16 vcc, 0x3fff, v50
    ds_read_b64 v[4:5], v4
    s_mov_b64 exec, -1
    s_waitcnt vmcnt(8)
    v_perm_b32 v51, v9, v6, s31
    v_perm_b32 v52, v9, v7, s32
    v_perm_b32 v53, v9, v8, s33
    v_lshlrev_b16 v10, 3, v8
    v_lshlrev_b16 v8, 3, v7
    v_lshlrev_b16 v6, 3, v6
    v_cmpx_ge_u16 vcc, 0x3fff, v51
    ds_read_b64 v[6:7], v6
    s_mov_b64 exec, -1
    v_cmpx_ge_u16 vcc, 0x3fff, v52
    ds_read_b64 v[8:9], v8
    s_mov_b64 exec, -1
    v_cmpx_ge_u16 vcc, 0x3fff, v53
    ds_read_b64 v[10:11], v10
    s_mov_b64 exec, -1
    s_waitcnt vmcnt(7)
    v_perm_b32 v54, v15, v12, s31
    v_perm_b32 v55, v15, v13, s32
    v_perm_b32 v56, v15, v14, s33
    v_lshlrev_b16 v16, 3, v14
    v_lshlrev_b16 v14, 3, v13
    v_lshlrev_b16 v12, 3, v12
    v_cmpx_ge_u16 vcc, 0x3fff, v54
    ds_read_b64 v[12:13], v12
    s_mov_b64 exec, -1
    v_cmpx_ge_u16 vcc, 0x3fff, v55
    ds_read_b64 v[14:15], v14
    s_mov_b64 exec, -1
    v_cmpx_ge_u16 vcc, 0x3fff, v56
    ds_read_b64 v[16:17], v16
    s_mov_b64 exec, -1
    s_waitcnt vmcnt(6)
    v_perm_b32 v57, v21, v18, s31
    v_perm_b32 v58, v21, v19, s32
    v_perm_b32 v59, v21, v20, s33
    v_lshlrev_b16 v22, 3, v20
    v_lshlrev_b16 v20, 3, v19
    v_lshlrev_b16 v18, 3, v18
    s_cmp_lt_u32 s16, 8
    s_cbranch_scc1 p2_g0r03
    v_cmpx_ge_u16 vcc, 0x3fff, v57
    ds_read_b64 v[18:19], v18
    s_mov_b64 exec, -1
    v_cmpx_ge_u16 vcc, 0x3fff, v58
    ds_read_b64 v[20:21], v20
    s_mov_b64 exec, -1
    v_cmpx_ge_u16 vcc, 0x3fff, v59
    ds_read_b64 v[22:23], v22
    s_mov_b64 exec, -1
p2_g0r03:
    s_waitcnt lgkmcnt(0)
    s_barrier
    s_waitcnt lgkmcnt(15)
    s_branch p2_tail
p2_drain0:
    v_cmpx_gt_i16 vcc, 0, v48
    ds_read_b64 v[0:1], v0
    s_mov_b64 exec, -1
    v_cmpx_gt_i16 vcc, 0, v49
    ds_read_b64 v[2:3], v2
    s_mov_b64 exec, -1
    v_cmpx_gt_i16 vcc, 0, v50
    ds_read_b64 v[4:5], v4
    s_mov_b64 exec, -1
    v_cmpx_gt_i16 vcc, 0, v51
    ds_read_b64 v[6:7], v6
    s_mov_b64 exec, -1
    v_cmpx_gt_i16 vcc, 0, v52
    ds_read_b64 v[8:9], v8
    s_mov_b64 exec, -1
    v_cmpx_gt_i16 vcc, 0, v53
    ds_read_b64 v[10:11], v10
    s_mov_b64 exec, -1
    v_cmpx_gt_i16 vcc, 0, v54
    ds_read_b64 v[12:13], v12
    s_mov_b64 exec, -1
    v_cmpx_gt_i16 vcc, 0, v55
    ds_read_b64 v[14:15], v14
    s_mov_b64 exec, -1
    v_cmpx_gt_i16 vcc, 0, v56
    ds_read_b64 v[16:17], v16
    s_mov_b64 exec, -1
    s_cmp_lt_u32 s15, 8
    s_cbranch_scc1 p2_gd0
    v_cmpx_gt_i16 vcc, 0, v57
    ds_read_b64 v[18:19], v18
    s_mov_b64 exec, -1
    v_cmpx_gt_i16 vcc, 0, v58
    ds_read_b64 v[20:21], v20
    s_mov_b64 exec, -1
    v_cmpx_gt_i16 vcc, 0, v59
    ds_read_b64 v[22:23], v22
    s_mov_b64 exec, -1
p2_gd0:
    v_cmpx_gt_i16 vcc, 0, v60
    ds_read_b64 v[24:25], v24
    s_mov_b64 exec, -1
    v_cmpx_gt_i16 vcc, 0, v61
    ds_read_b64 v[26:27], v26
    s_mov_b64 exec, -1
    v_cmpx_gt_i16 vcc, 0, v62
    ds_read_b64 v[28:29], v28
    s_mov_b64 exec, -1
    v_cmpx_gt_i16 vcc, 0, v63
    ds_read_b64 v[30:31], v30
    s_mov_b64 exec, -1
    v_cmpx_gt_i16 vcc, 0, v64
    ds_read_b64 v[32:33], v32
    s_mov_b64 exec, -1
    v_cmpx_gt_i16 vcc, 0, v65
    ds_read_b64 v[34:35], v34
    s_mov_b64 exec, -1
    v_cmpx_gt_i16 vcc, 0, v66
    ds_read_b64 v[36:37], v36
    s_mov_b64 exec, -1
    v_cmpx_gt_i16 vcc, 0, v67
    ds_read_b64 v[38:39], v38
    s_mov_b64 exec, -1
    v_cmpx_gt_i16 vcc, 0, v68
    ds_read_b64 v[40:41], v40
    s_mov_b64 exec, -1
    v_cmpx_gt_i16 vcc, 0, v69
    ds_read_b64 v[42:43], v42
    s_mov_b64 exec, -1
    v_cmpx_gt_i16 vcc, 0, v70
    ds_read_b64 v[44:45], v44
    s_mov_b64 exec, -1
    v_cmpx_gt_i16 vcc, 0, v71
    ds_read_b64 v[46:47], v46
    s_mov_b64 exec, -1
    s_waitcnt lgkmcnt(15)
    v_ashrrev_i32 v122, 5, v48
    v_lshlrev_b16 v123, 2, v48
    v_lshlrev_b32 v124, 16, v0
    v_bitop3_b32 v122, v122, v113, v113 bitop3:0x0c
    v_and_b32 v125, 0xffff0000, v0
    v_lshlrev_b32 v126, 16, v1
    v_mul_f32 v122, v114, v122
    v_and_b32 v127, 0xffff0000, v1
    v_add_u32 v123, v123, v123
    v_pk_fma_f32 v[124:125], v[124:125], v[122:123], s[34:35] op_sel_hi:[1,0,1]
    v_pk_fma_f32 v[126:127], v[126:127], v[122:123], s[34:35] op_sel_hi:[1,0,1]
    v_lshl_add_u32 v124, v125, 16, v124
    v_lshl_add_u32 v125, v127, 16, v126
    s_waitcnt lgkmcnt(15)
    v_bitop3_b32 v115, v115, v116, v117 bitop3:0xfe
    v_lshl_add_u64 v[124:125], v[124:125], 0, s[36:37]
    v_cmpx_le_u32 vcc, 0x1000000, v48
    ds_add_rtn_u64 v[116:117], v123, v[124:125] offset:54272
    s_mov_b64 exec, -1
    v_ashrrev_i32 v122, 5, v49
    v_lshlrev_b16 v123, 2, v49
    v_lshlrev_b32 v124, 16, v2
    v_bitop3_b32 v122, v122, v113, v113 bitop3:0x0c
    v_and_b32 v125, 0xffff0000, v2
    v_lshlrev_b32 v126, 16, v3
    v_mul_f32 v122, v114, v122
    v_and_b32 v127, 0xffff0000, v3
    v_add_u32 v123, v123, v123
    v_pk_fma_f32 v[124:125], v[124:125], v[122:123], s[34:35] op_sel_hi:[1,0,1]
    v_pk_fma_f32 v[126:127], v[126:127], v[122:123], s[34:35] op_sel_hi:[1,0,1]
    v_lshl_add_u32 v124, v125, 16, v124
    v_lshl_add_u32 v125, v127, 16, v126
    s_waitcnt lgkmcnt(15)
    v_bitop3_b32 v115, v115, v118, v119 bitop3:0xfe
    v_lshl_add_u64 v[124:125], v[124:125], 0, s[36:37]
    v_cmpx_le_u32 vcc, 0x1000000, v49
    ds_add_rtn_u64 v[118:119], v123, v[124:125] offset:54272
    s_mov_b64 exec, -1
    v_ashrrev_i32 v122, 5, v50
    v_lshlrev_b16 v123, 2, v50
    v_lshlrev_b32 v124, 16, v4
    v_bitop3_b32 v122, v122, v113, v113 bitop3:0x0c
    v_and_b32 v125, 0xffff0000, v4
    v_lshlrev_b32 v126, 16, v5
    v_mul_f32 v122, v114, v122
    v_and_b32 v127, 0xffff0000, v5
    v_add_u32 v123, v123, v123
    v_pk_fma_f32 v[124:125], v[124:125], v[122:123], s[34:35] op_sel_hi:[1,0,1]
    v_pk_fma_f32 v[126:127], v[126:127], v[122:123], s[34:35] op_sel_hi:[1,0,1]
    v_lshl_add_u32 v124, v125, 16, v124
    v_lshl_add_u32 v125, v127, 16, v126
    s_waitcnt lgkmcnt(15)
    v_bitop3_b32 v115, v115, v120, v121 bitop3:0xfe
    v_lshl_add_u64 v[124:125], v[124:125], 0, s[36:37]
    v_cmpx_le_u32 vcc, 0x1000000, v50
    ds_add_rtn_u64 v[120:121], v123, v[124:125] offset:54272
    s_mov_b64 exec, -1
    s_waitcnt lgkmcnt(15)
    v_ashrrev_i32 v122, 5, v51
    v_lshlrev_b16 v123, 2, v51
    v_lshlrev_b32 v124, 16, v6
    v_bitop3_b32 v122, v122, v113, v113 bitop3:0x0c
    v_and_b32 v125, 0xffff0000, v6
    v_lshlrev_b32 v126, 16, v7
    v_mul_f32 v122, v114, v122
    v_and_b32 v127, 0xffff0000, v7
    v_add_u32 v123, v123, v123
    v_pk_fma_f32 v[124:125], v[124:125], v[122:123], s[34:35] op_sel_hi:[1,0,1]
    v_pk_fma_f32 v[126:127], v[126:127], v[122:123], s[34:35] op_sel_hi:[1,0,1]
    v_lshl_add_u32 v124, v125, 16, v124
    v_lshl_add_u32 v125, v127, 16, v126
    s_waitcnt lgkmcnt(2)
    v_bitop3_b32 v115, v115, v116, v117 bitop3:0xfe
    v_lshl_add_u64 v[124:125], v[124:125], 0, s[36:37]
    v_cmpx_le_u32 vcc, 0x1000000, v51
    ds_add_rtn_u64 v[116:117], v123, v[124:125] offset:54272
    s_mov_b64 exec, -1
    v_ashrrev_i32 v122, 5, v52
    v_lshlrev_b16 v123, 2, v52
    v_lshlrev_b32 v124, 16, v8
    v_bitop3_b32 v122, v122, v113, v113 bitop3:0x0c
    v_and_b32 v125, 0xffff0000, v8
    v_lshlrev_b32 v126, 16, v9
    v_mul_f32 v122, v114, v122
    v_and_b32 v127, 0xffff0000, v9
    v_add_u32 v123, v123, v123
    v_pk_fma_f32 v[124:125], v[124:125], v[122:123], s[34:35] op_sel_hi:[1,0,1]
    v_pk_fma_f32 v[126:127], v[126:127], v[122:123], s[34:35] op_sel_hi:[1,0,1]
    v_lshl_add_u32 v124, v125, 16, v124
    v_lshl_add_u32 v125, v127, 16, v126
    s_waitcnt lgkmcnt(2)
    v_bitop3_b32 v115, v115, v118, v119 bitop3:0xfe
    v_lshl_add_u64 v[124:125], v[124:125], 0, s[36:37]
    v_cmpx_le_u32 vcc, 0x1000000, v52
    ds_add_rtn_u64 v[118:119], v123, v[124:125] offset:54272
    s_mov_b64 exec, -1
    v_ashrrev_i32 v122, 5, v53
    v_lshlrev_b16 v123, 2, v53
    v_lshlrev_b32 v124, 16, v10
    v_bitop3_b32 v122, v122, v113, v113 bitop3:0x0c
    v_and_b32 v125, 0xffff0000, v10
    v_lshlrev_b32 v126, 16, v11
    v_mul_f32 v122, v114, v122
    v_and_b32 v127, 0xffff0000, v11
    v_add_u32 v123, v123, v123
    v_pk_fma_f32 v[124:125], v[124:125], v[122:123], s[34:35] op_sel_hi:[1,0,1]
    v_pk_fma_f32 v[126:127], v[126:127], v[122:123], s[34:35] op_sel_hi:[1,0,1]
    v_lshl_add_u32 v124, v125, 16, v124
    v_lshl_add_u32 v125, v127, 16, v126
    s_waitcnt lgkmcnt(2)
    v_bitop3_b32 v115, v115, v120, v121 bitop3:0xfe
    v_lshl_add_u64 v[124:125], v[124:125], 0, s[36:37]
    v_cmpx_le_u32 vcc, 0x1000000, v53
    ds_add_rtn_u64 v[120:121], v123, v[124:125] offset:54272
    s_mov_b64 exec, -1
    s_waitcnt lgkmcnt(15)
    v_ashrrev_i32 v122, 5, v54
    v_lshlrev_b16 v123, 2, v54
    v_lshlrev_b32 v124, 16, v12
    v_bitop3_b32 v122, v122, v113, v113 bitop3:0x0c
    v_and_b32 v125, 0xffff0000, v12
    v_lshlrev_b32 v126, 16, v13
    v_mul_f32 v122, v114, v122
    v_and_b32 v127, 0xffff0000, v13
    v_add_u32 v123, v123, v123
    v_pk_fma_f32 v[124:125], v[124:125], v[122:123], s[34:35] op_sel_hi:[1,0,1]
    v_pk_fma_f32 v[126:127], v[126:127], v[122:123], s[34:35] op_sel_hi:[1,0,1]
    v_lshl_add_u32 v124, v125, 16, v124
    v_lshl_add_u32 v125, v127, 16, v126
    s_waitcnt lgkmcnt(2)
    v_bitop3_b32 v115, v115, v116, v117 bitop3:0xfe
    v_lshl_add_u64 v[124:125], v[124:125], 0, s[36:37]
    v_cmpx_le_u32 vcc, 0x1000000, v54
    ds_add_rtn_u64 v[116:117], v123, v[124:125] offset:54272
    s_mov_b64 exec, -1
    v_ashrrev_i32 v122, 5, v55
    v_lshlrev_b16 v123, 2, v55
    v_lshlrev_b32 v124, 16, v14
    v_bitop3_b32 v122, v122, v113, v113 bitop3:0x0c
    v_and_b32 v125, 0xffff0000, v14
    v_lshlrev_b32 v126, 16, v15
    v_mul_f32 v122, v114, v122
    v_and_b32 v127, 0xffff0000, v15
    v_add_u32 v123, v123, v123
    v_pk_fma_f32 v[124:125], v[124:125], v[122:123], s[34:35] op_sel_hi:[1,0,1]
    v_pk_fma_f32 v[126:127], v[126:127], v[122:123], s[34:35] op_sel_hi:[1,0,1]
    v_lshl_add_u32 v124, v125, 16, v124
    v_lshl_add_u32 v125, v127, 16, v126
    s_waitcnt lgkmcnt(2)
    v_bitop3_b32 v115, v115, v118, v119 bitop3:0xfe
    v_lshl_add_u64 v[124:125], v[124:125], 0, s[36:37]
    v_cmpx_le_u32 vcc, 0x1000000, v55
    ds_add_rtn_u64 v[118:119], v123, v[124:125] offset:54272
    s_mov_b64 exec, -1
    v_ashrrev_i32 v122, 5, v56
    v_lshlrev_b16 v123, 2, v56
    v_lshlrev_b32 v124, 16, v16
    v_bitop3_b32 v122, v122, v113, v113 bitop3:0x0c
    v_and_b32 v125, 0xffff0000, v16
    v_lshlrev_b32 v126, 16, v17
    v_mul_f32 v122, v114, v122
    v_and_b32 v127, 0xffff0000, v17
    v_add_u32 v123, v123, v123
    v_pk_fma_f32 v[124:125], v[124:125], v[122:123], s[34:35] op_sel_hi:[1,0,1]
    v_pk_fma_f32 v[126:127], v[126:127], v[122:123], s[34:35] op_sel_hi:[1,0,1]
    v_lshl_add_u32 v124, v125, 16, v124
    v_lshl_add_u32 v125, v127, 16, v126
    s_waitcnt lgkmcnt(2)
    v_bitop3_b32 v115, v115, v120, v121 bitop3:0xfe
    v_lshl_add_u64 v[124:125], v[124:125], 0, s[36:37]
    v_cmpx_le_u32 vcc, 0x1000000, v56
    ds_add_rtn_u64 v[120:121], v123, v[124:125] offset:54272
    s_mov_b64 exec, -1
    s_cmp_lt_u32 s15, 8
    s_cbranch_scc1 p2_nad0
    s_waitcnt lgkmcnt(15)
    v_ashrrev_i32 v122, 5, v57
    v_lshlrev_b16 v123, 2, v57
    v_lshlrev_b32 v124, 16, v18
    v_bitop3_b32 v122, v122, v113, v113 bitop3:0x0c
    v_and_b32 v125, 0xffff0000, v18
    v_lshlrev_b32 v126, 16, v19
    v_mul_f32 v122, v114, v122
    v_and_b32 v127, 0xffff0000, v19
    v_add_u32 v123, v123, v123
    v_pk_fma_f32 v[124:125], v[124:125], v[122:123], s[34:35] op_sel_hi:[1,0,1]
    v_pk_fma_f32 v[126:127], v[126:127], v[122:123], s[34:35] op_sel_hi:[1,0,1]
    v_lshl_add_u32 v124, v125, 16, v124
    v_lshl_add_u32 v125, v127, 16, v126
    s_waitcnt lgkmcnt(2)
    v_bitop3_b32 v115, v115, v116, v117 bitop3:0xfe
    v_lshl_add_u64 v[124:125], v[124:125], 0, s[36:37]
    v_cmpx_le_u32 vcc, 0x1000000, v57
    ds_add_rtn_u64 v[116:117], v123, v[124:125] offset:54272
    s_mov_b64 exec, -1
    v_ashrrev_i32 v122, 5, v58
    v_lshlrev_b16 v123, 2, v58
    v_lshlrev_b32 v124, 16, v20
    v_bitop3_b32 v122, v122, v113, v113 bitop3:0x0c
    v_and_b32 v125, 0xffff0000, v20
    v_lshlrev_b32 v126, 16, v21
    v_mul_f32 v122, v114, v122
    v_and_b32 v127, 0xffff0000, v21
    v_add_u32 v123, v123, v123
    v_pk_fma_f32 v[124:125], v[124:125], v[122:123], s[34:35] op_sel_hi:[1,0,1]
    v_pk_fma_f32 v[126:127], v[126:127], v[122:123], s[34:35] op_sel_hi:[1,0,1]
    v_lshl_add_u32 v124, v125, 16, v124
    v_lshl_add_u32 v125, v127, 16, v126
    s_waitcnt lgkmcnt(2)
    v_bitop3_b32 v115, v115, v118, v119 bitop3:0xfe
    v_lshl_add_u64 v[124:125], v[124:125], 0, s[36:37]
    v_cmpx_le_u32 vcc, 0x1000000, v58
    ds_add_rtn_u64 v[118:119], v123, v[124:125] offset:54272
    s_mov_b64 exec, -1
    v_ashrrev_i32 v122, 5, v59
    v_lshlrev_b16 v123, 2, v59
    v_lshlrev_b32 v124, 16, v22
    v_bitop3_b32 v122, v122, v113, v113 bitop3:0x0c
    v_and_b32 v125, 0xffff0000, v22
    v_lshlrev_b32 v126, 16, v23
    v_mul_f32 v122, v114, v122
    v_and_b32 v127, 0xffff0000, v23
    v_add_u32 v123, v123, v123
    v_pk_fma_f32 v[124:125], v[124:125], v[122:123], s[34:35] op_sel_hi:[1,0,1]
    v_pk_fma_f32 v[126:127], v[126:127], v[122:123], s[34:35] op_sel_hi:[1,0,1]
    v_lshl_add_u32 v124, v125, 16, v124
    v_lshl_add_u32 v125, v127, 16, v126
    s_waitcnt lgkmcnt(2)
    v_bitop3_b32 v115, v115, v120, v121 bitop3:0xfe
    v_lshl_add_u64 v[124:125], v[124:125], 0, s[36:37]
    v_cmpx_le_u32 vcc, 0x1000000, v59
    ds_add_rtn_u64 v[120:121], v123, v[124:125] offset:54272
    s_mov_b64 exec, -1
p2_nad0:
    s_waitcnt lgkmcnt(15)
    v_ashrrev_i32 v122, 5, v60
    v_lshlrev_b16 v123, 2, v60
    v_lshlrev_b32 v124, 16, v24
    v_bitop3_b32 v122, v122, v113, v113 bitop3:0x0c
    v_and_b32 v125, 0xffff0000, v24
    v_lshlrev_b32 v126, 16, v25
    v_mul_f32 v122, v114, v122
    v_and_b32 v127, 0xffff0000, v25
    v_add_u32 v123, v123, v123
    v_pk_fma_f32 v[124:125], v[124:125], v[122:123], s[34:35] op_sel_hi:[1,0,1]
    v_pk_fma_f32 v[126:127], v[126:127], v[122:123], s[34:35] op_sel_hi:[1,0,1]
    v_lshl_add_u32 v124, v125, 16, v124
    v_lshl_add_u32 v125, v127, 16, v126
    s_waitcnt lgkmcnt(2)
    v_bitop3_b32 v115, v115, v116, v117 bitop3:0xfe
    v_lshl_add_u64 v[124:125], v[124:125], 0, s[36:37]
    v_cmpx_le_u32 vcc, 0x1000000, v60
    ds_add_rtn_u64 v[116:117], v123, v[124:125] offset:54272
    s_mov_b64 exec, -1
    v_ashrrev_i32 v122, 5, v61
    v_lshlrev_b16 v123, 2, v61
    v_lshlrev_b32 v124, 16, v26
    v_bitop3_b32 v122, v122, v113, v113 bitop3:0x0c
    v_and_b32 v125, 0xffff0000, v26
    v_lshlrev_b32 v126, 16, v27
    v_mul_f32 v122, v114, v122
    v_and_b32 v127, 0xffff0000, v27
    v_add_u32 v123, v123, v123
    v_pk_fma_f32 v[124:125], v[124:125], v[122:123], s[34:35] op_sel_hi:[1,0,1]
    v_pk_fma_f32 v[126:127], v[126:127], v[122:123], s[34:35] op_sel_hi:[1,0,1]
    v_lshl_add_u32 v124, v125, 16, v124
    v_lshl_add_u32 v125, v127, 16, v126
    s_waitcnt lgkmcnt(2)
    v_bitop3_b32 v115, v115, v118, v119 bitop3:0xfe
    v_lshl_add_u64 v[124:125], v[124:125], 0, s[36:37]
    v_cmpx_le_u32 vcc, 0x1000000, v61
    ds_add_rtn_u64 v[118:119], v123, v[124:125] offset:54272
    s_mov_b64 exec, -1
    v_ashrrev_i32 v122, 5, v62
    v_lshlrev_b16 v123, 2, v62
    v_lshlrev_b32 v124, 16, v28
    v_bitop3_b32 v122, v122, v113, v113 bitop3:0x0c
    v_and_b32 v125, 0xffff0000, v28
    v_lshlrev_b32 v126, 16, v29
    v_mul_f32 v122, v114, v122
    v_and_b32 v127, 0xffff0000, v29
    v_add_u32 v123, v123, v123
    v_pk_fma_f32 v[124:125], v[124:125], v[122:123], s[34:35] op_sel_hi:[1,0,1]
    v_pk_fma_f32 v[126:127], v[126:127], v[122:123], s[34:35] op_sel_hi:[1,0,1]
    v_lshl_add_u32 v124, v125, 16, v124
    v_lshl_add_u32 v125, v127, 16, v126
    s_waitcnt lgkmcnt(2)
    v_bitop3_b32 v115, v115, v120, v121 bitop3:0xfe
    v_lshl_add_u64 v[124:125], v[124:125], 0, s[36:37]
    v_cmpx_le_u32 vcc, 0x1000000, v62
    ds_add_rtn_u64 v[120:121], v123, v[124:125] offset:54272
    s_mov_b64 exec, -1
    s_waitcnt lgkmcnt(15)
    v_ashrrev_i32 v122, 5, v63
    v_lshlrev_b16 v123, 2, v63
    v_lshlrev_b32 v124, 16, v30
    v_bitop3_b32 v122, v122, v113, v113 bitop3:0x0c
    v_and_b32 v125, 0xffff0000, v30
    v_lshlrev_b32 v126, 16, v31
    v_mul_f32 v122, v114, v122
    v_and_b32 v127, 0xffff0000, v31
    v_add_u32 v123, v123, v123
    v_pk_fma_f32 v[124:125], v[124:125], v[122:123], s[34:35] op_sel_hi:[1,0,1]
    v_pk_fma_f32 v[126:127], v[126:127], v[122:123], s[34:35] op_sel_hi:[1,0,1]
    v_lshl_add_u32 v124, v125, 16, v124
    v_lshl_add_u32 v125, v127, 16, v126
    s_waitcnt lgkmcnt(2)
    v_bitop3_b32 v115, v115, v116, v117 bitop3:0xfe
    v_lshl_add_u64 v[124:125], v[124:125], 0, s[36:37]
    v_cmpx_le_u32 vcc, 0x1000000, v63
    ds_add_rtn_u64 v[116:117], v123, v[124:125] offset:54272
    s_mov_b64 exec, -1
    v_ashrrev_i32 v122, 5, v64
    v_lshlrev_b16 v123, 2, v64
    v_lshlrev_b32 v124, 16, v32
    v_bitop3_b32 v122, v122, v113, v113 bitop3:0x0c
    v_and_b32 v125, 0xffff0000, v32
    v_lshlrev_b32 v126, 16, v33
    v_mul_f32 v122, v114, v122
    v_and_b32 v127, 0xffff0000, v33
    v_add_u32 v123, v123, v123
    v_pk_fma_f32 v[124:125], v[124:125], v[122:123], s[34:35] op_sel_hi:[1,0,1]
    v_pk_fma_f32 v[126:127], v[126:127], v[122:123], s[34:35] op_sel_hi:[1,0,1]
    v_lshl_add_u32 v124, v125, 16, v124
    v_lshl_add_u32 v125, v127, 16, v126
    s_waitcnt lgkmcnt(2)
    v_bitop3_b32 v115, v115, v118, v119 bitop3:0xfe
    v_lshl_add_u64 v[124:125], v[124:125], 0, s[36:37]
    v_cmpx_le_u32 vcc, 0x1000000, v64
    ds_add_rtn_u64 v[118:119], v123, v[124:125] offset:54272
    s_mov_b64 exec, -1
    v_ashrrev_i32 v122, 5, v65
    v_lshlrev_b16 v123, 2, v65
    v_lshlrev_b32 v124, 16, v34
    v_bitop3_b32 v122, v122, v113, v113 bitop3:0x0c
    v_and_b32 v125, 0xffff0000, v34
    v_lshlrev_b32 v126, 16, v35
    v_mul_f32 v122, v114, v122
    v_and_b32 v127, 0xffff0000, v35
    v_add_u32 v123, v123, v123
    v_pk_fma_f32 v[124:125], v[124:125], v[122:123], s[34:35] op_sel_hi:[1,0,1]
    v_pk_fma_f32 v[126:127], v[126:127], v[122:123], s[34:35] op_sel_hi:[1,0,1]
    v_lshl_add_u32 v124, v125, 16, v124
    v_lshl_add_u32 v125, v127, 16, v126
    s_waitcnt lgkmcnt(2)
    v_bitop3_b32 v115, v115, v120, v121 bitop3:0xfe
    v_lshl_add_u64 v[124:125], v[124:125], 0, s[36:37]
    v_cmpx_le_u32 vcc, 0x1000000, v65
    ds_add_rtn_u64 v[120:121], v123, v[124:125] offset:54272
    s_mov_b64 exec, -1
    s_waitcnt lgkmcnt(15)
    v_ashrrev_i32 v122, 5, v66
    v_lshlrev_b16 v123, 2, v66
    v_lshlrev_b32 v124, 16, v36
    v_bitop3_b32 v122, v122, v113, v113 bitop3:0x0c
    v_and_b32 v125, 0xffff0000, v36
    v_lshlrev_b32 v126, 16, v37
    v_mul_f32 v122, v114, v122
    v_and_b32 v127, 0xffff0000, v37
    v_add_u32 v123, v123, v123
    v_pk_fma_f32 v[124:125], v[124:125], v[122:123], s[34:35] op_sel_hi:[1,0,1]
    v_pk_fma_f32 v[126:127], v[126:127], v[122:123], s[34:35] op_sel_hi:[1,0,1]
    v_lshl_add_u32 v124, v125, 16, v124
    v_lshl_add_u32 v125, v127, 16, v126
    s_waitcnt lgkmcnt(2)
    v_bitop3_b32 v115, v115, v116, v117 bitop3:0xfe
    v_lshl_add_u64 v[124:125], v[124:125], 0, s[36:37]
    v_cmpx_le_u32 vcc, 0x1000000, v66
    ds_add_rtn_u64 v[116:117], v123, v[124:125] offset:54272
    s_mov_b64 exec, -1
    v_ashrrev_i32 v122, 5, v67
    v_lshlrev_b16 v123, 2, v67
    v_lshlrev_b32 v124, 16, v38
    v_bitop3_b32 v122, v122, v113, v113 bitop3:0x0c
    v_and_b32 v125, 0xffff0000, v38
    v_lshlrev_b32 v126, 16, v39
    v_mul_f32 v122, v114, v122
    v_and_b32 v127, 0xffff0000, v39
    v_add_u32 v123, v123, v123
    v_pk_fma_f32 v[124:125], v[124:125], v[122:123], s[34:35] op_sel_hi:[1,0,1]
    v_pk_fma_f32 v[126:127], v[126:127], v[122:123], s[34:35] op_sel_hi:[1,0,1]
    v_lshl_add_u32 v124, v125, 16, v124
    v_lshl_add_u32 v125, v127, 16, v126
    s_waitcnt lgkmcnt(2)
    v_bitop3_b32 v115, v115, v118, v119 bitop3:0xfe
    v_lshl_add_u64 v[124:125], v[124:125], 0, s[36:37]
    v_cmpx_le_u32 vcc, 0x1000000, v67
    ds_add_rtn_u64 v[118:119], v123, v[124:125] offset:54272
    s_mov_b64 exec, -1
    v_ashrrev_i32 v122, 5, v68
    v_lshlrev_b16 v123, 2, v68
    v_lshlrev_b32 v124, 16, v40
    v_bitop3_b32 v122, v122, v113, v113 bitop3:0x0c
    v_and_b32 v125, 0xffff0000, v40
    v_lshlrev_b32 v126, 16, v41
    v_mul_f32 v122, v114, v122
    v_and_b32 v127, 0xffff0000, v41
    v_add_u32 v123, v123, v123
    v_pk_fma_f32 v[124:125], v[124:125], v[122:123], s[34:35] op_sel_hi:[1,0,1]
    v_pk_fma_f32 v[126:127], v[126:127], v[122:123], s[34:35] op_sel_hi:[1,0,1]
    v_lshl_add_u32 v124, v125, 16, v124
    v_lshl_add_u32 v125, v127, 16, v126
    s_waitcnt lgkmcnt(2)
    v_bitop3_b32 v115, v115, v120, v121 bitop3:0xfe
    v_lshl_add_u64 v[124:125], v[124:125], 0, s[36:37]
    v_cmpx_le_u32 vcc, 0x1000000, v68
    ds_add_rtn_u64 v[120:121], v123, v[124:125] offset:54272
    s_mov_b64 exec, -1
    s_waitcnt lgkmcnt(15)
    v_ashrrev_i32 v122, 5, v69
    v_lshlrev_b16 v123, 2, v69
    v_lshlrev_b32 v124, 16, v42
    v_bitop3_b32 v122, v122, v113, v113 bitop3:0x0c
    v_and_b32 v125, 0xffff0000, v42
    v_lshlrev_b32 v126, 16, v43
    v_mul_f32 v122, v114, v122
    v_and_b32 v127, 0xffff0000, v43
    v_add_u32 v123, v123, v123
    v_pk_fma_f32 v[124:125], v[124:125], v[122:123], s[34:35] op_sel_hi:[1,0,1]
    v_pk_fma_f32 v[126:127], v[126:127], v[122:123], s[34:35] op_sel_hi:[1,0,1]
    v_lshl_add_u32 v124, v125, 16, v124
    v_lshl_add_u32 v125, v127, 16, v126
    s_waitcnt lgkmcnt(2)
    v_bitop3_b32 v115, v115, v116, v117 bitop3:0xfe
    v_lshl_add_u64 v[124:125], v[124:125], 0, s[36:37]
    v_cmpx_le_u32 vcc, 0x1000000, v69
    ds_add_rtn_u64 v[116:117], v123, v[124:125] offset:54272
    s_mov_b64 exec, -1
    v_ashrrev_i32 v122, 5, v70
    v_lshlrev_b16 v123, 2, v70
    v_lshlrev_b32 v124, 16, v44
    v_bitop3_b32 v122, v122, v113, v113 bitop3:0x0c
    v_and_b32 v125, 0xffff0000, v44
    v_lshlrev_b32 v126, 16, v45
    v_mul_f32 v122, v114, v122
    v_and_b32 v127, 0xffff0000, v45
    v_add_u32 v123, v123, v123
    v_pk_fma_f32 v[124:125], v[124:125], v[122:123], s[34:35] op_sel_hi:[1,0,1]
    v_pk_fma_f32 v[126:127], v[126:127], v[122:123], s[34:35] op_sel_hi:[1,0,1]
    v_lshl_add_u32 v124, v125, 16, v124
    v_lshl_add_u32 v125, v127, 16, v126
    s_waitcnt lgkmcnt(2)
    v_bitop3_b32 v115, v115, v118, v119 bitop3:0xfe
    v_lshl_add_u64 v[124:125], v[124:125], 0, s[36:37]
    v_cmpx_le_u32 vcc, 0x1000000, v70
    ds_add_rtn_u64 v[118:119], v123, v[124:125] offset:54272
    s_mov_b64 exec, -1
    v_ashrrev_i32 v122, 5, v71
    v_lshlrev_b16 v123, 2, v71
    v_lshlrev_b32 v124, 16, v46
    v_bitop3_b32 v122, v122, v113, v113 bitop3:0x0c
    v_and_b32 v125, 0xffff0000, v46
    v_lshlrev_b32 v126, 16, v47
    v_mul_f32 v122, v114, v122
    v_and_b32 v127, 0xffff0000, v47
    v_add_u32 v123, v123, v123
    v_pk_fma_f32 v[124:125], v[124:125], v[122:123], s[34:35] op_sel_hi:[1,0,1]
    v_pk_fma_f32 v[126:127], v[126:127], v[122:123], s[34:35] op_sel_hi:[1,0,1]
    v_lshl_add_u32 v124, v125, 16, v124
    v_lshl_add_u32 v125, v127, 16, v126
    s_waitcnt lgkmcnt(2)
    v_bitop3_b32 v115, v115, v120, v121 bitop3:0xfe
    v_lshl_add_u64 v[124:125], v[124:125], 0, s[36:37]
    v_cmpx_le_u32 vcc, 0x1000000, v71
    ds_add_rtn_u64 v[120:121], v123, v[124:125] offset:54272
    s_mov_b64 exec, -1
    s_branch p2_fin
p2_topf:
    s_cmp_eq_u32 s60, 10
    s_cbranch_scc1 p2_drain1
    s_setprio 3
    v_cmpx_gt_i16 vcc, 0, v48
    ds_read_b64 v[0:1], v0
    s_mov_b64 exec, -1
    v_cmpx_gt_i16 vcc, 0, v49
    ds_read_b64 v[2:3], v2
    s_mov_b64 exec, -1
    v_cmpx_gt_i16 vcc, 0, v50
    ds_read_b64 v[4:5], v4
    s_mov_b64 exec, -1
    v_cmpx_gt_i16 vcc, 0, v51
    ds_read_b64 v[6:7], v6
    s_mov_b64 exec, -1
    v_cmpx_gt_i16 vcc, 0, v52
    ds_read_b64 v[8:9], v8
    s_mov_b64 exec, -1
    v_cmpx_gt_i16 vcc, 0, v53
    ds_read_b64 v[10:11], v10
    s_mov_b64 exec, -1
    v_cmpx_gt_i16 vcc, 0, v54
    ds_read_b64 v[12:13], v12
    s_mov_b64 exec, -1
    v_cmpx_gt_i16 vcc, 0, v55
    ds_read_b64 v[14:15], v14
    s_mov_b64 exec, -1
    v_cmpx_gt_i16 vcc, 0, v56
    ds_read_b64 v[16:17], v16
    s_mov_b64 exec, -1
    s_cmp_lt_u32 s15, 8
    s_cbranch_scc1 p2_g1r23
    v_cmpx_gt_i16 vcc, 0, v57
    ds_read_b64 v[18:19], v18
    s_mov_b64 exec, -1
    v_cmpx_gt_i16 vcc, 0, v58
    ds_read_b64 v[20:21], v20
    s_mov_b64 exec, -1
    v_cmpx_gt_i16 vcc, 0, v59
    ds_read_b64 v[22:23], v22
    s_mov_b64 exec, -1
p2_g1r23:
    s_cmp_ge_u32 s10, 9
    s_cbranch_scc1 p2_nm1m0a
    v_lshrrev_b32 v84, 1, v112
    s_add_u32 s44, s20, s42
    buffer_load_dwordx2 v[84:85], v84, s[4:7], s44 offen
p2_nm1m0a:
    buffer_load_dwordx4 v[72:75], v112, s[4:7], s20 offen offset:0
    buffer_load_dwordx4 v[76:79], v112, s[4:7], s20 offen offset:1024
    buffer_load_dwordx4 v[80:83], v112, s[4:7], s20 offen offset:2048
    v_cmpx_gt_i16 vcc, 0, v60
    ds_read_b64 v[24:25], v24
    s_mov_b64 exec, -1
    v_cmpx_gt_i16 vcc, 0, v61
    ds_read_b64 v[26:27], v26
    s_mov_b64 exec, -1
    v_cmpx_gt_i16 vcc, 0, v62
    ds_read_b64 v[28:29], v28
    s_mov_b64 exec, -1
    v_cmpx_gt_i16 vcc, 0, v63
    ds_read_b64 v[30:31], v30
    s_mov_b64 exec, -1
    v_cmpx_gt_i16 vcc, 0, v64
    ds_read_b64 v[32:33], v32
    s_mov_b64 exec, -1
    v_cmpx_gt_i16 vcc, 0, v65
    ds_read_b64 v[34:35], v34
    s_mov_b64 exec, -1
    v_cmpx_gt_i16 vcc, 0, v66
    ds_read_b64 v[36:37], v36
    s_mov_b64 exec, -1
    v_cmpx_gt_i16 vcc, 0, v67
    ds_read_b64 v[38:39], v38
    s_mov_b64 exec, -1
    v_cmpx_gt_i16 vcc, 0, v68
    ds_read_b64 v[40:41], v40
    s_mov_b64 exec, -1
    v_cmpx_gt_i16 vcc, 0, v69
    ds_read_b64 v[42:43], v42
    s_mov_b64 exec, -1
    v_cmpx_gt_i16 vcc, 0, v70
    ds_read_b64 v[44:45], v44
    s_mov_b64 exec, -1
    v_cmpx_gt_i16 vcc, 0, v71
    ds_read_b64 v[46:47], v46
    s_mov_b64 exec, -1
    s_setprio 2
    s_waitcnt lgkmcnt(15)
    v_ashrrev_i32 v122, 5, v48
    v_lshlrev_b16 v123, 2, v48
    v_cndmask_b32 v126, v0, v1, s[66:67]
    v_bitop3_b32 v122, v122, v113, v113 bitop3:0x0c
    v_lshlrev_b32 v124, 16, v126
    v_mul_f32 v122, v114, v122
    v_and_b32 v125, 0xffff0000, v126
    v_add_u32 v123, v123, v123
    v_mul_f32 v124, v122, v124
    v_mul_f32 v125, v122, v125
    v_cmpx_le_u32 vcc, 0x1000000, v48
    ds_add_f32 v123, v124 offset:54272
    ds_add_f32 v123, v125 offset:54276
    s_mov_b64 exec, -1
    v_ashrrev_i32 v122, 5, v49
    v_lshlrev_b16 v123, 2, v49
    v_cndmask_b32 v126, v2, v3, s[66:67]
    v_bitop3_b32 v122, v122, v113, v113 bitop3:0x0c
    v_lshlrev_b32 v124, 16, v126
    v_mul_f32 v122, v114, v122
    v_and_b32 v125, 0xffff0000, v126
    v_add_u32 v123, v123, v123
    v_mul_f32 v124, v122, v124
    v_mul_f32 v125, v122, v125
    v_cmpx_le_u32 vcc, 0x1000000, v49
    ds_add_f32 v123, v124 offset:54272
    ds_add_f32 v123, v125 offset:54276
    s_mov_b64 exec, -1
    v_ashrrev_i32 v122, 5, v50
    v_lshlrev_b16 v123, 2, v50
    v_cndmask_b32 v126, v4, v5, s[66:67]
    v_bitop3_b32 v122, v122, v113, v113 bitop3:0x0c
    v_lshlrev_b32 v124, 16, v126
    v_mul_f32 v122, v114, v122
    v_and_b32 v125, 0xffff0000, v126
    v_add_u32 v123, v123, v123
    v_mul_f32 v124, v122, v124
    v_mul_f32 v125, v122, v125
    v_cmpx_le_u32 vcc, 0x1000000, v50
    ds_add_f32 v123, v124 offset:54272
    ds_add_f32 v123, v125 offset:54276
    s_mov_b64 exec, -1
    v_bfe_u32 v0, v102, 14, 4
    v_lshrrev_b32 v1, 18, v102
    v_and_b32 v102, 0x3fff, v102
    v_mad_u32_u24 v0, v0, s63, v1
    v_mad_u32_u24 v102, v0, s65, v102
    buffer_load_dwordx4 v[0:3], v102, s[68:71], 0 offen
    s_setprio 1
    s_waitcnt lgkmcnt(15)
    v_ashrrev_i32 v122, 5, v51
    v_lshlrev_b16 v123, 2, v51
    v_cndmask_b32 v126, v6, v7, s[66:67]
    v_bitop3_b32 v122, v122, v113, v113 bitop3:0x0c
    v_lshlrev_b32 v124, 16, v126
    v_mul_f32 v122, v114, v122
    v_and_b32 v125, 0xffff0000, v126
    v_add_u32 v123, v123, v123
    v_mul_f32 v124, v122, v124
    v_mul_f32 v125, v122, v125
    v_cmpx_le_u32 vcc, 0x1000000, v51
    ds_add_f32 v123, v124 offset:54272
    ds_add_f32 v123, v125 offset:54276
    s_mov_b64 exec, -1
    v_ashrrev_i32 v122, 5, v52
    v_lshlrev_b16 v123, 2, v52
    v_cndmask_b32 v126, v8, v9, s[66:67]
    v_bitop3_b32 v122, v122, v113, v113 bitop3:0x0c
    v_lshlrev_b32 v124, 16, v126
    v_mul_f32 v122, v114, v122
    v_and_b32 v125, 0xffff0000, v126
    v_add_u32 v123, v123, v123
    v_mul_f32 v124, v122, v124
    v_mul_f32 v125, v122, v125
    v_cmpx_le_u32 vcc, 0x1000000, v52
    ds_add_f32 v123, v124 offset:54272
    ds_add_f32 v123, v125 offset:54276
    s_mov_b64 exec, -1
    v_ashrrev_i32 v122, 5, v53
    v_lshlrev_b16 v123, 2, v53
    v_cndmask_b32 v126, v10, v11, s[66:67]
    v_bitop3_b32 v122, v122, v113, v113 bitop3:0x0c
    v_lshlrev_b32 v124, 16, v126
    v_mul_f32 v122, v114, v122
    v_and_b32 v125, 0xffff0000, v126
    v_add_u32 v123, v123, v123
    v_mul_f32 v124, v122, v124
    v_mul_f32 v125, v122, v125
    v_cmpx_le_u32 vcc, 0x1000000, v53
    ds_add_f32 v123, v124 offset:54272
    ds_add_f32 v123, v125 offset:54276
    s_mov_b64 exec, -1
    v_bfe_u32 v6, v103, 14, 4
    v_lshrrev_b32 v7, 18, v103
    v_and_b32 v103, 0x3fff, v103
    v_mad_u32_u24 v6, v6, s63, v7
    v_mad_u32_u24 v103, v6, s65, v103
    buffer_load_dwordx4 v[6:9], v103, s[68:71], 0 offen
    s_waitcnt lgkmcnt(12)
    s_barrier
    s_setprio 3
    s_waitcnt vmcnt(5)
    s_mov_b32 m0, s23
    v_mov_b32 v53, 0
    s_movk_i32 s44, 512
    v_sub_u32_sdwa v4, v111, v110 dst_sel:DWORD dst_unused:UNUSED_PAD src0_sel:WORD_0 src1_sel:WORD_0
    v_sub_u32_sdwa v5, v111, v110 dst_sel:DWORD dst_unused:UNUSED_PAD src0_sel:WORD_1 src1_sel:WORD_1
    v_med3_i32 v4, v4, 0, s44
    v_med3_i32 v5, v5, 0, s44
    v_add_u32 v48, v4, v5
    ds_write_addtid_b32 v53 offset:0
    ds_write_addtid_b32 v53 offset:256
    ds_write_addtid_b32 v53 offset:512
    ds_write_addtid_b32 v53 offset:768
    ds_write_addtid_b32 v53 offset:1024
    ds_write_addtid_b32 v53 offset:1280
    ds_write_addtid_b32 v53 offset:1536
    ds_write_addtid_b32 v53 offset:1792
    v_bfe_i32 v53, v112, 6, 1
    v_lshrrev_b32 v49, 6, v112
    v_bitop3_b32 v53, v53, 15, s10 bitop3:0x6a
    v_lshl_or_b32 v49, v49, 4, v53
    v_and_b32 v53, 0x30, v112
    v_lshl_or_b32 v53, v49, 6, v53
    v_lshlrev_b32 v53, 15, v53
    s_nop 1
    v_add_u32_dpp v48, v48, v48 row_shr:1 row_mask:0xf bank_mask:0xf bound_ctrl:0
    s_nop 1
    v_add_u32_dpp v48, v48, v48 row_shr:2 row_mask:0xf bank_mask:0xf bound_ctrl:0
    s_nop 1
    v_add_u32_dpp v48, v48, v48 row_shr:4 row_mask:0xf bank_mask:0xf bound_ctrl:0
    s_nop 1
    v_add_u32_dpp v48, v48, v48 row_shr:8 row_mask:0xf bank_mask:0xf bound_ctrl:0
    s_nop 1
    v_add_u32_dpp v48, v48, v48 row_bcast:15 row_mask:0xa bank_mask:0xf
    s_nop 1
    v_add_u32_dpp v48, v48, v48 row_bcast:31 row_mask:0xc bank_mask:0xf
    s_nop 1
    s_nop 0
    v_readlane_b32 s38, v48, 63
    v_sub_u32 v50, v48, v5
    v_sub_u32 v49, v50, v4
    v_writelane_b32 v5, 1, 63
    v_sub_u32 v10, 512, v49
    v_mad_u32_u16 v51, v110, 16, v53
    v_lshl_add_u32 v51, v10, 4, v51
    v_med3_i32 v10, v10, 0, v4
    v_lshl_add_u32 v49, v49, 2, s23
    v_sub_u32 v11, 512, v50
    v_mad_u32_u16 v52, v110, 16, v53 op_sel:[1,0,0,0]
    v_add_u32 v52, 262144, v52
    s_mov_b32 s44, 0x1fffc000
    v_writelane_b32 v52, s44, 63
    v_lshl_add_u32 v52, v11, 4, v52
    v_med3_i32 v11, v11, 0, v5
    v_lshl_add_u32 v50, v50, 2, s23
    v_lshl_add_u32 v48, v11, 16, v10
    v_add_u32 v110, v110, v48
    s_min_u32 s17, s38, 512
    s_add_u32 s17, s17, 63
    s_lshr_b32 s17, s17, 6
    v_cmpx_lt_i32 vcc, 0, v10
    ds_write_b32 v49, v51
    s_mov_b64 exec, -1
    v_cmpx_lt_i32 vcc, 0, v11
    ds_write_b32 v50, v52
    s_mov_b64 exec, -1
    s_cmp_lt_u32 s38, 512
    s_cbranch_scc1 p2_nomore1x
    v_cmp_lt_u32_sdwa s[44:45], v110, v111 src0_sel:WORD_0 src1_sel:WORD_0
    v_cmp_lt_u32_sdwa s[46:47], v110, v111 src0_sel:WORD_1 src1_sel:WORD_1
    s_nop 0
    s_or_b64 s[44:45], s[44:45], s[46:47]
    s_cbranch_scc0 p2_nomore1x
    v_mov_b32 v49, s19
    v_mov_b32 v50, 1
    ds_write_b32 v49, v50 offset:53760
p2_nomore1x:
    s_setprio 2
    s_waitcnt lgkmcnt(15)
    v_ashrrev_i32 v122, 5, v54
    v_lshlrev_b16 v123, 2, v54
    v_cndmask_b32 v126, v12, v13, s[66:67]
    v_bitop3_b32 v122, v122, v113, v113 bitop3:0x0c
    v_lshlrev_b32 v124, 16, v126
    v_mul_f32 v122, v114, v122
    v_and_b32 v125, 0xffff0000, v126
    v_add_u32 v123, v123, v123
    v_mul_f32 v124, v122, v124
    v_mul_f32 v125, v122, v125
    v_cmpx_le_u32 vcc, 0x1000000, v54
    ds_add_f32 v123, v124 offset:54272
    ds_add_f32 v123, v125 offset:54276
    s_mov_b64 exec, -1
    v_ashrrev_i32 v122, 5, v55
    v_lshlrev_b16 v123, 2, v55
    v_cndmask_b32 v126, v14, v15, s[66:67]
    v_bitop3_b32 v122, v122, v113, v113 bitop3:0x0c
    v_lshlrev_b32 v124, 16, v126
    v_mul_f32 v122, v114, v122
    v_and_b32 v125, 0xffff0000, v126
    v_add_u32 v123, v123, v123
    v_mul_f32 v124, v122, v124
    v_mul_f32 v125, v122, v125
    v_cmpx_le_u32 vcc, 0x1000000, v55
    ds_add_f32 v123, v124 offset:54272
    ds_add_f32 v123, v125 offset:54276
    s_mov_b64 exec, -1
    v_ashrrev_i32 v122, 5, v56
    v_lshlrev_b16 v123, 2, v56
    v_cndmask_b32 v126, v16, v17, s[66:67]
    v_bitop3_b32 v122, v122, v113, v113 bitop3:0x0c
    v_lshlrev_b32 v124, 16, v126
    v_mul_f32 v122, v114, v122
    v_and_b32 v125, 0xffff0000, v126
    v_add_u32 v123, v123, v123
    v_mul_f32 v124, v122, v124
    v_mul_f32 v125, v122, v125
    v_cmpx_le_u32 vcc, 0x1000000, v56
    ds_add_f32 v123, v124 offset:54272
    ds_add_f32 v123, v125 offset:54276
    s_mov_b64 exec, -1
    v_bfe_u32 v12, v104, 14, 4
    v_lshrrev_b32 v13, 18, v104
    v_and_b32 v104, 0x3fff, v104
    v_mad_u32_u24 v12, v12, s63, v13
    v_mad_u32_u24 v104, v12, s65, v104
    buffer_load_dwordx4 v[12:15], v104, s[68:71], 0 offen
    s_cmp_lt_u32 s15, 8
    s_cbranch_scc1 p2_na1a3
    s_waitcnt lgkmcnt(15)
    v_ashrrev_i32 v122, 5, v57
    v_lshlrev_b16 v123, 2, v57
    v_cndmask_b32 v126, v18, v19, s[66:67]
    v_bitop3_b32 v122, v122, v113, v113 bitop3:0x0c
    v_lshlrev_b32 v124, 16, v126
    v_mul_f32 v122, v114, v122
    v_and_b32 v125, 0xffff0000, v126
    v_add_u32 v123, v123, v123
    v_mul_f32 v124, v122, v124
    v_mul_f32 v125, v122, v125
    v_cmpx_le_u32 vcc, 0x1000000, v57
    ds_add_f32 v123, v124 offset:54272
    ds_add_f32 v123, v125 offset:54276
    s_mov_b64 exec, -1
    v_ashrrev_i32 v122, 5, v58
    v_lshlrev_b16 v123, 2, v58
    v_cndmask_b32 v126, v20, v21, s[66:67]
    v_bitop3_b32 v122, v122, v113, v113 bitop3:0x0c
    v_lshlrev_b32 v124, 16, v126
    v_mul_f32 v122, v114, v122
    v_and_b32 v125, 0xffff0000, v126
    v_add_u32 v123, v123, v123
    v_mul_f32 v124, v122, v124
    v_mul_f32 v125, v122, v125
    v_cmpx_le_u32 vcc, 0x1000000, v58
    ds_add_f32 v123, v124 offset:54272
    ds_add_f32 v123, v125 offset:54276
    s_mov_b64 exec, -1
    v_ashrrev_i32 v122, 5, v59
    v_lshlrev_b16 v123, 2, v59
    v_cndmask_b32 v126, v22, v23, s[66:67]
    v_bitop3_b32 v122, v122, v113, v113 bitop3:0x0c
    v_lshlrev_b32 v124, 16, v126
    v_mul_f32 v122, v114, v122
    v_and_b32 v125, 0xffff0000, v126
    v_add_u32 v123, v123, v123
    v_mul_f32 v124, v122, v124
    v_mul_f32 v125, v122, v125
    v_cmpx_le_u32 vcc, 0x1000000, v59
    ds_add_f32 v123, v124 offset:54272
    ds_add_f32 v123, v125 offset:54276
    s_mov_b64 exec, -1
p2_na1a3:
    v_bfe_u32 v18, v105, 14, 4
    v_lshrrev_b32 v19, 18, v105
    v_and_b32 v105, 0x3fff, v105
    v_mad_u32_u24 v18, v18, s63, v19
    v_mad_u32_u24 v105, v18, s65, v105
    buffer_load_dwordx4 v[18:21], v105, s[68:71], 0 offen
    s_mov_b32 m0, s23
    s_nop 0
    ds_read_addtid_b32 v102 offset:1024
    ds_read_addtid_b32 v103 offset:1280
    ds_read_addtid_b32 v104 offset:1536
    ds_read_addtid_b32 v105 offset:1792
    ds_read_addtid_b32 v106 offset:0
    ds_read_addtid_b32 v107 offset:256
    ds_read_addtid_b32 v108 offset:512
    ds_read_addtid_b32 v109 offset:768
    s_waitcnt vmcnt(4)
    s_mov_b32 m0, s24
    s_cmp_ge_u32 s10, 9
    s_cbranch_scc1 p2_st1s0
    ds_write_addtid_b32 v84 offset:49152
    ds_write_addtid_b32 v85 offset:49408
p2_st1s0:
    s_mov_b32 m0, s23
    s_add_u32 s20, s20, 53760
    ds_write_addtid_b32 v72 offset:0
    ds_write_addtid_b32 v73 offset:256
    ds_write_addtid_b32 v74 offset:512
    ds_write_addtid_b32 v75 offset:768
    ds_write_addtid_b32 v76 offset:1024
    ds_write_addtid_b32 v77 offset:1280
    ds_write_addtid_b32 v78 offset:1536
    ds_write_addtid_b32 v79 offset:1792
    ds_write_addtid_b32 v80 offset:2048
    ds_write_addtid_b32 v81 offset:2304
    ds_write_addtid_b32 v82 offset:2560
    ds_write_addtid_b32 v83 offset:2816
    s_setprio 1
    s_waitcnt lgkmcnt(15)
    v_ashrrev_i32 v122, 5, v60
    v_lshlrev_b16 v123, 2, v60
    v_cndmask_b32 v126, v24, v25, s[66:67]
    v_bitop3_b32 v122, v122, v113, v113 bitop3:0x0c
    v_lshlrev_b32 v124, 16, v126
    v_mul_f32 v122, v114, v122
    v_and_b32 v125, 0xffff0000, v126
    v_add_u32 v123, v123, v123
    v_mul_f32 v124, v122, v124
    v_mul_f32 v125, v122, v125
    v_cmpx_le_u32 vcc, 0x1000000, v60
    ds_add_f32 v123, v124 offset:54272
    ds_add_f32 v123, v125 offset:54276
    s_mov_b64 exec, -1
    v_ashrrev_i32 v122, 5, v61
    v_lshlrev_b16 v123, 2, v61
    v_cndmask_b32 v126, v26, v27, s[66:67]
    v_bitop3_b32 v122, v122, v113, v113 bitop3:0x0c
    v_lshlrev_b32 v124, 16, v126
    v_mul_f32 v122, v114, v122
    v_and_b32 v125, 0xffff0000, v126
    v_add_u32 v123, v123, v123
    v_mul_f32 v124, v122, v124
    v_mul_f32 v125, v122, v125
    v_cmpx_le_u32 vcc, 0x1000000, v61
    ds_add_f32 v123, v124 offset:54272
    ds_add_f32 v123, v125 offset:54276
    s_mov_b64 exec, -1
    v_ashrrev_i32 v122, 5, v62
    v_lshlrev_b16 v123, 2, v62
    v_cndmask_b32 v126, v28, v29, s[66:67]
    v_bitop3_b32 v122, v122, v113, v113 bitop3:0x0c
    v_lshlrev_b32 v124, 16, v126
    v_mul_f32 v122, v114, v122
    v_and_b32 v125, 0xffff0000, v126
    v_add_u32 v123, v123, v123
    v_mul_f32 v124, v122, v124
    v_mul_f32 v125, v122, v125
    v_cmpx_le_u32 vcc, 0x1000000, v62
    ds_add_f32 v123, v124 offset:54272
    ds_add_f32 v123, v125 offset:54276
    s_mov_b64 exec, -1
    s_waitcnt vmcnt(16)
    v_perm_b32 v60, v89, v86, s31
    v_perm_b32 v61, v89, v87, s32
    v_perm_b32 v62, v89, v88, s33
    v_lshlrev_b16 v28, 3, v88
    v_lshlrev_b16 v26, 3, v87
    v_lshlrev_b16 v24, 3, v86
    s_waitcnt lgkmcnt(15)
    s_nop 2
    s_nop 1
    v_max_u32_dpp v106, v106, v106 row_shr:1 row_mask:0xf bank_mask:0xf bound_ctrl:0
    v_max_u32_dpp v107, v107, v107 row_shr:1 row_mask:0xf bank_mask:0xf bound_ctrl:0
    s_nop 0
    v_max_u32_dpp v106, v106, v106 row_shr:2 row_mask:0xf bank_mask:0xf bound_ctrl:0
    v_max_u32_dpp v107, v107, v107 row_shr:2 row_mask:0xf bank_mask:0xf bound_ctrl:0
    s_nop 0
    v_max_u32_dpp v106, v106, v106 row_shr:4 row_mask:0xf bank_mask:0xf bound_ctrl:0
    v_max_u32_dpp v107, v107, v107 row_shr:4 row_mask:0xf bank_mask:0xf bound_ctrl:0
    s_nop 0
    v_max_u32_dpp v106, v106, v106 row_shr:8 row_mask:0xf bank_mask:0xf bound_ctrl:0
    v_max_u32_dpp v107, v107, v107 row_shr:8 row_mask:0xf bank_mask:0xf bound_ctrl:0
    s_nop 0
    v_max_u32_dpp v106, v106, v106 row_bcast:15 row_mask:0xa bank_mask:0xf
    v_max_u32_dpp v107, v107, v107 row_bcast:15 row_mask:0xa bank_mask:0xf
    s_nop 0
    v_max_u32_dpp v106, v106, v106 row_bcast:31 row_mask:0xc bank_mask:0xf
    v_max_u32_dpp v107, v107, v107 row_bcast:31 row_mask:0xc bank_mask:0xf
    s_nop 0
    s_nop 0
    v_readlane_b32 s41, v106, 63
    v_add_u32 v106, v106, v112
    v_add_u32 v106, 4294959104, v106
    v_max_u32 v107, s41, v107
    s_nop 0
    v_readlane_b32 s41, v107, 63
    v_add_u32 v107, v107, v112
    v_add_u32 v107, 4294960128, v107
    v_bfe_u32 v86, v106, 14, 4
    v_lshrrev_b32 v87, 18, v106
    v_and_b32 v106, 0x3fff, v106
    v_mad_u32_u24 v86, v86, s63, v87
    v_mad_u32_u24 v106, v86, s65, v106
    buffer_load_dwordx4 v[86:89], v106, s[68:71], 0 offen
    s_setprio 0
    s_waitcnt lgkmcnt(15)
    v_ashrrev_i32 v122, 5, v63
    v_lshlrev_b16 v123, 2, v63
    v_cndmask_b32 v126, v30, v31, s[66:67]
    v_bitop3_b32 v122, v122, v113, v113 bitop3:0x0c
    v_lshlrev_b32 v124, 16, v126
    v_mul_f32 v122, v114, v122
    v_and_b32 v125, 0xffff0000, v126
    v_add_u32 v123, v123, v123
    v_mul_f32 v124, v122, v124
    v_mul_f32 v125, v122, v125
    v_cmpx_le_u32 vcc, 0x1000000, v63
    ds_add_f32 v123, v124 offset:54272
    ds_add_f32 v123, v125 offset:54276
    s_mov_b64 exec, -1
    v_ashrrev_i32 v122, 5, v64
    v_lshlrev_b16 v123, 2, v64
    v_cndmask_b32 v126, v32, v33, s[66:67]
    v_bitop3_b32 v122, v122, v113, v113 bitop3:0x0c
    v_lshlrev_b32 v124, 16, v126
    v_mul_f32 v122, v114, v122
    v_and_b32 v125, 0xffff0000, v126
    v_add_u32 v123, v123, v123
    v_mul_f32 v124, v122, v124
    v_mul_f32 v125, v122, v125
    v_cmpx_le_u32 vcc, 0x1000000, v64
    ds_add_f32 v123, v124 offset:54272
    ds_add_f32 v123, v125 offset:54276
    s_mov_b64 exec, -1
    v_ashrrev_i32 v122, 5, v65
    v_lshlrev_b16 v123, 2, v65
    v_cndmask_b32 v126, v34, v35, s[66:67]
    v_bitop3_b32 v122, v122, v113, v113 bitop3:0x0c
    v_lshlrev_b32 v124, 16, v126
    v_mul_f32 v122, v114, v122
    v_and_b32 v125, 0xffff0000, v126
    v_add_u32 v123, v123, v123
    v_mul_f32 v124, v122, v124
    v_mul_f32 v125, v122, v125
    v_cmpx_le_u32 vcc, 0x1000000, v65
    ds_add_f32 v123, v124 offset:54272
    ds_add_f32 v123, v125 offset:54276
    s_mov_b64 exec, -1
    s_waitcnt vmcnt(13)
    v_perm_b32 v63, v93, v90, s31
    v_perm_b32 v64, v93, v91, s32
    v_perm_b32 v65, v93, v92, s33
    v_lshlrev_b16 v34, 3, v92
    v_lshlrev_b16 v32, 3, v91
    v_lshlrev_b16 v30, 3, v90
    s_waitcnt lgkmcnt(12)
    s_barrier
    s_setprio 3
    s_cmp_ge_u32 s10, 9
    s_cbranch_scc1 p2_nm1m1a
    v_lshrrev_b32 v84, 1, v112
    s_add_u32 s44, s20, s42
    buffer_load_dwordx2 v[84:85], v84, s[4:7], s44 offen
p2_nm1m1a:
    buffer_load_dwordx4 v[72:75], v112, s[4:7], s20 offen offset:0
    buffer_load_dwordx4 v[76:79], v112, s[4:7], s20 offen offset:1024
    buffer_load_dwordx4 v[80:83], v112, s[4:7], s20 offen offset:2048
    v_cmpx_ge_u16 vcc, 0x3fff, v60
    ds_read_b64 v[24:25], v24
    s_mov_b64 exec, -1
    v_cmpx_ge_u16 vcc, 0x3fff, v61
    ds_read_b64 v[26:27], v26
    s_mov_b64 exec, -1
    v_cmpx_ge_u16 vcc, 0x3fff, v62
    ds_read_b64 v[28:29], v28
    s_mov_b64 exec, -1
    v_cmpx_ge_u16 vcc, 0x3fff, v63
    ds_read_b64 v[30:31], v30
    s_mov_b64 exec, -1
    v_cmpx_ge_u16 vcc, 0x3fff, v64
    ds_read_b64 v[32:33], v32
    s_mov_b64 exec, -1
    v_cmpx_ge_u16 vcc, 0x3fff, v65
    ds_read_b64 v[34:35], v34
    s_mov_b64 exec, -1
    s_setprio 2
    s_waitcnt lgkmcnt(15)
    v_ashrrev_i32 v122, 5, v66
    v_lshlrev_b16 v123, 2, v66
    v_cndmask_b32 v126, v36, v37, s[66:67]
    v_bitop3_b32 v122, v122, v113, v113 bitop3:0x0c
    v_lshlrev_b32 v124, 16, v126
    v_mul_f32 v122, v114, v122
    v_and_b32 v125, 0xffff0000, v126
    v_add_u32 v123, v123, v123
    v_mul_f32 v124, v122, v124
    v_mul_f32 v125, v122, v125
    v_cmpx_le_u32 vcc, 0x1000000, v66
    ds_add_f32 v123, v124 offset:54272
    ds_add_f32 v123, v125 offset:54276
    s_mov_b64 exec, -1
    v_ashrrev_i32 v122, 5, v67
    v_lshlrev_b16 v123, 2, v67
    v_cndmask_b32 v126, v38, v39, s[66:67]
    v_bitop3_b32 v122, v122, v113, v113 bitop3:0x0c
    v_lshlrev_b32 v124, 16, v126
    v_mul_f32 v122, v114, v122
    v_and_b32 v125, 0xffff0000, v126
    v_add_u32 v123, v123, v123
    v_mul_f32 v124, v122, v124
    v_mul_f32 v125, v122, v125
    v_cmpx_le_u32 vcc, 0x1000000, v67
    ds_add_f32 v123, v124 offset:54272
    ds_add_f32 v123, v125 offset:54276
    s_mov_b64 exec, -1
    v_ashrrev_i32 v122, 5, v68
    v_lshlrev_b16 v123, 2, v68
    v_cndmask_b32 v126, v40, v41, s[66:67]
    v_bitop3_b32 v122, v122, v113, v113 bitop3:0x0c
    v_lshlrev_b32 v124, 16, v126
    v_mul_f32 v122, v114, v122
    v_and_b32 v125, 0xffff0000, v126
    v_add_u32 v123, v123, v123
    v_mul_f32 v124, v122, v124
    v_mul_f32 v125, v122, v125
    v_cmpx_le_u32 vcc, 0x1000000, v68
    ds_add_f32 v123, v124 offset:54272
    ds_add_f32 v123, v125 offset:54276
    s_mov_b64 exec, -1
    s_waitcnt vmcnt(15)
    v_perm_b32 v66, v97, v94, s31
    v_perm_b32 v67, v97, v95, s32
    v_perm_b32 v68, v97, v96, s33
    v_lshlrev_b16 v40, 3, v96
    v_lshlrev_b16 v38, 3, v95
    v_lshlrev_b16 v36, 3, v94
    v_cmpx_ge_u16 vcc, 0x3fff, v66
    ds_read_b64 v[36:37], v36
    s_mov_b64 exec, -1
    v_cmpx_ge_u16 vcc, 0x3fff, v67
    ds_read_b64 v[38:39], v38
    s_mov_b64 exec, -1
    v_cmpx_ge_u16 vcc, 0x3fff, v68
    ds_read_b64 v[40:41], v40
    s_mov_b64 exec, -1
    v_bfe_u32 v90, v107, 14, 4
    v_lshrrev_b32 v91, 18, v107
    v_and_b32 v107, 0x3fff, v107
    v_mad_u32_u24 v90, v90, s63, v91
    v_mad_u32_u24 v107, v90, s65, v107
    buffer_load_dwordx4 v[90:93], v107, s[68:71], 0 offen
    s_setprio 1
    s_waitcnt lgkmcnt(15)
    v_ashrrev_i32 v122, 5, v69
    v_lshlrev_b16 v123, 2, v69
    v_cndmask_b32 v126, v42, v43, s[66:67]
    v_bitop3_b32 v122, v122, v113, v113 bitop3:0x0c
    v_lshlrev_b32 v124, 16, v126
    v_mul_f32 v122, v114, v122
    v_and_b32 v125, 0xffff0000, v126
    v_add_u32 v123, v123, v123
    v_mul_f32 v124, v122, v124
    v_mul_f32 v125, v122, v125
    v_cmpx_le_u32 vcc, 0x1000000, v69
    ds_add_f32 v123, v124 offset:54272
    ds_add_f32 v123, v125 offset:54276
    s_mov_b64 exec, -1
    v_ashrrev_i32 v122, 5, v70
    v_lshlrev_b16 v123, 2, v70
    v_cndmask_b32 v126, v44, v45, s[66:67]
    v_bitop3_b32 v122, v122, v113, v113 bitop3:0x0c
    v_lshlrev_b32 v124, 16, v126
    v_mul_f32 v122, v114, v122
    v_and_b32 v125, 0xffff0000, v126
    v_add_u32 v123, v123, v123
    v_mul_f32 v124, v122, v124
    v_mul_f32 v125, v122, v125
    v_cmpx_le_u32 vcc, 0x1000000, v70
    ds_add_f32 v123, v124 offset:54272
    ds_add_f32 v123, v125 offset:54276
    s_mov_b64 exec, -1
    v_ashrrev_i32 v122, 5, v71
    v_lshlrev_b16 v123, 2, v71
    v_cndmask_b32 v126, v46, v47, s[66:67]
    v_bitop3_b32 v122, v122, v113, v113 bitop3:0x0c
    v_lshlrev_b32 v124, 16, v126
    v_mul_f32 v122, v114, v122
    v_and_b32 v125, 0xffff0000, v126
    v_add_u32 v123, v123, v123
    v_mul_f32 v124, v122, v124
    v_mul_f32 v125, v122, v125
    v_cmpx_le_u32 vcc, 0x1000000, v71
    ds_add_f32 v123, v124 offset:54272
    ds_add_f32 v123, v125 offset:54276
    s_mov_b64 exec, -1
    s_waitcnt vmcnt(12)
    v_perm_b32 v69, v101, v98, s31
    v_perm_b32 v70, v101, v99, s32
    v_perm_b32 v71, v101, v100, s33
    v_lshlrev_b16 v46, 3, v100
    v_lshlrev_b16 v44, 3, v99
    v_lshlrev_b16 v42, 3, v98
    v_cmpx_ge_u16 vcc, 0x3fff, v69
    ds_read_b64 v[42:43], v42
    s_mov_b64 exec, -1
    v_cmpx_ge_u16 vcc, 0x3fff, v70
    ds_read_b64 v[44:45], v44
    s_mov_b64 exec, -1
    v_cmpx_ge_u16 vcc, 0x3fff, v71
    ds_read_b64 v[46:47], v46
    s_mov_b64 exec, -1
    s_waitcnt lgkmcnt(15)
    s_nop 2
    s_nop 1
    v_max_u32_dpp v108, v108, v108 row_shr:1 row_mask:0xf bank_mask:0xf bound_ctrl:0
    v_max_u32_dpp v109, v109, v109 row_shr:1 row_mask:0xf bank_mask:0xf bound_ctrl:0
    s_nop 0
    v_max_u32_dpp v108, v108, v108 row_shr:2 row_mask:0xf bank_mask:0xf bound_ctrl:0
    v_max_u32_dpp v109, v109, v109 row_shr:2 row_mask:0xf bank_mask:0xf bound_ctrl:0
    s_nop 0
    v_max_u32_dpp v108, v108, v108 row_shr:4 row_mask:0xf bank_mask:0xf bound_ctrl:0
    v_max_u32_dpp v109, v109, v109 row_shr:4 row_mask:0xf bank_mask:0xf bound_ctrl:0
    s_nop 0
    v_max_u32_dpp v108, v108, v108 row_shr:8 row_mask:0xf bank_mask:0xf bound_ctrl:0
    v_max_u32_dpp v109, v109, v109 row_shr:8 row_mask:0xf bank_mask:0xf bound_ctrl:0
    s_nop 0
    v_max_u32_dpp v108, v108, v108 row_bcast:15 row_mask:0xa bank_mask:0xf
    v_max_u32_dpp v109, v109, v109 row_bcast:15 row_mask:0xa bank_mask:0xf
    s_nop 0
    v_max_u32_dpp v108, v108, v108 row_bcast:31 row_mask:0xc bank_mask:0xf
    v_max_u32_dpp v109, v109, v109 row_bcast:31 row_mask:0xc bank_mask:0xf
    s_nop 0
    s_nop 0
    v_max_u32 v108, s41, v108
    s_nop 0
    v_readlane_b32 s41, v108, 63
    v_add_u32 v108, v108, v112
    v_add_u32 v108, 4294961152, v108
    v_max_u32 v109, s41, v109
    s_nop 0
    v_readlane_b32 s41, v109, 63
    v_add_u32 v109, v109, v112
    v_add_u32 v109, 4294962176, v109
    v_bfe_u32 v94, v108, 14, 4
    v_lshrrev_b32 v95, 18, v108
    v_and_b32 v108, 0x3fff, v108
    v_mad_u32_u24 v94, v94, s63, v95
    v_mad_u32_u24 v108, v94, s65, v108
    buffer_load_dwordx4 v[94:97], v108, s[68:71], 0 offen
    s_setprio 0
    s_waitcnt vmcnt(9)
    v_perm_b32 v48, v3, v0, s31
    v_perm_b32 v49, v3, v1, s32
    v_perm_b32 v50, v3, v2, s33
    v_lshlrev_b16 v4, 3, v2
    v_lshlrev_b16 v2, 3, v1
    v_lshlrev_b16 v0, 3, v0
    v_cmpx_ge_u16 vcc, 0x3fff, v48
    ds_read_b64 v[0:1], v0
    s_mov_b64 exec, -1
    v_cmpx_ge_u16 vcc, 0x3fff, v49
    ds_read_b64 v[2:3], v2
    s_mov_b64 exec, -1
    v_cmpx_ge_u16 vcc, 0x3fff, v50
    ds_read_b64 v[4:5], v4
    s_mov_b64 exec, -1
    s_waitcnt vmcnt(8)
    v_perm_b32 v51, v9, v6, s31
    v_perm_b32 v52, v9, v7, s32
    v_perm_b32 v53, v9, v8, s33
    v_lshlrev_b16 v10, 3, v8
    v_lshlrev_b16 v8, 3, v7
    v_lshlrev_b16 v6, 3, v6
    v_cmpx_ge_u16 vcc, 0x3fff, v51
    ds_read_b64 v[6:7], v6
    s_mov_b64 exec, -1
    v_cmpx_ge_u16 vcc, 0x3fff, v52
    ds_read_b64 v[8:9], v8
    s_mov_b64 exec, -1
    v_cmpx_ge_u16 vcc, 0x3fff, v53
    ds_read_b64 v[10:11], v10
    s_mov_b64 exec, -1
    s_waitcnt vmcnt(7)
    v_perm_b32 v54, v15, v12, s31
    v_perm_b32 v55, v15, v13, s32
    v_perm_b32 v56, v15, v14, s33
    v_lshlrev_b16 v16, 3, v14
    v_lshlrev_b16 v14, 3, v13
    v_lshlrev_b16 v12, 3, v12
    v_cmpx_ge_u16 vcc, 0x3fff, v54
    ds_read_b64 v[12:13], v12
    s_mov_b64 exec, -1
    v_cmpx_ge_u16 vcc, 0x3fff, v55
    ds_read_b64 v[14:15], v14
    s_mov_b64 exec, -1
    v_cmpx_ge_u16 vcc, 0x3fff, v56
    ds_read_b64 v[16:17], v16
    s_mov_b64 exec, -1
    s_waitcnt vmcnt(6)
    v_perm_b32 v57, v21, v18, s31
    v_perm_b32 v58, v21, v19, s32
    v_perm_b32 v59, v21, v20, s33
    v_lshlrev_b16 v22, 3, v20
    v_lshlrev_b16 v20, 3, v19
    v_lshlrev_b16 v18, 3, v18
    s_cmp_lt_u32 s16, 8
    s_cbranch_scc1 p2_g1r03
    v_cmpx_ge_u16 vcc, 0x3fff, v57
    ds_read_b64 v[18:19], v18
    s_mov_b64 exec, -1
    v_cmpx_ge_u16 vcc, 0x3fff, v58
    ds_read_b64 v[20:21], v20
    s_mov_b64 exec, -1
    v_cmpx_ge_u16 vcc, 0x3fff, v59
    ds_read_b64 v[22:23], v22
    s_mov_b64 exec, -1
p2_g1r03:
    s_waitcnt lgkmcnt(0)
    s_barrier
    s_waitcnt lgkmcnt(15)
    s_branch p2_tail
p2_drain1:
    v_cmpx_gt_i16 vcc, 0, v48
    ds_read_b64 v[0:1], v0
    s_mov_b64 exec, -1
    v_cmpx_gt_i16 vcc, 0, v49
    ds_read_b64 v[2:3], v2
    s_mov_b64 exec, -1
    v_cmpx_gt_i16 vcc, 0, v50
    ds_read_b64 v[4:5], v4
    s_mov_b64 exec, -1
    v_cmpx_gt_i16 vcc, 0, v51
    ds_read_b64 v[6:7], v6
    s_mov_b64 exec, -1
    v_cmpx_gt_i16 vcc, 0, v52
    ds_read_b64 v[8:9], v8
    s_mov_b64 exec, -1
    v_cmpx_gt_i16 vcc, 0, v53
    ds_read_b64 v[10:11], v10
    s_mov_b64 exec, -1
    v_cmpx_gt_i16 vcc, 0, v54
    ds_read_b64 v[12:13], v12
    s_mov_b64 exec, -1
    v_cmpx_gt_i16 vcc, 0, v55
    ds_read_b64 v[14:15], v14
    s_mov_b64 exec, -1
    v_cmpx_gt_i16 vcc, 0, v56
    ds_read_b64 v[16:17], v16
    s_mov_b64 exec, -1
    s_cmp_lt_u32 s15, 8
    s_cbranch_scc1 p2_gd1
    v_cmpx_gt_i16 vcc, 0, v57
    ds_read_b64 v[18:19], v18
    s_mov_b64 exec, -1
    v_cmpx_gt_i16 vcc, 0, v58
    ds_read_b64 v[20:21], v20
    s_mov_b64 exec, -1
    v_cmpx_gt_i16 vcc, 0, v59
    ds_read_b64 v[22:23], v22
    s_mov_b64 exec, -1
p2_gd1:
    v_cmpx_gt_i16 vcc, 0, v60
    ds_read_b64 v[24:25], v24
    s_mov_b64 exec, -1
    v_cmpx_gt_i16 vcc, 0, v61
    ds_read_b64 v[26:27], v26
    s_mov_b64 exec, -1
    v_cmpx_gt_i16 vcc, 0, v62
    ds_read_b64 v[28:29], v28
    s_mov_b64 exec, -1
    v_cmpx_gt_i16 vcc, 0, v63
    ds_read_b64 v[30:31], v30
    s_mov_b64 exec, -1
    v_cmpx_gt_i16 vcc, 0, v64
    ds_read_b64 v[32:33], v32
    s_mov_b64 exec, -1
    v_cmpx_gt_i16 vcc, 0, v65
    ds_read_b64 v[34:35], v34
    s_mov_b64 exec, -1
    v_cmpx_gt_i16 vcc, 0, v66
    ds_read_b64 v[36:37], v36
    s_mov_b64 exec, -1
    v_cmpx_gt_i16 vcc, 0, v67
    ds_read_b64 v[38:39], v38
    s_mov_b64 exec, -1
    v_cmpx_gt_i16 vcc, 0, v68
    ds_read_b64 v[40:41], v40
    s_mov_b64 exec, -1
    v_cmpx_gt_i16 vcc, 0, v69
    ds_read_b64 v[42:43], v42
    s_mov_b64 exec, -1
    v_cmpx_gt_i16 vcc, 0, v70
    ds_read_b64 v[44:45], v44
    s_mov_b64 exec, -1
    v_cmpx_gt_i16 vcc, 0, v71
    ds_read_b64 v[46:47], v46
    s_mov_b64 exec, -1
    s_waitcnt lgkmcnt(15)
    v_ashrrev_i32 v122, 5, v48
    v_lshlrev_b16 v123, 2, v48
    v_cndmask_b32 v126, v0, v1, s[66:67]
    v_bitop3_b32 v122, v122, v113, v113 bitop3:0x0c
    v_lshlrev_b32 v124, 16, v126
    v_mul_f32 v122, v114, v122
    v_and_b32 v125, 0xffff0000, v126
    v_add_u32 v123, v123, v123
    v_mul_f32 v124, v122, v124
    v_mul_f32 v125, v122, v125
    v_cmpx_le_u32 vcc, 0x1000000, v48
    ds_add_f32 v123, v124 offset:54272
    ds_add_f32 v123, v125 offset:54276
    s_mov_b64 exec, -1
    v_ashrrev_i32 v122, 5, v49
    v_lshlrev_b16 v123, 2, v49
    v_cndmask_b32 v126, v2, v3, s[66:67]
    v_bitop3_b32 v122, v122, v113, v113 bitop3:0x0c
    v_lshlrev_b32 v124, 16, v126
    v_mul_f32 v122, v114, v122
    v_and_b32 v125, 0xffff0000, v126
    v_add_u32 v123, v123, v123
    v_mul_f32 v124, v122, v124
    v_mul_f32 v125, v122, v125
    v_cmpx_le_u32 vcc, 0x1000000, v49
    ds_add_f32 v123, v124 offset:54272
    ds_add_f32 v123, v125 offset:54276
    s_mov_b64 exec, -1
    v_ashrrev_i32 v122, 5, v50
    v_lshlrev_b16 v123, 2, v50
    v_cndmask_b32 v126, v4, v5, s[66:67]
    v_bitop3_b32 v122, v122, v113, v113 bitop3:0x0c
    v_lshlrev_b32 v124, 16, v126
    v_mul_f32 v122, v114, v122
    v_and_b32 v125, 0xffff0000, v126
    v_add_u32 v123, v123, v123
    v_mul_f32 v124, v122, v124
    v_mul_f32 v125, v122, v125
    v_cmpx_le_u32 vcc, 0x1000000, v50
    ds_add_f32 v123, v124 offset:54272
    ds_add_f32 v123, v125 offset:54276
    s_mov_b64 exec, -1
    s_waitcnt lgkmcnt(15)
    v_ashrrev_i32 v122, 5, v51
    v_lshlrev_b16 v123, 2, v51
    v_cndmask_b32 v126, v6, v7, s[66:67]
    v_bitop3_b32 v122, v122, v113, v113 bitop3:0x0c
    v_lshlrev_b32 v124, 16, v126
    v_mul_f32 v122, v114, v122
    v_and_b32 v125, 0xffff0000, v126
    v_add_u32 v123, v123, v123
    v_mul_f32 v124, v122, v124
    v_mul_f32 v125, v122, v125
    v_cmpx_le_u32 vcc, 0x1000000, v51
    ds_add_f32 v123, v124 offset:54272
    ds_add_f32 v123, v125 offset:54276
    s_mov_b64 exec, -1
    v_ashrrev_i32 v122, 5, v52
    v_lshlrev_b16 v123, 2, v52
    v_cndmask_b32 v126, v8, v9, s[66:67]
    v_bitop3_b32 v122, v122, v113, v113 bitop3:0x0c
    v_lshlrev_b32 v124, 16, v126
    v_mul_f32 v122, v114, v122
    v_and_b32 v125, 0xffff0000, v126
    v_add_u32 v123, v123, v123
    v_mul_f32 v124, v122, v124
    v_mul_f32 v125, v122, v125
    v_cmpx_le_u32 vcc, 0x1000000, v52
    ds_add_f32 v123, v124 offset:54272
    ds_add_f32 v123, v125 offset:54276
    s_mov_b64 exec, -1
    v_ashrrev_i32 v122, 5, v53
    v_lshlrev_b16 v123, 2, v53
    v_cndmask_b32 v126, v10, v11, s[66:67]
    v_bitop3_b32 v122, v122, v113, v113 bitop3:0x0c
    v_lshlrev_b32 v124, 16, v126
    v_mul_f32 v122, v114, v122
    v_and_b32 v125, 0xffff0000, v126
    v_add_u32 v123, v123, v123
    v_mul_f32 v124, v122, v124
    v_mul_f32 v125, v122, v125
    v_cmpx_le_u32 vcc, 0x1000000, v53
    ds_add_f32 v123, v124 offset:54272
    ds_add_f32 v123, v125 offset:54276
    s_mov_b64 exec, -1
    s_waitcnt lgkmcnt(15)
    v_ashrrev_i32 v122, 5, v54
    v_lshlrev_b16 v123, 2, v54
    v_cndmask_b32 v126, v12, v13, s[66:67]
    v_bitop3_b32 v122, v122, v113, v113 bitop3:0x0c
    v_lshlrev_b32 v124, 16, v126
    v_mul_f32 v122, v114, v122
    v_and_b32 v125, 0xffff0000, v126
    v_add_u32 v123, v123, v123
    v_mul_f32 v124, v122, v124
    v_mul_f32 v125, v122, v125
    v_cmpx_le_u32 vcc, 0x1000000, v54
    ds_add_f32 v123, v124 offset:54272
    ds_add_f32 v123, v125 offset:54276
    s_mov_b64 exec, -1
    v_ashrrev_i32 v122, 5, v55
    v_lshlrev_b16 v123, 2, v55
    v_cndmask_b32 v126, v14, v15, s[66:67]
    v_bitop3_b32 v122, v122, v113, v113 bitop3:0x0c
    v_lshlrev_b32 v124, 16, v126
    v_mul_f32 v122, v114, v122
    v_and_b32 v125, 0xffff0000, v126
    v_add_u32 v123, v123, v123
    v_mul_f32 v124, v122, v124
    v_mul_f32 v125, v122, v125
    v_cmpx_le_u32 vcc, 0x1000000, v55
    ds_add_f32 v123, v124 offset:54272
    ds_add_f32 v123, v125 offset:54276
    s_mov_b64 exec, -1
    v_ashrrev_i32 v122, 5, v56
    v_lshlrev_b16 v123, 2, v56
    v_cndmask_b32 v126, v16, v17, s[66:67]
    v_bitop3_b32 v122, v122, v113, v113 bitop3:0x0c
    v_lshlrev_b32 v124, 16, v126
    v_mul_f32 v122, v114, v122
    v_and_b32 v125, 0xffff0000, v126
    v_add_u32 v123, v123, v123
    v_mul_f32 v124, v122, v124
    v_mul_f32 v125, v122, v125
    v_cmpx_le_u32 vcc, 0x1000000, v56
    ds_add_f32 v123, v124 offset:54272
    ds_add_f32 v123, v125 offset:54276
    s_mov_b64 exec, -1
    s_cmp_lt_u32 s15, 8
    s_cbranch_scc1 p2_nad1
    s_waitcnt lgkmcnt(15)
    v_ashrrev_i32 v122, 5, v57
    v_lshlrev_b16 v123, 2, v57
    v_cndmask_b32 v126, v18, v19, s[66:67]
    v_bitop3_b32 v122, v122, v113, v113 bitop3:0x0c
    v_lshlrev_b32 v124, 16, v126
    v_mul_f32 v122, v114, v122
    v_and_b32 v125, 0xffff0000, v126
    v_add_u32 v123, v123, v123
    v_mul_f32 v124, v122, v124
    v_mul_f32 v125, v122, v125
    v_cmpx_le_u32 vcc, 0x1000000, v57
    ds_add_f32 v123, v124 offset:54272
    ds_add_f32 v123, v125 offset:54276
    s_mov_b64 exec, -1
    v_ashrrev_i32 v122, 5, v58
    v_lshlrev_b16 v123, 2, v58
    v_cndmask_b32 v126, v20, v21, s[66:67]
    v_bitop3_b32 v122, v122, v113, v113 bitop3:0x0c
    v_lshlrev_b32 v124, 16, v126
    v_mul_f32 v122, v114, v122
    v_and_b32 v125, 0xffff0000, v126
    v_add_u32 v123, v123, v123
    v_mul_f32 v124, v122, v124
    v_mul_f32 v125, v122, v125
    v_cmpx_le_u32 vcc, 0x1000000, v58
    ds_add_f32 v123, v124 offset:54272
    ds_add_f32 v123, v125 offset:54276
    s_mov_b64 exec, -1
    v_ashrrev_i32 v122, 5, v59
    v_lshlrev_b16 v123, 2, v59
    v_cndmask_b32 v126, v22, v23, s[66:67]
    v_bitop3_b32 v122, v122, v113, v113 bitop3:0x0c
    v_lshlrev_b32 v124, 16, v126
    v_mul_f32 v122, v114, v122
    v_and_b32 v125, 0xffff0000, v126
    v_add_u32 v123, v123, v123
    v_mul_f32 v124, v122, v124
    v_mul_f32 v125, v122, v125
    v_cmpx_le_u32 vcc, 0x1000000, v59
    ds_add_f32 v123, v124 offset:54272
    ds_add_f32 v123, v125 offset:54276
    s_mov_b64 exec, -1
p2_nad1:
    s_waitcnt lgkmcnt(15)
    v_ashrrev_i32 v122, 5, v60
    v_lshlrev_b16 v123, 2, v60
    v_cndmask_b32 v126, v24, v25, s[66:67]
    v_bitop3_b32 v122, v122, v113, v113 bitop3:0x0c
    v_lshlrev_b32 v124, 16, v126
    v_mul_f32 v122, v114, v122
    v_and_b32 v125, 0xffff0000, v126
    v_add_u32 v123, v123, v123
    v_mul_f32 v124, v122, v124
    v_mul_f32 v125, v122, v125
    v_cmpx_le_u32 vcc, 0x1000000, v60
    ds_add_f32 v123, v124 offset:54272
    ds_add_f32 v123, v125 offset:54276
    s_mov_b64 exec, -1
    v_ashrrev_i32 v122, 5, v61
    v_lshlrev_b16 v123, 2, v61
    v_cndmask_b32 v126, v26, v27, s[66:67]
    v_bitop3_b32 v122, v122, v113, v113 bitop3:0x0c
    v_lshlrev_b32 v124, 16, v126
    v_mul_f32 v122, v114, v122
    v_and_b32 v125, 0xffff0000, v126
    v_add_u32 v123, v123, v123
    v_mul_f32 v124, v122, v124
    v_mul_f32 v125, v122, v125
    v_cmpx_le_u32 vcc, 0x1000000, v61
    ds_add_f32 v123, v124 offset:54272
    ds_add_f32 v123, v125 offset:54276
    s_mov_b64 exec, -1
    v_ashrrev_i32 v122, 5, v62
    v_lshlrev_b16 v123, 2, v62
    v_cndmask_b32 v126, v28, v29, s[66:67]
    v_bitop3_b32 v122, v122, v113, v113 bitop3:0x0c
    v_lshlrev_b32 v124, 16, v126
    v_mul_f32 v122, v114, v122
    v_and_b32 v125, 0xffff0000, v126
    v_add_u32 v123, v123, v123
    v_mul_f32 v124, v122, v124
    v_mul_f32 v125, v122, v125
    v_cmpx_le_u32 vcc, 0x1000000, v62
    ds_add_f32 v123, v124 offset:54272
    ds_add_f32 v123, v125 offset:54276
    s_mov_b64 exec, -1
    s_waitcnt lgkmcnt(15)
    v_ashrrev_i32 v122, 5, v63
    v_lshlrev_b16 v123, 2, v63
    v_cndmask_b32 v126, v30, v31, s[66:67]
    v_bitop3_b32 v122, v122, v113, v113 bitop3:0x0c
    v_lshlrev_b32 v124, 16, v126
    v_mul_f32 v122, v114, v122
    v_and_b32 v125, 0xffff0000, v126
    v_add_u32 v123, v123, v123
    v_mul_f32 v124, v122, v124
    v_mul_f32 v125, v122, v125
    v_cmpx_le_u32 vcc, 0x1000000, v63
    ds_add_f32 v123, v124 offset:54272
    ds_add_f32 v123, v125 offset:54276
    s_mov_b64 exec, -1
    v_ashrrev_i32 v122, 5, v64
    v_lshlrev_b16 v123, 2, v64
    v_cndmask_b32 v126, v32, v33, s[66:67]
    v_bitop3_b32 v122, v122, v113, v113 bitop3:0x0c
    v_lshlrev_b32 v124, 16, v126
    v_mul_f32 v122, v114, v122
    v_and_b32 v125, 0xffff0000, v126
    v_add_u32 v123, v123, v123
    v_mul_f32 v124, v122, v124
    v_mul_f32 v125, v122, v125
    v_cmpx_le_u32 vcc, 0x1000000, v64
    ds_add_f32 v123, v124 offset:54272
    ds_add_f32 v123, v125 offset:54276
    s_mov_b64 exec, -1
    v_ashrrev_i32 v122, 5, v65
    v_lshlrev_b16 v123, 2, v65
    v_cndmask_b32 v126, v34, v35, s[66:67]
    v_bitop3_b32 v122, v122, v113, v113 bitop3:0x0c
    v_lshlrev_b32 v124, 16, v126
    v_mul_f32 v122, v114, v122
    v_and_b32 v125, 0xffff0000, v126
    v_add_u32 v123, v123, v123
    v_mul_f32 v124, v122, v124
    v_mul_f32 v125, v122, v125
    v_cmpx_le_u32 vcc, 0x1000000, v65
    ds_add_f32 v123, v124 offset:54272
    ds_add_f32 v123, v125 offset:54276
    s_mov_b64 exec, -1
    s_waitcnt lgkmcnt(15)
    v_ashrrev_i32 v122, 5, v66
    v_lshlrev_b16 v123, 2, v66
    v_cndmask_b32 v126, v36, v37, s[66:67]
    v_bitop3_b32 v122, v122, v113, v113 bitop3:0x0c
    v_lshlrev_b32 v124, 16, v126
    v_mul_f32 v122, v114, v122
    v_and_b32 v125, 0xffff0000, v126
    v_add_u32 v123, v123, v123
    v_mul_f32 v124, v122, v124
    v_mul_f32 v125, v122, v125
    v_cmpx_le_u32 vcc, 0x1000000, v66
    ds_add_f32 v123, v124 offset:54272
    ds_add_f32 v123, v125 offset:54276
    s_mov_b64 exec, -1
    v_ashrrev_i32 v122, 5, v67
    v_lshlrev_b16 v123, 2, v67
    v_cndmask_b32 v126, v38, v39, s[66:67]
    v_bitop3_b32 v122, v122, v113, v113 bitop3:0x0c
    v_lshlrev_b32 v124, 16, v126
    v_mul_f32 v122, v114, v122
    v_and_b32 v125, 0xffff0000, v126
    v_add_u32 v123, v123, v123
    v_mul_f32 v124, v122, v124
    v_mul_f32 v125, v122, v125
    v_cmpx_le_u32 vcc, 0x1000000, v67
    ds_add_f32 v123, v124 offset:54272
    ds_add_f32 v123, v125 offset:54276
    s_mov_b64 exec, -1
    v_ashrrev_i32 v122, 5, v68
    v_lshlrev_b16 v123, 2, v68
    v_cndmask_b32 v126, v40, v41, s[66:67]
    v_bitop3_b32 v122, v122, v113, v113 bitop3:0x0c
    v_lshlrev_b32 v124, 16, v126
    v_mul_f32 v122, v114, v122
    v_and_b32 v125, 0xffff0000, v126
    v_add_u32 v123, v123, v123
    v_mul_f32 v124, v122, v124
    v_mul_f32 v125, v122, v125
    v_cmpx_le_u32 vcc, 0x1000000, v68
    ds_add_f32 v123, v124 offset:54272
    ds_add_f32 v123, v125 offset:54276
    s_mov_b64 exec, -1
    s_waitcnt lgkmcnt(15)
    v_ashrrev_i32 v122, 5, v69
    v_lshlrev_b16 v123, 2, v69
    v_cndmask_b32 v126, v42, v43, s[66:67]
    v_bitop3_b32 v122, v122, v113, v113 bitop3:0x0c
    v_lshlrev_b32 v124, 16, v126
    v_mul_f32 v122, v114, v122
    v_and_b32 v125, 0xffff0000, v126
    v_add_u32 v123, v123, v123
    v_mul_f32 v124, v122, v124
    v_mul_f32 v125, v122, v125
    v_cmpx_le_u32 vcc, 0x1000000, v69
    ds_add_f32 v123, v124 offset:54272
    ds_add_f32 v123, v125 offset:54276
    s_mov_b64 exec, -1
    v_ashrrev_i32 v122, 5, v70
    v_lshlrev_b16 v123, 2, v70
    v_cndmask_b32 v126, v44, v45, s[66:67]
    v_bitop3_b32 v122, v122, v113, v113 bitop3:0x0c
    v_lshlrev_b32 v124, 16, v126
    v_mul_f32 v122, v114, v122
    v_and_b32 v125, 0xffff0000, v126
    v_add_u32 v123, v123, v123
    v_mul_f32 v124, v122, v124
    v_mul_f32 v125, v122, v125
    v_cmpx_le_u32 vcc, 0x1000000, v70
    ds_add_f32 v123, v124 offset:54272
    ds_add_f32 v123, v125 offset:54276
    s_mov_b64 exec, -1
    v_ashrrev_i32 v122, 5, v71
    v_lshlrev_b16 v123, 2, v71
    v_cndmask_b32 v126, v46, v47, s[66:67]
    v_bitop3_b32 v122, v122, v113, v113 bitop3:0x0c
    v_lshlrev_b32 v124, 16, v126
    v_mul_f32 v122, v114, v122
    v_and_b32 v125, 0xffff0000, v126
    v_add_u32 v123, v123, v123
    v_mul_f32 v124, v122, v124
    v_mul_f32 v125, v122, v125
    v_cmpx_le_u32 vcc, 0x1000000, v71
    ds_add_f32 v123, v124 offset:54272
    ds_add_f32 v123, v125 offset:54276
    s_mov_b64 exec, -1
    s_branch p2_fin
p2_tail:
    s_mov_b32 s60, s61
    s_mov_b32 s15, s16
    s_mov_b32 s16, s17
    v_mov_b32 v122, s19
    s_xor_b32 s19, s19, 4
    ds_read_b32 v125, v122 offset:53760
    v_mov_b32 v123, s19
    v_mov_b32 v124, 0
    ds_write_b32 v123, v124 offset:53760
    s_waitcnt vmcnt(2)
    s_mov_b32 m0, s24
    s_cmp_ge_u32 s10, 9
    s_cbranch_scc1 p2_st2s1
    ds_write_addtid_b32 v84 offset:49152
    ds_write_addtid_b32 v85 offset:49408
p2_st2s1:
    s_mov_b32 m0, s23
    s_add_u32 s20, s20, 53760
    ds_write_addtid_b32 v72 offset:0
    ds_write_addtid_b32 v73 offset:256
    ds_write_addtid_b32 v74 offset:512
    ds_write_addtid_b32 v75 offset:768
    ds_write_addtid_b32 v76 offset:1024
    ds_write_addtid_b32 v77 offset:1280
    ds_write_addtid_b32 v78 offset:1536
    ds_write_addtid_b32 v79 offset:1792
    ds_write_addtid_b32 v80 offset:2048
    ds_write_addtid_b32 v81 offset:2304
    ds_write_addtid_b32 v82 offset:2560
    ds_write_addtid_b32 v83 offset:2816
    s_cmp_ge_u32 s10, 9
    s_cbranch_scc1 p2_nm2m2a
    v_lshrrev_b32 v84, 1, v112
    s_add_u32 s44, s20, s42
    buffer_load_dwordx2 v[84:85], v84, s[4:7], s44 offen
p2_nm2m2a:
    buffer_load_dwordx4 v[72:75], v112, s[4:7], s20 offen offset:0
    buffer_load_dwordx4 v[76:79], v112, s[4:7], s20 offen offset:1024
    buffer_load_dwordx4 v[80:83], v112, s[4:7], s20 offen offset:2048
    s_waitcnt lgkmcnt(0)
    s_barrier
    s_setprio 3
    v_cmpx_lt_i16 vcc, 0x3fff, v48
    ds_read_b64 v[0:1], v0
    s_mov_b64 exec, -1
    v_cmpx_lt_i16 vcc, 0x3fff, v49
    ds_read_b64 v[2:3], v2
    s_mov_b64 exec, -1
    v_cmpx_lt_i16 vcc, 0x3fff, v50
    ds_read_b64 v[4:5], v4
    s_mov_b64 exec, -1
    v_cmpx_lt_i16 vcc, 0x3fff, v51
    ds_read_b64 v[6:7], v6
    s_mov_b64 exec, -1
    v_cmpx_lt_i16 vcc, 0x3fff, v52
    ds_read_b64 v[8:9], v8
    s_mov_b64 exec, -1
    v_cmpx_lt_i16 vcc, 0x3fff, v53
    ds_read_b64 v[10:11], v10
    s_mov_b64 exec, -1
    s_waitcnt lgkmcnt(15)
    s_nop 1
    v_readfirstlane_b32 s44, v125
    s_nop 0
    s_cmp_lg_u32 s44, 0
    s_cbranch_scc1 p2_advb
    s_add_u32 s61, s61, 1
    s_min_u32 s61, s61, 10
    v_mov_b32 v110, 0
    v_mov_b32 v111, 0
    s_cmp_eq_u32 s61, 10
    s_cbranch_scc1 p2_advb
    s_add_u32 s44, s61, s18
    s_cmp_ge_u32 s44, 10
    s_cselect_b32 s53, 10, 0
    s_sub_u32 s44, s44, s53
    s_mul_i32 s44, s44, 4160
    s_add_u32 s44, s44, s40
    v_bfe_i32 v111, v112, 6, 1
    v_lshrrev_b32 v110, 6, v112
    v_bitop3_b32 v111, v111, 15, s10 bitop3:0x6a
    v_lshl_or_b32 v110, v110, 4, v111
    v_bfe_u32 v111, v112, 2, 4
    v_mul_u32_u24 v110, 41600, v110
    v_add_u32 v111, v110, v111
    v_add_u32 v110, 256, v112
    v_and_b32 v110, 0x400, v110
    v_lshl_or_b32 v111, v110, 20, v111
    buffer_load_dword v110, v111, s[4:7], s44 offen
    buffer_load_dword v111, v111, s[4:7], s44 offen offset:16
p2_advb:
    s_cmp_lg_u32 s10, 15
    s_cbranch_scc1 p2_ntg
    s_lshr_b32 s44, s2, 3
    s_mul_i32 s44, s44, 5120
    s_add_u32 s45, s60, s18
    s_cmp_ge_u32 s45, 10
    s_cselect_b32 s53, 10, 0
    s_sub_u32 s45, s45, s53
    s_mul_i32 s45, s45, 645120
    s_add_u32 s44, s44, s45
    s_add_u32 s44, s44, s62
    s_sub_u32 s44, s44, s23
    v_lshlrev_b32 v84, 3, v112
    s_mov_b32 exec_hi, 0xff
    buffer_load_dword v85, v84, s[4:7], s44 offen
    s_mov_b64 exec, -1
p2_ntg:
    v_cmpx_lt_i16 vcc, 0x3fff, v54
    ds_read_b64 v[12:13], v12
    s_mov_b64 exec, -1
    v_cmpx_lt_i16 vcc, 0x3fff, v55
    ds_read_b64 v[14:15], v14
    s_mov_b64 exec, -1
    v_cmpx_lt_i16 vcc, 0x3fff, v56
    ds_read_b64 v[16:17], v16
    s_mov_b64 exec, -1
    s_cmp_lt_u32 s15, 8
    s_cbranch_scc1 p2_g2r13
    v_cmpx_lt_i16 vcc, 0x3fff, v57
    ds_read_b64 v[18:19], v18
    s_mov_b64 exec, -1
    v_cmpx_lt_i16 vcc, 0x3fff, v58
    ds_read_b64 v[20:21], v20
    s_mov_b64 exec, -1
    v_cmpx_lt_i16 vcc, 0x3fff, v59
    ds_read_b64 v[22:23], v22
    s_mov_b64 exec, -1
p2_g2r13:
    v_bfe_u32 v98, v109, 14, 4
    v_lshrrev_b32 v99, 18, v109
    v_and_b32 v109, 0x3fff, v109
    v_mad_u32_u24 v98, v98, s63, v99
    v_mad_u32_u24 v109, v98, s65, v109
    buffer_load_dwordx4 v[98:101], v109, s[68:71], 0 offen
    s_setprio 1
    v_cmpx_lt_i16 vcc, 0x3fff, v60
    ds_read_b64 v[24:25], v24
    s_mov_b64 exec, -1
    v_cmpx_lt_i16 vcc, 0x3fff, v61
    ds_read_b64 v[26:27], v26
    s_mov_b64 exec, -1
    v_cmpx_lt_i16 vcc, 0x3fff, v62
    ds_read_b64 v[28:29], v28
    s_mov_b64 exec, -1
    v_cmpx_lt_i16 vcc, 0x3fff, v63
    ds_read_b64 v[30:31], v30
    s_mov_b64 exec, -1
    v_cmpx_lt_i16 vcc, 0x3fff, v64
    ds_read_b64 v[32:33], v32
    s_mov_b64 exec, -1
    v_cmpx_lt_i16 vcc, 0x3fff, v65
    ds_read_b64 v[34:35], v34
    s_mov_b64 exec, -1
    s_nop 2
    s_nop 1
    v_max_u32_dpp v102, v102, v102 row_shr:1 row_mask:0xf bank_mask:0xf bound_ctrl:0
    v_max_u32_dpp v103, v103, v103 row_shr:1 row_mask:0xf bank_mask:0xf bound_ctrl:0
    s_nop 0
    v_max_u32_dpp v102, v102, v102 row_shr:2 row_mask:0xf bank_mask:0xf bound_ctrl:0
    v_max_u32_dpp v103, v103, v103 row_shr:2 row_mask:0xf bank_mask:0xf bound_ctrl:0
    s_nop 0
    v_max_u32_dpp v102, v102, v102 row_shr:4 row_mask:0xf bank_mask:0xf bound_ctrl:0
    v_max_u32_dpp v103, v103, v103 row_shr:4 row_mask:0xf bank_mask:0xf bound_ctrl:0
    s_nop 0
    v_max_u32_dpp v102, v102, v102 row_shr:8 row_mask:0xf bank_mask:0xf bound_ctrl:0
    v_max_u32_dpp v103, v103, v103 row_shr:8 row_mask:0xf bank_mask:0xf bound_ctrl:0
    s_nop 0
    v_max_u32_dpp v102, v102, v102 row_bcast:15 row_mask:0xa bank_mask:0xf
    v_max_u32_dpp v103, v103, v103 row_bcast:15 row_mask:0xa bank_mask:0xf
    s_nop 0
    v_max_u32_dpp v102, v102, v102 row_bcast:31 row_mask:0xc bank_mask:0xf
    v_max_u32_dpp v103, v103, v103 row_bcast:31 row_mask:0xc bank_mask:0xf
    s_nop 0
    s_nop 0
    v_max_u32 v102, s41, v102
    s_nop 0
    v_readlane_b32 s41, v102, 63
    v_add_u32 v102, v102, v112
    v_add_u32 v102, 4294963200, v102
    v_max_u32 v103, s41, v103
    s_nop 0
    v_readlane_b32 s41, v103, 63
    v_add_u32 v103, v103, v112
    v_add_u32 v103, 4294964224, v103
    v_cmpx_lt_i16 vcc, 0x3fff, v66
    ds_read_b64 v[36:37], v36
    s_mov_b64 exec, -1
    v_cmpx_lt_i16 vcc, 0x3fff, v67
    ds_read_b64 v[38:39], v38
    s_mov_b64 exec, -1
    v_cmpx_lt_i16 vcc, 0x3fff, v68
    ds_read_b64 v[40:41], v40
    s_mov_b64 exec, -1
    v_cmpx_lt_i16 vcc, 0x3fff, v69
    ds_read_b64 v[42:43], v42
    s_mov_b64 exec, -1
    v_cmpx_lt_i16 vcc, 0x3fff, v70
    ds_read_b64 v[44:45], v44
    s_mov_b64 exec, -1
    v_cmpx_lt_i16 vcc, 0x3fff, v71
    ds_read_b64 v[46:47], v46
    s_mov_b64 exec, -1
    s_waitcnt lgkmcnt(0)
    s_barrier
    s_waitcnt vmcnt(1)
    s_mov_b32 m0, s24
    s_cmp_ge_u32 s10, 9
    s_cbranch_scc1 p2_st2s2
    ds_write_addtid_b32 v84 offset:49152
    ds_write_addtid_b32 v85 offset:49408
p2_st2s2:
    s_mov_b32 m0, s23
    s_add_u32 s20, s60, s18
    s_cmp_ge_u32 s20, 10
    s_cselect_b32 s53, 10, 0
    s_sub_u32 s20, s20, s53
    s_mul_i32 s20, s20, 645120
    s_add_u32 s20, s20, s62
    ds_write_addtid_b32 v72 offset:0
    ds_write_addtid_b32 v73 offset:256
    ds_write_addtid_b32 v74 offset:512
    ds_write_addtid_b32 v75 offset:768
    ds_write_addtid_b32 v76 offset:1024
    ds_write_addtid_b32 v77 offset:1280
    ds_write_addtid_b32 v78 offset:1536
    ds_write_addtid_b32 v79 offset:1792
    ds_write_addtid_b32 v80 offset:2048
    ds_write_addtid_b32 v81 offset:2304
    ds_write_addtid_b32 v82 offset:2560
    ds_write_addtid_b32 v83 offset:2816
    s_nop 2
    s_nop 1
    v_max_u32_dpp v104, v104, v104 row_shr:1 row_mask:0xf bank_mask:0xf bound_ctrl:0
    v_max_u32_dpp v105, v105, v105 row_shr:1 row_mask:0xf bank_mask:0xf bound_ctrl:0
    s_nop 0
    v_max_u32_dpp v104, v104, v104 row_shr:2 row_mask:0xf bank_mask:0xf bound_ctrl:0
    v_max_u32_dpp v105, v105, v105 row_shr:2 row_mask:0xf bank_mask:0xf bound_ctrl:0
    s_nop 0
    v_max_u32_dpp v104, v104, v104 row_shr:4 row_mask:0xf bank_mask:0xf bound_ctrl:0
    v_max_u32_dpp v105, v105, v105 row_shr:4 row_mask:0xf bank_mask:0xf bound_ctrl:0
    s_nop 0
    v_max_u32_dpp v104, v104, v104 row_shr:8 row_mask:0xf bank_mask:0xf bound_ctrl:0
    v_max_u32_dpp v105, v105, v105 row_shr:8 row_mask:0xf bank_mask:0xf bound_ctrl:0
    s_nop 0
    v_max_u32_dpp v104, v104, v104 row_bcast:15 row_mask:0xa bank_mask:0xf
    v_max_u32_dpp v105, v105, v105 row_bcast:15 row_mask:0xa bank_mask:0xf
    s_nop 0
    v_max_u32_dpp v104, v104, v104 row_bcast:31 row_mask:0xc bank_mask:0xf
    v_max_u32_dpp v105, v105, v105 row_bcast:31 row_mask:0xc bank_mask:0xf
    s_nop 0
    s_nop 0
    v_max_u32 v104, s41, v104
    s_nop 0
    v_readlane_b32 s41, v104, 63
    v_add_u32 v104, v104, v112
    v_add_u32 v104, 4294965248, v104
    v_max_u32 v105, s41, v105
    s_nop 0
    v_readlane_b32 s41, v105, 63
    v_add_u32 v105, v105, v112
    v_add_u32 v105, 4294966272, v105
    s_waitcnt lgkmcnt(0)
    s_barrier
    s_branch p2_top
p2_fin:
    s_waitcnt vmcnt(0) lgkmcnt(0)
    s_barrier
    s_mov_b32 s48, s11
    s_mul_i32 s44, s48, 800768
    s_mul_i32 s45, s12, 12512
    s_add_u32 s49, s44, s45
    s_lshl_b32 s44, s49, 3
    s_add_u32 s44, s44, 492278784
    s_lshl_b32 s48, s48, 2
    s_lshl_b32 s45, s12, 4
    s_add_u32 s48, s48, s45
    s_add_u32 s48, s48, 492277760
    v_add_u32 v123, s64, v112
    v_add_u32 v122, s25, v123
    v_mov_b32 v24, 0
    v_mov_b32 v25, 0
    v_mov_b32 v26, 0
    v_mov_b32 v27, 0
    v_cmp_gt_u32 vcc, 1792, v123
    v_mov_b32 v124, 0x38000000
    v_mov_b32 v126, 0
    v_cndmask_b32 v124, v124, v123, vcc
    ds_read_b128 v[0:3], v122 offset:0
    ds_read_b128 v[4:7], v122 offset:16384
    ds_read_b128 v[8:11], v122 offset:32768
    v_add_u32 v122, 49152, v122
    ds_read_b128 v[12:15], v122 offset:0
    ds_read_b128 v[16:19], v122 offset:16384
    ds_read_b128 v[20:23], v122 offset:32768
    s_mov_b64 exec, vcc
    ds_read_b128 v[24:27], v122 offset:49152
    s_mov_b64 exec, -1
    s_cmp_lg_u32 s21, 0
    s_cbranch_scc1 p2_finf
    s_waitcnt lgkmcnt(6)
    buffer_store_dwordx4 v[0:3], v123, s[4:7], s44 offen nt
    s_add_u32 s44, s44, 16384
    s_waitcnt lgkmcnt(5)
    buffer_store_dwordx4 v[4:7], v123, s[4:7], s44 offen nt
    s_add_u32 s44, s44, 16384
    s_waitcnt lgkmcnt(4)
    buffer_store_dwordx4 v[8:11], v123, s[4:7], s44 offen nt
    s_add_u32 s44, s44, 16384
    s_waitcnt lgkmcnt(3)
    buffer_store_dwordx4 v[12:15], v123, s[4:7], s44 offen nt
    s_add_u32 s44, s44, 16384
    s_waitcnt lgkmcnt(2)
    buffer_store_dwordx4 v[16:19], v123, s[4:7], s44 offen nt
    s_add_u32 s44, s44, 16384
    s_waitcnt lgkmcnt(1)
    buffer_store_dwordx4 v[20:23], v123, s[4:7], s44 offen nt
    s_add_u32 s44, s44, 16384
    s_waitcnt lgkmcnt(0)
    buffer_store_dwordx4 v[24:27], v124, s[4:7], s44 offen nt
    s_add_u32 s44, s44, 16384
    v_bitop3_b32 v115, v115, v0, v1 bitop3:0xfe
    v_bitop3_b32 v115, v115, v2, v3 bitop3:0xfe
    v_bitop3_b32 v115, v115, v4, v5 bitop3:0xfe
    v_bitop3_b32 v115, v115, v6, v7 bitop3:0xfe
    v_bitop3_b32 v115, v115, v8, v9 bitop3:0xfe
    v_bitop3_b32 v115, v115, v10, v11 bitop3:0xfe
    v_bitop3_b32 v115, v115, v12, v13 bitop3:0xfe
    v_bitop3_b32 v115, v115, v14, v15 bitop3:0xfe
    v_bitop3_b32 v115, v115, v16, v17 bitop3:0xfe
    v_bitop3_b32 v115, v115, v18, v19 bitop3:0xfe
    v_bitop3_b32 v115, v115, v20, v21 bitop3:0xfe
    v_bitop3_b32 v115, v115, v22, v23 bitop3:0xfe
    v_bitop3_b32 v115, v115, v24, v25 bitop3:0xfe
    v_bitop3_b32 v115, v115, v26, v27 bitop3:0xfe
    v_bitop3_b32 v115, v115, v116, v117 bitop3:0xfe
    v_bitop3_b32 v115, v115, v118, v119 bitop3:0xfe
    v_bitop3_b32 v115, v115, v120, v121 bitop3:0xfe
    v_mov_b32 v28, 0
    v_mov_b32 v29, 0
    v_lshrrev_b32 v30, 1, v0
    v_bitop3_b32 v28, v28, v0, v30 bitop3:0xf6
    v_lshrrev_b32 v31, 1, v1
    v_bitop3_b32 v29, v29, v1, v31 bitop3:0xf6
    v_lshrrev_b32 v30, 1, v2
    v_bitop3_b32 v28, v28, v2, v30 bitop3:0xf6
    v_lshrrev_b32 v31, 1, v3
    v_bitop3_b32 v29, v29, v3, v31 bitop3:0xf6
    v_lshrrev_b32 v30, 1, v4
    v_bitop3_b32 v28, v28, v4, v30 bitop3:0xf6
    v_lshrrev_b32 v31, 1, v5
    v_bitop3_b32 v29, v29, v5, v31 bitop3:0xf6
    v_lshrrev_b32 v30, 1, v6
    v_bitop3_b32 v28, v28, v6, v30 bitop3:0xf6
    v_lshrrev_b32 v31, 1, v7
    v_bitop3_b32 v29, v29, v7, v31 bitop3:0xf6
    v_lshrrev_b32 v30, 1, v8
    v_bitop3_b32 v28, v28, v8, v30 bitop3:0xf6
    v_lshrrev_b32 v31, 1, v9
    v_bitop3_b32 v29, v29, v9, v31 bitop3:0xf6
    v_lshrrev_b32 v30, 1, v10
    v_bitop3_b32 v28, v28, v10, v30 bitop3:0xf6
    v_lshrrev_b32 v31, 1, v11
    v_bitop3_b32 v29, v29, v11, v31 bitop3:0xf6
    v_lshrrev_b32 v30, 1, v12
    v_bitop3_b32 v28, v28, v12, v30 bitop3:0xf6
    v_lshrrev_b32 v31, 1, v13
    v_bitop3_b32 v29, v29, v13, v31 bitop3:0xf6
    v_lshrrev_b32 v30, 1, v14
    v_bitop3_b32 v28, v28, v14, v30 bitop3:0xf6
    v_lshrrev_b32 v31, 1, v15
    v_bitop3_b32 v29, v29, v15, v31 bitop3:0xf6
    v_lshrrev_b32 v30, 1, v16
    v_bitop3_b32 v28, v28, v16, v30 bitop3:0xf6
    v_lshrrev_b32 v31, 1, v17
    v_bitop3_b32 v29, v29, v17, v31 bitop3:0xf6
    v_lshrrev_b32 v30, 1, v18
    v_bitop3_b32 v28, v28, v18, v30 bitop3:0xf6
    v_lshrrev_b32 v31, 1, v19
    v_bitop3_b32 v29, v29, v19, v31 bitop3:0xf6
    v_lshrrev_b32 v30, 1, v20
    v_bitop3_b32 v28, v28, v20, v30 bitop3:0xf6
    v_lshrrev_b32 v31, 1, v21
    v_bitop3_b32 v29, v29, v21, v31 bitop3:0xf6
    v_lshrrev_b32 v30, 1, v22
    v_bitop3_b32 v28, v28, v22, v30 bitop3:0xf6
    v_lshrrev_b32 v31, 1, v23
    v_bitop3_b32 v29, v29, v23, v31 bitop3:0xf6
    v_lshrrev_b32 v30, 1, v24
    v_bitop3_b32 v28, v28, v24, v30 bitop3:0xf6
    v_lshrrev_b32 v31, 1, v25
    v_bitop3_b32 v29, v29, v25, v31 bitop3:0xf6
    v_lshrrev_b32 v30, 1, v26
    v_bitop3_b32 v28, v28, v26, v30 bitop3:0xf6
    v_lshrrev_b32 v31, 1, v27
    v_bitop3_b32 v29, v29, v27, v31 bitop3:0xf6
    s_mov_b32 s45, 0
    v_and_b32 v30, 7168, v28
    v_cmp_ne_u32 vcc, 0, v30
    s_nop 0
    s_cmp_lg_u64 vcc, 0
    s_cselect_b32 s46, 1, 0
    s_or_b32 s45, s45, s46
    v_and_b32 v30, 469762048, v28
    v_cmp_ne_u32 vcc, 0, v30
    s_nop 0
    s_cmp_lg_u64 vcc, 0
    s_cselect_b32 s46, 2, 0
    s_or_b32 s45, s45, s46
    v_and_b32 v30, 7168, v29
    v_cmp_ne_u32 vcc, 0, v30
    s_nop 0
    s_cmp_lg_u64 vcc, 0
    s_cselect_b32 s46, 4, 0
    s_or_b32 s45, s45, s46
    v_and_b32 v30, 469762048, v29
    v_cmp_ne_u32 vcc, 0, v30
    s_nop 0
    s_cmp_lg_u64 vcc, 0
    s_cselect_b32 s46, 8, 0
    s_or_b32 s45, s45, s46
    v_and_b32 v30, 2147516416, v115
    v_cmp_ne_u32 vcc, 0, v30
    s_nop 0
    s_cmp_lg_u64 vcc, 0
    s_cselect_b32 s46, 16, 0
    s_or_b32 s45, s45, s46
    v_mov_b32 v30, s45
    s_mov_b64 exec, 1
    ds_or_b32 v126, v30 offset:53768
    s_mov_b64 exec, -1
    s_waitcnt lgkmcnt(0)
    s_barrier
    ds_read_b32 v125, v126 offset:53768
    s_waitcnt lgkmcnt(0)
    v_readfirstlane_b32 s45, v125
    s_nop 0
    s_cmp_eq_u32 s45, 15
    s_cbranch_scc1 p2_done
    s_mov_b32 s21, 1
    s_waitcnt vmcnt(0)
    s_branch p2_restart
p2_finf:
    s_lshl_b32 s49, s49, 4
    s_lshl_b32 s45, s21, 3
    s_add_u32 s49, s49, s45
    s_add_u32 s49, s49, 517903352
    v_mov_b32 v28, 1073758208
    v_mov_b32 v29, 1073758208
    v_mov_b32 v30, 1073758208
    v_mov_b32 v31, 1073758208
    v_lshlrev_b32 v122, 1, v123
    v_lshlrev_b32 v125, 1, v124
    s_waitcnt lgkmcnt(0)
    buffer_store_dwordx4 v[28:31], v123, s[4:7], s44 offen
    s_add_u32 s44, s44, 16384
    buffer_store_dwordx2 v[0:1], v122, s[4:7], s49 offen offset:0
    buffer_store_dwordx2 v[2:3], v122, s[4:7], s49 offen offset:16
    s_add_u32 s49, s49, 32768
    buffer_store_dwordx4 v[28:31], v123, s[4:7], s44 offen
    s_add_u32 s44, s44, 16384
    buffer_store_dwordx2 v[4:5], v122, s[4:7], s49 offen offset:0
    buffer_store_dwordx2 v[6:7], v122, s[4:7], s49 offen offset:16
    s_add_u32 s49, s49, 32768
    buffer_store_dwordx4 v[28:31], v123, s[4:7], s44 offen
    s_add_u32 s44, s44, 16384
    buffer_store_dwordx2 v[8:9], v122, s[4:7], s49 offen offset:0
    buffer_store_dwordx2 v[10:11], v122, s[4:7], s49 offen offset:16
    s_add_u32 s49, s49, 32768
    buffer_store_dwordx4 v[28:31], v123, s[4:7], s44 offen
    s_add_u32 s44, s44, 16384
    buffer_store_dwordx2 v[12:13], v122, s[4:7], s49 offen offset:0
    buffer_store_dwordx2 v[14:15], v122, s[4:7], s49 offen offset:16
    s_add_u32 s49, s49, 32768
    buffer_store_dwordx4 v[28:31], v123, s[4:7], s44 offen
    s_add_u32 s44, s44, 16384
    buffer_store_dwordx2 v[16:17], v122, s[4:7], s49 offen offset:0
    buffer_store_dwordx2 v[18:19], v122, s[4:7], s49 offen offset:16
    s_add_u32 s49, s49, 32768
    buffer_store_dwordx4 v[28:31], v123, s[4:7], s44 offen
    s_add_u32 s44, s44, 16384
    buffer_store_dwordx2 v[20:21], v122, s[4:7], s49 offen offset:0
    buffer_store_dwordx2 v[22:23], v122, s[4:7], s49 offen offset:16
    s_add_u32 s49, s49, 32768
    buffer_store_dwordx4 v[28:31], v124, s[4:7], s44 offen
    s_add_u32 s44, s44, 16384
    buffer_store_dwordx2 v[24:25], v125, s[4:7], s49 offen offset:0
    buffer_store_dwordx2 v[26:27], v125, s[4:7], s49 offen offset:16
    s_add_u32 s49, s49, 32768
    s_add_u32 s21, s21, 1
    s_mov_b32 s30, 0
    s_waitcnt vmcnt(0)
    s_cmp_eq_u32 s21, 2
    s_cbranch_scc1 p2_restart
p2_done:
    v_mov_b32 v125, s30
    buffer_store_dword v125, v126, s[4:7], s48 offen
p2_end:
    s_endpgm
.globl p3_kernel
.p2align 8
.type p3_kernel,@function
p3_kernel:
    s_cmp_ge_u32 s2, 1563
    s_cbranch_scc1 p3_end
    s_load_dwordx2 s[4:5], s[0:1], 0
    s_load_dwordx2 s[6:7], s[0:1], 24
    s_load_dwordx2 s[8:9], s[0:1], 40
    s_load_dwordx8 s[12:19], s[0:1], 56
    s_load_dwordx2 s[10:11], s[0:1], 88
    s_load_dwordx2 s[20:21], s[0:1], 104
    s_lshl_b32 s3, s2, 8
    v_add_u32 v0, s3, v0
    v_lshlrev_b32 v2, 4, v0
    v_lshlrev_b32 v3, 2, v0
    v_add_u32 v0, v0, v0
    v_mul_hi_u32_u24 v1, 343268, v0
    v_lshlrev_b16 v1, 4, v1
    s_waitcnt lgkmcnt(0)
    s_load_dwordx4 s[32:35], s[8:9], 0
    s_load_dwordx16 s[36:51], s[12:13], 0
    s_load_dwordx16 s[52:67], s[14:15], 0
    s_load_dwordx8 s[68:75], s[16:17], 0
    s_load_dwordx8 s[76:83], s[18:19], 0
    s_mov_b32 s24, s6
    s_and_b32 s25, s7, 0xffff
    s_mov_b32 s26, 1600000
    s_mov_b32 s27, 0x20000
    buffer_load_dword v4, v3, s[24:27], 0 offen nt
    s_mov_b32 s28, s20
    s_and_b32 s29, s21, 0xffff
    s_mov_b32 s30, 819200000
    s_mov_b32 s31, 0x20000
    s_mov_b32 s22, 492278784
    buffer_load_dwordx4 v[40:43], v2, s[28:31], s22 offen nt
    s_mov_b32 s22, 498684928
    buffer_load_dwordx4 v[44:47], v2, s[28:31], s22 offen nt
    s_mov_b32 s22, 505091072
    buffer_load_dwordx4 v[48:51], v2, s[28:31], s22 offen nt
    s_mov_b32 s22, 511497216
    buffer_load_dwordx4 v[52:55], v2, s[28:31], s22 offen nt
    s_mov_b32 s22, 492277760
    buffer_load_dwordx4 v[56:59], v1, s[28:31], s22 offen
    s_mov_b32 s24, s4
    s_and_b32 s25, s5, 0xffff
    s_mov_b32 s26, 6400000
    s_mov_b32 s27, 0x20000
    buffer_load_dwordx4 v[60:63], v2, s[24:27], 0 offen nt
    s_mov_b32 s24, s10
    s_and_b32 s25, s11, 0xffff
    s_mov_b32 s26, 6400000
    s_mov_b32 s27, 0x20000
    s_waitcnt vmcnt(6) lgkmcnt(0)
    v_and_b32 v5, 0xffff0000, v4
    v_lshlrev_b32 v4, 16, v4
    s_lshl_b32 s14, s32, 16
    s_and_b32 s15, s32, 0xffff0000
    v_pk_add_f32 v[8:9], v[4:5], s[14:15] op_sel:[0,0] op_sel_hi:[0,1] neg_lo:[0,1] neg_hi:[0,1]
    v_pk_add_f32 v[16:17], v[4:5], s[14:15] op_sel:[1,0] op_sel_hi:[1,1] neg_lo:[0,1] neg_hi:[0,1]
    s_lshl_b32 s16, s33, 16
    s_and_b32 s17, s33, 0xffff0000
    v_pk_add_f32 v[10:11], v[4:5], s[16:17] op_sel:[0,0] op_sel_hi:[0,1] neg_lo:[0,1] neg_hi:[0,1]
    v_pk_add_f32 v[18:19], v[4:5], s[16:17] op_sel:[1,0] op_sel_hi:[1,1] neg_lo:[0,1] neg_hi:[0,1]
    s_lshl_b32 s18, s34, 16
    s_and_b32 s19, s34, 0xffff0000
    v_pk_add_f32 v[12:13], v[4:5], s[18:19] op_sel:[0,0] op_sel_hi:[0,1] neg_lo:[0,1] neg_hi:[0,1]
    v_pk_add_f32 v[20:21], v[4:5], s[18:19] op_sel:[1,0] op_sel_hi:[1,1] neg_lo:[0,1] neg_hi:[0,1]
    s_lshl_b32 s12, s35, 16
    s_and_b32 s13, s35, 0xffff0000
    v_pk_add_f32 v[14:15], v[4:5], s[12:13] op_sel:[0,0] op_sel_hi:[0,1] neg_lo:[0,1] neg_hi:[0,1]
    v_pk_add_f32 v[22:23], v[4:5], s[12:13] op_sel:[1,0] op_sel_hi:[1,1] neg_lo:[0,1] neg_hi:[0,1]
    v_cvt_pk_bf16_f32 v8, v8, v9
    v_cvt_pk_bf16_f32 v10, v10, v11
    v_cvt_pk_bf16_f32 v12, v12, v13
    v_cvt_pk_bf16_f32 v14, v14, v15
    v_cvt_pk_bf16_f32 v16, v16, v17
    v_cvt_pk_bf16_f32 v18, v18, v19
    v_cvt_pk_bf16_f32 v20, v20, v21
    v_cvt_pk_bf16_f32 v22, v22, v23
    v_and_b32 v9, 0xffff0000, v8
    v_lshlrev_b32 v8, 16, v8
    v_and_b32 v11, 0xffff0000, v10
    v_lshlrev_b32 v10, 16, v10
    v_and_b32 v13, 0xffff0000, v12
    v_lshlrev_b32 v12, 16, v12
    v_and_b32 v15, 0xffff0000, v14
    v_lshlrev_b32 v14, 16, v14
    v_and_b32 v17, 0xffff0000, v16
    v_lshlrev_b32 v16, 16, v16
    v_and_b32 v19, 0xffff0000, v18
    v_lshlrev_b32 v18, 16, v18
    v_and_b32 v21, 0xffff0000, v20
    v_lshlrev_b32 v20, 16, v20
    v_and_b32 v23, 0xffff0000, v22
    v_lshlrev_b32 v22, 16, v22
    v_mul_f32 v8, v8, v8
    v_mul_f32 v9, v9, v9
    v_mul_f32 v10, v10, v10
    v_mul_f32 v11, v11, v11
    v_mul_f32 v12, v12, v12
    v_mul_f32 v13, v13, v13
    v_mul_f32 v14, v14, v14
    v_mul_f32 v15, v15, v15
    v_mul_f32 v16, v16, v16
    v_mul_f32 v17, v17, v17
    v_mul_f32 v18, v18, v18
    v_mul_f32 v19, v19, v19
    v_mul_f32 v20, v20, v20
    v_mul_f32 v21, v21, v21
    v_mul_f32 v22, v22, v22
    v_mul_f32 v23, v23, v23
    v_cvt_pk_bf16_f32 v8, v8, v9
    v_cvt_pk_bf16_f32 v10, v10, v11
    v_cvt_pk_bf16_f32 v12, v12, v13
    v_cvt_pk_bf16_f32 v14, v14, v15
    v_cvt_pk_bf16_f32 v16, v16, v17
    v_cvt_pk_bf16_f32 v18, v18, v19
    v_cvt_pk_bf16_f32 v20, v20, v21
    v_cvt_pk_bf16_f32 v22, v22, v23
    v_and_b32 v9, 0xffff0000, v8
    v_lshlrev_b32 v8, 16, v8
    v_and_b32 v11, 0xffff0000, v10
    v_lshlrev_b32 v10, 16, v10
    v_and_b32 v13, 0xffff0000, v12
    v_lshlrev_b32 v12, 16, v12
    v_and_b32 v15, 0xffff0000, v14
    v_lshlrev_b32 v14, 16, v14
    v_and_b32 v17, 0xffff0000, v16
    v_lshlrev_b32 v16, 16, v16
    v_and_b32 v19, 0xffff0000, v18
    v_lshlrev_b32 v18, 16, v18
    v_and_b32 v21, 0xffff0000, v20
    v_lshlrev_b32 v20, 16, v20
    v_and_b32 v23, 0xffff0000, v22
    v_lshlrev_b32 v22, 16, v22
    v_mul_f32 v8, 0xc1200000, v8
    v_mul_f32 v9, 0xc1200000, v9
    v_mul_f32 v10, 0xc1200000, v10
    v_mul_f32 v11, 0xc1200000, v11
    v_mul_f32 v12, 0xc1200000, v12
    v_mul_f32 v13, 0xc1200000, v13
    v_mul_f32 v14, 0xc1200000, v14
    v_mul_f32 v15, 0xc1200000, v15
    v_mul_f32 v16, 0xc1200000, v16
    v_mul_f32 v17, 0xc1200000, v17
    v_mul_f32 v18, 0xc1200000, v18
    v_mul_f32 v19, 0xc1200000, v19
    v_mul_f32 v20, 0xc1200000, v20
    v_mul_f32 v21, 0xc1200000, v21
    v_mul_f32 v22, 0xc1200000, v22
    v_mul_f32 v23, 0xc1200000, v23
    v_cvt_pk_bf16_f32 v8, v8, v9
    v_cvt_pk_bf16_f32 v10, v10, v11
    v_cvt_pk_bf16_f32 v12, v12, v13
    v_cvt_pk_bf16_f32 v14, v14, v15
    v_cvt_pk_bf16_f32 v16, v16, v17
    v_cvt_pk_bf16_f32 v18, v18, v19
    v_cvt_pk_bf16_f32 v20, v20, v21
    v_cvt_pk_bf16_f32 v22, v22, v23
    v_and_b32 v9, 0xffff0000, v8
    v_lshlrev_b32 v8, 16, v8
    v_and_b32 v11, 0xffff0000, v10
    v_lshlrev_b32 v10, 16, v10
    v_and_b32 v13, 0xffff0000, v12
    v_lshlrev_b32 v12, 16, v12
    v_and_b32 v15, 0xffff0000, v14
    v_lshlrev_b32 v14, 16, v14
    v_and_b32 v17, 0xffff0000, v16
    v_lshlrev_b32 v16, 16, v16
    v_and_b32 v19, 0xffff0000, v18
    v_lshlrev_b32 v18, 16, v18
    v_and_b32 v21, 0xffff0000, v20
    v_lshlrev_b32 v20, 16, v20
    v_and_b32 v23, 0xffff0000, v22
    v_lshlrev_b32 v22, 16, v22
    v_mul_f32 v8, 0x3fb8aa3b, v8
    v_mul_f32 v9, 0x3fb8aa3b, v9
    v_mul_f32 v10, 0x3fb8aa3b, v10
    v_mul_f32 v11, 0x3fb8aa3b, v11
    v_mul_f32 v12, 0x3fb8aa3b, v12
    v_mul_f32 v13, 0x3fb8aa3b, v13
    v_mul_f32 v14, 0x3fb8aa3b, v14
    v_mul_f32 v15, 0x3fb8aa3b, v15
    v_mul_f32 v16, 0x3fb8aa3b, v16
    v_mul_f32 v17, 0x3fb8aa3b, v17
    v_mul_f32 v18, 0x3fb8aa3b, v18
    v_mul_f32 v19, 0x3fb8aa3b, v19
    v_mul_f32 v20, 0x3fb8aa3b, v20
    v_mul_f32 v21, 0x3fb8aa3b, v21
    v_mul_f32 v22, 0x3fb8aa3b, v22
    v_mul_f32 v23, 0x3fb8aa3b, v23
    v_exp_f32 v8, v8
    v_exp_f32 v9, v9
    v_exp_f32 v10, v10
    v_exp_f32 v11, v11
    v_exp_f32 v12, v12
    v_exp_f32 v13, v13
    v_exp_f32 v14, v14
    v_exp_f32 v15, v15
    v_exp_f32 v16, v16
    v_exp_f32 v17, v17
    v_exp_f32 v18, v18
    v_exp_f32 v19, v19
    v_exp_f32 v20, v20
    v_exp_f32 v21, v21
    v_exp_f32 v22, v22
    v_exp_f32 v23, v23
    s_nop 0
    v_cvt_pk_bf16_f32 v8, v8, v9
    v_cvt_pk_bf16_f32 v10, v10, v11
    v_cvt_pk_bf16_f32 v12, v12, v13
    v_cvt_pk_bf16_f32 v14, v14, v15
    v_cvt_pk_bf16_f32 v16, v16, v17
    v_cvt_pk_bf16_f32 v18, v18, v19
    v_cvt_pk_bf16_f32 v20, v20, v21
    v_cvt_pk_bf16_f32 v22, v22, v23
    v_and_b32 v9, 0xffff0000, v8
    v_lshlrev_b32 v8, 16, v8
    v_and_b32 v11, 0xffff0000, v10
    v_lshlrev_b32 v10, 16, v10
    v_and_b32 v13, 0xffff0000, v12
    v_lshlrev_b32 v12, 16, v12
    v_and_b32 v15, 0xffff0000, v14
    v_lshlrev_b32 v14, 16, v14
    v_and_b32 v17, 0xffff0000, v16
    v_lshlrev_b32 v16, 16, v16
    v_and_b32 v19, 0xffff0000, v18
    v_lshlrev_b32 v18, 16, v18
    v_and_b32 v21, 0xffff0000, v20
    v_lshlrev_b32 v20, 16, v20
    v_and_b32 v23, 0xffff0000, v22
    v_lshlrev_b32 v22, 16, v22
    s_lshl_b32 s14, s52, 16
    s_and_b32 s15, s52, 0xffff0000
    v_pk_mul_f32 v[24:25], v[8:9], s[14:15] op_sel:[0,0] op_sel_hi:[0,1]
    v_pk_mul_f32 v[28:29], v[16:17], s[14:15] op_sel:[0,0] op_sel_hi:[0,1]
    s_lshl_b32 s16, s53, 16
    s_and_b32 s17, s53, 0xffff0000
    v_pk_mul_f32 v[26:27], v[8:9], s[16:17] op_sel:[0,0] op_sel_hi:[0,1]
    v_pk_mul_f32 v[30:31], v[16:17], s[16:17] op_sel:[0,0] op_sel_hi:[0,1]
    s_lshl_b32 s18, s54, 16
    s_and_b32 s19, s54, 0xffff0000
    v_pk_fma_f32 v[24:25], v[8:9], s[18:19], v[24:25] op_sel:[1,0,0] op_sel_hi:[1,1,1]
    v_pk_fma_f32 v[28:29], v[16:17], s[18:19], v[28:29] op_sel:[1,0,0] op_sel_hi:[1,1,1]
    s_lshl_b32 s12, s55, 16
    s_and_b32 s13, s55, 0xffff0000
    v_pk_fma_f32 v[26:27], v[8:9], s[12:13], v[26:27] op_sel:[1,0,0] op_sel_hi:[1,1,1]
    v_pk_fma_f32 v[30:31], v[16:17], s[12:13], v[30:31] op_sel:[1,0,0] op_sel_hi:[1,1,1]
    s_lshl_b32 s14, s56, 16
    s_and_b32 s15, s56, 0xffff0000
    v_pk_fma_f32 v[24:25], v[10:11], s[14:15], v[24:25] op_sel:[0,0,0] op_sel_hi:[0,1,1]
    v_pk_fma_f32 v[28:29], v[18:19], s[14:15], v[28:29] op_sel:[0,0,0] op_sel_hi:[0,1,1]
    s_lshl_b32 s16, s57, 16
    s_and_b32 s17, s57, 0xffff0000
    v_pk_fma_f32 v[26:27], v[10:11], s[16:17], v[26:27] op_sel:[0,0,0] op_sel_hi:[0,1,1]
    v_pk_fma_f32 v[30:31], v[18:19], s[16:17], v[30:31] op_sel:[0,0,0] op_sel_hi:[0,1,1]
    s_lshl_b32 s18, s58, 16
    s_and_b32 s19, s58, 0xffff0000
    v_pk_fma_f32 v[24:25], v[10:11], s[18:19], v[24:25] op_sel:[1,0,0] op_sel_hi:[1,1,1]
    v_pk_fma_f32 v[28:29], v[18:19], s[18:19], v[28:29] op_sel:[1,0,0] op_sel_hi:[1,1,1]
    s_lshl_b32 s12, s59, 16
    s_and_b32 s13, s59, 0xffff0000
    v_pk_fma_f32 v[26:27], v[10:11], s[12:13], v[26:27] op_sel:[1,0,0] op_sel_hi:[1,1,1]
    v_pk_fma_f32 v[30:31], v[18:19], s[12:13], v[30:31] op_sel:[1,0,0] op_sel_hi:[1,1,1]
    s_lshl_b32 s14, s60, 16
    s_and_b32 s15, s60, 0xffff0000
    v_pk_fma_f32 v[24:25], v[12:13], s[14:15], v[24:25] op_sel:[0,0,0] op_sel_hi:[0,1,1]
    v_pk_fma_f32 v[28:29], v[20:21], s[14:15], v[28:29] op_sel:[0,0,0] op_sel_hi:[0,1,1]
    s_lshl_b32 s16, s61, 16
    s_and_b32 s17, s61, 0xffff0000
    v_pk_fma_f32 v[26:27], v[12:13], s[16:17], v[26:27] op_sel:[0,0,0] op_sel_hi:[0,1,1]
    v_pk_fma_f32 v[30:31], v[20:21], s[16:17], v[30:31] op_sel:[0,0,0] op_sel_hi:[0,1,1]
    s_lshl_b32 s18, s62, 16
    s_and_b32 s19, s62, 0xffff0000
    v_pk_fma_f32 v[24:25], v[12:13], s[18:19], v[24:25] op_sel:[1,0,0] op_sel_hi:[1,1,1]
    v_pk_fma_f32 v[28:29], v[20:21], s[18:19], v[28:29] op_sel:[1,0,0] op_sel_hi:[1,1,1]
    s_lshl_b32 s12, s63, 16
    s_and_b32 s13, s63, 0xffff0000
    v_pk_fma_f32 v[26:27], v[12:13], s[12:13], v[26:27] op_sel:[1,0,0] op_sel_hi:[1,1,1]
    v_pk_fma_f32 v[30:31], v[20:21], s[12:13], v[30:31] op_sel:[1,0,0] op_sel_hi:[1,1,1]
    s_lshl_b32 s14, s64, 16
    s_and_b32 s15, s64, 0xffff0000
    v_pk_fma_f32 v[24:25], v[14:15], s[14:15], v[24:25] op_sel:[0,0,0] op_sel_hi:[0,1,1]
    v_pk_fma_f32 v[28:29], v[22:23], s[14:15], v[28:29] op_sel:[0,0,0] op_sel_hi:[0,1,1]
    s_lshl_b32 s16, s65, 16
    s_and_b32 s17, s65, 0xffff0000
    v_pk_fma_f32 v[26:27], v[14:15], s[16:17], v[26:27] op_sel:[0,0,0] op_sel_hi:[0,1,1]
    v_pk_fma_f32 v[30:31], v[22:23], s[16:17], v[30:31] op_sel:[0,0,0] op_sel_hi:[0,1,1]
    s_lshl_b32 s18, s66, 16
    s_and_b32 s19, s66, 0xffff0000
    v_pk_fma_f32 v[24:25], v[14:15], s[18:19], v[24:25] op_sel:[1,0,0] op_sel_hi:[1,1,1]
    v_pk_fma_f32 v[28:29], v[22:23], s[18:19], v[28:29] op_sel:[1,0,0] op_sel_hi:[1,1,1]
    s_lshl_b32 s12, s67, 16
    s_and_b32 s13, s67, 0xffff0000
    v_pk_fma_f32 v[26:27], v[14:15], s[12:13], v[26:27] op_sel:[1,0,0] op_sel_hi:[1,1,1]
    v_pk_fma_f32 v[30:31], v[22:23], s[12:13], v[30:31] op_sel:[1,0,0] op_sel_hi:[1,1,1]
    s_lshl_b32 s14, s36, 16
    s_and_b32 s15, s36, 0xffff0000
    v_pk_mul_f32 v[32:33], v[8:9], s[14:15] op_sel:[0,0] op_sel_hi:[0,1]
    v_pk_mul_f32 v[36:37], v[16:17], s[14:15] op_sel:[0,0] op_sel_hi:[0,1]
    s_lshl_b32 s16, s37, 16
    s_and_b32 s17, s37, 0xffff0000
    v_pk_mul_f32 v[34:35], v[8:9], s[16:17] op_sel:[0,0] op_sel_hi:[0,1]
    v_pk_mul_f32 v[38:39], v[16:17], s[16:17] op_sel:[0,0] op_sel_hi:[0,1]
    s_lshl_b32 s18, s38, 16
    s_and_b32 s19, s38, 0xffff0000
    v_pk_fma_f32 v[32:33], v[8:9], s[18:19], v[32:33] op_sel:[1,0,0] op_sel_hi:[1,1,1]
    v_pk_fma_f32 v[36:37], v[16:17], s[18:19], v[36:37] op_sel:[1,0,0] op_sel_hi:[1,1,1]
    s_lshl_b32 s12, s39, 16
    s_and_b32 s13, s39, 0xffff0000
    v_pk_fma_f32 v[34:35], v[8:9], s[12:13], v[34:35] op_sel:[1,0,0] op_sel_hi:[1,1,1]
    v_pk_fma_f32 v[38:39], v[16:17], s[12:13], v[38:39] op_sel:[1,0,0] op_sel_hi:[1,1,1]
    s_lshl_b32 s14, s40, 16
    s_and_b32 s15, s40, 0xffff0000
    v_pk_fma_f32 v[32:33], v[10:11], s[14:15], v[32:33] op_sel:[0,0,0] op_sel_hi:[0,1,1]
    v_pk_fma_f32 v[36:37], v[18:19], s[14:15], v[36:37] op_sel:[0,0,0] op_sel_hi:[0,1,1]
    s_lshl_b32 s16, s41, 16
    s_and_b32 s17, s41, 0xffff0000
    v_pk_fma_f32 v[34:35], v[10:11], s[16:17], v[34:35] op_sel:[0,0,0] op_sel_hi:[0,1,1]
    v_pk_fma_f32 v[38:39], v[18:19], s[16:17], v[38:39] op_sel:[0,0,0] op_sel_hi:[0,1,1]
    s_lshl_b32 s18, s42, 16
    s_and_b32 s19, s42, 0xffff0000
    v_pk_fma_f32 v[32:33], v[10:11], s[18:19], v[32:33] op_sel:[1,0,0] op_sel_hi:[1,1,1]
    v_pk_fma_f32 v[36:37], v[18:19], s[18:19], v[36:37] op_sel:[1,0,0] op_sel_hi:[1,1,1]
    s_lshl_b32 s12, s43, 16
    s_and_b32 s13, s43, 0xffff0000
    v_pk_fma_f32 v[34:35], v[10:11], s[12:13], v[34:35] op_sel:[1,0,0] op_sel_hi:[1,1,1]
    v_pk_fma_f32 v[38:39], v[18:19], s[12:13], v[38:39] op_sel:[1,0,0] op_sel_hi:[1,1,1]
    s_lshl_b32 s14, s44, 16
    s_and_b32 s15, s44, 0xffff0000
    v_pk_fma_f32 v[32:33], v[12:13], s[14:15], v[32:33] op_sel:[0,0,0] op_sel_hi:[0,1,1]
    v_pk_fma_f32 v[36:37], v[20:21], s[14:15], v[36:37] op_sel:[0,0,0] op_sel_hi:[0,1,1]
    s_lshl_b32 s16, s45, 16
    s_and_b32 s17, s45, 0xffff0000
    v_pk_fma_f32 v[34:35], v[12:13], s[16:17], v[34:35] op_sel:[0,0,0] op_sel_hi:[0,1,1]
    v_pk_fma_f32 v[38:39], v[20:21], s[16:17], v[38:39] op_sel:[0,0,0] op_sel_hi:[0,1,1]
    s_lshl_b32 s18, s46, 16
    s_and_b32 s19, s46, 0xffff0000
    v_pk_fma_f32 v[32:33], v[12:13], s[18:19], v[32:33] op_sel:[1,0,0] op_sel_hi:[1,1,1]
    v_pk_fma_f32 v[36:37], v[20:21], s[18:19], v[36:37] op_sel:[1,0,0] op_sel_hi:[1,1,1]
    s_lshl_b32 s12, s47, 16
    s_and_b32 s13, s47, 0xffff0000
    v_pk_fma_f32 v[34:35], v[12:13], s[12:13], v[34:35] op_sel:[1,0,0] op_sel_hi:[1,1,1]
    v_pk_fma_f32 v[38:39], v[20:21], s[12:13], v[38:39] op_sel:[1,0,0] op_sel_hi:[1,1,1]
    s_lshl_b32 s14, s48, 16
    s_and_b32 s15, s48, 0xffff0000
    v_pk_fma_f32 v[32:33], v[14:15], s[14:15], v[32:33] op_sel:[0,0,0] op_sel_hi:[0,1,1]
    v_pk_fma_f32 v[36:37], v[22:23], s[14:15], v[36:37] op_sel:[0,0,0] op_sel_hi:[0,1,1]
    s_lshl_b32 s16, s49, 16
    s_and_b32 s17, s49, 0xffff0000
    v_pk_fma_f32 v[34:35], v[14:15], s[16:17], v[34:35] op_sel:[0,0,0] op_sel_hi:[0,1,1]
    v_pk_fma_f32 v[38:39], v[22:23], s[16:17], v[38:39] op_sel:[0,0,0] op_sel_hi:[0,1,1]
    s_lshl_b32 s18, s50, 16
    s_and_b32 s19, s50, 0xffff0000
    v_pk_fma_f32 v[32:33], v[14:15], s[18:19], v[32:33] op_sel:[1,0,0] op_sel_hi:[1,1,1]
    v_pk_fma_f32 v[36:37], v[22:23], s[18:19], v[36:37] op_sel:[1,0,0] op_sel_hi:[1,1,1]
    s_lshl_b32 s12, s51, 16
    s_and_b32 s13, s51, 0xffff0000
    v_pk_fma_f32 v[34:35], v[14:15], s[12:13], v[34:35] op_sel:[1,0,0] op_sel_hi:[1,1,1]
    v_pk_fma_f32 v[38:39], v[22:23], s[12:13], v[38:39] op_sel:[1,0,0] op_sel_hi:[1,1,1]
    v_cvt_pk_bf16_f32 v32, v32, v33
    v_cvt_pk_bf16_f32 v34, v34, v35
    v_cvt_pk_bf16_f32 v36, v36, v37
    v_cvt_pk_bf16_f32 v38, v38, v39
    v_and_b32 v33, 0xffff0000, v32
    v_lshlrev_b32 v32, 16, v32
    v_and_b32 v35, 0xffff0000, v34
    v_lshlrev_b32 v34, 16, v34
    v_and_b32 v37, 0xffff0000, v36
    v_lshlrev_b32 v36, 16, v36
    v_and_b32 v39, 0xffff0000, v38
    v_lshlrev_b32 v38, 16, v38
    s_waitcnt vmcnt(1)
    v_add_u32 v40, v40, v44
    v_add_u32 v48, v48, v52
    v_add_u32 v41, v41, v45
    v_add_u32 v49, v49, v53
    v_add_u32 v42, v42, v46
    v_add_u32 v50, v50, v54
    v_add_u32 v43, v43, v47
    v_add_u32 v51, v51, v55
    v_add_u32_sdwa v8, v40, v48 dst_sel:DWORD dst_unused:UNUSED_PAD src0_sel:WORD_0 src1_sel:WORD_0
    v_add_u32_sdwa v9, v40, v48 dst_sel:DWORD dst_unused:UNUSED_PAD src0_sel:WORD_1 src1_sel:WORD_1
    v_add_u32_sdwa v10, v41, v49 dst_sel:DWORD dst_unused:UNUSED_PAD src0_sel:WORD_0 src1_sel:WORD_0
    v_add_u32_sdwa v11, v41, v49 dst_sel:DWORD dst_unused:UNUSED_PAD src0_sel:WORD_1 src1_sel:WORD_1
    v_add_u32_sdwa v12, v42, v50 dst_sel:DWORD dst_unused:UNUSED_PAD src0_sel:WORD_0 src1_sel:WORD_0
    v_add_u32_sdwa v13, v42, v50 dst_sel:DWORD dst_unused:UNUSED_PAD src0_sel:WORD_1 src1_sel:WORD_1
    v_add_u32_sdwa v14, v43, v51 dst_sel:DWORD dst_unused:UNUSED_PAD src0_sel:WORD_0 src1_sel:WORD_0
    v_add_u32_sdwa v15, v43, v51 dst_sel:DWORD dst_unused:UNUSED_PAD src0_sel:WORD_1 src1_sel:WORD_1
    v_min3_u32 v5, v56, v57, v58
    v_bitop3_b32 v4, v56, v57, v58 bitop3:0xfe
    v_min_u32 v5, v5, v59
    v_or_b32 v4, v4, v59
    v_or_b32 v8, 0x4b000000, v8
    v_or_b32 v9, 0x4b000000, v9
    v_or_b32 v10, 0x4b000000, v10
    v_or_b32 v11, 0x4b000000, v11
    v_or_b32 v12, 0x4b000000, v12
    v_or_b32 v13, 0x4b000000, v13
    v_or_b32 v14, 0x4b000000, v14
    v_or_b32 v15, 0x4b000000, v15
    v_cmp_eq_u32 vcc, 0, v5
    v_add_f32 v8, 0xcb010000, v8
    v_add_f32 v9, 0xcb010000, v9
    v_add_f32 v10, 0xcb010000, v10
    v_add_f32 v11, 0xcb010000, v11
    v_add_f32 v12, 0xcb010000, v12
    v_add_f32 v13, 0xcb010000, v13
    v_add_f32 v14, 0xcb010000, v14
    v_add_f32 v15, 0xcb010000, v15
    v_mul_f32 v8, v4, v8
    v_mul_f32 v9, v4, v9
    v_mul_f32 v10, v4, v10
    v_mul_f32 v11, v4, v11
    v_mul_f32 v12, v4, v12
    v_mul_f32 v13, v4, v13
    v_mul_f32 v14, v4, v14
    v_mul_f32 v15, v4, v15
    s_cbranch_vccz p3_nof
    v_lshlrev_b32 v1, 4, v0
    v_mov_b32 v3, 0x70000000
    v_cmp_eq_u32 vcc, 0, v56
    s_mov_b32 s22, 517903360
    s_nop 0
    v_cndmask_b32 v5, v3, v1, vcc
    buffer_load_dwordx4 v[16:19], v5, s[28:31], s22 offen
    buffer_load_dwordx4 v[20:23], v5, s[28:31], s22 offen offset:16
    s_waitcnt vmcnt(0)
    v_add_f32 v8, v8, v16
    v_add_f32 v9, v9, v17
    v_add_f32 v10, v10, v18
    v_add_f32 v11, v11, v19
    v_add_f32 v12, v12, v20
    v_add_f32 v13, v13, v21
    v_add_f32 v14, v14, v22
    v_add_f32 v15, v15, v23
    v_cmp_eq_u32 vcc, 0, v57
    s_mov_b32 s22, 530715648
    s_nop 0
    v_cndmask_b32 v5, v3, v1, vcc
    buffer_load_dwordx4 v[16:19], v5, s[28:31], s22 offen
    buffer_load_dwordx4 v[20:23], v5, s[28:31], s22 offen offset:16
    s_waitcnt vmcnt(0)
    v_add_f32 v8, v8, v16
    v_add_f32 v9, v9, v17
    v_add_f32 v10, v10, v18
    v_add_f32 v11, v11, v19
    v_add_f32 v12, v12, v20
    v_add_f32 v13, v13, v21
    v_add_f32 v14, v14, v22
    v_add_f32 v15, v15, v23
    v_cmp_eq_u32 vcc, 0, v58
    s_mov_b32 s22, 543527936
    s_nop 0
    v_cndmask_b32 v5, v3, v1, vcc
    buffer_load_dwordx4 v[16:19], v5, s[28:31], s22 offen
    buffer_load_dwordx4 v[20:23], v5, s[28:31], s22 offen offset:16
    s_waitcnt vmcnt(0)
    v_add_f32 v8, v8, v16
    v_add_f32 v9, v9, v17
    v_add_f32 v10, v10, v18
    v_add_f32 v11, v11, v19
    v_add_f32 v12, v12, v20
    v_add_f32 v13, v13, v21
    v_add_f32 v14, v14, v22
    v_add_f32 v15, v15, v23
    v_cmp_eq_u32 vcc, 0, v59
    s_mov_b32 s22, 556340224
    s_nop 0
    v_cndmask_b32 v5, v3, v1, vcc
    buffer_load_dwordx4 v[16:19], v5, s[28:31], s22 offen
    buffer_load_dwordx4 v[20:23], v5, s[28:31], s22 offen offset:16
    s_waitcnt vmcnt(0)
    v_add_f32 v8, v8, v16
    v_add_f32 v9, v9, v17
    v_add_f32 v10, v10, v18
    v_add_f32 v11, v11, v19
    v_add_f32 v12, v12, v20
    v_add_f32 v13, v13, v21
    v_add_f32 v14, v14, v22
    v_add_f32 v15, v15, v23
p3_nof:
    s_lshl_b32 s14, s68, 16
    s_and_b32 s15, s68, 0xffff0000
    v_pk_mul_f32 v[16:17], v[8:9], s[14:15] op_sel:[0,0] op_sel_hi:[0,1]
    v_pk_mul_f32 v[20:21], v[12:13], s[14:15] op_sel:[0,0] op_sel_hi:[0,1]
    s_lshl_b32 s16, s69, 16
    s_and_b32 s17, s69, 0xffff0000
    v_pk_mul_f32 v[18:19], v[8:9], s[16:17] op_sel:[0,0] op_sel_hi:[0,1]
    v_pk_mul_f32 v[22:23], v[12:13], s[16:17] op_sel:[0,0] op_sel_hi:[0,1]
    s_lshl_b32 s18, s70, 16
    s_and_b32 s19, s70, 0xffff0000
    v_pk_fma_f32 v[16:17], v[8:9], s[18:19], v[16:17] op_sel:[1,0,0] op_sel_hi:[1,1,1]
    v_pk_fma_f32 v[20:21], v[12:13], s[18:19], v[20:21] op_sel:[1,0,0] op_sel_hi:[1,1,1]
    s_lshl_b32 s12, s71, 16
    s_and_b32 s13, s71, 0xffff0000
    v_pk_fma_f32 v[18:19], v[8:9], s[12:13], v[18:19] op_sel:[1,0,0] op_sel_hi:[1,1,1]
    v_pk_fma_f32 v[22:23], v[12:13], s[12:13], v[22:23] op_sel:[1,0,0] op_sel_hi:[1,1,1]
    s_lshl_b32 s14, s72, 16
    s_and_b32 s15, s72, 0xffff0000
    v_pk_fma_f32 v[16:17], v[10:11], s[14:15], v[16:17] op_sel:[0,0,0] op_sel_hi:[0,1,1]
    v_pk_fma_f32 v[20:21], v[14:15], s[14:15], v[20:21] op_sel:[0,0,0] op_sel_hi:[0,1,1]
    s_lshl_b32 s16, s73, 16
    s_and_b32 s17, s73, 0xffff0000
    v_pk_fma_f32 v[18:19], v[10:11], s[16:17], v[18:19] op_sel:[0,0,0] op_sel_hi:[0,1,1]
    v_pk_fma_f32 v[22:23], v[14:15], s[16:17], v[22:23] op_sel:[0,0,0] op_sel_hi:[0,1,1]
    s_lshl_b32 s18, s74, 16
    s_and_b32 s19, s74, 0xffff0000
    v_pk_fma_f32 v[16:17], v[10:11], s[18:19], v[16:17] op_sel:[1,0,0] op_sel_hi:[1,1,1]
    v_pk_fma_f32 v[20:21], v[14:15], s[18:19], v[20:21] op_sel:[1,0,0] op_sel_hi:[1,1,1]
    s_lshl_b32 s12, s75, 16
    s_and_b32 s13, s75, 0xffff0000
    v_pk_fma_f32 v[18:19], v[10:11], s[12:13], v[18:19] op_sel:[1,0,0] op_sel_hi:[1,1,1]
    v_pk_fma_f32 v[22:23], v[14:15], s[12:13], v[22:23] op_sel:[1,0,0] op_sel_hi:[1,1,1]
    v_mul_f32 v24, v24, v16
    v_mul_f32 v25, v25, v17
    v_mul_f32 v26, v26, v18
    v_mul_f32 v27, v27, v19
    v_mul_f32 v28, v28, v20
    v_mul_f32 v29, v29, v21
    v_mul_f32 v30, v30, v22
    v_mul_f32 v31, v31, v23
    v_cvt_pk_bf16_f32 v24, v24, v25
    v_cvt_pk_bf16_f32 v26, v26, v27
    v_cvt_pk_bf16_f32 v28, v28, v29
    v_cvt_pk_bf16_f32 v30, v30, v31
    v_and_b32 v25, 0xffff0000, v24
    v_lshlrev_b32 v24, 16, v24
    v_and_b32 v27, 0xffff0000, v26
    v_lshlrev_b32 v26, 16, v26
    v_and_b32 v29, 0xffff0000, v28
    v_lshlrev_b32 v28, 16, v28
    v_and_b32 v31, 0xffff0000, v30
    v_lshlrev_b32 v30, 16, v30
    s_lshl_b32 s14, s76, 16
    s_and_b32 s15, s76, 0xffff0000
    v_pk_mul_f32 v[16:17], v[24:25], s[14:15] op_sel:[0,0] op_sel_hi:[0,1]
    v_pk_mul_f32 v[20:21], v[28:29], s[14:15] op_sel:[0,0] op_sel_hi:[0,1]
    s_lshl_b32 s16, s77, 16
    s_and_b32 s17, s77, 0xffff0000
    v_pk_mul_f32 v[18:19], v[24:25], s[16:17] op_sel:[0,0] op_sel_hi:[0,1]
    v_pk_mul_f32 v[22:23], v[28:29], s[16:17] op_sel:[0,0] op_sel_hi:[0,1]
    s_lshl_b32 s18, s78, 16
    s_and_b32 s19, s78, 0xffff0000
    v_pk_fma_f32 v[16:17], v[24:25], s[18:19], v[16:17] op_sel:[1,0,0] op_sel_hi:[1,1,1]
    v_pk_fma_f32 v[20:21], v[28:29], s[18:19], v[20:21] op_sel:[1,0,0] op_sel_hi:[1,1,1]
    s_lshl_b32 s12, s79, 16
    s_and_b32 s13, s79, 0xffff0000
    v_pk_fma_f32 v[18:19], v[24:25], s[12:13], v[18:19] op_sel:[1,0,0] op_sel_hi:[1,1,1]
    v_pk_fma_f32 v[22:23], v[28:29], s[12:13], v[22:23] op_sel:[1,0,0] op_sel_hi:[1,1,1]
    s_lshl_b32 s14, s80, 16
    s_and_b32 s15, s80, 0xffff0000
    v_pk_fma_f32 v[16:17], v[26:27], s[14:15], v[16:17] op_sel:[0,0,0] op_sel_hi:[0,1,1]
    v_pk_fma_f32 v[20:21], v[30:31], s[14:15], v[20:21] op_sel:[0,0,0] op_sel_hi:[0,1,1]
    s_lshl_b32 s16, s81, 16
    s_and_b32 s17, s81, 0xffff0000
    v_pk_fma_f32 v[18:19], v[26:27], s[16:17], v[18:19] op_sel:[0,0,0] op_sel_hi:[0,1,1]
    v_pk_fma_f32 v[22:23], v[30:31], s[16:17], v[22:23] op_sel:[0,0,0] op_sel_hi:[0,1,1]
    s_lshl_b32 s18, s82, 16
    s_and_b32 s19, s82, 0xffff0000
    v_pk_fma_f32 v[16:17], v[26:27], s[18:19], v[16:17] op_sel:[1,0,0] op_sel_hi:[1,1,1]
    v_pk_fma_f32 v[20:21], v[30:31], s[18:19], v[20:21] op_sel:[1,0,0] op_sel_hi:[1,1,1]
    s_lshl_b32 s12, s83, 16
    s_and_b32 s13, s83, 0xffff0000
    v_pk_fma_f32 v[18:19], v[26:27], s[12:13], v[18:19] op_sel:[1,0,0] op_sel_hi:[1,1,1]
    v_pk_fma_f32 v[22:23], v[30:31], s[12:13], v[22:23] op_sel:[1,0,0] op_sel_hi:[1,1,1]
    v_cvt_pk_bf16_f32 v16, v16, v17
    v_cvt_pk_bf16_f32 v18, v18, v19
    v_cvt_pk_bf16_f32 v20, v20, v21
    v_cvt_pk_bf16_f32 v22, v22, v23
    v_and_b32 v17, 0xffff0000, v16
    v_lshlrev_b32 v16, 16, v16
    v_and_b32 v19, 0xffff0000, v18
    v_lshlrev_b32 v18, 16, v18
    v_and_b32 v21, 0xffff0000, v20
    v_lshlrev_b32 v20, 16, v20
    v_and_b32 v23, 0xffff0000, v22
    v_lshlrev_b32 v22, 16, v22
    v_mul_f32 v16, v16, v32
    v_mul_f32 v17, v17, v33
    v_mul_f32 v18, v18, v34
    v_mul_f32 v19, v19, v35
    v_mul_f32 v20, v20, v36
    v_mul_f32 v21, v21, v37
    v_mul_f32 v22, v22, v38
    v_mul_f32 v23, v23, v39
    v_cvt_pk_bf16_f32 v16, v16, v17
    v_cvt_pk_bf16_f32 v18, v18, v19
    v_cvt_pk_bf16_f32 v20, v20, v21
    v_cvt_pk_bf16_f32 v22, v22, v23
    v_and_b32 v17, 0xffff0000, v16
    v_lshlrev_b32 v16, 16, v16
    v_and_b32 v19, 0xffff0000, v18
    v_lshlrev_b32 v18, 16, v18
    v_and_b32 v21, 0xffff0000, v20
    v_lshlrev_b32 v20, 16, v20
    v_and_b32 v23, 0xffff0000, v22
    v_lshlrev_b32 v22, 16, v22
    s_waitcnt vmcnt(0)
    v_lshlrev_b32 v8, 16, v60
    v_and_b32 v9, 0xffff0000, v60
    v_lshlrev_b32 v10, 16, v61
    v_and_b32 v11, 0xffff0000, v61
    v_lshlrev_b32 v12, 16, v62
    v_and_b32 v13, 0xffff0000, v62
    v_lshlrev_b32 v14, 16, v63
    v_and_b32 v15, 0xffff0000, v63
    v_add_f32 v8, v8, v16
    v_add_f32 v9, v9, v17
    v_add_f32 v10, v10, v18
    v_add_f32 v11, v11, v19
    v_add_f32 v12, v12, v20
    v_add_f32 v13, v13, v21
    v_add_f32 v14, v14, v22
    v_add_f32 v15, v15, v23
    v_cvt_pk_bf16_f32 v4, v8, v9
    v_cvt_pk_bf16_f32 v5, v10, v11
    v_cvt_pk_bf16_f32 v6, v12, v13
    v_cvt_pk_bf16_f32 v7, v14, v15
    buffer_store_dwordx4 v[4:7], v2, s[24:27], 0 offen nt
p3_end:
    s_endpgm
.section .rodata,"a"
.p2align 6
.amdhsa_kernel p1_kernel
  .amdhsa_next_free_vgpr 128
  .amdhsa_next_free_sgpr 72
  .amdhsa_accum_offset 128
  .amdhsa_group_segment_fixed_size 0
  .amdhsa_kernarg_size 112
  .amdhsa_user_sgpr_count 2
  .amdhsa_user_sgpr_kernarg_segment_ptr 1
  .amdhsa_system_sgpr_workgroup_id_x 1
  .amdhsa_float_denorm_mode_32 3
.end_amdhsa_kernel
.p2align 6
.amdhsa_kernel p2_kernel
  .amdhsa_next_free_vgpr 128
  .amdhsa_next_free_sgpr 72
  .amdhsa_accum_offset 128
  .amdhsa_group_segment_fixed_size 0
  .amdhsa_kernarg_size 112
  .amdhsa_user_sgpr_count 2
  .amdhsa_user_sgpr_kernarg_segment_ptr 1
  .amdhsa_system_sgpr_workgroup_id_x 1
  .amdhsa_float_denorm_mode_32 3
.end_amdhsa_kernel
.p2align 6
.amdhsa_kernel p3_kernel
  .amdhsa_next_free_vgpr 64
  .amdhsa_next_free_sgpr 84
  .amdhsa_accum_offset 64
  .amdhsa_group_segment_fixed_size 0
  .amdhsa_kernarg_size 112
  .amdhsa_user_sgpr_count 2
  .amdhsa_user_sgpr_kernarg_segment_ptr 1
  .amdhsa_system_sgpr_workgroup_id_x 1
  .amdhsa_float_denorm_mode_32 3
.end_amdhsa_kernel
```

```asm
; @launch kernel=p1_kernel grid=(256,1,1) block=(1024,1,1) lds=163072
; @launch kernel=p2_kernel grid=(256,1,1) block=(1024,1,1) lds=154368
; @launch kernel=p3_kernel grid=(1563,1,1) block=(256,1,1) lds=0
.amdgcn_target "amdgcn-amd-amdhsa--gfx950"
.text
.globl p1_kernel
.p2align 8
.type p1_kernel,@function
p1_kernel:
    s_cmp_ge_u32 s2, 256
    s_cbranch_scc1 p1_end
    s_load_dwordx2 s[52:53], s[0:1], 0
    s_load_dwordx4 s[56:59], s[0:1], 8
    s_load_dwordx2 s[54:55], s[0:1], 32
    s_load_dwordx2 s[60:61], s[0:1], 48
    s_load_dwordx2 s[48:49], s[0:1], 104
    s_load_dwordx2 s[62:63], s[0:1], 96
    v_lshlrev_b32 v1, 4, v0
    v_lshlrev_b32 v2, 3, v0
    v_mov_b32 v3, 1
    v_lshrrev_b32 v117, 6, v0
    s_nop 0
    v_readfirstlane_b32 s28, v117
    s_waitcnt lgkmcnt(0)
    s_load_dword s45, s[60:61], 0
    s_mov_b32 s4, s56
    s_and_b32 s5, s57, 0xffff
    s_mov_b32 s6, 204800000
    s_mov_b32 s7, 0x20000
    s_mov_b32 s8, s58
    s_and_b32 s9, s59, 0xffff
    s_mov_b32 s10, 204800000
    s_mov_b32 s11, 0x20000
    s_mov_b32 s12, s54
    s_and_b32 s13, s55, 0xffff
    s_mov_b32 s14, 102400000
    s_mov_b32 s15, 0x20000
    s_mov_b32 s16, s48
    s_and_b32 s17, s49, 0xffff
    s_mov_b32 s18, 819200000
    s_mov_b32 s19, 0x20000
    s_mov_b32 s29, s2
    s_mul_i32 s31, s2, 73728
    s_lshl_b32 s30, s31, 1
    s_add_u32 s32, s30, 0
    buffer_load_dwordx4 v[94:97], v1, s[4:7], s32 offen nt
    buffer_load_dwordx4 v[102:105], v1, s[8:11], s32 offen nt
    s_add_u32 s32, s31, 0
    buffer_load_dwordx2 v[76:77], v2, s[12:15], s32 offen nt
    s_add_u32 s32, s30, 16384
    buffer_load_dwordx4 v[98:101], v1, s[4:7], s32 offen nt
    buffer_load_dwordx4 v[106:109], v1, s[8:11], s32 offen nt
    s_add_u32 s32, s31, 8192
    buffer_load_dwordx2 v[78:79], v2, s[12:15], s32 offen nt
    s_add_u32 s32, s30, 32768
    buffer_load_dwordx4 v[12:15], v1, s[4:7], s32 offen nt
    buffer_load_dwordx4 v[48:51], v1, s[8:11], s32 offen nt
    s_add_u32 s32, s31, 16384
    buffer_load_dwordx2 v[80:81], v2, s[12:15], s32 offen nt
    s_add_u32 s32, s31, 24576
    buffer_load_dwordx2 v[82:83], v2, s[12:15], s32 offen nt
    s_add_u32 s32, s31, 32768
    buffer_load_dwordx2 v[84:85], v2, s[12:15], s32 offen nt
    s_add_u32 s32, s31, 40960
    buffer_load_dwordx2 v[86:87], v2, s[12:15], s32 offen nt
    s_add_u32 s32, s31, 49152
    buffer_load_dwordx2 v[88:89], v2, s[12:15], s32 offen nt
    s_add_u32 s32, s31, 57344
    buffer_load_dwordx2 v[90:91], v2, s[12:15], s32 offen nt
    s_add_u32 s32, s31, 65536
    buffer_load_dwordx2 v[92:93], v2, s[12:15], s32 offen nt
    s_mov_b32 s24, s52
    s_and_b32 s25, s53, 0xffff
    s_mov_b32 s26, 6400000
    s_mov_b32 s27, 0x20000
    s_mov_b32 s20, s48
    s_and_b32 s21, s49, 0xffff
    s_mov_b32 s22, 0
    s_mov_b32 s23, 0x20000
    s_mov_b32 s40, s62
    s_and_b32 s41, s63, 0xffff
    s_mov_b32 s42, 256
    s_mov_b32 s43, 0x20000
    s_mov_b32 s36, 643827
    s_mov_b32 s37, 214609
    s_mov_b32 s38, 343268
    s_mov_b32 s39, -6671
    s_mov_b32 s44, -12512
    s_mov_b32 s34, 1
    v_mov_b32 v73, 0x40000000
    v_mov_b32 v122, 0
    v_mov_b32 v123, 0
    v_mov_b32 v124, 0
    v_mov_b32 v125, 0
    ds_write_b128 v1, v[122:125] offset:0
    s_waitcnt lgkmcnt(0)
    s_barrier
    s_lshl_b32 s45, s45, 16
p1_tile:
    v_mov_b32 v122, 0
    v_mov_b32 v123, 0
    v_mov_b32 v124, 0
    v_mov_b32 v125, 0
    ds_write_b128 v1, v[122:125] offset:10496
    ds_write_b128 v1, v[122:125] offset:26880
    ds_write_b128 v1, v[122:125] offset:43264
    s_cmp_lg_u32 s28, 15
    s_cbranch_scc1 p1_tk0
    v_mov_b32 v127, 1
    s_mov_b64 exec, 1
    buffer_atomic_add v127, off, s[40:43], 0 offset:128 sc0 sc1
    s_mov_b64 exec, -1
p1_tk0:
    v_mov_b32 v123, s45
    v_mov_b32 v124, 0x007f007f
    v_mov_b32 v125, 0xe000
    v_mov_b32 v126, 0xffff0000
    s_cmp_lt_u32 s29, 1426
    s_cselect_b32 s6, 204800000, 0
    s_cselect_b32 s10, 204800000, 0
    s_add_u32 s32, s30, 49152
    buffer_load_dwordx4 v[16:19], v1, s[4:7], s32 offen nt
    buffer_load_dwordx4 v[52:55], v1, s[8:11], s32 offen nt
    s_waitcnt vmcnt(14)
    v_lshlrev_b32 v117, 16, v76
    v_and_b32 v118, v126, v76
    v_mul_f32 v117, v123, v117
    v_mul_f32 v118, v123, v118
    v_cvt_pk_bf16_f32 v117, v117, v118
    v_and_b32 v118, v126, v117
    v_lshlrev_b32 v117, 16, v117
    v_mul_f32 v117, 0.15915494, v117
    v_mul_f32 v118, 0.15915494, v118
    v_fract_f32 v117, v117
    v_fract_f32 v118, v118
    v_cos_f32 v117, v117
    v_cos_f32 v118, v118
    v_mul_hi_u32_u24 v122, s38, v102
    v_mul_hi_u32_u24 v121, s37, v94
    v_mul_hi_u32_u24 v120, s36, v94
    v_mad_i32_i24 v110, v122, s44, v102
    v_mad_u32_u24 v40, v122, 40, v121
    v_mad_i32_i24 v4, v120, s39, v94
    v_lshlrev_b16 v40, 2, v40
    v_mad_i32_i24 v120, v121, -3, v120
    ds_add_u32 v40, v3 offset:0
    v_lshl_or_b32 v4, v110, 16, v4
    v_lshl_or_b32 v4, v120, 30, v4
    v_mul_f32 v117, 0x03800000, v117
    v_mul_f32 v118, 0x03800000, v118
    v_cvt_pk_bf16_f32 v117, v117, v118
    v_mul_hi_u32_u24 v122, s38, v103
    v_mul_hi_u32_u24 v121, s37, v95
    v_mul_hi_u32_u24 v120, s36, v95
    v_mad_i32_i24 v110, v122, s44, v103
    v_mad_u32_u24 v41, v122, 40, v121
    v_mad_i32_i24 v5, v120, s39, v95
    v_lshlrev_b16 v41, 2, v41
    v_mad_i32_i24 v120, v121, -3, v120
    ds_add_u32 v41, v3 offset:0
    v_lshl_or_b32 v5, v110, 16, v5
    v_lshl_or_b32 v5, v120, 30, v5
    v_lshrrev_b32 v118, 3, v117
    v_lshrrev_b32 v119, 8, v117
    v_lshlrev_b16 v117, 13, v117
    v_bitop3_b32 v119, v118, v119, v124 bitop3:0x1b
    v_bitop3_b32 v4, v117, v125, v4 bitop3:0xae
    v_lshl_or_b32 v40, v119, 16, v40
    v_bitop3_b32 v5, v118, v125, v5 bitop3:0xae
    v_bitop3_b32 v41, v119, v126, v41 bitop3:0xea
    v_lshlrev_b32 v117, 16, v77
    v_and_b32 v118, v126, v77
    v_mul_f32 v117, v123, v117
    v_mul_f32 v118, v123, v118
    v_cvt_pk_bf16_f32 v117, v117, v118
    v_and_b32 v118, v126, v117
    v_lshlrev_b32 v117, 16, v117
    v_mul_f32 v117, 0.15915494, v117
    v_mul_f32 v118, 0.15915494, v118
    v_fract_f32 v117, v117
    v_fract_f32 v118, v118
    v_cos_f32 v117, v117
    v_cos_f32 v118, v118
    v_mul_hi_u32_u24 v122, s38, v104
    v_mul_hi_u32_u24 v121, s37, v96
    v_mul_hi_u32_u24 v120, s36, v96
    v_mad_i32_i24 v110, v122, s44, v104
    v_mad_u32_u24 v42, v122, 40, v121
    v_mad_i32_i24 v6, v120, s39, v96
    v_lshlrev_b16 v42, 2, v42
    v_mad_i32_i24 v120, v121, -3, v120
    ds_add_u32 v42, v3 offset:0
    v_lshl_or_b32 v6, v110, 16, v6
    v_lshl_or_b32 v6, v120, 30, v6
    v_mul_f32 v117, 0x03800000, v117
    v_mul_f32 v118, 0x03800000, v118
    v_cvt_pk_bf16_f32 v117, v117, v118
    v_mul_hi_u32_u24 v122, s38, v105
    v_mul_hi_u32_u24 v121, s37, v97
    v_mul_hi_u32_u24 v120, s36, v97
    v_mad_i32_i24 v110, v122, s44, v105
    v_mad_u32_u24 v43, v122, 40, v121
    v_mad_i32_i24 v7, v120, s39, v97
    v_lshlrev_b16 v43, 2, v43
    v_mad_i32_i24 v120, v121, -3, v120
    ds_add_u32 v43, v3 offset:0
    v_lshl_or_b32 v7, v110, 16, v7
    v_lshl_or_b32 v7, v120, 30, v7
    v_lshrrev_b32 v118, 3, v117
    v_lshrrev_b32 v119, 8, v117
    v_lshlrev_b16 v117, 13, v117
    v_bitop3_b32 v119, v118, v119, v124 bitop3:0x1b
    v_bitop3_b32 v6, v117, v125, v6 bitop3:0xae
    v_lshl_or_b32 v42, v119, 16, v42
    v_bitop3_b32 v7, v118, v125, v7 bitop3:0xae
    v_bitop3_b32 v43, v119, v126, v43 bitop3:0xea
    s_cmp_lt_u32 s29, 1389
    s_cselect_b32 s6, 204800000, 0
    s_cselect_b32 s10, 204800000, 0
    s_add_u32 s32, s30, 65536
    buffer_load_dwordx4 v[20:23], v1, s[4:7], s32 offen nt
    buffer_load_dwordx4 v[56:59], v1, s[8:11], s32 offen nt
    s_cmp_ge_u32 s29, 1499
    s_cbranch_scc1 p1_k2
    s_cmp_lg_u32 s34, 0
    s_cbranch_scc1 p1_w3
    s_waitcnt vmcnt(10)
p1_w3:
    s_waitcnt vmcnt(13)
    v_lshlrev_b32 v117, 16, v78
    v_and_b32 v118, v126, v78
    v_mul_f32 v117, v123, v117
    v_mul_f32 v118, v123, v118
    v_cvt_pk_bf16_f32 v117, v117, v118
    v_and_b32 v118, v126, v117
    v_lshlrev_b32 v117, 16, v117
    v_mul_f32 v117, 0.15915494, v117
    v_mul_f32 v118, 0.15915494, v118
    v_fract_f32 v117, v117
    v_fract_f32 v118, v118
    v_cos_f32 v117, v117
    v_cos_f32 v118, v118
    v_mul_hi_u32_u24 v122, s38, v106
    v_mul_hi_u32_u24 v121, s37, v98
    v_mul_hi_u32_u24 v120, s36, v98
    v_mad_i32_i24 v110, v122, s44, v106
    v_mad_u32_u24 v44, v122, 40, v121
    v_mad_i32_i24 v8, v120, s39, v98
    v_lshlrev_b16 v44, 2, v44
    v_mad_i32_i24 v120, v121, -3, v120
    ds_add_u32 v44, v3 offset:0
    v_lshl_or_b32 v8, v110, 16, v8
    v_lshl_or_b32 v8, v120, 30, v8
    v_mul_f32 v117, 0x03800000, v117
    v_mul_f32 v118, 0x03800000, v118
    v_cvt_pk_bf16_f32 v117, v117, v118
    v_mul_hi_u32_u24 v122, s38, v107
    v_mul_hi_u32_u24 v121, s37, v99
    v_mul_hi_u32_u24 v120, s36, v99
    v_mad_i32_i24 v110, v122, s44, v107
    v_mad_u32_u24 v45, v122, 40, v121
    v_mad_i32_i24 v9, v120, s39, v99
    v_lshlrev_b16 v45, 2, v45
    v_mad_i32_i24 v120, v121, -3, v120
    ds_add_u32 v45, v3 offset:0
    v_lshl_or_b32 v9, v110, 16, v9
    v_lshl_or_b32 v9, v120, 30, v9
    v_lshrrev_b32 v118, 3, v117
    v_lshrrev_b32 v119, 8, v117
    v_lshlrev_b16 v117, 13, v117
    v_bitop3_b32 v119, v118, v119, v124 bitop3:0x1b
    v_bitop3_b32 v8, v117, v125, v8 bitop3:0xae
    v_lshl_or_b32 v44, v119, 16, v44
    v_bitop3_b32 v9, v118, v125, v9 bitop3:0xae
    v_bitop3_b32 v45, v119, v126, v45 bitop3:0xea
    v_lshlrev_b32 v117, 16, v79
    v_and_b32 v118, v126, v79
    v_mul_f32 v117, v123, v117
    v_mul_f32 v118, v123, v118
    v_cvt_pk_bf16_f32 v117, v117, v118
    v_and_b32 v118, v126, v117
    v_lshlrev_b32 v117, 16, v117
    v_mul_f32 v117, 0.15915494, v117
    v_mul_f32 v118, 0.15915494, v118
    v_fract_f32 v117, v117
    v_fract_f32 v118, v118
    v_cos_f32 v117, v117
    v_cos_f32 v118, v118
    v_mul_hi_u32_u24 v122, s38, v108
    v_mul_hi_u32_u24 v121, s37, v100
    v_mul_hi_u32_u24 v120, s36, v100
    v_mad_i32_i24 v110, v122, s44, v108
    v_mad_u32_u24 v46, v122, 40, v121
    v_mad_i32_i24 v10, v120, s39, v100
    v_lshlrev_b16 v46, 2, v46
    v_mad_i32_i24 v120, v121, -3, v120
    ds_add_u32 v46, v3 offset:0
    v_lshl_or_b32 v10, v110, 16, v10
    v_lshl_or_b32 v10, v120, 30, v10
    v_mul_f32 v117, 0x03800000, v117
    v_mul_f32 v118, 0x03800000, v118
    v_cvt_pk_bf16_f32 v117, v117, v118
    v_mul_hi_u32_u24 v122, s38, v109
    v_mul_hi_u32_u24 v121, s37, v101
    v_mul_hi_u32_u24 v120, s36, v101
    v_mad_i32_i24 v110, v122, s44, v109
    v_mad_u32_u24 v47, v122, 40, v121
    v_mad_i32_i24 v11, v120, s39, v101
    v_lshlrev_b16 v47, 2, v47
    v_mad_i32_i24 v120, v121, -3, v120
    ds_add_u32 v47, v3 offset:0
    v_lshl_or_b32 v11, v110, 16, v11
    v_lshl_or_b32 v11, v120, 30, v11
    v_lshrrev_b32 v118, 3, v117
    v_lshrrev_b32 v119, 8, v117
    v_lshlrev_b16 v117, 13, v117
    v_bitop3_b32 v119, v118, v119, v124 bitop3:0x1b
    v_bitop3_b32 v10, v117, v125, v10 bitop3:0xae
    v_lshl_or_b32 v46, v119, 16, v46
    v_bitop3_b32 v11, v118, v125, v11 bitop3:0xae
    v_bitop3_b32 v47, v119, v126, v47 bitop3:0xea
p1_k2:
    s_cmp_lt_u32 s29, 1352
    s_cselect_b32 s6, 204800000, 0
    s_cselect_b32 s10, 204800000, 0
    s_add_u32 s32, s30, 81920
    buffer_load_dwordx4 v[24:27], v1, s[4:7], s32 offen nt
    buffer_load_dwordx4 v[60:63], v1, s[8:11], s32 offen nt
    s_cmp_ge_u32 s29, 1462
    s_cbranch_scc1 p1_k4
    s_cmp_lg_u32 s34, 0
    s_cbranch_scc1 p1_w5
    s_waitcnt vmcnt(6)
p1_w5:
    s_waitcnt vmcnt(11)
    v_lshlrev_b32 v117, 16, v80
    v_and_b32 v118, v126, v80
    v_mul_f32 v117, v123, v117
    v_mul_f32 v118, v123, v118
    v_cvt_pk_bf16_f32 v117, v117, v118
    v_and_b32 v118, v126, v117
    v_lshlrev_b32 v117, 16, v117
    v_mul_f32 v117, 0.15915494, v117
    v_mul_f32 v118, 0.15915494, v118
    v_fract_f32 v117, v117
    v_fract_f32 v118, v118
    v_cos_f32 v117, v117
    v_cos_f32 v118, v118
    v_mul_hi_u32_u24 v122, s38, v48
    v_mul_hi_u32_u24 v121, s37, v12
    v_mul_hi_u32_u24 v120, s36, v12
    v_mad_i32_i24 v110, v122, s44, v48
    v_mad_u32_u24 v48, v122, 40, v121
    v_mad_i32_i24 v12, v120, s39, v12
    v_lshlrev_b16 v48, 2, v48
    v_mad_i32_i24 v120, v121, -3, v120
    ds_add_u32 v48, v3 offset:0
    v_lshl_or_b32 v12, v110, 16, v12
    v_lshl_or_b32 v12, v120, 30, v12
    v_mul_f32 v117, 0x03800000, v117
    v_mul_f32 v118, 0x03800000, v118
    v_cvt_pk_bf16_f32 v117, v117, v118
    v_mul_hi_u32_u24 v122, s38, v49
    v_mul_hi_u32_u24 v121, s37, v13
    v_mul_hi_u32_u24 v120, s36, v13
    v_mad_i32_i24 v110, v122, s44, v49
    v_mad_u32_u24 v49, v122, 40, v121
    v_mad_i32_i24 v13, v120, s39, v13
    v_lshlrev_b16 v49, 2, v49
    v_mad_i32_i24 v120, v121, -3, v120
    ds_add_u32 v49, v3 offset:0
    v_lshl_or_b32 v13, v110, 16, v13
    v_lshl_or_b32 v13, v120, 30, v13
    v_lshrrev_b32 v118, 3, v117
    v_lshrrev_b32 v119, 8, v117
    v_lshlrev_b16 v117, 13, v117
    v_bitop3_b32 v119, v118, v119, v124 bitop3:0x1b
    v_bitop3_b32 v12, v117, v125, v12 bitop3:0xae
    v_lshl_or_b32 v48, v119, 16, v48
    v_bitop3_b32 v13, v118, v125, v13 bitop3:0xae
    v_bitop3_b32 v49, v119, v126, v49 bitop3:0xea
    v_lshlrev_b32 v117, 16, v81
    v_and_b32 v118, v126, v81
    v_mul_f32 v117, v123, v117
    v_mul_f32 v118, v123, v118
    v_cvt_pk_bf16_f32 v117, v117, v118
    v_and_b32 v118, v126, v117
    v_lshlrev_b32 v117, 16, v117
    v_mul_f32 v117, 0.15915494, v117
    v_mul_f32 v118, 0.15915494, v118
    v_fract_f32 v117, v117
    v_fract_f32 v118, v118
    v_cos_f32 v117, v117
    v_cos_f32 v118, v118
    v_mul_hi_u32_u24 v122, s38, v50
    v_mul_hi_u32_u24 v121, s37, v14
    v_mul_hi_u32_u24 v120, s36, v14
    v_mad_i32_i24 v110, v122, s44, v50
    v_mad_u32_u24 v50, v122, 40, v121
    v_mad_i32_i24 v14, v120, s39, v14
    v_lshlrev_b16 v50, 2, v50
    v_mad_i32_i24 v120, v121, -3, v120
    ds_add_u32 v50, v3 offset:0
    v_lshl_or_b32 v14, v110, 16, v14
    v_lshl_or_b32 v14, v120, 30, v14
    v_mul_f32 v117, 0x03800000, v117
    v_mul_f32 v118, 0x03800000, v118
    v_cvt_pk_bf16_f32 v117, v117, v118
    v_mul_hi_u32_u24 v122, s38, v51
    v_mul_hi_u32_u24 v121, s37, v15
    v_mul_hi_u32_u24 v120, s36, v15
    v_mad_i32_i24 v110, v122, s44, v51
    v_mad_u32_u24 v51, v122, 40, v121
    v_mad_i32_i24 v15, v120, s39, v15
    v_lshlrev_b16 v51, 2, v51
    v_mad_i32_i24 v120, v121, -3, v120
    ds_add_u32 v51, v3 offset:0
    v_lshl_or_b32 v15, v110, 16, v15
    v_lshl_or_b32 v15, v120, 30, v15
    v_lshrrev_b32 v118, 3, v117
    v_lshrrev_b32 v119, 8, v117
    v_lshlrev_b16 v117, 13, v117
    v_bitop3_b32 v119, v118, v119, v124 bitop3:0x1b
    v_bitop3_b32 v14, v117, v125, v14 bitop3:0xae
    v_lshl_or_b32 v50, v119, 16, v50
    v_bitop3_b32 v15, v118, v125, v15 bitop3:0xae
    v_bitop3_b32 v51, v119, v126, v51 bitop3:0xea
p1_k4:
    s_cmp_lt_u32 s29, 1315
    s_cselect_b32 s6, 204800000, 0
    s_cselect_b32 s10, 204800000, 0
    s_add_u32 s32, s30, 98304
    buffer_load_dwordx4 v[28:31], v1, s[4:7], s32 offen nt
    buffer_load_dwordx4 v[64:67], v1, s[8:11], s32 offen nt
    s_cmp_ge_u32 s29, 1426
    s_cbranch_scc1 p1_k6
    s_waitcnt vmcnt(6)
    v_lshlrev_b32 v117, 16, v82
    v_and_b32 v118, v126, v82
    v_mul_f32 v117, v123, v117
    v_mul_f32 v118, v123, v118
    v_cvt_pk_bf16_f32 v117, v117, v118
    v_and_b32 v118, v126, v117
    v_lshlrev_b32 v117, 16, v117
    v_mul_f32 v117, 0.15915494, v117
    v_mul_f32 v118, 0.15915494, v118
    v_fract_f32 v117, v117
    v_fract_f32 v118, v118
    v_cos_f32 v117, v117
    v_cos_f32 v118, v118
    v_mul_hi_u32_u24 v122, s38, v52
    v_mul_hi_u32_u24 v121, s37, v16
    v_mul_hi_u32_u24 v120, s36, v16
    v_mad_i32_i24 v110, v122, s44, v52
    v_mad_u32_u24 v52, v122, 40, v121
    v_mad_i32_i24 v16, v120, s39, v16
    v_lshlrev_b16 v52, 2, v52
    v_mad_i32_i24 v120, v121, -3, v120
    ds_add_u32 v52, v3 offset:0
    v_lshl_or_b32 v16, v110, 16, v16
    v_lshl_or_b32 v16, v120, 30, v16
    v_mul_f32 v117, 0x03800000, v117
    v_mul_f32 v118, 0x03800000, v118
    v_cvt_pk_bf16_f32 v117, v117, v118
    v_mul_hi_u32_u24 v122, s38, v53
    v_mul_hi_u32_u24 v121, s37, v17
    v_mul_hi_u32_u24 v120, s36, v17
    v_mad_i32_i24 v110, v122, s44, v53
    v_mad_u32_u24 v53, v122, 40, v121
    v_mad_i32_i24 v17, v120, s39, v17
    v_lshlrev_b16 v53, 2, v53
    v_mad_i32_i24 v120, v121, -3, v120
    ds_add_u32 v53, v3 offset:0
    v_lshl_or_b32 v17, v110, 16, v17
    v_lshl_or_b32 v17, v120, 30, v17
    v_lshrrev_b32 v118, 3, v117
    v_lshrrev_b32 v119, 8, v117
    v_lshlrev_b16 v117, 13, v117
    v_bitop3_b32 v119, v118, v119, v124 bitop3:0x1b
    v_bitop3_b32 v16, v117, v125, v16 bitop3:0xae
    v_lshl_or_b32 v52, v119, 16, v52
    v_bitop3_b32 v17, v118, v125, v17 bitop3:0xae
    v_bitop3_b32 v53, v119, v126, v53 bitop3:0xea
    v_lshlrev_b32 v117, 16, v83
    v_and_b32 v118, v126, v83
    v_mul_f32 v117, v123, v117
    v_mul_f32 v118, v123, v118
    v_cvt_pk_bf16_f32 v117, v117, v118
    v_and_b32 v118, v126, v117
    v_lshlrev_b32 v117, 16, v117
    v_mul_f32 v117, 0.15915494, v117
    v_mul_f32 v118, 0.15915494, v118
    v_fract_f32 v117, v117
    v_fract_f32 v118, v118
    v_cos_f32 v117, v117
    v_cos_f32 v118, v118
    v_mul_hi_u32_u24 v122, s38, v54
    v_mul_hi_u32_u24 v121, s37, v18
    v_mul_hi_u32_u24 v120, s36, v18
    v_mad_i32_i24 v110, v122, s44, v54
    v_mad_u32_u24 v54, v122, 40, v121
    v_mad_i32_i24 v18, v120, s39, v18
    v_lshlrev_b16 v54, 2, v54
    v_mad_i32_i24 v120, v121, -3, v120
    ds_add_u32 v54, v3 offset:0
    v_lshl_or_b32 v18, v110, 16, v18
    v_lshl_or_b32 v18, v120, 30, v18
    v_mul_f32 v117, 0x03800000, v117
    v_mul_f32 v118, 0x03800000, v118
    v_cvt_pk_bf16_f32 v117, v117, v118
    v_mul_hi_u32_u24 v122, s38, v55
    v_mul_hi_u32_u24 v121, s37, v19
    v_mul_hi_u32_u24 v120, s36, v19
    v_mad_i32_i24 v110, v122, s44, v55
    v_mad_u32_u24 v55, v122, 40, v121
    v_mad_i32_i24 v19, v120, s39, v19
    v_lshlrev_b16 v55, 2, v55
    v_mad_i32_i24 v120, v121, -3, v120
    ds_add_u32 v55, v3 offset:0
    v_lshl_or_b32 v19, v110, 16, v19
    v_lshl_or_b32 v19, v120, 30, v19
    v_lshrrev_b32 v118, 3, v117
    v_lshrrev_b32 v119, 8, v117
    v_lshlrev_b16 v117, 13, v117
    v_bitop3_b32 v119, v118, v119, v124 bitop3:0x1b
    v_bitop3_b32 v18, v117, v125, v18 bitop3:0xae
    v_lshl_or_b32 v54, v119, 16, v54
    v_bitop3_b32 v19, v118, v125, v19 bitop3:0xae
    v_bitop3_b32 v55, v119, v126, v55 bitop3:0xea
p1_k6:
    s_cmp_lt_u32 s29, 1279
    s_cselect_b32 s6, 204800000, 0
    s_cselect_b32 s10, 204800000, 0
    s_add_u32 s32, s30, 114688
    buffer_load_dwordx4 v[32:35], v1, s[4:7], s32 offen nt
    buffer_load_dwordx4 v[68:71], v1, s[8:11], s32 offen nt
    s_cmp_ge_u32 s29, 1389
    s_cbranch_scc1 p1_k8
    s_waitcnt vmcnt(6)
    v_lshlrev_b32 v117, 16, v84
    v_and_b32 v118, v126, v84
    v_mul_f32 v117, v123, v117
    v_mul_f32 v118, v123, v118
    v_cvt_pk_bf16_f32 v117, v117, v118
    v_and_b32 v118, v126, v117
    v_lshlrev_b32 v117, 16, v117
    v_mul_f32 v117, 0.15915494, v117
    v_mul_f32 v118, 0.15915494, v118
    v_fract_f32 v117, v117
    v_fract_f32 v118, v118
    v_cos_f32 v117, v117
    v_cos_f32 v118, v118
    v_mul_hi_u32_u24 v122, s38, v56
    v_mul_hi_u32_u24 v121, s37, v20
    v_mul_hi_u32_u24 v120, s36, v20
    v_mad_i32_i24 v110, v122, s44, v56
    v_mad_u32_u24 v56, v122, 40, v121
    v_mad_i32_i24 v20, v120, s39, v20
    v_lshlrev_b16 v56, 2, v56
    v_mad_i32_i24 v120, v121, -3, v120
    ds_add_u32 v56, v3 offset:0
    v_lshl_or_b32 v20, v110, 16, v20
    v_lshl_or_b32 v20, v120, 30, v20
    v_mul_f32 v117, 0x03800000, v117
    v_mul_f32 v118, 0x03800000, v118
    v_cvt_pk_bf16_f32 v117, v117, v118
    v_mul_hi_u32_u24 v122, s38, v57
    v_mul_hi_u32_u24 v121, s37, v21
    v_mul_hi_u32_u24 v120, s36, v21
    v_mad_i32_i24 v110, v122, s44, v57
    v_mad_u32_u24 v57, v122, 40, v121
    v_mad_i32_i24 v21, v120, s39, v21
    v_lshlrev_b16 v57, 2, v57
    v_mad_i32_i24 v120, v121, -3, v120
    ds_add_u32 v57, v3 offset:0
    v_lshl_or_b32 v21, v110, 16, v21
    v_lshl_or_b32 v21, v120, 30, v21
    v_lshrrev_b32 v118, 3, v117
    v_lshrrev_b32 v119, 8, v117
    v_lshlrev_b16 v117, 13, v117
    v_bitop3_b32 v119, v118, v119, v124 bitop3:0x1b
    v_bitop3_b32 v20, v117, v125, v20 bitop3:0xae
    v_lshl_or_b32 v56, v119, 16, v56
    v_bitop3_b32 v21, v118, v125, v21 bitop3:0xae
    v_bitop3_b32 v57, v119, v126, v57 bitop3:0xea
    v_lshlrev_b32 v117, 16, v85
    v_and_b32 v118, v126, v85
    v_mul_f32 v117, v123, v117
    v_mul_f32 v118, v123, v118
    v_cvt_pk_bf16_f32 v117, v117, v118
    v_and_b32 v118, v126, v117
    v_lshlrev_b32 v117, 16, v117
    v_mul_f32 v117, 0.15915494, v117
    v_mul_f32 v118, 0.15915494, v118
    v_fract_f32 v117, v117
    v_fract_f32 v118, v118
    v_cos_f32 v117, v117
    v_cos_f32 v118, v118
    v_mul_hi_u32_u24 v122, s38, v58
    v_mul_hi_u32_u24 v121, s37, v22
    v_mul_hi_u32_u24 v120, s36, v22
    v_mad_i32_i24 v110, v122, s44, v58
    v_mad_u32_u24 v58, v122, 40, v121
    v_mad_i32_i24 v22, v120, s39, v22
    v_lshlrev_b16 v58, 2, v58
    v_mad_i32_i24 v120, v121, -3, v120
    ds_add_u32 v58, v3 offset:0
    v_lshl_or_b32 v22, v110, 16, v22
    v_lshl_or_b32 v22, v120, 30, v22
    v_mul_f32 v117, 0x03800000, v117
    v_mul_f32 v118, 0x03800000, v118
    v_cvt_pk_bf16_f32 v117, v117, v118
    v_mul_hi_u32_u24 v122, s38, v59
    v_mul_hi_u32_u24 v121, s37, v23
    v_mul_hi_u32_u24 v120, s36, v23
    v_mad_i32_i24 v110, v122, s44, v59
    v_mad_u32_u24 v59, v122, 40, v121
    v_mad_i32_i24 v23, v120, s39, v23
    v_lshlrev_b16 v59, 2, v59
    v_mad_i32_i24 v120, v121, -3, v120
    ds_add_u32 v59, v3 offset:0
    v_lshl_or_b32 v23, v110, 16, v23
    v_lshl_or_b32 v23, v120, 30, v23
    v_lshrrev_b32 v118, 3, v117
    v_lshrrev_b32 v119, 8, v117
    v_lshlrev_b16 v117, 13, v117
    v_bitop3_b32 v119, v118, v119, v124 bitop3:0x1b
    v_bitop3_b32 v22, v117, v125, v22 bitop3:0xae
    v_lshl_or_b32 v58, v119, 16, v58
    v_bitop3_b32 v23, v118, v125, v23 bitop3:0xae
    v_bitop3_b32 v59, v119, v126, v59 bitop3:0xea
p1_k8:
    s_cmp_lt_u32 s29, 1242
    s_cselect_b32 s6, 204800000, 0
    s_cselect_b32 s10, 204800000, 0
    s_add_u32 s32, s30, 131072
    buffer_load_dwordx4 v[36:39], v1, s[4:7], s32 offen nt
    buffer_load_dwordx4 v[72:75], v1, s[8:11], s32 offen nt
    s_cmp_ge_u32 s29, 1352
    s_cbranch_scc1 p1_k10
    s_waitcnt vmcnt(6)
    v_lshlrev_b32 v117, 16, v86
    v_and_b32 v118, v126, v86
    v_mul_f32 v117, v123, v117
    v_mul_f32 v118, v123, v118
    v_cvt_pk_bf16_f32 v117, v117, v118
    v_and_b32 v118, v126, v117
    v_lshlrev_b32 v117, 16, v117
    v_mul_f32 v117, 0.15915494, v117
    v_mul_f32 v118, 0.15915494, v118
    v_fract_f32 v117, v117
    v_fract_f32 v118, v118
    v_cos_f32 v117, v117
    v_cos_f32 v118, v118
    v_mul_hi_u32_u24 v122, s38, v60
    v_mul_hi_u32_u24 v121, s37, v24
    v_mul_hi_u32_u24 v120, s36, v24
    v_mad_i32_i24 v110, v122, s44, v60
    v_mad_u32_u24 v60, v122, 40, v121
    v_mad_i32_i24 v24, v120, s39, v24
    v_lshlrev_b16 v60, 2, v60
    v_mad_i32_i24 v120, v121, -3, v120
    ds_add_u32 v60, v3 offset:0
    v_lshl_or_b32 v24, v110, 16, v24
    v_lshl_or_b32 v24, v120, 30, v24
    v_mul_f32 v117, 0x03800000, v117
    v_mul_f32 v118, 0x03800000, v118
    v_cvt_pk_bf16_f32 v117, v117, v118
    v_mul_hi_u32_u24 v122, s38, v61
    v_mul_hi_u32_u24 v121, s37, v25
    v_mul_hi_u32_u24 v120, s36, v25
    v_mad_i32_i24 v110, v122, s44, v61
    v_mad_u32_u24 v61, v122, 40, v121
    v_mad_i32_i24 v25, v120, s39, v25
    v_lshlrev_b16 v61, 2, v61
    v_mad_i32_i24 v120, v121, -3, v120
    ds_add_u32 v61, v3 offset:0
    v_lshl_or_b32 v25, v110, 16, v25
    v_lshl_or_b32 v25, v120, 30, v25
    v_lshrrev_b32 v118, 3, v117
    v_lshrrev_b32 v119, 8, v117
    v_lshlrev_b16 v117, 13, v117
    v_bitop3_b32 v119, v118, v119, v124 bitop3:0x1b
    v_bitop3_b32 v24, v117, v125, v24 bitop3:0xae
    v_lshl_or_b32 v60, v119, 16, v60
    v_bitop3_b32 v25, v118, v125, v25 bitop3:0xae
    v_bitop3_b32 v61, v119, v126, v61 bitop3:0xea
    v_lshlrev_b32 v117, 16, v87
    v_and_b32 v118, v126, v87
    v_mul_f32 v117, v123, v117
    v_mul_f32 v118, v123, v118
    v_cvt_pk_bf16_f32 v117, v117, v118
    v_and_b32 v118, v126, v117
    v_lshlrev_b32 v117, 16, v117
    v_mul_f32 v117, 0.15915494, v117
    v_mul_f32 v118, 0.15915494, v118
    v_fract_f32 v117, v117
    v_fract_f32 v118, v118
    v_cos_f32 v117, v117
    v_cos_f32 v118, v118
    v_mul_hi_u32_u24 v122, s38, v62
    v_mul_hi_u32_u24 v121, s37, v26
    v_mul_hi_u32_u24 v120, s36, v26
    v_mad_i32_i24 v110, v122, s44, v62
    v_mad_u32_u24 v62, v122, 40, v121
    v_mad_i32_i24 v26, v120, s39, v26
    v_lshlrev_b16 v62, 2, v62
    v_mad_i32_i24 v120, v121, -3, v120
    ds_add_u32 v62, v3 offset:0
    v_lshl_or_b32 v26, v110, 16, v26
    v_lshl_or_b32 v26, v120, 30, v26
    v_mul_f32 v117, 0x03800000, v117
    v_mul_f32 v118, 0x03800000, v118
    v_cvt_pk_bf16_f32 v117, v117, v118
    v_mul_hi_u32_u24 v122, s38, v63
    v_mul_hi_u32_u24 v121, s37, v27
    v_mul_hi_u32_u24 v120, s36, v27
    v_mad_i32_i24 v110, v122, s44, v63
    v_mad_u32_u24 v63, v122, 40, v121
    v_mad_i32_i24 v27, v120, s39, v27
    v_lshlrev_b16 v63, 2, v63
    v_mad_i32_i24 v120, v121, -3, v120
    ds_add_u32 v63, v3 offset:0
    v_lshl_or_b32 v27, v110, 16, v27
    v_lshl_or_b32 v27, v120, 30, v27
    v_lshrrev_b32 v118, 3, v117
    v_lshrrev_b32 v119, 8, v117
    v_lshlrev_b16 v117, 13, v117
    v_bitop3_b32 v119, v118, v119, v124 bitop3:0x1b
    v_bitop3_b32 v26, v117, v125, v26 bitop3:0xae
    v_lshl_or_b32 v62, v119, 16, v62
    v_bitop3_b32 v27, v118, v125, v27 bitop3:0xae
    v_bitop3_b32 v63, v119, v126, v63 bitop3:0xea
p1_k10:
    s_cmp_ge_u32 s29, 1315
    s_cbranch_scc1 p1_k12
    s_waitcnt vmcnt(4)
    v_lshlrev_b32 v117, 16, v88
    v_and_b32 v118, v126, v88
    v_mul_f32 v117, v123, v117
    v_mul_f32 v118, v123, v118
    v_cvt_pk_bf16_f32 v117, v117, v118
    v_and_b32 v118, v126, v117
    v_lshlrev_b32 v117, 16, v117
    v_mul_f32 v117, 0.15915494, v117
    v_mul_f32 v118, 0.15915494, v118
    v_fract_f32 v117, v117
    v_fract_f32 v118, v118
    v_cos_f32 v117, v117
    v_cos_f32 v118, v118
    v_mul_hi_u32_u24 v122, s38, v64
    v_mul_hi_u32_u24 v121, s37, v28
    v_mul_hi_u32_u24 v120, s36, v28
    v_mad_i32_i24 v110, v122, s44, v64
    v_mad_u32_u24 v64, v122, 40, v121
    v_mad_i32_i24 v28, v120, s39, v28
    v_lshlrev_b16 v64, 2, v64
    v_mad_i32_i24 v120, v121, -3, v120
    ds_add_u32 v64, v3 offset:0
    v_lshl_or_b32 v28, v110, 16, v28
    v_lshl_or_b32 v28, v120, 30, v28
    v_mul_f32 v117, 0x03800000, v117
    v_mul_f32 v118, 0x03800000, v118
    v_cvt_pk_bf16_f32 v117, v117, v118
    v_mul_hi_u32_u24 v122, s38, v65
    v_mul_hi_u32_u24 v121, s37, v29
    v_mul_hi_u32_u24 v120, s36, v29
    v_mad_i32_i24 v110, v122, s44, v65
    v_mad_u32_u24 v65, v122, 40, v121
    v_mad_i32_i24 v29, v120, s39, v29
    v_lshlrev_b16 v65, 2, v65
    v_mad_i32_i24 v120, v121, -3, v120
    ds_add_u32 v65, v3 offset:0
    v_lshl_or_b32 v29, v110, 16, v29
    v_lshl_or_b32 v29, v120, 30, v29
    v_lshrrev_b32 v118, 3, v117
    v_lshrrev_b32 v119, 8, v117
    v_lshlrev_b16 v117, 13, v117
    v_bitop3_b32 v119, v118, v119, v124 bitop3:0x1b
    v_bitop3_b32 v28, v117, v125, v28 bitop3:0xae
    v_lshl_or_b32 v64, v119, 16, v64
    v_bitop3_b32 v29, v118, v125, v29 bitop3:0xae
    v_bitop3_b32 v65, v119, v126, v65 bitop3:0xea
    v_lshlrev_b32 v117, 16, v89
    v_and_b32 v118, v126, v89
    v_mul_f32 v117, v123, v117
    v_mul_f32 v118, v123, v118
    v_cvt_pk_bf16_f32 v117, v117, v118
    v_and_b32 v118, v126, v117
    v_lshlrev_b32 v117, 16, v117
    v_mul_f32 v117, 0.15915494, v117
    v_mul_f32 v118, 0.15915494, v118
    v_fract_f32 v117, v117
    v_fract_f32 v118, v118
    v_cos_f32 v117, v117
    v_cos_f32 v118, v118
    v_mul_hi_u32_u24 v122, s38, v66
    v_mul_hi_u32_u24 v121, s37, v30
    v_mul_hi_u32_u24 v120, s36, v30
    v_mad_i32_i24 v110, v122, s44, v66
    v_mad_u32_u24 v66, v122, 40, v121
    v_mad_i32_i24 v30, v120, s39, v30
    v_lshlrev_b16 v66, 2, v66
    v_mad_i32_i24 v120, v121, -3, v120
    ds_add_u32 v66, v3 offset:0
    v_lshl_or_b32 v30, v110, 16, v30
    v_lshl_or_b32 v30, v120, 30, v30
    v_mul_f32 v117, 0x03800000, v117
    v_mul_f32 v118, 0x03800000, v118
    v_cvt_pk_bf16_f32 v117, v117, v118
    v_mul_hi_u32_u24 v122, s38, v67
    v_mul_hi_u32_u24 v121, s37, v31
    v_mul_hi_u32_u24 v120, s36, v31
    v_mad_i32_i24 v110, v122, s44, v67
    v_mad_u32_u24 v67, v122, 40, v121
    v_mad_i32_i24 v31, v120, s39, v31
    v_lshlrev_b16 v67, 2, v67
    v_mad_i32_i24 v120, v121, -3, v120
    ds_add_u32 v67, v3 offset:0
    v_lshl_or_b32 v31, v110, 16, v31
    v_lshl_or_b32 v31, v120, 30, v31
    v_lshrrev_b32 v118, 3, v117
    v_lshrrev_b32 v119, 8, v117
    v_lshlrev_b16 v117, 13, v117
    v_bitop3_b32 v119, v118, v119, v124 bitop3:0x1b
    v_bitop3_b32 v30, v117, v125, v30 bitop3:0xae
    v_lshl_or_b32 v66, v119, 16, v66
    v_bitop3_b32 v31, v118, v125, v31 bitop3:0xae
    v_bitop3_b32 v67, v119, v126, v67 bitop3:0xea
p1_k12:
    s_cmp_ge_u32 s29, 1279
    s_cbranch_scc1 p1_k14
    s_waitcnt vmcnt(2)
    v_lshlrev_b32 v117, 16, v90
    v_and_b32 v118, v126, v90
    v_mul_f32 v117, v123, v117
    v_mul_f32 v118, v123, v118
    v_cvt_pk_bf16_f32 v117, v117, v118
    v_and_b32 v118, v126, v117
    v_lshlrev_b32 v117, 16, v117
    v_mul_f32 v117, 0.15915494, v117
    v_mul_f32 v118, 0.15915494, v118
    v_fract_f32 v117, v117
    v_fract_f32 v118, v118
    v_cos_f32 v117, v117
    v_cos_f32 v118, v118
    v_mul_hi_u32_u24 v122, s38, v68
    v_mul_hi_u32_u24 v121, s37, v32
    v_mul_hi_u32_u24 v120, s36, v32
    v_mad_i32_i24 v110, v122, s44, v68
    v_mad_u32_u24 v68, v122, 40, v121
    v_mad_i32_i24 v32, v120, s39, v32
    v_lshlrev_b16 v68, 2, v68
    v_mad_i32_i24 v120, v121, -3, v120
    ds_add_u32 v68, v3 offset:0
    v_lshl_or_b32 v32, v110, 16, v32
    v_lshl_or_b32 v32, v120, 30, v32
    v_mul_f32 v117, 0x03800000, v117
    v_mul_f32 v118, 0x03800000, v118
    v_cvt_pk_bf16_f32 v117, v117, v118
    v_mul_hi_u32_u24 v122, s38, v69
    v_mul_hi_u32_u24 v121, s37, v33
    v_mul_hi_u32_u24 v120, s36, v33
    v_mad_i32_i24 v110, v122, s44, v69
    v_mad_u32_u24 v69, v122, 40, v121
    v_mad_i32_i24 v33, v120, s39, v33
    v_lshlrev_b16 v69, 2, v69
    v_mad_i32_i24 v120, v121, -3, v120
    ds_add_u32 v69, v3 offset:0
    v_lshl_or_b32 v33, v110, 16, v33
    v_lshl_or_b32 v33, v120, 30, v33
    v_lshrrev_b32 v118, 3, v117
    v_lshrrev_b32 v119, 8, v117
    v_lshlrev_b16 v117, 13, v117
    v_bitop3_b32 v119, v118, v119, v124 bitop3:0x1b
    v_bitop3_b32 v32, v117, v125, v32 bitop3:0xae
    v_lshl_or_b32 v68, v119, 16, v68
    v_bitop3_b32 v33, v118, v125, v33 bitop3:0xae
    v_bitop3_b32 v69, v119, v126, v69 bitop3:0xea
    v_lshlrev_b32 v117, 16, v91
    v_and_b32 v118, v126, v91
    v_mul_f32 v117, v123, v117
    v_mul_f32 v118, v123, v118
    v_cvt_pk_bf16_f32 v117, v117, v118
    v_and_b32 v118, v126, v117
    v_lshlrev_b32 v117, 16, v117
    v_mul_f32 v117, 0.15915494, v117
    v_mul_f32 v118, 0.15915494, v118
    v_fract_f32 v117, v117
    v_fract_f32 v118, v118
    v_cos_f32 v117, v117
    v_cos_f32 v118, v118
    v_mul_hi_u32_u24 v122, s38, v70
    v_mul_hi_u32_u24 v121, s37, v34
    v_mul_hi_u32_u24 v120, s36, v34
    v_mad_i32_i24 v110, v122, s44, v70
    v_mad_u32_u24 v70, v122, 40, v121
    v_mad_i32_i24 v34, v120, s39, v34
    v_lshlrev_b16 v70, 2, v70
    v_mad_i32_i24 v120, v121, -3, v120
    ds_add_u32 v70, v3 offset:0
    v_lshl_or_b32 v34, v110, 16, v34
    v_lshl_or_b32 v34, v120, 30, v34
    v_mul_f32 v117, 0x03800000, v117
    v_mul_f32 v118, 0x03800000, v118
    v_cvt_pk_bf16_f32 v117, v117, v118
    v_mul_hi_u32_u24 v122, s38, v71
    v_mul_hi_u32_u24 v121, s37, v35
    v_mul_hi_u32_u24 v120, s36, v35
    v_mad_i32_i24 v110, v122, s44, v71
    v_mad_u32_u24 v71, v122, 40, v121
    v_mad_i32_i24 v35, v120, s39, v35
    v_lshlrev_b16 v71, 2, v71
    v_mad_i32_i24 v120, v121, -3, v120
    ds_add_u32 v71, v3 offset:0
    v_lshl_or_b32 v35, v110, 16, v35
    v_lshl_or_b32 v35, v120, 30, v35
    v_lshrrev_b32 v118, 3, v117
    v_lshrrev_b32 v119, 8, v117
    v_lshlrev_b16 v117, 13, v117
    v_bitop3_b32 v119, v118, v119, v124 bitop3:0x1b
    v_bitop3_b32 v34, v117, v125, v34 bitop3:0xae
    v_lshl_or_b32 v70, v119, 16, v70
    v_bitop3_b32 v35, v118, v125, v35 bitop3:0xae
    v_bitop3_b32 v71, v119, v126, v71 bitop3:0xea
p1_k14:
    s_cmp_ge_u32 s29, 1242
    s_cbranch_scc1 p1_k16
    s_waitcnt vmcnt(0)
    v_lshlrev_b32 v117, 16, v92
    v_and_b32 v118, v126, v92
    v_mul_f32 v117, v123, v117
    v_mul_f32 v118, v123, v118
    v_cvt_pk_bf16_f32 v117, v117, v118
    v_and_b32 v118, v126, v117
    v_lshlrev_b32 v117, 16, v117
    v_mul_f32 v117, 0.15915494, v117
    v_mul_f32 v118, 0.15915494, v118
    v_fract_f32 v117, v117
    v_fract_f32 v118, v118
    v_cos_f32 v117, v117
    v_cos_f32 v118, v118
    v_mul_hi_u32_u24 v122, s38, v72
    v_mul_hi_u32_u24 v121, s37, v36
    v_mul_hi_u32_u24 v120, s36, v36
    v_mad_i32_i24 v110, v122, s44, v72
    v_mad_u32_u24 v72, v122, 40, v121
    v_mad_i32_i24 v36, v120, s39, v36
    v_lshlrev_b16 v72, 2, v72
    v_mad_i32_i24 v120, v121, -3, v120
    ds_add_u32 v72, v3 offset:0
    v_lshl_or_b32 v36, v110, 16, v36
    v_lshl_or_b32 v36, v120, 30, v36
    v_mul_f32 v117, 0x03800000, v117
    v_mul_f32 v118, 0x03800000, v118
    v_cvt_pk_bf16_f32 v117, v117, v118
    v_mul_hi_u32_u24 v122, s38, v73
    v_mul_hi_u32_u24 v121, s37, v37
    v_mul_hi_u32_u24 v120, s36, v37
    v_mad_i32_i24 v110, v122, s44, v73
    v_mad_u32_u24 v73, v122, 40, v121
    v_mad_i32_i24 v37, v120, s39, v37
    v_lshlrev_b16 v73, 2, v73
    v_mad_i32_i24 v120, v121, -3, v120
    ds_add_u32 v73, v3 offset:0
    v_lshl_or_b32 v37, v110, 16, v37
    v_lshl_or_b32 v37, v120, 30, v37
    v_lshrrev_b32 v118, 3, v117
    v_lshrrev_b32 v119, 8, v117
    v_lshlrev_b16 v117, 13, v117
    v_bitop3_b32 v119, v118, v119, v124 bitop3:0x1b
    v_bitop3_b32 v36, v117, v125, v36 bitop3:0xae
    v_lshl_or_b32 v72, v119, 16, v72
    v_bitop3_b32 v37, v118, v125, v37 bitop3:0xae
    v_bitop3_b32 v73, v119, v126, v73 bitop3:0xea
    v_lshlrev_b32 v117, 16, v93
    v_and_b32 v118, v126, v93
    v_mul_f32 v117, v123, v117
    v_mul_f32 v118, v123, v118
    v_cvt_pk_bf16_f32 v117, v117, v118
    v_and_b32 v118, v126, v117
    v_lshlrev_b32 v117, 16, v117
    v_mul_f32 v117, 0.15915494, v117
    v_mul_f32 v118, 0.15915494, v118
    v_fract_f32 v117, v117
    v_fract_f32 v118, v118
    v_cos_f32 v117, v117
    v_cos_f32 v118, v118
    v_mul_hi_u32_u24 v122, s38, v74
    v_mul_hi_u32_u24 v121, s37, v38
    v_mul_hi_u32_u24 v120, s36, v38
    v_mad_i32_i24 v110, v122, s44, v74
    v_mad_u32_u24 v74, v122, 40, v121
    v_mad_i32_i24 v38, v120, s39, v38
    v_lshlrev_b16 v74, 2, v74
    v_mad_i32_i24 v120, v121, -3, v120
    ds_add_u32 v74, v3 offset:0
    v_lshl_or_b32 v38, v110, 16, v38
    v_lshl_or_b32 v38, v120, 30, v38
    v_mul_f32 v117, 0x03800000, v117
    v_mul_f32 v118, 0x03800000, v118
    v_cvt_pk_bf16_f32 v117, v117, v118
    v_mul_hi_u32_u24 v122, s38, v75
    v_mul_hi_u32_u24 v121, s37, v39
    v_mul_hi_u32_u24 v120, s36, v39
    v_mad_i32_i24 v110, v122, s44, v75
    v_mad_u32_u24 v75, v122, 40, v121
    v_mad_i32_i24 v39, v120, s39, v39
    v_lshlrev_b16 v75, 2, v75
    v_mad_i32_i24 v120, v121, -3, v120
    ds_add_u32 v75, v3 offset:0
    v_lshl_or_b32 v39, v110, 16, v39
    v_lshl_or_b32 v39, v120, 30, v39
    v_lshrrev_b32 v118, 3, v117
    v_lshrrev_b32 v119, 8, v117
    v_lshlrev_b16 v117, 13, v117
    v_bitop3_b32 v119, v118, v119, v124 bitop3:0x1b
    v_bitop3_b32 v38, v117, v125, v38 bitop3:0xae
    v_lshl_or_b32 v74, v119, 16, v74
    v_bitop3_b32 v39, v118, v125, v39 bitop3:0xae
    v_bitop3_b32 v75, v119, v126, v75 bitop3:0xea
p1_k16:
    s_waitcnt vmcnt(0)
    s_cmp_lg_u32 s28, 15
    s_cbranch_scc1 p1_tk1
    v_mov_b32 v126, 0
    s_mov_b64 exec, 1
    ds_write_b32 v126, v127 offset:10456
    s_mov_b64 exec, -1
p1_tk1:
    s_waitcnt lgkmcnt(0)
    s_barrier
    s_cmp_ge_u32 s28, 10
    s_cbranch_scc1 p1_s1_skip
    v_and_b32 v126, 63, v0
    s_lshl_b32 s54, s28, 4
    v_mul_u32_u24 v117, 160, v126
    v_add_u32 v117, s54, v117
    ds_read_b128 v[118:121], v117 offset:0
    s_waitcnt lgkmcnt(0)
    v_add_u32 v118, 2, v118
    v_add_u32 v119, 2, v119
    v_add_u32 v120, 2, v120
    v_add_u32 v121, 2, v121
    v_mul_u32_u24 v118, 43691, v118
    v_mul_u32_u24 v119, 43691, v119
    v_mul_u32_u24 v120, 43691, v120
    v_mul_u32_u24 v121, 43691, v121
    v_lshrrev_b32 v118, 17, v118
    v_lshrrev_b32 v119, 17, v119
    v_lshrrev_b32 v120, 17, v120
    v_lshrrev_b32 v121, 17, v121
    v_lshl_or_b32 v122, v119, 16, v118
    v_lshl_or_b32 v123, v121, 16, v120
    v_mov_b32 v124, v122
    v_mov_b32 v125, v123
    s_nop 1
    v_add_u32_dpp v124, v124, v124 row_shr:1 row_mask:0xf bank_mask:0xf bound_ctrl:0
    v_add_u32_dpp v125, v125, v125 row_shr:1 row_mask:0xf bank_mask:0xf bound_ctrl:0
    s_nop 0
    v_add_u32_dpp v124, v124, v124 row_shr:2 row_mask:0xf bank_mask:0xf bound_ctrl:0
    v_add_u32_dpp v125, v125, v125 row_shr:2 row_mask:0xf bank_mask:0xf bound_ctrl:0
    s_nop 0
    v_add_u32_dpp v124, v124, v124 row_shr:4 row_mask:0xf bank_mask:0xf bound_ctrl:0
    v_add_u32_dpp v125, v125, v125 row_shr:4 row_mask:0xf bank_mask:0xf bound_ctrl:0
    s_nop 0
    v_add_u32_dpp v124, v124, v124 row_shr:8 row_mask:0xf bank_mask:0xf bound_ctrl:0
    v_add_u32_dpp v125, v125, v125 row_shr:8 row_mask:0xf bank_mask:0xf bound_ctrl:0
    s_nop 0
    v_add_u32_dpp v124, v124, v124 row_bcast:15 row_mask:0xa bank_mask:0xf
    v_add_u32_dpp v125, v125, v125 row_bcast:15 row_mask:0xa bank_mask:0xf
    s_nop 0
    v_add_u32_dpp v124, v124, v124 row_bcast:31 row_mask:0xc bank_mask:0xf
    v_add_u32_dpp v125, v125, v125 row_bcast:31 row_mask:0xc bank_mask:0xf
    s_nop 0
    s_nop 0
    v_mov_b32 v127, s54
    v_and_b32 v118, 0xffff, v124
    v_lshrrev_b32 v119, 16, v124
    v_and_b32 v120, 0xffff, v125
    v_lshrrev_b32 v121, 16, v125
    s_mov_b64 exec, 1
    s_lshl_b64 exec, exec, 63
    ds_write_b128 v127, v[118:121] offset:10240
    s_mov_b64 exec, -1
p1_s1_skip:
    s_waitcnt lgkmcnt(0)
    s_barrier
    v_and_b32 v127, 63, v0
    v_lshlrev_b32 v118, 2, v127
    v_cmp_gt_u32 vcc, 40, v127
    ds_read_b32 v119, v118 offset:10240
    s_waitcnt lgkmcnt(0)
    v_readlane_b32 s33, v119, 54
    v_cndmask_b32 v119, 0, v119, vcc
    v_mov_b32 v120, v119
    s_nop 1
    v_add_u32_dpp v120, v120, v120 row_shr:1 row_mask:0xf bank_mask:0xf bound_ctrl:0
    s_nop 1
    v_add_u32_dpp v120, v120, v120 row_shr:2 row_mask:0xf bank_mask:0xf bound_ctrl:0
    s_nop 1
    v_add_u32_dpp v120, v120, v120 row_shr:4 row_mask:0xf bank_mask:0xf bound_ctrl:0
    s_nop 1
    v_add_u32_dpp v120, v120, v120 row_shr:8 row_mask:0xf bank_mask:0xf bound_ctrl:0
    s_nop 1
    v_add_u32_dpp v120, v120, v120 row_bcast:15 row_mask:0xa bank_mask:0xf
    s_nop 1
    v_add_u32_dpp v120, v120, v120 row_bcast:31 row_mask:0xc bank_mask:0xf
    s_nop 1
    s_nop 0
    v_sub_u32 v119, v120, v119
    v_readlane_b32 s35, v120, 63
    s_add_u32 s33, s33, 256
    s_mul_i32 s46, s33, 1
    s_min_u32 s47, s33, 1499
    s_add_u32 s46, s46, s47
    s_min_u32 s47, s33, 1462
    s_add_u32 s46, s46, s47
    s_min_u32 s47, s33, 1426
    s_add_u32 s46, s46, s47
    s_min_u32 s47, s33, 1389
    s_add_u32 s46, s46, s47
    s_min_u32 s47, s33, 1352
    s_add_u32 s46, s46, s47
    s_min_u32 s47, s33, 1315
    s_add_u32 s46, s46, s47
    s_min_u32 s47, s33, 1279
    s_add_u32 s46, s46, s47
    s_min_u32 s47, s33, 1242
    s_add_u32 s46, s46, s47
    s_lshl_b32 s30, s46, 14
    s_lshl_b32 s31, s46, 13
    s_cmp_ge_u32 s28, 10
    s_cbranch_scc1 p1_s2_skip
    s_lshl_b32 s54, s28, 2
    s_add_u32 s55, s54, 0
    v_readlane_b32 s56, v119, s55
    s_add_u32 s55, s54, 1
    v_readlane_b32 s57, v119, s55
    s_add_u32 s55, s54, 2
    v_readlane_b32 s58, v119, s55
    s_add_u32 s55, s54, 3
    v_readlane_b32 s59, v119, s55
    s_nop 0
    s_lshl_b32 s57, s57, 16
    s_or_b32 s56, s56, s57
    s_lshl_b32 s59, s59, 16
    s_or_b32 s58, s58, s59
    v_add_u32 v124, s56, v124
    v_add_u32 v125, s58, v125
    v_sub_u32 v122, v124, v122
    v_sub_u32 v123, v125, v123
    v_and_b32 v118, 0xffff, v122
    v_lshrrev_b32 v119, 16, v122
    v_and_b32 v120, 0xffff, v123
    v_lshrrev_b32 v121, 16, v123
    v_mul_u32_u24 v118, 3, v118
    v_mul_u32_u24 v119, 3, v119
    v_mul_u32_u24 v120, 3, v120
    v_mul_u32_u24 v121, 3, v121
    ds_write_b128 v117, v[118:121] offset:0
    s_mul_i32 s55, s29, 5248
    s_mul_i32 s56, s28, 520
    s_add_u32 s55, s55, s56
    s_add_u32 s55, s55, 469762048
    v_lshlrev_b32 v127, 3, v126
    buffer_store_dwordx2 v[122:123], v127, s[16:19], s55 offen sc1
    s_mov_b64 exec, 1
    s_lshl_b64 exec, exec, 63
    buffer_store_dwordx2 v[124:125], v127, s[16:19], s55 offen offset:8 sc1
    s_mov_b64 exec, -1
p1_s2_skip:
    s_mul_i32 s50, s29, 16384
    s_lshr_b32 s52, s35, 10
    s_mul_i32 s52, s52, 33554432
    s_and_b32 s53, s35, 1023
    s_lshl_b32 s53, s53, 4
    s_add_u32 s52, s52, s53
    s_add_u32 s52, s52, s50
    s_min_u32 s22, s52, 469762048
    s_mov_b32 s68, 0
    s_cmp_lt_u32 s28, 12
    s_cselect_b32 s71, 8, 7
    s_cmp_lt_u32 s29, 1242
    s_cselect_b32 s35, 13994, s35
    s_waitcnt lgkmcnt(0)
    s_barrier
    s_cmp_lt_u32 s33, 1536
    s_cbranch_scc1 p1_f0
    s_cmp_lg_u32 s28, 15
    s_cbranch_scc1 p1_hv0
    s_sub_u32 s52, s33, 1536
    s_and_b32 s52, s52, 255
    s_lshl_b32 s58, s52, 2
    s_and_b32 s58, s58, 28
    s_lshl_b32 s53, 1, s58
    v_mov_b32 v127, s53
    s_lshr_b32 s52, s52, 3
    s_lshl_b32 s52, s52, 2
    s_mov_b64 exec, 1
    buffer_atomic_add v127, off, s[40:43], s52 sc0 sc1
    s_mov_b64 exec, -1
p1_hv0:
    s_cmp_ge_u32 s33, 1656
    s_cbranch_scc1 p1_f0
    s_sub_u32 s52, s33, 1536
    s_mul_i32 s52, s52, 53368
    s_mul_i32 s53, s28, 3072
    s_add_u32 s53, s53, s52
    v_and_b32 v92, 63, v0
    v_lshl_add_u32 v93, v92, 2, s53
    s_lshl_b32 s53, s28, 9
    s_add_u32 s53, s53, s52
    s_add_u32 s53, s53, 49152
    s_cmp_lt_u32 s28, 9
    s_cselect_b32 s53, s53, 0x40000000
    v_lshl_add_u32 v94, v92, 2, s53
    buffer_load_dword v76, v93, s[24:27], 0 offen offset:0
    buffer_load_dword v77, v93, s[24:27], 0 offen offset:256
    buffer_load_dword v78, v93, s[24:27], 0 offen offset:512
    buffer_load_dword v79, v93, s[24:27], 0 offen offset:768
    buffer_load_dword v80, v93, s[24:27], 0 offen offset:1024
    buffer_load_dword v81, v93, s[24:27], 0 offen offset:1280
    buffer_load_dword v82, v93, s[24:27], 0 offen offset:1536
    buffer_load_dword v83, v93, s[24:27], 0 offen offset:1792
    buffer_load_dword v84, v93, s[24:27], 0 offen offset:2048
    buffer_load_dword v85, v93, s[24:27], 0 offen offset:2304
    buffer_load_dword v86, v93, s[24:27], 0 offen offset:2560
    buffer_load_dword v87, v93, s[24:27], 0 offen offset:2816
    buffer_load_dword v88, v94, s[24:27], 0 offen offset:0
    buffer_load_dword v89, v94, s[24:27], 0 offen offset:256
p1_f0:
    v_and_b32 v117, 0xffff, v40
    ds_add_rtn_u32 v117, v117, v3 offset:0
    v_and_b32 v118, 0xffff, v41
    ds_add_rtn_u32 v118, v118, v3 offset:0
    v_and_b32 v119, 0xffff, v42
    ds_add_rtn_u32 v119, v119, v3 offset:0
    v_and_b32 v120, 0xffff, v43
    ds_add_rtn_u32 v120, v120, v3 offset:0
    s_cmp_ge_u32 s33, 1536
    s_cbranch_scc1 p1_k18
    s_cmp_lt_u32 s33, 1536
    s_cselect_b32 s14, 102400000, 0
    s_add_u32 s32, s31, 0
    buffer_load_dwordx2 v[76:77], v2, s[12:15], s32 offen nt
p1_k18:
    s_cmp_ge_u32 s33, 1536
    s_cbranch_scc1 p1_k19
    s_cmp_lt_u32 s33, 1536
    s_cselect_b32 s6, 204800000, 0
    s_cselect_b32 s10, 204800000, 0
    s_add_u32 s32, s30, 0
    buffer_load_dwordx4 v[94:97], v1, s[4:7], s32 offen nt
    buffer_load_dwordx4 v[102:105], v1, s[8:11], s32 offen nt
p1_k19:
    s_cmp_lt_u32 s29, 1499
    s_cbranch_scc1 p1_pa0
    s_waitcnt lgkmcnt(0)
    s_branch p1_pb0
p1_pa0:
    v_and_b32 v121, 0xffff, v44
    ds_add_rtn_u32 v121, v121, v3 offset:0
    v_and_b32 v122, 0xffff, v45
    ds_add_rtn_u32 v122, v122, v3 offset:0
    v_and_b32 v123, 0xffff, v46
    ds_add_rtn_u32 v123, v123, v3 offset:0
    v_and_b32 v124, 0xffff, v47
    ds_add_rtn_u32 v124, v124, v3 offset:0
    s_waitcnt lgkmcnt(4)
p1_pb0:
    ds_write_b8_d16_hi v117, v40 offset:10496
    v_lshlrev_b32 v40, 2, v117
    ds_write_b32 v40, v4 offset:52480
    ds_write_b8_d16_hi v118, v41 offset:10496
    v_lshlrev_b32 v41, 2, v118
    ds_write_b32 v41, v5 offset:52480
    ds_write_b8_d16_hi v119, v42 offset:10496
    v_lshlrev_b32 v42, 2, v119
    ds_write_b32 v42, v6 offset:52480
    ds_write_b8_d16_hi v120, v43 offset:10496
    v_lshlrev_b32 v43, 2, v120
    ds_write_b32 v43, v7 offset:52480
    s_cmp_ge_u32 s33, 1536
    s_cbranch_scc1 p1_k20
    s_cmp_lt_u32 s33, 1499
    s_cselect_b32 s14, 102400000, 0
    s_add_u32 s32, s31, 8192
    buffer_load_dwordx2 v[78:79], v2, s[12:15], s32 offen nt
p1_k20:
    s_cmp_lt_u32 s29, 1462
    s_cbranch_scc1 p1_pa1
    s_waitcnt lgkmcnt(0)
    s_branch p1_pb1
p1_pa1:
    v_and_b32 v117, 0xffff, v48
    ds_add_rtn_u32 v117, v117, v3 offset:0
    v_and_b32 v118, 0xffff, v49
    ds_add_rtn_u32 v118, v118, v3 offset:0
    v_and_b32 v119, 0xffff, v50
    ds_add_rtn_u32 v119, v119, v3 offset:0
    v_and_b32 v120, 0xffff, v51
    ds_add_rtn_u32 v120, v120, v3 offset:0
    s_waitcnt lgkmcnt(4)
p1_pb1:
    s_cmp_ge_u32 s29, 1499
    s_cbranch_scc1 p1_k21
    ds_write_b8_d16_hi v121, v44 offset:10496
    v_lshlrev_b32 v44, 2, v121
    ds_write_b32 v44, v8 offset:52480
    ds_write_b8_d16_hi v122, v45 offset:10496
    v_lshlrev_b32 v45, 2, v122
    ds_write_b32 v45, v9 offset:52480
    ds_write_b8_d16_hi v123, v46 offset:10496
    v_lshlrev_b32 v46, 2, v123
    ds_write_b32 v46, v10 offset:52480
    ds_write_b8_d16_hi v124, v47 offset:10496
    v_lshlrev_b32 v47, 2, v124
    ds_write_b32 v47, v11 offset:52480
p1_k21:
    s_cmp_ge_u32 s33, 1536
    s_cbranch_scc1 p1_k22
    s_cmp_lt_u32 s33, 1462
    s_cselect_b32 s14, 102400000, 0
    s_add_u32 s32, s31, 16384
    buffer_load_dwordx2 v[80:81], v2, s[12:15], s32 offen nt
p1_k22:
    s_cmp_lt_u32 s29, 1426
    s_cbranch_scc1 p1_pa2
    s_waitcnt lgkmcnt(0)
    s_branch p1_pb2
p1_pa2:
    v_and_b32 v121, 0xffff, v52
    ds_add_rtn_u32 v121, v121, v3 offset:0
    v_and_b32 v122, 0xffff, v53
    ds_add_rtn_u32 v122, v122, v3 offset:0
    v_and_b32 v123, 0xffff, v54
    ds_add_rtn_u32 v123, v123, v3 offset:0
    v_and_b32 v124, 0xffff, v55
    ds_add_rtn_u32 v124, v124, v3 offset:0
    s_waitcnt lgkmcnt(4)
p1_pb2:
    s_cmp_ge_u32 s29, 1462
    s_cbranch_scc1 p1_k23
    ds_write_b8_d16_hi v117, v48 offset:10496
    v_lshlrev_b32 v48, 2, v117
    ds_write_b32 v48, v12 offset:52480
    ds_write_b8_d16_hi v118, v49 offset:10496
    v_lshlrev_b32 v49, 2, v118
    ds_write_b32 v49, v13 offset:52480
    ds_write_b8_d16_hi v119, v50 offset:10496
    v_lshlrev_b32 v50, 2, v119
    ds_write_b32 v50, v14 offset:52480
    ds_write_b8_d16_hi v120, v51 offset:10496
    v_lshlrev_b32 v51, 2, v120
    ds_write_b32 v51, v15 offset:52480
p1_k23:
    s_cmp_ge_u32 s28, 10
    s_cbranch_scc1 p1_jn
    s_waitcnt vmcnt(0)
    v_mov_b32 v125, 0
    s_mov_b64 exec, 1
    ds_add_rtn_u32 v125, v125, v3 offset:10432
    s_waitcnt lgkmcnt(0)
    v_readfirstlane_b32 s52, v125
    s_lshr_b32 s53, s29, 1
    s_and_b32 s53, s53, 28
    s_cmp_lg_u32 s52, 9
    s_cbranch_scc1 p1_jn1
    s_lshl_b32 s54, 1, s53
    v_mov_b32 v127, s54
    s_lshr_b32 s54, s29, 6
    s_lshl_b32 s54, s54, 2
    s_mov_b32 s68, 1
    buffer_atomic_add v127, off, s[40:43], s54 sc0 sc1
p1_jn1:
    s_mov_b64 exec, -1
p1_jn:
    s_cmp_ge_u32 s33, 1536
    s_cbranch_scc1 p1_k24
    s_cmp_lt_u32 s33, 1426
    s_cselect_b32 s14, 102400000, 0
    s_add_u32 s32, s31, 24576
    buffer_load_dwordx2 v[82:83], v2, s[12:15], s32 offen nt
p1_k24:
    s_cmp_lt_u32 s29, 1389
    s_cbranch_scc1 p1_pa3
    s_waitcnt lgkmcnt(0)
    s_branch p1_pb3
p1_pa3:
    v_and_b32 v117, 0xffff, v56
    ds_add_rtn_u32 v117, v117, v3 offset:0
    v_and_b32 v118, 0xffff, v57
    ds_add_rtn_u32 v118, v118, v3 offset:0
    v_and_b32 v119, 0xffff, v58
    ds_add_rtn_u32 v119, v119, v3 offset:0
    v_and_b32 v120, 0xffff, v59
    ds_add_rtn_u32 v120, v120, v3 offset:0
    s_waitcnt lgkmcnt(4)
p1_pb3:
    s_cmp_ge_u32 s29, 1426
    s_cbranch_scc1 p1_k25
    ds_write_b8_d16_hi v121, v52 offset:10496
    v_lshlrev_b32 v52, 2, v121
    ds_write_b32 v52, v16 offset:52480
    ds_write_b8_d16_hi v122, v53 offset:10496
    v_lshlrev_b32 v53, 2, v122
    ds_write_b32 v53, v17 offset:52480
    ds_write_b8_d16_hi v123, v54 offset:10496
    v_lshlrev_b32 v54, 2, v123
    ds_write_b32 v54, v18 offset:52480
    ds_write_b8_d16_hi v124, v55 offset:10496
    v_lshlrev_b32 v55, 2, v124
    ds_write_b32 v55, v19 offset:52480
p1_k25:
    s_cmp_ge_u32 s33, 1536
    s_cbranch_scc1 p1_k26
    s_cmp_lt_u32 s33, 1389
    s_cselect_b32 s14, 102400000, 0
    s_add_u32 s32, s31, 32768
    buffer_load_dwordx2 v[84:85], v2, s[12:15], s32 offen nt
p1_k26:
    s_cmp_ge_u32 s33, 1536
    s_cbranch_scc1 p1_k27
    s_cmp_lt_u32 s33, 1499
    s_cselect_b32 s6, 204800000, 0
    s_cselect_b32 s10, 204800000, 0
    s_add_u32 s32, s30, 16384
    buffer_load_dwordx4 v[98:101], v1, s[4:7], s32 offen nt
    buffer_load_dwordx4 v[106:109], v1, s[8:11], s32 offen nt
p1_k27:
    s_cmp_lt_u32 s29, 1352
    s_cbranch_scc1 p1_pa4
    s_waitcnt lgkmcnt(0)
    s_branch p1_pb4
p1_pa4:
    v_and_b32 v121, 0xffff, v60
    ds_add_rtn_u32 v121, v121, v3 offset:0
    v_and_b32 v122, 0xffff, v61
    ds_add_rtn_u32 v122, v122, v3 offset:0
    v_and_b32 v123, 0xffff, v62
    ds_add_rtn_u32 v123, v123, v3 offset:0
    v_and_b32 v124, 0xffff, v63
    ds_add_rtn_u32 v124, v124, v3 offset:0
    s_waitcnt lgkmcnt(4)
p1_pb4:
    s_cmp_ge_u32 s29, 1389
    s_cbranch_scc1 p1_k28
    ds_write_b8_d16_hi v117, v56 offset:10496
    v_lshlrev_b32 v56, 2, v117
    ds_write_b32 v56, v20 offset:52480
    ds_write_b8_d16_hi v118, v57 offset:10496
    v_lshlrev_b32 v57, 2, v118
    ds_write_b32 v57, v21 offset:52480
    ds_write_b8_d16_hi v119, v58 offset:10496
    v_lshlrev_b32 v58, 2, v119
    ds_write_b32 v58, v22 offset:52480
    ds_write_b8_d16_hi v120, v59 offset:10496
    v_lshlrev_b32 v59, 2, v120
    ds_write_b32 v59, v23 offset:52480
p1_k28:
    s_cmp_ge_u32 s33, 1536
    s_cbranch_scc1 p1_k29
    s_cmp_lt_u32 s33, 1352
    s_cselect_b32 s14, 102400000, 0
    s_add_u32 s32, s31, 40960
    buffer_load_dwordx2 v[86:87], v2, s[12:15], s32 offen nt
p1_k29:
    s_cmp_lt_u32 s29, 1315
    s_cbranch_scc1 p1_pa5
    s_waitcnt lgkmcnt(0)
    s_branch p1_pb5
p1_pa5:
    v_and_b32 v117, 0xffff, v64
    ds_add_rtn_u32 v117, v117, v3 offset:0
    v_and_b32 v118, 0xffff, v65
    ds_add_rtn_u32 v118, v118, v3 offset:0
    v_and_b32 v119, 0xffff, v66
    ds_add_rtn_u32 v119, v119, v3 offset:0
    v_and_b32 v120, 0xffff, v67
    ds_add_rtn_u32 v120, v120, v3 offset:0
    s_waitcnt lgkmcnt(4)
p1_pb5:
    s_cmp_ge_u32 s29, 1352
    s_cbranch_scc1 p1_k30
    ds_write_b8_d16_hi v121, v60 offset:10496
    v_lshlrev_b32 v60, 2, v121
    ds_write_b32 v60, v24 offset:52480
    ds_write_b8_d16_hi v122, v61 offset:10496
    v_lshlrev_b32 v61, 2, v122
    ds_write_b32 v61, v25 offset:52480
    ds_write_b8_d16_hi v123, v62 offset:10496
    v_lshlrev_b32 v62, 2, v123
    ds_write_b32 v62, v26 offset:52480
    ds_write_b8_d16_hi v124, v63 offset:10496
    v_lshlrev_b32 v63, 2, v124
    ds_write_b32 v63, v27 offset:52480
p1_k30:
    s_cmp_ge_u32 s33, 1536
    s_cbranch_scc1 p1_k31
    s_cmp_lt_u32 s33, 1315
    s_cselect_b32 s14, 102400000, 0
    s_add_u32 s32, s31, 49152
    buffer_load_dwordx2 v[88:89], v2, s[12:15], s32 offen nt
p1_k31:
    s_cmp_lt_u32 s29, 1279
    s_cbranch_scc1 p1_pa6
    s_waitcnt lgkmcnt(0)
    s_branch p1_pb6
p1_pa6:
    v_and_b32 v121, 0xffff, v68
    ds_add_rtn_u32 v121, v121, v3 offset:0
    v_and_b32 v122, 0xffff, v69
    ds_add_rtn_u32 v122, v122, v3 offset:0
    v_and_b32 v123, 0xffff, v70
    ds_add_rtn_u32 v123, v123, v3 offset:0
    v_and_b32 v124, 0xffff, v71
    ds_add_rtn_u32 v124, v124, v3 offset:0
    s_waitcnt lgkmcnt(4)
p1_pb6:
    s_cmp_ge_u32 s29, 1315
    s_cbranch_scc1 p1_k32
    ds_write_b8_d16_hi v117, v64 offset:10496
    v_lshlrev_b32 v64, 2, v117
    ds_write_b32 v64, v28 offset:52480
    ds_write_b8_d16_hi v118, v65 offset:10496
    v_lshlrev_b32 v65, 2, v118
    ds_write_b32 v65, v29 offset:52480
    ds_write_b8_d16_hi v119, v66 offset:10496
    v_lshlrev_b32 v66, 2, v119
    ds_write_b32 v66, v30 offset:52480
    ds_write_b8_d16_hi v120, v67 offset:10496
    v_lshlrev_b32 v67, 2, v120
    ds_write_b32 v67, v31 offset:52480
p1_k32:
    s_cmp_ge_u32 s33, 1536
    s_cbranch_scc1 p1_k33
    s_cmp_lt_u32 s33, 1279
    s_cselect_b32 s14, 102400000, 0
    s_add_u32 s32, s31, 57344
    buffer_load_dwordx2 v[90:91], v2, s[12:15], s32 offen nt
p1_k33:
    s_cmp_lt_u32 s29, 1242
    s_cbranch_scc1 p1_pa7
    s_waitcnt lgkmcnt(0)
    s_branch p1_pb7
p1_pa7:
    v_and_b32 v117, 0xffff, v72
    ds_add_rtn_u32 v117, v117, v3 offset:0
    v_and_b32 v118, 0xffff, v73
    ds_add_rtn_u32 v118, v118, v3 offset:0
    v_and_b32 v119, 0xffff, v74
    ds_add_rtn_u32 v119, v119, v3 offset:0
    v_and_b32 v120, 0xffff, v75
    ds_add_rtn_u32 v120, v120, v3 offset:0
    s_waitcnt lgkmcnt(4)
p1_pb7:
    s_cmp_ge_u32 s29, 1279
    s_cbranch_scc1 p1_k34
    ds_write_b8_d16_hi v121, v68 offset:10496
    v_lshlrev_b32 v68, 2, v121
    ds_write_b32 v68, v32 offset:52480
    ds_write_b8_d16_hi v122, v69 offset:10496
    v_lshlrev_b32 v69, 2, v122
    ds_write_b32 v69, v33 offset:52480
    ds_write_b8_d16_hi v123, v70 offset:10496
    v_lshlrev_b32 v70, 2, v123
    ds_write_b32 v70, v34 offset:52480
    ds_write_b8_d16_hi v124, v71 offset:10496
    v_lshlrev_b32 v71, 2, v124
    ds_write_b32 v71, v35 offset:52480
p1_k34:
    s_cmp_ge_u32 s33, 1536
    s_cbranch_scc1 p1_k35
    s_cmp_lt_u32 s33, 1242
    s_cselect_b32 s14, 102400000, 0
    s_add_u32 s32, s31, 65536
    buffer_load_dwordx2 v[92:93], v2, s[12:15], s32 offen nt
p1_k35:
    s_waitcnt lgkmcnt(0)
    s_cmp_ge_u32 s29, 1242
    s_cbranch_scc1 p1_k36
    ds_write_b8_d16_hi v117, v72 offset:10496
    v_lshlrev_b32 v72, 2, v117
    ds_write_b32 v72, v36 offset:52480
    ds_write_b8_d16_hi v118, v73 offset:10496
    v_lshlrev_b32 v73, 2, v118
    ds_write_b32 v73, v37 offset:52480
    ds_write_b8_d16_hi v119, v74 offset:10496
    v_lshlrev_b32 v74, 2, v119
    ds_write_b32 v74, v38 offset:52480
    ds_write_b8_d16_hi v120, v75 offset:10496
    v_lshlrev_b32 v75, 2, v120
    ds_write_b32 v75, v39 offset:52480
p1_k36:
    s_cmp_eq_u32 s68, 0
    s_cbranch_scc1 p1_sg
    s_cmp_lt_u32 s33, 1536
    s_cbranch_scc1 p1_w37
    s_waitcnt vmcnt(0)
p1_w37:
    s_waitcnt vmcnt(8)
    v_bfe_u32 v127, v127, s53, 4
    v_mov_b32 v125, 0
    s_mov_b64 exec, 1
    ds_write_b32 v125, v127 offset:10452
    s_mov_b64 exec, -1
p1_sg:
    s_cmp_lt_u32 s33, 1536
    s_cbranch_scc1 p1_f1
    s_cmp_lg_u32 s28, 15
    s_cbranch_scc1 p1_hv1
    s_waitcnt vmcnt(0)
    v_bfe_u32 v127, v127, s58, 4
    v_mov_b32 v125, 0
    s_mov_b64 exec, 1
    ds_write_b32 v125, v127 offset:10448
    s_mov_b64 exec, -1
p1_hv1:
    s_cmp_ge_u32 s33, 1656
    s_cbranch_scc1 p1_f1
    s_sub_u32 s52, s33, 1536
    s_mul_i32 s53, s52, 53760
    s_add_u32 s53, s53, 485810176
    s_mul_i32 s54, s28, 3072
    v_lshl_add_u32 v93, v92, 4, s54
    s_lshl_b32 s54, s28, 9
    s_add_u32 s54, s54, 49152
    s_cmp_lt_u32 s28, 9
    s_cselect_b32 s54, s54, 0x40000000
    v_lshl_add_u32 v94, v92, 3, s54
    v_mov_b32 v96, 0
    v_mov_b32 v97, 0
    s_waitcnt vmcnt(0)
    buffer_store_dwordx4 v[76:79], v93, s[16:19], s53 offen offset:0
    buffer_store_dwordx4 v[80:83], v93, s[16:19], s53 offen offset:1024
    buffer_store_dwordx4 v[84:87], v93, s[16:19], s53 offen offset:2048
    buffer_store_dwordx2 v[88:89], v94, s[16:19], s53 offen
    v_and_b32 v98, 0x7fff7fff, v76
    v_pk_max_u16 v96, v96, v98
    v_lshlrev_b32 v99, 16, v98
    v_and_b32 v98, 0xffff0000, v98
    v_fmac_f32 v97, v99, v99
    v_fmac_f32 v97, v98, v98
    v_and_b32 v98, 0x7fff7fff, v77
    v_pk_max_u16 v96, v96, v98
    v_lshlrev_b32 v99, 16, v98
    v_and_b32 v98, 0xffff0000, v98
    v_fmac_f32 v97, v99, v99
    v_fmac_f32 v97, v98, v98
    v_and_b32 v98, 0x7fff7fff, v78
    v_pk_max_u16 v96, v96, v98
    v_lshlrev_b32 v99, 16, v98
    v_and_b32 v98, 0xffff0000, v98
    v_fmac_f32 v97, v99, v99
    v_fmac_f32 v97, v98, v98
    v_and_b32 v98, 0x7fff7fff, v79
    v_pk_max_u16 v96, v96, v98
    v_lshlrev_b32 v99, 16, v98
    v_and_b32 v98, 0xffff0000, v98
    v_fmac_f32 v97, v99, v99
    v_fmac_f32 v97, v98, v98
    v_and_b32 v98, 0x7fff7fff, v80
    v_pk_max_u16 v96, v96, v98
    v_lshlrev_b32 v99, 16, v98
    v_and_b32 v98, 0xffff0000, v98
    v_fmac_f32 v97, v99, v99
    v_fmac_f32 v97, v98, v98
    v_and_b32 v98, 0x7fff7fff, v81
    v_pk_max_u16 v96, v96, v98
    v_lshlrev_b32 v99, 16, v98
    v_and_b32 v98, 0xffff0000, v98
    v_fmac_f32 v97, v99, v99
    v_fmac_f32 v97, v98, v98
    v_and_b32 v98, 0x7fff7fff, v82
    v_pk_max_u16 v96, v96, v98
    v_lshlrev_b32 v99, 16, v98
    v_and_b32 v98, 0xffff0000, v98
    v_fmac_f32 v97, v99, v99
    v_fmac_f32 v97, v98, v98
    v_and_b32 v98, 0x7fff7fff, v83
    v_pk_max_u16 v96, v96, v98
    v_lshlrev_b32 v99, 16, v98
    v_and_b32 v98, 0xffff0000, v98
    v_fmac_f32 v97, v99, v99
    v_fmac_f32 v97, v98, v98
    v_and_b32 v98, 0x7fff7fff, v84
    v_pk_max_u16 v96, v96, v98
    v_lshlrev_b32 v99, 16, v98
    v_and_b32 v98, 0xffff0000, v98
    v_fmac_f32 v97, v99, v99
    v_fmac_f32 v97, v98, v98
    v_and_b32 v98, 0x7fff7fff, v85
    v_pk_max_u16 v96, v96, v98
    v_lshlrev_b32 v99, 16, v98
    v_and_b32 v98, 0xffff0000, v98
    v_fmac_f32 v97, v99, v99
    v_fmac_f32 v97, v98, v98
    v_and_b32 v98, 0x7fff7fff, v86
    v_pk_max_u16 v96, v96, v98
    v_lshlrev_b32 v99, 16, v98
    v_and_b32 v98, 0xffff0000, v98
    v_fmac_f32 v97, v99, v99
    v_fmac_f32 v97, v98, v98
    v_and_b32 v98, 0x7fff7fff, v87
    v_pk_max_u16 v96, v96, v98
    v_lshlrev_b32 v99, 16, v98
    v_and_b32 v98, 0xffff0000, v98
    v_fmac_f32 v97, v99, v99
    v_fmac_f32 v97, v98, v98
    v_and_b32 v98, 0x7fff7fff, v88
    v_pk_max_u16 v96, v96, v98
    v_lshlrev_b32 v99, 16, v98
    v_and_b32 v98, 0xffff0000, v98
    v_fmac_f32 v97, v99, v99
    v_fmac_f32 v97, v98, v98
    v_and_b32 v98, 0x7fff7fff, v89
    v_pk_max_u16 v96, v96, v98
    v_lshlrev_b32 v99, 16, v98
    v_and_b32 v98, 0xffff0000, v98
    v_fmac_f32 v97, v99, v99
    v_fmac_f32 v97, v98, v98
    v_lshrrev_b32 v98, 16, v96
    v_and_b32 v96, 0xffff, v96
    v_max_u32 v96, v96, v98
    s_nop 1
    v_max_u32_dpp v96, v96, v96 row_shr:1 row_mask:0xf bank_mask:0xf bound_ctrl:0
    v_add_f32_dpp v97, v97, v97 row_shr:1 row_mask:0xf bank_mask:0xf bound_ctrl:0
    s_nop 0
    v_max_u32_dpp v96, v96, v96 row_shr:2 row_mask:0xf bank_mask:0xf bound_ctrl:0
    v_add_f32_dpp v97, v97, v97 row_shr:2 row_mask:0xf bank_mask:0xf bound_ctrl:0
    s_nop 0
    v_max_u32_dpp v96, v96, v96 row_shr:4 row_mask:0xf bank_mask:0xf bound_ctrl:0
    v_add_f32_dpp v97, v97, v97 row_shr:4 row_mask:0xf bank_mask:0xf bound_ctrl:0
    s_nop 0
    v_max_u32_dpp v96, v96, v96 row_shr:8 row_mask:0xf bank_mask:0xf bound_ctrl:0
    v_add_f32_dpp v97, v97, v97 row_shr:8 row_mask:0xf bank_mask:0xf bound_ctrl:0
    s_nop 0
    v_max_u32_dpp v96, v96, v96 row_bcast:15 row_mask:0xa bank_mask:0xf
    v_add_f32_dpp v97, v97, v97 row_bcast:15 row_mask:0xa bank_mask:0xf
    s_nop 0
    v_max_u32_dpp v96, v96, v96 row_bcast:31 row_mask:0xc bank_mask:0xf
    v_add_f32_dpp v97, v97, v97 row_bcast:31 row_mask:0xc bank_mask:0xf
    s_nop 0
    s_nop 0
    s_lshl_b32 s52, s52, 4
    s_add_u32 s52, s52, s28
    s_lshl_b32 s52, s52, 3
    s_add_u32 s52, s52, 492261376
    s_mov_b64 exec, 1
    s_lshl_b64 exec, exec, 63
    buffer_store_dwordx2 v[96:97], off, s[16:19], s52
    s_mov_b64 exec, -1
p1_f1:
    s_waitcnt lgkmcnt(0)
    s_barrier
    v_mul_u32_u24 v119, 3, v0
    v_and_b32 v118, -4, v119
    v_add_u32 v120, s50, v1
    v_mov_b32 v122, 0
    v_mov_b32 v123, 0
    v_mov_b32 v124, 0
    v_mov_b32 v125, 0
    ds_read_b64 v[126:127], v122 offset:10448
    ds_write_b32 v122, v122 offset:10432
    v_cmp_gt_u32 vcc, 640, v0
    s_and_saveexec_b64 s[52:53], vcc
    ds_write_b128 v1, v[122:125] offset:0
    s_mov_b64 exec, -1
    s_waitcnt lgkmcnt(2)
    v_readfirstlane_b32 s70, v126
    v_readfirstlane_b32 s69, v127
    s_cmp_ge_u32 s33, 1536
    s_cselect_b32 s70, s70, 0
    s_cmp_gt_u32 s28, 10
    s_cselect_b32 s69, 0, s69
    s_cselect_b32 s70, 0, s70
    s_cmp_lg_u32 s70, 8
    s_cbranch_scc1 p1_h0
    s_sub_u32 s52, s33, 1536
    v_and_b32 v102, 63, v0
    s_cmp_eq_u32 s28, 10
    s_cbranch_scc1 p1_tr10
    s_mul_i32 s53, s28, 520
    v_lshl_add_u32 v100, v102, 3, s53
    s_mul_i32 s53, s28, 4160
    v_lshl_add_u32 v101, v102, 4, s53
    s_branch p1_tr20
p1_tr10:
    v_mul_u32_u24 v100, 520, v102
    v_add_u32 v100, 512, v100
    v_mul_u32_u24 v101, 4160, v102
    v_add_u32 v101, 1024, v101
    v_cmp_gt_u32 vcc, 10, v102
    v_mov_b32 v102, 0x40000000
    s_nop 0
    v_cndmask_b32 v100, v102, v100, vcc
    v_cndmask_b32 v101, v102, v101, vcc
p1_tr20:
    s_mul_i32 s52, s52, 41984
    s_add_u32 s52, s52, 469762048
    buffer_load_dwordx2 v[76:77], v100, s[16:19], s52 offen sc1
    s_add_u32 s52, s52, 5248
    buffer_load_dwordx2 v[78:79], v100, s[16:19], s52 offen sc1
    s_add_u32 s52, s52, 5248
    buffer_load_dwordx2 v[80:81], v100, s[16:19], s52 offen sc1
    s_add_u32 s52, s52, 5248
    buffer_load_dwordx2 v[82:83], v100, s[16:19], s52 offen sc1
    s_add_u32 s52, s52, 5248
    buffer_load_dwordx2 v[84:85], v100, s[16:19], s52 offen sc1
    s_add_u32 s52, s52, 5248
    buffer_load_dwordx2 v[86:87], v100, s[16:19], s52 offen sc1
    s_add_u32 s52, s52, 5248
    buffer_load_dwordx2 v[88:89], v100, s[16:19], s52 offen sc1
    s_add_u32 s52, s52, 5248
    buffer_load_dwordx2 v[90:91], v100, s[16:19], s52 offen sc1
    s_add_u32 s52, s52, 5248
p1_h0:
    v_lshlrev_b32 v117, 2, v119
    v_add_u32 v117, 52480, v117
    ds_read_b32 v110, v117 offset:0
    ds_read_b32 v111, v117 offset:4
    ds_read_b32 v112, v117 offset:8
    ds_read_b32 v113, v118 offset:10496
    ds_read_b32 v114, v118 offset:10500
    ds_read_b32 v122, v117 offset:12288
    ds_read_b32 v123, v117 offset:12292
    ds_read_b32 v124, v117 offset:12296
    ds_read_b32 v125, v118 offset:13568
    ds_read_b32 v121, v118 offset:13572
    s_waitcnt lgkmcnt(5)
    v_alignbyte_b32 v113, v114, v113, v119
    buffer_store_dwordx4 v[110:113], v120, s[20:23], 0 offen
    v_add_u32 v120, 33554432, v120
    s_nop 0
    ds_read_b32 v110, v117 offset:24576
    ds_read_b32 v111, v117 offset:24580
    ds_read_b32 v112, v117 offset:24584
    ds_read_b32 v113, v118 offset:16640
    ds_read_b32 v114, v118 offset:16644
    s_cmp_le_u32 s35, 1024
    s_cbranch_scc1 p1_ce0
    s_waitcnt lgkmcnt(5)
    v_alignbyte_b32 v125, v121, v125, v119
    buffer_store_dwordx4 v[122:125], v120, s[20:23], 0 offen
    v_add_u32 v120, 33554432, v120
    s_nop 0
    ds_read_b32 v122, v117 offset:36864
    ds_read_b32 v123, v117 offset:36868
    ds_read_b32 v124, v117 offset:36872
    ds_read_b32 v125, v118 offset:19712
    ds_read_b32 v121, v118 offset:19716
    s_cmp_le_u32 s35, 2048
    s_cbranch_scc1 p1_ce0
    s_waitcnt lgkmcnt(5)
    v_alignbyte_b32 v113, v114, v113, v119
    buffer_store_dwordx4 v[110:113], v120, s[20:23], 0 offen
    v_add_u32 v120, 33554432, v120
    s_nop 0
    ds_read_b32 v110, v117 offset:49152
    ds_read_b32 v111, v117 offset:49156
    ds_read_b32 v112, v117 offset:49160
    ds_read_b32 v113, v118 offset:22784
    ds_read_b32 v114, v118 offset:22788
    s_cmp_le_u32 s35, 3072
    s_cbranch_scc1 p1_ce0
    s_waitcnt lgkmcnt(5)
    v_alignbyte_b32 v125, v121, v125, v119
    buffer_store_dwordx4 v[122:125], v120, s[20:23], 0 offen
    v_add_u32 v120, 33554432, v120
    s_nop 0
    v_lshlrev_b32 v117, 2, v119
    v_add_u32 v117, 113920, v117
    ds_read_b32 v122, v117 offset:0
    ds_read_b32 v123, v117 offset:4
    ds_read_b32 v124, v117 offset:8
    ds_read_b32 v125, v118 offset:25856
    ds_read_b32 v121, v118 offset:25860
    s_cmp_le_u32 s35, 4096
    s_cbranch_scc1 p1_ce0
    s_waitcnt lgkmcnt(5)
    v_alignbyte_b32 v113, v114, v113, v119
    buffer_store_dwordx4 v[110:113], v120, s[20:23], 0 offen
    v_add_u32 v120, 33554432, v120
    s_nop 0
    ds_read_b32 v110, v117 offset:12288
    ds_read_b32 v111, v117 offset:12292
    ds_read_b32 v112, v117 offset:12296
    ds_read_b32 v113, v118 offset:28928
    ds_read_b32 v114, v118 offset:28932
    s_cmp_le_u32 s35, 5120
    s_cbranch_scc1 p1_ce0
    s_waitcnt lgkmcnt(5)
    v_alignbyte_b32 v125, v121, v125, v119
    buffer_store_dwordx4 v[122:125], v120, s[20:23], 0 offen
    v_add_u32 v120, 33554432, v120
    s_nop 0
    ds_read_b32 v122, v117 offset:24576
    ds_read_b32 v123, v117 offset:24580
    ds_read_b32 v124, v117 offset:24584
    ds_read_b32 v125, v118 offset:32000
    ds_read_b32 v121, v118 offset:32004
    s_cmp_le_u32 s35, 6144
    s_cbranch_scc1 p1_ce0
    s_waitcnt lgkmcnt(5)
    v_alignbyte_b32 v113, v114, v113, v119
    buffer_store_dwordx4 v[110:113], v120, s[20:23], 0 offen
    v_add_u32 v120, 33554432, v120
    s_nop 0
    ds_read_b32 v110, v117 offset:36864
    ds_read_b32 v111, v117 offset:36868
    ds_read_b32 v112, v117 offset:36872
    ds_read_b32 v113, v118 offset:35072
    ds_read_b32 v114, v118 offset:35076
    s_cmp_le_u32 s35, 7168
    s_cbranch_scc1 p1_ce0
    s_waitcnt lgkmcnt(5)
    v_alignbyte_b32 v125, v121, v125, v119
    s_cmp_le_u32 s71, 7
    s_cbranch_scc1 p1_pw7
    buffer_store_dwordx4 v[122:125], v120, s[20:23], 0 offen
    s_branch p1_px7
p1_pw7:
    buffer_store_dwordx4 v[122:125], v120, s[20:23], 0 offen nt
p1_px7:
    v_add_u32 v120, 33554432, v120
    s_nop 0
    s_cmp_le_u32 s35, 8192
    s_cbranch_scc1 p1_ce0
    s_waitcnt lgkmcnt(0)
    v_alignbyte_b32 v113, v114, v113, v119
    buffer_store_dwordx4 v[110:113], v120, s[20:23], 0 offen nt
    v_add_u32 v120, 33554432, v120
    s_nop 0
p1_ce0:
    s_waitcnt lgkmcnt(0)
    s_cmp_lg_u32 s70, 8
    s_cbranch_scc1 p1_h1
    s_sub_u32 s52, s33, 1536
    s_mul_i32 s52, s52, 41600
    s_add_u32 s52, s52, 477822976
    s_mov_b32 s54, 0x05040100
    s_mov_b32 s55, 0x07060302
    s_waitcnt vmcnt(1)
    v_perm_b32 v92, v78, v76, s54
    v_perm_b32 v93, v82, v80, s54
    v_perm_b32 v94, v86, v84, s54
    v_perm_b32 v95, v90, v88, s54
    buffer_store_dwordx4 v[92:95], v101, s[16:19], s52 offen offset:0
    v_perm_b32 v96, v78, v76, s55
    v_perm_b32 v97, v82, v80, s55
    v_perm_b32 v98, v86, v84, s55
    v_perm_b32 v99, v90, v88, s55
    buffer_store_dwordx4 v[96:99], v101, s[16:19], s52 offen offset:1040
    v_perm_b32 v92, v79, v77, s54
    v_perm_b32 v93, v83, v81, s54
    v_perm_b32 v94, v87, v85, s54
    v_perm_b32 v95, v91, v89, s54
    buffer_store_dwordx4 v[92:95], v101, s[16:19], s52 offen offset:2080
    v_perm_b32 v96, v79, v77, s55
    v_perm_b32 v97, v83, v81, s55
    v_perm_b32 v98, v87, v85, s55
    v_perm_b32 v99, v91, v89, s55
    buffer_store_dwordx4 v[96:99], v101, s[16:19], s52 offen offset:3120
p1_h1:
    s_barrier
    s_cmp_ge_u32 s29, 1462
    s_cbranch_scc1 p1_k38
    s_cmp_le_u32 s35, 9216
    s_cbranch_scc1 p1_s1k2
    v_sub_u32 v48, 221180, v48
    ds_write_b32 v48, v12 offset:52480
    v_sub_u32 v49, 221180, v49
    ds_write_b32 v49, v13 offset:52480
    v_sub_u32 v50, 221180, v50
    ds_write_b32 v50, v14 offset:52480
    v_sub_u32 v51, 221180, v51
    ds_write_b32 v51, v15 offset:52480
p1_s1k2:
p1_k38:
    s_cmp_ge_u32 s33, 1536
    s_cbranch_scc1 p1_k39
    s_cmp_lt_u32 s33, 1462
    s_cselect_b32 s6, 204800000, 0
    s_cselect_b32 s10, 204800000, 0
    s_add_u32 s32, s30, 32768
    buffer_load_dwordx4 v[12:15], v1, s[4:7], s32 offen nt
    buffer_load_dwordx4 v[48:51], v1, s[8:11], s32 offen nt
p1_k39:
    s_cmp_ge_u32 s29, 1426
    s_cbranch_scc1 p1_k40
    s_cmp_le_u32 s35, 9216
    s_cbranch_scc1 p1_s1k3
    v_sub_u32 v52, 221180, v52
    ds_write_b32 v52, v16 offset:52480
    v_sub_u32 v53, 221180, v53
    ds_write_b32 v53, v17 offset:52480
    v_sub_u32 v54, 221180, v54
    ds_write_b32 v54, v18 offset:52480
    v_sub_u32 v55, 221180, v55
    ds_write_b32 v55, v19 offset:52480
p1_s1k3:
p1_k40:
    s_cmp_ge_u32 s29, 1389
    s_cbranch_scc1 p1_k41
    s_cmp_le_u32 s35, 9216
    s_cbranch_scc1 p1_s1k4
    v_sub_u32 v56, 221180, v56
    ds_write_b32 v56, v20 offset:52480
    v_sub_u32 v57, 221180, v57
    ds_write_b32 v57, v21 offset:52480
    v_sub_u32 v58, 221180, v58
    ds_write_b32 v58, v22 offset:52480
    v_sub_u32 v59, 221180, v59
    ds_write_b32 v59, v23 offset:52480
p1_s1k4:
p1_k41:
    s_cmp_ge_u32 s29, 1352
    s_cbranch_scc1 p1_k42
    s_cmp_le_u32 s35, 9216
    s_cbranch_scc1 p1_s1k5
    v_sub_u32 v60, 221180, v60
    ds_write_b32 v60, v24 offset:52480
    v_sub_u32 v61, 221180, v61
    ds_write_b32 v61, v25 offset:52480
    v_sub_u32 v62, 221180, v62
    ds_write_b32 v62, v26 offset:52480
    v_sub_u32 v63, 221180, v63
    ds_write_b32 v63, v27 offset:52480
p1_s1k5:
p1_k42:
    s_cmp_ge_u32 s29, 1315
    s_cbranch_scc1 p1_k43
    s_cmp_le_u32 s35, 9216
    s_cbranch_scc1 p1_s1k6
    v_sub_u32 v64, 221180, v64
    ds_write_b32 v64, v28 offset:52480
    v_sub_u32 v65, 221180, v65
    ds_write_b32 v65, v29 offset:52480
    v_sub_u32 v66, 221180, v66
    ds_write_b32 v66, v30 offset:52480
    v_sub_u32 v67, 221180, v67
    ds_write_b32 v67, v31 offset:52480
p1_s1k6:
p1_k43:
    s_cmp_ge_u32 s29, 1279
    s_cbranch_scc1 p1_k44
    s_cmp_le_u32 s35, 9216
    s_cbranch_scc1 p1_s1k7
    v_sub_u32 v68, 221180, v68
    ds_write_b32 v68, v32 offset:52480
    v_sub_u32 v69, 221180, v69
    ds_write_b32 v69, v33 offset:52480
    v_sub_u32 v70, 221180, v70
    ds_write_b32 v70, v34 offset:52480
    v_sub_u32 v71, 221180, v71
    ds_write_b32 v71, v35 offset:52480
p1_s1k7:
p1_k44:
    s_cmp_ge_u32 s29, 1242
    s_cbranch_scc1 p1_k45
    s_cmp_le_u32 s35, 9216
    s_cbranch_scc1 p1_s1k8
    v_sub_u32 v72, 221180, v72
    ds_write_b32 v72, v36 offset:52480
    v_sub_u32 v73, 221180, v73
    ds_write_b32 v73, v37 offset:52480
    v_sub_u32 v74, 221180, v74
    ds_write_b32 v74, v38 offset:52480
    v_sub_u32 v75, 221180, v75
    ds_write_b32 v75, v39 offset:52480
p1_s1k8:
p1_k45:
    s_cmp_le_u32 s35, 9216
    s_cbranch_scc1 p1_s1k0
    v_sub_u32 v40, 221180, v40
    ds_write_b32 v40, v4 offset:52480
    v_sub_u32 v41, 221180, v41
    ds_write_b32 v41, v5 offset:52480
    v_sub_u32 v42, 221180, v42
    ds_write_b32 v42, v6 offset:52480
    v_sub_u32 v43, 221180, v43
    ds_write_b32 v43, v7 offset:52480
p1_s1k0:
    s_cmp_ge_u32 s29, 1499
    s_cbranch_scc1 p1_k46
    s_cmp_le_u32 s35, 9216
    s_cbranch_scc1 p1_s1k1
    v_sub_u32 v44, 221180, v44
    ds_write_b32 v44, v8 offset:52480
    v_sub_u32 v45, 221180, v45
    ds_write_b32 v45, v9 offset:52480
    v_sub_u32 v46, 221180, v46
    ds_write_b32 v46, v10 offset:52480
    v_sub_u32 v47, 221180, v47
    ds_write_b32 v47, v11 offset:52480
p1_s1k1:
p1_k46:
    s_cmp_lg_u32 s69, 8
    s_cbranch_scc1 p1_o1
    s_lshr_b32 s52, s29, 3
    v_and_b32 v74, 63, v0
    s_cmp_eq_u32 s28, 10
    s_cbranch_scc1 p1_tr11
    s_mul_i32 s53, s28, 520
    v_lshl_add_u32 v72, v74, 3, s53
    s_mul_i32 s53, s28, 4160
    v_lshl_add_u32 v73, v74, 4, s53
    s_branch p1_tr21
p1_tr11:
    v_mul_u32_u24 v72, 520, v74
    v_add_u32 v72, 512, v72
    v_mul_u32_u24 v73, 4160, v74
    v_add_u32 v73, 1024, v73
    v_cmp_gt_u32 vcc, 10, v74
    v_mov_b32 v74, 0x40000000
    s_nop 0
    v_cndmask_b32 v72, v74, v72, vcc
    v_cndmask_b32 v73, v74, v73, vcc
p1_tr21:
    s_mul_i32 s52, s52, 41984
    s_add_u32 s52, s52, 469762048
    buffer_load_dwordx2 v[24:25], v72, s[16:19], s52 offen sc1
    s_add_u32 s52, s52, 5248
    buffer_load_dwordx2 v[26:27], v72, s[16:19], s52 offen sc1
    s_add_u32 s52, s52, 5248
    buffer_load_dwordx2 v[28:29], v72, s[16:19], s52 offen sc1
    s_add_u32 s52, s52, 5248
    buffer_load_dwordx2 v[30:31], v72, s[16:19], s52 offen sc1
    s_add_u32 s52, s52, 5248
    buffer_load_dwordx2 v[32:33], v72, s[16:19], s52 offen sc1
    s_add_u32 s52, s52, 5248
    buffer_load_dwordx2 v[34:35], v72, s[16:19], s52 offen sc1
    s_add_u32 s52, s52, 5248
    buffer_load_dwordx2 v[36:37], v72, s[16:19], s52 offen sc1
    s_add_u32 s52, s52, 5248
    buffer_load_dwordx2 v[38:39], v72, s[16:19], s52 offen sc1
    s_add_u32 s52, s52, 5248
    s_cmp_ge_u32 s33, 1536
    s_cbranch_scc1 p1_o1
    s_lshr_b32 s52, s29, 3
    s_mul_i32 s52, s52, 41600
    s_add_u32 s52, s52, 477822976
    s_mov_b32 s54, 0x05040100
    s_mov_b32 s55, 0x07060302
    s_waitcnt vmcnt(0)
    v_perm_b32 v64, v26, v24, s54
    v_perm_b32 v65, v30, v28, s54
    v_perm_b32 v66, v34, v32, s54
    v_perm_b32 v67, v38, v36, s54
    buffer_store_dwordx4 v[64:67], v73, s[16:19], s52 offen offset:0
    v_perm_b32 v68, v26, v24, s55
    v_perm_b32 v69, v30, v28, s55
    v_perm_b32 v70, v34, v32, s55
    v_perm_b32 v71, v38, v36, s55
    buffer_store_dwordx4 v[68:71], v73, s[16:19], s52 offen offset:1040
    v_perm_b32 v64, v27, v25, s54
    v_perm_b32 v65, v31, v29, s54
    v_perm_b32 v66, v35, v33, s54
    v_perm_b32 v67, v39, v37, s54
    buffer_store_dwordx4 v[64:67], v73, s[16:19], s52 offen offset:2080
    v_perm_b32 v68, v27, v25, s55
    v_perm_b32 v69, v31, v29, s55
    v_perm_b32 v70, v35, v33, s55
    v_perm_b32 v71, v39, v37, s55
    buffer_store_dwordx4 v[68:71], v73, s[16:19], s52 offen offset:3120
    s_mov_b32 s69, 0
p1_o1:
    s_waitcnt lgkmcnt(0)
    s_barrier
    s_cmp_le_u32 s35, 9216
    s_cbranch_scc1 p1_ce1
    v_lshlrev_b32 v117, 2, v119
    v_sub_u32 v117, 113908, v117
    ds_read_b32 v122, v117 offset:49160
    ds_read_b32 v123, v117 offset:49156
    ds_read_b32 v124, v117 offset:49152
    ds_read_b32 v125, v118 offset:38144
    ds_read_b32 v121, v118 offset:38148
    ds_read_b32 v110, v117 offset:36872
    ds_read_b32 v111, v117 offset:36868
    ds_read_b32 v112, v117 offset:36864
    ds_read_b32 v113, v118 offset:41216
    ds_read_b32 v114, v118 offset:41220
    s_waitcnt lgkmcnt(5)
    v_alignbyte_b32 v125, v121, v125, v119
    buffer_store_dwordx4 v[122:125], v120, s[20:23], 0 offen nt
    v_add_u32 v120, 33554432, v120
    s_nop 0
    ds_read_b32 v122, v117 offset:24584
    ds_read_b32 v123, v117 offset:24580
    ds_read_b32 v124, v117 offset:24576
    ds_read_b32 v125, v118 offset:44288
    ds_read_b32 v121, v118 offset:44292
    s_cmp_le_u32 s35, 10240
    s_cbranch_scc1 p1_ce1
    s_waitcnt lgkmcnt(5)
    v_alignbyte_b32 v113, v114, v113, v119
    buffer_store_dwordx4 v[110:113], v120, s[20:23], 0 offen nt
    v_add_u32 v120, 33554432, v120
    s_nop 0
    ds_read_b32 v110, v117 offset:12296
    ds_read_b32 v111, v117 offset:12292
    ds_read_b32 v112, v117 offset:12288
    ds_read_b32 v113, v118 offset:47360
    ds_read_b32 v114, v118 offset:47364
    s_cmp_le_u32 s35, 11264
    s_cbranch_scc1 p1_ce1
    s_waitcnt lgkmcnt(5)
    v_alignbyte_b32 v125, v121, v125, v119
    buffer_store_dwordx4 v[122:125], v120, s[20:23], 0 offen nt
    v_add_u32 v120, 33554432, v120
    s_nop 0
    ds_read_b32 v122, v117 offset:8
    ds_read_b32 v123, v117 offset:4
    ds_read_b32 v124, v117 offset:0
    ds_read_b32 v125, v118 offset:50432
    ds_read_b32 v121, v118 offset:50436
    s_cmp_le_u32 s35, 12288
    s_cbranch_scc1 p1_ce1
    s_waitcnt lgkmcnt(5)
    v_alignbyte_b32 v113, v114, v113, v119
    buffer_store_dwordx4 v[110:113], v120, s[20:23], 0 offen nt
    v_add_u32 v120, 33554432, v120
    s_nop 0
    s_cmp_le_u32 s35, 13312
    s_cbranch_scc1 p1_ce1
    s_waitcnt lgkmcnt(0)
    v_alignbyte_b32 v125, v121, v125, v119
    buffer_store_dwordx4 v[122:125], v120, s[20:23], 0 offen nt
    v_add_u32 v120, 33554432, v120
    s_nop 0
p1_ce1:
    s_waitcnt lgkmcnt(0)
    s_cmp_lg_u32 s69, 8
    s_cbranch_scc1 p1_o2
    s_lshr_b32 s52, s29, 3
    s_mul_i32 s52, s52, 41600
    s_add_u32 s52, s52, 477822976
    s_mov_b32 s54, 0x05040100
    s_mov_b32 s55, 0x07060302
    s_waitcnt vmcnt(0)
    v_perm_b32 v64, v26, v24, s54
    v_perm_b32 v65, v30, v28, s54
    v_perm_b32 v66, v34, v32, s54
    v_perm_b32 v67, v38, v36, s54
    buffer_store_dwordx4 v[64:67], v73, s[16:19], s52 offen offset:0
    v_perm_b32 v68, v26, v24, s55
    v_perm_b32 v69, v30, v28, s55
    v_perm_b32 v70, v34, v32, s55
    v_perm_b32 v71, v38, v36, s55
    buffer_store_dwordx4 v[68:71], v73, s[16:19], s52 offen offset:1040
    v_perm_b32 v64, v27, v25, s54
    v_perm_b32 v65, v31, v29, s54
    v_perm_b32 v66, v35, v33, s54
    v_perm_b32 v67, v39, v37, s54
    buffer_store_dwordx4 v[64:67], v73, s[16:19], s52 offen offset:2080
    v_perm_b32 v68, v27, v25, s55
    v_perm_b32 v69, v31, v29, s55
    v_perm_b32 v70, v35, v33, s55
    v_perm_b32 v71, v39, v37, s55
    buffer_store_dwordx4 v[68:71], v73, s[16:19], s52 offen offset:3120
p1_o2:
    s_barrier
    s_mov_b32 s29, s33
    s_cmp_lt_u32 s29, 1242
    s_cselect_b32 s34, 1, 0
    s_cmp_lt_u32 s29, 1536
    s_cbranch_scc1 p1_tile
p1_end:
    s_endpgm
.globl p2_kernel
.p2align 8
.type p2_kernel,@function
p2_kernel:
    s_cmp_ge_u32 s2, 256
    s_cbranch_scc1 p2_end
    s_load_dwordx2 s[8:9], s[0:1], 104
    v_and_b32 v112, 63, v0
    v_lshrrev_b32 v122, 6, v0
    v_lshlrev_b32 v112, 4, v112
    v_readfirstlane_b32 s10, v122
    v_mov_b32 v113, 0x83ff0000
    s_and_b32 s44, s2, 7
    s_lshr_b32 s11, s44, 1
    s_and_b32 s44, s44, 1
    s_lshl_b32 s12, s44, 5
    s_lshr_b32 s44, s2, 3
    s_add_u32 s12, s12, s44
    s_mov_b32 s25, 54272
    s_mov_b32 s31, 67175170
    s_mov_b32 s32, 83952386
    s_mov_b32 s33, 100729602
    s_mov_b32 s21, 0
    s_mul_i32 s23, s10, 3072
    s_lshl_b32 s24, s10, 9
    s_lshl_b32 s64, s10, 10
    s_sub_u32 s42, s24, s23
    s_add_u32 s42, s42, 49152
    s_movk_i32 s63, 2048
    s_movk_i32 s65, 16384
    s_mul_i32 s62, s11, 161280
    s_add_u32 s62, s62, 485810176
    s_add_u32 s62, s62, s23
    s_mov_b32 s40, 477822976
    s_mul_i32 s44, s11, 1040
    s_add_u32 s40, s40, s44
    s_lshl_b32 s44, s12, 4
    s_add_u32 s40, s40, s44
    s_waitcnt lgkmcnt(0)
    s_mov_b32 s4, s8
    s_and_b32 s5, s9, 0xffff
    s_mov_b32 s6, 819200000
    s_mov_b32 s7, 0x20000
    s_mov_b32 s68, s8
    s_and_b32 s69, s9, 0xffff
    s_mov_b32 s70, 469762048
    s_mov_b32 s71, 0x20000
    s_and_b32 s44, s2, 7
    s_lshl_b32 s44, s44, 2
    s_lshr_b32 s18, 0x00000000, s44
    s_and_b32 s18, s18, 15
p2_restart:
    s_mov_b32 s61, 0
    s_add_u32 s44, s61, s18
    s_cmp_ge_u32 s44, 10
    s_cselect_b32 s53, 10, 0
    s_sub_u32 s44, s44, s53
    s_mul_i32 s44, s44, 4160
    s_add_u32 s44, s44, s40
    v_bfe_i32 v111, v112, 6, 1
    v_lshrrev_b32 v110, 6, v112
    v_bitop3_b32 v111, v111, 15, s10 bitop3:0x6a
    v_lshl_or_b32 v110, v110, 4, v111
    v_bfe_u32 v111, v112, 2, 4
    v_mul_u32_u24 v110, 41600, v110
    v_add_u32 v111, v110, v111
    v_add_u32 v110, 256, v112
    v_and_b32 v110, 0x400, v110
    v_lshl_or_b32 v111, v110, 20, v111
    buffer_load_dword v110, v111, s[4:7], s44 offen
    buffer_load_dword v111, v111, s[4:7], s44 offen offset:16
    s_mov_b32 s61, 1
    s_add_u32 s44, s61, s18
    s_cmp_ge_u32 s44, 10
    s_cselect_b32 s53, 10, 0
    s_sub_u32 s44, s44, s53
    s_mul_i32 s44, s44, 4160
    s_add_u32 s44, s44, s40
    v_bfe_i32 v67, v112, 6, 1
    v_lshrrev_b32 v66, 6, v112
    v_bitop3_b32 v67, v67, 15, s10 bitop3:0x6a
    v_lshl_or_b32 v66, v66, 4, v67
    v_bfe_u32 v67, v112, 2, 4
    v_mul_u32_u24 v66, 41600, v66
    v_add_u32 v67, v66, v67
    v_add_u32 v66, 256, v112
    v_and_b32 v66, 0x400, v66
    v_lshl_or_b32 v67, v66, 20, v67
    buffer_load_dword v66, v67, s[4:7], s44 offen
    buffer_load_dword v67, v67, s[4:7], s44 offen offset:16
    s_mov_b32 s61, 0
    s_cmp_lt_u32 s10, 15
    s_cselect_b32 s44, s64, 0x40000000
    v_add_u32 v58, s44, v112
    s_mov_b32 s44, 492261376
    buffer_load_dwordx4 v[58:61], v58, s[4:7], s44 offen
    s_mul_i32 s20, s18, 645120
    s_add_u32 s20, s20, s62
    s_cmp_ge_u32 s10, 9
    s_cbranch_scc1 p2_nmp
    v_lshrrev_b32 v84, 1, v112
    s_add_u32 s44, s20, s42
    buffer_load_dwordx2 v[84:85], v84, s[4:7], s44 offen
p2_nmp:
    buffer_load_dwordx4 v[72:75], v112, s[4:7], s20 offen offset:0
    buffer_load_dwordx4 v[76:79], v112, s[4:7], s20 offen offset:1024
    buffer_load_dwordx4 v[80:83], v112, s[4:7], s20 offen offset:2048
    s_barrier
    v_mov_b32 v115, 0
    v_mov_b32 v116, 0
    v_mov_b32 v117, 0
    v_mov_b32 v118, 0
    v_mov_b32 v119, 0
    v_mov_b32 v120, 0
    v_mov_b32 v121, 0
    ds_write_b128 v115, v[116:119] offset:53760
    s_mov_b32 s19, 0
    s_cmp_eq_u32 s21, 2
    s_cselect_b64 s[66:67], -1, 0
    s_waitcnt lgkmcnt(0)
    s_barrier
    s_waitcnt vmcnt(6)
    s_mov_b32 m0, s23
    v_mov_b32 v53, 0
    s_movk_i32 s44, 512
    v_sub_u32_sdwa v4, v111, v110 dst_sel:DWORD dst_unused:UNUSED_PAD src0_sel:WORD_0 src1_sel:WORD_0
    v_sub_u32_sdwa v5, v111, v110 dst_sel:DWORD dst_unused:UNUSED_PAD src0_sel:WORD_1 src1_sel:WORD_1
    v_med3_i32 v4, v4, 0, s44
    v_med3_i32 v5, v5, 0, s44
    v_add_u32 v48, v4, v5
    ds_write_addtid_b32 v53 offset:0
    ds_write_addtid_b32 v53 offset:256
    ds_write_addtid_b32 v53 offset:512
    ds_write_addtid_b32 v53 offset:768
    ds_write_addtid_b32 v53 offset:1024
    ds_write_addtid_b32 v53 offset:1280
    ds_write_addtid_b32 v53 offset:1536
    ds_write_addtid_b32 v53 offset:1792
    v_bfe_i32 v53, v112, 6, 1
    v_lshrrev_b32 v49, 6, v112
    v_bitop3_b32 v53, v53, 15, s10 bitop3:0x6a
    v_lshl_or_b32 v49, v49, 4, v53
    v_and_b32 v53, 0x30, v112
    v_lshl_or_b32 v53, v49, 6, v53
    v_lshlrev_b32 v53, 15, v53
    s_nop 1
    v_add_u32_dpp v48, v48, v48 row_shr:1 row_mask:0xf bank_mask:0xf bound_ctrl:0
    s_nop 1
    v_add_u32_dpp v48, v48, v48 row_shr:2 row_mask:0xf bank_mask:0xf bound_ctrl:0
    s_nop 1
    v_add_u32_dpp v48, v48, v48 row_shr:4 row_mask:0xf bank_mask:0xf bound_ctrl:0
    s_nop 1
    v_add_u32_dpp v48, v48, v48 row_shr:8 row_mask:0xf bank_mask:0xf bound_ctrl:0
    s_nop 1
    v_add_u32_dpp v48, v48, v48 row_bcast:15 row_mask:0xa bank_mask:0xf
    s_nop 1
    v_add_u32_dpp v48, v48, v48 row_bcast:31 row_mask:0xc bank_mask:0xf
    s_nop 1
    s_nop 0
    v_readlane_b32 s38, v48, 63
    v_sub_u32 v50, v48, v5
    v_sub_u32 v49, v50, v4
    v_writelane_b32 v5, 1, 63
    v_sub_u32 v10, 512, v49
    v_mad_u32_u16 v51, v110, 16, v53
    v_lshl_add_u32 v51, v10, 4, v51
    v_med3_i32 v10, v10, 0, v4
    v_lshl_add_u32 v49, v49, 2, s23
    v_sub_u32 v11, 512, v50
    v_mad_u32_u16 v52, v110, 16, v53 op_sel:[1,0,0,0]
    v_add_u32 v52, 262144, v52
    s_mov_b32 s44, 0x1fffc000
    v_writelane_b32 v52, s44, 63
    v_lshl_add_u32 v52, v11, 4, v52
    v_med3_i32 v11, v11, 0, v5
    v_lshl_add_u32 v50, v50, 2, s23
    v_lshl_add_u32 v48, v11, 16, v10
    v_add_u32 v110, v110, v48
    s_min_u32 s17, s38, 512
    s_add_u32 s17, s17, 63
    s_lshr_b32 s17, s17, 6
    v_cmpx_lt_i32 vcc, 0, v10
    ds_write_b32 v49, v51
    s_mov_b64 exec, -1
    v_cmpx_lt_i32 vcc, 0, v11
    ds_write_b32 v50, v52
    s_mov_b64 exec, -1
    s_cmp_lt_u32 s38, 512
    s_cbranch_scc1 p2_nomorea
    v_cmp_lt_u32_sdwa s[44:45], v110, v111 src0_sel:WORD_0 src1_sel:WORD_0
    v_cmp_lt_u32_sdwa s[46:47], v110, v111 src0_sel:WORD_1 src1_sel:WORD_1
    s_nop 0
    s_or_b64 s[44:45], s[44:45], s[46:47]
    s_cbranch_scc0 p2_nomorea
    v_mov_b32 v49, s19
    v_mov_b32 v50, 1
    ds_write_b32 v49, v50 offset:53760
p2_nomorea:
    s_mov_b32 m0, s23
    s_nop 0
    ds_read_addtid_b32 v2 offset:1024
    ds_read_addtid_b32 v8 offset:1280
    ds_read_addtid_b32 v14 offset:1536
    ds_read_addtid_b32 v20 offset:1792
    ds_read_addtid_b32 v88 offset:0
    ds_read_addtid_b32 v92 offset:256
    ds_read_addtid_b32 v96 offset:512
    ds_read_addtid_b32 v100 offset:768
    s_waitcnt lgkmcnt(0)
    s_nop 2
    s_nop 1
    v_max_u32_dpp v88, v88, v88 row_shr:1 row_mask:0xf bank_mask:0xf bound_ctrl:0
    v_max_u32_dpp v92, v92, v92 row_shr:1 row_mask:0xf bank_mask:0xf bound_ctrl:0
    v_max_u32_dpp v96, v96, v96 row_shr:1 row_mask:0xf bank_mask:0xf bound_ctrl:0
    v_max_u32_dpp v100, v100, v100 row_shr:1 row_mask:0xf bank_mask:0xf bound_ctrl:0
    v_max_u32_dpp v2, v2, v2 row_shr:1 row_mask:0xf bank_mask:0xf bound_ctrl:0
    v_max_u32_dpp v8, v8, v8 row_shr:1 row_mask:0xf bank_mask:0xf bound_ctrl:0
    v_max_u32_dpp v14, v14, v14 row_shr:1 row_mask:0xf bank_mask:0xf bound_ctrl:0
    v_max_u32_dpp v20, v20, v20 row_shr:1 row_mask:0xf bank_mask:0xf bound_ctrl:0
    v_max_u32_dpp v88, v88, v88 row_shr:2 row_mask:0xf bank_mask:0xf bound_ctrl:0
    v_max_u32_dpp v92, v92, v92 row_shr:2 row_mask:0xf bank_mask:0xf bound_ctrl:0
    v_max_u32_dpp v96, v96, v96 row_shr:2 row_mask:0xf bank_mask:0xf bound_ctrl:0
    v_max_u32_dpp v100, v100, v100 row_shr:2 row_mask:0xf bank_mask:0xf bound_ctrl:0
    v_max_u32_dpp v2, v2, v2 row_shr:2 row_mask:0xf bank_mask:0xf bound_ctrl:0
    v_max_u32_dpp v8, v8, v8 row_shr:2 row_mask:0xf bank_mask:0xf bound_ctrl:0
    v_max_u32_dpp v14, v14, v14 row_shr:2 row_mask:0xf bank_mask:0xf bound_ctrl:0
    v_max_u32_dpp v20, v20, v20 row_shr:2 row_mask:0xf bank_mask:0xf bound_ctrl:0
    v_max_u32_dpp v88, v88, v88 row_shr:4 row_mask:0xf bank_mask:0xf bound_ctrl:0
    v_max_u32_dpp v92, v92, v92 row_shr:4 row_mask:0xf bank_mask:0xf bound_ctrl:0
    v_max_u32_dpp v96, v96, v96 row_shr:4 row_mask:0xf bank_mask:0xf bound_ctrl:0
    v_max_u32_dpp v100, v100, v100 row_shr:4 row_mask:0xf bank_mask:0xf bound_ctrl:0
    v_max_u32_dpp v2, v2, v2 row_shr:4 row_mask:0xf bank_mask:0xf bound_ctrl:0
    v_max_u32_dpp v8, v8, v8 row_shr:4 row_mask:0xf bank_mask:0xf bound_ctrl:0
    v_max_u32_dpp v14, v14, v14 row_shr:4 row_mask:0xf bank_mask:0xf bound_ctrl:0
    v_max_u32_dpp v20, v20, v20 row_shr:4 row_mask:0xf bank_mask:0xf bound_ctrl:0
    v_max_u32_dpp v88, v88, v88 row_shr:8 row_mask:0xf bank_mask:0xf bound_ctrl:0
    v_max_u32_dpp v92, v92, v92 row_shr:8 row_mask:0xf bank_mask:0xf bound_ctrl:0
    v_max_u32_dpp v96, v96, v96 row_shr:8 row_mask:0xf bank_mask:0xf bound_ctrl:0
    v_max_u32_dpp v100, v100, v100 row_shr:8 row_mask:0xf bank_mask:0xf bound_ctrl:0
    v_max_u32_dpp v2, v2, v2 row_shr:8 row_mask:0xf bank_mask:0xf bound_ctrl:0
    v_max_u32_dpp v8, v8, v8 row_shr:8 row_mask:0xf bank_mask:0xf bound_ctrl:0
    v_max_u32_dpp v14, v14, v14 row_shr:8 row_mask:0xf bank_mask:0xf bound_ctrl:0
    v_max_u32_dpp v20, v20, v20 row_shr:8 row_mask:0xf bank_mask:0xf bound_ctrl:0
    v_max_u32_dpp v88, v88, v88 row_bcast:15 row_mask:0xa bank_mask:0xf
    v_max_u32_dpp v92, v92, v92 row_bcast:15 row_mask:0xa bank_mask:0xf
    v_max_u32_dpp v96, v96, v96 row_bcast:15 row_mask:0xa bank_mask:0xf
    v_max_u32_dpp v100, v100, v100 row_bcast:15 row_mask:0xa bank_mask:0xf
    v_max_u32_dpp v2, v2, v2 row_bcast:15 row_mask:0xa bank_mask:0xf
    v_max_u32_dpp v8, v8, v8 row_bcast:15 row_mask:0xa bank_mask:0xf
    v_max_u32_dpp v14, v14, v14 row_bcast:15 row_mask:0xa bank_mask:0xf
    v_max_u32_dpp v20, v20, v20 row_bcast:15 row_mask:0xa bank_mask:0xf
    v_max_u32_dpp v88, v88, v88 row_bcast:31 row_mask:0xc bank_mask:0xf
    v_max_u32_dpp v92, v92, v92 row_bcast:31 row_mask:0xc bank_mask:0xf
    v_max_u32_dpp v96, v96, v96 row_bcast:31 row_mask:0xc bank_mask:0xf
    v_max_u32_dpp v100, v100, v100 row_bcast:31 row_mask:0xc bank_mask:0xf
    v_max_u32_dpp v2, v2, v2 row_bcast:31 row_mask:0xc bank_mask:0xf
    v_max_u32_dpp v8, v8, v8 row_bcast:31 row_mask:0xc bank_mask:0xf
    v_max_u32_dpp v14, v14, v14 row_bcast:31 row_mask:0xc bank_mask:0xf
    v_max_u32_dpp v20, v20, v20 row_bcast:31 row_mask:0xc bank_mask:0xf
    s_nop 0
    v_readlane_b32 s41, v88, 63
    v_add_u32 v88, v88, v112
    v_add_u32 v88, 4294959104, v88
    v_max_u32 v92, s41, v92
    s_nop 0
    v_readlane_b32 s41, v92, 63
    v_add_u32 v92, v92, v112
    v_add_u32 v92, 4294960128, v92
    v_max_u32 v96, s41, v96
    s_nop 0
    v_readlane_b32 s41, v96, 63
    v_add_u32 v96, v96, v112
    v_add_u32 v96, 4294961152, v96
    v_max_u32 v100, s41, v100
    s_nop 0
    v_readlane_b32 s41, v100, 63
    v_add_u32 v100, v100, v112
    v_add_u32 v100, 4294962176, v100
    v_max_u32 v2, s41, v2
    s_nop 0
    v_readlane_b32 s41, v2, 63
    v_add_u32 v2, v2, v112
    v_add_u32 v2, 4294963200, v2
    v_max_u32 v8, s41, v8
    s_nop 0
    v_readlane_b32 s41, v8, 63
    v_add_u32 v8, v8, v112
    v_add_u32 v8, 4294964224, v8
    v_max_u32 v14, s41, v14
    s_nop 0
    v_readlane_b32 s41, v14, 63
    v_add_u32 v14, v14, v112
    v_add_u32 v14, 4294965248, v14
    v_max_u32 v20, s41, v20
    s_nop 0
    v_readlane_b32 s41, v20, 63
    v_add_u32 v20, v20, v112
    v_add_u32 v20, 4294966272, v20
    v_bfe_u32 v0, v2, 14, 4
    v_lshrrev_b32 v1, 18, v2
    v_and_b32 v2, 0x3fff, v2
    v_mad_u32_u24 v0, v0, s63, v1
    v_mad_u32_u24 v2, v0, s65, v2
    buffer_load_dwordx4 v[0:3], v2, s[68:71], 0 offen
    v_bfe_u32 v6, v8, 14, 4
    v_lshrrev_b32 v7, 18, v8
    v_and_b32 v8, 0x3fff, v8
    v_mad_u32_u24 v6, v6, s63, v7
    v_mad_u32_u24 v8, v6, s65, v8
    buffer_load_dwordx4 v[6:9], v8, s[68:71], 0 offen
    s_cmp_eq_u32 s21, 0
    s_cselect_b32 s44, 1073758208, 0
    v_mov_b32 v124, s44
    v_mov_b32 v125, s44
    v_mov_b32 v126, s44
    v_mov_b32 v127, s44
    v_add_u32 v123, s64, v112
    v_add_u32 v122, s25, v123
    ds_write_b128 v122, v[124:127] offset:0
    ds_write_b128 v122, v[124:127] offset:16384
    ds_write_b128 v122, v[124:127] offset:32768
    v_add_u32 v122, 49152, v122
    ds_write_b128 v122, v[124:127] offset:0
    ds_write_b128 v122, v[124:127] offset:16384
    ds_write_b128 v122, v[124:127] offset:32768
    v_cmpx_gt_u32 vcc, 1792, v123
    ds_write_b128 v122, v[124:127] offset:49152
    s_mov_b64 exec, -1
    v_bfe_u32 v12, v14, 14, 4
    v_lshrrev_b32 v13, 18, v14
    v_and_b32 v14, 0x3fff, v14
    v_mad_u32_u24 v12, v12, s63, v13
    v_mad_u32_u24 v14, v12, s65, v14
    buffer_load_dwordx4 v[12:15], v14, s[68:71], 0 offen
    s_mov_b32 s16, s17
    s_waitcnt vmcnt(6)
    s_cmp_lg_u32 s21, 0
    s_cbranch_scc1 p2_nostat1
    v_max_u32 v58, v58, v60
    v_add_f32 v59, v59, v61
    s_nop 1
    v_max_u32_dpp v58, v58, v58 row_shr:1 row_mask:0xf bank_mask:0xf bound_ctrl:0
    v_add_f32_dpp v59, v59, v59 row_shr:1 row_mask:0xf bank_mask:0xf bound_ctrl:0
    s_nop 0
    v_max_u32_dpp v58, v58, v58 row_shr:2 row_mask:0xf bank_mask:0xf bound_ctrl:0
    v_add_f32_dpp v59, v59, v59 row_shr:2 row_mask:0xf bank_mask:0xf bound_ctrl:0
    s_nop 0
    v_max_u32_dpp v58, v58, v58 row_shr:4 row_mask:0xf bank_mask:0xf bound_ctrl:0
    v_add_f32_dpp v59, v59, v59 row_shr:4 row_mask:0xf bank_mask:0xf bound_ctrl:0
    s_nop 0
    v_max_u32_dpp v58, v58, v58 row_shr:8 row_mask:0xf bank_mask:0xf bound_ctrl:0
    v_add_f32_dpp v59, v59, v59 row_shr:8 row_mask:0xf bank_mask:0xf bound_ctrl:0
    s_nop 0
    v_max_u32_dpp v58, v58, v58 row_bcast:15 row_mask:0xa bank_mask:0xf
    v_add_f32_dpp v59, v59, v59 row_bcast:15 row_mask:0xa bank_mask:0xf
    s_nop 0
    v_max_u32_dpp v58, v58, v58 row_bcast:31 row_mask:0xc bank_mask:0xf
    v_add_f32_dpp v59, v59, v59 row_bcast:31 row_mask:0xc bank_mask:0xf
    s_nop 0
    s_nop 0
    s_lshl_b32 s44, s10, 3
    v_mov_b32 v60, s44
    s_mov_b64 exec, 1
    s_lshl_b64 exec, exec, 63
    ds_write_b64 v60, v[58:59] offset:53824
    s_mov_b64 exec, -1
p2_nostat1:
    s_waitcnt lgkmcnt(0)
    s_barrier
    v_bfe_u32 v18, v20, 14, 4
    v_lshrrev_b32 v19, 18, v20
    v_and_b32 v20, 0x3fff, v20
    v_mad_u32_u24 v18, v18, s63, v19
    v_mad_u32_u24 v20, v18, s65, v20
    buffer_load_dwordx4 v[18:21], v20, s[68:71], 0 offen
    v_mov_b32 v122, s19
    s_xor_b32 s19, s19, 4
    ds_read_b32 v125, v122 offset:53760
    s_cmp_lg_u32 s21, 0
    s_cbranch_scc1 p2_nostat2
    v_bfe_u32 v60, v112, 1, 7
    ds_read_b64 v[58:59], v60 offset:53824
    s_waitcnt lgkmcnt(0)
    s_nop 1
    v_max_u32_dpp v58, v58, v58 row_shr:1 row_mask:0xf bank_mask:0xf bound_ctrl:0
    v_add_f32_dpp v59, v59, v59 row_shr:1 row_mask:0xf bank_mask:0xf bound_ctrl:0
    s_nop 0
    v_max_u32_dpp v58, v58, v58 row_shr:2 row_mask:0xf bank_mask:0xf bound_ctrl:0
    v_add_f32_dpp v59, v59, v59 row_shr:2 row_mask:0xf bank_mask:0xf bound_ctrl:0
    s_nop 0
    v_max_u32_dpp v58, v58, v58 row_shr:4 row_mask:0xf bank_mask:0xf bound_ctrl:0
    v_add_f32_dpp v59, v59, v59 row_shr:4 row_mask:0xf bank_mask:0xf bound_ctrl:0
    s_nop 0
    v_max_u32_dpp v58, v58, v58 row_shr:8 row_mask:0xf bank_mask:0xf bound_ctrl:0
    v_add_f32_dpp v59, v59, v59 row_shr:8 row_mask:0xf bank_mask:0xf bound_ctrl:0
    s_nop 0
    v_max_u32_dpp v58, v58, v58 row_bcast:15 row_mask:0xa bank_mask:0xf
    v_add_f32_dpp v59, v59, v59 row_bcast:15 row_mask:0xa bank_mask:0xf
    s_nop 0
    v_max_u32_dpp v58, v58, v58 row_bcast:31 row_mask:0xc bank_mask:0xf
    v_add_f32_dpp v59, v59, v59 row_bcast:31 row_mask:0xc bank_mask:0xf
    s_nop 0
    s_nop 0
    v_readlane_b32 s44, v58, 15
    v_readlane_b32 s45, v59, 15
    s_nop 1
    s_lshl_b32 s44, s44, 16
    s_lshr_b32 s46, s44, 23
    s_sub_u32 s47, s46, 80
    s_cmp_lt_u32 s47, 100
    s_cselect_b32 s21, 0, 1
    v_mov_b32 v58, s45
    v_mul_f32 v58, 0x34a7c5ac, v58
    v_sqrt_f32 v58, v58
    v_mov_b32 v59, s44
    v_mul_f32 v60, 0x41800000, v58
    v_cmp_nle_f32 vcc, v59, v60
    v_mul_f32 v58, 0x3ac00000, v58
    v_mul_f32 v59, 0x3901742e, v59
    v_max_f32 v58, v58, v59
    s_cmp_lg_u64 vcc, 0
    s_cselect_b32 s21, 1, s21
    v_readfirstlane_b32 s44, v58
    s_nop 0
    s_and_b32 s47, s44, 0x7fffff
    s_or_b32 s47, s47, 0x3f000000
    s_and_b32 s48, s44, 0x7f800000
    s_add_u32 s48, s48, 0x800000
    v_rcp_f32 v58, s47
    s_nop 0
    v_rcp_f32 v59, v58
    v_mul_f32 v58, 0x7b800000, v58
    v_mul_f32 v59, s48, v59
    s_nop 0
    v_readfirstlane_b32 s26, v58
    v_readfirstlane_b32 s30, v59
    s_add_u32 s34, s48, 197132288
    s_mov_b32 s35, s34
    s_sub_u32 s36, 0, s34
    s_subb_u32 s37, 0, s34
    s_cmp_eq_u32 s21, 0
    s_cbranch_scc1 p2_nostat2
    s_waitcnt vmcnt(0) lgkmcnt(0)
    s_branch p2_restart
p2_nostat2:
    s_cmp_eq_u32 s21, 0
    s_cselect_b32 s26, s26, 0x7b800000
    v_mov_b32 v114, s26
    s_waitcnt lgkmcnt(0)
    v_readfirstlane_b32 s44, v125
    s_nop 0
    s_cmp_lg_u32 s44, 0
    s_cbranch_scc1 p2_adva
    s_mov_b32 s61, 1
    v_mov_b32 v110, v66
    v_mov_b32 v111, v67
p2_adva:
    v_bfe_u32 v86, v88, 14, 4
    v_lshrrev_b32 v87, 18, v88
    v_and_b32 v88, 0x3fff, v88
    v_mad_u32_u24 v86, v86, s63, v87
    v_mad_u32_u24 v88, v86, s65, v88
    buffer_load_dwordx4 v[86:89], v88, s[68:71], 0 offen
    s_mov_b32 m0, s23
    v_mov_b32 v53, 0
    s_movk_i32 s44, 512
    v_sub_u32_sdwa v4, v111, v110 dst_sel:DWORD dst_unused:UNUSED_PAD src0_sel:WORD_0 src1_sel:WORD_0
    v_sub_u32_sdwa v5, v111, v110 dst_sel:DWORD dst_unused:UNUSED_PAD src0_sel:WORD_1 src1_sel:WORD_1
    v_med3_i32 v4, v4, 0, s44
    v_med3_i32 v5, v5, 0, s44
    v_add_u32 v48, v4, v5
    ds_write_addtid_b32 v53 offset:0
    ds_write_addtid_b32 v53 offset:256
    ds_write_addtid_b32 v53 offset:512
    ds_write_addtid_b32 v53 offset:768
    ds_write_addtid_b32 v53 offset:1024
    ds_write_addtid_b32 v53 offset:1280
    ds_write_addtid_b32 v53 offset:1536
    ds_write_addtid_b32 v53 offset:1792
    v_bfe_i32 v53, v112, 6, 1
    v_lshrrev_b32 v49, 6, v112
    v_bitop3_b32 v53, v53, 15, s10 bitop3:0x6a
    v_lshl_or_b32 v49, v49, 4, v53
    v_and_b32 v53, 0x30, v112
    v_lshl_or_b32 v53, v49, 6, v53
    v_lshlrev_b32 v53, 15, v53
    s_nop 1
    v_add_u32_dpp v48, v48, v48 row_shr:1 row_mask:0xf bank_mask:0xf bound_ctrl:0
    s_nop 1
    v_add_u32_dpp v48, v48, v48 row_shr:2 row_mask:0xf bank_mask:0xf bound_ctrl:0
    s_nop 1
    v_add_u32_dpp v48, v48, v48 row_shr:4 row_mask:0xf bank_mask:0xf bound_ctrl:0
    s_nop 1
    v_add_u32_dpp v48, v48, v48 row_shr:8 row_mask:0xf bank_mask:0xf bound_ctrl:0
    s_nop 1
    v_add_u32_dpp v48, v48, v48 row_bcast:15 row_mask:0xa bank_mask:0xf
    s_nop 1
    v_add_u32_dpp v48, v48, v48 row_bcast:31 row_mask:0xc bank_mask:0xf
    s_nop 1
    s_nop 0
    v_readlane_b32 s38, v48, 63
    v_sub_u32 v50, v48, v5
    v_sub_u32 v49, v50, v4
    v_writelane_b32 v5, 1, 63
    v_sub_u32 v10, 512, v49
    v_mad_u32_u16 v51, v110, 16, v53
    v_lshl_add_u32 v51, v10, 4, v51
    v_med3_i32 v10, v10, 0, v4
    v_lshl_add_u32 v49, v49, 2, s23
    v_sub_u32 v11, 512, v50
    v_mad_u32_u16 v52, v110, 16, v53 op_sel:[1,0,0,0]
    v_add_u32 v52, 262144, v52
    s_mov_b32 s44, 0x1fffc000
    v_writelane_b32 v52, s44, 63
    v_lshl_add_u32 v52, v11, 4, v52
    v_med3_i32 v11, v11, 0, v5
    v_lshl_add_u32 v50, v50, 2, s23
    v_lshl_add_u32 v48, v11, 16, v10
    v_add_u32 v110, v110, v48
    s_min_u32 s17, s38, 512
    s_add_u32 s17, s17, 63
    s_lshr_b32 s17, s17, 6
    v_cmpx_lt_i32 vcc, 0, v10
    ds_write_b32 v49, v51
    s_mov_b64 exec, -1
    v_cmpx_lt_i32 vcc, 0, v11
    ds_write_b32 v50, v52
    s_mov_b64 exec, -1
    s_cmp_lt_u32 s38, 512
    s_cbranch_scc1 p2_nomoreb
    v_cmp_lt_u32_sdwa s[44:45], v110, v111 src0_sel:WORD_0 src1_sel:WORD_0
    v_cmp_lt_u32_sdwa s[46:47], v110, v111 src0_sel:WORD_1 src1_sel:WORD_1
    s_nop 0
    s_or_b64 s[44:45], s[44:45], s[46:47]
    s_cbranch_scc0 p2_nomoreb
    v_mov_b32 v49, s19
    v_mov_b32 v50, 1
    ds_write_b32 v49, v50 offset:53760
p2_nomoreb:
    s_mov_b32 m0, s23
    s_nop 0
    ds_read_addtid_b32 v102 offset:1024
    ds_read_addtid_b32 v103 offset:1280
    ds_read_addtid_b32 v104 offset:1536
    ds_read_addtid_b32 v105 offset:1792
    ds_read_addtid_b32 v106 offset:0
    ds_read_addtid_b32 v107 offset:256
    ds_read_addtid_b32 v108 offset:512
    ds_read_addtid_b32 v109 offset:768
    v_bfe_u32 v90, v92, 14, 4
    v_lshrrev_b32 v91, 18, v92
    v_and_b32 v92, 0x3fff, v92
    v_mad_u32_u24 v90, v90, s63, v91
    v_mad_u32_u24 v92, v90, s65, v92
    buffer_load_dwordx4 v[90:93], v92, s[68:71], 0 offen
    s_waitcnt vmcnt(6)
    s_mov_b32 m0, s24
    s_cmp_ge_u32 s10, 9
    s_cbranch_scc1 p2_stp
    ds_write_addtid_b32 v84 offset:49152
    ds_write_addtid_b32 v85 offset:49408
p2_stp:
    s_mov_b32 m0, s23
    s_add_u32 s20, s20, 53760
    ds_write_addtid_b32 v72 offset:0
    ds_write_addtid_b32 v73 offset:256
    ds_write_addtid_b32 v74 offset:512
    ds_write_addtid_b32 v75 offset:768
    ds_write_addtid_b32 v76 offset:1024
    ds_write_addtid_b32 v77 offset:1280
    ds_write_addtid_b32 v78 offset:1536
    ds_write_addtid_b32 v79 offset:1792
    ds_write_addtid_b32 v80 offset:2048
    ds_write_addtid_b32 v81 offset:2304
    ds_write_addtid_b32 v82 offset:2560
    ds_write_addtid_b32 v83 offset:2816
    s_waitcnt lgkmcnt(0)
    s_barrier
    v_bfe_u32 v94, v96, 14, 4
    v_lshrrev_b32 v95, 18, v96
    v_and_b32 v96, 0x3fff, v96
    v_mad_u32_u24 v94, v94, s63, v95
    v_mad_u32_u24 v96, v94, s65, v96
    buffer_load_dwordx4 v[94:97], v96, s[68:71], 0 offen
    v_bfe_u32 v98, v100, 14, 4
    v_lshrrev_b32 v99, 18, v100
    v_and_b32 v100, 0x3fff, v100
    v_mad_u32_u24 v98, v98, s63, v99
    v_mad_u32_u24 v100, v98, s65, v100
    buffer_load_dwordx4 v[98:101], v100, s[68:71], 0 offen
    s_nop 2
    s_nop 1
    v_max_u32_dpp v106, v106, v106 row_shr:1 row_mask:0xf bank_mask:0xf bound_ctrl:0
    v_max_u32_dpp v107, v107, v107 row_shr:1 row_mask:0xf bank_mask:0xf bound_ctrl:0
    v_max_u32_dpp v108, v108, v108 row_shr:1 row_mask:0xf bank_mask:0xf bound_ctrl:0
    v_max_u32_dpp v109, v109, v109 row_shr:1 row_mask:0xf bank_mask:0xf bound_ctrl:0
    v_max_u32_dpp v106, v106, v106 row_shr:2 row_mask:0xf bank_mask:0xf bound_ctrl:0
    v_max_u32_dpp v107, v107, v107 row_shr:2 row_mask:0xf bank_mask:0xf bound_ctrl:0
    v_max_u32_dpp v108, v108, v108 row_shr:2 row_mask:0xf bank_mask:0xf bound_ctrl:0
    v_max_u32_dpp v109, v109, v109 row_shr:2 row_mask:0xf bank_mask:0xf bound_ctrl:0
    v_max_u32_dpp v106, v106, v106 row_shr:4 row_mask:0xf bank_mask:0xf bound_ctrl:0
    v_max_u32_dpp v107, v107, v107 row_shr:4 row_mask:0xf bank_mask:0xf bound_ctrl:0
    v_max_u32_dpp v108, v108, v108 row_shr:4 row_mask:0xf bank_mask:0xf bound_ctrl:0
    v_max_u32_dpp v109, v109, v109 row_shr:4 row_mask:0xf bank_mask:0xf bound_ctrl:0
    v_max_u32_dpp v106, v106, v106 row_shr:8 row_mask:0xf bank_mask:0xf bound_ctrl:0
    v_max_u32_dpp v107, v107, v107 row_shr:8 row_mask:0xf bank_mask:0xf bound_ctrl:0
    v_max_u32_dpp v108, v108, v108 row_shr:8 row_mask:0xf bank_mask:0xf bound_ctrl:0
    v_max_u32_dpp v109, v109, v109 row_shr:8 row_mask:0xf bank_mask:0xf bound_ctrl:0
    v_max_u32_dpp v106, v106, v106 row_bcast:15 row_mask:0xa bank_mask:0xf
    v_max_u32_dpp v107, v107, v107 row_bcast:15 row_mask:0xa bank_mask:0xf
    v_max_u32_dpp v108, v108, v108 row_bcast:15 row_mask:0xa bank_mask:0xf
    v_max_u32_dpp v109, v109, v109 row_bcast:15 row_mask:0xa bank_mask:0xf
    v_max_u32_dpp v106, v106, v106 row_bcast:31 row_mask:0xc bank_mask:0xf
    v_max_u32_dpp v107, v107, v107 row_bcast:31 row_mask:0xc bank_mask:0xf
    v_max_u32_dpp v108, v108, v108 row_bcast:31 row_mask:0xc bank_mask:0xf
    v_max_u32_dpp v109, v109, v109 row_bcast:31 row_mask:0xc bank_mask:0xf
    s_nop 0
    v_readlane_b32 s41, v106, 63
    v_add_u32 v106, v106, v112
    v_add_u32 v106, 4294959104, v106
    v_max_u32 v107, s41, v107
    s_nop 0
    v_readlane_b32 s41, v107, 63
    v_add_u32 v107, v107, v112
    v_add_u32 v107, 4294960128, v107
    v_max_u32 v108, s41, v108
    s_nop 0
    v_readlane_b32 s41, v108, 63
    v_add_u32 v108, v108, v112
    v_add_u32 v108, 4294961152, v108
    v_max_u32 v109, s41, v109
    s_nop 0
    v_readlane_b32 s41, v109, 63
    v_add_u32 v109, v109, v112
    v_add_u32 v109, 4294962176, v109
    s_waitcnt vmcnt(7)
    v_perm_b32 v48, v3, v0, s31
    v_perm_b32 v49, v3, v1, s32
    v_perm_b32 v50, v3, v2, s33
    v_lshlrev_b16 v4, 3, v2
    v_lshlrev_b16 v2, 3, v1
    v_lshlrev_b16 v0, 3, v0
    v_cmpx_ge_u16 vcc, 0x3fff, v48
    ds_read_b64 v[0:1], v0
    s_mov_b64 exec, -1
    v_cmpx_ge_u16 vcc, 0x3fff, v49
    ds_read_b64 v[2:3], v2
    s_mov_b64 exec, -1
    v_cmpx_ge_u16 vcc, 0x3fff, v50
    ds_read_b64 v[4:5], v4
    s_mov_b64 exec, -1
    s_waitcnt vmcnt(6)
    v_perm_b32 v51, v9, v6, s31
    v_perm_b32 v52, v9, v7, s32
    v_perm_b32 v53, v9, v8, s33
    v_lshlrev_b16 v10, 3, v8
    v_lshlrev_b16 v8, 3, v7
    v_lshlrev_b16 v6, 3, v6
    v_cmpx_ge_u16 vcc, 0x3fff, v51
    ds_read_b64 v[6:7], v6
    s_mov_b64 exec, -1
    v_cmpx_ge_u16 vcc, 0x3fff, v52
    ds_read_b64 v[8:9], v8
    s_mov_b64 exec, -1
    v_cmpx_ge_u16 vcc, 0x3fff, v53
    ds_read_b64 v[10:11], v10
    s_mov_b64 exec, -1
    s_waitcnt vmcnt(5)
    v_perm_b32 v54, v15, v12, s31
    v_perm_b32 v55, v15, v13, s32
    v_perm_b32 v56, v15, v14, s33
    v_lshlrev_b16 v16, 3, v14
    v_lshlrev_b16 v14, 3, v13
    v_lshlrev_b16 v12, 3, v12
    v_cmpx_ge_u16 vcc, 0x3fff, v54
    ds_read_b64 v[12:13], v12
    s_mov_b64 exec, -1
    v_cmpx_ge_u16 vcc, 0x3fff, v55
    ds_read_b64 v[14:15], v14
    s_mov_b64 exec, -1
    v_cmpx_ge_u16 vcc, 0x3fff, v56
    ds_read_b64 v[16:17], v16
    s_mov_b64 exec, -1
    s_waitcnt vmcnt(4)
    v_perm_b32 v57, v21, v18, s31
    v_perm_b32 v58, v21, v19, s32
    v_perm_b32 v59, v21, v20, s33
    v_lshlrev_b16 v22, 3, v20
    v_lshlrev_b16 v20, 3, v19
    v_lshlrev_b16 v18, 3, v18
    s_cmp_lt_u32 s16, 8
    s_cbranch_scc1 p2_gp
    v_cmpx_ge_u16 vcc, 0x3fff, v57
    ds_read_b64 v[18:19], v18
    s_mov_b64 exec, -1
    v_cmpx_ge_u16 vcc, 0x3fff, v58
    ds_read_b64 v[20:21], v20
    s_mov_b64 exec, -1
    v_cmpx_ge_u16 vcc, 0x3fff, v59
    ds_read_b64 v[22:23], v22
    s_mov_b64 exec, -1
p2_gp:
    s_waitcnt vmcnt(3)
    v_perm_b32 v60, v89, v86, s31
    v_perm_b32 v61, v89, v87, s32
    v_perm_b32 v62, v89, v88, s33
    v_lshlrev_b16 v28, 3, v88
    v_lshlrev_b16 v26, 3, v87
    v_lshlrev_b16 v24, 3, v86
    v_cmpx_ge_u16 vcc, 0x3fff, v60
    ds_read_b64 v[24:25], v24
    s_mov_b64 exec, -1
    v_cmpx_ge_u16 vcc, 0x3fff, v61
    ds_read_b64 v[26:27], v26
    s_mov_b64 exec, -1
    v_cmpx_ge_u16 vcc, 0x3fff, v62
    ds_read_b64 v[28:29], v28
    s_mov_b64 exec, -1
    v_bfe_u32 v86, v106, 14, 4
    v_lshrrev_b32 v87, 18, v106
    v_and_b32 v106, 0x3fff, v106
    v_mad_u32_u24 v86, v86, s63, v87
    v_mad_u32_u24 v106, v86, s65, v106
    buffer_load_dwordx4 v[86:89], v106, s[68:71], 0 offen
    s_cmp_ge_u32 s10, 9
    s_cbranch_scc1 p2_nmq
    v_lshrrev_b32 v84, 1, v112
    s_add_u32 s44, s20, s42
    buffer_load_dwordx2 v[84:85], v84, s[4:7], s44 offen
p2_nmq:
    buffer_load_dwordx4 v[72:75], v112, s[4:7], s20 offen offset:0
    buffer_load_dwordx4 v[76:79], v112, s[4:7], s20 offen offset:1024
    buffer_load_dwordx4 v[80:83], v112, s[4:7], s20 offen offset:2048
    s_waitcnt vmcnt(6)
    v_perm_b32 v63, v93, v90, s31
    v_perm_b32 v64, v93, v91, s32
    v_perm_b32 v65, v93, v92, s33
    v_lshlrev_b16 v34, 3, v92
    v_lshlrev_b16 v32, 3, v91
    v_lshlrev_b16 v30, 3, v90
    v_cmpx_ge_u16 vcc, 0x3fff, v63
    ds_read_b64 v[30:31], v30
    s_mov_b64 exec, -1
    v_cmpx_ge_u16 vcc, 0x3fff, v64
    ds_read_b64 v[32:33], v32
    s_mov_b64 exec, -1
    v_cmpx_ge_u16 vcc, 0x3fff, v65
    ds_read_b64 v[34:35], v34
    s_mov_b64 exec, -1
    v_bfe_u32 v90, v107, 14, 4
    v_lshrrev_b32 v91, 18, v107
    v_and_b32 v107, 0x3fff, v107
    v_mad_u32_u24 v90, v90, s63, v91
    v_mad_u32_u24 v107, v90, s65, v107
    buffer_load_dwordx4 v[90:93], v107, s[68:71], 0 offen
    s_waitcnt vmcnt(6)
    v_perm_b32 v66, v97, v94, s31
    v_perm_b32 v67, v97, v95, s32
    v_perm_b32 v68, v97, v96, s33
    v_lshlrev_b16 v40, 3, v96
    v_lshlrev_b16 v38, 3, v95
    v_lshlrev_b16 v36, 3, v94
    v_cmpx_ge_u16 vcc, 0x3fff, v66
    ds_read_b64 v[36:37], v36
    s_mov_b64 exec, -1
    v_cmpx_ge_u16 vcc, 0x3fff, v67
    ds_read_b64 v[38:39], v38
    s_mov_b64 exec, -1
    v_cmpx_ge_u16 vcc, 0x3fff, v68
    ds_read_b64 v[40:41], v40
    s_mov_b64 exec, -1
    v_bfe_u32 v94, v108, 14, 4
    v_lshrrev_b32 v95, 18, v108
    v_and_b32 v108, 0x3fff, v108
    v_mad_u32_u24 v94, v94, s63, v95
    v_mad_u32_u24 v108, v94, s65, v108
    buffer_load_dwordx4 v[94:97], v108, s[68:71], 0 offen
    s_waitcnt vmcnt(6)
    v_perm_b32 v69, v101, v98, s31
    v_perm_b32 v70, v101, v99, s32
    v_perm_b32 v71, v101, v100, s33
    v_lshlrev_b16 v46, 3, v100
    v_lshlrev_b16 v44, 3, v99
    v_lshlrev_b16 v42, 3, v98
    v_cmpx_ge_u16 vcc, 0x3fff, v69
    ds_read_b64 v[42:43], v42
    s_mov_b64 exec, -1
    v_cmpx_ge_u16 vcc, 0x3fff, v70
    ds_read_b64 v[44:45], v44
    s_mov_b64 exec, -1
    v_cmpx_ge_u16 vcc, 0x3fff, v71
    ds_read_b64 v[46:47], v46
    s_mov_b64 exec, -1
    s_waitcnt lgkmcnt(0)
    s_barrier
    s_branch p2_tail
p2_top:
    s_cmp_lg_u32 s21, 0
    s_cbranch_scc1 p2_topf
    s_cmp_eq_u32 s60, 10
    s_cbranch_scc1 p2_drain0
    s_setprio 3
    v_cmpx_gt_i16 vcc, 0, v48
    ds_read_b64 v[0:1], v0
    s_mov_b64 exec, -1
    v_cmpx_gt_i16 vcc, 0, v49
    ds_read_b64 v[2:3], v2
    s_mov_b64 exec, -1
    v_cmpx_gt_i16 vcc, 0, v50
    ds_read_b64 v[4:5], v4
    s_mov_b64 exec, -1
    v_cmpx_gt_i16 vcc, 0, v51
    ds_read_b64 v[6:7], v6
    s_mov_b64 exec, -1
    v_cmpx_gt_i16 vcc, 0, v52
    ds_read_b64 v[8:9], v8
    s_mov_b64 exec, -1
    v_cmpx_gt_i16 vcc, 0, v53
    ds_read_b64 v[10:11], v10
    s_mov_b64 exec, -1
    v_cmpx_gt_i16 vcc, 0, v54
    ds_read_b64 v[12:13], v12
    s_mov_b64 exec, -1
    v_cmpx_gt_i16 vcc, 0, v55
    ds_read_b64 v[14:15], v14
    s_mov_b64 exec, -1
    v_cmpx_gt_i16 vcc, 0, v56
    ds_read_b64 v[16:17], v16
    s_mov_b64 exec, -1
    s_cmp_lt_u32 s15, 8
    s_cbranch_scc1 p2_g0r23
    v_cmpx_gt_i16 vcc, 0, v57
    ds_read_b64 v[18:19], v18
    s_mov_b64 exec, -1
    v_cmpx_gt_i16 vcc, 0, v58
    ds_read_b64 v[20:21], v20
    s_mov_b64 exec, -1
    v_cmpx_gt_i16 vcc, 0, v59
    ds_read_b64 v[22:23], v22
    s_mov_b64 exec, -1
p2_g0r23:
    s_cmp_ge_u32 s10, 9
    s_cbranch_scc1 p2_nm0m0a
    v_lshrrev_b32 v84, 1, v112
    s_add_u32 s44, s20, s42
    buffer_load_dwordx2 v[84:85], v84, s[4:7], s44 offen
p2_nm0m0a:
    buffer_load_dwordx4 v[72:75], v112, s[4:7], s20 offen offset:0
    buffer_load_dwordx4 v[76:79], v112, s[4:7], s20 offen offset:1024
    buffer_load_dwordx4 v[80:83], v112, s[4:7], s20 offen offset:2048
    v_cmpx_gt_i16 vcc, 0, v60
    ds_read_b64 v[24:25], v24
    s_mov_b64 exec, -1
    v_cmpx_gt_i16 vcc, 0, v61
    ds_read_b64 v[26:27], v26
    s_mov_b64 exec, -1
    v_cmpx_gt_i16 vcc, 0, v62
    ds_read_b64 v[28:29], v28
    s_mov_b64 exec, -1
    v_cmpx_gt_i16 vcc, 0, v63
    ds_read_b64 v[30:31], v30
    s_mov_b64 exec, -1
    v_cmpx_gt_i16 vcc, 0, v64
    ds_read_b64 v[32:33], v32
    s_mov_b64 exec, -1
    v_cmpx_gt_i16 vcc, 0, v65
    ds_read_b64 v[34:35], v34
    s_mov_b64 exec, -1
    v_cmpx_gt_i16 vcc, 0, v66
    ds_read_b64 v[36:37], v36
    s_mov_b64 exec, -1
    v_cmpx_gt_i16 vcc, 0, v67
    ds_read_b64 v[38:39], v38
    s_mov_b64 exec, -1
    v_cmpx_gt_i16 vcc, 0, v68
    ds_read_b64 v[40:41], v40
    s_mov_b64 exec, -1
    v_cmpx_gt_i16 vcc, 0, v69
    ds_read_b64 v[42:43], v42
    s_mov_b64 exec, -1
    v_cmpx_gt_i16 vcc, 0, v70
    ds_read_b64 v[44:45], v44
    s_mov_b64 exec, -1
    v_cmpx_gt_i16 vcc, 0, v71
    ds_read_b64 v[46:47], v46
    s_mov_b64 exec, -1
    s_setprio 2
    s_waitcnt lgkmcnt(15)
    v_ashrrev_i32 v122, 5, v48
    v_lshlrev_b16 v123, 2, v48
    v_lshlrev_b32 v124, 16, v0
    v_bitop3_b32 v122, v122, v113, v113 bitop3:0x0c
    v_and_b32 v125, 0xffff0000, v0
    v_lshlrev_b32 v126, 16, v1
    v_mul_f32 v122, v114, v122
    v_and_b32 v127, 0xffff0000, v1
    v_add_u32 v123, v123, v123
    v_pk_fma_f32 v[124:125], v[124:125], v[122:123], s[34:35] op_sel_hi:[1,0,1]
    v_pk_fma_f32 v[126:127], v[126:127], v[122:123], s[34:35] op_sel_hi:[1,0,1]
    v_lshl_add_u32 v124, v125, 16, v124
    v_lshl_add_u32 v125, v127, 16, v126
    s_waitcnt lgkmcnt(15)
    v_bitop3_b32 v115, v115, v116, v117 bitop3:0xfe
    v_lshl_add_u64 v[124:125], v[124:125], 0, s[36:37]
    v_cmpx_le_u32 vcc, 0x1000000, v48
    ds_add_rtn_u64 v[116:117], v123, v[124:125] offset:54272
    s_mov_b64 exec, -1
    v_ashrrev_i32 v122, 5, v49
    v_lshlrev_b16 v123, 2, v49
    v_lshlrev_b32 v124, 16, v2
    v_bitop3_b32 v122, v122, v113, v113 bitop3:0x0c
    v_and_b32 v125, 0xffff0000, v2
    v_lshlrev_b32 v126, 16, v3
    v_mul_f32 v122, v114, v122
    v_and_b32 v127, 0xffff0000, v3
    v_add_u32 v123, v123, v123
    v_pk_fma_f32 v[124:125], v[124:125], v[122:123], s[34:35] op_sel_hi:[1,0,1]
    v_pk_fma_f32 v[126:127], v[126:127], v[122:123], s[34:35] op_sel_hi:[1,0,1]
    v_lshl_add_u32 v124, v125, 16, v124
    v_lshl_add_u32 v125, v127, 16, v126
    s_waitcnt lgkmcnt(15)
    v_bitop3_b32 v115, v115, v118, v119 bitop3:0xfe
    v_lshl_add_u64 v[124:125], v[124:125], 0, s[36:37]
    v_cmpx_le_u32 vcc, 0x1000000, v49
    ds_add_rtn_u64 v[118:119], v123, v[124:125] offset:54272
    s_mov_b64 exec, -1
    v_ashrrev_i32 v122, 5, v50
    v_lshlrev_b16 v123, 2, v50
    v_lshlrev_b32 v124, 16, v4
    v_bitop3_b32 v122, v122, v113, v113 bitop3:0x0c
    v_and_b32 v125, 0xffff0000, v4
    v_lshlrev_b32 v126, 16, v5
    v_mul_f32 v122, v114, v122
    v_and_b32 v127, 0xffff0000, v5
    v_add_u32 v123, v123, v123
    v_pk_fma_f32 v[124:125], v[124:125], v[122:123], s[34:35] op_sel_hi:[1,0,1]
    v_pk_fma_f32 v[126:127], v[126:127], v[122:123], s[34:35] op_sel_hi:[1,0,1]
    v_lshl_add_u32 v124, v125, 16, v124
    v_lshl_add_u32 v125, v127, 16, v126
    s_waitcnt lgkmcnt(15)
    v_bitop3_b32 v115, v115, v120, v121 bitop3:0xfe
    v_lshl_add_u64 v[124:125], v[124:125], 0, s[36:37]
    v_cmpx_le_u32 vcc, 0x1000000, v50
    ds_add_rtn_u64 v[120:121], v123, v[124:125] offset:54272
    s_mov_b64 exec, -1
    v_bfe_u32 v0, v102, 14, 4
    v_lshrrev_b32 v1, 18, v102
    v_and_b32 v102, 0x3fff, v102
    v_mad_u32_u24 v0, v0, s63, v1
    v_mad_u32_u24 v102, v0, s65, v102
    buffer_load_dwordx4 v[0:3], v102, s[68:71], 0 offen
    s_setprio 1
    s_waitcnt lgkmcnt(15)
    v_ashrrev_i32 v122, 5, v51
    v_lshlrev_b16 v123, 2, v51
    v_lshlrev_b32 v124, 16, v6
    v_bitop3_b32 v122, v122, v113, v113 bitop3:0x0c
    v_and_b32 v125, 0xffff0000, v6
    v_lshlrev_b32 v126, 16, v7
    v_mul_f32 v122, v114, v122
    v_and_b32 v127, 0xffff0000, v7
    v_add_u32 v123, v123, v123
    v_pk_fma_f32 v[124:125], v[124:125], v[122:123], s[34:35] op_sel_hi:[1,0,1]
    v_pk_fma_f32 v[126:127], v[126:127], v[122:123], s[34:35] op_sel_hi:[1,0,1]
    v_lshl_add_u32 v124, v125, 16, v124
    v_lshl_add_u32 v125, v127, 16, v126
    s_waitcnt lgkmcnt(2)
    v_bitop3_b32 v115, v115, v116, v117 bitop3:0xfe
    v_lshl_add_u64 v[124:125], v[124:125], 0, s[36:37]
    v_cmpx_le_u32 vcc, 0x1000000, v51
    ds_add_rtn_u64 v[116:117], v123, v[124:125] offset:54272
    s_mov_b64 exec, -1
    v_ashrrev_i32 v122, 5, v52
    v_lshlrev_b16 v123, 2, v52
    v_lshlrev_b32 v124, 16, v8
    v_bitop3_b32 v122, v122, v113, v113 bitop3:0x0c
    v_and_b32 v125, 0xffff0000, v8
    v_lshlrev_b32 v126, 16, v9
    v_mul_f32 v122, v114, v122
    v_and_b32 v127, 0xffff0000, v9
    v_add_u32 v123, v123, v123
    v_pk_fma_f32 v[124:125], v[124:125], v[122:123], s[34:35] op_sel_hi:[1,0,1]
    v_pk_fma_f32 v[126:127], v[126:127], v[122:123], s[34:35] op_sel_hi:[1,0,1]
    v_lshl_add_u32 v124, v125, 16, v124
    v_lshl_add_u32 v125, v127, 16, v126
    s_waitcnt lgkmcnt(2)
    v_bitop3_b32 v115, v115, v118, v119 bitop3:0xfe
    v_lshl_add_u64 v[124:125], v[124:125], 0, s[36:37]
    v_cmpx_le_u32 vcc, 0x1000000, v52
    ds_add_rtn_u64 v[118:119], v123, v[124:125] offset:54272
    s_mov_b64 exec, -1
    v_ashrrev_i32 v122, 5, v53
    v_lshlrev_b16 v123, 2, v53
    v_lshlrev_b32 v124, 16, v10
    v_bitop3_b32 v122, v122, v113, v113 bitop3:0x0c
    v_and_b32 v125, 0xffff0000, v10
    v_lshlrev_b32 v126, 16, v11
    v_mul_f32 v122, v114, v122
    v_and_b32 v127, 0xffff0000, v11
    v_add_u32 v123, v123, v123
    v_pk_fma_f32 v[124:125], v[124:125], v[122:123], s[34:35] op_sel_hi:[1,0,1]
    v_pk_fma_f32 v[126:127], v[126:127], v[122:123], s[34:35] op_sel_hi:[1,0,1]
    v_lshl_add_u32 v124, v125, 16, v124
    v_lshl_add_u32 v125, v127, 16, v126
    s_waitcnt lgkmcnt(2)
    v_bitop3_b32 v115, v115, v120, v121 bitop3:0xfe
    v_lshl_add_u64 v[124:125], v[124:125], 0, s[36:37]
    v_cmpx_le_u32 vcc, 0x1000000, v53
    ds_add_rtn_u64 v[120:121], v123, v[124:125] offset:54272
    s_mov_b64 exec, -1
    v_bfe_u32 v6, v103, 14, 4
    v_lshrrev_b32 v7, 18, v103
    v_and_b32 v103, 0x3fff, v103
    v_mad_u32_u24 v6, v6, s63, v7
    v_mad_u32_u24 v103, v6, s65, v103
    buffer_load_dwordx4 v[6:9], v103, s[68:71], 0 offen
    s_waitcnt lgkmcnt(6)
    s_barrier
    s_setprio 3
    s_waitcnt vmcnt(5)
    s_mov_b32 m0, s23
    v_mov_b32 v53, 0
    s_movk_i32 s44, 512
    v_sub_u32_sdwa v4, v111, v110 dst_sel:DWORD dst_unused:UNUSED_PAD src0_sel:WORD_0 src1_sel:WORD_0
    v_sub_u32_sdwa v5, v111, v110 dst_sel:DWORD dst_unused:UNUSED_PAD src0_sel:WORD_1 src1_sel:WORD_1
    v_med3_i32 v4, v4, 0, s44
    v_med3_i32 v5, v5, 0, s44
    v_add_u32 v48, v4, v5
    ds_write_addtid_b32 v53 offset:0
    ds_write_addtid_b32 v53 offset:256
    ds_write_addtid_b32 v53 offset:512
    ds_write_addtid_b32 v53 offset:768
    ds_write_addtid_b32 v53 offset:1024
    ds_write_addtid_b32 v53 offset:1280
    ds_write_addtid_b32 v53 offset:1536
    ds_write_addtid_b32 v53 offset:1792
    v_bfe_i32 v53, v112, 6, 1
    v_lshrrev_b32 v49, 6, v112
    v_bitop3_b32 v53, v53, 15, s10 bitop3:0x6a
    v_lshl_or_b32 v49, v49, 4, v53
    v_and_b32 v53, 0x30, v112
    v_lshl_or_b32 v53, v49, 6, v53
    v_lshlrev_b32 v53, 15, v53
    s_nop 1
    v_add_u32_dpp v48, v48, v48 row_shr:1 row_mask:0xf bank_mask:0xf bound_ctrl:0
    s_nop 1
    v_add_u32_dpp v48, v48, v48 row_shr:2 row_mask:0xf bank_mask:0xf bound_ctrl:0
    s_nop 1
    v_add_u32_dpp v48, v48, v48 row_shr:4 row_mask:0xf bank_mask:0xf bound_ctrl:0
    s_nop 1
    v_add_u32_dpp v48, v48, v48 row_shr:8 row_mask:0xf bank_mask:0xf bound_ctrl:0
    s_nop 1
    v_add_u32_dpp v48, v48, v48 row_bcast:15 row_mask:0xa bank_mask:0xf
    s_nop 1
    v_add_u32_dpp v48, v48, v48 row_bcast:31 row_mask:0xc bank_mask:0xf
    s_nop 1
    s_nop 0
    v_readlane_b32 s38, v48, 63
    v_sub_u32 v50, v48, v5
    v_sub_u32 v49, v50, v4
    v_writelane_b32 v5, 1, 63
    v_sub_u32 v10, 512, v49
    v_mad_u32_u16 v51, v110, 16, v53
    v_lshl_add_u32 v51, v10, 4, v51
    v_med3_i32 v10, v10, 0, v4
    v_lshl_add_u32 v49, v49, 2, s23
    v_sub_u32 v11, 512, v50
    v_mad_u32_u16 v52, v110, 16, v53 op_sel:[1,0,0,0]
    v_add_u32 v52, 262144, v52
    s_mov_b32 s44, 0x1fffc000
    v_writelane_b32 v52, s44, 63
    v_lshl_add_u32 v52, v11, 4, v52
    v_med3_i32 v11, v11, 0, v5
    v_lshl_add_u32 v50, v50, 2, s23
    v_lshl_add_u32 v48, v11, 16, v10
    v_add_u32 v110, v110, v48
    s_min_u32 s17, s38, 512
    s_add_u32 s17, s17, 63
    s_lshr_b32 s17, s17, 6
    v_cmpx_lt_i32 vcc, 0, v10
    ds_write_b32 v49, v51
    s_mov_b64 exec, -1
    v_cmpx_lt_i32 vcc, 0, v11
    ds_write_b32 v50, v52
    s_mov_b64 exec, -1
    s_cmp_lt_u32 s38, 512
    s_cbranch_scc1 p2_nomore0x
    v_cmp_lt_u32_sdwa s[44:45], v110, v111 src0_sel:WORD_0 src1_sel:WORD_0
    v_cmp_lt_u32_sdwa s[46:47], v110, v111 src0_sel:WORD_1 src1_sel:WORD_1
    s_nop 0
    s_or_b64 s[44:45], s[44:45], s[46:47]
    s_cbranch_scc0 p2_nomore0x
    v_mov_b32 v49, s19
    v_mov_b32 v50, 1
    ds_write_b32 v49, v50 offset:53760
p2_nomore0x:
    s_setprio 2
    s_waitcnt lgkmcnt(15)
    v_ashrrev_i32 v122, 5, v54
    v_lshlrev_b16 v123, 2, v54
    v_lshlrev_b32 v124, 16, v12
    v_bitop3_b32 v122, v122, v113, v113 bitop3:0x0c
    v_and_b32 v125, 0xffff0000, v12
    v_lshlrev_b32 v126, 16, v13
    v_mul_f32 v122, v114, v122
    v_and_b32 v127, 0xffff0000, v13
    v_add_u32 v123, v123, v123
    v_pk_fma_f32 v[124:125], v[124:125], v[122:123], s[34:35] op_sel_hi:[1,0,1]
    v_pk_fma_f32 v[126:127], v[126:127], v[122:123], s[34:35] op_sel_hi:[1,0,1]
    v_lshl_add_u32 v124, v125, 16, v124
    v_lshl_add_u32 v125, v127, 16, v126
    s_waitcnt lgkmcnt(12)
    v_bitop3_b32 v115, v115, v116, v117 bitop3:0xfe
    v_lshl_add_u64 v[124:125], v[124:125], 0, s[36:37]
    v_cmpx_le_u32 vcc, 0x1000000, v54
    ds_add_rtn_u64 v[116:117], v123, v[124:125] offset:54272
    s_mov_b64 exec, -1
    v_ashrrev_i32 v122, 5, v55
    v_lshlrev_b16 v123, 2, v55
    v_lshlrev_b32 v124, 16, v14
    v_bitop3_b32 v122, v122, v113, v113 bitop3:0x0c
    v_and_b32 v125, 0xffff0000, v14
    v_lshlrev_b32 v126, 16, v15
    v_mul_f32 v122, v114, v122
    v_and_b32 v127, 0xffff0000, v15
    v_add_u32 v123, v123, v123
    v_pk_fma_f32 v[124:125], v[124:125], v[122:123], s[34:35] op_sel_hi:[1,0,1]
    v_pk_fma_f32 v[126:127], v[126:127], v[122:123], s[34:35] op_sel_hi:[1,0,1]
    v_lshl_add_u32 v124, v125, 16, v124
    v_lshl_add_u32 v125, v127, 16, v126
    s_waitcnt lgkmcnt(12)
    v_bitop3_b32 v115, v115, v118, v119 bitop3:0xfe
    v_lshl_add_u64 v[124:125], v[124:125], 0, s[36:37]
    v_cmpx_le_u32 vcc, 0x1000000, v55
    ds_add_rtn_u64 v[118:119], v123, v[124:125] offset:54272
    s_mov_b64 exec, -1
    v_ashrrev_i32 v122, 5, v56
    v_lshlrev_b16 v123, 2, v56
    v_lshlrev_b32 v124, 16, v16
    v_bitop3_b32 v122, v122, v113, v113 bitop3:0x0c
    v_and_b32 v125, 0xffff0000, v16
    v_lshlrev_b32 v126, 16, v17
    v_mul_f32 v122, v114, v122
    v_and_b32 v127, 0xffff0000, v17
    v_add_u32 v123, v123, v123
    v_pk_fma_f32 v[124:125], v[124:125], v[122:123], s[34:35] op_sel_hi:[1,0,1]
    v_pk_fma_f32 v[126:127], v[126:127], v[122:123], s[34:35] op_sel_hi:[1,0,1]
    v_lshl_add_u32 v124, v125, 16, v124
    v_lshl_add_u32 v125, v127, 16, v126
    s_waitcnt lgkmcnt(12)
    v_bitop3_b32 v115, v115, v120, v121 bitop3:0xfe
    v_lshl_add_u64 v[124:125], v[124:125], 0, s[36:37]
    v_cmpx_le_u32 vcc, 0x1000000, v56
    ds_add_rtn_u64 v[120:121], v123, v[124:125] offset:54272
    s_mov_b64 exec, -1
    v_bfe_u32 v12, v104, 14, 4
    v_lshrrev_b32 v13, 18, v104
    v_and_b32 v104, 0x3fff, v104
    v_mad_u32_u24 v12, v12, s63, v13
    v_mad_u32_u24 v104, v12, s65, v104
    buffer_load_dwordx4 v[12:15], v104, s[68:71], 0 offen
    s_cmp_lt_u32 s15, 8
    s_cbranch_scc1 p2_na0a3
    s_waitcnt lgkmcnt(15)
    v_ashrrev_i32 v122, 5, v57
    v_lshlrev_b16 v123, 2, v57
    v_lshlrev_b32 v124, 16, v18
    v_bitop3_b32 v122, v122, v113, v113 bitop3:0x0c
    v_and_b32 v125, 0xffff0000, v18
    v_lshlrev_b32 v126, 16, v19
    v_mul_f32 v122, v114, v122
    v_and_b32 v127, 0xffff0000, v19
    v_add_u32 v123, v123, v123
    v_pk_fma_f32 v[124:125], v[124:125], v[122:123], s[34:35] op_sel_hi:[1,0,1]
    v_pk_fma_f32 v[126:127], v[126:127], v[122:123], s[34:35] op_sel_hi:[1,0,1]
    v_lshl_add_u32 v124, v125, 16, v124
    v_lshl_add_u32 v125, v127, 16, v126
    s_waitcnt lgkmcnt(2)
    v_bitop3_b32 v115, v115, v116, v117 bitop3:0xfe
    v_lshl_add_u64 v[124:125], v[124:125], 0, s[36:37]
    v_cmpx_le_u32 vcc, 0x1000000, v57
    ds_add_rtn_u64 v[116:117], v123, v[124:125] offset:54272
    s_mov_b64 exec, -1
    v_ashrrev_i32 v122, 5, v58
    v_lshlrev_b16 v123, 2, v58
    v_lshlrev_b32 v124, 16, v20
    v_bitop3_b32 v122, v122, v113, v113 bitop3:0x0c
    v_and_b32 v125, 0xffff0000, v20
    v_lshlrev_b32 v126, 16, v21
    v_mul_f32 v122, v114, v122
    v_and_b32 v127, 0xffff0000, v21
    v_add_u32 v123, v123, v123
    v_pk_fma_f32 v[124:125], v[124:125], v[122:123], s[34:35] op_sel_hi:[1,0,1]
    v_pk_fma_f32 v[126:127], v[126:127], v[122:123], s[34:35] op_sel_hi:[1,0,1]
    v_lshl_add_u32 v124, v125, 16, v124
    v_lshl_add_u32 v125, v127, 16, v126
    s_waitcnt lgkmcnt(2)
    v_bitop3_b32 v115, v115, v118, v119 bitop3:0xfe
    v_lshl_add_u64 v[124:125], v[124:125], 0, s[36:37]
    v_cmpx_le_u32 vcc, 0x1000000, v58
    ds_add_rtn_u64 v[118:119], v123, v[124:125] offset:54272
    s_mov_b64 exec, -1
    v_ashrrev_i32 v122, 5, v59
    v_lshlrev_b16 v123, 2, v59
    v_lshlrev_b32 v124, 16, v22
    v_bitop3_b32 v122, v122, v113, v113 bitop3:0x0c
    v_and_b32 v125, 0xffff0000, v22
    v_lshlrev_b32 v126, 16, v23
    v_mul_f32 v122, v114, v122
    v_and_b32 v127, 0xffff0000, v23
    v_add_u32 v123, v123, v123
    v_pk_fma_f32 v[124:125], v[124:125], v[122:123], s[34:35] op_sel_hi:[1,0,1]
    v_pk_fma_f32 v[126:127], v[126:127], v[122:123], s[34:35] op_sel_hi:[1,0,1]
    v_lshl_add_u32 v124, v125, 16, v124
    v_lshl_add_u32 v125, v127, 16, v126
    s_waitcnt lgkmcnt(2)
    v_bitop3_b32 v115, v115, v120, v121 bitop3:0xfe
    v_lshl_add_u64 v[124:125], v[124:125], 0, s[36:37]
    v_cmpx_le_u32 vcc, 0x1000000, v59
    ds_add_rtn_u64 v[120:121], v123, v[124:125] offset:54272
    s_mov_b64 exec, -1
p2_na0a3:
    v_bfe_u32 v18, v105, 14, 4
    v_lshrrev_b32 v19, 18, v105
    v_and_b32 v105, 0x3fff, v105
    v_mad_u32_u24 v18, v18, s63, v19
    v_mad_u32_u24 v105, v18, s65, v105
    buffer_load_dwordx4 v[18:21], v105, s[68:71], 0 offen
    s_mov_b32 m0, s23
    s_nop 0
    ds_read_addtid_b32 v102 offset:1024
    ds_read_addtid_b32 v103 offset:1280
    ds_read_addtid_b32 v104 offset:1536
    ds_read_addtid_b32 v105 offset:1792
    ds_read_addtid_b32 v106 offset:0
    ds_read_addtid_b32 v107 offset:256
    ds_read_addtid_b32 v108 offset:512
    ds_read_addtid_b32 v109 offset:768
    s_waitcnt vmcnt(4)
    s_mov_b32 m0, s24
    s_cmp_ge_u32 s10, 9
    s_cbranch_scc1 p2_st0s0
    ds_write_addtid_b32 v84 offset:49152
    ds_write_addtid_b32 v85 offset:49408
p2_st0s0:
    s_mov_b32 m0, s23
    s_add_u32 s20, s20, 53760
    ds_write_addtid_b32 v72 offset:0
    ds_write_addtid_b32 v73 offset:256
    ds_write_addtid_b32 v74 offset:512
    ds_write_addtid_b32 v75 offset:768
    ds_write_addtid_b32 v76 offset:1024
    ds_write_addtid_b32 v77 offset:1280
    ds_write_addtid_b32 v78 offset:1536
    ds_write_addtid_b32 v79 offset:1792
    ds_write_addtid_b32 v80 offset:2048
    ds_write_addtid_b32 v81 offset:2304
    ds_write_addtid_b32 v82 offset:2560
    ds_write_addtid_b32 v83 offset:2816
    s_setprio 1
    s_waitcnt lgkmcnt(15)
    v_ashrrev_i32 v122, 5, v60
    v_lshlrev_b16 v123, 2, v60
    v_lshlrev_b32 v124, 16, v24
    v_bitop3_b32 v122, v122, v113, v113 bitop3:0x0c
    v_and_b32 v125, 0xffff0000, v24
    v_lshlrev_b32 v126, 16, v25
    v_mul_f32 v122, v114, v122
    v_and_b32 v127, 0xffff0000, v25
    v_add_u32 v123, v123, v123
    v_pk_fma_f32 v[124:125], v[124:125], v[122:123], s[34:35] op_sel_hi:[1,0,1]
    v_pk_fma_f32 v[126:127], v[126:127], v[122:123], s[34:35] op_sel_hi:[1,0,1]
    v_lshl_add_u32 v124, v125, 16, v124
    v_lshl_add_u32 v125, v127, 16, v126
    s_waitcnt lgkmcnt(15)
    v_bitop3_b32 v115, v115, v116, v117 bitop3:0xfe
    v_lshl_add_u64 v[124:125], v[124:125], 0, s[36:37]
    v_cmpx_le_u32 vcc, 0x1000000, v60
    ds_add_rtn_u64 v[116:117], v123, v[124:125] offset:54272
    s_mov_b64 exec, -1
    v_ashrrev_i32 v122, 5, v61
    v_lshlrev_b16 v123, 2, v61
    v_lshlrev_b32 v124, 16, v26
    v_bitop3_b32 v122, v122, v113, v113 bitop3:0x0c
    v_and_b32 v125, 0xffff0000, v26
    v_lshlrev_b32 v126, 16, v27
    v_mul_f32 v122, v114, v122
    v_and_b32 v127, 0xffff0000, v27
    v_add_u32 v123, v123, v123
    v_pk_fma_f32 v[124:125], v[124:125], v[122:123], s[34:35] op_sel_hi:[1,0,1]
    v_pk_fma_f32 v[126:127], v[126:127], v[122:123], s[34:35] op_sel_hi:[1,0,1]
    v_lshl_add_u32 v124, v125, 16, v124
    v_lshl_add_u32 v125, v127, 16, v126
    s_waitcnt lgkmcnt(15)
    v_bitop3_b32 v115, v115, v118, v119 bitop3:0xfe
    v_lshl_add_u64 v[124:125], v[124:125], 0, s[36:37]
    v_cmpx_le_u32 vcc, 0x1000000, v61
    ds_add_rtn_u64 v[118:119], v123, v[124:125] offset:54272
    s_mov_b64 exec, -1
    v_ashrrev_i32 v122, 5, v62
    v_lshlrev_b16 v123, 2, v62
    v_lshlrev_b32 v124, 16, v28
    v_bitop3_b32 v122, v122, v113, v113 bitop3:0x0c
    v_and_b32 v125, 0xffff0000, v28
    v_lshlrev_b32 v126, 16, v29
    v_mul_f32 v122, v114, v122
    v_and_b32 v127, 0xffff0000, v29
    v_add_u32 v123, v123, v123
    v_pk_fma_f32 v[124:125], v[124:125], v[122:123], s[34:35] op_sel_hi:[1,0,1]
    v_pk_fma_f32 v[126:127], v[126:127], v[122:123], s[34:35] op_sel_hi:[1,0,1]
    v_lshl_add_u32 v124, v125, 16, v124
    v_lshl_add_u32 v125, v127, 16, v126
    s_waitcnt lgkmcnt(15)
    v_bitop3_b32 v115, v115, v120, v121 bitop3:0xfe
    v_lshl_add_u64 v[124:125], v[124:125], 0, s[36:37]
    v_cmpx_le_u32 vcc, 0x1000000, v62
    ds_add_rtn_u64 v[120:121], v123, v[124:125] offset:54272
    s_mov_b64 exec, -1
    s_waitcnt vmcnt(16)
    v_perm_b32 v60, v89, v86, s31
    v_perm_b32 v61, v89, v87, s32
    v_perm_b32 v62, v89, v88, s33
    v_lshlrev_b16 v28, 3, v88
    v_lshlrev_b16 v26, 3, v87
    v_lshlrev_b16 v24, 3, v86
    s_waitcnt lgkmcnt(15)
    s_nop 2
    s_nop 1
    v_max_u32_dpp v106, v106, v106 row_shr:1 row_mask:0xf bank_mask:0xf bound_ctrl:0
    v_max_u32_dpp v107, v107, v107 row_shr:1 row_mask:0xf bank_mask:0xf bound_ctrl:0
    s_nop 0
    v_max_u32_dpp v106, v106, v106 row_shr:2 row_mask:0xf bank_mask:0xf bound_ctrl:0
    v_max_u32_dpp v107, v107, v107 row_shr:2 row_mask:0xf bank_mask:0xf bound_ctrl:0
    s_nop 0
    v_max_u32_dpp v106, v106, v106 row_shr:4 row_mask:0xf bank_mask:0xf bound_ctrl:0
    v_max_u32_dpp v107, v107, v107 row_shr:4 row_mask:0xf bank_mask:0xf bound_ctrl:0
    s_nop 0
    v_max_u32_dpp v106, v106, v106 row_shr:8 row_mask:0xf bank_mask:0xf bound_ctrl:0
    v_max_u32_dpp v107, v107, v107 row_shr:8 row_mask:0xf bank_mask:0xf bound_ctrl:0
    s_nop 0
    v_max_u32_dpp v106, v106, v106 row_bcast:15 row_mask:0xa bank_mask:0xf
    v_max_u32_dpp v107, v107, v107 row_bcast:15 row_mask:0xa bank_mask:0xf
    s_nop 0
    v_max_u32_dpp v106, v106, v106 row_bcast:31 row_mask:0xc bank_mask:0xf
    v_max_u32_dpp v107, v107, v107 row_bcast:31 row_mask:0xc bank_mask:0xf
    s_nop 0
    s_nop 0
    v_readlane_b32 s41, v106, 63
    v_add_u32 v106, v106, v112
    v_add_u32 v106, 4294959104, v106
    v_max_u32 v107, s41, v107
    s_nop 0
    v_readlane_b32 s41, v107, 63
    v_add_u32 v107, v107, v112
    v_add_u32 v107, 4294960128, v107
    v_bfe_u32 v86, v106, 14, 4
    v_lshrrev_b32 v87, 18, v106
    v_and_b32 v106, 0x3fff, v106
    v_mad_u32_u24 v86, v86, s63, v87
    v_mad_u32_u24 v106, v86, s65, v106
    buffer_load_dwordx4 v[86:89], v106, s[68:71], 0 offen
    s_setprio 0
    s_waitcnt lgkmcnt(15)
    v_ashrrev_i32 v122, 5, v63
    v_lshlrev_b16 v123, 2, v63
    v_lshlrev_b32 v124, 16, v30
    v_bitop3_b32 v122, v122, v113, v113 bitop3:0x0c
    v_and_b32 v125, 0xffff0000, v30
    v_lshlrev_b32 v126, 16, v31
    v_mul_f32 v122, v114, v122
    v_and_b32 v127, 0xffff0000, v31
    v_add_u32 v123, v123, v123
    v_pk_fma_f32 v[124:125], v[124:125], v[122:123], s[34:35] op_sel_hi:[1,0,1]
    v_pk_fma_f32 v[126:127], v[126:127], v[122:123], s[34:35] op_sel_hi:[1,0,1]
    v_lshl_add_u32 v124, v125, 16, v124
    v_lshl_add_u32 v125, v127, 16, v126
    s_waitcnt lgkmcnt(2)
    v_bitop3_b32 v115, v115, v116, v117 bitop3:0xfe
    v_lshl_add_u64 v[124:125], v[124:125], 0, s[36:37]
    v_cmpx_le_u32 vcc, 0x1000000, v63
    ds_add_rtn_u64 v[116:117], v123, v[124:125] offset:54272
    s_mov_b64 exec, -1
    v_ashrrev_i32 v122, 5, v64
    v_lshlrev_b16 v123, 2, v64
    v_lshlrev_b32 v124, 16, v32
    v_bitop3_b32 v122, v122, v113, v113 bitop3:0x0c
    v_and_b32 v125, 0xffff0000, v32
    v_lshlrev_b32 v126, 16, v33
    v_mul_f32 v122, v114, v122
    v_and_b32 v127, 0xffff0000, v33
    v_add_u32 v123, v123, v123
    v_pk_fma_f32 v[124:125], v[124:125], v[122:123], s[34:35] op_sel_hi:[1,0,1]
    v_pk_fma_f32 v[126:127], v[126:127], v[122:123], s[34:35] op_sel_hi:[1,0,1]
    v_lshl_add_u32 v124, v125, 16, v124
    v_lshl_add_u32 v125, v127, 16, v126
    s_waitcnt lgkmcnt(2)
    v_bitop3_b32 v115, v115, v118, v119 bitop3:0xfe
    v_lshl_add_u64 v[124:125], v[124:125], 0, s[36:37]
    v_cmpx_le_u32 vcc, 0x1000000, v64
    ds_add_rtn_u64 v[118:119], v123, v[124:125] offset:54272
    s_mov_b64 exec, -1
    v_ashrrev_i32 v122, 5, v65
    v_lshlrev_b16 v123, 2, v65
    v_lshlrev_b32 v124, 16, v34
    v_bitop3_b32 v122, v122, v113, v113 bitop3:0x0c
    v_and_b32 v125, 0xffff0000, v34
    v_lshlrev_b32 v126, 16, v35
    v_mul_f32 v122, v114, v122
    v_and_b32 v127, 0xffff0000, v35
    v_add_u32 v123, v123, v123
    v_pk_fma_f32 v[124:125], v[124:125], v[122:123], s[34:35] op_sel_hi:[1,0,1]
    v_pk_fma_f32 v[126:127], v[126:127], v[122:123], s[34:35] op_sel_hi:[1,0,1]
    v_lshl_add_u32 v124, v125, 16, v124
    v_lshl_add_u32 v125, v127, 16, v126
    s_waitcnt lgkmcnt(2)
    v_bitop3_b32 v115, v115, v120, v121 bitop3:0xfe
    v_lshl_add_u64 v[124:125], v[124:125], 0, s[36:37]
    v_cmpx_le_u32 vcc, 0x1000000, v65
    ds_add_rtn_u64 v[120:121], v123, v[124:125] offset:54272
    s_mov_b64 exec, -1
    s_waitcnt vmcnt(13)
    v_perm_b32 v63, v93, v90, s31
    v_perm_b32 v64, v93, v91, s32
    v_perm_b32 v65, v93, v92, s33
    v_lshlrev_b16 v34, 3, v92
    v_lshlrev_b16 v32, 3, v91
    v_lshlrev_b16 v30, 3, v90
    s_waitcnt lgkmcnt(6)
    s_barrier
    s_setprio 3
    s_cmp_ge_u32 s10, 9
    s_cbranch_scc1 p2_nm0m1a
    v_lshrrev_b32 v84, 1, v112
    s_add_u32 s44, s20, s42
    buffer_load_dwordx2 v[84:85], v84, s[4:7], s44 offen
p2_nm0m1a:
    buffer_load_dwordx4 v[72:75], v112, s[4:7], s20 offen offset:0
    buffer_load_dwordx4 v[76:79], v112, s[4:7], s20 offen offset:1024
    buffer_load_dwordx4 v[80:83], v112, s[4:7], s20 offen offset:2048
    v_cmpx_ge_u16 vcc, 0x3fff, v60
    ds_read_b64 v[24:25], v24
    s_mov_b64 exec, -1
    v_cmpx_ge_u16 vcc, 0x3fff, v61
    ds_read_b64 v[26:27], v26
    s_mov_b64 exec, -1
    v_cmpx_ge_u16 vcc, 0x3fff, v62
    ds_read_b64 v[28:29], v28
    s_mov_b64 exec, -1
    v_cmpx_ge_u16 vcc, 0x3fff, v63
    ds_read_b64 v[30:31], v30
    s_mov_b64 exec, -1
    v_cmpx_ge_u16 vcc, 0x3fff, v64
    ds_read_b64 v[32:33], v32
    s_mov_b64 exec, -1
    v_cmpx_ge_u16 vcc, 0x3fff, v65
    ds_read_b64 v[34:35], v34
    s_mov_b64 exec, -1
    s_setprio 2
    s_waitcnt lgkmcnt(15)
    v_ashrrev_i32 v122, 5, v66
    v_lshlrev_b16 v123, 2, v66
    v_lshlrev_b32 v124, 16, v36
    v_bitop3_b32 v122, v122, v113, v113 bitop3:0x0c
    v_and_b32 v125, 0xffff0000, v36
    v_lshlrev_b32 v126, 16, v37
    v_mul_f32 v122, v114, v122
    v_and_b32 v127, 0xffff0000, v37
    v_add_u32 v123, v123, v123
    v_pk_fma_f32 v[124:125], v[124:125], v[122:123], s[34:35] op_sel_hi:[1,0,1]
    v_pk_fma_f32 v[126:127], v[126:127], v[122:123], s[34:35] op_sel_hi:[1,0,1]
    v_lshl_add_u32 v124, v125, 16, v124
    v_lshl_add_u32 v125, v127, 16, v126
    s_waitcnt lgkmcnt(8)
    v_bitop3_b32 v115, v115, v116, v117 bitop3:0xfe
    v_lshl_add_u64 v[124:125], v[124:125], 0, s[36:37]
    v_cmpx_le_u32 vcc, 0x1000000, v66
    ds_add_rtn_u64 v[116:117], v123, v[124:125] offset:54272
    s_mov_b64 exec, -1
    v_ashrrev_i32 v122, 5, v67
    v_lshlrev_b16 v123, 2, v67
    v_lshlrev_b32 v124, 16, v38
    v_bitop3_b32 v122, v122, v113, v113 bitop3:0x0c
    v_and_b32 v125, 0xffff0000, v38
    v_lshlrev_b32 v126, 16, v39
    v_mul_f32 v122, v114, v122
    v_and_b32 v127, 0xffff0000, v39
    v_add_u32 v123, v123, v123
    v_pk_fma_f32 v[124:125], v[124:125], v[122:123], s[34:35] op_sel_hi:[1,0,1]
    v_pk_fma_f32 v[126:127], v[126:127], v[122:123], s[34:35] op_sel_hi:[1,0,1]
    v_lshl_add_u32 v124, v125, 16, v124
    v_lshl_add_u32 v125, v127, 16, v126
    s_waitcnt lgkmcnt(8)
    v_bitop3_b32 v115, v115, v118, v119 bitop3:0xfe
    v_lshl_add_u64 v[124:125], v[124:125], 0, s[36:37]
    v_cmpx_le_u32 vcc, 0x1000000, v67
    ds_add_rtn_u64 v[118:119], v123, v[124:125] offset:54272
    s_mov_b64 exec, -1
    v_ashrrev_i32 v122, 5, v68
    v_lshlrev_b16 v123, 2, v68
    v_lshlrev_b32 v124, 16, v40
    v_bitop3_b32 v122, v122, v113, v113 bitop3:0x0c
    v_and_b32 v125, 0xffff0000, v40
    v_lshlrev_b32 v126, 16, v41
    v_mul_f32 v122, v114, v122
    v_and_b32 v127, 0xffff0000, v41
    v_add_u32 v123, v123, v123
    v_pk_fma_f32 v[124:125], v[124:125], v[122:123], s[34:35] op_sel_hi:[1,0,1]
    v_pk_fma_f32 v[126:127], v[126:127], v[122:123], s[34:35] op_sel_hi:[1,0,1]
    v_lshl_add_u32 v124, v125, 16, v124
    v_lshl_add_u32 v125, v127, 16, v126
    s_waitcnt lgkmcnt(8)
    v_bitop3_b32 v115, v115, v120, v121 bitop3:0xfe
    v_lshl_add_u64 v[124:125], v[124:125], 0, s[36:37]
    v_cmpx_le_u32 vcc, 0x1000000, v68
    ds_add_rtn_u64 v[120:121], v123, v[124:125] offset:54272
    s_mov_b64 exec, -1
    s_waitcnt vmcnt(15)
    v_perm_b32 v66, v97, v94, s31
    v_perm_b32 v67, v97, v95, s32
    v_perm_b32 v68, v97, v96, s33
    v_lshlrev_b16 v40, 3, v96
    v_lshlrev_b16 v38, 3, v95
    v_lshlrev_b16 v36, 3, v94
    v_cmpx_ge_u16 vcc, 0x3fff, v66
    ds_read_b64 v[36:37], v36
    s_mov_b64 exec, -1
    v_cmpx_ge_u16 vcc, 0x3fff, v67
    ds_read_b64 v[38:39], v38
    s_mov_b64 exec, -1
    v_cmpx_ge_u16 vcc, 0x3fff, v68
    ds_read_b64 v[40:41], v40
    s_mov_b64 exec, -1
    v_bfe_u32 v90, v107, 14, 4
    v_lshrrev_b32 v91, 18, v107
    v_and_b32 v107, 0x3fff, v107
    v_mad_u32_u24 v90, v90, s63, v91
    v_mad_u32_u24 v107, v90, s65, v107
    buffer_load_dwordx4 v[90:93], v107, s[68:71], 0 offen
    s_setprio 1
    s_waitcnt lgkmcnt(15)
    v_ashrrev_i32 v122, 5, v69
    v_lshlrev_b16 v123, 2, v69
    v_lshlrev_b32 v124, 16, v42
    v_bitop3_b32 v122, v122, v113, v113 bitop3:0x0c
    v_and_b32 v125, 0xffff0000, v42
    v_lshlrev_b32 v126, 16, v43
    v_mul_f32 v122, v114, v122
    v_and_b32 v127, 0xffff0000, v43
    v_add_u32 v123, v123, v123
    v_pk_fma_f32 v[124:125], v[124:125], v[122:123], s[34:35] op_sel_hi:[1,0,1]
    v_pk_fma_f32 v[126:127], v[126:127], v[122:123], s[34:35] op_sel_hi:[1,0,1]
    v_lshl_add_u32 v124, v125, 16, v124
    v_lshl_add_u32 v125, v127, 16, v126
    s_waitcnt lgkmcnt(5)
    v_bitop3_b32 v115, v115, v116, v117 bitop3:0xfe
    v_lshl_add_u64 v[124:125], v[124:125], 0, s[36:37]
    v_cmpx_le_u32 vcc, 0x1000000, v69
    ds_add_rtn_u64 v[116:117], v123, v[124:125] offset:54272
    s_mov_b64 exec, -1
    v_ashrrev_i32 v122, 5, v70
    v_lshlrev_b16 v123, 2, v70
    v_lshlrev_b32 v124, 16, v44
    v_bitop3_b32 v122, v122, v113, v113 bitop3:0x0c
    v_and_b32 v125, 0xffff0000, v44
    v_lshlrev_b32 v126, 16, v45
    v_mul_f32 v122, v114, v122
    v_and_b32 v127, 0xffff0000, v45
    v_add_u32 v123, v123, v123
    v_pk_fma_f32 v[124:125], v[124:125], v[122:123], s[34:35] op_sel_hi:[1,0,1]
    v_pk_fma_f32 v[126:127], v[126:127], v[122:123], s[34:35] op_sel_hi:[1,0,1]
    v_lshl_add_u32 v124, v125, 16, v124
    v_lshl_add_u32 v125, v127, 16, v126
    s_waitcnt lgkmcnt(5)
    v_bitop3_b32 v115, v115, v118, v119 bitop3:0xfe
    v_lshl_add_u64 v[124:125], v[124:125], 0, s[36:37]
    v_cmpx_le_u32 vcc, 0x1000000, v70
    ds_add_rtn_u64 v[118:119], v123, v[124:125] offset:54272
    s_mov_b64 exec, -1
    v_ashrrev_i32 v122, 5, v71
    v_lshlrev_b16 v123, 2, v71
    v_lshlrev_b32 v124, 16, v46
    v_bitop3_b32 v122, v122, v113, v113 bitop3:0x0c
    v_and_b32 v125, 0xffff0000, v46
    v_lshlrev_b32 v126, 16, v47
    v_mul_f32 v122, v114, v122
    v_and_b32 v127, 0xffff0000, v47
    v_add_u32 v123, v123, v123
    v_pk_fma_f32 v[124:125], v[124:125], v[122:123], s[34:35] op_sel_hi:[1,0,1]
    v_pk_fma_f32 v[126:127], v[126:127], v[122:123], s[34:35] op_sel_hi:[1,0,1]
    v_lshl_add_u32 v124, v125, 16, v124
    v_lshl_add_u32 v125, v127, 16, v126
    s_waitcnt lgkmcnt(5)
    v_bitop3_b32 v115, v115, v120, v121 bitop3:0xfe
    v_lshl_add_u64 v[124:125], v[124:125], 0, s[36:37]
    v_cmpx_le_u32 vcc, 0x1000000, v71
    ds_add_rtn_u64 v[120:121], v123, v[124:125] offset:54272
    s_mov_b64 exec, -1
    s_waitcnt vmcnt(12)
    v_perm_b32 v69, v101, v98, s31
    v_perm_b32 v70, v101, v99, s32
    v_perm_b32 v71, v101, v100, s33
    v_lshlrev_b16 v46, 3, v100
    v_lshlrev_b16 v44, 3, v99
    v_lshlrev_b16 v42, 3, v98
    v_cmpx_ge_u16 vcc, 0x3fff, v69
    ds_read_b64 v[42:43], v42
    s_mov_b64 exec, -1
    v_cmpx_ge_u16 vcc, 0x3fff, v70
    ds_read_b64 v[44:45], v44
    s_mov_b64 exec, -1
    v_cmpx_ge_u16 vcc, 0x3fff, v71
    ds_read_b64 v[46:47], v46
    s_mov_b64 exec, -1
    s_waitcnt lgkmcnt(15)
    s_nop 2
    s_nop 1
    v_max_u32_dpp v108, v108, v108 row_shr:1 row_mask:0xf bank_mask:0xf bound_ctrl:0
    v_max_u32_dpp v109, v109, v109 row_shr:1 row_mask:0xf bank_mask:0xf bound_ctrl:0
    s_nop 0
    v_max_u32_dpp v108, v108, v108 row_shr:2 row_mask:0xf bank_mask:0xf bound_ctrl:0
    v_max_u32_dpp v109, v109, v109 row_shr:2 row_mask:0xf bank_mask:0xf bound_ctrl:0
    s_nop 0
    v_max_u32_dpp v108, v108, v108 row_shr:4 row_mask:0xf bank_mask:0xf bound_ctrl:0
    v_max_u32_dpp v109, v109, v109 row_shr:4 row_mask:0xf bank_mask:0xf bound_ctrl:0
    s_nop 0
    v_max_u32_dpp v108, v108, v108 row_shr:8 row_mask:0xf bank_mask:0xf bound_ctrl:0
    v_max_u32_dpp v109, v109, v109 row_shr:8 row_mask:0xf bank_mask:0xf bound_ctrl:0
    s_nop 0
    v_max_u32_dpp v108, v108, v108 row_bcast:15 row_mask:0xa bank_mask:0xf
    v_max_u32_dpp v109, v109, v109 row_bcast:15 row_mask:0xa bank_mask:0xf
    s_nop 0
    v_max_u32_dpp v108, v108, v108 row_bcast:31 row_mask:0xc bank_mask:0xf
    v_max_u32_dpp v109, v109, v109 row_bcast:31 row_mask:0xc bank_mask:0xf
    s_nop 0
    s_nop 0
    v_max_u32 v108, s41, v108
    s_nop 0
    v_readlane_b32 s41, v108, 63
    v_add_u32 v108, v108, v112
    v_add_u32 v108, 4294961152, v108
    v_max_u32 v109, s41, v109
    s_nop 0
    v_readlane_b32 s41, v109, 63
    v_add_u32 v109, v109, v112
    v_add_u32 v109, 4294962176, v109
    v_bfe_u32 v94, v108, 14, 4
    v_lshrrev_b32 v95, 18, v108
    v_and_b32 v108, 0x3fff, v108
    v_mad_u32_u24 v94, v94, s63, v95
    v_mad_u32_u24 v108, v94, s65, v108
    buffer_load_dwordx4 v[94:97], v108, s[68:71], 0 offen
    s_setprio 0
    s_waitcnt vmcnt(9)
    v_perm_b32 v48, v3, v0, s31
    v_perm_b32 v49, v3, v1, s32
    v_perm_b32 v50, v3, v2, s33
    v_lshlrev_b16 v4, 3, v2
    v_lshlrev_b16 v2, 3, v1
    v_lshlrev_b16 v0, 3, v0
    v_cmpx_ge_u16 vcc, 0x3fff, v48
    ds_read_b64 v[0:1], v0
    s_mov_b64 exec, -1
    v_cmpx_ge_u16 vcc, 0x3fff, v49
    ds_read_b64 v[2:3], v2
    s_mov_b64 exec, -1
    v_cmpx_ge_u16 vcc, 0x3fff, v50
    ds_read_b64 v[4:5], v4
    s_mov_b64 exec, -1
    s_waitcnt vmcnt(8)
    v_perm_b32 v51, v9, v6, s31
    v_perm_b32 v52, v9, v7, s32
    v_perm_b32 v53, v9, v8, s33
    v_lshlrev_b16 v10, 3, v8
    v_lshlrev_b16 v8, 3, v7
    v_lshlrev_b16 v6, 3, v6
    v_cmpx_ge_u16 vcc, 0x3fff, v51
    ds_read_b64 v[6:7], v6
    s_mov_b64 exec, -1
    v_cmpx_ge_u16 vcc, 0x3fff, v52
    ds_read_b64 v[8:9], v8
    s_mov_b64 exec, -1
    v_cmpx_ge_u16 vcc, 0x3fff, v53
    ds_read_b64 v[10:11], v10
    s_mov_b64 exec, -1
    s_waitcnt vmcnt(7)
    v_perm_b32 v54, v15, v12, s31
    v_perm_b32 v55, v15, v13, s32
    v_perm_b32 v56, v15, v14, s33
    v_lshlrev_b16 v16, 3, v14
    v_lshlrev_b16 v14, 3, v13
    v_lshlrev_b16 v12, 3, v12
    v_cmpx_ge_u16 vcc, 0x3fff, v54
    ds_read_b64 v[12:13], v12
    s_mov_b64 exec, -1
    v_cmpx_ge_u16 vcc, 0x3fff, v55
    ds_read_b64 v[14:15], v14
    s_mov_b64 exec, -1
    v_cmpx_ge_u16 vcc, 0x3fff, v56
    ds_read_b64 v[16:17], v16
    s_mov_b64 exec, -1
    s_waitcnt vmcnt(6)
    v_perm_b32 v57, v21, v18, s31
    v_perm_b32 v58, v21, v19, s32
    v_perm_b32 v59, v21, v20, s33
    v_lshlrev_b16 v22, 3, v20
    v_lshlrev_b16 v20, 3, v19
    v_lshlrev_b16 v18, 3, v18
    s_cmp_lt_u32 s16, 8
    s_cbranch_scc1 p2_g0r03
    v_cmpx_ge_u16 vcc, 0x3fff, v57
    ds_read_b64 v[18:19], v18
    s_mov_b64 exec, -1
    v_cmpx_ge_u16 vcc, 0x3fff, v58
    ds_read_b64 v[20:21], v20
    s_mov_b64 exec, -1
    v_cmpx_ge_u16 vcc, 0x3fff, v59
    ds_read_b64 v[22:23], v22
    s_mov_b64 exec, -1
p2_g0r03:
    s_waitcnt lgkmcnt(0)
    s_barrier
    s_waitcnt lgkmcnt(15)
    s_branch p2_tail
p2_drain0:
    v_cmpx_gt_i16 vcc, 0, v48
    ds_read_b64 v[0:1], v0
    s_mov_b64 exec, -1
    v_cmpx_gt_i16 vcc, 0, v49
    ds_read_b64 v[2:3], v2
    s_mov_b64 exec, -1
    v_cmpx_gt_i16 vcc, 0, v50
    ds_read_b64 v[4:5], v4
    s_mov_b64 exec, -1
    v_cmpx_gt_i16 vcc, 0, v51
    ds_read_b64 v[6:7], v6
    s_mov_b64 exec, -1
    v_cmpx_gt_i16 vcc, 0, v52
    ds_read_b64 v[8:9], v8
    s_mov_b64 exec, -1
    v_cmpx_gt_i16 vcc, 0, v53
    ds_read_b64 v[10:11], v10
    s_mov_b64 exec, -1
    v_cmpx_gt_i16 vcc, 0, v54
    ds_read_b64 v[12:13], v12
    s_mov_b64 exec, -1
    v_cmpx_gt_i16 vcc, 0, v55
    ds_read_b64 v[14:15], v14
    s_mov_b64 exec, -1
    v_cmpx_gt_i16 vcc, 0, v56
    ds_read_b64 v[16:17], v16
    s_mov_b64 exec, -1
    s_cmp_lt_u32 s15, 8
    s_cbranch_scc1 p2_gd0
    v_cmpx_gt_i16 vcc, 0, v57
    ds_read_b64 v[18:19], v18
    s_mov_b64 exec, -1
    v_cmpx_gt_i16 vcc, 0, v58
    ds_read_b64 v[20:21], v20
    s_mov_b64 exec, -1
    v_cmpx_gt_i16 vcc, 0, v59
    ds_read_b64 v[22:23], v22
    s_mov_b64 exec, -1
p2_gd0:
    v_cmpx_gt_i16 vcc, 0, v60
    ds_read_b64 v[24:25], v24
    s_mov_b64 exec, -1
    v_cmpx_gt_i16 vcc, 0, v61
    ds_read_b64 v[26:27], v26
    s_mov_b64 exec, -1
    v_cmpx_gt_i16 vcc, 0, v62
    ds_read_b64 v[28:29], v28
    s_mov_b64 exec, -1
    v_cmpx_gt_i16 vcc, 0, v63
    ds_read_b64 v[30:31], v30
    s_mov_b64 exec, -1
    v_cmpx_gt_i16 vcc, 0, v64
    ds_read_b64 v[32:33], v32
    s_mov_b64 exec, -1
    v_cmpx_gt_i16 vcc, 0, v65
    ds_read_b64 v[34:35], v34
    s_mov_b64 exec, -1
    v_cmpx_gt_i16 vcc, 0, v66
    ds_read_b64 v[36:37], v36
    s_mov_b64 exec, -1
    v_cmpx_gt_i16 vcc, 0, v67
    ds_read_b64 v[38:39], v38
    s_mov_b64 exec, -1
    v_cmpx_gt_i16 vcc, 0, v68
    ds_read_b64 v[40:41], v40
    s_mov_b64 exec, -1
    v_cmpx_gt_i16 vcc, 0, v69
    ds_read_b64 v[42:43], v42
    s_mov_b64 exec, -1
    v_cmpx_gt_i16 vcc, 0, v70
    ds_read_b64 v[44:45], v44
    s_mov_b64 exec, -1
    v_cmpx_gt_i16 vcc, 0, v71
    ds_read_b64 v[46:47], v46
    s_mov_b64 exec, -1
    s_waitcnt lgkmcnt(15)
    v_ashrrev_i32 v122, 5, v48
    v_lshlrev_b16 v123, 2, v48
    v_lshlrev_b32 v124, 16, v0
    v_bitop3_b32 v122, v122, v113, v113 bitop3:0x0c
    v_and_b32 v125, 0xffff0000, v0
    v_lshlrev_b32 v126, 16, v1
    v_mul_f32 v122, v114, v122
    v_and_b32 v127, 0xffff0000, v1
    v_add_u32 v123, v123, v123
    v_pk_fma_f32 v[124:125], v[124:125], v[122:123], s[34:35] op_sel_hi:[1,0,1]
    v_pk_fma_f32 v[126:127], v[126:127], v[122:123], s[34:35] op_sel_hi:[1,0,1]
    v_lshl_add_u32 v124, v125, 16, v124
    v_lshl_add_u32 v125, v127, 16, v126
    s_waitcnt lgkmcnt(15)
    v_bitop3_b32 v115, v115, v116, v117 bitop3:0xfe
    v_lshl_add_u64 v[124:125], v[124:125], 0, s[36:37]
    v_cmpx_le_u32 vcc, 0x1000000, v48
    ds_add_rtn_u64 v[116:117], v123, v[124:125] offset:54272
    s_mov_b64 exec, -1
    v_ashrrev_i32 v122, 5, v49
    v_lshlrev_b16 v123, 2, v49
    v_lshlrev_b32 v124, 16, v2
    v_bitop3_b32 v122, v122, v113, v113 bitop3:0x0c
    v_and_b32 v125, 0xffff0000, v2
    v_lshlrev_b32 v126, 16, v3
    v_mul_f32 v122, v114, v122
    v_and_b32 v127, 0xffff0000, v3
    v_add_u32 v123, v123, v123
    v_pk_fma_f32 v[124:125], v[124:125], v[122:123], s[34:35] op_sel_hi:[1,0,1]
    v_pk_fma_f32 v[126:127], v[126:127], v[122:123], s[34:35] op_sel_hi:[1,0,1]
    v_lshl_add_u32 v124, v125, 16, v124
    v_lshl_add_u32 v125, v127, 16, v126
    s_waitcnt lgkmcnt(15)
    v_bitop3_b32 v115, v115, v118, v119 bitop3:0xfe
    v_lshl_add_u64 v[124:125], v[124:125], 0, s[36:37]
    v_cmpx_le_u32 vcc, 0x1000000, v49
    ds_add_rtn_u64 v[118:119], v123, v[124:125] offset:54272
    s_mov_b64 exec, -1
    v_ashrrev_i32 v122, 5, v50
    v_lshlrev_b16 v123, 2, v50
    v_lshlrev_b32 v124, 16, v4
    v_bitop3_b32 v122, v122, v113, v113 bitop3:0x0c
    v_and_b32 v125, 0xffff0000, v4
    v_lshlrev_b32 v126, 16, v5
    v_mul_f32 v122, v114, v122
    v_and_b32 v127, 0xffff0000, v5
    v_add_u32 v123, v123, v123
    v_pk_fma_f32 v[124:125], v[124:125], v[122:123], s[34:35] op_sel_hi:[1,0,1]
    v_pk_fma_f32 v[126:127], v[126:127], v[122:123], s[34:35] op_sel_hi:[1,0,1]
    v_lshl_add_u32 v124, v125, 16, v124
    v_lshl_add_u32 v125, v127, 16, v126
    s_waitcnt lgkmcnt(15)
    v_bitop3_b32 v115, v115, v120, v121 bitop3:0xfe
    v_lshl_add_u64 v[124:125], v[124:125], 0, s[36:37]
    v_cmpx_le_u32 vcc, 0x1000000, v50
    ds_add_rtn_u64 v[120:121], v123, v[124:125] offset:54272
    s_mov_b64 exec, -1
    s_waitcnt lgkmcnt(15)
    v_ashrrev_i32 v122, 5, v51
    v_lshlrev_b16 v123, 2, v51
    v_lshlrev_b32 v124, 16, v6
    v_bitop3_b32 v122, v122, v113, v113 bitop3:0x0c
    v_and_b32 v125, 0xffff0000, v6
    v_lshlrev_b32 v126, 16, v7
    v_mul_f32 v122, v114, v122
    v_and_b32 v127, 0xffff0000, v7
    v_add_u32 v123, v123, v123
    v_pk_fma_f32 v[124:125], v[124:125], v[122:123], s[34:35] op_sel_hi:[1,0,1]
    v_pk_fma_f32 v[126:127], v[126:127], v[122:123], s[34:35] op_sel_hi:[1,0,1]
    v_lshl_add_u32 v124, v125, 16, v124
    v_lshl_add_u32 v125, v127, 16, v126
    s_waitcnt lgkmcnt(2)
    v_bitop3_b32 v115, v115, v116, v117 bitop3:0xfe
    v_lshl_add_u64 v[124:125], v[124:125], 0, s[36:37]
    v_cmpx_le_u32 vcc, 0x1000000, v51
    ds_add_rtn_u64 v[116:117], v123, v[124:125] offset:54272
    s_mov_b64 exec, -1
    v_ashrrev_i32 v122, 5, v52
    v_lshlrev_b16 v123, 2, v52
    v_lshlrev_b32 v124, 16, v8
    v_bitop3_b32 v122, v122, v113, v113 bitop3:0x0c
    v_and_b32 v125, 0xffff0000, v8
    v_lshlrev_b32 v126, 16, v9
    v_mul_f32 v122, v114, v122
    v_and_b32 v127, 0xffff0000, v9
    v_add_u32 v123, v123, v123
    v_pk_fma_f32 v[124:125], v[124:125], v[122:123], s[34:35] op_sel_hi:[1,0,1]
    v_pk_fma_f32 v[126:127], v[126:127], v[122:123], s[34:35] op_sel_hi:[1,0,1]
    v_lshl_add_u32 v124, v125, 16, v124
    v_lshl_add_u32 v125, v127, 16, v126
    s_waitcnt lgkmcnt(2)
    v_bitop3_b32 v115, v115, v118, v119 bitop3:0xfe
    v_lshl_add_u64 v[124:125], v[124:125], 0, s[36:37]
    v_cmpx_le_u32 vcc, 0x1000000, v52
    ds_add_rtn_u64 v[118:119], v123, v[124:125] offset:54272
    s_mov_b64 exec, -1
    v_ashrrev_i32 v122, 5, v53
    v_lshlrev_b16 v123, 2, v53
    v_lshlrev_b32 v124, 16, v10
    v_bitop3_b32 v122, v122, v113, v113 bitop3:0x0c
    v_and_b32 v125, 0xffff0000, v10
    v_lshlrev_b32 v126, 16, v11
    v_mul_f32 v122, v114, v122
    v_and_b32 v127, 0xffff0000, v11
    v_add_u32 v123, v123, v123
    v_pk_fma_f32 v[124:125], v[124:125], v[122:123], s[34:35] op_sel_hi:[1,0,1]
    v_pk_fma_f32 v[126:127], v[126:127], v[122:123], s[34:35] op_sel_hi:[1,0,1]
    v_lshl_add_u32 v124, v125, 16, v124
    v_lshl_add_u32 v125, v127, 16, v126
    s_waitcnt lgkmcnt(2)
    v_bitop3_b32 v115, v115, v120, v121 bitop3:0xfe
    v_lshl_add_u64 v[124:125], v[124:125], 0, s[36:37]
    v_cmpx_le_u32 vcc, 0x1000000, v53
    ds_add_rtn_u64 v[120:121], v123, v[124:125] offset:54272
    s_mov_b64 exec, -1
    s_waitcnt lgkmcnt(15)
    v_ashrrev_i32 v122, 5, v54
    v_lshlrev_b16 v123, 2, v54
    v_lshlrev_b32 v124, 16, v12
    v_bitop3_b32 v122, v122, v113, v113 bitop3:0x0c
    v_and_b32 v125, 0xffff0000, v12
    v_lshlrev_b32 v126, 16, v13
    v_mul_f32 v122, v114, v122
    v_and_b32 v127, 0xffff0000, v13
    v_add_u32 v123, v123, v123
    v_pk_fma_f32 v[124:125], v[124:125], v[122:123], s[34:35] op_sel_hi:[1,0,1]
    v_pk_fma_f32 v[126:127], v[126:127], v[122:123], s[34:35] op_sel_hi:[1,0,1]
    v_lshl_add_u32 v124, v125, 16, v124
    v_lshl_add_u32 v125, v127, 16, v126
    s_waitcnt lgkmcnt(2)
    v_bitop3_b32 v115, v115, v116, v117 bitop3:0xfe
    v_lshl_add_u64 v[124:125], v[124:125], 0, s[36:37]
    v_cmpx_le_u32 vcc, 0x1000000, v54
    ds_add_rtn_u64 v[116:117], v123, v[124:125] offset:54272
    s_mov_b64 exec, -1
    v_ashrrev_i32 v122, 5, v55
    v_lshlrev_b16 v123, 2, v55
    v_lshlrev_b32 v124, 16, v14
    v_bitop3_b32 v122, v122, v113, v113 bitop3:0x0c
    v_and_b32 v125, 0xffff0000, v14
    v_lshlrev_b32 v126, 16, v15
    v_mul_f32 v122, v114, v122
    v_and_b32 v127, 0xffff0000, v15
    v_add_u32 v123, v123, v123
    v_pk_fma_f32 v[124:125], v[124:125], v[122:123], s[34:35] op_sel_hi:[1,0,1]
    v_pk_fma_f32 v[126:127], v[126:127], v[122:123], s[34:35] op_sel_hi:[1,0,1]
    v_lshl_add_u32 v124, v125, 16, v124
    v_lshl_add_u32 v125, v127, 16, v126
    s_waitcnt lgkmcnt(2)
    v_bitop3_b32 v115, v115, v118, v119 bitop3:0xfe
    v_lshl_add_u64 v[124:125], v[124:125], 0, s[36:37]
    v_cmpx_le_u32 vcc, 0x1000000, v55
    ds_add_rtn_u64 v[118:119], v123, v[124:125] offset:54272
    s_mov_b64 exec, -1
    v_ashrrev_i32 v122, 5, v56
    v_lshlrev_b16 v123, 2, v56
    v_lshlrev_b32 v124, 16, v16
    v_bitop3_b32 v122, v122, v113, v113 bitop3:0x0c
    v_and_b32 v125, 0xffff0000, v16
    v_lshlrev_b32 v126, 16, v17
    v_mul_f32 v122, v114, v122
    v_and_b32 v127, 0xffff0000, v17
    v_add_u32 v123, v123, v123
    v_pk_fma_f32 v[124:125], v[124:125], v[122:123], s[34:35] op_sel_hi:[1,0,1]
    v_pk_fma_f32 v[126:127], v[126:127], v[122:123], s[34:35] op_sel_hi:[1,0,1]
    v_lshl_add_u32 v124, v125, 16, v124
    v_lshl_add_u32 v125, v127, 16, v126
    s_waitcnt lgkmcnt(2)
    v_bitop3_b32 v115, v115, v120, v121 bitop3:0xfe
    v_lshl_add_u64 v[124:125], v[124:125], 0, s[36:37]
    v_cmpx_le_u32 vcc, 0x1000000, v56
    ds_add_rtn_u64 v[120:121], v123, v[124:125] offset:54272
    s_mov_b64 exec, -1
    s_cmp_lt_u32 s15, 8
    s_cbranch_scc1 p2_nad0
    s_waitcnt lgkmcnt(15)
    v_ashrrev_i32 v122, 5, v57
    v_lshlrev_b16 v123, 2, v57
    v_lshlrev_b32 v124, 16, v18
    v_bitop3_b32 v122, v122, v113, v113 bitop3:0x0c
    v_and_b32 v125, 0xffff0000, v18
    v_lshlrev_b32 v126, 16, v19
    v_mul_f32 v122, v114, v122
    v_and_b32 v127, 0xffff0000, v19
    v_add_u32 v123, v123, v123
    v_pk_fma_f32 v[124:125], v[124:125], v[122:123], s[34:35] op_sel_hi:[1,0,1]
    v_pk_fma_f32 v[126:127], v[126:127], v[122:123], s[34:35] op_sel_hi:[1,0,1]
    v_lshl_add_u32 v124, v125, 16, v124
    v_lshl_add_u32 v125, v127, 16, v126
    s_waitcnt lgkmcnt(2)
    v_bitop3_b32 v115, v115, v116, v117 bitop3:0xfe
    v_lshl_add_u64 v[124:125], v[124:125], 0, s[36:37]
    v_cmpx_le_u32 vcc, 0x1000000, v57
    ds_add_rtn_u64 v[116:117], v123, v[124:125] offset:54272
    s_mov_b64 exec, -1
    v_ashrrev_i32 v122, 5, v58
    v_lshlrev_b16 v123, 2, v58
    v_lshlrev_b32 v124, 16, v20
    v_bitop3_b32 v122, v122, v113, v113 bitop3:0x0c
    v_and_b32 v125, 0xffff0000, v20
    v_lshlrev_b32 v126, 16, v21
    v_mul_f32 v122, v114, v122
    v_and_b32 v127, 0xffff0000, v21
    v_add_u32 v123, v123, v123
    v_pk_fma_f32 v[124:125], v[124:125], v[122:123], s[34:35] op_sel_hi:[1,0,1]
    v_pk_fma_f32 v[126:127], v[126:127], v[122:123], s[34:35] op_sel_hi:[1,0,1]
    v_lshl_add_u32 v124, v125, 16, v124
    v_lshl_add_u32 v125, v127, 16, v126
    s_waitcnt lgkmcnt(2)
    v_bitop3_b32 v115, v115, v118, v119 bitop3:0xfe
    v_lshl_add_u64 v[124:125], v[124:125], 0, s[36:37]
    v_cmpx_le_u32 vcc, 0x1000000, v58
    ds_add_rtn_u64 v[118:119], v123, v[124:125] offset:54272
    s_mov_b64 exec, -1
    v_ashrrev_i32 v122, 5, v59
    v_lshlrev_b16 v123, 2, v59
    v_lshlrev_b32 v124, 16, v22
    v_bitop3_b32 v122, v122, v113, v113 bitop3:0x0c
    v_and_b32 v125, 0xffff0000, v22
    v_lshlrev_b32 v126, 16, v23
    v_mul_f32 v122, v114, v122
    v_and_b32 v127, 0xffff0000, v23
    v_add_u32 v123, v123, v123
    v_pk_fma_f32 v[124:125], v[124:125], v[122:123], s[34:35] op_sel_hi:[1,0,1]
    v_pk_fma_f32 v[126:127], v[126:127], v[122:123], s[34:35] op_sel_hi:[1,0,1]
    v_lshl_add_u32 v124, v125, 16, v124
    v_lshl_add_u32 v125, v127, 16, v126
    s_waitcnt lgkmcnt(2)
    v_bitop3_b32 v115, v115, v120, v121 bitop3:0xfe
    v_lshl_add_u64 v[124:125], v[124:125], 0, s[36:37]
    v_cmpx_le_u32 vcc, 0x1000000, v59
    ds_add_rtn_u64 v[120:121], v123, v[124:125] offset:54272
    s_mov_b64 exec, -1
p2_nad0:
    s_waitcnt lgkmcnt(15)
    v_ashrrev_i32 v122, 5, v60
    v_lshlrev_b16 v123, 2, v60
    v_lshlrev_b32 v124, 16, v24
    v_bitop3_b32 v122, v122, v113, v113 bitop3:0x0c
    v_and_b32 v125, 0xffff0000, v24
    v_lshlrev_b32 v126, 16, v25
    v_mul_f32 v122, v114, v122
    v_and_b32 v127, 0xffff0000, v25
    v_add_u32 v123, v123, v123
    v_pk_fma_f32 v[124:125], v[124:125], v[122:123], s[34:35] op_sel_hi:[1,0,1]
    v_pk_fma_f32 v[126:127], v[126:127], v[122:123], s[34:35] op_sel_hi:[1,0,1]
    v_lshl_add_u32 v124, v125, 16, v124
    v_lshl_add_u32 v125, v127, 16, v126
    s_waitcnt lgkmcnt(2)
    v_bitop3_b32 v115, v115, v116, v117 bitop3:0xfe
    v_lshl_add_u64 v[124:125], v[124:125], 0, s[36:37]
    v_cmpx_le_u32 vcc, 0x1000000, v60
    ds_add_rtn_u64 v[116:117], v123, v[124:125] offset:54272
    s_mov_b64 exec, -1
    v_ashrrev_i32 v122, 5, v61
    v_lshlrev_b16 v123, 2, v61
    v_lshlrev_b32 v124, 16, v26
    v_bitop3_b32 v122, v122, v113, v113 bitop3:0x0c
    v_and_b32 v125, 0xffff0000, v26
    v_lshlrev_b32 v126, 16, v27
    v_mul_f32 v122, v114, v122
    v_and_b32 v127, 0xffff0000, v27
    v_add_u32 v123, v123, v123
    v_pk_fma_f32 v[124:125], v[124:125], v[122:123], s[34:35] op_sel_hi:[1,0,1]
    v_pk_fma_f32 v[126:127], v[126:127], v[122:123], s[34:35] op_sel_hi:[1,0,1]
    v_lshl_add_u32 v124, v125, 16, v124
    v_lshl_add_u32 v125, v127, 16, v126
    s_waitcnt lgkmcnt(2)
    v_bitop3_b32 v115, v115, v118, v119 bitop3:0xfe
    v_lshl_add_u64 v[124:125], v[124:125], 0, s[36:37]
    v_cmpx_le_u32 vcc, 0x1000000, v61
    ds_add_rtn_u64 v[118:119], v123, v[124:125] offset:54272
    s_mov_b64 exec, -1
    v_ashrrev_i32 v122, 5, v62
    v_lshlrev_b16 v123, 2, v62
    v_lshlrev_b32 v124, 16, v28
    v_bitop3_b32 v122, v122, v113, v113 bitop3:0x0c
    v_and_b32 v125, 0xffff0000, v28
    v_lshlrev_b32 v126, 16, v29
    v_mul_f32 v122, v114, v122
    v_and_b32 v127, 0xffff0000, v29
    v_add_u32 v123, v123, v123
    v_pk_fma_f32 v[124:125], v[124:125], v[122:123], s[34:35] op_sel_hi:[1,0,1]
    v_pk_fma_f32 v[126:127], v[126:127], v[122:123], s[34:35] op_sel_hi:[1,0,1]
    v_lshl_add_u32 v124, v125, 16, v124
    v_lshl_add_u32 v125, v127, 16, v126
    s_waitcnt lgkmcnt(2)
    v_bitop3_b32 v115, v115, v120, v121 bitop3:0xfe
    v_lshl_add_u64 v[124:125], v[124:125], 0, s[36:37]
    v_cmpx_le_u32 vcc, 0x1000000, v62
    ds_add_rtn_u64 v[120:121], v123, v[124:125] offset:54272
    s_mov_b64 exec, -1
    s_waitcnt lgkmcnt(15)
    v_ashrrev_i32 v122, 5, v63
    v_lshlrev_b16 v123, 2, v63
    v_lshlrev_b32 v124, 16, v30
    v_bitop3_b32 v122, v122, v113, v113 bitop3:0x0c
    v_and_b32 v125, 0xffff0000, v30
    v_lshlrev_b32 v126, 16, v31
    v_mul_f32 v122, v114, v122
    v_and_b32 v127, 0xffff0000, v31
    v_add_u32 v123, v123, v123
    v_pk_fma_f32 v[124:125], v[124:125], v[122:123], s[34:35] op_sel_hi:[1,0,1]
    v_pk_fma_f32 v[126:127], v[126:127], v[122:123], s[34:35] op_sel_hi:[1,0,1]
    v_lshl_add_u32 v124, v125, 16, v124
    v_lshl_add_u32 v125, v127, 16, v126
    s_waitcnt lgkmcnt(2)
    v_bitop3_b32 v115, v115, v116, v117 bitop3:0xfe
    v_lshl_add_u64 v[124:125], v[124:125], 0, s[36:37]
    v_cmpx_le_u32 vcc, 0x1000000, v63
    ds_add_rtn_u64 v[116:117], v123, v[124:125] offset:54272
    s_mov_b64 exec, -1
    v_ashrrev_i32 v122, 5, v64
    v_lshlrev_b16 v123, 2, v64
    v_lshlrev_b32 v124, 16, v32
    v_bitop3_b32 v122, v122, v113, v113 bitop3:0x0c
    v_and_b32 v125, 0xffff0000, v32
    v_lshlrev_b32 v126, 16, v33
    v_mul_f32 v122, v114, v122
    v_and_b32 v127, 0xffff0000, v33
    v_add_u32 v123, v123, v123
    v_pk_fma_f32 v[124:125], v[124:125], v[122:123], s[34:35] op_sel_hi:[1,0,1]
    v_pk_fma_f32 v[126:127], v[126:127], v[122:123], s[34:35] op_sel_hi:[1,0,1]
    v_lshl_add_u32 v124, v125, 16, v124
    v_lshl_add_u32 v125, v127, 16, v126
    s_waitcnt lgkmcnt(2)
    v_bitop3_b32 v115, v115, v118, v119 bitop3:0xfe
    v_lshl_add_u64 v[124:125], v[124:125], 0, s[36:37]
    v_cmpx_le_u32 vcc, 0x1000000, v64
    ds_add_rtn_u64 v[118:119], v123, v[124:125] offset:54272
    s_mov_b64 exec, -1
    v_ashrrev_i32 v122, 5, v65
    v_lshlrev_b16 v123, 2, v65
    v_lshlrev_b32 v124, 16, v34
    v_bitop3_b32 v122, v122, v113, v113 bitop3:0x0c
    v_and_b32 v125, 0xffff0000, v34
    v_lshlrev_b32 v126, 16, v35
    v_mul_f32 v122, v114, v122
    v_and_b32 v127, 0xffff0000, v35
    v_add_u32 v123, v123, v123
    v_pk_fma_f32 v[124:125], v[124:125], v[122:123], s[34:35] op_sel_hi:[1,0,1]
    v_pk_fma_f32 v[126:127], v[126:127], v[122:123], s[34:35] op_sel_hi:[1,0,1]
    v_lshl_add_u32 v124, v125, 16, v124
    v_lshl_add_u32 v125, v127, 16, v126
    s_waitcnt lgkmcnt(2)
    v_bitop3_b32 v115, v115, v120, v121 bitop3:0xfe
    v_lshl_add_u64 v[124:125], v[124:125], 0, s[36:37]
    v_cmpx_le_u32 vcc, 0x1000000, v65
    ds_add_rtn_u64 v[120:121], v123, v[124:125] offset:54272
    s_mov_b64 exec, -1
    s_waitcnt lgkmcnt(15)
    v_ashrrev_i32 v122, 5, v66
    v_lshlrev_b16 v123, 2, v66
    v_lshlrev_b32 v124, 16, v36
    v_bitop3_b32 v122, v122, v113, v113 bitop3:0x0c
    v_and_b32 v125, 0xffff0000, v36
    v_lshlrev_b32 v126, 16, v37
    v_mul_f32 v122, v114, v122
    v_and_b32 v127, 0xffff0000, v37
    v_add_u32 v123, v123, v123
    v_pk_fma_f32 v[124:125], v[124:125], v[122:123], s[34:35] op_sel_hi:[1,0,1]
    v_pk_fma_f32 v[126:127], v[126:127], v[122:123], s[34:35] op_sel_hi:[1,0,1]
    v_lshl_add_u32 v124, v125, 16, v124
    v_lshl_add_u32 v125, v127, 16, v126
    s_waitcnt lgkmcnt(2)
    v_bitop3_b32 v115, v115, v116, v117 bitop3:0xfe
    v_lshl_add_u64 v[124:125], v[124:125], 0, s[36:37]
    v_cmpx_le_u32 vcc, 0x1000000, v66
    ds_add_rtn_u64 v[116:117], v123, v[124:125] offset:54272
    s_mov_b64 exec, -1
    v_ashrrev_i32 v122, 5, v67
    v_lshlrev_b16 v123, 2, v67
    v_lshlrev_b32 v124, 16, v38
    v_bitop3_b32 v122, v122, v113, v113 bitop3:0x0c
    v_and_b32 v125, 0xffff0000, v38
    v_lshlrev_b32 v126, 16, v39
    v_mul_f32 v122, v114, v122
    v_and_b32 v127, 0xffff0000, v39
    v_add_u32 v123, v123, v123
    v_pk_fma_f32 v[124:125], v[124:125], v[122:123], s[34:35] op_sel_hi:[1,0,1]
    v_pk_fma_f32 v[126:127], v[126:127], v[122:123], s[34:35] op_sel_hi:[1,0,1]
    v_lshl_add_u32 v124, v125, 16, v124
    v_lshl_add_u32 v125, v127, 16, v126
    s_waitcnt lgkmcnt(2)
    v_bitop3_b32 v115, v115, v118, v119 bitop3:0xfe
    v_lshl_add_u64 v[124:125], v[124:125], 0, s[36:37]
    v_cmpx_le_u32 vcc, 0x1000000, v67
    ds_add_rtn_u64 v[118:119], v123, v[124:125] offset:54272
    s_mov_b64 exec, -1
    v_ashrrev_i32 v122, 5, v68
    v_lshlrev_b16 v123, 2, v68
    v_lshlrev_b32 v124, 16, v40
    v_bitop3_b32 v122, v122, v113, v113 bitop3:0x0c
    v_and_b32 v125, 0xffff0000, v40
    v_lshlrev_b32 v126, 16, v41
    v_mul_f32 v122, v114, v122
    v_and_b32 v127, 0xffff0000, v41
    v_add_u32 v123, v123, v123
    v_pk_fma_f32 v[124:125], v[124:125], v[122:123], s[34:35] op_sel_hi:[1,0,1]
    v_pk_fma_f32 v[126:127], v[126:127], v[122:123], s[34:35] op_sel_hi:[1,0,1]
    v_lshl_add_u32 v124, v125, 16, v124
    v_lshl_add_u32 v125, v127, 16, v126
    s_waitcnt lgkmcnt(2)
    v_bitop3_b32 v115, v115, v120, v121 bitop3:0xfe
    v_lshl_add_u64 v[124:125], v[124:125], 0, s[36:37]
    v_cmpx_le_u32 vcc, 0x1000000, v68
    ds_add_rtn_u64 v[120:121], v123, v[124:125] offset:54272
    s_mov_b64 exec, -1
    s_waitcnt lgkmcnt(15)
    v_ashrrev_i32 v122, 5, v69
    v_lshlrev_b16 v123, 2, v69
    v_lshlrev_b32 v124, 16, v42
    v_bitop3_b32 v122, v122, v113, v113 bitop3:0x0c
    v_and_b32 v125, 0xffff0000, v42
    v_lshlrev_b32 v126, 16, v43
    v_mul_f32 v122, v114, v122
    v_and_b32 v127, 0xffff0000, v43
    v_add_u32 v123, v123, v123
    v_pk_fma_f32 v[124:125], v[124:125], v[122:123], s[34:35] op_sel_hi:[1,0,1]
    v_pk_fma_f32 v[126:127], v[126:127], v[122:123], s[34:35] op_sel_hi:[1,0,1]
    v_lshl_add_u32 v124, v125, 16, v124
    v_lshl_add_u32 v125, v127, 16, v126
    s_waitcnt lgkmcnt(2)
    v_bitop3_b32 v115, v115, v116, v117 bitop3:0xfe
    v_lshl_add_u64 v[124:125], v[124:125], 0, s[36:37]
    v_cmpx_le_u32 vcc, 0x1000000, v69
    ds_add_rtn_u64 v[116:117], v123, v[124:125] offset:54272
    s_mov_b64 exec, -1
    v_ashrrev_i32 v122, 5, v70
    v_lshlrev_b16 v123, 2, v70
    v_lshlrev_b32 v124, 16, v44
    v_bitop3_b32 v122, v122, v113, v113 bitop3:0x0c
    v_and_b32 v125, 0xffff0000, v44
    v_lshlrev_b32 v126, 16, v45
    v_mul_f32 v122, v114, v122
    v_and_b32 v127, 0xffff0000, v45
    v_add_u32 v123, v123, v123
    v_pk_fma_f32 v[124:125], v[124:125], v[122:123], s[34:35] op_sel_hi:[1,0,1]
    v_pk_fma_f32 v[126:127], v[126:127], v[122:123], s[34:35] op_sel_hi:[1,0,1]
    v_lshl_add_u32 v124, v125, 16, v124
    v_lshl_add_u32 v125, v127, 16, v126
    s_waitcnt lgkmcnt(2)
    v_bitop3_b32 v115, v115, v118, v119 bitop3:0xfe
    v_lshl_add_u64 v[124:125], v[124:125], 0, s[36:37]
    v_cmpx_le_u32 vcc, 0x1000000, v70
    ds_add_rtn_u64 v[118:119], v123, v[124:125] offset:54272
    s_mov_b64 exec, -1
    v_ashrrev_i32 v122, 5, v71
    v_lshlrev_b16 v123, 2, v71
    v_lshlrev_b32 v124, 16, v46
    v_bitop3_b32 v122, v122, v113, v113 bitop3:0x0c
    v_and_b32 v125, 0xffff0000, v46
    v_lshlrev_b32 v126, 16, v47
    v_mul_f32 v122, v114, v122
    v_and_b32 v127, 0xffff0000, v47
    v_add_u32 v123, v123, v123
    v_pk_fma_f32 v[124:125], v[124:125], v[122:123], s[34:35] op_sel_hi:[1,0,1]
    v_pk_fma_f32 v[126:127], v[126:127], v[122:123], s[34:35] op_sel_hi:[1,0,1]
    v_lshl_add_u32 v124, v125, 16, v124
    v_lshl_add_u32 v125, v127, 16, v126
    s_waitcnt lgkmcnt(2)
    v_bitop3_b32 v115, v115, v120, v121 bitop3:0xfe
    v_lshl_add_u64 v[124:125], v[124:125], 0, s[36:37]
    v_cmpx_le_u32 vcc, 0x1000000, v71
    ds_add_rtn_u64 v[120:121], v123, v[124:125] offset:54272
    s_mov_b64 exec, -1
    s_branch p2_fin
p2_topf:
    s_cmp_eq_u32 s60, 10
    s_cbranch_scc1 p2_drain1
    s_setprio 3
    v_cmpx_gt_i16 vcc, 0, v48
    ds_read_b64 v[0:1], v0
    s_mov_b64 exec, -1
    v_cmpx_gt_i16 vcc, 0, v49
    ds_read_b64 v[2:3], v2
    s_mov_b64 exec, -1
    v_cmpx_gt_i16 vcc, 0, v50
    ds_read_b64 v[4:5], v4
    s_mov_b64 exec, -1
    v_cmpx_gt_i16 vcc, 0, v51
    ds_read_b64 v[6:7], v6
    s_mov_b64 exec, -1
    v_cmpx_gt_i16 vcc, 0, v52
    ds_read_b64 v[8:9], v8
    s_mov_b64 exec, -1
    v_cmpx_gt_i16 vcc, 0, v53
    ds_read_b64 v[10:11], v10
    s_mov_b64 exec, -1
    v_cmpx_gt_i16 vcc, 0, v54
    ds_read_b64 v[12:13], v12
    s_mov_b64 exec, -1
    v_cmpx_gt_i16 vcc, 0, v55
    ds_read_b64 v[14:15], v14
    s_mov_b64 exec, -1
    v_cmpx_gt_i16 vcc, 0, v56
    ds_read_b64 v[16:17], v16
    s_mov_b64 exec, -1
    s_cmp_lt_u32 s15, 8
    s_cbranch_scc1 p2_g1r23
    v_cmpx_gt_i16 vcc, 0, v57
    ds_read_b64 v[18:19], v18
    s_mov_b64 exec, -1
    v_cmpx_gt_i16 vcc, 0, v58
    ds_read_b64 v[20:21], v20
    s_mov_b64 exec, -1
    v_cmpx_gt_i16 vcc, 0, v59
    ds_read_b64 v[22:23], v22
    s_mov_b64 exec, -1
p2_g1r23:
    s_cmp_ge_u32 s10, 9
    s_cbranch_scc1 p2_nm1m0a
    v_lshrrev_b32 v84, 1, v112
    s_add_u32 s44, s20, s42
    buffer_load_dwordx2 v[84:85], v84, s[4:7], s44 offen
p2_nm1m0a:
    buffer_load_dwordx4 v[72:75], v112, s[4:7], s20 offen offset:0
    buffer_load_dwordx4 v[76:79], v112, s[4:7], s20 offen offset:1024
    buffer_load_dwordx4 v[80:83], v112, s[4:7], s20 offen offset:2048
    v_cmpx_gt_i16 vcc, 0, v60
    ds_read_b64 v[24:25], v24
    s_mov_b64 exec, -1
    v_cmpx_gt_i16 vcc, 0, v61
    ds_read_b64 v[26:27], v26
    s_mov_b64 exec, -1
    v_cmpx_gt_i16 vcc, 0, v62
    ds_read_b64 v[28:29], v28
    s_mov_b64 exec, -1
    v_cmpx_gt_i16 vcc, 0, v63
    ds_read_b64 v[30:31], v30
    s_mov_b64 exec, -1
    v_cmpx_gt_i16 vcc, 0, v64
    ds_read_b64 v[32:33], v32
    s_mov_b64 exec, -1
    v_cmpx_gt_i16 vcc, 0, v65
    ds_read_b64 v[34:35], v34
    s_mov_b64 exec, -1
    v_cmpx_gt_i16 vcc, 0, v66
    ds_read_b64 v[36:37], v36
    s_mov_b64 exec, -1
    v_cmpx_gt_i16 vcc, 0, v67
    ds_read_b64 v[38:39], v38
    s_mov_b64 exec, -1
    v_cmpx_gt_i16 vcc, 0, v68
    ds_read_b64 v[40:41], v40
    s_mov_b64 exec, -1
    v_cmpx_gt_i16 vcc, 0, v69
    ds_read_b64 v[42:43], v42
    s_mov_b64 exec, -1
    v_cmpx_gt_i16 vcc, 0, v70
    ds_read_b64 v[44:45], v44
    s_mov_b64 exec, -1
    v_cmpx_gt_i16 vcc, 0, v71
    ds_read_b64 v[46:47], v46
    s_mov_b64 exec, -1
    s_setprio 2
    s_waitcnt lgkmcnt(15)
    v_ashrrev_i32 v122, 5, v48
    v_lshlrev_b16 v123, 2, v48
    v_cndmask_b32 v126, v0, v1, s[66:67]
    v_bitop3_b32 v122, v122, v113, v113 bitop3:0x0c
    v_lshlrev_b32 v124, 16, v126
    v_mul_f32 v122, v114, v122
    v_and_b32 v125, 0xffff0000, v126
    v_add_u32 v123, v123, v123
    v_mul_f32 v124, v122, v124
    v_mul_f32 v125, v122, v125
    v_cmpx_le_u32 vcc, 0x1000000, v48
    ds_add_f32 v123, v124 offset:54272
    ds_add_f32 v123, v125 offset:54276
    s_mov_b64 exec, -1
    v_ashrrev_i32 v122, 5, v49
    v_lshlrev_b16 v123, 2, v49
    v_cndmask_b32 v126, v2, v3, s[66:67]
    v_bitop3_b32 v122, v122, v113, v113 bitop3:0x0c
    v_lshlrev_b32 v124, 16, v126
    v_mul_f32 v122, v114, v122
    v_and_b32 v125, 0xffff0000, v126
    v_add_u32 v123, v123, v123
    v_mul_f32 v124, v122, v124
    v_mul_f32 v125, v122, v125
    v_cmpx_le_u32 vcc, 0x1000000, v49
    ds_add_f32 v123, v124 offset:54272
    ds_add_f32 v123, v125 offset:54276
    s_mov_b64 exec, -1
    v_ashrrev_i32 v122, 5, v50
    v_lshlrev_b16 v123, 2, v50
    v_cndmask_b32 v126, v4, v5, s[66:67]
    v_bitop3_b32 v122, v122, v113, v113 bitop3:0x0c
    v_lshlrev_b32 v124, 16, v126
    v_mul_f32 v122, v114, v122
    v_and_b32 v125, 0xffff0000, v126
    v_add_u32 v123, v123, v123
    v_mul_f32 v124, v122, v124
    v_mul_f32 v125, v122, v125
    v_cmpx_le_u32 vcc, 0x1000000, v50
    ds_add_f32 v123, v124 offset:54272
    ds_add_f32 v123, v125 offset:54276
    s_mov_b64 exec, -1
    v_bfe_u32 v0, v102, 14, 4
    v_lshrrev_b32 v1, 18, v102
    v_and_b32 v102, 0x3fff, v102
    v_mad_u32_u24 v0, v0, s63, v1
    v_mad_u32_u24 v102, v0, s65, v102
    buffer_load_dwordx4 v[0:3], v102, s[68:71], 0 offen
    s_setprio 1
    s_waitcnt lgkmcnt(15)
    v_ashrrev_i32 v122, 5, v51
    v_lshlrev_b16 v123, 2, v51
    v_cndmask_b32 v126, v6, v7, s[66:67]
    v_bitop3_b32 v122, v122, v113, v113 bitop3:0x0c
    v_lshlrev_b32 v124, 16, v126
    v_mul_f32 v122, v114, v122
    v_and_b32 v125, 0xffff0000, v126
    v_add_u32 v123, v123, v123
    v_mul_f32 v124, v122, v124
    v_mul_f32 v125, v122, v125
    v_cmpx_le_u32 vcc, 0x1000000, v51
    ds_add_f32 v123, v124 offset:54272
    ds_add_f32 v123, v125 offset:54276
    s_mov_b64 exec, -1
    v_ashrrev_i32 v122, 5, v52
    v_lshlrev_b16 v123, 2, v52
    v_cndmask_b32 v126, v8, v9, s[66:67]
    v_bitop3_b32 v122, v122, v113, v113 bitop3:0x0c
    v_lshlrev_b32 v124, 16, v126
    v_mul_f32 v122, v114, v122
    v_and_b32 v125, 0xffff0000, v126
    v_add_u32 v123, v123, v123
    v_mul_f32 v124, v122, v124
    v_mul_f32 v125, v122, v125
    v_cmpx_le_u32 vcc, 0x1000000, v52
    ds_add_f32 v123, v124 offset:54272
    ds_add_f32 v123, v125 offset:54276
    s_mov_b64 exec, -1
    v_ashrrev_i32 v122, 5, v53
    v_lshlrev_b16 v123, 2, v53
    v_cndmask_b32 v126, v10, v11, s[66:67]
    v_bitop3_b32 v122, v122, v113, v113 bitop3:0x0c
    v_lshlrev_b32 v124, 16, v126
    v_mul_f32 v122, v114, v122
    v_and_b32 v125, 0xffff0000, v126
    v_add_u32 v123, v123, v123
    v_mul_f32 v124, v122, v124
    v_mul_f32 v125, v122, v125
    v_cmpx_le_u32 vcc, 0x1000000, v53
    ds_add_f32 v123, v124 offset:54272
    ds_add_f32 v123, v125 offset:54276
    s_mov_b64 exec, -1
    v_bfe_u32 v6, v103, 14, 4
    v_lshrrev_b32 v7, 18, v103
    v_and_b32 v103, 0x3fff, v103
    v_mad_u32_u24 v6, v6, s63, v7
    v_mad_u32_u24 v103, v6, s65, v103
    buffer_load_dwordx4 v[6:9], v103, s[68:71], 0 offen
    s_waitcnt lgkmcnt(12)
    s_barrier
    s_setprio 3
    s_waitcnt vmcnt(5)
    s_mov_b32 m0, s23
    v_mov_b32 v53, 0
    s_movk_i32 s44, 512
    v_sub_u32_sdwa v4, v111, v110 dst_sel:DWORD dst_unused:UNUSED_PAD src0_sel:WORD_0 src1_sel:WORD_0
    v_sub_u32_sdwa v5, v111, v110 dst_sel:DWORD dst_unused:UNUSED_PAD src0_sel:WORD_1 src1_sel:WORD_1
    v_med3_i32 v4, v4, 0, s44
    v_med3_i32 v5, v5, 0, s44
    v_add_u32 v48, v4, v5
    ds_write_addtid_b32 v53 offset:0
    ds_write_addtid_b32 v53 offset:256
    ds_write_addtid_b32 v53 offset:512
    ds_write_addtid_b32 v53 offset:768
    ds_write_addtid_b32 v53 offset:1024
    ds_write_addtid_b32 v53 offset:1280
    ds_write_addtid_b32 v53 offset:1536
    ds_write_addtid_b32 v53 offset:1792
    v_bfe_i32 v53, v112, 6, 1
    v_lshrrev_b32 v49, 6, v112
    v_bitop3_b32 v53, v53, 15, s10 bitop3:0x6a
    v_lshl_or_b32 v49, v49, 4, v53
    v_and_b32 v53, 0x30, v112
    v_lshl_or_b32 v53, v49, 6, v53
    v_lshlrev_b32 v53, 15, v53
    s_nop 1
    v_add_u32_dpp v48, v48, v48 row_shr:1 row_mask:0xf bank_mask:0xf bound_ctrl:0
    s_nop 1
    v_add_u32_dpp v48, v48, v48 row_shr:2 row_mask:0xf bank_mask:0xf bound_ctrl:0
    s_nop 1
    v_add_u32_dpp v48, v48, v48 row_shr:4 row_mask:0xf bank_mask:0xf bound_ctrl:0
    s_nop 1
    v_add_u32_dpp v48, v48, v48 row_shr:8 row_mask:0xf bank_mask:0xf bound_ctrl:0
    s_nop 1
    v_add_u32_dpp v48, v48, v48 row_bcast:15 row_mask:0xa bank_mask:0xf
    s_nop 1
    v_add_u32_dpp v48, v48, v48 row_bcast:31 row_mask:0xc bank_mask:0xf
    s_nop 1
    s_nop 0
    v_readlane_b32 s38, v48, 63
    v_sub_u32 v50, v48, v5
    v_sub_u32 v49, v50, v4
    v_writelane_b32 v5, 1, 63
    v_sub_u32 v10, 512, v49
    v_mad_u32_u16 v51, v110, 16, v53
    v_lshl_add_u32 v51, v10, 4, v51
    v_med3_i32 v10, v10, 0, v4
    v_lshl_add_u32 v49, v49, 2, s23
    v_sub_u32 v11, 512, v50
    v_mad_u32_u16 v52, v110, 16, v53 op_sel:[1,0,0,0]
    v_add_u32 v52, 262144, v52
    s_mov_b32 s44, 0x1fffc000
    v_writelane_b32 v52, s44, 63
    v_lshl_add_u32 v52, v11, 4, v52
    v_med3_i32 v11, v11, 0, v5
    v_lshl_add_u32 v50, v50, 2, s23
    v_lshl_add_u32 v48, v11, 16, v10
    v_add_u32 v110, v110, v48
    s_min_u32 s17, s38, 512
    s_add_u32 s17, s17, 63
    s_lshr_b32 s17, s17, 6
    v_cmpx_lt_i32 vcc, 0, v10
    ds_write_b32 v49, v51
    s_mov_b64 exec, -1
    v_cmpx_lt_i32 vcc, 0, v11
    ds_write_b32 v50, v52
    s_mov_b64 exec, -1
    s_cmp_lt_u32 s38, 512
    s_cbranch_scc1 p2_nomore1x
    v_cmp_lt_u32_sdwa s[44:45], v110, v111 src0_sel:WORD_0 src1_sel:WORD_0
    v_cmp_lt_u32_sdwa s[46:47], v110, v111 src0_sel:WORD_1 src1_sel:WORD_1
    s_nop 0
    s_or_b64 s[44:45], s[44:45], s[46:47]
    s_cbranch_scc0 p2_nomore1x
    v_mov_b32 v49, s19
    v_mov_b32 v50, 1
    ds_write_b32 v49, v50 offset:53760
p2_nomore1x:
    s_setprio 2
    s_waitcnt lgkmcnt(15)
    v_ashrrev_i32 v122, 5, v54
    v_lshlrev_b16 v123, 2, v54
    v_cndmask_b32 v126, v12, v13, s[66:67]
    v_bitop3_b32 v122, v122, v113, v113 bitop3:0x0c
    v_lshlrev_b32 v124, 16, v126
    v_mul_f32 v122, v114, v122
    v_and_b32 v125, 0xffff0000, v126
    v_add_u32 v123, v123, v123
    v_mul_f32 v124, v122, v124
    v_mul_f32 v125, v122, v125
    v_cmpx_le_u32 vcc, 0x1000000, v54
    ds_add_f32 v123, v124 offset:54272
    ds_add_f32 v123, v125 offset:54276
    s_mov_b64 exec, -1
    v_ashrrev_i32 v122, 5, v55
    v_lshlrev_b16 v123, 2, v55
    v_cndmask_b32 v126, v14, v15, s[66:67]
    v_bitop3_b32 v122, v122, v113, v113 bitop3:0x0c
    v_lshlrev_b32 v124, 16, v126
    v_mul_f32 v122, v114, v122
    v_and_b32 v125, 0xffff0000, v126
    v_add_u32 v123, v123, v123
    v_mul_f32 v124, v122, v124
    v_mul_f32 v125, v122, v125
    v_cmpx_le_u32 vcc, 0x1000000, v55
    ds_add_f32 v123, v124 offset:54272
    ds_add_f32 v123, v125 offset:54276
    s_mov_b64 exec, -1
    v_ashrrev_i32 v122, 5, v56
    v_lshlrev_b16 v123, 2, v56
    v_cndmask_b32 v126, v16, v17, s[66:67]
    v_bitop3_b32 v122, v122, v113, v113 bitop3:0x0c
    v_lshlrev_b32 v124, 16, v126
    v_mul_f32 v122, v114, v122
    v_and_b32 v125, 0xffff0000, v126
    v_add_u32 v123, v123, v123
    v_mul_f32 v124, v122, v124
    v_mul_f32 v125, v122, v125
    v_cmpx_le_u32 vcc, 0x1000000, v56
    ds_add_f32 v123, v124 offset:54272
    ds_add_f32 v123, v125 offset:54276
    s_mov_b64 exec, -1
    v_bfe_u32 v12, v104, 14, 4
    v_lshrrev_b32 v13, 18, v104
    v_and_b32 v104, 0x3fff, v104
    v_mad_u32_u24 v12, v12, s63, v13
    v_mad_u32_u24 v104, v12, s65, v104
    buffer_load_dwordx4 v[12:15], v104, s[68:71], 0 offen
    s_cmp_lt_u32 s15, 8
    s_cbranch_scc1 p2_na1a3
    s_waitcnt lgkmcnt(15)
    v_ashrrev_i32 v122, 5, v57
    v_lshlrev_b16 v123, 2, v57
    v_cndmask_b32 v126, v18, v19, s[66:67]
    v_bitop3_b32 v122, v122, v113, v113 bitop3:0x0c
    v_lshlrev_b32 v124, 16, v126
    v_mul_f32 v122, v114, v122
    v_and_b32 v125, 0xffff0000, v126
    v_add_u32 v123, v123, v123
    v_mul_f32 v124, v122, v124
    v_mul_f32 v125, v122, v125
    v_cmpx_le_u32 vcc, 0x1000000, v57
    ds_add_f32 v123, v124 offset:54272
    ds_add_f32 v123, v125 offset:54276
    s_mov_b64 exec, -1
    v_ashrrev_i32 v122, 5, v58
    v_lshlrev_b16 v123, 2, v58
    v_cndmask_b32 v126, v20, v21, s[66:67]
    v_bitop3_b32 v122, v122, v113, v113 bitop3:0x0c
    v_lshlrev_b32 v124, 16, v126
    v_mul_f32 v122, v114, v122
    v_and_b32 v125, 0xffff0000, v126
    v_add_u32 v123, v123, v123
    v_mul_f32 v124, v122, v124
    v_mul_f32 v125, v122, v125
    v_cmpx_le_u32 vcc, 0x1000000, v58
    ds_add_f32 v123, v124 offset:54272
    ds_add_f32 v123, v125 offset:54276
    s_mov_b64 exec, -1
    v_ashrrev_i32 v122, 5, v59
    v_lshlrev_b16 v123, 2, v59
    v_cndmask_b32 v126, v22, v23, s[66:67]
    v_bitop3_b32 v122, v122, v113, v113 bitop3:0x0c
    v_lshlrev_b32 v124, 16, v126
    v_mul_f32 v122, v114, v122
    v_and_b32 v125, 0xffff0000, v126
    v_add_u32 v123, v123, v123
    v_mul_f32 v124, v122, v124
    v_mul_f32 v125, v122, v125
    v_cmpx_le_u32 vcc, 0x1000000, v59
    ds_add_f32 v123, v124 offset:54272
    ds_add_f32 v123, v125 offset:54276
    s_mov_b64 exec, -1
p2_na1a3:
    v_bfe_u32 v18, v105, 14, 4
    v_lshrrev_b32 v19, 18, v105
    v_and_b32 v105, 0x3fff, v105
    v_mad_u32_u24 v18, v18, s63, v19
    v_mad_u32_u24 v105, v18, s65, v105
    buffer_load_dwordx4 v[18:21], v105, s[68:71], 0 offen
    s_mov_b32 m0, s23
    s_nop 0
    ds_read_addtid_b32 v102 offset:1024
    ds_read_addtid_b32 v103 offset:1280
    ds_read_addtid_b32 v104 offset:1536
    ds_read_addtid_b32 v105 offset:1792
    ds_read_addtid_b32 v106 offset:0
    ds_read_addtid_b32 v107 offset:256
    ds_read_addtid_b32 v108 offset:512
    ds_read_addtid_b32 v109 offset:768
    s_waitcnt vmcnt(4)
    s_mov_b32 m0, s24
    s_cmp_ge_u32 s10, 9
    s_cbranch_scc1 p2_st1s0
    ds_write_addtid_b32 v84 offset:49152
    ds_write_addtid_b32 v85 offset:49408
p2_st1s0:
    s_mov_b32 m0, s23
    s_add_u32 s20, s20, 53760
    ds_write_addtid_b32 v72 offset:0
    ds_write_addtid_b32 v73 offset:256
    ds_write_addtid_b32 v74 offset:512
    ds_write_addtid_b32 v75 offset:768
    ds_write_addtid_b32 v76 offset:1024
    ds_write_addtid_b32 v77 offset:1280
    ds_write_addtid_b32 v78 offset:1536
    ds_write_addtid_b32 v79 offset:1792
    ds_write_addtid_b32 v80 offset:2048
    ds_write_addtid_b32 v81 offset:2304
    ds_write_addtid_b32 v82 offset:2560
    ds_write_addtid_b32 v83 offset:2816
    s_setprio 1
    s_waitcnt lgkmcnt(15)
    v_ashrrev_i32 v122, 5, v60
    v_lshlrev_b16 v123, 2, v60
    v_cndmask_b32 v126, v24, v25, s[66:67]
    v_bitop3_b32 v122, v122, v113, v113 bitop3:0x0c
    v_lshlrev_b32 v124, 16, v126
    v_mul_f32 v122, v114, v122
    v_and_b32 v125, 0xffff0000, v126
    v_add_u32 v123, v123, v123
    v_mul_f32 v124, v122, v124
    v_mul_f32 v125, v122, v125
    v_cmpx_le_u32 vcc, 0x1000000, v60
    ds_add_f32 v123, v124 offset:54272
    ds_add_f32 v123, v125 offset:54276
    s_mov_b64 exec, -1
    v_ashrrev_i32 v122, 5, v61
    v_lshlrev_b16 v123, 2, v61
    v_cndmask_b32 v126, v26, v27, s[66:67]
    v_bitop3_b32 v122, v122, v113, v113 bitop3:0x0c
    v_lshlrev_b32 v124, 16, v126
    v_mul_f32 v122, v114, v122
    v_and_b32 v125, 0xffff0000, v126
    v_add_u32 v123, v123, v123
    v_mul_f32 v124, v122, v124
    v_mul_f32 v125, v122, v125
    v_cmpx_le_u32 vcc, 0x1000000, v61
    ds_add_f32 v123, v124 offset:54272
    ds_add_f32 v123, v125 offset:54276
    s_mov_b64 exec, -1
    v_ashrrev_i32 v122, 5, v62
    v_lshlrev_b16 v123, 2, v62
    v_cndmask_b32 v126, v28, v29, s[66:67]
    v_bitop3_b32 v122, v122, v113, v113 bitop3:0x0c
    v_lshlrev_b32 v124, 16, v126
    v_mul_f32 v122, v114, v122
    v_and_b32 v125, 0xffff0000, v126
    v_add_u32 v123, v123, v123
    v_mul_f32 v124, v122, v124
    v_mul_f32 v125, v122, v125
    v_cmpx_le_u32 vcc, 0x1000000, v62
    ds_add_f32 v123, v124 offset:54272
    ds_add_f32 v123, v125 offset:54276
    s_mov_b64 exec, -1
    s_waitcnt vmcnt(16)
    v_perm_b32 v60, v89, v86, s31
    v_perm_b32 v61, v89, v87, s32
    v_perm_b32 v62, v89, v88, s33
    v_lshlrev_b16 v28, 3, v88
    v_lshlrev_b16 v26, 3, v87
    v_lshlrev_b16 v24, 3, v86
    s_waitcnt lgkmcnt(15)
    s_nop 2
    s_nop 1
    v_max_u32_dpp v106, v106, v106 row_shr:1 row_mask:0xf bank_mask:0xf bound_ctrl:0
    v_max_u32_dpp v107, v107, v107 row_shr:1 row_mask:0xf bank_mask:0xf bound_ctrl:0
    s_nop 0
    v_max_u32_dpp v106, v106, v106 row_shr:2 row_mask:0xf bank_mask:0xf bound_ctrl:0
    v_max_u32_dpp v107, v107, v107 row_shr:2 row_mask:0xf bank_mask:0xf bound_ctrl:0
    s_nop 0
    v_max_u32_dpp v106, v106, v106 row_shr:4 row_mask:0xf bank_mask:0xf bound_ctrl:0
    v_max_u32_dpp v107, v107, v107 row_shr:4 row_mask:0xf bank_mask:0xf bound_ctrl:0
    s_nop 0
    v_max_u32_dpp v106, v106, v106 row_shr:8 row_mask:0xf bank_mask:0xf bound_ctrl:0
    v_max_u32_dpp v107, v107, v107 row_shr:8 row_mask:0xf bank_mask:0xf bound_ctrl:0
    s_nop 0
    v_max_u32_dpp v106, v106, v106 row_bcast:15 row_mask:0xa bank_mask:0xf
    v_max_u32_dpp v107, v107, v107 row_bcast:15 row_mask:0xa bank_mask:0xf
    s_nop 0
    v_max_u32_dpp v106, v106, v106 row_bcast:31 row_mask:0xc bank_mask:0xf
    v_max_u32_dpp v107, v107, v107 row_bcast:31 row_mask:0xc bank_mask:0xf
    s_nop 0
    s_nop 0
    v_readlane_b32 s41, v106, 63
    v_add_u32 v106, v106, v112
    v_add_u32 v106, 4294959104, v106
    v_max_u32 v107, s41, v107
    s_nop 0
    v_readlane_b32 s41, v107, 63
    v_add_u32 v107, v107, v112
    v_add_u32 v107, 4294960128, v107
    v_bfe_u32 v86, v106, 14, 4
    v_lshrrev_b32 v87, 18, v106
    v_and_b32 v106, 0x3fff, v106
    v_mad_u32_u24 v86, v86, s63, v87
    v_mad_u32_u24 v106, v86, s65, v106
    buffer_load_dwordx4 v[86:89], v106, s[68:71], 0 offen
    s_setprio 0
    s_waitcnt lgkmcnt(15)
    v_ashrrev_i32 v122, 5, v63
    v_lshlrev_b16 v123, 2, v63
    v_cndmask_b32 v126, v30, v31, s[66:67]
    v_bitop3_b32 v122, v122, v113, v113 bitop3:0x0c
    v_lshlrev_b32 v124, 16, v126
    v_mul_f32 v122, v114, v122
    v_and_b32 v125, 0xffff0000, v126
    v_add_u32 v123, v123, v123
    v_mul_f32 v124, v122, v124
    v_mul_f32 v125, v122, v125
    v_cmpx_le_u32 vcc, 0x1000000, v63
    ds_add_f32 v123, v124 offset:54272
    ds_add_f32 v123, v125 offset:54276
    s_mov_b64 exec, -1
    v_ashrrev_i32 v122, 5, v64
    v_lshlrev_b16 v123, 2, v64
    v_cndmask_b32 v126, v32, v33, s[66:67]
    v_bitop3_b32 v122, v122, v113, v113 bitop3:0x0c
    v_lshlrev_b32 v124, 16, v126
    v_mul_f32 v122, v114, v122
    v_and_b32 v125, 0xffff0000, v126
    v_add_u32 v123, v123, v123
    v_mul_f32 v124, v122, v124
    v_mul_f32 v125, v122, v125
    v_cmpx_le_u32 vcc, 0x1000000, v64
    ds_add_f32 v123, v124 offset:54272
    ds_add_f32 v123, v125 offset:54276
    s_mov_b64 exec, -1
    v_ashrrev_i32 v122, 5, v65
    v_lshlrev_b16 v123, 2, v65
    v_cndmask_b32 v126, v34, v35, s[66:67]
    v_bitop3_b32 v122, v122, v113, v113 bitop3:0x0c
    v_lshlrev_b32 v124, 16, v126
    v_mul_f32 v122, v114, v122
    v_and_b32 v125, 0xffff0000, v126
    v_add_u32 v123, v123, v123
    v_mul_f32 v124, v122, v124
    v_mul_f32 v125, v122, v125
    v_cmpx_le_u32 vcc, 0x1000000, v65
    ds_add_f32 v123, v124 offset:54272
    ds_add_f32 v123, v125 offset:54276
    s_mov_b64 exec, -1
    s_waitcnt vmcnt(13)
    v_perm_b32 v63, v93, v90, s31
    v_perm_b32 v64, v93, v91, s32
    v_perm_b32 v65, v93, v92, s33
    v_lshlrev_b16 v34, 3, v92
    v_lshlrev_b16 v32, 3, v91
    v_lshlrev_b16 v30, 3, v90
    s_waitcnt lgkmcnt(12)
    s_barrier
    s_setprio 3
    s_cmp_ge_u32 s10, 9
    s_cbranch_scc1 p2_nm1m1a
    v_lshrrev_b32 v84, 1, v112
    s_add_u32 s44, s20, s42
    buffer_load_dwordx2 v[84:85], v84, s[4:7], s44 offen
p2_nm1m1a:
    buffer_load_dwordx4 v[72:75], v112, s[4:7], s20 offen offset:0
    buffer_load_dwordx4 v[76:79], v112, s[4:7], s20 offen offset:1024
    buffer_load_dwordx4 v[80:83], v112, s[4:7], s20 offen offset:2048
    v_cmpx_ge_u16 vcc, 0x3fff, v60
    ds_read_b64 v[24:25], v24
    s_mov_b64 exec, -1
    v_cmpx_ge_u16 vcc, 0x3fff, v61
    ds_read_b64 v[26:27], v26
    s_mov_b64 exec, -1
    v_cmpx_ge_u16 vcc, 0x3fff, v62
    ds_read_b64 v[28:29], v28
    s_mov_b64 exec, -1
    v_cmpx_ge_u16 vcc, 0x3fff, v63
    ds_read_b64 v[30:31], v30
    s_mov_b64 exec, -1
    v_cmpx_ge_u16 vcc, 0x3fff, v64
    ds_read_b64 v[32:33], v32
    s_mov_b64 exec, -1
    v_cmpx_ge_u16 vcc, 0x3fff, v65
    ds_read_b64 v[34:35], v34
    s_mov_b64 exec, -1
    s_setprio 2
    s_waitcnt lgkmcnt(15)
    v_ashrrev_i32 v122, 5, v66
    v_lshlrev_b16 v123, 2, v66
    v_cndmask_b32 v126, v36, v37, s[66:67]
    v_bitop3_b32 v122, v122, v113, v113 bitop3:0x0c
    v_lshlrev_b32 v124, 16, v126
    v_mul_f32 v122, v114, v122
    v_and_b32 v125, 0xffff0000, v126
    v_add_u32 v123, v123, v123
    v_mul_f32 v124, v122, v124
    v_mul_f32 v125, v122, v125
    v_cmpx_le_u32 vcc, 0x1000000, v66
    ds_add_f32 v123, v124 offset:54272
    ds_add_f32 v123, v125 offset:54276
    s_mov_b64 exec, -1
    v_ashrrev_i32 v122, 5, v67
    v_lshlrev_b16 v123, 2, v67
    v_cndmask_b32 v126, v38, v39, s[66:67]
    v_bitop3_b32 v122, v122, v113, v113 bitop3:0x0c
    v_lshlrev_b32 v124, 16, v126
    v_mul_f32 v122, v114, v122
    v_and_b32 v125, 0xffff0000, v126
    v_add_u32 v123, v123, v123
    v_mul_f32 v124, v122, v124
    v_mul_f32 v125, v122, v125
    v_cmpx_le_u32 vcc, 0x1000000, v67
    ds_add_f32 v123, v124 offset:54272
    ds_add_f32 v123, v125 offset:54276
    s_mov_b64 exec, -1
    v_ashrrev_i32 v122, 5, v68
    v_lshlrev_b16 v123, 2, v68
    v_cndmask_b32 v126, v40, v41, s[66:67]
    v_bitop3_b32 v122, v122, v113, v113 bitop3:0x0c
    v_lshlrev_b32 v124, 16, v126
    v_mul_f32 v122, v114, v122
    v_and_b32 v125, 0xffff0000, v126
    v_add_u32 v123, v123, v123
    v_mul_f32 v124, v122, v124
    v_mul_f32 v125, v122, v125
    v_cmpx_le_u32 vcc, 0x1000000, v68
    ds_add_f32 v123, v124 offset:54272
    ds_add_f32 v123, v125 offset:54276
    s_mov_b64 exec, -1
    s_waitcnt vmcnt(15)
    v_perm_b32 v66, v97, v94, s31
    v_perm_b32 v67, v97, v95, s32
    v_perm_b32 v68, v97, v96, s33
    v_lshlrev_b16 v40, 3, v96
    v_lshlrev_b16 v38, 3, v95
    v_lshlrev_b16 v36, 3, v94
    v_cmpx_ge_u16 vcc, 0x3fff, v66
    ds_read_b64 v[36:37], v36
    s_mov_b64 exec, -1
    v_cmpx_ge_u16 vcc, 0x3fff, v67
    ds_read_b64 v[38:39], v38
    s_mov_b64 exec, -1
    v_cmpx_ge_u16 vcc, 0x3fff, v68
    ds_read_b64 v[40:41], v40
    s_mov_b64 exec, -1
    v_bfe_u32 v90, v107, 14, 4
    v_lshrrev_b32 v91, 18, v107
    v_and_b32 v107, 0x3fff, v107
    v_mad_u32_u24 v90, v90, s63, v91
    v_mad_u32_u24 v107, v90, s65, v107
    buffer_load_dwordx4 v[90:93], v107, s[68:71], 0 offen
    s_setprio 1
    s_waitcnt lgkmcnt(15)
    v_ashrrev_i32 v122, 5, v69
    v_lshlrev_b16 v123, 2, v69
    v_cndmask_b32 v126, v42, v43, s[66:67]
    v_bitop3_b32 v122, v122, v113, v113 bitop3:0x0c
    v_lshlrev_b32 v124, 16, v126
    v_mul_f32 v122, v114, v122
    v_and_b32 v125, 0xffff0000, v126
    v_add_u32 v123, v123, v123
    v_mul_f32 v124, v122, v124
    v_mul_f32 v125, v122, v125
    v_cmpx_le_u32 vcc, 0x1000000, v69
    ds_add_f32 v123, v124 offset:54272
    ds_add_f32 v123, v125 offset:54276
    s_mov_b64 exec, -1
    v_ashrrev_i32 v122, 5, v70
    v_lshlrev_b16 v123, 2, v70
    v_cndmask_b32 v126, v44, v45, s[66:67]
    v_bitop3_b32 v122, v122, v113, v113 bitop3:0x0c
    v_lshlrev_b32 v124, 16, v126
    v_mul_f32 v122, v114, v122
    v_and_b32 v125, 0xffff0000, v126
    v_add_u32 v123, v123, v123
    v_mul_f32 v124, v122, v124
    v_mul_f32 v125, v122, v125
    v_cmpx_le_u32 vcc, 0x1000000, v70
    ds_add_f32 v123, v124 offset:54272
    ds_add_f32 v123, v125 offset:54276
    s_mov_b64 exec, -1
    v_ashrrev_i32 v122, 5, v71
    v_lshlrev_b16 v123, 2, v71
    v_cndmask_b32 v126, v46, v47, s[66:67]
    v_bitop3_b32 v122, v122, v113, v113 bitop3:0x0c
    v_lshlrev_b32 v124, 16, v126
    v_mul_f32 v122, v114, v122
    v_and_b32 v125, 0xffff0000, v126
    v_add_u32 v123, v123, v123
    v_mul_f32 v124, v122, v124
    v_mul_f32 v125, v122, v125
    v_cmpx_le_u32 vcc, 0x1000000, v71
    ds_add_f32 v123, v124 offset:54272
    ds_add_f32 v123, v125 offset:54276
    s_mov_b64 exec, -1
    s_waitcnt vmcnt(12)
    v_perm_b32 v69, v101, v98, s31
    v_perm_b32 v70, v101, v99, s32
    v_perm_b32 v71, v101, v100, s33
    v_lshlrev_b16 v46, 3, v100
    v_lshlrev_b16 v44, 3, v99
    v_lshlrev_b16 v42, 3, v98
    v_cmpx_ge_u16 vcc, 0x3fff, v69
    ds_read_b64 v[42:43], v42
    s_mov_b64 exec, -1
    v_cmpx_ge_u16 vcc, 0x3fff, v70
    ds_read_b64 v[44:45], v44
    s_mov_b64 exec, -1
    v_cmpx_ge_u16 vcc, 0x3fff, v71
    ds_read_b64 v[46:47], v46
    s_mov_b64 exec, -1
    s_waitcnt lgkmcnt(15)
    s_nop 2
    s_nop 1
    v_max_u32_dpp v108, v108, v108 row_shr:1 row_mask:0xf bank_mask:0xf bound_ctrl:0
    v_max_u32_dpp v109, v109, v109 row_shr:1 row_mask:0xf bank_mask:0xf bound_ctrl:0
    s_nop 0
    v_max_u32_dpp v108, v108, v108 row_shr:2 row_mask:0xf bank_mask:0xf bound_ctrl:0
    v_max_u32_dpp v109, v109, v109 row_shr:2 row_mask:0xf bank_mask:0xf bound_ctrl:0
    s_nop 0
    v_max_u32_dpp v108, v108, v108 row_shr:4 row_mask:0xf bank_mask:0xf bound_ctrl:0
    v_max_u32_dpp v109, v109, v109 row_shr:4 row_mask:0xf bank_mask:0xf bound_ctrl:0
    s_nop 0
    v_max_u32_dpp v108, v108, v108 row_shr:8 row_mask:0xf bank_mask:0xf bound_ctrl:0
    v_max_u32_dpp v109, v109, v109 row_shr:8 row_mask:0xf bank_mask:0xf bound_ctrl:0
    s_nop 0
    v_max_u32_dpp v108, v108, v108 row_bcast:15 row_mask:0xa bank_mask:0xf
    v_max_u32_dpp v109, v109, v109 row_bcast:15 row_mask:0xa bank_mask:0xf
    s_nop 0
    v_max_u32_dpp v108, v108, v108 row_bcast:31 row_mask:0xc bank_mask:0xf
    v_max_u32_dpp v109, v109, v109 row_bcast:31 row_mask:0xc bank_mask:0xf
    s_nop 0
    s_nop 0
    v_max_u32 v108, s41, v108
    s_nop 0
    v_readlane_b32 s41, v108, 63
    v_add_u32 v108, v108, v112
    v_add_u32 v108, 4294961152, v108
    v_max_u32 v109, s41, v109
    s_nop 0
    v_readlane_b32 s41, v109, 63
    v_add_u32 v109, v109, v112
    v_add_u32 v109, 4294962176, v109
    v_bfe_u32 v94, v108, 14, 4
    v_lshrrev_b32 v95, 18, v108
    v_and_b32 v108, 0x3fff, v108
    v_mad_u32_u24 v94, v94, s63, v95
    v_mad_u32_u24 v108, v94, s65, v108
    buffer_load_dwordx4 v[94:97], v108, s[68:71], 0 offen
    s_setprio 0
    s_waitcnt vmcnt(9)
    v_perm_b32 v48, v3, v0, s31
    v_perm_b32 v49, v3, v1, s32
    v_perm_b32 v50, v3, v2, s33
    v_lshlrev_b16 v4, 3, v2
    v_lshlrev_b16 v2, 3, v1
    v_lshlrev_b16 v0, 3, v0
    v_cmpx_ge_u16 vcc, 0x3fff, v48
    ds_read_b64 v[0:1], v0
    s_mov_b64 exec, -1
    v_cmpx_ge_u16 vcc, 0x3fff, v49
    ds_read_b64 v[2:3], v2
    s_mov_b64 exec, -1
    v_cmpx_ge_u16 vcc, 0x3fff, v50
    ds_read_b64 v[4:5], v4
    s_mov_b64 exec, -1
    s_waitcnt vmcnt(8)
    v_perm_b32 v51, v9, v6, s31
    v_perm_b32 v52, v9, v7, s32
    v_perm_b32 v53, v9, v8, s33
    v_lshlrev_b16 v10, 3, v8
    v_lshlrev_b16 v8, 3, v7
    v_lshlrev_b16 v6, 3, v6
    v_cmpx_ge_u16 vcc, 0x3fff, v51
    ds_read_b64 v[6:7], v6
    s_mov_b64 exec, -1
    v_cmpx_ge_u16 vcc, 0x3fff, v52
    ds_read_b64 v[8:9], v8
    s_mov_b64 exec, -1
    v_cmpx_ge_u16 vcc, 0x3fff, v53
    ds_read_b64 v[10:11], v10
    s_mov_b64 exec, -1
    s_waitcnt vmcnt(7)
    v_perm_b32 v54, v15, v12, s31
    v_perm_b32 v55, v15, v13, s32
    v_perm_b32 v56, v15, v14, s33
    v_lshlrev_b16 v16, 3, v14
    v_lshlrev_b16 v14, 3, v13
    v_lshlrev_b16 v12, 3, v12
    v_cmpx_ge_u16 vcc, 0x3fff, v54
    ds_read_b64 v[12:13], v12
    s_mov_b64 exec, -1
    v_cmpx_ge_u16 vcc, 0x3fff, v55
    ds_read_b64 v[14:15], v14
    s_mov_b64 exec, -1
    v_cmpx_ge_u16 vcc, 0x3fff, v56
    ds_read_b64 v[16:17], v16
    s_mov_b64 exec, -1
    s_waitcnt vmcnt(6)
    v_perm_b32 v57, v21, v18, s31
    v_perm_b32 v58, v21, v19, s32
    v_perm_b32 v59, v21, v20, s33
    v_lshlrev_b16 v22, 3, v20
    v_lshlrev_b16 v20, 3, v19
    v_lshlrev_b16 v18, 3, v18
    s_cmp_lt_u32 s16, 8
    s_cbranch_scc1 p2_g1r03
    v_cmpx_ge_u16 vcc, 0x3fff, v57
    ds_read_b64 v[18:19], v18
    s_mov_b64 exec, -1
    v_cmpx_ge_u16 vcc, 0x3fff, v58
    ds_read_b64 v[20:21], v20
    s_mov_b64 exec, -1
    v_cmpx_ge_u16 vcc, 0x3fff, v59
    ds_read_b64 v[22:23], v22
    s_mov_b64 exec, -1
p2_g1r03:
    s_waitcnt lgkmcnt(0)
    s_barrier
    s_waitcnt lgkmcnt(15)
    s_branch p2_tail
p2_drain1:
    v_cmpx_gt_i16 vcc, 0, v48
    ds_read_b64 v[0:1], v0
    s_mov_b64 exec, -1
    v_cmpx_gt_i16 vcc, 0, v49
    ds_read_b64 v[2:3], v2
    s_mov_b64 exec, -1
    v_cmpx_gt_i16 vcc, 0, v50
    ds_read_b64 v[4:5], v4
    s_mov_b64 exec, -1
    v_cmpx_gt_i16 vcc, 0, v51
    ds_read_b64 v[6:7], v6
    s_mov_b64 exec, -1
    v_cmpx_gt_i16 vcc, 0, v52
    ds_read_b64 v[8:9], v8
    s_mov_b64 exec, -1
    v_cmpx_gt_i16 vcc, 0, v53
    ds_read_b64 v[10:11], v10
    s_mov_b64 exec, -1
    v_cmpx_gt_i16 vcc, 0, v54
    ds_read_b64 v[12:13], v12
    s_mov_b64 exec, -1
    v_cmpx_gt_i16 vcc, 0, v55
    ds_read_b64 v[14:15], v14
    s_mov_b64 exec, -1
    v_cmpx_gt_i16 vcc, 0, v56
    ds_read_b64 v[16:17], v16
    s_mov_b64 exec, -1
    s_cmp_lt_u32 s15, 8
    s_cbranch_scc1 p2_gd1
    v_cmpx_gt_i16 vcc, 0, v57
    ds_read_b64 v[18:19], v18
    s_mov_b64 exec, -1
    v_cmpx_gt_i16 vcc, 0, v58
    ds_read_b64 v[20:21], v20
    s_mov_b64 exec, -1
    v_cmpx_gt_i16 vcc, 0, v59
    ds_read_b64 v[22:23], v22
    s_mov_b64 exec, -1
p2_gd1:
    v_cmpx_gt_i16 vcc, 0, v60
    ds_read_b64 v[24:25], v24
    s_mov_b64 exec, -1
    v_cmpx_gt_i16 vcc, 0, v61
    ds_read_b64 v[26:27], v26
    s_mov_b64 exec, -1
    v_cmpx_gt_i16 vcc, 0, v62
    ds_read_b64 v[28:29], v28
    s_mov_b64 exec, -1
    v_cmpx_gt_i16 vcc, 0, v63
    ds_read_b64 v[30:31], v30
    s_mov_b64 exec, -1
    v_cmpx_gt_i16 vcc, 0, v64
    ds_read_b64 v[32:33], v32
    s_mov_b64 exec, -1
    v_cmpx_gt_i16 vcc, 0, v65
    ds_read_b64 v[34:35], v34
    s_mov_b64 exec, -1
    v_cmpx_gt_i16 vcc, 0, v66
    ds_read_b64 v[36:37], v36
    s_mov_b64 exec, -1
    v_cmpx_gt_i16 vcc, 0, v67
    ds_read_b64 v[38:39], v38
    s_mov_b64 exec, -1
    v_cmpx_gt_i16 vcc, 0, v68
    ds_read_b64 v[40:41], v40
    s_mov_b64 exec, -1
    v_cmpx_gt_i16 vcc, 0, v69
    ds_read_b64 v[42:43], v42
    s_mov_b64 exec, -1
    v_cmpx_gt_i16 vcc, 0, v70
    ds_read_b64 v[44:45], v44
    s_mov_b64 exec, -1
    v_cmpx_gt_i16 vcc, 0, v71
    ds_read_b64 v[46:47], v46
    s_mov_b64 exec, -1
    s_waitcnt lgkmcnt(15)
    v_ashrrev_i32 v122, 5, v48
    v_lshlrev_b16 v123, 2, v48
    v_cndmask_b32 v126, v0, v1, s[66:67]
    v_bitop3_b32 v122, v122, v113, v113 bitop3:0x0c
    v_lshlrev_b32 v124, 16, v126
    v_mul_f32 v122, v114, v122
    v_and_b32 v125, 0xffff0000, v126
    v_add_u32 v123, v123, v123
    v_mul_f32 v124, v122, v124
    v_mul_f32 v125, v122, v125
    v_cmpx_le_u32 vcc, 0x1000000, v48
    ds_add_f32 v123, v124 offset:54272
    ds_add_f32 v123, v125 offset:54276
    s_mov_b64 exec, -1
    v_ashrrev_i32 v122, 5, v49
    v_lshlrev_b16 v123, 2, v49
    v_cndmask_b32 v126, v2, v3, s[66:67]
    v_bitop3_b32 v122, v122, v113, v113 bitop3:0x0c
    v_lshlrev_b32 v124, 16, v126
    v_mul_f32 v122, v114, v122
    v_and_b32 v125, 0xffff0000, v126
    v_add_u32 v123, v123, v123
    v_mul_f32 v124, v122, v124
    v_mul_f32 v125, v122, v125
    v_cmpx_le_u32 vcc, 0x1000000, v49
    ds_add_f32 v123, v124 offset:54272
    ds_add_f32 v123, v125 offset:54276
    s_mov_b64 exec, -1
    v_ashrrev_i32 v122, 5, v50
    v_lshlrev_b16 v123, 2, v50
    v_cndmask_b32 v126, v4, v5, s[66:67]
    v_bitop3_b32 v122, v122, v113, v113 bitop3:0x0c
    v_lshlrev_b32 v124, 16, v126
    v_mul_f32 v122, v114, v122
    v_and_b32 v125, 0xffff0000, v126
    v_add_u32 v123, v123, v123
    v_mul_f32 v124, v122, v124
    v_mul_f32 v125, v122, v125
    v_cmpx_le_u32 vcc, 0x1000000, v50
    ds_add_f32 v123, v124 offset:54272
    ds_add_f32 v123, v125 offset:54276
    s_mov_b64 exec, -1
    s_waitcnt lgkmcnt(15)
    v_ashrrev_i32 v122, 5, v51
    v_lshlrev_b16 v123, 2, v51
    v_cndmask_b32 v126, v6, v7, s[66:67]
    v_bitop3_b32 v122, v122, v113, v113 bitop3:0x0c
    v_lshlrev_b32 v124, 16, v126
    v_mul_f32 v122, v114, v122
    v_and_b32 v125, 0xffff0000, v126
    v_add_u32 v123, v123, v123
    v_mul_f32 v124, v122, v124
    v_mul_f32 v125, v122, v125
    v_cmpx_le_u32 vcc, 0x1000000, v51
    ds_add_f32 v123, v124 offset:54272
    ds_add_f32 v123, v125 offset:54276
    s_mov_b64 exec, -1
    v_ashrrev_i32 v122, 5, v52
    v_lshlrev_b16 v123, 2, v52
    v_cndmask_b32 v126, v8, v9, s[66:67]
    v_bitop3_b32 v122, v122, v113, v113 bitop3:0x0c
    v_lshlrev_b32 v124, 16, v126
    v_mul_f32 v122, v114, v122
    v_and_b32 v125, 0xffff0000, v126
    v_add_u32 v123, v123, v123
    v_mul_f32 v124, v122, v124
    v_mul_f32 v125, v122, v125
    v_cmpx_le_u32 vcc, 0x1000000, v52
    ds_add_f32 v123, v124 offset:54272
    ds_add_f32 v123, v125 offset:54276
    s_mov_b64 exec, -1
    v_ashrrev_i32 v122, 5, v53
    v_lshlrev_b16 v123, 2, v53
    v_cndmask_b32 v126, v10, v11, s[66:67]
    v_bitop3_b32 v122, v122, v113, v113 bitop3:0x0c
    v_lshlrev_b32 v124, 16, v126
    v_mul_f32 v122, v114, v122
    v_and_b32 v125, 0xffff0000, v126
    v_add_u32 v123, v123, v123
    v_mul_f32 v124, v122, v124
    v_mul_f32 v125, v122, v125
    v_cmpx_le_u32 vcc, 0x1000000, v53
    ds_add_f32 v123, v124 offset:54272
    ds_add_f32 v123, v125 offset:54276
    s_mov_b64 exec, -1
    s_waitcnt lgkmcnt(15)
    v_ashrrev_i32 v122, 5, v54
    v_lshlrev_b16 v123, 2, v54
    v_cndmask_b32 v126, v12, v13, s[66:67]
    v_bitop3_b32 v122, v122, v113, v113 bitop3:0x0c
    v_lshlrev_b32 v124, 16, v126
    v_mul_f32 v122, v114, v122
    v_and_b32 v125, 0xffff0000, v126
    v_add_u32 v123, v123, v123
    v_mul_f32 v124, v122, v124
    v_mul_f32 v125, v122, v125
    v_cmpx_le_u32 vcc, 0x1000000, v54
    ds_add_f32 v123, v124 offset:54272
    ds_add_f32 v123, v125 offset:54276
    s_mov_b64 exec, -1
    v_ashrrev_i32 v122, 5, v55
    v_lshlrev_b16 v123, 2, v55
    v_cndmask_b32 v126, v14, v15, s[66:67]
    v_bitop3_b32 v122, v122, v113, v113 bitop3:0x0c
    v_lshlrev_b32 v124, 16, v126
    v_mul_f32 v122, v114, v122
    v_and_b32 v125, 0xffff0000, v126
    v_add_u32 v123, v123, v123
    v_mul_f32 v124, v122, v124
    v_mul_f32 v125, v122, v125
    v_cmpx_le_u32 vcc, 0x1000000, v55
    ds_add_f32 v123, v124 offset:54272
    ds_add_f32 v123, v125 offset:54276
    s_mov_b64 exec, -1
    v_ashrrev_i32 v122, 5, v56
    v_lshlrev_b16 v123, 2, v56
    v_cndmask_b32 v126, v16, v17, s[66:67]
    v_bitop3_b32 v122, v122, v113, v113 bitop3:0x0c
    v_lshlrev_b32 v124, 16, v126
    v_mul_f32 v122, v114, v122
    v_and_b32 v125, 0xffff0000, v126
    v_add_u32 v123, v123, v123
    v_mul_f32 v124, v122, v124
    v_mul_f32 v125, v122, v125
    v_cmpx_le_u32 vcc, 0x1000000, v56
    ds_add_f32 v123, v124 offset:54272
    ds_add_f32 v123, v125 offset:54276
    s_mov_b64 exec, -1
    s_cmp_lt_u32 s15, 8
    s_cbranch_scc1 p2_nad1
    s_waitcnt lgkmcnt(15)
    v_ashrrev_i32 v122, 5, v57
    v_lshlrev_b16 v123, 2, v57
    v_cndmask_b32 v126, v18, v19, s[66:67]
    v_bitop3_b32 v122, v122, v113, v113 bitop3:0x0c
    v_lshlrev_b32 v124, 16, v126
    v_mul_f32 v122, v114, v122
    v_and_b32 v125, 0xffff0000, v126
    v_add_u32 v123, v123, v123
    v_mul_f32 v124, v122, v124
    v_mul_f32 v125, v122, v125
    v_cmpx_le_u32 vcc, 0x1000000, v57
    ds_add_f32 v123, v124 offset:54272
    ds_add_f32 v123, v125 offset:54276
    s_mov_b64 exec, -1
    v_ashrrev_i32 v122, 5, v58
    v_lshlrev_b16 v123, 2, v58
    v_cndmask_b32 v126, v20, v21, s[66:67]
    v_bitop3_b32 v122, v122, v113, v113 bitop3:0x0c
    v_lshlrev_b32 v124, 16, v126
    v_mul_f32 v122, v114, v122
    v_and_b32 v125, 0xffff0000, v126
    v_add_u32 v123, v123, v123
    v_mul_f32 v124, v122, v124
    v_mul_f32 v125, v122, v125
    v_cmpx_le_u32 vcc, 0x1000000, v58
    ds_add_f32 v123, v124 offset:54272
    ds_add_f32 v123, v125 offset:54276
    s_mov_b64 exec, -1
    v_ashrrev_i32 v122, 5, v59
    v_lshlrev_b16 v123, 2, v59
    v_cndmask_b32 v126, v22, v23, s[66:67]
    v_bitop3_b32 v122, v122, v113, v113 bitop3:0x0c
    v_lshlrev_b32 v124, 16, v126
    v_mul_f32 v122, v114, v122
    v_and_b32 v125, 0xffff0000, v126
    v_add_u32 v123, v123, v123
    v_mul_f32 v124, v122, v124
    v_mul_f32 v125, v122, v125
    v_cmpx_le_u32 vcc, 0x1000000, v59
    ds_add_f32 v123, v124 offset:54272
    ds_add_f32 v123, v125 offset:54276
    s_mov_b64 exec, -1
p2_nad1:
    s_waitcnt lgkmcnt(15)
    v_ashrrev_i32 v122, 5, v60
    v_lshlrev_b16 v123, 2, v60
    v_cndmask_b32 v126, v24, v25, s[66:67]
    v_bitop3_b32 v122, v122, v113, v113 bitop3:0x0c
    v_lshlrev_b32 v124, 16, v126
    v_mul_f32 v122, v114, v122
    v_and_b32 v125, 0xffff0000, v126
    v_add_u32 v123, v123, v123
    v_mul_f32 v124, v122, v124
    v_mul_f32 v125, v122, v125
    v_cmpx_le_u32 vcc, 0x1000000, v60
    ds_add_f32 v123, v124 offset:54272
    ds_add_f32 v123, v125 offset:54276
    s_mov_b64 exec, -1
    v_ashrrev_i32 v122, 5, v61
    v_lshlrev_b16 v123, 2, v61
    v_cndmask_b32 v126, v26, v27, s[66:67]
    v_bitop3_b32 v122, v122, v113, v113 bitop3:0x0c
    v_lshlrev_b32 v124, 16, v126
    v_mul_f32 v122, v114, v122
    v_and_b32 v125, 0xffff0000, v126
    v_add_u32 v123, v123, v123
    v_mul_f32 v124, v122, v124
    v_mul_f32 v125, v122, v125
    v_cmpx_le_u32 vcc, 0x1000000, v61
    ds_add_f32 v123, v124 offset:54272
    ds_add_f32 v123, v125 offset:54276
    s_mov_b64 exec, -1
    v_ashrrev_i32 v122, 5, v62
    v_lshlrev_b16 v123, 2, v62
    v_cndmask_b32 v126, v28, v29, s[66:67]
    v_bitop3_b32 v122, v122, v113, v113 bitop3:0x0c
    v_lshlrev_b32 v124, 16, v126
    v_mul_f32 v122, v114, v122
    v_and_b32 v125, 0xffff0000, v126
    v_add_u32 v123, v123, v123
    v_mul_f32 v124, v122, v124
    v_mul_f32 v125, v122, v125
    v_cmpx_le_u32 vcc, 0x1000000, v62
    ds_add_f32 v123, v124 offset:54272
    ds_add_f32 v123, v125 offset:54276
    s_mov_b64 exec, -1
    s_waitcnt lgkmcnt(15)
    v_ashrrev_i32 v122, 5, v63
    v_lshlrev_b16 v123, 2, v63
    v_cndmask_b32 v126, v30, v31, s[66:67]
    v_bitop3_b32 v122, v122, v113, v113 bitop3:0x0c
    v_lshlrev_b32 v124, 16, v126
    v_mul_f32 v122, v114, v122
    v_and_b32 v125, 0xffff0000, v126
    v_add_u32 v123, v123, v123
    v_mul_f32 v124, v122, v124
    v_mul_f32 v125, v122, v125
    v_cmpx_le_u32 vcc, 0x1000000, v63
    ds_add_f32 v123, v124 offset:54272
    ds_add_f32 v123, v125 offset:54276
    s_mov_b64 exec, -1
    v_ashrrev_i32 v122, 5, v64
    v_lshlrev_b16 v123, 2, v64
    v_cndmask_b32 v126, v32, v33, s[66:67]
    v_bitop3_b32 v122, v122, v113, v113 bitop3:0x0c
    v_lshlrev_b32 v124, 16, v126
    v_mul_f32 v122, v114, v122
    v_and_b32 v125, 0xffff0000, v126
    v_add_u32 v123, v123, v123
    v_mul_f32 v124, v122, v124
    v_mul_f32 v125, v122, v125
    v_cmpx_le_u32 vcc, 0x1000000, v64
    ds_add_f32 v123, v124 offset:54272
    ds_add_f32 v123, v125 offset:54276
    s_mov_b64 exec, -1
    v_ashrrev_i32 v122, 5, v65
    v_lshlrev_b16 v123, 2, v65
    v_cndmask_b32 v126, v34, v35, s[66:67]
    v_bitop3_b32 v122, v122, v113, v113 bitop3:0x0c
    v_lshlrev_b32 v124, 16, v126
    v_mul_f32 v122, v114, v122
    v_and_b32 v125, 0xffff0000, v126
    v_add_u32 v123, v123, v123
    v_mul_f32 v124, v122, v124
    v_mul_f32 v125, v122, v125
    v_cmpx_le_u32 vcc, 0x1000000, v65
    ds_add_f32 v123, v124 offset:54272
    ds_add_f32 v123, v125 offset:54276
    s_mov_b64 exec, -1
    s_waitcnt lgkmcnt(15)
    v_ashrrev_i32 v122, 5, v66
    v_lshlrev_b16 v123, 2, v66
    v_cndmask_b32 v126, v36, v37, s[66:67]
    v_bitop3_b32 v122, v122, v113, v113 bitop3:0x0c
    v_lshlrev_b32 v124, 16, v126
    v_mul_f32 v122, v114, v122
    v_and_b32 v125, 0xffff0000, v126
    v_add_u32 v123, v123, v123
    v_mul_f32 v124, v122, v124
    v_mul_f32 v125, v122, v125
    v_cmpx_le_u32 vcc, 0x1000000, v66
    ds_add_f32 v123, v124 offset:54272
    ds_add_f32 v123, v125 offset:54276
    s_mov_b64 exec, -1
    v_ashrrev_i32 v122, 5, v67
    v_lshlrev_b16 v123, 2, v67
    v_cndmask_b32 v126, v38, v39, s[66:67]
    v_bitop3_b32 v122, v122, v113, v113 bitop3:0x0c
    v_lshlrev_b32 v124, 16, v126
    v_mul_f32 v122, v114, v122
    v_and_b32 v125, 0xffff0000, v126
    v_add_u32 v123, v123, v123
    v_mul_f32 v124, v122, v124
    v_mul_f32 v125, v122, v125
    v_cmpx_le_u32 vcc, 0x1000000, v67
    ds_add_f32 v123, v124 offset:54272
    ds_add_f32 v123, v125 offset:54276
    s_mov_b64 exec, -1
    v_ashrrev_i32 v122, 5, v68
    v_lshlrev_b16 v123, 2, v68
    v_cndmask_b32 v126, v40, v41, s[66:67]
    v_bitop3_b32 v122, v122, v113, v113 bitop3:0x0c
    v_lshlrev_b32 v124, 16, v126
    v_mul_f32 v122, v114, v122
    v_and_b32 v125, 0xffff0000, v126
    v_add_u32 v123, v123, v123
    v_mul_f32 v124, v122, v124
    v_mul_f32 v125, v122, v125
    v_cmpx_le_u32 vcc, 0x1000000, v68
    ds_add_f32 v123, v124 offset:54272
    ds_add_f32 v123, v125 offset:54276
    s_mov_b64 exec, -1
    s_waitcnt lgkmcnt(15)
    v_ashrrev_i32 v122, 5, v69
    v_lshlrev_b16 v123, 2, v69
    v_cndmask_b32 v126, v42, v43, s[66:67]
    v_bitop3_b32 v122, v122, v113, v113 bitop3:0x0c
    v_lshlrev_b32 v124, 16, v126
    v_mul_f32 v122, v114, v122
    v_and_b32 v125, 0xffff0000, v126
    v_add_u32 v123, v123, v123
    v_mul_f32 v124, v122, v124
    v_mul_f32 v125, v122, v125
    v_cmpx_le_u32 vcc, 0x1000000, v69
    ds_add_f32 v123, v124 offset:54272
    ds_add_f32 v123, v125 offset:54276
    s_mov_b64 exec, -1
    v_ashrrev_i32 v122, 5, v70
    v_lshlrev_b16 v123, 2, v70
    v_cndmask_b32 v126, v44, v45, s[66:67]
    v_bitop3_b32 v122, v122, v113, v113 bitop3:0x0c
    v_lshlrev_b32 v124, 16, v126
    v_mul_f32 v122, v114, v122
    v_and_b32 v125, 0xffff0000, v126
    v_add_u32 v123, v123, v123
    v_mul_f32 v124, v122, v124
    v_mul_f32 v125, v122, v125
    v_cmpx_le_u32 vcc, 0x1000000, v70
    ds_add_f32 v123, v124 offset:54272
    ds_add_f32 v123, v125 offset:54276
    s_mov_b64 exec, -1
    v_ashrrev_i32 v122, 5, v71
    v_lshlrev_b16 v123, 2, v71
    v_cndmask_b32 v126, v46, v47, s[66:67]
    v_bitop3_b32 v122, v122, v113, v113 bitop3:0x0c
    v_lshlrev_b32 v124, 16, v126
    v_mul_f32 v122, v114, v122
    v_and_b32 v125, 0xffff0000, v126
    v_add_u32 v123, v123, v123
    v_mul_f32 v124, v122, v124
    v_mul_f32 v125, v122, v125
    v_cmpx_le_u32 vcc, 0x1000000, v71
    ds_add_f32 v123, v124 offset:54272
    ds_add_f32 v123, v125 offset:54276
    s_mov_b64 exec, -1
    s_branch p2_fin
p2_tail:
    s_mov_b32 s60, s61
    s_mov_b32 s15, s16
    s_mov_b32 s16, s17
    v_mov_b32 v122, s19
    s_xor_b32 s19, s19, 4
    ds_read_b32 v125, v122 offset:53760
    v_mov_b32 v123, s19
    v_mov_b32 v124, 0
    ds_write_b32 v123, v124 offset:53760
    s_waitcnt vmcnt(2)
    s_mov_b32 m0, s24
    s_cmp_ge_u32 s10, 9
    s_cbranch_scc1 p2_st2s1
    ds_write_addtid_b32 v84 offset:49152
    ds_write_addtid_b32 v85 offset:49408
p2_st2s1:
    s_mov_b32 m0, s23
    s_add_u32 s20, s20, 53760
    ds_write_addtid_b32 v72 offset:0
    ds_write_addtid_b32 v73 offset:256
    ds_write_addtid_b32 v74 offset:512
    ds_write_addtid_b32 v75 offset:768
    ds_write_addtid_b32 v76 offset:1024
    ds_write_addtid_b32 v77 offset:1280
    ds_write_addtid_b32 v78 offset:1536
    ds_write_addtid_b32 v79 offset:1792
    ds_write_addtid_b32 v80 offset:2048
    ds_write_addtid_b32 v81 offset:2304
    ds_write_addtid_b32 v82 offset:2560
    ds_write_addtid_b32 v83 offset:2816
    s_cmp_ge_u32 s10, 9
    s_cbranch_scc1 p2_nm2m2a
    v_lshrrev_b32 v84, 1, v112
    s_add_u32 s44, s20, s42
    buffer_load_dwordx2 v[84:85], v84, s[4:7], s44 offen
p2_nm2m2a:
    buffer_load_dwordx4 v[72:75], v112, s[4:7], s20 offen offset:0
    buffer_load_dwordx4 v[76:79], v112, s[4:7], s20 offen offset:1024
    buffer_load_dwordx4 v[80:83], v112, s[4:7], s20 offen offset:2048
    s_waitcnt lgkmcnt(0)
    s_barrier
    s_setprio 3
    v_cmpx_lt_i16 vcc, 0x3fff, v48
    ds_read_b64 v[0:1], v0
    s_mov_b64 exec, -1
    v_cmpx_lt_i16 vcc, 0x3fff, v49
    ds_read_b64 v[2:3], v2
    s_mov_b64 exec, -1
    v_cmpx_lt_i16 vcc, 0x3fff, v50
    ds_read_b64 v[4:5], v4
    s_mov_b64 exec, -1
    v_cmpx_lt_i16 vcc, 0x3fff, v51
    ds_read_b64 v[6:7], v6
    s_mov_b64 exec, -1
    v_cmpx_lt_i16 vcc, 0x3fff, v52
    ds_read_b64 v[8:9], v8
    s_mov_b64 exec, -1
    v_cmpx_lt_i16 vcc, 0x3fff, v53
    ds_read_b64 v[10:11], v10
    s_mov_b64 exec, -1
    s_waitcnt lgkmcnt(15)
    s_nop 1
    v_readfirstlane_b32 s44, v125
    s_nop 0
    s_cmp_lg_u32 s44, 0
    s_cbranch_scc1 p2_advb
    s_add_u32 s61, s61, 1
    s_min_u32 s61, s61, 10
    v_mov_b32 v110, 0
    v_mov_b32 v111, 0
    s_cmp_eq_u32 s61, 10
    s_cbranch_scc1 p2_advb
    s_add_u32 s44, s61, s18
    s_cmp_ge_u32 s44, 10
    s_cselect_b32 s53, 10, 0
    s_sub_u32 s44, s44, s53
    s_mul_i32 s44, s44, 4160
    s_add_u32 s44, s44, s40
    v_bfe_i32 v111, v112, 6, 1
    v_lshrrev_b32 v110, 6, v112
    v_bitop3_b32 v111, v111, 15, s10 bitop3:0x6a
    v_lshl_or_b32 v110, v110, 4, v111
    v_bfe_u32 v111, v112, 2, 4
    v_mul_u32_u24 v110, 41600, v110
    v_add_u32 v111, v110, v111
    v_add_u32 v110, 256, v112
    v_and_b32 v110, 0x400, v110
    v_lshl_or_b32 v111, v110, 20, v111
    buffer_load_dword v110, v111, s[4:7], s44 offen
    buffer_load_dword v111, v111, s[4:7], s44 offen offset:16
p2_advb:
    s_cmp_lg_u32 s10, 15
    s_cbranch_scc1 p2_ntg
    s_lshr_b32 s44, s2, 3
    s_mul_i32 s44, s44, 5120
    s_add_u32 s45, s60, s18
    s_cmp_ge_u32 s45, 10
    s_cselect_b32 s53, 10, 0
    s_sub_u32 s45, s45, s53
    s_mul_i32 s45, s45, 645120
    s_add_u32 s44, s44, s45
    s_add_u32 s44, s44, s62
    s_sub_u32 s44, s44, s23
    v_lshlrev_b32 v84, 3, v112
    s_mov_b32 exec_hi, 0xff
    buffer_load_dword v85, v84, s[4:7], s44 offen
    s_mov_b64 exec, -1
p2_ntg:
    v_cmpx_lt_i16 vcc, 0x3fff, v54
    ds_read_b64 v[12:13], v12
    s_mov_b64 exec, -1
    v_cmpx_lt_i16 vcc, 0x3fff, v55
    ds_read_b64 v[14:15], v14
    s_mov_b64 exec, -1
    v_cmpx_lt_i16 vcc, 0x3fff, v56
    ds_read_b64 v[16:17], v16
    s_mov_b64 exec, -1
    s_cmp_lt_u32 s15, 8
    s_cbranch_scc1 p2_g2r13
    v_cmpx_lt_i16 vcc, 0x3fff, v57
    ds_read_b64 v[18:19], v18
    s_mov_b64 exec, -1
    v_cmpx_lt_i16 vcc, 0x3fff, v58
    ds_read_b64 v[20:21], v20
    s_mov_b64 exec, -1
    v_cmpx_lt_i16 vcc, 0x3fff, v59
    ds_read_b64 v[22:23], v22
    s_mov_b64 exec, -1
p2_g2r13:
    v_bfe_u32 v98, v109, 14, 4
    v_lshrrev_b32 v99, 18, v109
    v_and_b32 v109, 0x3fff, v109
    v_mad_u32_u24 v98, v98, s63, v99
    v_mad_u32_u24 v109, v98, s65, v109
    buffer_load_dwordx4 v[98:101], v109, s[68:71], 0 offen
    s_setprio 1
    v_cmpx_lt_i16 vcc, 0x3fff, v60
    ds_read_b64 v[24:25], v24
    s_mov_b64 exec, -1
    v_cmpx_lt_i16 vcc, 0x3fff, v61
    ds_read_b64 v[26:27], v26
    s_mov_b64 exec, -1
    v_cmpx_lt_i16 vcc, 0x3fff, v62
    ds_read_b64 v[28:29], v28
    s_mov_b64 exec, -1
    v_cmpx_lt_i16 vcc, 0x3fff, v63
    ds_read_b64 v[30:31], v30
    s_mov_b64 exec, -1
    v_cmpx_lt_i16 vcc, 0x3fff, v64
    ds_read_b64 v[32:33], v32
    s_mov_b64 exec, -1
    v_cmpx_lt_i16 vcc, 0x3fff, v65
    ds_read_b64 v[34:35], v34
    s_mov_b64 exec, -1
    s_nop 2
    s_nop 1
    v_max_u32_dpp v102, v102, v102 row_shr:1 row_mask:0xf bank_mask:0xf bound_ctrl:0
    v_max_u32_dpp v103, v103, v103 row_shr:1 row_mask:0xf bank_mask:0xf bound_ctrl:0
    s_nop 0
    v_max_u32_dpp v102, v102, v102 row_shr:2 row_mask:0xf bank_mask:0xf bound_ctrl:0
    v_max_u32_dpp v103, v103, v103 row_shr:2 row_mask:0xf bank_mask:0xf bound_ctrl:0
    s_nop 0
    v_max_u32_dpp v102, v102, v102 row_shr:4 row_mask:0xf bank_mask:0xf bound_ctrl:0
    v_max_u32_dpp v103, v103, v103 row_shr:4 row_mask:0xf bank_mask:0xf bound_ctrl:0
    s_nop 0
    v_max_u32_dpp v102, v102, v102 row_shr:8 row_mask:0xf bank_mask:0xf bound_ctrl:0
    v_max_u32_dpp v103, v103, v103 row_shr:8 row_mask:0xf bank_mask:0xf bound_ctrl:0
    s_nop 0
    v_max_u32_dpp v102, v102, v102 row_bcast:15 row_mask:0xa bank_mask:0xf
    v_max_u32_dpp v103, v103, v103 row_bcast:15 row_mask:0xa bank_mask:0xf
    s_nop 0
    v_max_u32_dpp v102, v102, v102 row_bcast:31 row_mask:0xc bank_mask:0xf
    v_max_u32_dpp v103, v103, v103 row_bcast:31 row_mask:0xc bank_mask:0xf
    s_nop 0
    s_nop 0
    v_max_u32 v102, s41, v102
    s_nop 0
    v_readlane_b32 s41, v102, 63
    v_add_u32 v102, v102, v112
    v_add_u32 v102, 4294963200, v102
    v_max_u32 v103, s41, v103
    s_nop 0
    v_readlane_b32 s41, v103, 63
    v_add_u32 v103, v103, v112
    v_add_u32 v103, 4294964224, v103
    v_cmpx_lt_i16 vcc, 0x3fff, v66
    ds_read_b64 v[36:37], v36
    s_mov_b64 exec, -1
    v_cmpx_lt_i16 vcc, 0x3fff, v67
    ds_read_b64 v[38:39], v38
    s_mov_b64 exec, -1
    v_cmpx_lt_i16 vcc, 0x3fff, v68
    ds_read_b64 v[40:41], v40
    s_mov_b64 exec, -1
    v_cmpx_lt_i16 vcc, 0x3fff, v69
    ds_read_b64 v[42:43], v42
    s_mov_b64 exec, -1
    v_cmpx_lt_i16 vcc, 0x3fff, v70
    ds_read_b64 v[44:45], v44
    s_mov_b64 exec, -1
    v_cmpx_lt_i16 vcc, 0x3fff, v71
    ds_read_b64 v[46:47], v46
    s_mov_b64 exec, -1
    s_waitcnt lgkmcnt(0)
    s_barrier
    s_waitcnt vmcnt(1)
    s_mov_b32 m0, s24
    s_cmp_ge_u32 s10, 9
    s_cbranch_scc1 p2_st2s2
    ds_write_addtid_b32 v84 offset:49152
    ds_write_addtid_b32 v85 offset:49408
p2_st2s2:
    s_mov_b32 m0, s23
    s_add_u32 s20, s60, s18
    s_cmp_ge_u32 s20, 10
    s_cselect_b32 s53, 10, 0
    s_sub_u32 s20, s20, s53
    s_mul_i32 s20, s20, 645120
    s_add_u32 s20, s20, s62
    ds_write_addtid_b32 v72 offset:0
    ds_write_addtid_b32 v73 offset:256
    ds_write_addtid_b32 v74 offset:512
    ds_write_addtid_b32 v75 offset:768
    ds_write_addtid_b32 v76 offset:1024
    ds_write_addtid_b32 v77 offset:1280
    ds_write_addtid_b32 v78 offset:1536
    ds_write_addtid_b32 v79 offset:1792
    ds_write_addtid_b32 v80 offset:2048
    ds_write_addtid_b32 v81 offset:2304
    ds_write_addtid_b32 v82 offset:2560
    ds_write_addtid_b32 v83 offset:2816
    s_nop 2
    s_nop 1
    v_max_u32_dpp v104, v104, v104 row_shr:1 row_mask:0xf bank_mask:0xf bound_ctrl:0
    v_max_u32_dpp v105, v105, v105 row_shr:1 row_mask:0xf bank_mask:0xf bound_ctrl:0
    s_nop 0
    v_max_u32_dpp v104, v104, v104 row_shr:2 row_mask:0xf bank_mask:0xf bound_ctrl:0
    v_max_u32_dpp v105, v105, v105 row_shr:2 row_mask:0xf bank_mask:0xf bound_ctrl:0
    s_nop 0
    v_max_u32_dpp v104, v104, v104 row_shr:4 row_mask:0xf bank_mask:0xf bound_ctrl:0
    v_max_u32_dpp v105, v105, v105 row_shr:4 row_mask:0xf bank_mask:0xf bound_ctrl:0
    s_nop 0
    v_max_u32_dpp v104, v104, v104 row_shr:8 row_mask:0xf bank_mask:0xf bound_ctrl:0
    v_max_u32_dpp v105, v105, v105 row_shr:8 row_mask:0xf bank_mask:0xf bound_ctrl:0
    s_nop 0
    v_max_u32_dpp v104, v104, v104 row_bcast:15 row_mask:0xa bank_mask:0xf
    v_max_u32_dpp v105, v105, v105 row_bcast:15 row_mask:0xa bank_mask:0xf
    s_nop 0
    v_max_u32_dpp v104, v104, v104 row_bcast:31 row_mask:0xc bank_mask:0xf
    v_max_u32_dpp v105, v105, v105 row_bcast:31 row_mask:0xc bank_mask:0xf
    s_nop 0
    s_nop 0
    v_max_u32 v104, s41, v104
    s_nop 0
    v_readlane_b32 s41, v104, 63
    v_add_u32 v104, v104, v112
    v_add_u32 v104, 4294965248, v104
    v_max_u32 v105, s41, v105
    s_nop 0
    v_readlane_b32 s41, v105, 63
    v_add_u32 v105, v105, v112
    v_add_u32 v105, 4294966272, v105
    s_waitcnt lgkmcnt(0)
    s_barrier
    s_branch p2_top
p2_fin:
    s_waitcnt vmcnt(0) lgkmcnt(0)
    s_barrier
    s_mov_b32 s48, s11
    s_mul_i32 s44, s48, 800768
    s_mul_i32 s45, s12, 12512
    s_add_u32 s49, s44, s45
    s_lshl_b32 s44, s49, 3
    s_add_u32 s44, s44, 492278784
    s_lshl_b32 s48, s48, 2
    s_lshl_b32 s45, s12, 4
    s_add_u32 s48, s48, s45
    s_add_u32 s48, s48, 492277760
    v_add_u32 v123, s64, v112
    v_add_u32 v122, s25, v123
    v_mov_b32 v24, 0
    v_mov_b32 v25, 0
    v_mov_b32 v26, 0
    v_mov_b32 v27, 0
    v_cmp_gt_u32 vcc, 1792, v123
    v_mov_b32 v124, 0x38000000
    v_mov_b32 v126, 0
    v_cndmask_b32 v124, v124, v123, vcc
    ds_read_b128 v[0:3], v122 offset:0
    ds_read_b128 v[4:7], v122 offset:16384
    ds_read_b128 v[8:11], v122 offset:32768
    v_add_u32 v122, 49152, v122
    ds_read_b128 v[12:15], v122 offset:0
    ds_read_b128 v[16:19], v122 offset:16384
    ds_read_b128 v[20:23], v122 offset:32768
    s_mov_b64 exec, vcc
    ds_read_b128 v[24:27], v122 offset:49152
    s_mov_b64 exec, -1
    s_cmp_lg_u32 s21, 0
    s_cbranch_scc1 p2_finf
    s_waitcnt lgkmcnt(6)
    buffer_store_dwordx4 v[0:3], v123, s[4:7], s44 offen nt
    s_add_u32 s44, s44, 16384
    s_waitcnt lgkmcnt(5)
    buffer_store_dwordx4 v[4:7], v123, s[4:7], s44 offen nt
    s_add_u32 s44, s44, 16384
    s_waitcnt lgkmcnt(4)
    buffer_store_dwordx4 v[8:11], v123, s[4:7], s44 offen nt
    s_add_u32 s44, s44, 16384
    s_waitcnt lgkmcnt(3)
    buffer_store_dwordx4 v[12:15], v123, s[4:7], s44 offen nt
    s_add_u32 s44, s44, 16384
    s_waitcnt lgkmcnt(2)
    buffer_store_dwordx4 v[16:19], v123, s[4:7], s44 offen nt
    s_add_u32 s44, s44, 16384
    s_waitcnt lgkmcnt(1)
    buffer_store_dwordx4 v[20:23], v123, s[4:7], s44 offen nt
    s_add_u32 s44, s44, 16384
    s_waitcnt lgkmcnt(0)
    buffer_store_dwordx4 v[24:27], v124, s[4:7], s44 offen nt
    s_add_u32 s44, s44, 16384
    v_bitop3_b32 v115, v115, v0, v1 bitop3:0xfe
    v_bitop3_b32 v115, v115, v2, v3 bitop3:0xfe
    v_bitop3_b32 v115, v115, v4, v5 bitop3:0xfe
    v_bitop3_b32 v115, v115, v6, v7 bitop3:0xfe
    v_bitop3_b32 v115, v115, v8, v9 bitop3:0xfe
    v_bitop3_b32 v115, v115, v10, v11 bitop3:0xfe
    v_bitop3_b32 v115, v115, v12, v13 bitop3:0xfe
    v_bitop3_b32 v115, v115, v14, v15 bitop3:0xfe
    v_bitop3_b32 v115, v115, v16, v17 bitop3:0xfe
    v_bitop3_b32 v115, v115, v18, v19 bitop3:0xfe
    v_bitop3_b32 v115, v115, v20, v21 bitop3:0xfe
    v_bitop3_b32 v115, v115, v22, v23 bitop3:0xfe
    v_bitop3_b32 v115, v115, v24, v25 bitop3:0xfe
    v_bitop3_b32 v115, v115, v26, v27 bitop3:0xfe
    v_bitop3_b32 v115, v115, v116, v117 bitop3:0xfe
    v_bitop3_b32 v115, v115, v118, v119 bitop3:0xfe
    v_bitop3_b32 v115, v115, v120, v121 bitop3:0xfe
    v_mov_b32 v28, 0
    v_mov_b32 v29, 0
    v_lshrrev_b32 v30, 1, v0
    v_bitop3_b32 v28, v28, v0, v30 bitop3:0xf6
    v_lshrrev_b32 v31, 1, v1
    v_bitop3_b32 v29, v29, v1, v31 bitop3:0xf6
    v_lshrrev_b32 v30, 1, v2
    v_bitop3_b32 v28, v28, v2, v30 bitop3:0xf6
    v_lshrrev_b32 v31, 1, v3
    v_bitop3_b32 v29, v29, v3, v31 bitop3:0xf6
    v_lshrrev_b32 v30, 1, v4
    v_bitop3_b32 v28, v28, v4, v30 bitop3:0xf6
    v_lshrrev_b32 v31, 1, v5
    v_bitop3_b32 v29, v29, v5, v31 bitop3:0xf6
    v_lshrrev_b32 v30, 1, v6
    v_bitop3_b32 v28, v28, v6, v30 bitop3:0xf6
    v_lshrrev_b32 v31, 1, v7
    v_bitop3_b32 v29, v29, v7, v31 bitop3:0xf6
    v_lshrrev_b32 v30, 1, v8
    v_bitop3_b32 v28, v28, v8, v30 bitop3:0xf6
    v_lshrrev_b32 v31, 1, v9
    v_bitop3_b32 v29, v29, v9, v31 bitop3:0xf6
    v_lshrrev_b32 v30, 1, v10
    v_bitop3_b32 v28, v28, v10, v30 bitop3:0xf6
    v_lshrrev_b32 v31, 1, v11
    v_bitop3_b32 v29, v29, v11, v31 bitop3:0xf6
    v_lshrrev_b32 v30, 1, v12
    v_bitop3_b32 v28, v28, v12, v30 bitop3:0xf6
    v_lshrrev_b32 v31, 1, v13
    v_bitop3_b32 v29, v29, v13, v31 bitop3:0xf6
    v_lshrrev_b32 v30, 1, v14
    v_bitop3_b32 v28, v28, v14, v30 bitop3:0xf6
    v_lshrrev_b32 v31, 1, v15
    v_bitop3_b32 v29, v29, v15, v31 bitop3:0xf6
    v_lshrrev_b32 v30, 1, v16
    v_bitop3_b32 v28, v28, v16, v30 bitop3:0xf6
    v_lshrrev_b32 v31, 1, v17
    v_bitop3_b32 v29, v29, v17, v31 bitop3:0xf6
    v_lshrrev_b32 v30, 1, v18
    v_bitop3_b32 v28, v28, v18, v30 bitop3:0xf6
    v_lshrrev_b32 v31, 1, v19
    v_bitop3_b32 v29, v29, v19, v31 bitop3:0xf6
    v_lshrrev_b32 v30, 1, v20
    v_bitop3_b32 v28, v28, v20, v30 bitop3:0xf6
    v_lshrrev_b32 v31, 1, v21
    v_bitop3_b32 v29, v29, v21, v31 bitop3:0xf6
    v_lshrrev_b32 v30, 1, v22
    v_bitop3_b32 v28, v28, v22, v30 bitop3:0xf6
    v_lshrrev_b32 v31, 1, v23
    v_bitop3_b32 v29, v29, v23, v31 bitop3:0xf6
    v_lshrrev_b32 v30, 1, v24
    v_bitop3_b32 v28, v28, v24, v30 bitop3:0xf6
    v_lshrrev_b32 v31, 1, v25
    v_bitop3_b32 v29, v29, v25, v31 bitop3:0xf6
    v_lshrrev_b32 v30, 1, v26
    v_bitop3_b32 v28, v28, v26, v30 bitop3:0xf6
    v_lshrrev_b32 v31, 1, v27
    v_bitop3_b32 v29, v29, v27, v31 bitop3:0xf6
    s_mov_b32 s45, 0
    v_and_b32 v30, 7168, v28
    v_cmp_ne_u32 vcc, 0, v30
    s_nop 0
    s_cmp_lg_u64 vcc, 0
    s_cselect_b32 s46, 1, 0
    s_or_b32 s45, s45, s46
    v_and_b32 v30, 469762048, v28
    v_cmp_ne_u32 vcc, 0, v30
    s_nop 0
    s_cmp_lg_u64 vcc, 0
    s_cselect_b32 s46, 2, 0
    s_or_b32 s45, s45, s46
    v_and_b32 v30, 7168, v29
    v_cmp_ne_u32 vcc, 0, v30
    s_nop 0
    s_cmp_lg_u64 vcc, 0
    s_cselect_b32 s46, 4, 0
    s_or_b32 s45, s45, s46
    v_and_b32 v30, 469762048, v29
    v_cmp_ne_u32 vcc, 0, v30
    s_nop 0
    s_cmp_lg_u64 vcc, 0
    s_cselect_b32 s46, 8, 0
    s_or_b32 s45, s45, s46
    v_and_b32 v30, 2147516416, v115
    v_cmp_ne_u32 vcc, 0, v30
    s_nop 0
    s_cmp_lg_u64 vcc, 0
    s_cselect_b32 s46, 16, 0
    s_or_b32 s45, s45, s46
    v_mov_b32 v30, s45
    s_mov_b64 exec, 1
    ds_or_b32 v126, v30 offset:53768
    s_mov_b64 exec, -1
    s_waitcnt lgkmcnt(0)
    s_barrier
    ds_read_b32 v125, v126 offset:53768
    s_waitcnt lgkmcnt(0)
    v_readfirstlane_b32 s45, v125
    s_nop 0
    s_cmp_eq_u32 s45, 15
    s_cbranch_scc1 p2_done
    s_mov_b32 s21, 1
    s_waitcnt vmcnt(0)
    s_branch p2_restart
p2_finf:
    s_lshl_b32 s49, s49, 4
    s_lshl_b32 s45, s21, 3
    s_add_u32 s49, s49, s45
    s_add_u32 s49, s49, 517903352
    v_mov_b32 v28, 1073758208
    v_mov_b32 v29, 1073758208
    v_mov_b32 v30, 1073758208
    v_mov_b32 v31, 1073758208
    v_lshlrev_b32 v122, 1, v123
    v_lshlrev_b32 v125, 1, v124
    s_waitcnt lgkmcnt(0)
    buffer_store_dwordx4 v[28:31], v123, s[4:7], s44 offen
    s_add_u32 s44, s44, 16384
    buffer_store_dwordx2 v[0:1], v122, s[4:7], s49 offen offset:0
    buffer_store_dwordx2 v[2:3], v122, s[4:7], s49 offen offset:16
    s_add_u32 s49, s49, 32768
    buffer_store_dwordx4 v[28:31], v123, s[4:7], s44 offen
    s_add_u32 s44, s44, 16384
    buffer_store_dwordx2 v[4:5], v122, s[4:7], s49 offen offset:0
    buffer_store_dwordx2 v[6:7], v122, s[4:7], s49 offen offset:16
    s_add_u32 s49, s49, 32768
    buffer_store_dwordx4 v[28:31], v123, s[4:7], s44 offen
    s_add_u32 s44, s44, 16384
    buffer_store_dwordx2 v[8:9], v122, s[4:7], s49 offen offset:0
    buffer_store_dwordx2 v[10:11], v122, s[4:7], s49 offen offset:16
    s_add_u32 s49, s49, 32768
    buffer_store_dwordx4 v[28:31], v123, s[4:7], s44 offen
    s_add_u32 s44, s44, 16384
    buffer_store_dwordx2 v[12:13], v122, s[4:7], s49 offen offset:0
    buffer_store_dwordx2 v[14:15], v122, s[4:7], s49 offen offset:16
    s_add_u32 s49, s49, 32768
    buffer_store_dwordx4 v[28:31], v123, s[4:7], s44 offen
    s_add_u32 s44, s44, 16384
    buffer_store_dwordx2 v[16:17], v122, s[4:7], s49 offen offset:0
    buffer_store_dwordx2 v[18:19], v122, s[4:7], s49 offen offset:16
    s_add_u32 s49, s49, 32768
    buffer_store_dwordx4 v[28:31], v123, s[4:7], s44 offen
    s_add_u32 s44, s44, 16384
    buffer_store_dwordx2 v[20:21], v122, s[4:7], s49 offen offset:0
    buffer_store_dwordx2 v[22:23], v122, s[4:7], s49 offen offset:16
    s_add_u32 s49, s49, 32768
    buffer_store_dwordx4 v[28:31], v124, s[4:7], s44 offen
    s_add_u32 s44, s44, 16384
    buffer_store_dwordx2 v[24:25], v125, s[4:7], s49 offen offset:0
    buffer_store_dwordx2 v[26:27], v125, s[4:7], s49 offen offset:16
    s_add_u32 s49, s49, 32768
    s_add_u32 s21, s21, 1
    s_mov_b32 s30, 0
    s_waitcnt vmcnt(0)
    s_cmp_eq_u32 s21, 2
    s_cbranch_scc1 p2_restart
p2_done:
    v_mov_b32 v125, s30
    buffer_store_dword v125, v126, s[4:7], s48 offen
p2_end:
    s_endpgm
.globl p3_kernel
.p2align 8
.type p3_kernel,@function
p3_kernel:
    s_cmp_ge_u32 s2, 1563
    s_cbranch_scc1 p3_end
    s_load_dwordx2 s[4:5], s[0:1], 0
    s_load_dwordx2 s[6:7], s[0:1], 24
    s_load_dwordx2 s[8:9], s[0:1], 40
    s_load_dwordx8 s[12:19], s[0:1], 56
    s_load_dwordx2 s[10:11], s[0:1], 88
    s_load_dwordx2 s[20:21], s[0:1], 104
    s_lshl_b32 s3, s2, 8
    v_add_u32 v0, s3, v0
    v_lshlrev_b32 v2, 4, v0
    v_lshlrev_b32 v3, 2, v0
    v_add_u32 v0, v0, v0
    v_mul_hi_u32_u24 v1, 343268, v0
    v_lshlrev_b16 v1, 4, v1
    s_waitcnt lgkmcnt(0)
    s_load_dwordx4 s[32:35], s[8:9], 0
    s_load_dwordx16 s[36:51], s[12:13], 0
    s_load_dwordx16 s[52:67], s[14:15], 0
    s_load_dwordx8 s[68:75], s[16:17], 0
    s_load_dwordx8 s[76:83], s[18:19], 0
    s_mov_b32 s24, s6
    s_and_b32 s25, s7, 0xffff
    s_mov_b32 s26, 1600000
    s_mov_b32 s27, 0x20000
    buffer_load_dword v4, v3, s[24:27], 0 offen nt
    s_mov_b32 s28, s20
    s_and_b32 s29, s21, 0xffff
    s_mov_b32 s30, 819200000
    s_mov_b32 s31, 0x20000
    s_mov_b32 s22, 492278784
    buffer_load_dwordx4 v[40:43], v2, s[28:31], s22 offen nt
    s_mov_b32 s22, 498684928
    buffer_load_dwordx4 v[44:47], v2, s[28:31], s22 offen nt
    s_mov_b32 s22, 505091072
    buffer_load_dwordx4 v[48:51], v2, s[28:31], s22 offen nt
    s_mov_b32 s22, 511497216
    buffer_load_dwordx4 v[52:55], v2, s[28:31], s22 offen nt
    s_mov_b32 s22, 492277760
    buffer_load_dwordx4 v[56:59], v1, s[28:31], s22 offen
    s_mov_b32 s24, s4
    s_and_b32 s25, s5, 0xffff
    s_mov_b32 s26, 6400000
    s_mov_b32 s27, 0x20000
    buffer_load_dwordx4 v[60:63], v2, s[24:27], 0 offen nt
    s_mov_b32 s24, s10
    s_and_b32 s25, s11, 0xffff
    s_mov_b32 s26, 6400000
    s_mov_b32 s27, 0x20000
    s_waitcnt vmcnt(6) lgkmcnt(0)
    v_and_b32 v5, 0xffff0000, v4
    v_lshlrev_b32 v4, 16, v4
    s_lshl_b32 s14, s32, 16
    s_and_b32 s15, s32, 0xffff0000
    v_pk_add_f32 v[8:9], v[4:5], s[14:15] op_sel:[0,0] op_sel_hi:[0,1] neg_lo:[0,1] neg_hi:[0,1]
    v_pk_add_f32 v[16:17], v[4:5], s[14:15] op_sel:[1,0] op_sel_hi:[1,1] neg_lo:[0,1] neg_hi:[0,1]
    s_lshl_b32 s16, s33, 16
    s_and_b32 s17, s33, 0xffff0000
    v_pk_add_f32 v[10:11], v[4:5], s[16:17] op_sel:[0,0] op_sel_hi:[0,1] neg_lo:[0,1] neg_hi:[0,1]
    v_pk_add_f32 v[18:19], v[4:5], s[16:17] op_sel:[1,0] op_sel_hi:[1,1] neg_lo:[0,1] neg_hi:[0,1]
    s_lshl_b32 s18, s34, 16
    s_and_b32 s19, s34, 0xffff0000
    v_pk_add_f32 v[12:13], v[4:5], s[18:19] op_sel:[0,0] op_sel_hi:[0,1] neg_lo:[0,1] neg_hi:[0,1]
    v_pk_add_f32 v[20:21], v[4:5], s[18:19] op_sel:[1,0] op_sel_hi:[1,1] neg_lo:[0,1] neg_hi:[0,1]
    s_lshl_b32 s12, s35, 16
    s_and_b32 s13, s35, 0xffff0000
    v_pk_add_f32 v[14:15], v[4:5], s[12:13] op_sel:[0,0] op_sel_hi:[0,1] neg_lo:[0,1] neg_hi:[0,1]
    v_pk_add_f32 v[22:23], v[4:5], s[12:13] op_sel:[1,0] op_sel_hi:[1,1] neg_lo:[0,1] neg_hi:[0,1]
    v_cvt_pk_bf16_f32 v8, v8, v9
    v_cvt_pk_bf16_f32 v10, v10, v11
    v_cvt_pk_bf16_f32 v12, v12, v13
    v_cvt_pk_bf16_f32 v14, v14, v15
    v_cvt_pk_bf16_f32 v16, v16, v17
    v_cvt_pk_bf16_f32 v18, v18, v19
    v_cvt_pk_bf16_f32 v20, v20, v21
    v_cvt_pk_bf16_f32 v22, v22, v23
    v_and_b32 v9, 0xffff0000, v8
    v_lshlrev_b32 v8, 16, v8
    v_and_b32 v11, 0xffff0000, v10
    v_lshlrev_b32 v10, 16, v10
    v_and_b32 v13, 0xffff0000, v12
    v_lshlrev_b32 v12, 16, v12
    v_and_b32 v15, 0xffff0000, v14
    v_lshlrev_b32 v14, 16, v14
    v_and_b32 v17, 0xffff0000, v16
    v_lshlrev_b32 v16, 16, v16
    v_and_b32 v19, 0xffff0000, v18
    v_lshlrev_b32 v18, 16, v18
    v_and_b32 v21, 0xffff0000, v20
    v_lshlrev_b32 v20, 16, v20
    v_and_b32 v23, 0xffff0000, v22
    v_lshlrev_b32 v22, 16, v22
    v_mul_f32 v8, v8, v8
    v_mul_f32 v9, v9, v9
    v_mul_f32 v10, v10, v10
    v_mul_f32 v11, v11, v11
    v_mul_f32 v12, v12, v12
    v_mul_f32 v13, v13, v13
    v_mul_f32 v14, v14, v14
    v_mul_f32 v15, v15, v15
    v_mul_f32 v16, v16, v16
    v_mul_f32 v17, v17, v17
    v_mul_f32 v18, v18, v18
    v_mul_f32 v19, v19, v19
    v_mul_f32 v20, v20, v20
    v_mul_f32 v21, v21, v21
    v_mul_f32 v22, v22, v22
    v_mul_f32 v23, v23, v23
    v_cvt_pk_bf16_f32 v8, v8, v9
    v_cvt_pk_bf16_f32 v10, v10, v11
    v_cvt_pk_bf16_f32 v12, v12, v13
    v_cvt_pk_bf16_f32 v14, v14, v15
    v_cvt_pk_bf16_f32 v16, v16, v17
    v_cvt_pk_bf16_f32 v18, v18, v19
    v_cvt_pk_bf16_f32 v20, v20, v21
    v_cvt_pk_bf16_f32 v22, v22, v23
    v_and_b32 v9, 0xffff0000, v8
    v_lshlrev_b32 v8, 16, v8
    v_and_b32 v11, 0xffff0000, v10
    v_lshlrev_b32 v10, 16, v10
    v_and_b32 v13, 0xffff0000, v12
    v_lshlrev_b32 v12, 16, v12
    v_and_b32 v15, 0xffff0000, v14
    v_lshlrev_b32 v14, 16, v14
    v_and_b32 v17, 0xffff0000, v16
    v_lshlrev_b32 v16, 16, v16
    v_and_b32 v19, 0xffff0000, v18
    v_lshlrev_b32 v18, 16, v18
    v_and_b32 v21, 0xffff0000, v20
    v_lshlrev_b32 v20, 16, v20
    v_and_b32 v23, 0xffff0000, v22
    v_lshlrev_b32 v22, 16, v22
    v_mul_f32 v8, 0xc1200000, v8
    v_mul_f32 v9, 0xc1200000, v9
    v_mul_f32 v10, 0xc1200000, v10
    v_mul_f32 v11, 0xc1200000, v11
    v_mul_f32 v12, 0xc1200000, v12
    v_mul_f32 v13, 0xc1200000, v13
    v_mul_f32 v14, 0xc1200000, v14
    v_mul_f32 v15, 0xc1200000, v15
    v_mul_f32 v16, 0xc1200000, v16
    v_mul_f32 v17, 0xc1200000, v17
    v_mul_f32 v18, 0xc1200000, v18
    v_mul_f32 v19, 0xc1200000, v19
    v_mul_f32 v20, 0xc1200000, v20
    v_mul_f32 v21, 0xc1200000, v21
    v_mul_f32 v22, 0xc1200000, v22
    v_mul_f32 v23, 0xc1200000, v23
    v_cvt_pk_bf16_f32 v8, v8, v9
    v_cvt_pk_bf16_f32 v10, v10, v11
    v_cvt_pk_bf16_f32 v12, v12, v13
    v_cvt_pk_bf16_f32 v14, v14, v15
    v_cvt_pk_bf16_f32 v16, v16, v17
    v_cvt_pk_bf16_f32 v18, v18, v19
    v_cvt_pk_bf16_f32 v20, v20, v21
    v_cvt_pk_bf16_f32 v22, v22, v23
    v_and_b32 v9, 0xffff0000, v8
    v_lshlrev_b32 v8, 16, v8
    v_and_b32 v11, 0xffff0000, v10
    v_lshlrev_b32 v10, 16, v10
    v_and_b32 v13, 0xffff0000, v12
    v_lshlrev_b32 v12, 16, v12
    v_and_b32 v15, 0xffff0000, v14
    v_lshlrev_b32 v14, 16, v14
    v_and_b32 v17, 0xffff0000, v16
    v_lshlrev_b32 v16, 16, v16
    v_and_b32 v19, 0xffff0000, v18
    v_lshlrev_b32 v18, 16, v18
    v_and_b32 v21, 0xffff0000, v20
    v_lshlrev_b32 v20, 16, v20
    v_and_b32 v23, 0xffff0000, v22
    v_lshlrev_b32 v22, 16, v22
    v_mul_f32 v8, 0x3fb8aa3b, v8
    v_mul_f32 v9, 0x3fb8aa3b, v9
    v_mul_f32 v10, 0x3fb8aa3b, v10
    v_mul_f32 v11, 0x3fb8aa3b, v11
    v_mul_f32 v12, 0x3fb8aa3b, v12
    v_mul_f32 v13, 0x3fb8aa3b, v13
    v_mul_f32 v14, 0x3fb8aa3b, v14
    v_mul_f32 v15, 0x3fb8aa3b, v15
    v_mul_f32 v16, 0x3fb8aa3b, v16
    v_mul_f32 v17, 0x3fb8aa3b, v17
    v_mul_f32 v18, 0x3fb8aa3b, v18
    v_mul_f32 v19, 0x3fb8aa3b, v19
    v_mul_f32 v20, 0x3fb8aa3b, v20
    v_mul_f32 v21, 0x3fb8aa3b, v21
    v_mul_f32 v22, 0x3fb8aa3b, v22
    v_mul_f32 v23, 0x3fb8aa3b, v23
    v_exp_f32 v8, v8
    v_exp_f32 v9, v9
    v_exp_f32 v10, v10
    v_exp_f32 v11, v11
    v_exp_f32 v12, v12
    v_exp_f32 v13, v13
    v_exp_f32 v14, v14
    v_exp_f32 v15, v15
    v_exp_f32 v16, v16
    v_exp_f32 v17, v17
    v_exp_f32 v18, v18
    v_exp_f32 v19, v19
    v_exp_f32 v20, v20
    v_exp_f32 v21, v21
    v_exp_f32 v22, v22
    v_exp_f32 v23, v23
    s_nop 0
    v_cvt_pk_bf16_f32 v8, v8, v9
    v_cvt_pk_bf16_f32 v10, v10, v11
    v_cvt_pk_bf16_f32 v12, v12, v13
    v_cvt_pk_bf16_f32 v14, v14, v15
    v_cvt_pk_bf16_f32 v16, v16, v17
    v_cvt_pk_bf16_f32 v18, v18, v19
    v_cvt_pk_bf16_f32 v20, v20, v21
    v_cvt_pk_bf16_f32 v22, v22, v23
    v_and_b32 v9, 0xffff0000, v8
    v_lshlrev_b32 v8, 16, v8
    v_and_b32 v11, 0xffff0000, v10
    v_lshlrev_b32 v10, 16, v10
    v_and_b32 v13, 0xffff0000, v12
    v_lshlrev_b32 v12, 16, v12
    v_and_b32 v15, 0xffff0000, v14
    v_lshlrev_b32 v14, 16, v14
    v_and_b32 v17, 0xffff0000, v16
    v_lshlrev_b32 v16, 16, v16
    v_and_b32 v19, 0xffff0000, v18
    v_lshlrev_b32 v18, 16, v18
    v_and_b32 v21, 0xffff0000, v20
    v_lshlrev_b32 v20, 16, v20
    v_and_b32 v23, 0xffff0000, v22
    v_lshlrev_b32 v22, 16, v22
    s_lshl_b32 s14, s52, 16
    s_and_b32 s15, s52, 0xffff0000
    v_pk_mul_f32 v[24:25], v[8:9], s[14:15] op_sel:[0,0] op_sel_hi:[0,1]
    v_pk_mul_f32 v[28:29], v[16:17], s[14:15] op_sel:[0,0] op_sel_hi:[0,1]
    s_lshl_b32 s16, s53, 16
    s_and_b32 s17, s53, 0xffff0000
    v_pk_mul_f32 v[26:27], v[8:9], s[16:17] op_sel:[0,0] op_sel_hi:[0,1]
    v_pk_mul_f32 v[30:31], v[16:17], s[16:17] op_sel:[0,0] op_sel_hi:[0,1]
    s_lshl_b32 s18, s54, 16
    s_and_b32 s19, s54, 0xffff0000
    v_pk_fma_f32 v[24:25], v[8:9], s[18:19], v[24:25] op_sel:[1,0,0] op_sel_hi:[1,1,1]
    v_pk_fma_f32 v[28:29], v[16:17], s[18:19], v[28:29] op_sel:[1,0,0] op_sel_hi:[1,1,1]
    s_lshl_b32 s12, s55, 16
    s_and_b32 s13, s55, 0xffff0000
    v_pk_fma_f32 v[26:27], v[8:9], s[12:13], v[26:27] op_sel:[1,0,0] op_sel_hi:[1,1,1]
    v_pk_fma_f32 v[30:31], v[16:17], s[12:13], v[30:31] op_sel:[1,0,0] op_sel_hi:[1,1,1]
    s_lshl_b32 s14, s56, 16
    s_and_b32 s15, s56, 0xffff0000
    v_pk_fma_f32 v[24:25], v[10:11], s[14:15], v[24:25] op_sel:[0,0,0] op_sel_hi:[0,1,1]
    v_pk_fma_f32 v[28:29], v[18:19], s[14:15], v[28:29] op_sel:[0,0,0] op_sel_hi:[0,1,1]
    s_lshl_b32 s16, s57, 16
    s_and_b32 s17, s57, 0xffff0000
    v_pk_fma_f32 v[26:27], v[10:11], s[16:17], v[26:27] op_sel:[0,0,0] op_sel_hi:[0,1,1]
    v_pk_fma_f32 v[30:31], v[18:19], s[16:17], v[30:31] op_sel:[0,0,0] op_sel_hi:[0,1,1]
    s_lshl_b32 s18, s58, 16
    s_and_b32 s19, s58, 0xffff0000
    v_pk_fma_f32 v[24:25], v[10:11], s[18:19], v[24:25] op_sel:[1,0,0] op_sel_hi:[1,1,1]
    v_pk_fma_f32 v[28:29], v[18:19], s[18:19], v[28:29] op_sel:[1,0,0] op_sel_hi:[1,1,1]
    s_lshl_b32 s12, s59, 16
    s_and_b32 s13, s59, 0xffff0000
    v_pk_fma_f32 v[26:27], v[10:11], s[12:13], v[26:27] op_sel:[1,0,0] op_sel_hi:[1,1,1]
    v_pk_fma_f32 v[30:31], v[18:19], s[12:13], v[30:31] op_sel:[1,0,0] op_sel_hi:[1,1,1]
    s_lshl_b32 s14, s60, 16
    s_and_b32 s15, s60, 0xffff0000
    v_pk_fma_f32 v[24:25], v[12:13], s[14:15], v[24:25] op_sel:[0,0,0] op_sel_hi:[0,1,1]
    v_pk_fma_f32 v[28:29], v[20:21], s[14:15], v[28:29] op_sel:[0,0,0] op_sel_hi:[0,1,1]
    s_lshl_b32 s16, s61, 16
    s_and_b32 s17, s61, 0xffff0000
    v_pk_fma_f32 v[26:27], v[12:13], s[16:17], v[26:27] op_sel:[0,0,0] op_sel_hi:[0,1,1]
    v_pk_fma_f32 v[30:31], v[20:21], s[16:17], v[30:31] op_sel:[0,0,0] op_sel_hi:[0,1,1]
    s_lshl_b32 s18, s62, 16
    s_and_b32 s19, s62, 0xffff0000
    v_pk_fma_f32 v[24:25], v[12:13], s[18:19], v[24:25] op_sel:[1,0,0] op_sel_hi:[1,1,1]
    v_pk_fma_f32 v[28:29], v[20:21], s[18:19], v[28:29] op_sel:[1,0,0] op_sel_hi:[1,1,1]
    s_lshl_b32 s12, s63, 16
    s_and_b32 s13, s63, 0xffff0000
    v_pk_fma_f32 v[26:27], v[12:13], s[12:13], v[26:27] op_sel:[1,0,0] op_sel_hi:[1,1,1]
    v_pk_fma_f32 v[30:31], v[20:21], s[12:13], v[30:31] op_sel:[1,0,0] op_sel_hi:[1,1,1]
    s_lshl_b32 s14, s64, 16
    s_and_b32 s15, s64, 0xffff0000
    v_pk_fma_f32 v[24:25], v[14:15], s[14:15], v[24:25] op_sel:[0,0,0] op_sel_hi:[0,1,1]
    v_pk_fma_f32 v[28:29], v[22:23], s[14:15], v[28:29] op_sel:[0,0,0] op_sel_hi:[0,1,1]
    s_lshl_b32 s16, s65, 16
    s_and_b32 s17, s65, 0xffff0000
    v_pk_fma_f32 v[26:27], v[14:15], s[16:17], v[26:27] op_sel:[0,0,0] op_sel_hi:[0,1,1]
    v_pk_fma_f32 v[30:31], v[22:23], s[16:17], v[30:31] op_sel:[0,0,0] op_sel_hi:[0,1,1]
    s_lshl_b32 s18, s66, 16
    s_and_b32 s19, s66, 0xffff0000
    v_pk_fma_f32 v[24:25], v[14:15], s[18:19], v[24:25] op_sel:[1,0,0] op_sel_hi:[1,1,1]
    v_pk_fma_f32 v[28:29], v[22:23], s[18:19], v[28:29] op_sel:[1,0,0] op_sel_hi:[1,1,1]
    s_lshl_b32 s12, s67, 16
    s_and_b32 s13, s67, 0xffff0000
    v_pk_fma_f32 v[26:27], v[14:15], s[12:13], v[26:27] op_sel:[1,0,0] op_sel_hi:[1,1,1]
    v_pk_fma_f32 v[30:31], v[22:23], s[12:13], v[30:31] op_sel:[1,0,0] op_sel_hi:[1,1,1]
    s_lshl_b32 s14, s36, 16
    s_and_b32 s15, s36, 0xffff0000
    v_pk_mul_f32 v[32:33], v[8:9], s[14:15] op_sel:[0,0] op_sel_hi:[0,1]
    v_pk_mul_f32 v[36:37], v[16:17], s[14:15] op_sel:[0,0] op_sel_hi:[0,1]
    s_lshl_b32 s16, s37, 16
    s_and_b32 s17, s37, 0xffff0000
    v_pk_mul_f32 v[34:35], v[8:9], s[16:17] op_sel:[0,0] op_sel_hi:[0,1]
    v_pk_mul_f32 v[38:39], v[16:17], s[16:17] op_sel:[0,0] op_sel_hi:[0,1]
    s_lshl_b32 s18, s38, 16
    s_and_b32 s19, s38, 0xffff0000
    v_pk_fma_f32 v[32:33], v[8:9], s[18:19], v[32:33] op_sel:[1,0,0] op_sel_hi:[1,1,1]
    v_pk_fma_f32 v[36:37], v[16:17], s[18:19], v[36:37] op_sel:[1,0,0] op_sel_hi:[1,1,1]
    s_lshl_b32 s12, s39, 16
    s_and_b32 s13, s39, 0xffff0000
    v_pk_fma_f32 v[34:35], v[8:9], s[12:13], v[34:35] op_sel:[1,0,0] op_sel_hi:[1,1,1]
    v_pk_fma_f32 v[38:39], v[16:17], s[12:13], v[38:39] op_sel:[1,0,0] op_sel_hi:[1,1,1]
    s_lshl_b32 s14, s40, 16
    s_and_b32 s15, s40, 0xffff0000
    v_pk_fma_f32 v[32:33], v[10:11], s[14:15], v[32:33] op_sel:[0,0,0] op_sel_hi:[0,1,1]
    v_pk_fma_f32 v[36:37], v[18:19], s[14:15], v[36:37] op_sel:[0,0,0] op_sel_hi:[0,1,1]
    s_lshl_b32 s16, s41, 16
    s_and_b32 s17, s41, 0xffff0000
    v_pk_fma_f32 v[34:35], v[10:11], s[16:17], v[34:35] op_sel:[0,0,0] op_sel_hi:[0,1,1]
    v_pk_fma_f32 v[38:39], v[18:19], s[16:17], v[38:39] op_sel:[0,0,0] op_sel_hi:[0,1,1]
    s_lshl_b32 s18, s42, 16
    s_and_b32 s19, s42, 0xffff0000
    v_pk_fma_f32 v[32:33], v[10:11], s[18:19], v[32:33] op_sel:[1,0,0] op_sel_hi:[1,1,1]
    v_pk_fma_f32 v[36:37], v[18:19], s[18:19], v[36:37] op_sel:[1,0,0] op_sel_hi:[1,1,1]
    s_lshl_b32 s12, s43, 16
    s_and_b32 s13, s43, 0xffff0000
    v_pk_fma_f32 v[34:35], v[10:11], s[12:13], v[34:35] op_sel:[1,0,0] op_sel_hi:[1,1,1]
    v_pk_fma_f32 v[38:39], v[18:19], s[12:13], v[38:39] op_sel:[1,0,0] op_sel_hi:[1,1,1]
    s_lshl_b32 s14, s44, 16
    s_and_b32 s15, s44, 0xffff0000
    v_pk_fma_f32 v[32:33], v[12:13], s[14:15], v[32:33] op_sel:[0,0,0] op_sel_hi:[0,1,1]
    v_pk_fma_f32 v[36:37], v[20:21], s[14:15], v[36:37] op_sel:[0,0,0] op_sel_hi:[0,1,1]
    s_lshl_b32 s16, s45, 16
    s_and_b32 s17, s45, 0xffff0000
    v_pk_fma_f32 v[34:35], v[12:13], s[16:17], v[34:35] op_sel:[0,0,0] op_sel_hi:[0,1,1]
    v_pk_fma_f32 v[38:39], v[20:21], s[16:17], v[38:39] op_sel:[0,0,0] op_sel_hi:[0,1,1]
    s_lshl_b32 s18, s46, 16
    s_and_b32 s19, s46, 0xffff0000
    v_pk_fma_f32 v[32:33], v[12:13], s[18:19], v[32:33] op_sel:[1,0,0] op_sel_hi:[1,1,1]
    v_pk_fma_f32 v[36:37], v[20:21], s[18:19], v[36:37] op_sel:[1,0,0] op_sel_hi:[1,1,1]
    s_lshl_b32 s12, s47, 16
    s_and_b32 s13, s47, 0xffff0000
    v_pk_fma_f32 v[34:35], v[12:13], s[12:13], v[34:35] op_sel:[1,0,0] op_sel_hi:[1,1,1]
    v_pk_fma_f32 v[38:39], v[20:21], s[12:13], v[38:39] op_sel:[1,0,0] op_sel_hi:[1,1,1]
    s_lshl_b32 s14, s48, 16
    s_and_b32 s15, s48, 0xffff0000
    v_pk_fma_f32 v[32:33], v[14:15], s[14:15], v[32:33] op_sel:[0,0,0] op_sel_hi:[0,1,1]
    v_pk_fma_f32 v[36:37], v[22:23], s[14:15], v[36:37] op_sel:[0,0,0] op_sel_hi:[0,1,1]
    s_lshl_b32 s16, s49, 16
    s_and_b32 s17, s49, 0xffff0000
    v_pk_fma_f32 v[34:35], v[14:15], s[16:17], v[34:35] op_sel:[0,0,0] op_sel_hi:[0,1,1]
    v_pk_fma_f32 v[38:39], v[22:23], s[16:17], v[38:39] op_sel:[0,0,0] op_sel_hi:[0,1,1]
    s_lshl_b32 s18, s50, 16
    s_and_b32 s19, s50, 0xffff0000
    v_pk_fma_f32 v[32:33], v[14:15], s[18:19], v[32:33] op_sel:[1,0,0] op_sel_hi:[1,1,1]
    v_pk_fma_f32 v[36:37], v[22:23], s[18:19], v[36:37] op_sel:[1,0,0] op_sel_hi:[1,1,1]
    s_lshl_b32 s12, s51, 16
    s_and_b32 s13, s51, 0xffff0000
    v_pk_fma_f32 v[34:35], v[14:15], s[12:13], v[34:35] op_sel:[1,0,0] op_sel_hi:[1,1,1]
    v_pk_fma_f32 v[38:39], v[22:23], s[12:13], v[38:39] op_sel:[1,0,0] op_sel_hi:[1,1,1]
    v_cvt_pk_bf16_f32 v32, v32, v33
    v_cvt_pk_bf16_f32 v34, v34, v35
    v_cvt_pk_bf16_f32 v36, v36, v37
    v_cvt_pk_bf16_f32 v38, v38, v39
    v_and_b32 v33, 0xffff0000, v32
    v_lshlrev_b32 v32, 16, v32
    v_and_b32 v35, 0xffff0000, v34
    v_lshlrev_b32 v34, 16, v34
    v_and_b32 v37, 0xffff0000, v36
    v_lshlrev_b32 v36, 16, v36
    v_and_b32 v39, 0xffff0000, v38
    v_lshlrev_b32 v38, 16, v38
    s_waitcnt vmcnt(1)
    v_add_u32 v40, v40, v44
    v_add_u32 v48, v48, v52
    v_add_u32 v41, v41, v45
    v_add_u32 v49, v49, v53
    v_add_u32 v42, v42, v46
    v_add_u32 v50, v50, v54
    v_add_u32 v43, v43, v47
    v_add_u32 v51, v51, v55
    v_add_u32_sdwa v8, v40, v48 dst_sel:DWORD dst_unused:UNUSED_PAD src0_sel:WORD_0 src1_sel:WORD_0
    v_add_u32_sdwa v9, v40, v48 dst_sel:DWORD dst_unused:UNUSED_PAD src0_sel:WORD_1 src1_sel:WORD_1
    v_add_u32_sdwa v10, v41, v49 dst_sel:DWORD dst_unused:UNUSED_PAD src0_sel:WORD_0 src1_sel:WORD_0
    v_add_u32_sdwa v11, v41, v49 dst_sel:DWORD dst_unused:UNUSED_PAD src0_sel:WORD_1 src1_sel:WORD_1
    v_add_u32_sdwa v12, v42, v50 dst_sel:DWORD dst_unused:UNUSED_PAD src0_sel:WORD_0 src1_sel:WORD_0
    v_add_u32_sdwa v13, v42, v50 dst_sel:DWORD dst_unused:UNUSED_PAD src0_sel:WORD_1 src1_sel:WORD_1
    v_add_u32_sdwa v14, v43, v51 dst_sel:DWORD dst_unused:UNUSED_PAD src0_sel:WORD_0 src1_sel:WORD_0
    v_add_u32_sdwa v15, v43, v51 dst_sel:DWORD dst_unused:UNUSED_PAD src0_sel:WORD_1 src1_sel:WORD_1
    v_min3_u32 v5, v56, v57, v58
    v_bitop3_b32 v4, v56, v57, v58 bitop3:0xfe
    v_min_u32 v5, v5, v59
    v_or_b32 v4, v4, v59
    v_or_b32 v8, 0x4b000000, v8
    v_or_b32 v9, 0x4b000000, v9
    v_or_b32 v10, 0x4b000000, v10
    v_or_b32 v11, 0x4b000000, v11
    v_or_b32 v12, 0x4b000000, v12
    v_or_b32 v13, 0x4b000000, v13
    v_or_b32 v14, 0x4b000000, v14
    v_or_b32 v15, 0x4b000000, v15
    v_cmp_eq_u32 vcc, 0, v5
    v_add_f32 v8, 0xcb010000, v8
    v_add_f32 v9, 0xcb010000, v9
    v_add_f32 v10, 0xcb010000, v10
    v_add_f32 v11, 0xcb010000, v11
    v_add_f32 v12, 0xcb010000, v12
    v_add_f32 v13, 0xcb010000, v13
    v_add_f32 v14, 0xcb010000, v14
    v_add_f32 v15, 0xcb010000, v15
    v_mul_f32 v8, v4, v8
    v_mul_f32 v9, v4, v9
    v_mul_f32 v10, v4, v10
    v_mul_f32 v11, v4, v11
    v_mul_f32 v12, v4, v12
    v_mul_f32 v13, v4, v13
    v_mul_f32 v14, v4, v14
    v_mul_f32 v15, v4, v15
    s_cbranch_vccz p3_nof
    v_lshlrev_b32 v1, 4, v0
    v_mov_b32 v3, 0x70000000
    v_cmp_eq_u32 vcc, 0, v56
    s_mov_b32 s22, 517903360
    s_nop 0
    v_cndmask_b32 v5, v3, v1, vcc
    buffer_load_dwordx4 v[16:19], v5, s[28:31], s22 offen
    buffer_load_dwordx4 v[20:23], v5, s[28:31], s22 offen offset:16
    s_waitcnt vmcnt(0)
    v_add_f32 v8, v8, v16
    v_add_f32 v9, v9, v17
    v_add_f32 v10, v10, v18
    v_add_f32 v11, v11, v19
    v_add_f32 v12, v12, v20
    v_add_f32 v13, v13, v21
    v_add_f32 v14, v14, v22
    v_add_f32 v15, v15, v23
    v_cmp_eq_u32 vcc, 0, v57
    s_mov_b32 s22, 530715648
    s_nop 0
    v_cndmask_b32 v5, v3, v1, vcc
    buffer_load_dwordx4 v[16:19], v5, s[28:31], s22 offen
    buffer_load_dwordx4 v[20:23], v5, s[28:31], s22 offen offset:16
    s_waitcnt vmcnt(0)
    v_add_f32 v8, v8, v16
    v_add_f32 v9, v9, v17
    v_add_f32 v10, v10, v18
    v_add_f32 v11, v11, v19
    v_add_f32 v12, v12, v20
    v_add_f32 v13, v13, v21
    v_add_f32 v14, v14, v22
    v_add_f32 v15, v15, v23
    v_cmp_eq_u32 vcc, 0, v58
    s_mov_b32 s22, 543527936
    s_nop 0
    v_cndmask_b32 v5, v3, v1, vcc
    buffer_load_dwordx4 v[16:19], v5, s[28:31], s22 offen
    buffer_load_dwordx4 v[20:23], v5, s[28:31], s22 offen offset:16
    s_waitcnt vmcnt(0)
    v_add_f32 v8, v8, v16
    v_add_f32 v9, v9, v17
    v_add_f32 v10, v10, v18
    v_add_f32 v11, v11, v19
    v_add_f32 v12, v12, v20
    v_add_f32 v13, v13, v21
    v_add_f32 v14, v14, v22
    v_add_f32 v15, v15, v23
    v_cmp_eq_u32 vcc, 0, v59
    s_mov_b32 s22, 556340224
    s_nop 0
    v_cndmask_b32 v5, v3, v1, vcc
    buffer_load_dwordx4 v[16:19], v5, s[28:31], s22 offen
    buffer_load_dwordx4 v[20:23], v5, s[28:31], s22 offen offset:16
    s_waitcnt vmcnt(0)
    v_add_f32 v8, v8, v16
    v_add_f32 v9, v9, v17
    v_add_f32 v10, v10, v18
    v_add_f32 v11, v11, v19
    v_add_f32 v12, v12, v20
    v_add_f32 v13, v13, v21
    v_add_f32 v14, v14, v22
    v_add_f32 v15, v15, v23
p3_nof:
    s_lshl_b32 s14, s68, 16
    s_and_b32 s15, s68, 0xffff0000
    v_pk_mul_f32 v[16:17], v[8:9], s[14:15] op_sel:[0,0] op_sel_hi:[0,1]
    v_pk_mul_f32 v[20:21], v[12:13], s[14:15] op_sel:[0,0] op_sel_hi:[0,1]
    s_lshl_b32 s16, s69, 16
    s_and_b32 s17, s69, 0xffff0000
    v_pk_mul_f32 v[18:19], v[8:9], s[16:17] op_sel:[0,0] op_sel_hi:[0,1]
    v_pk_mul_f32 v[22:23], v[12:13], s[16:17] op_sel:[0,0] op_sel_hi:[0,1]
    s_lshl_b32 s18, s70, 16
    s_and_b32 s19, s70, 0xffff0000
    v_pk_fma_f32 v[16:17], v[8:9], s[18:19], v[16:17] op_sel:[1,0,0] op_sel_hi:[1,1,1]
    v_pk_fma_f32 v[20:21], v[12:13], s[18:19], v[20:21] op_sel:[1,0,0] op_sel_hi:[1,1,1]
    s_lshl_b32 s12, s71, 16
    s_and_b32 s13, s71, 0xffff0000
    v_pk_fma_f32 v[18:19], v[8:9], s[12:13], v[18:19] op_sel:[1,0,0] op_sel_hi:[1,1,1]
    v_pk_fma_f32 v[22:23], v[12:13], s[12:13], v[22:23] op_sel:[1,0,0] op_sel_hi:[1,1,1]
    s_lshl_b32 s14, s72, 16
    s_and_b32 s15, s72, 0xffff0000
    v_pk_fma_f32 v[16:17], v[10:11], s[14:15], v[16:17] op_sel:[0,0,0] op_sel_hi:[0,1,1]
    v_pk_fma_f32 v[20:21], v[14:15], s[14:15], v[20:21] op_sel:[0,0,0] op_sel_hi:[0,1,1]
    s_lshl_b32 s16, s73, 16
    s_and_b32 s17, s73, 0xffff0000
    v_pk_fma_f32 v[18:19], v[10:11], s[16:17], v[18:19] op_sel:[0,0,0] op_sel_hi:[0,1,1]
    v_pk_fma_f32 v[22:23], v[14:15], s[16:17], v[22:23] op_sel:[0,0,0] op_sel_hi:[0,1,1]
    s_lshl_b32 s18, s74, 16
    s_and_b32 s19, s74, 0xffff0000
    v_pk_fma_f32 v[16:17], v[10:11], s[18:19], v[16:17] op_sel:[1,0,0] op_sel_hi:[1,1,1]
    v_pk_fma_f32 v[20:21], v[14:15], s[18:19], v[20:21] op_sel:[1,0,0] op_sel_hi:[1,1,1]
    s_lshl_b32 s12, s75, 16
    s_and_b32 s13, s75, 0xffff0000
    v_pk_fma_f32 v[18:19], v[10:11], s[12:13], v[18:19] op_sel:[1,0,0] op_sel_hi:[1,1,1]
    v_pk_fma_f32 v[22:23], v[14:15], s[12:13], v[22:23] op_sel:[1,0,0] op_sel_hi:[1,1,1]
    v_mul_f32 v24, v24, v16
    v_mul_f32 v25, v25, v17
    v_mul_f32 v26, v26, v18
    v_mul_f32 v27, v27, v19
    v_mul_f32 v28, v28, v20
    v_mul_f32 v29, v29, v21
    v_mul_f32 v30, v30, v22
    v_mul_f32 v31, v31, v23
    v_cvt_pk_bf16_f32 v24, v24, v25
    v_cvt_pk_bf16_f32 v26, v26, v27
    v_cvt_pk_bf16_f32 v28, v28, v29
    v_cvt_pk_bf16_f32 v30, v30, v31
    v_and_b32 v25, 0xffff0000, v24
    v_lshlrev_b32 v24, 16, v24
    v_and_b32 v27, 0xffff0000, v26
    v_lshlrev_b32 v26, 16, v26
    v_and_b32 v29, 0xffff0000, v28
    v_lshlrev_b32 v28, 16, v28
    v_and_b32 v31, 0xffff0000, v30
    v_lshlrev_b32 v30, 16, v30
    s_lshl_b32 s14, s76, 16
    s_and_b32 s15, s76, 0xffff0000
    v_pk_mul_f32 v[16:17], v[24:25], s[14:15] op_sel:[0,0] op_sel_hi:[0,1]
    v_pk_mul_f32 v[20:21], v[28:29], s[14:15] op_sel:[0,0] op_sel_hi:[0,1]
    s_lshl_b32 s16, s77, 16
    s_and_b32 s17, s77, 0xffff0000
    v_pk_mul_f32 v[18:19], v[24:25], s[16:17] op_sel:[0,0] op_sel_hi:[0,1]
    v_pk_mul_f32 v[22:23], v[28:29], s[16:17] op_sel:[0,0] op_sel_hi:[0,1]
    s_lshl_b32 s18, s78, 16
    s_and_b32 s19, s78, 0xffff0000
    v_pk_fma_f32 v[16:17], v[24:25], s[18:19], v[16:17] op_sel:[1,0,0] op_sel_hi:[1,1,1]
    v_pk_fma_f32 v[20:21], v[28:29], s[18:19], v[20:21] op_sel:[1,0,0] op_sel_hi:[1,1,1]
    s_lshl_b32 s12, s79, 16
    s_and_b32 s13, s79, 0xffff0000
    v_pk_fma_f32 v[18:19], v[24:25], s[12:13], v[18:19] op_sel:[1,0,0] op_sel_hi:[1,1,1]
    v_pk_fma_f32 v[22:23], v[28:29], s[12:13], v[22:23] op_sel:[1,0,0] op_sel_hi:[1,1,1]
    s_lshl_b32 s14, s80, 16
    s_and_b32 s15, s80, 0xffff0000
    v_pk_fma_f32 v[16:17], v[26:27], s[14:15], v[16:17] op_sel:[0,0,0] op_sel_hi:[0,1,1]
    v_pk_fma_f32 v[20:21], v[30:31], s[14:15], v[20:21] op_sel:[0,0,0] op_sel_hi:[0,1,1]
    s_lshl_b32 s16, s81, 16
    s_and_b32 s17, s81, 0xffff0000
    v_pk_fma_f32 v[18:19], v[26:27], s[16:17], v[18:19] op_sel:[0,0,0] op_sel_hi:[0,1,1]
    v_pk_fma_f32 v[22:23], v[30:31], s[16:17], v[22:23] op_sel:[0,0,0] op_sel_hi:[0,1,1]
    s_lshl_b32 s18, s82, 16
    s_and_b32 s19, s82, 0xffff0000
    v_pk_fma_f32 v[16:17], v[26:27], s[18:19], v[16:17] op_sel:[1,0,0] op_sel_hi:[1,1,1]
    v_pk_fma_f32 v[20:21], v[30:31], s[18:19], v[20:21] op_sel:[1,0,0] op_sel_hi:[1,1,1]
    s_lshl_b32 s12, s83, 16
    s_and_b32 s13, s83, 0xffff0000
    v_pk_fma_f32 v[18:19], v[26:27], s[12:13], v[18:19] op_sel:[1,0,0] op_sel_hi:[1,1,1]
    v_pk_fma_f32 v[22:23], v[30:31], s[12:13], v[22:23] op_sel:[1,0,0] op_sel_hi:[1,1,1]
    v_cvt_pk_bf16_f32 v16, v16, v17
    v_cvt_pk_bf16_f32 v18, v18, v19
    v_cvt_pk_bf16_f32 v20, v20, v21
    v_cvt_pk_bf16_f32 v22, v22, v23
    v_and_b32 v17, 0xffff0000, v16
    v_lshlrev_b32 v16, 16, v16
    v_and_b32 v19, 0xffff0000, v18
    v_lshlrev_b32 v18, 16, v18
    v_and_b32 v21, 0xffff0000, v20
    v_lshlrev_b32 v20, 16, v20
    v_and_b32 v23, 0xffff0000, v22
    v_lshlrev_b32 v22, 16, v22
    v_mul_f32 v16, v16, v32
    v_mul_f32 v17, v17, v33
    v_mul_f32 v18, v18, v34
    v_mul_f32 v19, v19, v35
    v_mul_f32 v20, v20, v36
    v_mul_f32 v21, v21, v37
    v_mul_f32 v22, v22, v38
    v_mul_f32 v23, v23, v39
    v_cvt_pk_bf16_f32 v16, v16, v17
    v_cvt_pk_bf16_f32 v18, v18, v19
    v_cvt_pk_bf16_f32 v20, v20, v21
    v_cvt_pk_bf16_f32 v22, v22, v23
    v_and_b32 v17, 0xffff0000, v16
    v_lshlrev_b32 v16, 16, v16
    v_and_b32 v19, 0xffff0000, v18
    v_lshlrev_b32 v18, 16, v18
    v_and_b32 v21, 0xffff0000, v20
    v_lshlrev_b32 v20, 16, v20
    v_and_b32 v23, 0xffff0000, v22
    v_lshlrev_b32 v22, 16, v22
    s_waitcnt vmcnt(0)
    v_lshlrev_b32 v8, 16, v60
    v_and_b32 v9, 0xffff0000, v60
    v_lshlrev_b32 v10, 16, v61
    v_and_b32 v11, 0xffff0000, v61
    v_lshlrev_b32 v12, 16, v62
    v_and_b32 v13, 0xffff0000, v62
    v_lshlrev_b32 v14, 16, v63
    v_and_b32 v15, 0xffff0000, v63
    v_add_f32 v8, v8, v16
    v_add_f32 v9, v9, v17
    v_add_f32 v10, v10, v18
    v_add_f32 v11, v11, v19
    v_add_f32 v12, v12, v20
    v_add_f32 v13, v13, v21
    v_add_f32 v14, v14, v22
    v_add_f32 v15, v15, v23
    v_cvt_pk_bf16_f32 v4, v8, v9
    v_cvt_pk_bf16_f32 v5, v10, v11
    v_cvt_pk_bf16_f32 v6, v12, v13
    v_cvt_pk_bf16_f32 v7, v14, v15
    buffer_store_dwordx4 v[4:7], v2, s[24:27], 0 offen nt
p3_end:
    s_endpgm
.section .rodata,"a"
.p2align 6
.amdhsa_kernel p1_kernel
  .amdhsa_next_free_vgpr 128
  .amdhsa_next_free_sgpr 72
  .amdhsa_accum_offset 128
  .amdhsa_group_segment_fixed_size 0
  .amdhsa_kernarg_size 112
  .amdhsa_user_sgpr_count 2
  .amdhsa_user_sgpr_kernarg_segment_ptr 1
  .amdhsa_system_sgpr_workgroup_id_x 1
  .amdhsa_float_denorm_mode_32 3
.end_amdhsa_kernel
.p2align 6
.amdhsa_kernel p2_kernel
  .amdhsa_next_free_vgpr 128
  .amdhsa_next_free_sgpr 72
  .amdhsa_accum_offset 128
  .amdhsa_group_segment_fixed_size 0
  .amdhsa_kernarg_size 112
  .amdhsa_user_sgpr_count 2
  .amdhsa_user_sgpr_kernarg_segment_ptr 1
  .amdhsa_system_sgpr_workgroup_id_x 1
  .amdhsa_float_denorm_mode_32 3
.end_amdhsa_kernel
.p2align 6
.amdhsa_kernel p3_kernel
  .amdhsa_next_free_vgpr 64
  .amdhsa_next_free_sgpr 84
  .amdhsa_accum_offset 64
  .amdhsa_group_segment_fixed_size 0
  .amdhsa_kernarg_size 112
  .amdhsa_user_sgpr_count 2
  .amdhsa_user_sgpr_kernarg_segment_ptr 1
  .amdhsa_system_sgpr_workgroup_id_x 1
  .amdhsa_float_denorm_mode_32 3
.end_amdhsa_kernel
```

```asm
; @launch kernel=p1_kernel grid=(256,1,1) block=(1024,1,1) lds=163072
; @launch kernel=p2_kernel grid=(256,1,1) block=(1024,1,1) lds=154368
; @launch kernel=p3_kernel grid=(1563,1,1) block=(256,1,1) lds=0
.amdgcn_target "amdgcn-amd-amdhsa--gfx950"
.text
.globl p1_kernel
.p2align 8
.type p1_kernel,@function
p1_kernel:
    s_cmp_ge_u32 s2, 256
    s_cbranch_scc1 p1_end
    s_load_dwordx2 s[52:53], s[0:1], 0
    s_load_dwordx4 s[56:59], s[0:1], 8
    s_load_dwordx2 s[54:55], s[0:1], 32
    s_load_dwordx2 s[60:61], s[0:1], 48
    s_load_dwordx2 s[48:49], s[0:1], 104
    s_load_dwordx2 s[62:63], s[0:1], 96
    v_lshlrev_b32 v1, 4, v0
    v_lshlrev_b32 v2, 3, v0
    v_mov_b32 v3, 1
    v_lshrrev_b32 v117, 6, v0
    s_nop 0
    v_readfirstlane_b32 s28, v117
    s_waitcnt lgkmcnt(0)
    s_load_dword s45, s[60:61], 0
    s_mov_b32 s4, s56
    s_and_b32 s5, s57, 0xffff
    s_mov_b32 s6, 204800000
    s_mov_b32 s7, 0x20000
    s_mov_b32 s8, s58
    s_and_b32 s9, s59, 0xffff
    s_mov_b32 s10, 204800000
    s_mov_b32 s11, 0x20000
    s_mov_b32 s12, s54
    s_and_b32 s13, s55, 0xffff
    s_mov_b32 s14, 102400000
    s_mov_b32 s15, 0x20000
    s_mov_b32 s16, s48
    s_and_b32 s17, s49, 0xffff
    s_mov_b32 s18, 819200000
    s_mov_b32 s19, 0x20000
    s_mov_b32 s29, s2
    s_mul_i32 s31, s2, 73728
    s_lshl_b32 s30, s31, 1
    s_add_u32 s32, s30, 0
    buffer_load_dwordx4 v[94:97], v1, s[4:7], s32 offen nt
    s_add_u32 s32, s30, 0
    buffer_load_dwordx4 v[102:105], v1, s[8:11], s32 offen nt
    s_add_u32 s32, s31, 0
    buffer_load_dwordx2 v[76:77], v2, s[12:15], s32 offen nt
    s_add_u32 s32, s30, 16384
    buffer_load_dwordx4 v[98:101], v1, s[4:7], s32 offen nt
    s_add_u32 s32, s30, 16384
    buffer_load_dwordx4 v[106:109], v1, s[8:11], s32 offen nt
    s_add_u32 s32, s31, 8192
    buffer_load_dwordx2 v[78:79], v2, s[12:15], s32 offen nt
    s_add_u32 s32, s30, 32768
    buffer_load_dwordx4 v[12:15], v1, s[4:7], s32 offen nt
    s_add_u32 s32, s30, 32768
    buffer_load_dwordx4 v[48:51], v1, s[8:11], s32 offen nt
    s_add_u32 s32, s31, 16384
    buffer_load_dwordx2 v[80:81], v2, s[12:15], s32 offen nt
    s_add_u32 s32, s30, 49152
    buffer_load_dwordx4 v[52:55], v1, s[8:11], s32 offen nt
    s_add_u32 s32, s31, 24576
    buffer_load_dwordx2 v[82:83], v2, s[12:15], s32 offen nt
    s_add_u32 s32, s31, 32768
    buffer_load_dwordx2 v[84:85], v2, s[12:15], s32 offen nt
    s_add_u32 s32, s30, 81920
    buffer_load_dwordx4 v[60:63], v1, s[8:11], s32 offen nt
    s_add_u32 s32, s31, 40960
    buffer_load_dwordx2 v[86:87], v2, s[12:15], s32 offen nt
    s_add_u32 s32, s31, 49152
    buffer_load_dwordx2 v[88:89], v2, s[12:15], s32 offen nt
    s_add_u32 s32, s30, 114688
    buffer_load_dwordx4 v[68:71], v1, s[8:11], s32 offen nt
    s_add_u32 s32, s31, 57344
    buffer_load_dwordx2 v[90:91], v2, s[12:15], s32 offen nt
    s_add_u32 s32, s31, 65536
    buffer_load_dwordx2 v[92:93], v2, s[12:15], s32 offen nt
    s_mov_b32 s24, s52
    s_and_b32 s25, s53, 0xffff
    s_mov_b32 s26, 6400000
    s_mov_b32 s27, 0x20000
    s_mov_b32 s20, s48
    s_and_b32 s21, s49, 0xffff
    s_mov_b32 s22, 0
    s_mov_b32 s23, 0x20000
    s_mov_b32 s40, s62
    s_and_b32 s41, s63, 0xffff
    s_mov_b32 s42, 256
    s_mov_b32 s43, 0x20000
    s_mov_b32 s36, 643827
    s_mov_b32 s37, 214609
    s_mov_b32 s38, 343268
    s_mov_b32 s39, -6671
    s_mov_b32 s44, -12512
    s_mov_b32 s34, 1
    v_mov_b32 v122, 0
    v_mov_b32 v123, 0
    v_mov_b32 v124, 0
    v_mov_b32 v125, 0
    ds_write_b128 v1, v[122:125] offset:0
    s_waitcnt lgkmcnt(0)
    s_barrier
    s_lshl_b32 s45, s45, 16
p1_tile:
    v_mov_b32 v122, 0
    v_mov_b32 v123, 0
    v_mov_b32 v124, 0
    v_mov_b32 v125, 0
    ds_write_b128 v1, v[122:125] offset:10496
    ds_write_b128 v1, v[122:125] offset:26880
    ds_write_b128 v1, v[122:125] offset:43264
    s_cmp_lg_u32 s28, 15
    s_cbranch_scc1 p1_tk0
    v_mov_b32 v127, 1
    s_mov_b64 exec, 1
    buffer_atomic_add v127, off, s[40:43], 0 offset:128 sc0 sc1
    s_mov_b64 exec, -1
p1_tk0:
    v_mov_b32 v123, s45
    v_mov_b32 v124, 0x007f007f
    v_mov_b32 v125, 0xe000
    v_mov_b32 v126, 0xffff0000
    s_cmp_lt_u32 s29, 1426
    s_cselect_b32 s6, 204800000, 0
    s_add_u32 s32, s30, 49152
    buffer_load_dwordx4 v[16:19], v1, s[4:7], s32 offen nt
    s_cmp_lg_u32 s34, 0
    s_cbranch_scc1 p1_w1
    s_waitcnt vmcnt(15)
p1_w1:
    s_waitcnt vmcnt(16)
    v_lshlrev_b32 v117, 16, v76
    v_and_b32 v118, v126, v76
    v_mul_f32 v117, v123, v117
    v_mul_f32 v118, v123, v118
    v_cvt_pk_bf16_f32 v117, v117, v118
    v_and_b32 v118, v126, v117
    v_lshlrev_b32 v117, 16, v117
    v_mul_f32 v117, 0.15915494, v117
    v_mul_f32 v118, 0.15915494, v118
    v_fract_f32 v117, v117
    v_fract_f32 v118, v118
    v_cos_f32 v117, v117
    v_cos_f32 v118, v118
    v_mul_hi_u32_u24 v122, s38, v102
    v_mul_hi_u32_u24 v121, s37, v94
    v_mul_hi_u32_u24 v120, s36, v94
    v_mad_i32_i24 v110, v122, s44, v102
    v_mad_u32_u24 v40, v122, 40, v121
    v_mad_i32_i24 v4, v120, s39, v94
    v_lshlrev_b16 v40, 2, v40
    v_mad_i32_i24 v120, v121, -3, v120
    ds_add_u32 v40, v3 offset:0
    v_lshl_or_b32 v4, v110, 16, v4
    v_lshl_or_b32 v4, v120, 30, v4
    v_mul_f32 v117, 0x03800000, v117
    v_mul_f32 v118, 0x03800000, v118
    v_cvt_pk_bf16_f32 v117, v117, v118
    v_mul_hi_u32_u24 v122, s38, v103
    v_mul_hi_u32_u24 v121, s37, v95
    v_mul_hi_u32_u24 v120, s36, v95
    v_mad_i32_i24 v110, v122, s44, v103
    v_mad_u32_u24 v41, v122, 40, v121
    v_mad_i32_i24 v5, v120, s39, v95
    v_lshlrev_b16 v41, 2, v41
    v_mad_i32_i24 v120, v121, -3, v120
    ds_add_u32 v41, v3 offset:0
    v_lshl_or_b32 v5, v110, 16, v5
    v_lshl_or_b32 v5, v120, 30, v5
    v_lshrrev_b32 v118, 3, v117
    v_lshrrev_b32 v119, 8, v117
    v_lshlrev_b16 v117, 13, v117
    v_bitop3_b32 v119, v118, v119, v124 bitop3:0x1b
    v_bitop3_b32 v4, v117, v125, v4 bitop3:0xae
    v_lshl_or_b32 v40, v119, 16, v40
    v_bitop3_b32 v5, v118, v125, v5 bitop3:0xae
    v_bitop3_b32 v41, v119, v126, v41 bitop3:0xea
    v_lshlrev_b32 v117, 16, v77
    v_and_b32 v118, v126, v77
    v_mul_f32 v117, v123, v117
    v_mul_f32 v118, v123, v118
    v_cvt_pk_bf16_f32 v117, v117, v118
    v_and_b32 v118, v126, v117
    v_lshlrev_b32 v117, 16, v117
    v_mul_f32 v117, 0.15915494, v117
    v_mul_f32 v118, 0.15915494, v118
    v_fract_f32 v117, v117
    v_fract_f32 v118, v118
    v_cos_f32 v117, v117
    v_cos_f32 v118, v118
    v_mul_hi_u32_u24 v122, s38, v104
    v_mul_hi_u32_u24 v121, s37, v96
    v_mul_hi_u32_u24 v120, s36, v96
    v_mad_i32_i24 v110, v122, s44, v104
    v_mad_u32_u24 v42, v122, 40, v121
    v_mad_i32_i24 v6, v120, s39, v96
    v_lshlrev_b16 v42, 2, v42
    v_mad_i32_i24 v120, v121, -3, v120
    ds_add_u32 v42, v3 offset:0
    v_lshl_or_b32 v6, v110, 16, v6
    v_lshl_or_b32 v6, v120, 30, v6
    v_mul_f32 v117, 0x03800000, v117
    v_mul_f32 v118, 0x03800000, v118
    v_cvt_pk_bf16_f32 v117, v117, v118
    v_mul_hi_u32_u24 v122, s38, v105
    v_mul_hi_u32_u24 v121, s37, v97
    v_mul_hi_u32_u24 v120, s36, v97
    v_mad_i32_i24 v110, v122, s44, v105
    v_mad_u32_u24 v43, v122, 40, v121
    v_mad_i32_i24 v7, v120, s39, v97
    v_lshlrev_b16 v43, 2, v43
    v_mad_i32_i24 v120, v121, -3, v120
    ds_add_u32 v43, v3 offset:0
    v_lshl_or_b32 v7, v110, 16, v7
    v_lshl_or_b32 v7, v120, 30, v7
    v_lshrrev_b32 v118, 3, v117
    v_lshrrev_b32 v119, 8, v117
    v_lshlrev_b16 v117, 13, v117
    v_bitop3_b32 v119, v118, v119, v124 bitop3:0x1b
    v_bitop3_b32 v6, v117, v125, v6 bitop3:0xae
    v_lshl_or_b32 v42, v119, 16, v42
    v_bitop3_b32 v7, v118, v125, v7 bitop3:0xae
    v_bitop3_b32 v43, v119, v126, v43 bitop3:0xea
    s_cmp_lt_u32 s29, 1389
    s_cselect_b32 s6, 204800000, 0
    s_add_u32 s32, s30, 65536
    buffer_load_dwordx4 v[20:23], v1, s[4:7], s32 offen nt
    s_cmp_lt_u32 s29, 1389
    s_cselect_b32 s10, 204800000, 0
    s_add_u32 s32, s30, 65536
    buffer_load_dwordx4 v[56:59], v1, s[8:11], s32 offen nt
    s_cmp_ge_u32 s29, 1499
    s_cbranch_scc1 p1_k2
    s_cmp_lg_u32 s34, 0
    s_cbranch_scc1 p1_w3
    s_waitcnt vmcnt(6)
p1_w3:
    s_waitcnt vmcnt(15)
    v_lshlrev_b32 v117, 16, v78
    v_and_b32 v118, v126, v78
    v_mul_f32 v117, v123, v117
    v_mul_f32 v118, v123, v118
    v_cvt_pk_bf16_f32 v117, v117, v118
    v_and_b32 v118, v126, v117
    v_lshlrev_b32 v117, 16, v117
    v_mul_f32 v117, 0.15915494, v117
    v_mul_f32 v118, 0.15915494, v118
    v_fract_f32 v117, v117
    v_fract_f32 v118, v118
    v_cos_f32 v117, v117
    v_cos_f32 v118, v118
    v_mul_hi_u32_u24 v122, s38, v106
    v_mul_hi_u32_u24 v121, s37, v98
    v_mul_hi_u32_u24 v120, s36, v98
    v_mad_i32_i24 v110, v122, s44, v106
    v_mad_u32_u24 v44, v122, 40, v121
    v_mad_i32_i24 v8, v120, s39, v98
    v_lshlrev_b16 v44, 2, v44
    v_mad_i32_i24 v120, v121, -3, v120
    ds_add_u32 v44, v3 offset:0
    v_lshl_or_b32 v8, v110, 16, v8
    v_lshl_or_b32 v8, v120, 30, v8
    v_mul_f32 v117, 0x03800000, v117
    v_mul_f32 v118, 0x03800000, v118
    v_cvt_pk_bf16_f32 v117, v117, v118
    v_mul_hi_u32_u24 v122, s38, v107
    v_mul_hi_u32_u24 v121, s37, v99
    v_mul_hi_u32_u24 v120, s36, v99
    v_mad_i32_i24 v110, v122, s44, v107
    v_mad_u32_u24 v45, v122, 40, v121
    v_mad_i32_i24 v9, v120, s39, v99
    v_lshlrev_b16 v45, 2, v45
    v_mad_i32_i24 v120, v121, -3, v120
    ds_add_u32 v45, v3 offset:0
    v_lshl_or_b32 v9, v110, 16, v9
    v_lshl_or_b32 v9, v120, 30, v9
    v_lshrrev_b32 v118, 3, v117
    v_lshrrev_b32 v119, 8, v117
    v_lshlrev_b16 v117, 13, v117
    v_bitop3_b32 v119, v118, v119, v124 bitop3:0x1b
    v_bitop3_b32 v8, v117, v125, v8 bitop3:0xae
    v_lshl_or_b32 v44, v119, 16, v44
    v_bitop3_b32 v9, v118, v125, v9 bitop3:0xae
    v_bitop3_b32 v45, v119, v126, v45 bitop3:0xea
    v_lshlrev_b32 v117, 16, v79
    v_and_b32 v118, v126, v79
    v_mul_f32 v117, v123, v117
    v_mul_f32 v118, v123, v118
    v_cvt_pk_bf16_f32 v117, v117, v118
    v_and_b32 v118, v126, v117
    v_lshlrev_b32 v117, 16, v117
    v_mul_f32 v117, 0.15915494, v117
    v_mul_f32 v118, 0.15915494, v118
    v_fract_f32 v117, v117
    v_fract_f32 v118, v118
    v_cos_f32 v117, v117
    v_cos_f32 v118, v118
    v_mul_hi_u32_u24 v122, s38, v108
    v_mul_hi_u32_u24 v121, s37, v100
    v_mul_hi_u32_u24 v120, s36, v100
    v_mad_i32_i24 v110, v122, s44, v108
    v_mad_u32_u24 v46, v122, 40, v121
    v_mad_i32_i24 v10, v120, s39, v100
    v_lshlrev_b16 v46, 2, v46
    v_mad_i32_i24 v120, v121, -3, v120
    ds_add_u32 v46, v3 offset:0
    v_lshl_or_b32 v10, v110, 16, v10
    v_lshl_or_b32 v10, v120, 30, v10
    v_mul_f32 v117, 0x03800000, v117
    v_mul_f32 v118, 0x03800000, v118
    v_cvt_pk_bf16_f32 v117, v117, v118
    v_mul_hi_u32_u24 v122, s38, v109
    v_mul_hi_u32_u24 v121, s37, v101
    v_mul_hi_u32_u24 v120, s36, v101
    v_mad_i32_i24 v110, v122, s44, v109
    v_mad_u32_u24 v47, v122, 40, v121
    v_mad_i32_i24 v11, v120, s39, v101
    v_lshlrev_b16 v47, 2, v47
    v_mad_i32_i24 v120, v121, -3, v120
    ds_add_u32 v47, v3 offset:0
    v_lshl_or_b32 v11, v110, 16, v11
    v_lshl_or_b32 v11, v120, 30, v11
    v_lshrrev_b32 v118, 3, v117
    v_lshrrev_b32 v119, 8, v117
    v_lshlrev_b16 v117, 13, v117
    v_bitop3_b32 v119, v118, v119, v124 bitop3:0x1b
    v_bitop3_b32 v10, v117, v125, v10 bitop3:0xae
    v_lshl_or_b32 v46, v119, 16, v46
    v_bitop3_b32 v11, v118, v125, v11 bitop3:0xae
    v_bitop3_b32 v47, v119, v126, v47 bitop3:0xea
p1_k2:
    s_cmp_lt_u32 s29, 1352
    s_cselect_b32 s6, 204800000, 0
    s_add_u32 s32, s30, 81920
    buffer_load_dwordx4 v[24:27], v1, s[4:7], s32 offen nt
    s_cmp_ge_u32 s29, 1462
    s_cbranch_scc1 p1_k4
    s_cmp_lg_u32 s34, 0
    s_cbranch_scc1 p1_w5
    s_waitcnt vmcnt(4)
p1_w5:
    s_waitcnt vmcnt(9)
    v_lshlrev_b32 v117, 16, v80
    v_and_b32 v118, v126, v80
    v_mul_f32 v117, v123, v117
    v_mul_f32 v118, v123, v118
    v_cvt_pk_bf16_f32 v117, v117, v118
    v_and_b32 v118, v126, v117
    v_lshlrev_b32 v117, 16, v117
    v_mul_f32 v117, 0.15915494, v117
    v_mul_f32 v118, 0.15915494, v118
    v_fract_f32 v117, v117
    v_fract_f32 v118, v118
    v_cos_f32 v117, v117
    v_cos_f32 v118, v118
    v_mul_hi_u32_u24 v122, s38, v48
    v_mul_hi_u32_u24 v121, s37, v12
    v_mul_hi_u32_u24 v120, s36, v12
    v_mad_i32_i24 v110, v122, s44, v48
    v_mad_u32_u24 v48, v122, 40, v121
    v_mad_i32_i24 v12, v120, s39, v12
    v_lshlrev_b16 v48, 2, v48
    v_mad_i32_i24 v120, v121, -3, v120
    ds_add_u32 v48, v3 offset:0
    v_lshl_or_b32 v12, v110, 16, v12
    v_lshl_or_b32 v12, v120, 30, v12
    v_mul_f32 v117, 0x03800000, v117
    v_mul_f32 v118, 0x03800000, v118
    v_cvt_pk_bf16_f32 v117, v117, v118
    v_mul_hi_u32_u24 v122, s38, v49
    v_mul_hi_u32_u24 v121, s37, v13
    v_mul_hi_u32_u24 v120, s36, v13
    v_mad_i32_i24 v110, v122, s44, v49
    v_mad_u32_u24 v49, v122, 40, v121
    v_mad_i32_i24 v13, v120, s39, v13
    v_lshlrev_b16 v49, 2, v49
    v_mad_i32_i24 v120, v121, -3, v120
    ds_add_u32 v49, v3 offset:0
    v_lshl_or_b32 v13, v110, 16, v13
    v_lshl_or_b32 v13, v120, 30, v13
    v_lshrrev_b32 v118, 3, v117
    v_lshrrev_b32 v119, 8, v117
    v_lshlrev_b16 v117, 13, v117
    v_bitop3_b32 v119, v118, v119, v124 bitop3:0x1b
    v_bitop3_b32 v12, v117, v125, v12 bitop3:0xae
    v_lshl_or_b32 v48, v119, 16, v48
    v_bitop3_b32 v13, v118, v125, v13 bitop3:0xae
    v_bitop3_b32 v49, v119, v126, v49 bitop3:0xea
    v_lshlrev_b32 v117, 16, v81
    v_and_b32 v118, v126, v81
    v_mul_f32 v117, v123, v117
    v_mul_f32 v118, v123, v118
    v_cvt_pk_bf16_f32 v117, v117, v118
    v_and_b32 v118, v126, v117
    v_lshlrev_b32 v117, 16, v117
    v_mul_f32 v117, 0.15915494, v117
    v_mul_f32 v118, 0.15915494, v118
    v_fract_f32 v117, v117
    v_fract_f32 v118, v118
    v_cos_f32 v117, v117
    v_cos_f32 v118, v118
    v_mul_hi_u32_u24 v122, s38, v50
    v_mul_hi_u32_u24 v121, s37, v14
    v_mul_hi_u32_u24 v120, s36, v14
    v_mad_i32_i24 v110, v122, s44, v50
    v_mad_u32_u24 v50, v122, 40, v121
    v_mad_i32_i24 v14, v120, s39, v14
    v_lshlrev_b16 v50, 2, v50
    v_mad_i32_i24 v120, v121, -3, v120
    ds_add_u32 v50, v3 offset:0
    v_lshl_or_b32 v14, v110, 16, v14
    v_lshl_or_b32 v14, v120, 30, v14
    v_mul_f32 v117, 0x03800000, v117
    v_mul_f32 v118, 0x03800000, v118
    v_cvt_pk_bf16_f32 v117, v117, v118
    v_mul_hi_u32_u24 v122, s38, v51
    v_mul_hi_u32_u24 v121, s37, v15
    v_mul_hi_u32_u24 v120, s36, v15
    v_mad_i32_i24 v110, v122, s44, v51
    v_mad_u32_u24 v51, v122, 40, v121
    v_mad_i32_i24 v15, v120, s39, v15
    v_lshlrev_b16 v51, 2, v51
    v_mad_i32_i24 v120, v121, -3, v120
    ds_add_u32 v51, v3 offset:0
    v_lshl_or_b32 v15, v110, 16, v15
    v_lshl_or_b32 v15, v120, 30, v15
    v_lshrrev_b32 v118, 3, v117
    v_lshrrev_b32 v119, 8, v117
    v_lshlrev_b16 v117, 13, v117
    v_bitop3_b32 v119, v118, v119, v124 bitop3:0x1b
    v_bitop3_b32 v14, v117, v125, v14 bitop3:0xae
    v_lshl_or_b32 v50, v119, 16, v50
    v_bitop3_b32 v15, v118, v125, v15 bitop3:0xae
    v_bitop3_b32 v51, v119, v126, v51 bitop3:0xea
p1_k4:
    s_cmp_lt_u32 s29, 1315
    s_cselect_b32 s6, 204800000, 0
    s_add_u32 s32, s30, 98304
    buffer_load_dwordx4 v[28:31], v1, s[4:7], s32 offen nt
    s_cmp_lt_u32 s29, 1315
    s_cselect_b32 s10, 204800000, 0
    s_add_u32 s32, s30, 98304
    buffer_load_dwordx4 v[64:67], v1, s[8:11], s32 offen nt
    s_cmp_ge_u32 s29, 1426
    s_cbranch_scc1 p1_k6
    s_waitcnt vmcnt(5)
    v_lshlrev_b32 v117, 16, v82
    v_and_b32 v118, v126, v82
    v_mul_f32 v117, v123, v117
    v_mul_f32 v118, v123, v118
    v_cvt_pk_bf16_f32 v117, v117, v118
    v_and_b32 v118, v126, v117
    v_lshlrev_b32 v117, 16, v117
    v_mul_f32 v117, 0.15915494, v117
    v_mul_f32 v118, 0.15915494, v118
    v_fract_f32 v117, v117
    v_fract_f32 v118, v118
    v_cos_f32 v117, v117
    v_cos_f32 v118, v118
    v_mul_hi_u32_u24 v122, s38, v52
    v_mul_hi_u32_u24 v121, s37, v16
    v_mul_hi_u32_u24 v120, s36, v16
    v_mad_i32_i24 v110, v122, s44, v52
    v_mad_u32_u24 v52, v122, 40, v121
    v_mad_i32_i24 v16, v120, s39, v16
    v_lshlrev_b16 v52, 2, v52
    v_mad_i32_i24 v120, v121, -3, v120
    ds_add_u32 v52, v3 offset:0
    v_lshl_or_b32 v16, v110, 16, v16
    v_lshl_or_b32 v16, v120, 30, v16
    v_mul_f32 v117, 0x03800000, v117
    v_mul_f32 v118, 0x03800000, v118
    v_cvt_pk_bf16_f32 v117, v117, v118
    v_mul_hi_u32_u24 v122, s38, v53
    v_mul_hi_u32_u24 v121, s37, v17
    v_mul_hi_u32_u24 v120, s36, v17
    v_mad_i32_i24 v110, v122, s44, v53
    v_mad_u32_u24 v53, v122, 40, v121
    v_mad_i32_i24 v17, v120, s39, v17
    v_lshlrev_b16 v53, 2, v53
    v_mad_i32_i24 v120, v121, -3, v120
    ds_add_u32 v53, v3 offset:0
    v_lshl_or_b32 v17, v110, 16, v17
    v_lshl_or_b32 v17, v120, 30, v17
    v_lshrrev_b32 v118, 3, v117
    v_lshrrev_b32 v119, 8, v117
    v_lshlrev_b16 v117, 13, v117
    v_bitop3_b32 v119, v118, v119, v124 bitop3:0x1b
    v_bitop3_b32 v16, v117, v125, v16 bitop3:0xae
    v_lshl_or_b32 v52, v119, 16, v52
    v_bitop3_b32 v17, v118, v125, v17 bitop3:0xae
    v_bitop3_b32 v53, v119, v126, v53 bitop3:0xea
    v_lshlrev_b32 v117, 16, v83
    v_and_b32 v118, v126, v83
    v_mul_f32 v117, v123, v117
    v_mul_f32 v118, v123, v118
    v_cvt_pk_bf16_f32 v117, v117, v118
    v_and_b32 v118, v126, v117
    v_lshlrev_b32 v117, 16, v117
    v_mul_f32 v117, 0.15915494, v117
    v_mul_f32 v118, 0.15915494, v118
    v_fract_f32 v117, v117
    v_fract_f32 v118, v118
    v_cos_f32 v117, v117
    v_cos_f32 v118, v118
    v_mul_hi_u32_u24 v122, s38, v54
    v_mul_hi_u32_u24 v121, s37, v18
    v_mul_hi_u32_u24 v120, s36, v18
    v_mad_i32_i24 v110, v122, s44, v54
    v_mad_u32_u24 v54, v122, 40, v121
    v_mad_i32_i24 v18, v120, s39, v18
    v_lshlrev_b16 v54, 2, v54
    v_mad_i32_i24 v120, v121, -3, v120
    ds_add_u32 v54, v3 offset:0
    v_lshl_or_b32 v18, v110, 16, v18
    v_lshl_or_b32 v18, v120, 30, v18
    v_mul_f32 v117, 0x03800000, v117
    v_mul_f32 v118, 0x03800000, v118
    v_cvt_pk_bf16_f32 v117, v117, v118
    v_mul_hi_u32_u24 v122, s38, v55
    v_mul_hi_u32_u24 v121, s37, v19
    v_mul_hi_u32_u24 v120, s36, v19
    v_mad_i32_i24 v110, v122, s44, v55
    v_mad_u32_u24 v55, v122, 40, v121
    v_mad_i32_i24 v19, v120, s39, v19
    v_lshlrev_b16 v55, 2, v55
    v_mad_i32_i24 v120, v121, -3, v120
    ds_add_u32 v55, v3 offset:0
    v_lshl_or_b32 v19, v110, 16, v19
    v_lshl_or_b32 v19, v120, 30, v19
    v_lshrrev_b32 v118, 3, v117
    v_lshrrev_b32 v119, 8, v117
    v_lshlrev_b16 v117, 13, v117
    v_bitop3_b32 v119, v118, v119, v124 bitop3:0x1b
    v_bitop3_b32 v18, v117, v125, v18 bitop3:0xae
    v_lshl_or_b32 v54, v119, 16, v54
    v_bitop3_b32 v19, v118, v125, v19 bitop3:0xae
    v_bitop3_b32 v55, v119, v126, v55 bitop3:0xea
p1_k6:
    s_cmp_lt_u32 s29, 1279
    s_cselect_b32 s6, 204800000, 0
    s_add_u32 s32, s30, 114688
    buffer_load_dwordx4 v[32:35], v1, s[4:7], s32 offen nt
    s_cmp_ge_u32 s29, 1389
    s_cbranch_scc1 p1_k8
    s_waitcnt vmcnt(4)
    v_lshlrev_b32 v117, 16, v84
    v_and_b32 v118, v126, v84
    v_mul_f32 v117, v123, v117
    v_mul_f32 v118, v123, v118
    v_cvt_pk_bf16_f32 v117, v117, v118
    v_and_b32 v118, v126, v117
    v_lshlrev_b32 v117, 16, v117
    v_mul_f32 v117, 0.15915494, v117
    v_mul_f32 v118, 0.15915494, v118
    v_fract_f32 v117, v117
    v_fract_f32 v118, v118
    v_cos_f32 v117, v117
    v_cos_f32 v118, v118
    v_mul_hi_u32_u24 v122, s38, v56
    v_mul_hi_u32_u24 v121, s37, v20
    v_mul_hi_u32_u24 v120, s36, v20
    v_mad_i32_i24 v110, v122, s44, v56
    v_mad_u32_u24 v56, v122, 40, v121
    v_mad_i32_i24 v20, v120, s39, v20
    v_lshlrev_b16 v56, 2, v56
    v_mad_i32_i24 v120, v121, -3, v120
    ds_add_u32 v56, v3 offset:0
    v_lshl_or_b32 v20, v110, 16, v20
    v_lshl_or_b32 v20, v120, 30, v20
    v_mul_f32 v117, 0x03800000, v117
    v_mul_f32 v118, 0x03800000, v118
    v_cvt_pk_bf16_f32 v117, v117, v118
    v_mul_hi_u32_u24 v122, s38, v57
    v_mul_hi_u32_u24 v121, s37, v21
    v_mul_hi_u32_u24 v120, s36, v21
    v_mad_i32_i24 v110, v122, s44, v57
    v_mad_u32_u24 v57, v122, 40, v121
    v_mad_i32_i24 v21, v120, s39, v21
    v_lshlrev_b16 v57, 2, v57
    v_mad_i32_i24 v120, v121, -3, v120
    ds_add_u32 v57, v3 offset:0
    v_lshl_or_b32 v21, v110, 16, v21
    v_lshl_or_b32 v21, v120, 30, v21
    v_lshrrev_b32 v118, 3, v117
    v_lshrrev_b32 v119, 8, v117
    v_lshlrev_b16 v117, 13, v117
    v_bitop3_b32 v119, v118, v119, v124 bitop3:0x1b
    v_bitop3_b32 v20, v117, v125, v20 bitop3:0xae
    v_lshl_or_b32 v56, v119, 16, v56
    v_bitop3_b32 v21, v118, v125, v21 bitop3:0xae
    v_bitop3_b32 v57, v119, v126, v57 bitop3:0xea
    v_lshlrev_b32 v117, 16, v85
    v_and_b32 v118, v126, v85
    v_mul_f32 v117, v123, v117
    v_mul_f32 v118, v123, v118
    v_cvt_pk_bf16_f32 v117, v117, v118
    v_and_b32 v118, v126, v117
    v_lshlrev_b32 v117, 16, v117
    v_mul_f32 v117, 0.15915494, v117
    v_mul_f32 v118, 0.15915494, v118
    v_fract_f32 v117, v117
    v_fract_f32 v118, v118
    v_cos_f32 v117, v117
    v_cos_f32 v118, v118
    v_mul_hi_u32_u24 v122, s38, v58
    v_mul_hi_u32_u24 v121, s37, v22
    v_mul_hi_u32_u24 v120, s36, v22
    v_mad_i32_i24 v110, v122, s44, v58
    v_mad_u32_u24 v58, v122, 40, v121
    v_mad_i32_i24 v22, v120, s39, v22
    v_lshlrev_b16 v58, 2, v58
    v_mad_i32_i24 v120, v121, -3, v120
    ds_add_u32 v58, v3 offset:0
    v_lshl_or_b32 v22, v110, 16, v22
    v_lshl_or_b32 v22, v120, 30, v22
    v_mul_f32 v117, 0x03800000, v117
    v_mul_f32 v118, 0x03800000, v118
    v_cvt_pk_bf16_f32 v117, v117, v118
    v_mul_hi_u32_u24 v122, s38, v59
    v_mul_hi_u32_u24 v121, s37, v23
    v_mul_hi_u32_u24 v120, s36, v23
    v_mad_i32_i24 v110, v122, s44, v59
    v_mad_u32_u24 v59, v122, 40, v121
    v_mad_i32_i24 v23, v120, s39, v23
    v_lshlrev_b16 v59, 2, v59
    v_mad_i32_i24 v120, v121, -3, v120
    ds_add_u32 v59, v3 offset:0
    v_lshl_or_b32 v23, v110, 16, v23
    v_lshl_or_b32 v23, v120, 30, v23
    v_lshrrev_b32 v118, 3, v117
    v_lshrrev_b32 v119, 8, v117
    v_lshlrev_b16 v117, 13, v117
    v_bitop3_b32 v119, v118, v119, v124 bitop3:0x1b
    v_bitop3_b32 v22, v117, v125, v22 bitop3:0xae
    v_lshl_or_b32 v58, v119, 16, v58
    v_bitop3_b32 v23, v118, v125, v23 bitop3:0xae
    v_bitop3_b32 v59, v119, v126, v59 bitop3:0xea
p1_k8:
    s_cmp_lt_u32 s29, 1242
    s_cselect_b32 s6, 204800000, 0
    s_add_u32 s32, s30, 131072
    buffer_load_dwordx4 v[36:39], v1, s[4:7], s32 offen nt
    s_cmp_lt_u32 s29, 1242
    s_cselect_b32 s10, 204800000, 0
    s_add_u32 s32, s30, 131072
    buffer_load_dwordx4 v[72:75], v1, s[8:11], s32 offen nt
    s_cmp_ge_u32 s29, 1352
    s_cbranch_scc1 p1_k10
    s_waitcnt vmcnt(5)
    v_lshlrev_b32 v117, 16, v86
    v_and_b32 v118, v126, v86
    v_mul_f32 v117, v123, v117
    v_mul_f32 v118, v123, v118
    v_cvt_pk_bf16_f32 v117, v117, v118
    v_and_b32 v118, v126, v117
    v_lshlrev_b32 v117, 16, v117
    v_mul_f32 v117, 0.15915494, v117
    v_mul_f32 v118, 0.15915494, v118
    v_fract_f32 v117, v117
    v_fract_f32 v118, v118
    v_cos_f32 v117, v117
    v_cos_f32 v118, v118
    v_mul_hi_u32_u24 v122, s38, v60
    v_mul_hi_u32_u24 v121, s37, v24
    v_mul_hi_u32_u24 v120, s36, v24
    v_mad_i32_i24 v110, v122, s44, v60
    v_mad_u32_u24 v60, v122, 40, v121
    v_mad_i32_i24 v24, v120, s39, v24
    v_lshlrev_b16 v60, 2, v60
    v_mad_i32_i24 v120, v121, -3, v120
    ds_add_u32 v60, v3 offset:0
    v_lshl_or_b32 v24, v110, 16, v24
    v_lshl_or_b32 v24, v120, 30, v24
    v_mul_f32 v117, 0x03800000, v117
    v_mul_f32 v118, 0x03800000, v118
    v_cvt_pk_bf16_f32 v117, v117, v118
    v_mul_hi_u32_u24 v122, s38, v61
    v_mul_hi_u32_u24 v121, s37, v25
    v_mul_hi_u32_u24 v120, s36, v25
    v_mad_i32_i24 v110, v122, s44, v61
    v_mad_u32_u24 v61, v122, 40, v121
    v_mad_i32_i24 v25, v120, s39, v25
    v_lshlrev_b16 v61, 2, v61
    v_mad_i32_i24 v120, v121, -3, v120
    ds_add_u32 v61, v3 offset:0
    v_lshl_or_b32 v25, v110, 16, v25
    v_lshl_or_b32 v25, v120, 30, v25
    v_lshrrev_b32 v118, 3, v117
    v_lshrrev_b32 v119, 8, v117
    v_lshlrev_b16 v117, 13, v117
    v_bitop3_b32 v119, v118, v119, v124 bitop3:0x1b
    v_bitop3_b32 v24, v117, v125, v24 bitop3:0xae
    v_lshl_or_b32 v60, v119, 16, v60
    v_bitop3_b32 v25, v118, v125, v25 bitop3:0xae
    v_bitop3_b32 v61, v119, v126, v61 bitop3:0xea
    v_lshlrev_b32 v117, 16, v87
    v_and_b32 v118, v126, v87
    v_mul_f32 v117, v123, v117
    v_mul_f32 v118, v123, v118
    v_cvt_pk_bf16_f32 v117, v117, v118
    v_and_b32 v118, v126, v117
    v_lshlrev_b32 v117, 16, v117
    v_mul_f32 v117, 0.15915494, v117
    v_mul_f32 v118, 0.15915494, v118
    v_fract_f32 v117, v117
    v_fract_f32 v118, v118
    v_cos_f32 v117, v117
    v_cos_f32 v118, v118
    v_mul_hi_u32_u24 v122, s38, v62
    v_mul_hi_u32_u24 v121, s37, v26
    v_mul_hi_u32_u24 v120, s36, v26
    v_mad_i32_i24 v110, v122, s44, v62
    v_mad_u32_u24 v62, v122, 40, v121
    v_mad_i32_i24 v26, v120, s39, v26
    v_lshlrev_b16 v62, 2, v62
    v_mad_i32_i24 v120, v121, -3, v120
    ds_add_u32 v62, v3 offset:0
    v_lshl_or_b32 v26, v110, 16, v26
    v_lshl_or_b32 v26, v120, 30, v26
    v_mul_f32 v117, 0x03800000, v117
    v_mul_f32 v118, 0x03800000, v118
    v_cvt_pk_bf16_f32 v117, v117, v118
    v_mul_hi_u32_u24 v122, s38, v63
    v_mul_hi_u32_u24 v121, s37, v27
    v_mul_hi_u32_u24 v120, s36, v27
    v_mad_i32_i24 v110, v122, s44, v63
    v_mad_u32_u24 v63, v122, 40, v121
    v_mad_i32_i24 v27, v120, s39, v27
    v_lshlrev_b16 v63, 2, v63
    v_mad_i32_i24 v120, v121, -3, v120
    ds_add_u32 v63, v3 offset:0
    v_lshl_or_b32 v27, v110, 16, v27
    v_lshl_or_b32 v27, v120, 30, v27
    v_lshrrev_b32 v118, 3, v117
    v_lshrrev_b32 v119, 8, v117
    v_lshlrev_b16 v117, 13, v117
    v_bitop3_b32 v119, v118, v119, v124 bitop3:0x1b
    v_bitop3_b32 v26, v117, v125, v26 bitop3:0xae
    v_lshl_or_b32 v62, v119, 16, v62
    v_bitop3_b32 v27, v118, v125, v27 bitop3:0xae
    v_bitop3_b32 v63, v119, v126, v63 bitop3:0xea
p1_k10:
    s_cmp_ge_u32 s29, 1315
    s_cbranch_scc1 p1_k12
    s_waitcnt vmcnt(3)
    v_lshlrev_b32 v117, 16, v88
    v_and_b32 v118, v126, v88
    v_mul_f32 v117, v123, v117
    v_mul_f32 v118, v123, v118
    v_cvt_pk_bf16_f32 v117, v117, v118
    v_and_b32 v118, v126, v117
    v_lshlrev_b32 v117, 16, v117
    v_mul_f32 v117, 0.15915494, v117
    v_mul_f32 v118, 0.15915494, v118
    v_fract_f32 v117, v117
    v_fract_f32 v118, v118
    v_cos_f32 v117, v117
    v_cos_f32 v118, v118
    v_mul_hi_u32_u24 v122, s38, v64
    v_mul_hi_u32_u24 v121, s37, v28
    v_mul_hi_u32_u24 v120, s36, v28
    v_mad_i32_i24 v110, v122, s44, v64
    v_mad_u32_u24 v64, v122, 40, v121
    v_mad_i32_i24 v28, v120, s39, v28
    v_lshlrev_b16 v64, 2, v64
    v_mad_i32_i24 v120, v121, -3, v120
    ds_add_u32 v64, v3 offset:0
    v_lshl_or_b32 v28, v110, 16, v28
    v_lshl_or_b32 v28, v120, 30, v28
    v_mul_f32 v117, 0x03800000, v117
    v_mul_f32 v118, 0x03800000, v118
    v_cvt_pk_bf16_f32 v117, v117, v118
    v_mul_hi_u32_u24 v122, s38, v65
    v_mul_hi_u32_u24 v121, s37, v29
    v_mul_hi_u32_u24 v120, s36, v29
    v_mad_i32_i24 v110, v122, s44, v65
    v_mad_u32_u24 v65, v122, 40, v121
    v_mad_i32_i24 v29, v120, s39, v29
    v_lshlrev_b16 v65, 2, v65
    v_mad_i32_i24 v120, v121, -3, v120
    ds_add_u32 v65, v3 offset:0
    v_lshl_or_b32 v29, v110, 16, v29
    v_lshl_or_b32 v29, v120, 30, v29
    v_lshrrev_b32 v118, 3, v117
    v_lshrrev_b32 v119, 8, v117
    v_lshlrev_b16 v117, 13, v117
    v_bitop3_b32 v119, v118, v119, v124 bitop3:0x1b
    v_bitop3_b32 v28, v117, v125, v28 bitop3:0xae
    v_lshl_or_b32 v64, v119, 16, v64
    v_bitop3_b32 v29, v118, v125, v29 bitop3:0xae
    v_bitop3_b32 v65, v119, v126, v65 bitop3:0xea
    v_lshlrev_b32 v117, 16, v89
    v_and_b32 v118, v126, v89
    v_mul_f32 v117, v123, v117
    v_mul_f32 v118, v123, v118
    v_cvt_pk_bf16_f32 v117, v117, v118
    v_and_b32 v118, v126, v117
    v_lshlrev_b32 v117, 16, v117
    v_mul_f32 v117, 0.15915494, v117
    v_mul_f32 v118, 0.15915494, v118
    v_fract_f32 v117, v117
    v_fract_f32 v118, v118
    v_cos_f32 v117, v117
    v_cos_f32 v118, v118
    v_mul_hi_u32_u24 v122, s38, v66
    v_mul_hi_u32_u24 v121, s37, v30
    v_mul_hi_u32_u24 v120, s36, v30
    v_mad_i32_i24 v110, v122, s44, v66
    v_mad_u32_u24 v66, v122, 40, v121
    v_mad_i32_i24 v30, v120, s39, v30
    v_lshlrev_b16 v66, 2, v66
    v_mad_i32_i24 v120, v121, -3, v120
    ds_add_u32 v66, v3 offset:0
    v_lshl_or_b32 v30, v110, 16, v30
    v_lshl_or_b32 v30, v120, 30, v30
    v_mul_f32 v117, 0x03800000, v117
    v_mul_f32 v118, 0x03800000, v118
    v_cvt_pk_bf16_f32 v117, v117, v118
    v_mul_hi_u32_u24 v122, s38, v67
    v_mul_hi_u32_u24 v121, s37, v31
    v_mul_hi_u32_u24 v120, s36, v31
    v_mad_i32_i24 v110, v122, s44, v67
    v_mad_u32_u24 v67, v122, 40, v121
    v_mad_i32_i24 v31, v120, s39, v31
    v_lshlrev_b16 v67, 2, v67
    v_mad_i32_i24 v120, v121, -3, v120
    ds_add_u32 v67, v3 offset:0
    v_lshl_or_b32 v31, v110, 16, v31
    v_lshl_or_b32 v31, v120, 30, v31
    v_lshrrev_b32 v118, 3, v117
    v_lshrrev_b32 v119, 8, v117
    v_lshlrev_b16 v117, 13, v117
    v_bitop3_b32 v119, v118, v119, v124 bitop3:0x1b
    v_bitop3_b32 v30, v117, v125, v30 bitop3:0xae
    v_lshl_or_b32 v66, v119, 16, v66
    v_bitop3_b32 v31, v118, v125, v31 bitop3:0xae
    v_bitop3_b32 v67, v119, v126, v67 bitop3:0xea
p1_k12:
    s_cmp_ge_u32 s29, 1279
    s_cbranch_scc1 p1_k14
    s_waitcnt vmcnt(2)
    v_lshlrev_b32 v117, 16, v90
    v_and_b32 v118, v126, v90
    v_mul_f32 v117, v123, v117
    v_mul_f32 v118, v123, v118
    v_cvt_pk_bf16_f32 v117, v117, v118
    v_and_b32 v118, v126, v117
    v_lshlrev_b32 v117, 16, v117
    v_mul_f32 v117, 0.15915494, v117
    v_mul_f32 v118, 0.15915494, v118
    v_fract_f32 v117, v117
    v_fract_f32 v118, v118
    v_cos_f32 v117, v117
    v_cos_f32 v118, v118
    v_mul_hi_u32_u24 v122, s38, v68
    v_mul_hi_u32_u24 v121, s37, v32
    v_mul_hi_u32_u24 v120, s36, v32
    v_mad_i32_i24 v110, v122, s44, v68
    v_mad_u32_u24 v68, v122, 40, v121
    v_mad_i32_i24 v32, v120, s39, v32
    v_lshlrev_b16 v68, 2, v68
    v_mad_i32_i24 v120, v121, -3, v120
    ds_add_u32 v68, v3 offset:0
    v_lshl_or_b32 v32, v110, 16, v32
    v_lshl_or_b32 v32, v120, 30, v32
    v_mul_f32 v117, 0x03800000, v117
    v_mul_f32 v118, 0x03800000, v118
    v_cvt_pk_bf16_f32 v117, v117, v118
    v_mul_hi_u32_u24 v122, s38, v69
    v_mul_hi_u32_u24 v121, s37, v33
    v_mul_hi_u32_u24 v120, s36, v33
    v_mad_i32_i24 v110, v122, s44, v69
    v_mad_u32_u24 v69, v122, 40, v121
    v_mad_i32_i24 v33, v120, s39, v33
    v_lshlrev_b16 v69, 2, v69
    v_mad_i32_i24 v120, v121, -3, v120
    ds_add_u32 v69, v3 offset:0
    v_lshl_or_b32 v33, v110, 16, v33
    v_lshl_or_b32 v33, v120, 30, v33
    v_lshrrev_b32 v118, 3, v117
    v_lshrrev_b32 v119, 8, v117
    v_lshlrev_b16 v117, 13, v117
    v_bitop3_b32 v119, v118, v119, v124 bitop3:0x1b
    v_bitop3_b32 v32, v117, v125, v32 bitop3:0xae
    v_lshl_or_b32 v68, v119, 16, v68
    v_bitop3_b32 v33, v118, v125, v33 bitop3:0xae
    v_bitop3_b32 v69, v119, v126, v69 bitop3:0xea
    v_lshlrev_b32 v117, 16, v91
    v_and_b32 v118, v126, v91
    v_mul_f32 v117, v123, v117
    v_mul_f32 v118, v123, v118
    v_cvt_pk_bf16_f32 v117, v117, v118
    v_and_b32 v118, v126, v117
    v_lshlrev_b32 v117, 16, v117
    v_mul_f32 v117, 0.15915494, v117
    v_mul_f32 v118, 0.15915494, v118
    v_fract_f32 v117, v117
    v_fract_f32 v118, v118
    v_cos_f32 v117, v117
    v_cos_f32 v118, v118
    v_mul_hi_u32_u24 v122, s38, v70
    v_mul_hi_u32_u24 v121, s37, v34
    v_mul_hi_u32_u24 v120, s36, v34
    v_mad_i32_i24 v110, v122, s44, v70
    v_mad_u32_u24 v70, v122, 40, v121
    v_mad_i32_i24 v34, v120, s39, v34
    v_lshlrev_b16 v70, 2, v70
    v_mad_i32_i24 v120, v121, -3, v120
    ds_add_u32 v70, v3 offset:0
    v_lshl_or_b32 v34, v110, 16, v34
    v_lshl_or_b32 v34, v120, 30, v34
    v_mul_f32 v117, 0x03800000, v117
    v_mul_f32 v118, 0x03800000, v118
    v_cvt_pk_bf16_f32 v117, v117, v118
    v_mul_hi_u32_u24 v122, s38, v71
    v_mul_hi_u32_u24 v121, s37, v35
    v_mul_hi_u32_u24 v120, s36, v35
    v_mad_i32_i24 v110, v122, s44, v71
    v_mad_u32_u24 v71, v122, 40, v121
    v_mad_i32_i24 v35, v120, s39, v35
    v_lshlrev_b16 v71, 2, v71
    v_mad_i32_i24 v120, v121, -3, v120
    ds_add_u32 v71, v3 offset:0
    v_lshl_or_b32 v35, v110, 16, v35
    v_lshl_or_b32 v35, v120, 30, v35
    v_lshrrev_b32 v118, 3, v117
    v_lshrrev_b32 v119, 8, v117
    v_lshlrev_b16 v117, 13, v117
    v_bitop3_b32 v119, v118, v119, v124 bitop3:0x1b
    v_bitop3_b32 v34, v117, v125, v34 bitop3:0xae
    v_lshl_or_b32 v70, v119, 16, v70
    v_bitop3_b32 v35, v118, v125, v35 bitop3:0xae
    v_bitop3_b32 v71, v119, v126, v71 bitop3:0xea
p1_k14:
    s_cmp_ge_u32 s29, 1242
    s_cbranch_scc1 p1_k16
    s_waitcnt vmcnt(0)
    v_lshlrev_b32 v117, 16, v92
    v_and_b32 v118, v126, v92
    v_mul_f32 v117, v123, v117
    v_mul_f32 v118, v123, v118
    v_cvt_pk_bf16_f32 v117, v117, v118
    v_and_b32 v118, v126, v117
    v_lshlrev_b32 v117, 16, v117
    v_mul_f32 v117, 0.15915494, v117
    v_mul_f32 v118, 0.15915494, v118
    v_fract_f32 v117, v117
    v_fract_f32 v118, v118
    v_cos_f32 v117, v117
    v_cos_f32 v118, v118
    v_mul_hi_u32_u24 v122, s38, v72
    v_mul_hi_u32_u24 v121, s37, v36
    v_mul_hi_u32_u24 v120, s36, v36
    v_mad_i32_i24 v110, v122, s44, v72
    v_mad_u32_u24 v72, v122, 40, v121
    v_mad_i32_i24 v36, v120, s39, v36
    v_lshlrev_b16 v72, 2, v72
    v_mad_i32_i24 v120, v121, -3, v120
    ds_add_u32 v72, v3 offset:0
    v_lshl_or_b32 v36, v110, 16, v36
    v_lshl_or_b32 v36, v120, 30, v36
    v_mul_f32 v117, 0x03800000, v117
    v_mul_f32 v118, 0x03800000, v118
    v_cvt_pk_bf16_f32 v117, v117, v118
    v_mul_hi_u32_u24 v122, s38, v73
    v_mul_hi_u32_u24 v121, s37, v37
    v_mul_hi_u32_u24 v120, s36, v37
    v_mad_i32_i24 v110, v122, s44, v73
    v_mad_u32_u24 v73, v122, 40, v121
    v_mad_i32_i24 v37, v120, s39, v37
    v_lshlrev_b16 v73, 2, v73
    v_mad_i32_i24 v120, v121, -3, v120
    ds_add_u32 v73, v3 offset:0
    v_lshl_or_b32 v37, v110, 16, v37
    v_lshl_or_b32 v37, v120, 30, v37
    v_lshrrev_b32 v118, 3, v117
    v_lshrrev_b32 v119, 8, v117
    v_lshlrev_b16 v117, 13, v117
    v_bitop3_b32 v119, v118, v119, v124 bitop3:0x1b
    v_bitop3_b32 v36, v117, v125, v36 bitop3:0xae
    v_lshl_or_b32 v72, v119, 16, v72
    v_bitop3_b32 v37, v118, v125, v37 bitop3:0xae
    v_bitop3_b32 v73, v119, v126, v73 bitop3:0xea
    v_lshlrev_b32 v117, 16, v93
    v_and_b32 v118, v126, v93
    v_mul_f32 v117, v123, v117
    v_mul_f32 v118, v123, v118
    v_cvt_pk_bf16_f32 v117, v117, v118
    v_and_b32 v118, v126, v117
    v_lshlrev_b32 v117, 16, v117
    v_mul_f32 v117, 0.15915494, v117
    v_mul_f32 v118, 0.15915494, v118
    v_fract_f32 v117, v117
    v_fract_f32 v118, v118
    v_cos_f32 v117, v117
    v_cos_f32 v118, v118
    v_mul_hi_u32_u24 v122, s38, v74
    v_mul_hi_u32_u24 v121, s37, v38
    v_mul_hi_u32_u24 v120, s36, v38
    v_mad_i32_i24 v110, v122, s44, v74
    v_mad_u32_u24 v74, v122, 40, v121
    v_mad_i32_i24 v38, v120, s39, v38
    v_lshlrev_b16 v74, 2, v74
    v_mad_i32_i24 v120, v121, -3, v120
    ds_add_u32 v74, v3 offset:0
    v_lshl_or_b32 v38, v110, 16, v38
    v_lshl_or_b32 v38, v120, 30, v38
    v_mul_f32 v117, 0x03800000, v117
    v_mul_f32 v118, 0x03800000, v118
    v_cvt_pk_bf16_f32 v117, v117, v118
    v_mul_hi_u32_u24 v122, s38, v75
    v_mul_hi_u32_u24 v121, s37, v39
    v_mul_hi_u32_u24 v120, s36, v39
    v_mad_i32_i24 v110, v122, s44, v75
    v_mad_u32_u24 v75, v122, 40, v121
    v_mad_i32_i24 v39, v120, s39, v39
    v_lshlrev_b16 v75, 2, v75
    v_mad_i32_i24 v120, v121, -3, v120
    ds_add_u32 v75, v3 offset:0
    v_lshl_or_b32 v39, v110, 16, v39
    v_lshl_or_b32 v39, v120, 30, v39
    v_lshrrev_b32 v118, 3, v117
    v_lshrrev_b32 v119, 8, v117
    v_lshlrev_b16 v117, 13, v117
    v_bitop3_b32 v119, v118, v119, v124 bitop3:0x1b
    v_bitop3_b32 v38, v117, v125, v38 bitop3:0xae
    v_lshl_or_b32 v74, v119, 16, v74
    v_bitop3_b32 v39, v118, v125, v39 bitop3:0xae
    v_bitop3_b32 v75, v119, v126, v75 bitop3:0xea
p1_k16:
    s_waitcnt vmcnt(0)
    s_cmp_lg_u32 s28, 15
    s_cbranch_scc1 p1_tk1
    v_mov_b32 v126, 0
    s_mov_b64 exec, 1
    ds_write_b32 v126, v127 offset:10456
    s_mov_b64 exec, -1
p1_tk1:
    s_waitcnt lgkmcnt(0)
    s_barrier
    s_cmp_ge_u32 s28, 10
    s_cbranch_scc1 p1_s1_skip
    v_and_b32 v126, 63, v0
    s_lshl_b32 s54, s28, 4
    v_mul_u32_u24 v117, 160, v126
    v_add_u32 v117, s54, v117
    ds_read_b128 v[118:121], v117 offset:0
    s_waitcnt lgkmcnt(0)
    v_add_u32 v118, 2, v118
    v_add_u32 v119, 2, v119
    v_add_u32 v120, 2, v120
    v_add_u32 v121, 2, v121
    v_mul_u32_u24 v118, 43691, v118
    v_mul_u32_u24 v119, 43691, v119
    v_mul_u32_u24 v120, 43691, v120
    v_mul_u32_u24 v121, 43691, v121
    v_lshrrev_b32 v118, 17, v118
    v_lshrrev_b32 v119, 17, v119
    v_lshrrev_b32 v120, 17, v120
    v_lshrrev_b32 v121, 17, v121
    v_lshl_or_b32 v122, v119, 16, v118
    v_lshl_or_b32 v123, v121, 16, v120
    v_mov_b32 v124, v122
    v_mov_b32 v125, v123
    s_nop 1
    v_add_u32_dpp v124, v124, v124 row_shr:1 row_mask:0xf bank_mask:0xf bound_ctrl:0
    v_add_u32_dpp v125, v125, v125 row_shr:1 row_mask:0xf bank_mask:0xf bound_ctrl:0
    s_nop 0
    v_add_u32_dpp v124, v124, v124 row_shr:2 row_mask:0xf bank_mask:0xf bound_ctrl:0
    v_add_u32_dpp v125, v125, v125 row_shr:2 row_mask:0xf bank_mask:0xf bound_ctrl:0
    s_nop 0
    v_add_u32_dpp v124, v124, v124 row_shr:4 row_mask:0xf bank_mask:0xf bound_ctrl:0
    v_add_u32_dpp v125, v125, v125 row_shr:4 row_mask:0xf bank_mask:0xf bound_ctrl:0
    s_nop 0
    v_add_u32_dpp v124, v124, v124 row_shr:8 row_mask:0xf bank_mask:0xf bound_ctrl:0
    v_add_u32_dpp v125, v125, v125 row_shr:8 row_mask:0xf bank_mask:0xf bound_ctrl:0
    s_nop 0
    v_add_u32_dpp v124, v124, v124 row_bcast:15 row_mask:0xa bank_mask:0xf
    v_add_u32_dpp v125, v125, v125 row_bcast:15 row_mask:0xa bank_mask:0xf
    s_nop 0
    v_add_u32_dpp v124, v124, v124 row_bcast:31 row_mask:0xc bank_mask:0xf
    v_add_u32_dpp v125, v125, v125 row_bcast:31 row_mask:0xc bank_mask:0xf
    s_nop 0
    s_nop 0
    v_mov_b32 v127, s54
    v_and_b32 v118, 0xffff, v124
    v_lshrrev_b32 v119, 16, v124
    v_and_b32 v120, 0xffff, v125
    v_lshrrev_b32 v121, 16, v125
    s_mov_b64 exec, 1
    s_lshl_b64 exec, exec, 63
    ds_write_b128 v127, v[118:121] offset:10240
    s_mov_b64 exec, -1
p1_s1_skip:
    s_waitcnt lgkmcnt(0)
    s_barrier
    v_and_b32 v127, 63, v0
    v_lshlrev_b32 v118, 2, v127
    v_cmp_gt_u32 vcc, 40, v127
    ds_read_b32 v119, v118 offset:10240
    s_waitcnt lgkmcnt(0)
    v_readlane_b32 s33, v119, 54
    v_cndmask_b32 v119, 0, v119, vcc
    v_mov_b32 v120, v119
    s_nop 1
    v_add_u32_dpp v120, v120, v120 row_shr:1 row_mask:0xf bank_mask:0xf bound_ctrl:0
    s_nop 1
    v_add_u32_dpp v120, v120, v120 row_shr:2 row_mask:0xf bank_mask:0xf bound_ctrl:0
    s_nop 1
    v_add_u32_dpp v120, v120, v120 row_shr:4 row_mask:0xf bank_mask:0xf bound_ctrl:0
    s_nop 1
    v_add_u32_dpp v120, v120, v120 row_shr:8 row_mask:0xf bank_mask:0xf bound_ctrl:0
    s_nop 1
    v_add_u32_dpp v120, v120, v120 row_bcast:15 row_mask:0xa bank_mask:0xf
    s_nop 1
    v_add_u32_dpp v120, v120, v120 row_bcast:31 row_mask:0xc bank_mask:0xf
    s_nop 1
    s_nop 0
    v_sub_u32 v119, v120, v119
    v_readlane_b32 s35, v120, 63
    s_add_u32 s33, s33, 256
    s_mul_i32 s46, s33, 1
    s_min_u32 s47, s33, 1499
    s_add_u32 s46, s46, s47
    s_min_u32 s47, s33, 1462
    s_add_u32 s46, s46, s47
    s_min_u32 s47, s33, 1426
    s_add_u32 s46, s46, s47
    s_min_u32 s47, s33, 1389
    s_add_u32 s46, s46, s47
    s_min_u32 s47, s33, 1352
    s_add_u32 s46, s46, s47
    s_min_u32 s47, s33, 1315
    s_add_u32 s46, s46, s47
    s_min_u32 s47, s33, 1279
    s_add_u32 s46, s46, s47
    s_min_u32 s47, s33, 1242
    s_add_u32 s46, s46, s47
    s_lshl_b32 s30, s46, 14
    s_lshl_b32 s31, s46, 13
    s_cmp_ge_u32 s28, 10
    s_cbranch_scc1 p1_s2_skip
    s_lshl_b32 s54, s28, 2
    s_add_u32 s55, s54, 0
    v_readlane_b32 s56, v119, s55
    s_add_u32 s55, s54, 1
    v_readlane_b32 s57, v119, s55
    s_add_u32 s55, s54, 2
    v_readlane_b32 s58, v119, s55
    s_add_u32 s55, s54, 3
    v_readlane_b32 s59, v119, s55
    s_nop 0
    s_lshl_b32 s57, s57, 16
    s_or_b32 s56, s56, s57
    s_lshl_b32 s59, s59, 16
    s_or_b32 s58, s58, s59
    v_add_u32 v124, s56, v124
    v_add_u32 v125, s58, v125
    v_sub_u32 v122, v124, v122
    v_sub_u32 v123, v125, v123
    v_and_b32 v118, 0xffff, v122
    v_lshrrev_b32 v119, 16, v122
    v_and_b32 v120, 0xffff, v123
    v_lshrrev_b32 v121, 16, v123
    v_mul_u32_u24 v118, 3, v118
    v_mul_u32_u24 v119, 3, v119
    v_mul_u32_u24 v120, 3, v120
    v_mul_u32_u24 v121, 3, v121
    ds_write_b128 v117, v[118:121] offset:0
    s_mul_i32 s55, s29, 5248
    s_mul_i32 s56, s28, 520
    s_add_u32 s55, s55, s56
    s_add_u32 s55, s55, 469762048
    v_lshlrev_b32 v127, 3, v126
    buffer_store_dwordx2 v[122:123], v127, s[16:19], s55 offen sc1
    s_mov_b64 exec, 1
    s_lshl_b64 exec, exec, 63
    buffer_store_dwordx2 v[124:125], v127, s[16:19], s55 offen offset:8 sc1
    s_mov_b64 exec, -1
p1_s2_skip:
    s_mul_i32 s50, s29, 16384
    s_lshr_b32 s52, s35, 10
    s_mul_i32 s52, s52, 33554432
    s_and_b32 s53, s35, 1023
    s_lshl_b32 s53, s53, 4
    s_add_u32 s52, s52, s53
    s_add_u32 s52, s52, s50
    s_min_u32 s22, s52, 469762048
    s_mov_b32 s68, 0
    s_cmp_lt_u32 s28, 12
    s_cselect_b32 s71, 8, 7
    s_cmp_lt_u32 s29, 1242
    s_cselect_b32 s35, 13994, s35
    s_waitcnt lgkmcnt(0)
    s_barrier
    s_cmp_lt_u32 s33, 1536
    s_cbranch_scc1 p1_f0
    s_cmp_lg_u32 s28, 15
    s_cbranch_scc1 p1_hv0
    s_sub_u32 s52, s33, 1536
    s_and_b32 s52, s52, 255
    s_lshl_b32 s58, s52, 2
    s_and_b32 s58, s58, 28
    s_lshl_b32 s53, 1, s58
    v_mov_b32 v127, s53
    s_lshr_b32 s52, s52, 3
    s_lshl_b32 s52, s52, 2
    s_mov_b64 exec, 1
    buffer_atomic_add v127, off, s[40:43], s52 sc0 sc1
    s_mov_b64 exec, -1
p1_hv0:
    s_cmp_ge_u32 s33, 1656
    s_cbranch_scc1 p1_f0
    s_sub_u32 s52, s33, 1536
    s_mul_i32 s52, s52, 53368
    s_mul_i32 s53, s28, 3072
    s_add_u32 s53, s53, s52
    v_and_b32 v92, 63, v0
    v_lshl_add_u32 v93, v92, 2, s53
    s_lshl_b32 s53, s28, 9
    s_add_u32 s53, s53, s52
    s_add_u32 s53, s53, 49152
    s_cmp_lt_u32 s28, 9
    s_cselect_b32 s53, s53, 0x40000000
    v_lshl_add_u32 v94, v92, 2, s53
    buffer_load_dword v76, v93, s[24:27], 0 offen offset:0
    buffer_load_dword v77, v93, s[24:27], 0 offen offset:256
    buffer_load_dword v78, v93, s[24:27], 0 offen offset:512
    buffer_load_dword v79, v93, s[24:27], 0 offen offset:768
    buffer_load_dword v80, v93, s[24:27], 0 offen offset:1024
    buffer_load_dword v81, v93, s[24:27], 0 offen offset:1280
    buffer_load_dword v82, v93, s[24:27], 0 offen offset:1536
    buffer_load_dword v83, v93, s[24:27], 0 offen offset:1792
    buffer_load_dword v84, v93, s[24:27], 0 offen offset:2048
    buffer_load_dword v85, v93, s[24:27], 0 offen offset:2304
    buffer_load_dword v86, v93, s[24:27], 0 offen offset:2560
    buffer_load_dword v87, v93, s[24:27], 0 offen offset:2816
    buffer_load_dword v88, v94, s[24:27], 0 offen offset:0
    buffer_load_dword v89, v94, s[24:27], 0 offen offset:256
p1_f0:
    v_and_b32 v117, 0xffff, v40
    ds_add_rtn_u32 v117, v117, v3 offset:0
    v_and_b32 v118, 0xffff, v41
    ds_add_rtn_u32 v118, v118, v3 offset:0
    v_and_b32 v119, 0xffff, v42
    ds_add_rtn_u32 v119, v119, v3 offset:0
    v_and_b32 v120, 0xffff, v43
    ds_add_rtn_u32 v120, v120, v3 offset:0
    s_cmp_ge_u32 s33, 1536
    s_cbranch_scc1 p1_k18
    s_cmp_lt_u32 s33, 1536
    s_cselect_b32 s6, 204800000, 0
    s_add_u32 s32, s30, 0
    buffer_load_dwordx4 v[94:97], v1, s[4:7], s32 offen nt
p1_k18:
    s_cmp_ge_u32 s33, 1536
    s_cbranch_scc1 p1_k19
    s_cmp_lt_u32 s33, 1536
    s_cselect_b32 s14, 102400000, 0
    s_add_u32 s32, s31, 0
    buffer_load_dwordx2 v[76:77], v2, s[12:15], s32 offen nt
p1_k19:
    s_cmp_ge_u32 s33, 1536
    s_cbranch_scc1 p1_k20
    s_cmp_lt_u32 s33, 1499
    s_cselect_b32 s14, 102400000, 0
    s_add_u32 s32, s31, 8192
    buffer_load_dwordx2 v[78:79], v2, s[12:15], s32 offen nt
p1_k20:
    s_cmp_lt_u32 s29, 1462
    s_cbranch_scc1 p1_pa0
    s_waitcnt lgkmcnt(0)
    s_branch p1_pb0
p1_pa0:
    v_and_b32 v121, 0xffff, v48
    ds_add_rtn_u32 v121, v121, v3 offset:0
    v_and_b32 v122, 0xffff, v49
    ds_add_rtn_u32 v122, v122, v3 offset:0
    v_and_b32 v123, 0xffff, v50
    ds_add_rtn_u32 v123, v123, v3 offset:0
    v_and_b32 v124, 0xffff, v51
    ds_add_rtn_u32 v124, v124, v3 offset:0
    s_waitcnt lgkmcnt(4)
p1_pb0:
    ds_write_b8_d16_hi v117, v40 offset:10496
    v_sub_u32 v40, 55295, v117
    v_lshlrev_b32 v117, 2, v117
    ds_write_b32 v117, v4 offset:52480
    ds_write_b8_d16_hi v118, v41 offset:10496
    v_sub_u32 v41, 55295, v118
    v_lshlrev_b32 v118, 2, v118
    ds_write_b32 v118, v5 offset:52480
    ds_write_b8_d16_hi v119, v42 offset:10496
    v_sub_u32 v42, 55295, v119
    v_lshlrev_b32 v119, 2, v119
    ds_write_b32 v119, v6 offset:52480
    ds_write_b8_d16_hi v120, v43 offset:10496
    v_sub_u32 v43, 55295, v120
    v_lshlrev_b32 v120, 2, v120
    ds_write_b32 v120, v7 offset:52480
    s_cmp_ge_u32 s33, 1536
    s_cbranch_scc1 p1_k21
    s_cmp_lt_u32 s33, 1536
    s_cselect_b32 s10, 204800000, 0
    s_add_u32 s32, s30, 0
    buffer_load_dwordx4 v[102:105], v1, s[8:11], s32 offen nt
p1_k21:
    s_cmp_ge_u32 s33, 1536
    s_cbranch_scc1 p1_k22
    s_cmp_lt_u32 s33, 1462
    s_cselect_b32 s14, 102400000, 0
    s_add_u32 s32, s31, 16384
    buffer_load_dwordx2 v[80:81], v2, s[12:15], s32 offen nt
p1_k22:
    s_cmp_ge_u32 s33, 1536
    s_cbranch_scc1 p1_k23
    s_cmp_lt_u32 s33, 1426
    s_cselect_b32 s14, 102400000, 0
    s_add_u32 s32, s31, 24576
    buffer_load_dwordx2 v[82:83], v2, s[12:15], s32 offen nt
p1_k23:
    s_cmp_lt_u32 s29, 1499
    s_cbranch_scc1 p1_pa1
    s_waitcnt lgkmcnt(0)
    s_branch p1_pb1
p1_pa1:
    v_and_b32 v117, 0xffff, v44
    ds_add_rtn_u32 v117, v117, v3 offset:0
    v_and_b32 v118, 0xffff, v45
    ds_add_rtn_u32 v118, v118, v3 offset:0
    v_and_b32 v119, 0xffff, v46
    ds_add_rtn_u32 v119, v119, v3 offset:0
    v_and_b32 v120, 0xffff, v47
    ds_add_rtn_u32 v120, v120, v3 offset:0
    s_waitcnt lgkmcnt(4)
p1_pb1:
    s_cmp_ge_u32 s29, 1462
    s_cbranch_scc1 p1_k24
    ds_write_b8_d16_hi v121, v48 offset:10496
    v_sub_u32 v48, 55295, v121
    v_lshlrev_b32 v121, 2, v121
    v_lshl_or_b32 v40, v48, 16, v40
    ds_write_b32 v121, v12 offset:52480
    ds_write_b8_d16_hi v122, v49 offset:10496
    v_sub_u32 v49, 55295, v122
    v_lshlrev_b32 v122, 2, v122
    v_lshl_or_b32 v41, v49, 16, v41
    ds_write_b32 v122, v13 offset:52480
    ds_write_b8_d16_hi v123, v50 offset:10496
    v_sub_u32 v50, 55295, v123
    v_lshlrev_b32 v123, 2, v123
    v_lshl_or_b32 v42, v50, 16, v42
    ds_write_b32 v123, v14 offset:52480
    ds_write_b8_d16_hi v124, v51 offset:10496
    v_sub_u32 v51, 55295, v124
    v_lshlrev_b32 v124, 2, v124
    v_lshl_or_b32 v43, v51, 16, v43
    ds_write_b32 v124, v15 offset:52480
p1_k24:
    s_cmp_ge_u32 s33, 1536
    s_cbranch_scc1 p1_k25
    s_cmp_lt_u32 s33, 1462
    s_cselect_b32 s10, 204800000, 0
    s_add_u32 s32, s30, 32768
    buffer_load_dwordx4 v[48:51], v1, s[8:11], s32 offen nt
p1_k25:
    s_cmp_ge_u32 s33, 1536
    s_cbranch_scc1 p1_k26
    s_cmp_lt_u32 s33, 1389
    s_cselect_b32 s14, 102400000, 0
    s_add_u32 s32, s31, 32768
    buffer_load_dwordx2 v[84:85], v2, s[12:15], s32 offen nt
p1_k26:
    s_cmp_ge_u32 s33, 1536
    s_cbranch_scc1 p1_k27
    s_cmp_lt_u32 s33, 1352
    s_cselect_b32 s14, 102400000, 0
    s_add_u32 s32, s31, 40960
    buffer_load_dwordx2 v[86:87], v2, s[12:15], s32 offen nt
p1_k27:
    s_cmp_lt_u32 s29, 1426
    s_cbranch_scc1 p1_pa2
    s_waitcnt lgkmcnt(0)
    s_branch p1_pb2
p1_pa2:
    v_and_b32 v121, 0xffff, v52
    ds_add_rtn_u32 v121, v121, v3 offset:0
    v_and_b32 v122, 0xffff, v53
    ds_add_rtn_u32 v122, v122, v3 offset:0
    v_and_b32 v123, 0xffff, v54
    ds_add_rtn_u32 v123, v123, v3 offset:0
    v_and_b32 v124, 0xffff, v55
    ds_add_rtn_u32 v124, v124, v3 offset:0
    s_waitcnt lgkmcnt(4)
p1_pb2:
    s_cmp_ge_u32 s29, 1499
    s_cbranch_scc1 p1_k28
    ds_write_b8_d16_hi v117, v44 offset:10496
    v_sub_u32 v44, 55295, v117
    v_lshlrev_b32 v117, 2, v117
    ds_write_b32 v117, v8 offset:52480
    ds_write_b8_d16_hi v118, v45 offset:10496
    v_sub_u32 v45, 55295, v118
    v_lshlrev_b32 v118, 2, v118
    ds_write_b32 v118, v9 offset:52480
    ds_write_b8_d16_hi v119, v46 offset:10496
    v_sub_u32 v46, 55295, v119
    v_lshlrev_b32 v119, 2, v119
    ds_write_b32 v119, v10 offset:52480
    ds_write_b8_d16_hi v120, v47 offset:10496
    v_sub_u32 v47, 55295, v120
    v_lshlrev_b32 v120, 2, v120
    ds_write_b32 v120, v11 offset:52480
p1_k28:
    s_cmp_ge_u32 s28, 10
    s_cbranch_scc1 p1_jn
    s_waitcnt vmcnt(0)
    v_mov_b32 v125, 0
    s_mov_b64 exec, 1
    ds_add_rtn_u32 v125, v125, v3 offset:10432
    s_waitcnt lgkmcnt(0)
    v_readfirstlane_b32 s52, v125
    s_lshr_b32 s53, s29, 1
    s_and_b32 s53, s53, 28
    s_cmp_lg_u32 s52, 9
    s_cbranch_scc1 p1_jn1
    s_lshl_b32 s54, 1, s53
    v_mov_b32 v127, s54
    s_lshr_b32 s54, s29, 6
    s_lshl_b32 s54, s54, 2
    s_mov_b32 s68, 1
    buffer_atomic_add v127, off, s[40:43], s54 sc0 sc1
p1_jn1:
    s_mov_b64 exec, -1
p1_jn:
    s_cmp_ge_u32 s33, 1536
    s_cbranch_scc1 p1_k29
    s_cmp_lt_u32 s33, 1499
    s_cselect_b32 s6, 204800000, 0
    s_add_u32 s32, s30, 16384
    buffer_load_dwordx4 v[98:101], v1, s[4:7], s32 offen nt
p1_k29:
    s_cmp_ge_u32 s33, 1536
    s_cbranch_scc1 p1_k30
    s_cmp_lt_u32 s33, 1315
    s_cselect_b32 s14, 102400000, 0
    s_add_u32 s32, s31, 49152
    buffer_load_dwordx2 v[88:89], v2, s[12:15], s32 offen nt
p1_k30:
    s_cmp_ge_u32 s33, 1536
    s_cbranch_scc1 p1_k31
    s_cmp_lt_u32 s33, 1279
    s_cselect_b32 s14, 102400000, 0
    s_add_u32 s32, s31, 57344
    buffer_load_dwordx2 v[90:91], v2, s[12:15], s32 offen nt
p1_k31:
    s_cmp_lt_u32 s29, 1389
    s_cbranch_scc1 p1_pa3
    s_waitcnt lgkmcnt(0)
    s_branch p1_pb3
p1_pa3:
    v_and_b32 v117, 0xffff, v56
    ds_add_rtn_u32 v117, v117, v3 offset:0
    v_and_b32 v118, 0xffff, v57
    ds_add_rtn_u32 v118, v118, v3 offset:0
    v_and_b32 v119, 0xffff, v58
    ds_add_rtn_u32 v119, v119, v3 offset:0
    v_and_b32 v120, 0xffff, v59
    ds_add_rtn_u32 v120, v120, v3 offset:0
    s_waitcnt lgkmcnt(4)
p1_pb3:
    s_cmp_ge_u32 s29, 1426
    s_cbranch_scc1 p1_k32
    ds_write_b8_d16_hi v121, v52 offset:10496
    v_sub_u32 v52, 55295, v121
    v_lshlrev_b32 v121, 2, v121
    v_lshl_or_b32 v44, v52, 16, v44
    ds_write_b32 v121, v16 offset:52480
    ds_write_b8_d16_hi v122, v53 offset:10496
    v_sub_u32 v53, 55295, v122
    v_lshlrev_b32 v122, 2, v122
    v_lshl_or_b32 v45, v53, 16, v45
    ds_write_b32 v122, v17 offset:52480
    ds_write_b8_d16_hi v123, v54 offset:10496
    v_sub_u32 v54, 55295, v123
    v_lshlrev_b32 v123, 2, v123
    v_lshl_or_b32 v46, v54, 16, v46
    ds_write_b32 v123, v18 offset:52480
    ds_write_b8_d16_hi v124, v55 offset:10496
    v_sub_u32 v55, 55295, v124
    v_lshlrev_b32 v124, 2, v124
    v_lshl_or_b32 v47, v55, 16, v47
    ds_write_b32 v124, v19 offset:52480
p1_k32:
    s_cmp_ge_u32 s33, 1536
    s_cbranch_scc1 p1_k33
    s_cmp_lt_u32 s33, 1426
    s_cselect_b32 s10, 204800000, 0
    s_add_u32 s32, s30, 49152
    buffer_load_dwordx4 v[52:55], v1, s[8:11], s32 offen nt
p1_k33:
    s_cmp_ge_u32 s33, 1536
    s_cbranch_scc1 p1_k34
    s_cmp_lt_u32 s33, 1242
    s_cselect_b32 s14, 102400000, 0
    s_add_u32 s32, s31, 65536
    buffer_load_dwordx2 v[92:93], v2, s[12:15], s32 offen nt
p1_k34:
    s_cmp_lt_u32 s29, 1352
    s_cbranch_scc1 p1_pa4
    s_waitcnt lgkmcnt(0)
    s_branch p1_pb4
p1_pa4:
    v_and_b32 v121, 0xffff, v60
    ds_add_rtn_u32 v121, v121, v3 offset:0
    v_and_b32 v122, 0xffff, v61
    ds_add_rtn_u32 v122, v122, v3 offset:0
    v_and_b32 v123, 0xffff, v62
    ds_add_rtn_u32 v123, v123, v3 offset:0
    v_and_b32 v124, 0xffff, v63
    ds_add_rtn_u32 v124, v124, v3 offset:0
    s_waitcnt lgkmcnt(4)
p1_pb4:
    s_cmp_ge_u32 s29, 1389
    s_cbranch_scc1 p1_k35
    ds_write_b8_d16_hi v117, v56 offset:10496
    v_sub_u32 v56, 55295, v117
    v_lshlrev_b32 v117, 2, v117
    ds_write_b32 v117, v20 offset:52480
    ds_write_b8_d16_hi v118, v57 offset:10496
    v_sub_u32 v57, 55295, v118
    v_lshlrev_b32 v118, 2, v118
    ds_write_b32 v118, v21 offset:52480
    ds_write_b8_d16_hi v119, v58 offset:10496
    v_sub_u32 v58, 55295, v119
    v_lshlrev_b32 v119, 2, v119
    ds_write_b32 v119, v22 offset:52480
    ds_write_b8_d16_hi v120, v59 offset:10496
    v_sub_u32 v59, 55295, v120
    v_lshlrev_b32 v120, 2, v120
    ds_write_b32 v120, v23 offset:52480
p1_k35:
    s_cmp_ge_u32 s33, 1536
    s_cbranch_scc1 p1_k36
    s_cmp_lt_u32 s33, 1499
    s_cselect_b32 s10, 204800000, 0
    s_add_u32 s32, s30, 16384
    buffer_load_dwordx4 v[106:109], v1, s[8:11], s32 offen nt
p1_k36:
    s_cmp_lt_u32 s29, 1315
    s_cbranch_scc1 p1_pa5
    s_waitcnt lgkmcnt(0)
    s_branch p1_pb5
p1_pa5:
    v_and_b32 v117, 0xffff, v64
    ds_add_rtn_u32 v117, v117, v3 offset:0
    v_and_b32 v118, 0xffff, v65
    ds_add_rtn_u32 v118, v118, v3 offset:0
    v_and_b32 v119, 0xffff, v66
    ds_add_rtn_u32 v119, v119, v3 offset:0
    v_and_b32 v120, 0xffff, v67
    ds_add_rtn_u32 v120, v120, v3 offset:0
    s_waitcnt lgkmcnt(4)
p1_pb5:
    s_cmp_ge_u32 s29, 1352
    s_cbranch_scc1 p1_k37
    ds_write_b8_d16_hi v121, v60 offset:10496
    v_sub_u32 v60, 55295, v121
    v_lshlrev_b32 v121, 2, v121
    v_lshl_or_b32 v56, v60, 16, v56
    ds_write_b32 v121, v24 offset:52480
    ds_write_b8_d16_hi v122, v61 offset:10496
    v_sub_u32 v61, 55295, v122
    v_lshlrev_b32 v122, 2, v122
    v_lshl_or_b32 v57, v61, 16, v57
    ds_write_b32 v122, v25 offset:52480
    ds_write_b8_d16_hi v123, v62 offset:10496
    v_sub_u32 v62, 55295, v123
    v_lshlrev_b32 v123, 2, v123
    v_lshl_or_b32 v58, v62, 16, v58
    ds_write_b32 v123, v26 offset:52480
    ds_write_b8_d16_hi v124, v63 offset:10496
    v_sub_u32 v63, 55295, v124
    v_lshlrev_b32 v124, 2, v124
    v_lshl_or_b32 v59, v63, 16, v59
    ds_write_b32 v124, v27 offset:52480
p1_k37:
    s_cmp_ge_u32 s33, 1536
    s_cbranch_scc1 p1_k38
    s_cmp_lt_u32 s33, 1352
    s_cselect_b32 s10, 204800000, 0
    s_add_u32 s32, s30, 81920
    buffer_load_dwordx4 v[60:63], v1, s[8:11], s32 offen nt
p1_k38:
    s_cmp_lt_u32 s29, 1279
    s_cbranch_scc1 p1_pa6
    s_waitcnt lgkmcnt(0)
    s_branch p1_pb6
p1_pa6:
    v_and_b32 v121, 0xffff, v68
    ds_add_rtn_u32 v121, v121, v3 offset:0
    v_and_b32 v122, 0xffff, v69
    ds_add_rtn_u32 v122, v122, v3 offset:0
    v_and_b32 v123, 0xffff, v70
    ds_add_rtn_u32 v123, v123, v3 offset:0
    v_and_b32 v124, 0xffff, v71
    ds_add_rtn_u32 v124, v124, v3 offset:0
    s_waitcnt lgkmcnt(4)
p1_pb6:
    s_cmp_ge_u32 s29, 1315
    s_cbranch_scc1 p1_k39
    ds_write_b8_d16_hi v117, v64 offset:10496
    v_sub_u32 v64, 55295, v117
    v_lshlrev_b32 v117, 2, v117
    ds_write_b32 v117, v28 offset:52480
    ds_write_b8_d16_hi v118, v65 offset:10496
    v_sub_u32 v65, 55295, v118
    v_lshlrev_b32 v118, 2, v118
    ds_write_b32 v118, v29 offset:52480
    ds_write_b8_d16_hi v119, v66 offset:10496
    v_sub_u32 v66, 55295, v119
    v_lshlrev_b32 v119, 2, v119
    ds_write_b32 v119, v30 offset:52480
    ds_write_b8_d16_hi v120, v67 offset:10496
    v_sub_u32 v67, 55295, v120
    v_lshlrev_b32 v120, 2, v120
    ds_write_b32 v120, v31 offset:52480
p1_k39:
    s_cmp_lt_u32 s29, 1242
    s_cbranch_scc1 p1_pa7
    s_waitcnt lgkmcnt(0)
    s_branch p1_pb7
p1_pa7:
    v_and_b32 v117, 0xffff, v72
    ds_add_rtn_u32 v117, v117, v3 offset:0
    v_and_b32 v118, 0xffff, v73
    ds_add_rtn_u32 v118, v118, v3 offset:0
    v_and_b32 v119, 0xffff, v74
    ds_add_rtn_u32 v119, v119, v3 offset:0
    v_and_b32 v120, 0xffff, v75
    ds_add_rtn_u32 v120, v120, v3 offset:0
    s_waitcnt lgkmcnt(4)
p1_pb7:
    s_cmp_ge_u32 s29, 1279
    s_cbranch_scc1 p1_k40
    ds_write_b8_d16_hi v121, v68 offset:10496
    v_sub_u32 v68, 55295, v121
    v_lshlrev_b32 v121, 2, v121
    v_lshl_or_b32 v64, v68, 16, v64
    ds_write_b32 v121, v32 offset:52480
    ds_write_b8_d16_hi v122, v69 offset:10496
    v_sub_u32 v69, 55295, v122
    v_lshlrev_b32 v122, 2, v122
    v_lshl_or_b32 v65, v69, 16, v65
    ds_write_b32 v122, v33 offset:52480
    ds_write_b8_d16_hi v123, v70 offset:10496
    v_sub_u32 v70, 55295, v123
    v_lshlrev_b32 v123, 2, v123
    v_lshl_or_b32 v66, v70, 16, v66
    ds_write_b32 v123, v34 offset:52480
    ds_write_b8_d16_hi v124, v71 offset:10496
    v_sub_u32 v71, 55295, v124
    v_lshlrev_b32 v124, 2, v124
    v_lshl_or_b32 v67, v71, 16, v67
    ds_write_b32 v124, v35 offset:52480
p1_k40:
    s_cmp_ge_u32 s33, 1536
    s_cbranch_scc1 p1_k41
    s_cmp_lt_u32 s33, 1279
    s_cselect_b32 s10, 204800000, 0
    s_add_u32 s32, s30, 114688
    buffer_load_dwordx4 v[68:71], v1, s[8:11], s32 offen nt
p1_k41:
    s_waitcnt lgkmcnt(0)
    s_cmp_ge_u32 s29, 1242
    s_cbranch_scc1 p1_k42
    ds_write_b8_d16_hi v117, v72 offset:10496
    v_sub_u32 v72, 55295, v117
    v_lshlrev_b32 v117, 2, v117
    ds_write_b32 v117, v36 offset:52480
    ds_write_b8_d16_hi v118, v73 offset:10496
    v_sub_u32 v73, 55295, v118
    v_lshlrev_b32 v118, 2, v118
    ds_write_b32 v118, v37 offset:52480
    ds_write_b8_d16_hi v119, v74 offset:10496
    v_sub_u32 v74, 55295, v119
    v_lshlrev_b32 v119, 2, v119
    ds_write_b32 v119, v38 offset:52480
    ds_write_b8_d16_hi v120, v75 offset:10496
    v_sub_u32 v75, 55295, v120
    v_lshlrev_b32 v120, 2, v120
    ds_write_b32 v120, v39 offset:52480
p1_k42:
    s_cmp_eq_u32 s68, 0
    s_cbranch_scc1 p1_sg
    s_cmp_lt_u32 s33, 1536
    s_cbranch_scc1 p1_w43
    s_waitcnt vmcnt(0)
p1_w43:
    s_waitcnt vmcnt(8)
    v_bfe_u32 v127, v127, s53, 4
    v_mov_b32 v125, 0
    s_mov_b64 exec, 1
    ds_write_b32 v125, v127 offset:10452
    s_mov_b64 exec, -1
p1_sg:
    s_cmp_lt_u32 s33, 1536
    s_cbranch_scc1 p1_f1
    s_cmp_lg_u32 s28, 15
    s_cbranch_scc1 p1_hv1
    s_waitcnt vmcnt(0)
    v_bfe_u32 v127, v127, s58, 4
    v_mov_b32 v125, 0
    s_mov_b64 exec, 1
    ds_write_b32 v125, v127 offset:10448
    s_mov_b64 exec, -1
p1_hv1:
    s_cmp_ge_u32 s33, 1656
    s_cbranch_scc1 p1_f1
    s_sub_u32 s52, s33, 1536
    s_mul_i32 s53, s52, 53760
    s_add_u32 s53, s53, 485810176
    s_mul_i32 s54, s28, 3072
    v_lshl_add_u32 v93, v92, 4, s54
    s_lshl_b32 s54, s28, 9
    s_add_u32 s54, s54, 49152
    s_cmp_lt_u32 s28, 9
    s_cselect_b32 s54, s54, 0x40000000
    v_lshl_add_u32 v94, v92, 3, s54
    v_mov_b32 v96, 0
    v_mov_b32 v97, 0
    s_waitcnt vmcnt(0)
    buffer_store_dwordx4 v[76:79], v93, s[16:19], s53 offen offset:0
    buffer_store_dwordx4 v[80:83], v93, s[16:19], s53 offen offset:1024
    buffer_store_dwordx4 v[84:87], v93, s[16:19], s53 offen offset:2048
    buffer_store_dwordx2 v[88:89], v94, s[16:19], s53 offen
    v_and_b32 v98, 0x7fff7fff, v76
    v_pk_max_u16 v96, v96, v98
    v_lshlrev_b32 v99, 16, v98
    v_and_b32 v98, 0xffff0000, v98
    v_fmac_f32 v97, v99, v99
    v_fmac_f32 v97, v98, v98
    v_and_b32 v98, 0x7fff7fff, v77
    v_pk_max_u16 v96, v96, v98
    v_lshlrev_b32 v99, 16, v98
    v_and_b32 v98, 0xffff0000, v98
    v_fmac_f32 v97, v99, v99
    v_fmac_f32 v97, v98, v98
    v_and_b32 v98, 0x7fff7fff, v78
    v_pk_max_u16 v96, v96, v98
    v_lshlrev_b32 v99, 16, v98
    v_and_b32 v98, 0xffff0000, v98
    v_fmac_f32 v97, v99, v99
    v_fmac_f32 v97, v98, v98
    v_and_b32 v98, 0x7fff7fff, v79
    v_pk_max_u16 v96, v96, v98
    v_lshlrev_b32 v99, 16, v98
    v_and_b32 v98, 0xffff0000, v98
    v_fmac_f32 v97, v99, v99
    v_fmac_f32 v97, v98, v98
    v_and_b32 v98, 0x7fff7fff, v80
    v_pk_max_u16 v96, v96, v98
    v_lshlrev_b32 v99, 16, v98
    v_and_b32 v98, 0xffff0000, v98
    v_fmac_f32 v97, v99, v99
    v_fmac_f32 v97, v98, v98
    v_and_b32 v98, 0x7fff7fff, v81
    v_pk_max_u16 v96, v96, v98
    v_lshlrev_b32 v99, 16, v98
    v_and_b32 v98, 0xffff0000, v98
    v_fmac_f32 v97, v99, v99
    v_fmac_f32 v97, v98, v98
    v_and_b32 v98, 0x7fff7fff, v82
    v_pk_max_u16 v96, v96, v98
    v_lshlrev_b32 v99, 16, v98
    v_and_b32 v98, 0xffff0000, v98
    v_fmac_f32 v97, v99, v99
    v_fmac_f32 v97, v98, v98
    v_and_b32 v98, 0x7fff7fff, v83
    v_pk_max_u16 v96, v96, v98
    v_lshlrev_b32 v99, 16, v98
    v_and_b32 v98, 0xffff0000, v98
    v_fmac_f32 v97, v99, v99
    v_fmac_f32 v97, v98, v98
    v_and_b32 v98, 0x7fff7fff, v84
    v_pk_max_u16 v96, v96, v98
    v_lshlrev_b32 v99, 16, v98
    v_and_b32 v98, 0xffff0000, v98
    v_fmac_f32 v97, v99, v99
    v_fmac_f32 v97, v98, v98
    v_and_b32 v98, 0x7fff7fff, v85
    v_pk_max_u16 v96, v96, v98
    v_lshlrev_b32 v99, 16, v98
    v_and_b32 v98, 0xffff0000, v98
    v_fmac_f32 v97, v99, v99
    v_fmac_f32 v97, v98, v98
    v_and_b32 v98, 0x7fff7fff, v86
    v_pk_max_u16 v96, v96, v98
    v_lshlrev_b32 v99, 16, v98
    v_and_b32 v98, 0xffff0000, v98
    v_fmac_f32 v97, v99, v99
    v_fmac_f32 v97, v98, v98
    v_and_b32 v98, 0x7fff7fff, v87
    v_pk_max_u16 v96, v96, v98
    v_lshlrev_b32 v99, 16, v98
    v_and_b32 v98, 0xffff0000, v98
    v_fmac_f32 v97, v99, v99
    v_fmac_f32 v97, v98, v98
    v_and_b32 v98, 0x7fff7fff, v88
    v_pk_max_u16 v96, v96, v98
    v_lshlrev_b32 v99, 16, v98
    v_and_b32 v98, 0xffff0000, v98
    v_fmac_f32 v97, v99, v99
    v_fmac_f32 v97, v98, v98
    v_and_b32 v98, 0x7fff7fff, v89
    v_pk_max_u16 v96, v96, v98
    v_lshlrev_b32 v99, 16, v98
    v_and_b32 v98, 0xffff0000, v98
    v_fmac_f32 v97, v99, v99
    v_fmac_f32 v97, v98, v98
    v_lshrrev_b32 v98, 16, v96
    v_and_b32 v96, 0xffff, v96
    v_max_u32 v96, v96, v98
    s_nop 1
    v_max_u32_dpp v96, v96, v96 row_shr:1 row_mask:0xf bank_mask:0xf bound_ctrl:0
    v_add_f32_dpp v97, v97, v97 row_shr:1 row_mask:0xf bank_mask:0xf bound_ctrl:0
    s_nop 0
    v_max_u32_dpp v96, v96, v96 row_shr:2 row_mask:0xf bank_mask:0xf bound_ctrl:0
    v_add_f32_dpp v97, v97, v97 row_shr:2 row_mask:0xf bank_mask:0xf bound_ctrl:0
    s_nop 0
    v_max_u32_dpp v96, v96, v96 row_shr:4 row_mask:0xf bank_mask:0xf bound_ctrl:0
    v_add_f32_dpp v97, v97, v97 row_shr:4 row_mask:0xf bank_mask:0xf bound_ctrl:0
    s_nop 0
    v_max_u32_dpp v96, v96, v96 row_shr:8 row_mask:0xf bank_mask:0xf bound_ctrl:0
    v_add_f32_dpp v97, v97, v97 row_shr:8 row_mask:0xf bank_mask:0xf bound_ctrl:0
    s_nop 0
    v_max_u32_dpp v96, v96, v96 row_bcast:15 row_mask:0xa bank_mask:0xf
    v_add_f32_dpp v97, v97, v97 row_bcast:15 row_mask:0xa bank_mask:0xf
    s_nop 0
    v_max_u32_dpp v96, v96, v96 row_bcast:31 row_mask:0xc bank_mask:0xf
    v_add_f32_dpp v97, v97, v97 row_bcast:31 row_mask:0xc bank_mask:0xf
    s_nop 0
    s_nop 0
    s_lshl_b32 s52, s52, 4
    s_add_u32 s52, s52, s28
    s_lshl_b32 s52, s52, 3
    s_add_u32 s52, s52, 492261376
    s_mov_b64 exec, 1
    s_lshl_b64 exec, exec, 63
    buffer_store_dwordx2 v[96:97], off, s[16:19], s52
    s_mov_b64 exec, -1
p1_f1:
    s_waitcnt lgkmcnt(0)
    s_barrier
    v_mul_u32_u24 v119, 3, v0
    v_and_b32 v118, -4, v119
    v_add_u32 v120, s50, v1
    v_mov_b32 v122, 0
    v_mov_b32 v123, 0
    v_mov_b32 v124, 0
    v_mov_b32 v125, 0
    ds_read_b64 v[126:127], v122 offset:10448
    ds_write_b32 v122, v122 offset:10432
    v_cmp_gt_u32 vcc, 640, v0
    s_and_saveexec_b64 s[52:53], vcc
    ds_write_b128 v1, v[122:125] offset:0
    s_mov_b64 exec, -1
    s_waitcnt lgkmcnt(2)
    v_readfirstlane_b32 s70, v126
    v_readfirstlane_b32 s69, v127
    s_cmp_ge_u32 s33, 1536
    s_cselect_b32 s70, s70, 0
    s_cmp_gt_u32 s28, 10
    s_cselect_b32 s69, 0, s69
    s_cselect_b32 s70, 0, s70
    s_cmp_lg_u32 s70, 8
    s_cbranch_scc1 p1_h0
    s_sub_u32 s52, s33, 1536
    v_and_b32 v102, 63, v0
    s_cmp_eq_u32 s28, 10
    s_cbranch_scc1 p1_tr10
    s_mul_i32 s53, s28, 520
    v_lshl_add_u32 v100, v102, 3, s53
    s_mul_i32 s53, s28, 4160
    v_lshl_add_u32 v101, v102, 4, s53
    s_branch p1_tr20
p1_tr10:
    v_mul_u32_u24 v100, 520, v102
    v_add_u32 v100, 512, v100
    v_mul_u32_u24 v101, 4160, v102
    v_add_u32 v101, 1024, v101
    v_cmp_gt_u32 vcc, 10, v102
    v_mov_b32 v102, 0x40000000
    s_nop 0
    v_cndmask_b32 v100, v102, v100, vcc
    v_cndmask_b32 v101, v102, v101, vcc
p1_tr20:
    s_mul_i32 s52, s52, 41984
    s_add_u32 s52, s52, 469762048
    buffer_load_dwordx2 v[76:77], v100, s[16:19], s52 offen sc1
    s_add_u32 s52, s52, 5248
    buffer_load_dwordx2 v[78:79], v100, s[16:19], s52 offen sc1
    s_add_u32 s52, s52, 5248
    buffer_load_dwordx2 v[80:81], v100, s[16:19], s52 offen sc1
    s_add_u32 s52, s52, 5248
    buffer_load_dwordx2 v[82:83], v100, s[16:19], s52 offen sc1
    s_add_u32 s52, s52, 5248
    buffer_load_dwordx2 v[84:85], v100, s[16:19], s52 offen sc1
    s_add_u32 s52, s52, 5248
    buffer_load_dwordx2 v[86:87], v100, s[16:19], s52 offen sc1
    s_add_u32 s52, s52, 5248
    buffer_load_dwordx2 v[88:89], v100, s[16:19], s52 offen sc1
    s_add_u32 s52, s52, 5248
    buffer_load_dwordx2 v[90:91], v100, s[16:19], s52 offen sc1
    s_add_u32 s52, s52, 5248
p1_h0:
    v_lshlrev_b32 v117, 2, v119
    v_add_u32 v117, 52480, v117
    ds_read_b32 v110, v117 offset:0
    ds_read_b32 v111, v117 offset:4
    ds_read_b32 v112, v117 offset:8
    ds_read_b32 v113, v118 offset:10496
    ds_read_b32 v114, v118 offset:10500
    ds_read_b32 v122, v117 offset:12288
    ds_read_b32 v123, v117 offset:12292
    ds_read_b32 v124, v117 offset:12296
    ds_read_b32 v125, v118 offset:13568
    ds_read_b32 v121, v118 offset:13572
    s_waitcnt lgkmcnt(5)
    v_alignbyte_b32 v113, v114, v113, v119
    buffer_store_dwordx4 v[110:113], v120, s[20:23], 0 offen
    v_add_u32 v120, 33554432, v120
    s_nop 0
    ds_read_b32 v110, v117 offset:24576
    ds_read_b32 v111, v117 offset:24580
    ds_read_b32 v112, v117 offset:24584
    ds_read_b32 v113, v118 offset:16640
    ds_read_b32 v114, v118 offset:16644
    s_cmp_le_u32 s35, 1024
    s_cbranch_scc1 p1_ce0
    s_waitcnt lgkmcnt(5)
    v_alignbyte_b32 v125, v121, v125, v119
    buffer_store_dwordx4 v[122:125], v120, s[20:23], 0 offen
    v_add_u32 v120, 33554432, v120
    s_nop 0
    ds_read_b32 v122, v117 offset:36864
    ds_read_b32 v123, v117 offset:36868
    ds_read_b32 v124, v117 offset:36872
    ds_read_b32 v125, v118 offset:19712
    ds_read_b32 v121, v118 offset:19716
    s_cmp_le_u32 s35, 2048
    s_cbranch_scc1 p1_ce0
    s_waitcnt lgkmcnt(5)
    v_alignbyte_b32 v113, v114, v113, v119
    buffer_store_dwordx4 v[110:113], v120, s[20:23], 0 offen
    v_add_u32 v120, 33554432, v120
    s_nop 0
    ds_read_b32 v110, v117 offset:49152
    ds_read_b32 v111, v117 offset:49156
    ds_read_b32 v112, v117 offset:49160
    ds_read_b32 v113, v118 offset:22784
    ds_read_b32 v114, v118 offset:22788
    s_cmp_le_u32 s35, 3072
    s_cbranch_scc1 p1_ce0
    s_waitcnt lgkmcnt(5)
    v_alignbyte_b32 v125, v121, v125, v119
    buffer_store_dwordx4 v[122:125], v120, s[20:23], 0 offen
    v_add_u32 v120, 33554432, v120
    s_nop 0
    v_lshlrev_b32 v117, 2, v119
    v_add_u32 v117, 113920, v117
    ds_read_b32 v122, v117 offset:0
    ds_read_b32 v123, v117 offset:4
    ds_read_b32 v124, v117 offset:8
    ds_read_b32 v125, v118 offset:25856
    ds_read_b32 v121, v118 offset:25860
    s_cmp_le_u32 s35, 4096
    s_cbranch_scc1 p1_ce0
    s_waitcnt lgkmcnt(5)
    v_alignbyte_b32 v113, v114, v113, v119
    buffer_store_dwordx4 v[110:113], v120, s[20:23], 0 offen
    v_add_u32 v120, 33554432, v120
    s_nop 0
    ds_read_b32 v110, v117 offset:12288
    ds_read_b32 v111, v117 offset:12292
    ds_read_b32 v112, v117 offset:12296
    ds_read_b32 v113, v118 offset:28928
    ds_read_b32 v114, v118 offset:28932
    s_cmp_le_u32 s35, 5120
    s_cbranch_scc1 p1_ce0
    s_waitcnt lgkmcnt(5)
    v_alignbyte_b32 v125, v121, v125, v119
    buffer_store_dwordx4 v[122:125], v120, s[20:23], 0 offen
    v_add_u32 v120, 33554432, v120
    s_nop 0
    ds_read_b32 v122, v117 offset:24576
    ds_read_b32 v123, v117 offset:24580
    ds_read_b32 v124, v117 offset:24584
    ds_read_b32 v125, v118 offset:32000
    ds_read_b32 v121, v118 offset:32004
    s_cmp_le_u32 s35, 6144
    s_cbranch_scc1 p1_ce0
    s_waitcnt lgkmcnt(5)
    v_alignbyte_b32 v113, v114, v113, v119
    buffer_store_dwordx4 v[110:113], v120, s[20:23], 0 offen
    v_add_u32 v120, 33554432, v120
    s_nop 0
    ds_read_b32 v110, v117 offset:36864
    ds_read_b32 v111, v117 offset:36868
    ds_read_b32 v112, v117 offset:36872
    ds_read_b32 v113, v118 offset:35072
    ds_read_b32 v114, v118 offset:35076
    s_cmp_le_u32 s35, 7168
    s_cbranch_scc1 p1_ce0
    s_waitcnt lgkmcnt(5)
    v_alignbyte_b32 v125, v121, v125, v119
    s_cmp_le_u32 s71, 7
    s_cbranch_scc1 p1_pw7
    buffer_store_dwordx4 v[122:125], v120, s[20:23], 0 offen
    s_branch p1_px7
p1_pw7:
    buffer_store_dwordx4 v[122:125], v120, s[20:23], 0 offen nt
p1_px7:
    v_add_u32 v120, 33554432, v120
    s_nop 0
    s_cmp_le_u32 s35, 8192
    s_cbranch_scc1 p1_ce0
    s_waitcnt lgkmcnt(0)
    v_alignbyte_b32 v113, v114, v113, v119
    buffer_store_dwordx4 v[110:113], v120, s[20:23], 0 offen nt
    v_add_u32 v120, 33554432, v120
    s_nop 0
p1_ce0:
    s_waitcnt lgkmcnt(0)
    s_cmp_lg_u32 s70, 8
    s_cbranch_scc1 p1_h1
    s_sub_u32 s52, s33, 1536
    s_mul_i32 s52, s52, 41600
    s_add_u32 s52, s52, 477822976
    s_mov_b32 s54, 0x05040100
    s_mov_b32 s55, 0x07060302
    s_waitcnt vmcnt(1)
    v_perm_b32 v92, v78, v76, s54
    v_perm_b32 v93, v82, v80, s54
    v_perm_b32 v94, v86, v84, s54
    v_perm_b32 v95, v90, v88, s54
    buffer_store_dwordx4 v[92:95], v101, s[16:19], s52 offen offset:0
    v_perm_b32 v96, v78, v76, s55
    v_perm_b32 v97, v82, v80, s55
    v_perm_b32 v98, v86, v84, s55
    v_perm_b32 v99, v90, v88, s55
    buffer_store_dwordx4 v[96:99], v101, s[16:19], s52 offen offset:1040
    v_perm_b32 v92, v79, v77, s54
    v_perm_b32 v93, v83, v81, s54
    v_perm_b32 v94, v87, v85, s54
    v_perm_b32 v95, v91, v89, s54
    buffer_store_dwordx4 v[92:95], v101, s[16:19], s52 offen offset:2080
    v_perm_b32 v96, v79, v77, s55
    v_perm_b32 v97, v83, v81, s55
    v_perm_b32 v98, v87, v85, s55
    v_perm_b32 v99, v91, v89, s55
    buffer_store_dwordx4 v[96:99], v101, s[16:19], s52 offen offset:3120
p1_h1:
    s_barrier
    s_cmp_ge_u32 s29, 1462
    s_cbranch_scc1 p1_k44
    s_cmp_le_u32 s35, 9216
    s_cbranch_scc1 p1_s1k2
    v_lshlrev_b32_sdwa v122, 2, v40 dst_sel:DWORD dst_unused:UNUSED_PAD src0_sel:DWORD src1_sel:WORD_1
    ds_write_b32 v122, v12 offset:52480
    v_lshlrev_b32_sdwa v123, 2, v41 dst_sel:DWORD dst_unused:UNUSED_PAD src0_sel:DWORD src1_sel:WORD_1
    ds_write_b32 v123, v13 offset:52480
    v_lshlrev_b32_sdwa v124, 2, v42 dst_sel:DWORD dst_unused:UNUSED_PAD src0_sel:DWORD src1_sel:WORD_1
    ds_write_b32 v124, v14 offset:52480
    v_lshlrev_b32_sdwa v125, 2, v43 dst_sel:DWORD dst_unused:UNUSED_PAD src0_sel:DWORD src1_sel:WORD_1
    ds_write_b32 v125, v15 offset:52480
p1_s1k2:
p1_k44:
    s_cmp_ge_u32 s33, 1536
    s_cbranch_scc1 p1_k45
    s_cmp_lt_u32 s33, 1462
    s_cselect_b32 s6, 204800000, 0
    s_add_u32 s32, s30, 32768
    buffer_load_dwordx4 v[12:15], v1, s[4:7], s32 offen nt
p1_k45:
    s_cmp_ge_u32 s29, 1426
    s_cbranch_scc1 p1_k46
    s_cmp_le_u32 s35, 9216
    s_cbranch_scc1 p1_s1k3
    v_lshlrev_b32_sdwa v122, 2, v44 dst_sel:DWORD dst_unused:UNUSED_PAD src0_sel:DWORD src1_sel:WORD_1
    ds_write_b32 v122, v16 offset:52480
    v_lshlrev_b32_sdwa v123, 2, v45 dst_sel:DWORD dst_unused:UNUSED_PAD src0_sel:DWORD src1_sel:WORD_1
    ds_write_b32 v123, v17 offset:52480
    v_lshlrev_b32_sdwa v124, 2, v46 dst_sel:DWORD dst_unused:UNUSED_PAD src0_sel:DWORD src1_sel:WORD_1
    ds_write_b32 v124, v18 offset:52480
    v_lshlrev_b32_sdwa v125, 2, v47 dst_sel:DWORD dst_unused:UNUSED_PAD src0_sel:DWORD src1_sel:WORD_1
    ds_write_b32 v125, v19 offset:52480
p1_s1k3:
p1_k46:
    s_cmp_ge_u32 s29, 1352
    s_cbranch_scc1 p1_k47
    s_cmp_le_u32 s35, 9216
    s_cbranch_scc1 p1_s1k5
    v_lshlrev_b32_sdwa v122, 2, v56 dst_sel:DWORD dst_unused:UNUSED_PAD src0_sel:DWORD src1_sel:WORD_1
    ds_write_b32 v122, v24 offset:52480
    v_lshlrev_b32_sdwa v123, 2, v57 dst_sel:DWORD dst_unused:UNUSED_PAD src0_sel:DWORD src1_sel:WORD_1
    ds_write_b32 v123, v25 offset:52480
    v_lshlrev_b32_sdwa v124, 2, v58 dst_sel:DWORD dst_unused:UNUSED_PAD src0_sel:DWORD src1_sel:WORD_1
    ds_write_b32 v124, v26 offset:52480
    v_lshlrev_b32_sdwa v125, 2, v59 dst_sel:DWORD dst_unused:UNUSED_PAD src0_sel:DWORD src1_sel:WORD_1
    ds_write_b32 v125, v27 offset:52480
p1_s1k5:
p1_k47:
    s_cmp_ge_u32 s29, 1279
    s_cbranch_scc1 p1_k48
    s_cmp_le_u32 s35, 9216
    s_cbranch_scc1 p1_s1k7
    v_lshlrev_b32_sdwa v122, 2, v64 dst_sel:DWORD dst_unused:UNUSED_PAD src0_sel:DWORD src1_sel:WORD_1
    ds_write_b32 v122, v32 offset:52480
    v_lshlrev_b32_sdwa v123, 2, v65 dst_sel:DWORD dst_unused:UNUSED_PAD src0_sel:DWORD src1_sel:WORD_1
    ds_write_b32 v123, v33 offset:52480
    v_lshlrev_b32_sdwa v124, 2, v66 dst_sel:DWORD dst_unused:UNUSED_PAD src0_sel:DWORD src1_sel:WORD_1
    ds_write_b32 v124, v34 offset:52480
    v_lshlrev_b32_sdwa v125, 2, v67 dst_sel:DWORD dst_unused:UNUSED_PAD src0_sel:DWORD src1_sel:WORD_1
    ds_write_b32 v125, v35 offset:52480
p1_s1k7:
p1_k48:
    s_cmp_ge_u32 s29, 1389
    s_cbranch_scc1 p1_k49
    s_cmp_le_u32 s35, 9216
    s_cbranch_scc1 p1_s1k4
    v_lshlrev_b32_sdwa v122, 2, v56 dst_sel:DWORD dst_unused:UNUSED_PAD src0_sel:DWORD src1_sel:WORD_0
    ds_write_b32 v122, v20 offset:52480
    v_lshlrev_b32_sdwa v123, 2, v57 dst_sel:DWORD dst_unused:UNUSED_PAD src0_sel:DWORD src1_sel:WORD_0
    ds_write_b32 v123, v21 offset:52480
    v_lshlrev_b32_sdwa v124, 2, v58 dst_sel:DWORD dst_unused:UNUSED_PAD src0_sel:DWORD src1_sel:WORD_0
    ds_write_b32 v124, v22 offset:52480
    v_lshlrev_b32_sdwa v125, 2, v59 dst_sel:DWORD dst_unused:UNUSED_PAD src0_sel:DWORD src1_sel:WORD_0
    ds_write_b32 v125, v23 offset:52480
p1_s1k4:
p1_k49:
    s_cmp_ge_u32 s29, 1315
    s_cbranch_scc1 p1_k50
    s_cmp_le_u32 s35, 9216
    s_cbranch_scc1 p1_s1k6
    v_lshlrev_b32_sdwa v122, 2, v64 dst_sel:DWORD dst_unused:UNUSED_PAD src0_sel:DWORD src1_sel:WORD_0
    ds_write_b32 v122, v28 offset:52480
    v_lshlrev_b32_sdwa v123, 2, v65 dst_sel:DWORD dst_unused:UNUSED_PAD src0_sel:DWORD src1_sel:WORD_0
    ds_write_b32 v123, v29 offset:52480
    v_lshlrev_b32_sdwa v124, 2, v66 dst_sel:DWORD dst_unused:UNUSED_PAD src0_sel:DWORD src1_sel:WORD_0
    ds_write_b32 v124, v30 offset:52480
    v_lshlrev_b32_sdwa v125, 2, v67 dst_sel:DWORD dst_unused:UNUSED_PAD src0_sel:DWORD src1_sel:WORD_0
    ds_write_b32 v125, v31 offset:52480
p1_s1k6:
p1_k50:
    s_cmp_ge_u32 s29, 1242
    s_cbranch_scc1 p1_k51
    s_cmp_le_u32 s35, 9216
    s_cbranch_scc1 p1_s1k8
    v_lshlrev_b32_sdwa v122, 2, v72 dst_sel:DWORD dst_unused:UNUSED_PAD src0_sel:DWORD src1_sel:WORD_0
    ds_write_b32 v122, v36 offset:52480
    v_lshlrev_b32_sdwa v123, 2, v73 dst_sel:DWORD dst_unused:UNUSED_PAD src0_sel:DWORD src1_sel:WORD_0
    ds_write_b32 v123, v37 offset:52480
    v_lshlrev_b32_sdwa v124, 2, v74 dst_sel:DWORD dst_unused:UNUSED_PAD src0_sel:DWORD src1_sel:WORD_0
    ds_write_b32 v124, v38 offset:52480
    v_lshlrev_b32_sdwa v125, 2, v75 dst_sel:DWORD dst_unused:UNUSED_PAD src0_sel:DWORD src1_sel:WORD_0
    ds_write_b32 v125, v39 offset:52480
p1_s1k8:
p1_k51:
    s_cmp_le_u32 s35, 9216
    s_cbranch_scc1 p1_s1k0
    v_lshlrev_b32_sdwa v122, 2, v40 dst_sel:DWORD dst_unused:UNUSED_PAD src0_sel:DWORD src1_sel:WORD_0
    ds_write_b32 v122, v4 offset:52480
    v_lshlrev_b32_sdwa v123, 2, v41 dst_sel:DWORD dst_unused:UNUSED_PAD src0_sel:DWORD src1_sel:WORD_0
    ds_write_b32 v123, v5 offset:52480
    v_lshlrev_b32_sdwa v124, 2, v42 dst_sel:DWORD dst_unused:UNUSED_PAD src0_sel:DWORD src1_sel:WORD_0
    ds_write_b32 v124, v6 offset:52480
    v_lshlrev_b32_sdwa v125, 2, v43 dst_sel:DWORD dst_unused:UNUSED_PAD src0_sel:DWORD src1_sel:WORD_0
    ds_write_b32 v125, v7 offset:52480
p1_s1k0:
    s_cmp_ge_u32 s29, 1499
    s_cbranch_scc1 p1_k52
    s_cmp_le_u32 s35, 9216
    s_cbranch_scc1 p1_s1k1
    v_lshlrev_b32_sdwa v122, 2, v44 dst_sel:DWORD dst_unused:UNUSED_PAD src0_sel:DWORD src1_sel:WORD_0
    ds_write_b32 v122, v8 offset:52480
    v_lshlrev_b32_sdwa v123, 2, v45 dst_sel:DWORD dst_unused:UNUSED_PAD src0_sel:DWORD src1_sel:WORD_0
    ds_write_b32 v123, v9 offset:52480
    v_lshlrev_b32_sdwa v124, 2, v46 dst_sel:DWORD dst_unused:UNUSED_PAD src0_sel:DWORD src1_sel:WORD_0
    ds_write_b32 v124, v10 offset:52480
    v_lshlrev_b32_sdwa v125, 2, v47 dst_sel:DWORD dst_unused:UNUSED_PAD src0_sel:DWORD src1_sel:WORD_0
    ds_write_b32 v125, v11 offset:52480
p1_s1k1:
p1_k52:
    s_cmp_lg_u32 s69, 8
    s_cbranch_scc1 p1_o1
    s_lshr_b32 s52, s29, 3
    v_and_b32 v6, 63, v0
    s_cmp_eq_u32 s28, 10
    s_cbranch_scc1 p1_tr11
    s_mul_i32 s53, s28, 520
    v_lshl_add_u32 v4, v6, 3, s53
    s_mul_i32 s53, s28, 4160
    v_lshl_add_u32 v5, v6, 4, s53
    s_branch p1_tr21
p1_tr11:
    v_mul_u32_u24 v4, 520, v6
    v_add_u32 v4, 512, v4
    v_mul_u32_u24 v5, 4160, v6
    v_add_u32 v5, 1024, v5
    v_cmp_gt_u32 vcc, 10, v6
    v_mov_b32 v6, 0x40000000
    s_nop 0
    v_cndmask_b32 v4, v6, v4, vcc
    v_cndmask_b32 v5, v6, v5, vcc
p1_tr21:
    s_mul_i32 s52, s52, 41984
    s_add_u32 s52, s52, 469762048
    buffer_load_dwordx2 v[16:17], v4, s[16:19], s52 offen sc1
    s_add_u32 s52, s52, 5248
    buffer_load_dwordx2 v[18:19], v4, s[16:19], s52 offen sc1
    s_add_u32 s52, s52, 5248
    buffer_load_dwordx2 v[20:21], v4, s[16:19], s52 offen sc1
    s_add_u32 s52, s52, 5248
    buffer_load_dwordx2 v[22:23], v4, s[16:19], s52 offen sc1
    s_add_u32 s52, s52, 5248
    buffer_load_dwordx2 v[24:25], v4, s[16:19], s52 offen sc1
    s_add_u32 s52, s52, 5248
    buffer_load_dwordx2 v[26:27], v4, s[16:19], s52 offen sc1
    s_add_u32 s52, s52, 5248
    buffer_load_dwordx2 v[28:29], v4, s[16:19], s52 offen sc1
    s_add_u32 s52, s52, 5248
    buffer_load_dwordx2 v[30:31], v4, s[16:19], s52 offen sc1
    s_add_u32 s52, s52, 5248
    s_cmp_ge_u32 s33, 1536
    s_cbranch_scc1 p1_o1
    s_lshr_b32 s52, s29, 3
    s_mul_i32 s52, s52, 41600
    s_add_u32 s52, s52, 477822976
    s_mov_b32 s54, 0x05040100
    s_mov_b32 s55, 0x07060302
    s_waitcnt vmcnt(0)
    v_perm_b32 v32, v18, v16, s54
    v_perm_b32 v33, v22, v20, s54
    v_perm_b32 v34, v26, v24, s54
    v_perm_b32 v35, v30, v28, s54
    buffer_store_dwordx4 v[32:35], v5, s[16:19], s52 offen offset:0
    v_perm_b32 v36, v18, v16, s55
    v_perm_b32 v37, v22, v20, s55
    v_perm_b32 v38, v26, v24, s55
    v_perm_b32 v39, v30, v28, s55
    buffer_store_dwordx4 v[36:39], v5, s[16:19], s52 offen offset:1040
    v_perm_b32 v32, v19, v17, s54
    v_perm_b32 v33, v23, v21, s54
    v_perm_b32 v34, v27, v25, s54
    v_perm_b32 v35, v31, v29, s54
    buffer_store_dwordx4 v[32:35], v5, s[16:19], s52 offen offset:2080
    v_perm_b32 v36, v19, v17, s55
    v_perm_b32 v37, v23, v21, s55
    v_perm_b32 v38, v27, v25, s55
    v_perm_b32 v39, v31, v29, s55
    buffer_store_dwordx4 v[36:39], v5, s[16:19], s52 offen offset:3120
    s_mov_b32 s69, 0
p1_o1:
    s_waitcnt lgkmcnt(0)
    s_barrier
    s_cmp_le_u32 s35, 9216
    s_cbranch_scc1 p1_ce1
    v_lshlrev_b32 v117, 2, v119
    v_sub_u32 v117, 113908, v117
    ds_read_b32 v122, v117 offset:49160
    ds_read_b32 v123, v117 offset:49156
    ds_read_b32 v124, v117 offset:49152
    ds_read_b32 v125, v118 offset:38144
    ds_read_b32 v121, v118 offset:38148
    ds_read_b32 v110, v117 offset:36872
    ds_read_b32 v111, v117 offset:36868
    ds_read_b32 v112, v117 offset:36864
    ds_read_b32 v113, v118 offset:41216
    ds_read_b32 v114, v118 offset:41220
    s_waitcnt lgkmcnt(5)
    v_alignbyte_b32 v125, v121, v125, v119
    buffer_store_dwordx4 v[122:125], v120, s[20:23], 0 offen nt
    v_add_u32 v120, 33554432, v120
    s_nop 0
    ds_read_b32 v122, v117 offset:24584
    ds_read_b32 v123, v117 offset:24580
    ds_read_b32 v124, v117 offset:24576
    ds_read_b32 v125, v118 offset:44288
    ds_read_b32 v121, v118 offset:44292
    s_cmp_le_u32 s35, 10240
    s_cbranch_scc1 p1_ce1
    s_waitcnt lgkmcnt(5)
    v_alignbyte_b32 v113, v114, v113, v119
    buffer_store_dwordx4 v[110:113], v120, s[20:23], 0 offen nt
    v_add_u32 v120, 33554432, v120
    s_nop 0
    ds_read_b32 v110, v117 offset:12296
    ds_read_b32 v111, v117 offset:12292
    ds_read_b32 v112, v117 offset:12288
    ds_read_b32 v113, v118 offset:47360
    ds_read_b32 v114, v118 offset:47364
    s_cmp_le_u32 s35, 11264
    s_cbranch_scc1 p1_ce1
    s_waitcnt lgkmcnt(5)
    v_alignbyte_b32 v125, v121, v125, v119
    buffer_store_dwordx4 v[122:125], v120, s[20:23], 0 offen nt
    v_add_u32 v120, 33554432, v120
    s_nop 0
    ds_read_b32 v122, v117 offset:8
    ds_read_b32 v123, v117 offset:4
    ds_read_b32 v124, v117 offset:0
    ds_read_b32 v125, v118 offset:50432
    ds_read_b32 v121, v118 offset:50436
    s_cmp_le_u32 s35, 12288
    s_cbranch_scc1 p1_ce1
    s_waitcnt lgkmcnt(5)
    v_alignbyte_b32 v113, v114, v113, v119
    buffer_store_dwordx4 v[110:113], v120, s[20:23], 0 offen nt
    v_add_u32 v120, 33554432, v120
    s_nop 0
    s_cmp_le_u32 s35, 13312
    s_cbranch_scc1 p1_ce1
    s_waitcnt lgkmcnt(0)
    v_alignbyte_b32 v125, v121, v125, v119
    buffer_store_dwordx4 v[122:125], v120, s[20:23], 0 offen nt
    v_add_u32 v120, 33554432, v120
    s_nop 0
p1_ce1:
    s_waitcnt lgkmcnt(0)
    s_cmp_lg_u32 s69, 8
    s_cbranch_scc1 p1_o2
    s_lshr_b32 s52, s29, 3
    s_mul_i32 s52, s52, 41600
    s_add_u32 s52, s52, 477822976
    s_mov_b32 s54, 0x05040100
    s_mov_b32 s55, 0x07060302
    s_waitcnt vmcnt(0)
    v_perm_b32 v32, v18, v16, s54
    v_perm_b32 v33, v22, v20, s54
    v_perm_b32 v34, v26, v24, s54
    v_perm_b32 v35, v30, v28, s54
    buffer_store_dwordx4 v[32:35], v5, s[16:19], s52 offen offset:0
    v_perm_b32 v36, v18, v16, s55
    v_perm_b32 v37, v22, v20, s55
    v_perm_b32 v38, v26, v24, s55
    v_perm_b32 v39, v30, v28, s55
    buffer_store_dwordx4 v[36:39], v5, s[16:19], s52 offen offset:1040
    v_perm_b32 v32, v19, v17, s54
    v_perm_b32 v33, v23, v21, s54
    v_perm_b32 v34, v27, v25, s54
    v_perm_b32 v35, v31, v29, s54
    buffer_store_dwordx4 v[32:35], v5, s[16:19], s52 offen offset:2080
    v_perm_b32 v36, v19, v17, s55
    v_perm_b32 v37, v23, v21, s55
    v_perm_b32 v38, v27, v25, s55
    v_perm_b32 v39, v31, v29, s55
    buffer_store_dwordx4 v[36:39], v5, s[16:19], s52 offen offset:3120
p1_o2:
    s_barrier
    s_mov_b32 s29, s33
    s_cmp_lt_u32 s29, 1242
    s_cselect_b32 s34, 1, 0
    s_cmp_lt_u32 s29, 1536
    s_cbranch_scc1 p1_tile
p1_end:
    s_endpgm
.globl p2_kernel
.p2align 8
.type p2_kernel,@function
p2_kernel:
    s_cmp_ge_u32 s2, 256
    s_cbranch_scc1 p2_end
    s_load_dwordx2 s[8:9], s[0:1], 104
    v_and_b32 v112, 63, v0
    v_lshrrev_b32 v122, 6, v0
    v_lshlrev_b32 v112, 4, v112
    v_readfirstlane_b32 s10, v122
    v_mov_b32 v113, 0x83ff0000
    s_and_b32 s44, s2, 7
    s_lshr_b32 s11, s44, 1
    s_and_b32 s44, s44, 1
    s_lshl_b32 s12, s44, 5
    s_lshr_b32 s44, s2, 3
    s_add_u32 s12, s12, s44
    s_mov_b32 s25, 54272
    s_mov_b32 s31, 67175170
    s_mov_b32 s32, 83952386
    s_mov_b32 s33, 100729602
    s_mov_b32 s21, 0
    s_mul_i32 s23, s10, 3072
    s_lshl_b32 s24, s10, 9
    s_lshl_b32 s64, s10, 10
    s_sub_u32 s42, s24, s23
    s_add_u32 s42, s42, 49152
    s_movk_i32 s63, 2048
    s_movk_i32 s65, 16384
    s_mul_i32 s62, s11, 161280
    s_add_u32 s62, s62, 485810176
    s_add_u32 s62, s62, s23
    s_mov_b32 s40, 477822976
    s_mul_i32 s44, s11, 1040
    s_add_u32 s40, s40, s44
    s_lshl_b32 s44, s12, 4
    s_add_u32 s40, s40, s44
    s_waitcnt lgkmcnt(0)
    s_mov_b32 s4, s8
    s_and_b32 s5, s9, 0xffff
    s_mov_b32 s6, 819200000
    s_mov_b32 s7, 0x20000
    s_mov_b32 s68, s8
    s_and_b32 s69, s9, 0xffff
    s_mov_b32 s70, 469762048
    s_mov_b32 s71, 0x20000
    s_and_b32 s44, s2, 7
    s_lshl_b32 s44, s44, 2
    s_lshr_b32 s18, 0x00000000, s44
    s_and_b32 s18, s18, 15
p2_restart:
    s_mov_b32 s61, 0
    s_add_u32 s44, s61, s18
    s_cmp_ge_u32 s44, 10
    s_cselect_b32 s53, 10, 0
    s_sub_u32 s44, s44, s53
    s_mul_i32 s44, s44, 4160
    s_add_u32 s44, s44, s40
    v_bfe_i32 v111, v112, 6, 1
    v_lshrrev_b32 v110, 6, v112
    v_bitop3_b32 v111, v111, 15, s10 bitop3:0x6a
    v_lshl_or_b32 v110, v110, 4, v111
    v_add_u32 v111, 64, v110
    v_and_b32 v111, 0x100, v111
    v_lshl_or_b32 v110, v111, 7, v110
    v_bfe_u32 v111, v112, 2, 4
    v_mul_u32_u24 v110, 41600, v110
    v_add_u32 v111, v110, v111
    buffer_load_dword v110, v111, s[4:7], s44 offen
    buffer_load_dword v111, v111, s[4:7], s44 offen offset:16
    s_mov_b32 s61, 1
    s_add_u32 s44, s61, s18
    s_cmp_ge_u32 s44, 10
    s_cselect_b32 s53, 10, 0
    s_sub_u32 s44, s44, s53
    s_mul_i32 s44, s44, 4160
    s_add_u32 s44, s44, s40
    v_bfe_i32 v67, v112, 6, 1
    v_lshrrev_b32 v66, 6, v112
    v_bitop3_b32 v67, v67, 15, s10 bitop3:0x6a
    v_lshl_or_b32 v66, v66, 4, v67
    v_add_u32 v67, 64, v66
    v_and_b32 v67, 0x100, v67
    v_lshl_or_b32 v66, v67, 7, v66
    v_bfe_u32 v67, v112, 2, 4
    v_mul_u32_u24 v66, 41600, v66
    v_add_u32 v67, v66, v67
    buffer_load_dword v66, v67, s[4:7], s44 offen
    buffer_load_dword v67, v67, s[4:7], s44 offen offset:16
    s_mov_b32 s61, 0
    s_cmp_lt_u32 s10, 15
    s_cselect_b32 s44, s64, 0x40000000
    v_add_u32 v58, s44, v112
    s_mov_b32 s44, 492261376
    buffer_load_dwordx4 v[58:61], v58, s[4:7], s44 offen
    s_mul_i32 s20, s18, 645120
    s_add_u32 s20, s20, s62
    s_cmp_ge_u32 s10, 9
    s_cbranch_scc1 p2_nmp
    v_lshrrev_b32 v84, 1, v112
    s_add_u32 s44, s20, s42
    buffer_load_dwordx2 v[84:85], v84, s[4:7], s44 offen
p2_nmp:
    buffer_load_dwordx4 v[72:75], v112, s[4:7], s20 offen offset:0
    buffer_load_dwordx4 v[76:79], v112, s[4:7], s20 offen offset:1024
    buffer_load_dwordx4 v[80:83], v112, s[4:7], s20 offen offset:2048
    s_barrier
    v_mov_b32 v115, 0
    v_mov_b32 v116, 0
    v_mov_b32 v117, 0
    v_mov_b32 v118, 0
    v_mov_b32 v119, 0
    v_mov_b32 v120, 0
    v_mov_b32 v121, 0
    ds_write_b128 v115, v[116:119] offset:53760
    s_mov_b32 s19, 0
    s_cmp_eq_u32 s21, 2
    s_cselect_b64 s[66:67], -1, 0
    s_waitcnt lgkmcnt(0)
    s_barrier
    s_waitcnt vmcnt(6)
    s_mov_b32 m0, s23
    v_mov_b32 v53, 0
    s_movk_i32 s44, 512
    v_sub_u32_sdwa v4, v111, v110 dst_sel:DWORD dst_unused:UNUSED_PAD src0_sel:WORD_0 src1_sel:WORD_0
    v_sub_u32_sdwa v5, v111, v110 dst_sel:DWORD dst_unused:UNUSED_PAD src0_sel:WORD_1 src1_sel:WORD_1
    v_med3_i32 v4, v4, 0, s44
    v_med3_i32 v5, v5, 0, s44
    v_add_u32 v48, v4, v5
    ds_write_addtid_b32 v53 offset:0
    ds_write_addtid_b32 v53 offset:256
    ds_write_addtid_b32 v53 offset:512
    ds_write_addtid_b32 v53 offset:768
    ds_write_addtid_b32 v53 offset:1024
    ds_write_addtid_b32 v53 offset:1280
    ds_write_addtid_b32 v53 offset:1536
    ds_write_addtid_b32 v53 offset:1792
    v_bfe_i32 v53, v112, 6, 1
    v_lshrrev_b32 v49, 6, v112
    v_bitop3_b32 v53, v53, 15, s10 bitop3:0x6a
    v_lshl_or_b32 v49, v49, 4, v53
    v_and_b32 v53, 0x30, v112
    v_lshl_or_b32 v53, v49, 6, v53
    v_lshlrev_b32 v53, 15, v53
    s_nop 1
    v_add_u32_dpp v48, v48, v48 row_shr:1 row_mask:0xf bank_mask:0xf bound_ctrl:0
    s_nop 1
    v_add_u32_dpp v48, v48, v48 row_shr:2 row_mask:0xf bank_mask:0xf bound_ctrl:0
    s_nop 1
    v_add_u32_dpp v48, v48, v48 row_shr:4 row_mask:0xf bank_mask:0xf bound_ctrl:0
    s_nop 1
    v_add_u32_dpp v48, v48, v48 row_shr:8 row_mask:0xf bank_mask:0xf bound_ctrl:0
    s_nop 1
    v_add_u32_dpp v48, v48, v48 row_bcast:15 row_mask:0xa bank_mask:0xf
    s_nop 1
    v_add_u32_dpp v48, v48, v48 row_bcast:31 row_mask:0xc bank_mask:0xf
    s_nop 1
    s_nop 0
    v_readlane_b32 s38, v48, 63
    v_sub_u32 v50, v48, v5
    v_sub_u32 v49, v50, v4
    v_writelane_b32 v5, 1, 63
    v_sub_u32 v10, 512, v49
    v_mad_u32_u16 v51, v110, 16, v53
    v_lshl_add_u32 v51, v10, 4, v51
    v_med3_i32 v10, v10, 0, v4
    v_lshl_add_u32 v49, v49, 2, s23
    v_sub_u32 v11, 512, v50
    v_mad_u32_u16 v52, v110, 16, v53 op_sel:[1,0,0,0]
    v_add_u32 v52, 262144, v52
    s_mov_b32 s44, 0x1fffc000
    v_writelane_b32 v52, s44, 63
    v_lshl_add_u32 v52, v11, 4, v52
    v_med3_i32 v11, v11, 0, v5
    v_lshl_add_u32 v50, v50, 2, s23
    v_lshl_add_u32 v48, v11, 16, v10
    v_add_u32 v110, v110, v48
    s_min_u32 s17, s38, 512
    s_add_u32 s17, s17, 63
    s_lshr_b32 s17, s17, 6
    v_cmpx_lt_i32 vcc, 0, v10
    ds_write_b32 v49, v51
    s_mov_b64 exec, -1
    v_cmpx_lt_i32 vcc, 0, v11
    ds_write_b32 v50, v52
    s_mov_b64 exec, -1
    s_cmp_lt_u32 s38, 512
    s_cbranch_scc1 p2_nomorea
    v_cmp_lt_u32_sdwa s[44:45], v110, v111 src0_sel:WORD_0 src1_sel:WORD_0
    v_cmp_lt_u32_sdwa s[46:47], v110, v111 src0_sel:WORD_1 src1_sel:WORD_1
    s_nop 0
    s_or_b64 s[44:45], s[44:45], s[46:47]
    s_cbranch_scc0 p2_nomorea
    v_mov_b32 v49, s19
    v_mov_b32 v50, 1
    ds_write_b32 v49, v50 offset:53760
p2_nomorea:
    s_mov_b32 m0, s23
    s_nop 0
    ds_read_addtid_b32 v2 offset:1024
    ds_read_addtid_b32 v8 offset:1280
    ds_read_addtid_b32 v14 offset:1536
    ds_read_addtid_b32 v20 offset:1792
    ds_read_addtid_b32 v88 offset:0
    ds_read_addtid_b32 v92 offset:256
    ds_read_addtid_b32 v96 offset:512
    ds_read_addtid_b32 v100 offset:768
    s_waitcnt lgkmcnt(0)
    s_nop 2
    s_nop 1
    v_max_u32_dpp v88, v88, v88 row_shr:1 row_mask:0xf bank_mask:0xf bound_ctrl:0
    v_max_u32_dpp v92, v92, v92 row_shr:1 row_mask:0xf bank_mask:0xf bound_ctrl:0
    v_max_u32_dpp v96, v96, v96 row_shr:1 row_mask:0xf bank_mask:0xf bound_ctrl:0
    v_max_u32_dpp v100, v100, v100 row_shr:1 row_mask:0xf bank_mask:0xf bound_ctrl:0
    v_max_u32_dpp v2, v2, v2 row_shr:1 row_mask:0xf bank_mask:0xf bound_ctrl:0
    v_max_u32_dpp v8, v8, v8 row_shr:1 row_mask:0xf bank_mask:0xf bound_ctrl:0
    v_max_u32_dpp v14, v14, v14 row_shr:1 row_mask:0xf bank_mask:0xf bound_ctrl:0
    v_max_u32_dpp v20, v20, v20 row_shr:1 row_mask:0xf bank_mask:0xf bound_ctrl:0
    v_max_u32_dpp v88, v88, v88 row_shr:2 row_mask:0xf bank_mask:0xf bound_ctrl:0
    v_max_u32_dpp v92, v92, v92 row_shr:2 row_mask:0xf bank_mask:0xf bound_ctrl:0
    v_max_u32_dpp v96, v96, v96 row_shr:2 row_mask:0xf bank_mask:0xf bound_ctrl:0
    v_max_u32_dpp v100, v100, v100 row_shr:2 row_mask:0xf bank_mask:0xf bound_ctrl:0
    v_max_u32_dpp v2, v2, v2 row_shr:2 row_mask:0xf bank_mask:0xf bound_ctrl:0
    v_max_u32_dpp v8, v8, v8 row_shr:2 row_mask:0xf bank_mask:0xf bound_ctrl:0
    v_max_u32_dpp v14, v14, v14 row_shr:2 row_mask:0xf bank_mask:0xf bound_ctrl:0
    v_max_u32_dpp v20, v20, v20 row_shr:2 row_mask:0xf bank_mask:0xf bound_ctrl:0
    v_max_u32_dpp v88, v88, v88 row_shr:4 row_mask:0xf bank_mask:0xf bound_ctrl:0
    v_max_u32_dpp v92, v92, v92 row_shr:4 row_mask:0xf bank_mask:0xf bound_ctrl:0
    v_max_u32_dpp v96, v96, v96 row_shr:4 row_mask:0xf bank_mask:0xf bound_ctrl:0
    v_max_u32_dpp v100, v100, v100 row_shr:4 row_mask:0xf bank_mask:0xf bound_ctrl:0
    v_max_u32_dpp v2, v2, v2 row_shr:4 row_mask:0xf bank_mask:0xf bound_ctrl:0
    v_max_u32_dpp v8, v8, v8 row_shr:4 row_mask:0xf bank_mask:0xf bound_ctrl:0
    v_max_u32_dpp v14, v14, v14 row_shr:4 row_mask:0xf bank_mask:0xf bound_ctrl:0
    v_max_u32_dpp v20, v20, v20 row_shr:4 row_mask:0xf bank_mask:0xf bound_ctrl:0
    v_max_u32_dpp v88, v88, v88 row_shr:8 row_mask:0xf bank_mask:0xf bound_ctrl:0
    v_max_u32_dpp v92, v92, v92 row_shr:8 row_mask:0xf bank_mask:0xf bound_ctrl:0
    v_max_u32_dpp v96, v96, v96 row_shr:8 row_mask:0xf bank_mask:0xf bound_ctrl:0
    v_max_u32_dpp v100, v100, v100 row_shr:8 row_mask:0xf bank_mask:0xf bound_ctrl:0
    v_max_u32_dpp v2, v2, v2 row_shr:8 row_mask:0xf bank_mask:0xf bound_ctrl:0
    v_max_u32_dpp v8, v8, v8 row_shr:8 row_mask:0xf bank_mask:0xf bound_ctrl:0
    v_max_u32_dpp v14, v14, v14 row_shr:8 row_mask:0xf bank_mask:0xf bound_ctrl:0
    v_max_u32_dpp v20, v20, v20 row_shr:8 row_mask:0xf bank_mask:0xf bound_ctrl:0
    v_max_u32_dpp v88, v88, v88 row_bcast:15 row_mask:0xa bank_mask:0xf
    v_max_u32_dpp v92, v92, v92 row_bcast:15 row_mask:0xa bank_mask:0xf
    v_max_u32_dpp v96, v96, v96 row_bcast:15 row_mask:0xa bank_mask:0xf
    v_max_u32_dpp v100, v100, v100 row_bcast:15 row_mask:0xa bank_mask:0xf
    v_max_u32_dpp v2, v2, v2 row_bcast:15 row_mask:0xa bank_mask:0xf
    v_max_u32_dpp v8, v8, v8 row_bcast:15 row_mask:0xa bank_mask:0xf
    v_max_u32_dpp v14, v14, v14 row_bcast:15 row_mask:0xa bank_mask:0xf
    v_max_u32_dpp v20, v20, v20 row_bcast:15 row_mask:0xa bank_mask:0xf
    v_max_u32_dpp v88, v88, v88 row_bcast:31 row_mask:0xc bank_mask:0xf
    v_max_u32_dpp v92, v92, v92 row_bcast:31 row_mask:0xc bank_mask:0xf
    v_max_u32_dpp v96, v96, v96 row_bcast:31 row_mask:0xc bank_mask:0xf
    v_max_u32_dpp v100, v100, v100 row_bcast:31 row_mask:0xc bank_mask:0xf
    v_max_u32_dpp v2, v2, v2 row_bcast:31 row_mask:0xc bank_mask:0xf
    v_max_u32_dpp v8, v8, v8 row_bcast:31 row_mask:0xc bank_mask:0xf
    v_max_u32_dpp v14, v14, v14 row_bcast:31 row_mask:0xc bank_mask:0xf
    v_max_u32_dpp v20, v20, v20 row_bcast:31 row_mask:0xc bank_mask:0xf
    s_nop 0
    v_readlane_b32 s41, v88, 63
    v_add_u32 v88, v88, v112
    v_add_u32 v88, 4294959104, v88
    v_max_u32 v92, s41, v92
    s_nop 0
    v_readlane_b32 s41, v92, 63
    v_add_u32 v92, v92, v112
    v_add_u32 v92, 4294960128, v92
    v_max_u32 v96, s41, v96
    s_nop 0
    v_readlane_b32 s41, v96, 63
    v_add_u32 v96, v96, v112
    v_add_u32 v96, 4294961152, v96
    v_max_u32 v100, s41, v100
    s_nop 0
    v_readlane_b32 s41, v100, 63
    v_add_u32 v100, v100, v112
    v_add_u32 v100, 4294962176, v100
    v_max_u32 v2, s41, v2
    s_nop 0
    v_readlane_b32 s41, v2, 63
    v_add_u32 v2, v2, v112
    v_add_u32 v2, 4294963200, v2
    v_max_u32 v8, s41, v8
    s_nop 0
    v_readlane_b32 s41, v8, 63
    v_add_u32 v8, v8, v112
    v_add_u32 v8, 4294964224, v8
    v_max_u32 v14, s41, v14
    s_nop 0
    v_readlane_b32 s41, v14, 63
    v_add_u32 v14, v14, v112
    v_add_u32 v14, 4294965248, v14
    v_max_u32 v20, s41, v20
    s_nop 0
    v_readlane_b32 s41, v20, 63
    v_add_u32 v20, v20, v112
    v_add_u32 v20, 4294966272, v20
    v_bfe_u32 v0, v2, 14, 4
    v_lshrrev_b32 v1, 18, v2
    v_and_b32 v2, 0x3fff, v2
    v_mad_u32_u24 v0, v0, s63, v1
    v_mad_u32_u24 v2, v0, s65, v2
    buffer_load_dwordx4 v[0:3], v2, s[68:71], 0 offen
    v_bfe_u32 v6, v8, 14, 4
    v_lshrrev_b32 v7, 18, v8
    v_and_b32 v8, 0x3fff, v8
    v_mad_u32_u24 v6, v6, s63, v7
    v_mad_u32_u24 v8, v6, s65, v8
    buffer_load_dwordx4 v[6:9], v8, s[68:71], 0 offen
    s_cmp_eq_u32 s21, 0
    s_cselect_b32 s44, 1073758208, 0
    v_mov_b32 v124, s44
    v_mov_b32 v125, s44
    v_mov_b32 v126, s44
    v_mov_b32 v127, s44
    v_add_u32 v123, s64, v112
    v_add_u32 v122, s25, v123
    ds_write_b128 v122, v[124:127] offset:0
    ds_write_b128 v122, v[124:127] offset:16384
    ds_write_b128 v122, v[124:127] offset:32768
    v_add_u32 v122, 49152, v122
    ds_write_b128 v122, v[124:127] offset:0
    ds_write_b128 v122, v[124:127] offset:16384
    ds_write_b128 v122, v[124:127] offset:32768
    v_cmpx_gt_u32 vcc, 1792, v123
    ds_write_b128 v122, v[124:127] offset:49152
    s_mov_b64 exec, -1
    v_bfe_u32 v12, v14, 14, 4
    v_lshrrev_b32 v13, 18, v14
    v_and_b32 v14, 0x3fff, v14
    v_mad_u32_u24 v12, v12, s63, v13
    v_mad_u32_u24 v14, v12, s65, v14
    buffer_load_dwordx4 v[12:15], v14, s[68:71], 0 offen
    s_mov_b32 s16, s17
    s_waitcnt vmcnt(6)
    s_cmp_lg_u32 s21, 0
    s_cbranch_scc1 p2_nostat1
    v_max_u32 v58, v58, v60
    v_add_f32 v59, v59, v61
    s_nop 1
    v_max_u32_dpp v58, v58, v58 row_shr:1 row_mask:0xf bank_mask:0xf bound_ctrl:0
    v_add_f32_dpp v59, v59, v59 row_shr:1 row_mask:0xf bank_mask:0xf bound_ctrl:0
    s_nop 0
    v_max_u32_dpp v58, v58, v58 row_shr:2 row_mask:0xf bank_mask:0xf bound_ctrl:0
    v_add_f32_dpp v59, v59, v59 row_shr:2 row_mask:0xf bank_mask:0xf bound_ctrl:0
    s_nop 0
    v_max_u32_dpp v58, v58, v58 row_shr:4 row_mask:0xf bank_mask:0xf bound_ctrl:0
    v_add_f32_dpp v59, v59, v59 row_shr:4 row_mask:0xf bank_mask:0xf bound_ctrl:0
    s_nop 0
    v_max_u32_dpp v58, v58, v58 row_shr:8 row_mask:0xf bank_mask:0xf bound_ctrl:0
    v_add_f32_dpp v59, v59, v59 row_shr:8 row_mask:0xf bank_mask:0xf bound_ctrl:0
    s_nop 0
    v_max_u32_dpp v58, v58, v58 row_bcast:15 row_mask:0xa bank_mask:0xf
    v_add_f32_dpp v59, v59, v59 row_bcast:15 row_mask:0xa bank_mask:0xf
    s_nop 0
    v_max_u32_dpp v58, v58, v58 row_bcast:31 row_mask:0xc bank_mask:0xf
    v_add_f32_dpp v59, v59, v59 row_bcast:31 row_mask:0xc bank_mask:0xf
    s_nop 0
    s_nop 0
    s_lshl_b32 s44, s10, 3
    v_mov_b32 v60, s44
    s_mov_b64 exec, 1
    s_lshl_b64 exec, exec, 63
    ds_write_b64 v60, v[58:59] offset:53824
    s_mov_b64 exec, -1
p2_nostat1:
    s_waitcnt lgkmcnt(0)
    s_barrier
    v_bfe_u32 v18, v20, 14, 4
    v_lshrrev_b32 v19, 18, v20
    v_and_b32 v20, 0x3fff, v20
    v_mad_u32_u24 v18, v18, s63, v19
    v_mad_u32_u24 v20, v18, s65, v20
    buffer_load_dwordx4 v[18:21], v20, s[68:71], 0 offen
    v_mov_b32 v122, s19
    s_xor_b32 s19, s19, 4
    ds_read_b32 v125, v122 offset:53760
    s_cmp_lg_u32 s21, 0
    s_cbranch_scc1 p2_nostat2
    v_bfe_u32 v60, v112, 1, 7
    ds_read_b64 v[58:59], v60 offset:53824
    s_waitcnt lgkmcnt(0)
    s_nop 1
    v_max_u32_dpp v58, v58, v58 row_shr:1 row_mask:0xf bank_mask:0xf bound_ctrl:0
    v_add_f32_dpp v59, v59, v59 row_shr:1 row_mask:0xf bank_mask:0xf bound_ctrl:0
    s_nop 0
    v_max_u32_dpp v58, v58, v58 row_shr:2 row_mask:0xf bank_mask:0xf bound_ctrl:0
    v_add_f32_dpp v59, v59, v59 row_shr:2 row_mask:0xf bank_mask:0xf bound_ctrl:0
    s_nop 0
    v_max_u32_dpp v58, v58, v58 row_shr:4 row_mask:0xf bank_mask:0xf bound_ctrl:0
    v_add_f32_dpp v59, v59, v59 row_shr:4 row_mask:0xf bank_mask:0xf bound_ctrl:0
    s_nop 0
    v_max_u32_dpp v58, v58, v58 row_shr:8 row_mask:0xf bank_mask:0xf bound_ctrl:0
    v_add_f32_dpp v59, v59, v59 row_shr:8 row_mask:0xf bank_mask:0xf bound_ctrl:0
    s_nop 0
    v_max_u32_dpp v58, v58, v58 row_bcast:15 row_mask:0xa bank_mask:0xf
    v_add_f32_dpp v59, v59, v59 row_bcast:15 row_mask:0xa bank_mask:0xf
    s_nop 0
    v_max_u32_dpp v58, v58, v58 row_bcast:31 row_mask:0xc bank_mask:0xf
    v_add_f32_dpp v59, v59, v59 row_bcast:31 row_mask:0xc bank_mask:0xf
    s_nop 0
    s_nop 0
    v_readlane_b32 s44, v58, 15
    v_readlane_b32 s45, v59, 15
    s_nop 1
    s_lshl_b32 s44, s44, 16
    s_lshr_b32 s46, s44, 23
    s_sub_u32 s47, s46, 80
    s_cmp_lt_u32 s47, 100
    s_cselect_b32 s21, 0, 1
    v_mov_b32 v58, s45
    v_mul_f32 v58, 0x34a7c5ac, v58
    v_sqrt_f32 v58, v58
    v_mov_b32 v59, s44
    v_mul_f32 v60, 0x41800000, v58
    v_cmp_nle_f32 vcc, v59, v60
    v_mul_f32 v58, 0x3ac00000, v58
    v_mul_f32 v59, 0x3901742e, v59
    v_max_f32 v58, v58, v59
    s_cmp_lg_u64 vcc, 0
    s_cselect_b32 s21, 1, s21
    v_readfirstlane_b32 s44, v58
    s_nop 0
    s_and_b32 s47, s44, 0x7fffff
    s_or_b32 s47, s47, 0x3f000000
    s_and_b32 s48, s44, 0x7f800000
    s_add_u32 s48, s48, 0x800000
    v_rcp_f32 v58, s47
    s_nop 0
    v_rcp_f32 v59, v58
    v_mul_f32 v58, 0x7b800000, v58
    v_mul_f32 v59, s48, v59
    s_nop 0
    v_readfirstlane_b32 s26, v58
    v_readfirstlane_b32 s30, v59
    s_add_u32 s34, s48, 197132288
    s_mov_b32 s35, s34
    s_sub_u32 s36, 0, s34
    s_subb_u32 s37, 0, s34
    s_cmp_eq_u32 s21, 0
    s_cbranch_scc1 p2_nostat2
    s_waitcnt vmcnt(0) lgkmcnt(0)
    s_branch p2_restart
p2_nostat2:
    s_cmp_eq_u32 s21, 0
    s_cselect_b32 s26, s26, 0x7b800000
    v_mov_b32 v114, s26
    s_waitcnt lgkmcnt(0)
    v_readfirstlane_b32 s44, v125
    s_nop 0
    s_cmp_lg_u32 s44, 0
    s_cbranch_scc1 p2_adva
    s_mov_b32 s61, 1
    v_mov_b32 v110, v66
    v_mov_b32 v111, v67
p2_adva:
    v_bfe_u32 v86, v88, 14, 4
    v_lshrrev_b32 v87, 18, v88
    v_and_b32 v88, 0x3fff, v88
    v_mad_u32_u24 v86, v86, s63, v87
    v_mad_u32_u24 v88, v86, s65, v88
    buffer_load_dwordx4 v[86:89], v88, s[68:71], 0 offen
    s_mov_b32 m0, s23
    v_mov_b32 v53, 0
    s_movk_i32 s44, 512
    v_sub_u32_sdwa v4, v111, v110 dst_sel:DWORD dst_unused:UNUSED_PAD src0_sel:WORD_0 src1_sel:WORD_0
    v_sub_u32_sdwa v5, v111, v110 dst_sel:DWORD dst_unused:UNUSED_PAD src0_sel:WORD_1 src1_sel:WORD_1
    v_med3_i32 v4, v4, 0, s44
    v_med3_i32 v5, v5, 0, s44
    v_add_u32 v48, v4, v5
    ds_write_addtid_b32 v53 offset:0
    ds_write_addtid_b32 v53 offset:256
    ds_write_addtid_b32 v53 offset:512
    ds_write_addtid_b32 v53 offset:768
    ds_write_addtid_b32 v53 offset:1024
    ds_write_addtid_b32 v53 offset:1280
    ds_write_addtid_b32 v53 offset:1536
    ds_write_addtid_b32 v53 offset:1792
    v_bfe_i32 v53, v112, 6, 1
    v_lshrrev_b32 v49, 6, v112
    v_bitop3_b32 v53, v53, 15, s10 bitop3:0x6a
    v_lshl_or_b32 v49, v49, 4, v53
    v_and_b32 v53, 0x30, v112
    v_lshl_or_b32 v53, v49, 6, v53
    v_lshlrev_b32 v53, 15, v53
    s_nop 1
    v_add_u32_dpp v48, v48, v48 row_shr:1 row_mask:0xf bank_mask:0xf bound_ctrl:0
    s_nop 1
    v_add_u32_dpp v48, v48, v48 row_shr:2 row_mask:0xf bank_mask:0xf bound_ctrl:0
    s_nop 1
    v_add_u32_dpp v48, v48, v48 row_shr:4 row_mask:0xf bank_mask:0xf bound_ctrl:0
    s_nop 1
    v_add_u32_dpp v48, v48, v48 row_shr:8 row_mask:0xf bank_mask:0xf bound_ctrl:0
    s_nop 1
    v_add_u32_dpp v48, v48, v48 row_bcast:15 row_mask:0xa bank_mask:0xf
    s_nop 1
    v_add_u32_dpp v48, v48, v48 row_bcast:31 row_mask:0xc bank_mask:0xf
    s_nop 1
    s_nop 0
    v_readlane_b32 s38, v48, 63
    v_sub_u32 v50, v48, v5
    v_sub_u32 v49, v50, v4
    v_writelane_b32 v5, 1, 63
    v_sub_u32 v10, 512, v49
    v_mad_u32_u16 v51, v110, 16, v53
    v_lshl_add_u32 v51, v10, 4, v51
    v_med3_i32 v10, v10, 0, v4
    v_lshl_add_u32 v49, v49, 2, s23
    v_sub_u32 v11, 512, v50
    v_mad_u32_u16 v52, v110, 16, v53 op_sel:[1,0,0,0]
    v_add_u32 v52, 262144, v52
    s_mov_b32 s44, 0x1fffc000
    v_writelane_b32 v52, s44, 63
    v_lshl_add_u32 v52, v11, 4, v52
    v_med3_i32 v11, v11, 0, v5
    v_lshl_add_u32 v50, v50, 2, s23
    v_lshl_add_u32 v48, v11, 16, v10
    v_add_u32 v110, v110, v48
    s_min_u32 s17, s38, 512
    s_add_u32 s17, s17, 63
    s_lshr_b32 s17, s17, 6
    v_cmpx_lt_i32 vcc, 0, v10
    ds_write_b32 v49, v51
    s_mov_b64 exec, -1
    v_cmpx_lt_i32 vcc, 0, v11
    ds_write_b32 v50, v52
    s_mov_b64 exec, -1
    s_cmp_lt_u32 s38, 512
    s_cbranch_scc1 p2_nomoreb
    v_cmp_lt_u32_sdwa s[44:45], v110, v111 src0_sel:WORD_0 src1_sel:WORD_0
    v_cmp_lt_u32_sdwa s[46:47], v110, v111 src0_sel:WORD_1 src1_sel:WORD_1
    s_nop 0
    s_or_b64 s[44:45], s[44:45], s[46:47]
    s_cbranch_scc0 p2_nomoreb
    v_mov_b32 v49, s19
    v_mov_b32 v50, 1
    ds_write_b32 v49, v50 offset:53760
p2_nomoreb:
    s_mov_b32 m0, s23
    s_nop 0
    ds_read_addtid_b32 v102 offset:1024
    ds_read_addtid_b32 v103 offset:1280
    ds_read_addtid_b32 v104 offset:1536
    ds_read_addtid_b32 v105 offset:1792
    ds_read_addtid_b32 v106 offset:0
    ds_read_addtid_b32 v107 offset:256
    ds_read_addtid_b32 v108 offset:512
    ds_read_addtid_b32 v109 offset:768
    v_bfe_u32 v90, v92, 14, 4
    v_lshrrev_b32 v91, 18, v92
    v_and_b32 v92, 0x3fff, v92
    v_mad_u32_u24 v90, v90, s63, v91
    v_mad_u32_u24 v92, v90, s65, v92
    buffer_load_dwordx4 v[90:93], v92, s[68:71], 0 offen
    s_waitcnt vmcnt(6)
    s_mov_b32 m0, s24
    s_cmp_ge_u32 s10, 9
    s_cbranch_scc1 p2_stp
    ds_write_addtid_b32 v84 offset:49152
    ds_write_addtid_b32 v85 offset:49408
p2_stp:
    s_mov_b32 m0, s23
    s_add_u32 s20, s20, 53760
    ds_write_addtid_b32 v72 offset:0
    ds_write_addtid_b32 v73 offset:256
    ds_write_addtid_b32 v74 offset:512
    ds_write_addtid_b32 v75 offset:768
    ds_write_addtid_b32 v76 offset:1024
    ds_write_addtid_b32 v77 offset:1280
    ds_write_addtid_b32 v78 offset:1536
    ds_write_addtid_b32 v79 offset:1792
    ds_write_addtid_b32 v80 offset:2048
    ds_write_addtid_b32 v81 offset:2304
    ds_write_addtid_b32 v82 offset:2560
    ds_write_addtid_b32 v83 offset:2816
    s_waitcnt lgkmcnt(0)
    s_barrier
    v_bfe_u32 v94, v96, 14, 4
    v_lshrrev_b32 v95, 18, v96
    v_and_b32 v96, 0x3fff, v96
    v_mad_u32_u24 v94, v94, s63, v95
    v_mad_u32_u24 v96, v94, s65, v96
    buffer_load_dwordx4 v[94:97], v96, s[68:71], 0 offen
    v_bfe_u32 v98, v100, 14, 4
    v_lshrrev_b32 v99, 18, v100
    v_and_b32 v100, 0x3fff, v100
    v_mad_u32_u24 v98, v98, s63, v99
    v_mad_u32_u24 v100, v98, s65, v100
    buffer_load_dwordx4 v[98:101], v100, s[68:71], 0 offen
    s_nop 2
    s_nop 1
    v_max_u32_dpp v106, v106, v106 row_shr:1 row_mask:0xf bank_mask:0xf bound_ctrl:0
    v_max_u32_dpp v107, v107, v107 row_shr:1 row_mask:0xf bank_mask:0xf bound_ctrl:0
    v_max_u32_dpp v108, v108, v108 row_shr:1 row_mask:0xf bank_mask:0xf bound_ctrl:0
    v_max_u32_dpp v109, v109, v109 row_shr:1 row_mask:0xf bank_mask:0xf bound_ctrl:0
    v_max_u32_dpp v106, v106, v106 row_shr:2 row_mask:0xf bank_mask:0xf bound_ctrl:0
    v_max_u32_dpp v107, v107, v107 row_shr:2 row_mask:0xf bank_mask:0xf bound_ctrl:0
    v_max_u32_dpp v108, v108, v108 row_shr:2 row_mask:0xf bank_mask:0xf bound_ctrl:0
    v_max_u32_dpp v109, v109, v109 row_shr:2 row_mask:0xf bank_mask:0xf bound_ctrl:0
    v_max_u32_dpp v106, v106, v106 row_shr:4 row_mask:0xf bank_mask:0xf bound_ctrl:0
    v_max_u32_dpp v107, v107, v107 row_shr:4 row_mask:0xf bank_mask:0xf bound_ctrl:0
    v_max_u32_dpp v108, v108, v108 row_shr:4 row_mask:0xf bank_mask:0xf bound_ctrl:0
    v_max_u32_dpp v109, v109, v109 row_shr:4 row_mask:0xf bank_mask:0xf bound_ctrl:0
    v_max_u32_dpp v106, v106, v106 row_shr:8 row_mask:0xf bank_mask:0xf bound_ctrl:0
    v_max_u32_dpp v107, v107, v107 row_shr:8 row_mask:0xf bank_mask:0xf bound_ctrl:0
    v_max_u32_dpp v108, v108, v108 row_shr:8 row_mask:0xf bank_mask:0xf bound_ctrl:0
    v_max_u32_dpp v109, v109, v109 row_shr:8 row_mask:0xf bank_mask:0xf bound_ctrl:0
    v_max_u32_dpp v106, v106, v106 row_bcast:15 row_mask:0xa bank_mask:0xf
    v_max_u32_dpp v107, v107, v107 row_bcast:15 row_mask:0xa bank_mask:0xf
    v_max_u32_dpp v108, v108, v108 row_bcast:15 row_mask:0xa bank_mask:0xf
    v_max_u32_dpp v109, v109, v109 row_bcast:15 row_mask:0xa bank_mask:0xf
    v_max_u32_dpp v106, v106, v106 row_bcast:31 row_mask:0xc bank_mask:0xf
    v_max_u32_dpp v107, v107, v107 row_bcast:31 row_mask:0xc bank_mask:0xf
    v_max_u32_dpp v108, v108, v108 row_bcast:31 row_mask:0xc bank_mask:0xf
    v_max_u32_dpp v109, v109, v109 row_bcast:31 row_mask:0xc bank_mask:0xf
    s_nop 0
    v_readlane_b32 s41, v106, 63
    v_add_u32 v106, v106, v112
    v_add_u32 v106, 4294959104, v106
    v_max_u32 v107, s41, v107
    s_nop 0
    v_readlane_b32 s41, v107, 63
    v_add_u32 v107, v107, v112
    v_add_u32 v107, 4294960128, v107
    v_max_u32 v108, s41, v108
    s_nop 0
    v_readlane_b32 s41, v108, 63
    v_add_u32 v108, v108, v112
    v_add_u32 v108, 4294961152, v108
    v_max_u32 v109, s41, v109
    s_nop 0
    v_readlane_b32 s41, v109, 63
    v_add_u32 v109, v109, v112
    v_add_u32 v109, 4294962176, v109
    s_waitcnt vmcnt(7)
    v_perm_b32 v48, v3, v0, s31
    v_perm_b32 v49, v3, v1, s32
    v_perm_b32 v50, v3, v2, s33
    v_lshlrev_b16 v4, 3, v2
    v_lshlrev_b16 v2, 3, v1
    v_lshlrev_b16 v0, 3, v0
    v_cmpx_ge_u16 vcc, 0x3fff, v48
    ds_read_b64 v[0:1], v0
    s_mov_b64 exec, -1
    v_cmpx_ge_u16 vcc, 0x3fff, v49
    ds_read_b64 v[2:3], v2
    s_mov_b64 exec, -1
    v_cmpx_ge_u16 vcc, 0x3fff, v50
    ds_read_b64 v[4:5], v4
    s_mov_b64 exec, -1
    s_waitcnt vmcnt(6)
    v_perm_b32 v51, v9, v6, s31
    v_perm_b32 v52, v9, v7, s32
    v_perm_b32 v53, v9, v8, s33
    v_lshlrev_b16 v10, 3, v8
    v_lshlrev_b16 v8, 3, v7
    v_lshlrev_b16 v6, 3, v6
    v_cmpx_ge_u16 vcc, 0x3fff, v51
    ds_read_b64 v[6:7], v6
    s_mov_b64 exec, -1
    v_cmpx_ge_u16 vcc, 0x3fff, v52
    ds_read_b64 v[8:9], v8
    s_mov_b64 exec, -1
    v_cmpx_ge_u16 vcc, 0x3fff, v53
    ds_read_b64 v[10:11], v10
    s_mov_b64 exec, -1
    s_waitcnt vmcnt(5)
    v_perm_b32 v54, v15, v12, s31
    v_perm_b32 v55, v15, v13, s32
    v_perm_b32 v56, v15, v14, s33
    v_lshlrev_b16 v16, 3, v14
    v_lshlrev_b16 v14, 3, v13
    v_lshlrev_b16 v12, 3, v12
    v_cmpx_ge_u16 vcc, 0x3fff, v54
    ds_read_b64 v[12:13], v12
    s_mov_b64 exec, -1
    v_cmpx_ge_u16 vcc, 0x3fff, v55
    ds_read_b64 v[14:15], v14
    s_mov_b64 exec, -1
    v_cmpx_ge_u16 vcc, 0x3fff, v56
    ds_read_b64 v[16:17], v16
    s_mov_b64 exec, -1
    s_waitcnt vmcnt(4)
    v_perm_b32 v57, v21, v18, s31
    v_perm_b32 v58, v21, v19, s32
    v_perm_b32 v59, v21, v20, s33
    v_lshlrev_b16 v22, 3, v20
    v_lshlrev_b16 v20, 3, v19
    v_lshlrev_b16 v18, 3, v18
    s_cmp_lt_u32 s16, 8
    s_cbranch_scc1 p2_gp
    v_cmpx_ge_u16 vcc, 0x3fff, v57
    ds_read_b64 v[18:19], v18
    s_mov_b64 exec, -1
    v_cmpx_ge_u16 vcc, 0x3fff, v58
    ds_read_b64 v[20:21], v20
    s_mov_b64 exec, -1
    v_cmpx_ge_u16 vcc, 0x3fff, v59
    ds_read_b64 v[22:23], v22
    s_mov_b64 exec, -1
p2_gp:
    s_waitcnt vmcnt(3)
    v_perm_b32 v60, v89, v86, s31
    v_perm_b32 v61, v89, v87, s32
    v_perm_b32 v62, v89, v88, s33
    v_lshlrev_b16 v28, 3, v88
    v_lshlrev_b16 v26, 3, v87
    v_lshlrev_b16 v24, 3, v86
    v_cmpx_ge_u16 vcc, 0x3fff, v60
    ds_read_b64 v[24:25], v24
    s_mov_b64 exec, -1
    v_cmpx_ge_u16 vcc, 0x3fff, v61
    ds_read_b64 v[26:27], v26
    s_mov_b64 exec, -1
    v_cmpx_ge_u16 vcc, 0x3fff, v62
    ds_read_b64 v[28:29], v28
    s_mov_b64 exec, -1
    v_bfe_u32 v86, v106, 14, 4
    v_lshrrev_b32 v87, 18, v106
    v_and_b32 v106, 0x3fff, v106
    v_mad_u32_u24 v86, v86, s63, v87
    v_mad_u32_u24 v106, v86, s65, v106
    buffer_load_dwordx4 v[86:89], v106, s[68:71], 0 offen
    s_cmp_ge_u32 s10, 9
    s_cbranch_scc1 p2_nmq
    v_lshrrev_b32 v84, 1, v112
    s_add_u32 s44, s20, s42
    buffer_load_dwordx2 v[84:85], v84, s[4:7], s44 offen
p2_nmq:
    buffer_load_dwordx4 v[72:75], v112, s[4:7], s20 offen offset:0
    buffer_load_dwordx4 v[76:79], v112, s[4:7], s20 offen offset:1024
    buffer_load_dwordx4 v[80:83], v112, s[4:7], s20 offen offset:2048
    s_waitcnt vmcnt(6)
    v_perm_b32 v63, v93, v90, s31
    v_perm_b32 v64, v93, v91, s32
    v_perm_b32 v65, v93, v92, s33
    v_lshlrev_b16 v34, 3, v92
    v_lshlrev_b16 v32, 3, v91
    v_lshlrev_b16 v30, 3, v90
    v_cmpx_ge_u16 vcc, 0x3fff, v63
    ds_read_b64 v[30:31], v30
    s_mov_b64 exec, -1
    v_cmpx_ge_u16 vcc, 0x3fff, v64
    ds_read_b64 v[32:33], v32
    s_mov_b64 exec, -1
    v_cmpx_ge_u16 vcc, 0x3fff, v65
    ds_read_b64 v[34:35], v34
    s_mov_b64 exec, -1
    v_bfe_u32 v90, v107, 14, 4
    v_lshrrev_b32 v91, 18, v107
    v_and_b32 v107, 0x3fff, v107
    v_mad_u32_u24 v90, v90, s63, v91
    v_mad_u32_u24 v107, v90, s65, v107
    buffer_load_dwordx4 v[90:93], v107, s[68:71], 0 offen
    s_waitcnt vmcnt(6)
    v_perm_b32 v66, v97, v94, s31
    v_perm_b32 v67, v97, v95, s32
    v_perm_b32 v68, v97, v96, s33
    v_lshlrev_b16 v40, 3, v96
    v_lshlrev_b16 v38, 3, v95
    v_lshlrev_b16 v36, 3, v94
    v_cmpx_ge_u16 vcc, 0x3fff, v66
    ds_read_b64 v[36:37], v36
    s_mov_b64 exec, -1
    v_cmpx_ge_u16 vcc, 0x3fff, v67
    ds_read_b64 v[38:39], v38
    s_mov_b64 exec, -1
    v_cmpx_ge_u16 vcc, 0x3fff, v68
    ds_read_b64 v[40:41], v40
    s_mov_b64 exec, -1
    v_bfe_u32 v94, v108, 14, 4
    v_lshrrev_b32 v95, 18, v108
    v_and_b32 v108, 0x3fff, v108
    v_mad_u32_u24 v94, v94, s63, v95
    v_mad_u32_u24 v108, v94, s65, v108
    buffer_load_dwordx4 v[94:97], v108, s[68:71], 0 offen
    s_waitcnt vmcnt(6)
    v_perm_b32 v69, v101, v98, s31
    v_perm_b32 v70, v101, v99, s32
    v_perm_b32 v71, v101, v100, s33
    v_lshlrev_b16 v46, 3, v100
    v_lshlrev_b16 v44, 3, v99
    v_lshlrev_b16 v42, 3, v98
    v_cmpx_ge_u16 vcc, 0x3fff, v69
    ds_read_b64 v[42:43], v42
    s_mov_b64 exec, -1
    v_cmpx_ge_u16 vcc, 0x3fff, v70
    ds_read_b64 v[44:45], v44
    s_mov_b64 exec, -1
    v_cmpx_ge_u16 vcc, 0x3fff, v71
    ds_read_b64 v[46:47], v46
    s_mov_b64 exec, -1
    s_waitcnt lgkmcnt(0)
    s_barrier
    s_branch p2_tail
p2_top:
    s_cmp_lg_u32 s21, 0
    s_cbranch_scc1 p2_topf
    s_cmp_eq_u32 s60, 10
    s_cbranch_scc1 p2_drain0
    s_setprio 3
    v_cmpx_gt_i16 vcc, 0, v48
    ds_read_b64 v[0:1], v0
    s_mov_b64 exec, -1
    v_cmpx_gt_i16 vcc, 0, v49
    ds_read_b64 v[2:3], v2
    s_mov_b64 exec, -1
    v_cmpx_gt_i16 vcc, 0, v50
    ds_read_b64 v[4:5], v4
    s_mov_b64 exec, -1
    v_cmpx_gt_i16 vcc, 0, v51
    ds_read_b64 v[6:7], v6
    s_mov_b64 exec, -1
    v_cmpx_gt_i16 vcc, 0, v52
    ds_read_b64 v[8:9], v8
    s_mov_b64 exec, -1
    v_cmpx_gt_i16 vcc, 0, v53
    ds_read_b64 v[10:11], v10
    s_mov_b64 exec, -1
    v_cmpx_gt_i16 vcc, 0, v54
    ds_read_b64 v[12:13], v12
    s_mov_b64 exec, -1
    v_cmpx_gt_i16 vcc, 0, v55
    ds_read_b64 v[14:15], v14
    s_mov_b64 exec, -1
    v_cmpx_gt_i16 vcc, 0, v56
    ds_read_b64 v[16:17], v16
    s_mov_b64 exec, -1
    s_cmp_lt_u32 s15, 8
    s_cbranch_scc1 p2_g0r23
    v_cmpx_gt_i16 vcc, 0, v57
    ds_read_b64 v[18:19], v18
    s_mov_b64 exec, -1
    v_cmpx_gt_i16 vcc, 0, v58
    ds_read_b64 v[20:21], v20
    s_mov_b64 exec, -1
    v_cmpx_gt_i16 vcc, 0, v59
    ds_read_b64 v[22:23], v22
    s_mov_b64 exec, -1
p2_g0r23:
    s_cmp_ge_u32 s10, 9
    s_cbranch_scc1 p2_nm0m0a
    v_lshrrev_b32 v84, 1, v112
    s_add_u32 s44, s20, s42
    buffer_load_dwordx2 v[84:85], v84, s[4:7], s44 offen
p2_nm0m0a:
    buffer_load_dwordx4 v[72:75], v112, s[4:7], s20 offen offset:0
    buffer_load_dwordx4 v[76:79], v112, s[4:7], s20 offen offset:1024
    buffer_load_dwordx4 v[80:83], v112, s[4:7], s20 offen offset:2048
    v_cmpx_gt_i16 vcc, 0, v60
    ds_read_b64 v[24:25], v24
    s_mov_b64 exec, -1
    v_cmpx_gt_i16 vcc, 0, v61
    ds_read_b64 v[26:27], v26
    s_mov_b64 exec, -1
    v_cmpx_gt_i16 vcc, 0, v62
    ds_read_b64 v[28:29], v28
    s_mov_b64 exec, -1
    v_cmpx_gt_i16 vcc, 0, v63
    ds_read_b64 v[30:31], v30
    s_mov_b64 exec, -1
    v_cmpx_gt_i16 vcc, 0, v64
    ds_read_b64 v[32:33], v32
    s_mov_b64 exec, -1
    v_cmpx_gt_i16 vcc, 0, v65
    ds_read_b64 v[34:35], v34
    s_mov_b64 exec, -1
    v_cmpx_gt_i16 vcc, 0, v66
    ds_read_b64 v[36:37], v36
    s_mov_b64 exec, -1
    v_cmpx_gt_i16 vcc, 0, v67
    ds_read_b64 v[38:39], v38
    s_mov_b64 exec, -1
    v_cmpx_gt_i16 vcc, 0, v68
    ds_read_b64 v[40:41], v40
    s_mov_b64 exec, -1
    v_cmpx_gt_i16 vcc, 0, v69
    ds_read_b64 v[42:43], v42
    s_mov_b64 exec, -1
    v_cmpx_gt_i16 vcc, 0, v70
    ds_read_b64 v[44:45], v44
    s_mov_b64 exec, -1
    v_cmpx_gt_i16 vcc, 0, v71
    ds_read_b64 v[46:47], v46
    s_mov_b64 exec, -1
    s_setprio 2
    s_waitcnt lgkmcnt(15)
    v_ashrrev_i32 v122, 5, v48
    v_lshlrev_b16 v123, 2, v48
    v_lshlrev_b32 v124, 16, v0
    v_bitop3_b32 v122, v122, v113, v113 bitop3:0x0c
    v_and_b32 v125, 0xffff0000, v0
    v_lshlrev_b32 v126, 16, v1
    v_mul_f32 v122, v114, v122
    v_and_b32 v127, 0xffff0000, v1
    v_add_u32 v123, v123, v123
    v_pk_fma_f32 v[124:125], v[124:125], v[122:123], s[34:35] op_sel_hi:[1,0,1]
    v_pk_fma_f32 v[126:127], v[126:127], v[122:123], s[34:35] op_sel_hi:[1,0,1]
    v_lshl_add_u32 v124, v125, 16, v124
    v_lshl_add_u32 v125, v127, 16, v126
    s_waitcnt lgkmcnt(15)
    v_bitop3_b32 v115, v115, v116, v117 bitop3:0xfe
    v_lshl_add_u64 v[124:125], v[124:125], 0, s[36:37]
    v_cmpx_le_u32 vcc, 0x1000000, v48
    ds_add_rtn_u64 v[116:117], v123, v[124:125] offset:54272
    s_mov_b64 exec, -1
    v_ashrrev_i32 v122, 5, v49
    v_lshlrev_b16 v123, 2, v49
    v_lshlrev_b32 v124, 16, v2
    v_bitop3_b32 v122, v122, v113, v113 bitop3:0x0c
    v_and_b32 v125, 0xffff0000, v2
    v_lshlrev_b32 v126, 16, v3
    v_mul_f32 v122, v114, v122
    v_and_b32 v127, 0xffff0000, v3
    v_add_u32 v123, v123, v123
    v_pk_fma_f32 v[124:125], v[124:125], v[122:123], s[34:35] op_sel_hi:[1,0,1]
    v_pk_fma_f32 v[126:127], v[126:127], v[122:123], s[34:35] op_sel_hi:[1,0,1]
    v_lshl_add_u32 v124, v125, 16, v124
    v_lshl_add_u32 v125, v127, 16, v126
    s_waitcnt lgkmcnt(15)
    v_bitop3_b32 v115, v115, v118, v119 bitop3:0xfe
    v_lshl_add_u64 v[124:125], v[124:125], 0, s[36:37]
    v_cmpx_le_u32 vcc, 0x1000000, v49
    ds_add_rtn_u64 v[118:119], v123, v[124:125] offset:54272
    s_mov_b64 exec, -1
    v_ashrrev_i32 v122, 5, v50
    v_lshlrev_b16 v123, 2, v50
    v_lshlrev_b32 v124, 16, v4
    v_bitop3_b32 v122, v122, v113, v113 bitop3:0x0c
    v_and_b32 v125, 0xffff0000, v4
    v_lshlrev_b32 v126, 16, v5
    v_mul_f32 v122, v114, v122
    v_and_b32 v127, 0xffff0000, v5
    v_add_u32 v123, v123, v123
    v_pk_fma_f32 v[124:125], v[124:125], v[122:123], s[34:35] op_sel_hi:[1,0,1]
    v_pk_fma_f32 v[126:127], v[126:127], v[122:123], s[34:35] op_sel_hi:[1,0,1]
    v_lshl_add_u32 v124, v125, 16, v124
    v_lshl_add_u32 v125, v127, 16, v126
    s_waitcnt lgkmcnt(15)
    v_bitop3_b32 v115, v115, v120, v121 bitop3:0xfe
    v_lshl_add_u64 v[124:125], v[124:125], 0, s[36:37]
    v_cmpx_le_u32 vcc, 0x1000000, v50
    ds_add_rtn_u64 v[120:121], v123, v[124:125] offset:54272
    s_mov_b64 exec, -1
    v_bfe_u32 v0, v102, 14, 4
    v_lshrrev_b32 v1, 18, v102
    v_and_b32 v102, 0x3fff, v102
    v_mad_u32_u24 v0, v0, s63, v1
    v_mad_u32_u24 v102, v0, s65, v102
    buffer_load_dwordx4 v[0:3], v102, s[68:71], 0 offen
    s_setprio 1
    s_waitcnt lgkmcnt(15)
    v_ashrrev_i32 v122, 5, v51
    v_lshlrev_b16 v123, 2, v51
    v_lshlrev_b32 v124, 16, v6
    v_bitop3_b32 v122, v122, v113, v113 bitop3:0x0c
    v_and_b32 v125, 0xffff0000, v6
    v_lshlrev_b32 v126, 16, v7
    v_mul_f32 v122, v114, v122
    v_and_b32 v127, 0xffff0000, v7
    v_add_u32 v123, v123, v123
    v_pk_fma_f32 v[124:125], v[124:125], v[122:123], s[34:35] op_sel_hi:[1,0,1]
    v_pk_fma_f32 v[126:127], v[126:127], v[122:123], s[34:35] op_sel_hi:[1,0,1]
    v_lshl_add_u32 v124, v125, 16, v124
    v_lshl_add_u32 v125, v127, 16, v126
    s_waitcnt lgkmcnt(2)
    v_bitop3_b32 v115, v115, v116, v117 bitop3:0xfe
    v_lshl_add_u64 v[124:125], v[124:125], 0, s[36:37]
    v_cmpx_le_u32 vcc, 0x1000000, v51
    ds_add_rtn_u64 v[116:117], v123, v[124:125] offset:54272
    s_mov_b64 exec, -1
    v_ashrrev_i32 v122, 5, v52
    v_lshlrev_b16 v123, 2, v52
    v_lshlrev_b32 v124, 16, v8
    v_bitop3_b32 v122, v122, v113, v113 bitop3:0x0c
    v_and_b32 v125, 0xffff0000, v8
    v_lshlrev_b32 v126, 16, v9
    v_mul_f32 v122, v114, v122
    v_and_b32 v127, 0xffff0000, v9
    v_add_u32 v123, v123, v123
    v_pk_fma_f32 v[124:125], v[124:125], v[122:123], s[34:35] op_sel_hi:[1,0,1]
    v_pk_fma_f32 v[126:127], v[126:127], v[122:123], s[34:35] op_sel_hi:[1,0,1]
    v_lshl_add_u32 v124, v125, 16, v124
    v_lshl_add_u32 v125, v127, 16, v126
    s_waitcnt lgkmcnt(2)
    v_bitop3_b32 v115, v115, v118, v119 bitop3:0xfe
    v_lshl_add_u64 v[124:125], v[124:125], 0, s[36:37]
    v_cmpx_le_u32 vcc, 0x1000000, v52
    ds_add_rtn_u64 v[118:119], v123, v[124:125] offset:54272
    s_mov_b64 exec, -1
    v_ashrrev_i32 v122, 5, v53
    v_lshlrev_b16 v123, 2, v53
    v_lshlrev_b32 v124, 16, v10
    v_bitop3_b32 v122, v122, v113, v113 bitop3:0x0c
    v_and_b32 v125, 0xffff0000, v10
    v_lshlrev_b32 v126, 16, v11
    v_mul_f32 v122, v114, v122
    v_and_b32 v127, 0xffff0000, v11
    v_add_u32 v123, v123, v123
    v_pk_fma_f32 v[124:125], v[124:125], v[122:123], s[34:35] op_sel_hi:[1,0,1]
    v_pk_fma_f32 v[126:127], v[126:127], v[122:123], s[34:35] op_sel_hi:[1,0,1]
    v_lshl_add_u32 v124, v125, 16, v124
    v_lshl_add_u32 v125, v127, 16, v126
    s_waitcnt lgkmcnt(2)
    v_bitop3_b32 v115, v115, v120, v121 bitop3:0xfe
    v_lshl_add_u64 v[124:125], v[124:125], 0, s[36:37]
    v_cmpx_le_u32 vcc, 0x1000000, v53
    ds_add_rtn_u64 v[120:121], v123, v[124:125] offset:54272
    s_mov_b64 exec, -1
    v_bfe_u32 v6, v103, 14, 4
    v_lshrrev_b32 v7, 18, v103
    v_and_b32 v103, 0x3fff, v103
    v_mad_u32_u24 v6, v6, s63, v7
    v_mad_u32_u24 v103, v6, s65, v103
    buffer_load_dwordx4 v[6:9], v103, s[68:71], 0 offen
    s_waitcnt lgkmcnt(6)
    s_barrier
    s_setprio 3
    s_waitcnt vmcnt(5)
    s_mov_b32 m0, s23
    v_mov_b32 v53, 0
    s_movk_i32 s44, 512
    v_sub_u32_sdwa v4, v111, v110 dst_sel:DWORD dst_unused:UNUSED_PAD src0_sel:WORD_0 src1_sel:WORD_0
    v_sub_u32_sdwa v5, v111, v110 dst_sel:DWORD dst_unused:UNUSED_PAD src0_sel:WORD_1 src1_sel:WORD_1
    v_med3_i32 v4, v4, 0, s44
    v_med3_i32 v5, v5, 0, s44
    v_add_u32 v48, v4, v5
    ds_write_addtid_b32 v53 offset:0
    ds_write_addtid_b32 v53 offset:256
    ds_write_addtid_b32 v53 offset:512
    ds_write_addtid_b32 v53 offset:768
    ds_write_addtid_b32 v53 offset:1024
    ds_write_addtid_b32 v53 offset:1280
    ds_write_addtid_b32 v53 offset:1536
    ds_write_addtid_b32 v53 offset:1792
    v_bfe_i32 v53, v112, 6, 1
    v_lshrrev_b32 v49, 6, v112
    v_bitop3_b32 v53, v53, 15, s10 bitop3:0x6a
    v_lshl_or_b32 v49, v49, 4, v53
    v_and_b32 v53, 0x30, v112
    v_lshl_or_b32 v53, v49, 6, v53
    v_lshlrev_b32 v53, 15, v53
    s_nop 1
    v_add_u32_dpp v48, v48, v48 row_shr:1 row_mask:0xf bank_mask:0xf bound_ctrl:0
    s_nop 1
    v_add_u32_dpp v48, v48, v48 row_shr:2 row_mask:0xf bank_mask:0xf bound_ctrl:0
    s_nop 1
    v_add_u32_dpp v48, v48, v48 row_shr:4 row_mask:0xf bank_mask:0xf bound_ctrl:0
    s_nop 1
    v_add_u32_dpp v48, v48, v48 row_shr:8 row_mask:0xf bank_mask:0xf bound_ctrl:0
    s_nop 1
    v_add_u32_dpp v48, v48, v48 row_bcast:15 row_mask:0xa bank_mask:0xf
    s_nop 1
    v_add_u32_dpp v48, v48, v48 row_bcast:31 row_mask:0xc bank_mask:0xf
    s_nop 1
    s_nop 0
    v_readlane_b32 s38, v48, 63
    v_sub_u32 v50, v48, v5
    v_sub_u32 v49, v50, v4
    v_writelane_b32 v5, 1, 63
    v_sub_u32 v10, 512, v49
    v_mad_u32_u16 v51, v110, 16, v53
    v_lshl_add_u32 v51, v10, 4, v51
    v_med3_i32 v10, v10, 0, v4
    v_lshl_add_u32 v49, v49, 2, s23
    v_sub_u32 v11, 512, v50
    v_mad_u32_u16 v52, v110, 16, v53 op_sel:[1,0,0,0]
    v_add_u32 v52, 262144, v52
    s_mov_b32 s44, 0x1fffc000
    v_writelane_b32 v52, s44, 63
    v_lshl_add_u32 v52, v11, 4, v52
    v_med3_i32 v11, v11, 0, v5
    v_lshl_add_u32 v50, v50, 2, s23
    v_lshl_add_u32 v48, v11, 16, v10
    v_add_u32 v110, v110, v48
    s_min_u32 s17, s38, 512
    s_add_u32 s17, s17, 63
    s_lshr_b32 s17, s17, 6
    v_cmpx_lt_i32 vcc, 0, v10
    ds_write_b32 v49, v51
    s_mov_b64 exec, -1
    v_cmpx_lt_i32 vcc, 0, v11
    ds_write_b32 v50, v52
    s_mov_b64 exec, -1
    s_cmp_lt_u32 s38, 512
    s_cbranch_scc1 p2_nomore0x
    v_cmp_lt_u32_sdwa s[44:45], v110, v111 src0_sel:WORD_0 src1_sel:WORD_0
    v_cmp_lt_u32_sdwa s[46:47], v110, v111 src0_sel:WORD_1 src1_sel:WORD_1
    s_nop 0
    s_or_b64 s[44:45], s[44:45], s[46:47]
    s_cbranch_scc0 p2_nomore0x
    v_mov_b32 v49, s19
    v_mov_b32 v50, 1
    ds_write_b32 v49, v50 offset:53760
p2_nomore0x:
    s_setprio 2
    s_waitcnt lgkmcnt(15)
    v_ashrrev_i32 v122, 5, v54
    v_lshlrev_b16 v123, 2, v54
    v_lshlrev_b32 v124, 16, v12
    v_bitop3_b32 v122, v122, v113, v113 bitop3:0x0c
    v_and_b32 v125, 0xffff0000, v12
    v_lshlrev_b32 v126, 16, v13
    v_mul_f32 v122, v114, v122
    v_and_b32 v127, 0xffff0000, v13
    v_add_u32 v123, v123, v123
    v_pk_fma_f32 v[124:125], v[124:125], v[122:123], s[34:35] op_sel_hi:[1,0,1]
    v_pk_fma_f32 v[126:127], v[126:127], v[122:123], s[34:35] op_sel_hi:[1,0,1]
    v_lshl_add_u32 v124, v125, 16, v124
    v_lshl_add_u32 v125, v127, 16, v126
    s_waitcnt lgkmcnt(12)
    v_bitop3_b32 v115, v115, v116, v117 bitop3:0xfe
    v_lshl_add_u64 v[124:125], v[124:125], 0, s[36:37]
    v_cmpx_le_u32 vcc, 0x1000000, v54
    ds_add_rtn_u64 v[116:117], v123, v[124:125] offset:54272
    s_mov_b64 exec, -1
    v_ashrrev_i32 v122, 5, v55
    v_lshlrev_b16 v123, 2, v55
    v_lshlrev_b32 v124, 16, v14
    v_bitop3_b32 v122, v122, v113, v113 bitop3:0x0c
    v_and_b32 v125, 0xffff0000, v14
    v_lshlrev_b32 v126, 16, v15
    v_mul_f32 v122, v114, v122
    v_and_b32 v127, 0xffff0000, v15
    v_add_u32 v123, v123, v123
    v_pk_fma_f32 v[124:125], v[124:125], v[122:123], s[34:35] op_sel_hi:[1,0,1]
    v_pk_fma_f32 v[126:127], v[126:127], v[122:123], s[34:35] op_sel_hi:[1,0,1]
    v_lshl_add_u32 v124, v125, 16, v124
    v_lshl_add_u32 v125, v127, 16, v126
    s_waitcnt lgkmcnt(12)
    v_bitop3_b32 v115, v115, v118, v119 bitop3:0xfe
    v_lshl_add_u64 v[124:125], v[124:125], 0, s[36:37]
    v_cmpx_le_u32 vcc, 0x1000000, v55
    ds_add_rtn_u64 v[118:119], v123, v[124:125] offset:54272
    s_mov_b64 exec, -1
    v_ashrrev_i32 v122, 5, v56
    v_lshlrev_b16 v123, 2, v56
    v_lshlrev_b32 v124, 16, v16
    v_bitop3_b32 v122, v122, v113, v113 bitop3:0x0c
    v_and_b32 v125, 0xffff0000, v16
    v_lshlrev_b32 v126, 16, v17
    v_mul_f32 v122, v114, v122
    v_and_b32 v127, 0xffff0000, v17
    v_add_u32 v123, v123, v123
    v_pk_fma_f32 v[124:125], v[124:125], v[122:123], s[34:35] op_sel_hi:[1,0,1]
    v_pk_fma_f32 v[126:127], v[126:127], v[122:123], s[34:35] op_sel_hi:[1,0,1]
    v_lshl_add_u32 v124, v125, 16, v124
    v_lshl_add_u32 v125, v127, 16, v126
    s_waitcnt lgkmcnt(12)
    v_bitop3_b32 v115, v115, v120, v121 bitop3:0xfe
    v_lshl_add_u64 v[124:125], v[124:125], 0, s[36:37]
    v_cmpx_le_u32 vcc, 0x1000000, v56
    ds_add_rtn_u64 v[120:121], v123, v[124:125] offset:54272
    s_mov_b64 exec, -1
    v_bfe_u32 v12, v104, 14, 4
    v_lshrrev_b32 v13, 18, v104
    v_and_b32 v104, 0x3fff, v104
    v_mad_u32_u24 v12, v12, s63, v13
    v_mad_u32_u24 v104, v12, s65, v104
    buffer_load_dwordx4 v[12:15], v104, s[68:71], 0 offen
    s_cmp_lt_u32 s15, 8
    s_cbranch_scc1 p2_na0a3
    s_waitcnt lgkmcnt(15)
    v_ashrrev_i32 v122, 5, v57
    v_lshlrev_b16 v123, 2, v57
    v_lshlrev_b32 v124, 16, v18
    v_bitop3_b32 v122, v122, v113, v113 bitop3:0x0c
    v_and_b32 v125, 0xffff0000, v18
    v_lshlrev_b32 v126, 16, v19
    v_mul_f32 v122, v114, v122
    v_and_b32 v127, 0xffff0000, v19
    v_add_u32 v123, v123, v123
    v_pk_fma_f32 v[124:125], v[124:125], v[122:123], s[34:35] op_sel_hi:[1,0,1]
    v_pk_fma_f32 v[126:127], v[126:127], v[122:123], s[34:35] op_sel_hi:[1,0,1]
    v_lshl_add_u32 v124, v125, 16, v124
    v_lshl_add_u32 v125, v127, 16, v126
    s_waitcnt lgkmcnt(2)
    v_bitop3_b32 v115, v115, v116, v117 bitop3:0xfe
    v_lshl_add_u64 v[124:125], v[124:125], 0, s[36:37]
    v_cmpx_le_u32 vcc, 0x1000000, v57
    ds_add_rtn_u64 v[116:117], v123, v[124:125] offset:54272
    s_mov_b64 exec, -1
    v_ashrrev_i32 v122, 5, v58
    v_lshlrev_b16 v123, 2, v58
    v_lshlrev_b32 v124, 16, v20
    v_bitop3_b32 v122, v122, v113, v113 bitop3:0x0c
    v_and_b32 v125, 0xffff0000, v20
    v_lshlrev_b32 v126, 16, v21
    v_mul_f32 v122, v114, v122
    v_and_b32 v127, 0xffff0000, v21
    v_add_u32 v123, v123, v123
    v_pk_fma_f32 v[124:125], v[124:125], v[122:123], s[34:35] op_sel_hi:[1,0,1]
    v_pk_fma_f32 v[126:127], v[126:127], v[122:123], s[34:35] op_sel_hi:[1,0,1]
    v_lshl_add_u32 v124, v125, 16, v124
    v_lshl_add_u32 v125, v127, 16, v126
    s_waitcnt lgkmcnt(2)
    v_bitop3_b32 v115, v115, v118, v119 bitop3:0xfe
    v_lshl_add_u64 v[124:125], v[124:125], 0, s[36:37]
    v_cmpx_le_u32 vcc, 0x1000000, v58
    ds_add_rtn_u64 v[118:119], v123, v[124:125] offset:54272
    s_mov_b64 exec, -1
    v_ashrrev_i32 v122, 5, v59
    v_lshlrev_b16 v123, 2, v59
    v_lshlrev_b32 v124, 16, v22
    v_bitop3_b32 v122, v122, v113, v113 bitop3:0x0c
    v_and_b32 v125, 0xffff0000, v22
    v_lshlrev_b32 v126, 16, v23
    v_mul_f32 v122, v114, v122
    v_and_b32 v127, 0xffff0000, v23
    v_add_u32 v123, v123, v123
    v_pk_fma_f32 v[124:125], v[124:125], v[122:123], s[34:35] op_sel_hi:[1,0,1]
    v_pk_fma_f32 v[126:127], v[126:127], v[122:123], s[34:35] op_sel_hi:[1,0,1]
    v_lshl_add_u32 v124, v125, 16, v124
    v_lshl_add_u32 v125, v127, 16, v126
    s_waitcnt lgkmcnt(2)
    v_bitop3_b32 v115, v115, v120, v121 bitop3:0xfe
    v_lshl_add_u64 v[124:125], v[124:125], 0, s[36:37]
    v_cmpx_le_u32 vcc, 0x1000000, v59
    ds_add_rtn_u64 v[120:121], v123, v[124:125] offset:54272
    s_mov_b64 exec, -1
p2_na0a3:
    v_bfe_u32 v18, v105, 14, 4
    v_lshrrev_b32 v19, 18, v105
    v_and_b32 v105, 0x3fff, v105
    v_mad_u32_u24 v18, v18, s63, v19
    v_mad_u32_u24 v105, v18, s65, v105
    buffer_load_dwordx4 v[18:21], v105, s[68:71], 0 offen
    s_mov_b32 m0, s23
    s_nop 0
    ds_read_addtid_b32 v102 offset:1024
    ds_read_addtid_b32 v103 offset:1280
    ds_read_addtid_b32 v104 offset:1536
    ds_read_addtid_b32 v105 offset:1792
    ds_read_addtid_b32 v106 offset:0
    ds_read_addtid_b32 v107 offset:256
    ds_read_addtid_b32 v108 offset:512
    ds_read_addtid_b32 v109 offset:768
    s_waitcnt vmcnt(4)
    s_mov_b32 m0, s24
    s_cmp_ge_u32 s10, 9
    s_cbranch_scc1 p2_st0s0
    ds_write_addtid_b32 v84 offset:49152
    ds_write_addtid_b32 v85 offset:49408
p2_st0s0:
    s_mov_b32 m0, s23
    s_add_u32 s20, s20, 53760
    ds_write_addtid_b32 v72 offset:0
    ds_write_addtid_b32 v73 offset:256
    ds_write_addtid_b32 v74 offset:512
    ds_write_addtid_b32 v75 offset:768
    ds_write_addtid_b32 v76 offset:1024
    ds_write_addtid_b32 v77 offset:1280
    ds_write_addtid_b32 v78 offset:1536
    ds_write_addtid_b32 v79 offset:1792
    ds_write_addtid_b32 v80 offset:2048
    ds_write_addtid_b32 v81 offset:2304
    ds_write_addtid_b32 v82 offset:2560
    ds_write_addtid_b32 v83 offset:2816
    s_setprio 1
    s_waitcnt lgkmcnt(15)
    v_ashrrev_i32 v122, 5, v60
    v_lshlrev_b16 v123, 2, v60
    v_lshlrev_b32 v124, 16, v24
    v_bitop3_b32 v122, v122, v113, v113 bitop3:0x0c
    v_and_b32 v125, 0xffff0000, v24
    v_lshlrev_b32 v126, 16, v25
    v_mul_f32 v122, v114, v122
    v_and_b32 v127, 0xffff0000, v25
    v_add_u32 v123, v123, v123
    v_pk_fma_f32 v[124:125], v[124:125], v[122:123], s[34:35] op_sel_hi:[1,0,1]
    v_pk_fma_f32 v[126:127], v[126:127], v[122:123], s[34:35] op_sel_hi:[1,0,1]
    v_lshl_add_u32 v124, v125, 16, v124
    v_lshl_add_u32 v125, v127, 16, v126
    s_waitcnt lgkmcnt(15)
    v_bitop3_b32 v115, v115, v116, v117 bitop3:0xfe
    v_lshl_add_u64 v[124:125], v[124:125], 0, s[36:37]
    v_cmpx_le_u32 vcc, 0x1000000, v60
    ds_add_rtn_u64 v[116:117], v123, v[124:125] offset:54272
    s_mov_b64 exec, -1
    v_ashrrev_i32 v122, 5, v61
    v_lshlrev_b16 v123, 2, v61
    v_lshlrev_b32 v124, 16, v26
    v_bitop3_b32 v122, v122, v113, v113 bitop3:0x0c
    v_and_b32 v125, 0xffff0000, v26
    v_lshlrev_b32 v126, 16, v27
    v_mul_f32 v122, v114, v122
    v_and_b32 v127, 0xffff0000, v27
    v_add_u32 v123, v123, v123
    v_pk_fma_f32 v[124:125], v[124:125], v[122:123], s[34:35] op_sel_hi:[1,0,1]
    v_pk_fma_f32 v[126:127], v[126:127], v[122:123], s[34:35] op_sel_hi:[1,0,1]
    v_lshl_add_u32 v124, v125, 16, v124
    v_lshl_add_u32 v125, v127, 16, v126
    s_waitcnt lgkmcnt(15)
    v_bitop3_b32 v115, v115, v118, v119 bitop3:0xfe
    v_lshl_add_u64 v[124:125], v[124:125], 0, s[36:37]
    v_cmpx_le_u32 vcc, 0x1000000, v61
    ds_add_rtn_u64 v[118:119], v123, v[124:125] offset:54272
    s_mov_b64 exec, -1
    v_ashrrev_i32 v122, 5, v62
    v_lshlrev_b16 v123, 2, v62
    v_lshlrev_b32 v124, 16, v28
    v_bitop3_b32 v122, v122, v113, v113 bitop3:0x0c
    v_and_b32 v125, 0xffff0000, v28
    v_lshlrev_b32 v126, 16, v29
    v_mul_f32 v122, v114, v122
    v_and_b32 v127, 0xffff0000, v29
    v_add_u32 v123, v123, v123
    v_pk_fma_f32 v[124:125], v[124:125], v[122:123], s[34:35] op_sel_hi:[1,0,1]
    v_pk_fma_f32 v[126:127], v[126:127], v[122:123], s[34:35] op_sel_hi:[1,0,1]
    v_lshl_add_u32 v124, v125, 16, v124
    v_lshl_add_u32 v125, v127, 16, v126
    s_waitcnt lgkmcnt(15)
    v_bitop3_b32 v115, v115, v120, v121 bitop3:0xfe
    v_lshl_add_u64 v[124:125], v[124:125], 0, s[36:37]
    v_cmpx_le_u32 vcc, 0x1000000, v62
    ds_add_rtn_u64 v[120:121], v123, v[124:125] offset:54272
    s_mov_b64 exec, -1
    s_waitcnt vmcnt(16)
    v_perm_b32 v60, v89, v86, s31
    v_perm_b32 v61, v89, v87, s32
    v_perm_b32 v62, v89, v88, s33
    v_lshlrev_b16 v28, 3, v88
    v_lshlrev_b16 v26, 3, v87
    v_lshlrev_b16 v24, 3, v86
    s_waitcnt lgkmcnt(15)
    s_nop 2
    s_nop 1
    v_max_u32_dpp v106, v106, v106 row_shr:1 row_mask:0xf bank_mask:0xf bound_ctrl:0
    v_max_u32_dpp v107, v107, v107 row_shr:1 row_mask:0xf bank_mask:0xf bound_ctrl:0
    s_nop 0
    v_max_u32_dpp v106, v106, v106 row_shr:2 row_mask:0xf bank_mask:0xf bound_ctrl:0
    v_max_u32_dpp v107, v107, v107 row_shr:2 row_mask:0xf bank_mask:0xf bound_ctrl:0
    s_nop 0
    v_max_u32_dpp v106, v106, v106 row_shr:4 row_mask:0xf bank_mask:0xf bound_ctrl:0
    v_max_u32_dpp v107, v107, v107 row_shr:4 row_mask:0xf bank_mask:0xf bound_ctrl:0
    s_nop 0
    v_max_u32_dpp v106, v106, v106 row_shr:8 row_mask:0xf bank_mask:0xf bound_ctrl:0
    v_max_u32_dpp v107, v107, v107 row_shr:8 row_mask:0xf bank_mask:0xf bound_ctrl:0
    s_nop 0
    v_max_u32_dpp v106, v106, v106 row_bcast:15 row_mask:0xa bank_mask:0xf
    v_max_u32_dpp v107, v107, v107 row_bcast:15 row_mask:0xa bank_mask:0xf
    s_nop 0
    v_max_u32_dpp v106, v106, v106 row_bcast:31 row_mask:0xc bank_mask:0xf
    v_max_u32_dpp v107, v107, v107 row_bcast:31 row_mask:0xc bank_mask:0xf
    s_nop 0
    s_nop 0
    v_readlane_b32 s41, v106, 63
    v_add_u32 v106, v106, v112
    v_add_u32 v106, 4294959104, v106
    v_max_u32 v107, s41, v107
    s_nop 0
    v_readlane_b32 s41, v107, 63
    v_add_u32 v107, v107, v112
    v_add_u32 v107, 4294960128, v107
    v_bfe_u32 v86, v106, 14, 4
    v_lshrrev_b32 v87, 18, v106
    v_and_b32 v106, 0x3fff, v106
    v_mad_u32_u24 v86, v86, s63, v87
    v_mad_u32_u24 v106, v86, s65, v106
    buffer_load_dwordx4 v[86:89], v106, s[68:71], 0 offen
    s_setprio 0
    s_waitcnt lgkmcnt(15)
    v_ashrrev_i32 v122, 5, v63
    v_lshlrev_b16 v123, 2, v63
    v_lshlrev_b32 v124, 16, v30
    v_bitop3_b32 v122, v122, v113, v113 bitop3:0x0c
    v_and_b32 v125, 0xffff0000, v30
    v_lshlrev_b32 v126, 16, v31
    v_mul_f32 v122, v114, v122
    v_and_b32 v127, 0xffff0000, v31
    v_add_u32 v123, v123, v123
    v_pk_fma_f32 v[124:125], v[124:125], v[122:123], s[34:35] op_sel_hi:[1,0,1]
    v_pk_fma_f32 v[126:127], v[126:127], v[122:123], s[34:35] op_sel_hi:[1,0,1]
    v_lshl_add_u32 v124, v125, 16, v124
    v_lshl_add_u32 v125, v127, 16, v126
    s_waitcnt lgkmcnt(2)
    v_bitop3_b32 v115, v115, v116, v117 bitop3:0xfe
    v_lshl_add_u64 v[124:125], v[124:125], 0, s[36:37]
    v_cmpx_le_u32 vcc, 0x1000000, v63
    ds_add_rtn_u64 v[116:117], v123, v[124:125] offset:54272
    s_mov_b64 exec, -1
    v_ashrrev_i32 v122, 5, v64
    v_lshlrev_b16 v123, 2, v64
    v_lshlrev_b32 v124, 16, v32
    v_bitop3_b32 v122, v122, v113, v113 bitop3:0x0c
    v_and_b32 v125, 0xffff0000, v32
    v_lshlrev_b32 v126, 16, v33
    v_mul_f32 v122, v114, v122
    v_and_b32 v127, 0xffff0000, v33
    v_add_u32 v123, v123, v123
    v_pk_fma_f32 v[124:125], v[124:125], v[122:123], s[34:35] op_sel_hi:[1,0,1]
    v_pk_fma_f32 v[126:127], v[126:127], v[122:123], s[34:35] op_sel_hi:[1,0,1]
    v_lshl_add_u32 v124, v125, 16, v124
    v_lshl_add_u32 v125, v127, 16, v126
    s_waitcnt lgkmcnt(2)
    v_bitop3_b32 v115, v115, v118, v119 bitop3:0xfe
    v_lshl_add_u64 v[124:125], v[124:125], 0, s[36:37]
    v_cmpx_le_u32 vcc, 0x1000000, v64
    ds_add_rtn_u64 v[118:119], v123, v[124:125] offset:54272
    s_mov_b64 exec, -1
    v_ashrrev_i32 v122, 5, v65
    v_lshlrev_b16 v123, 2, v65
    v_lshlrev_b32 v124, 16, v34
    v_bitop3_b32 v122, v122, v113, v113 bitop3:0x0c
    v_and_b32 v125, 0xffff0000, v34
    v_lshlrev_b32 v126, 16, v35
    v_mul_f32 v122, v114, v122
    v_and_b32 v127, 0xffff0000, v35
    v_add_u32 v123, v123, v123
    v_pk_fma_f32 v[124:125], v[124:125], v[122:123], s[34:35] op_sel_hi:[1,0,1]
    v_pk_fma_f32 v[126:127], v[126:127], v[122:123], s[34:35] op_sel_hi:[1,0,1]
    v_lshl_add_u32 v124, v125, 16, v124
    v_lshl_add_u32 v125, v127, 16, v126
    s_waitcnt lgkmcnt(2)
    v_bitop3_b32 v115, v115, v120, v121 bitop3:0xfe
    v_lshl_add_u64 v[124:125], v[124:125], 0, s[36:37]
    v_cmpx_le_u32 vcc, 0x1000000, v65
    ds_add_rtn_u64 v[120:121], v123, v[124:125] offset:54272
    s_mov_b64 exec, -1
    s_waitcnt vmcnt(13)
    v_perm_b32 v63, v93, v90, s31
    v_perm_b32 v64, v93, v91, s32
    v_perm_b32 v65, v93, v92, s33
    v_lshlrev_b16 v34, 3, v92
    v_lshlrev_b16 v32, 3, v91
    v_lshlrev_b16 v30, 3, v90
    s_waitcnt lgkmcnt(6)
    s_barrier
    s_setprio 3
    s_cmp_ge_u32 s10, 9
    s_cbranch_scc1 p2_nm0m1a
    v_lshrrev_b32 v84, 1, v112
    s_add_u32 s44, s20, s42
    buffer_load_dwordx2 v[84:85], v84, s[4:7], s44 offen
p2_nm0m1a:
    buffer_load_dwordx4 v[72:75], v112, s[4:7], s20 offen offset:0
    buffer_load_dwordx4 v[76:79], v112, s[4:7], s20 offen offset:1024
    buffer_load_dwordx4 v[80:83], v112, s[4:7], s20 offen offset:2048
    v_cmpx_ge_u16 vcc, 0x3fff, v60
    ds_read_b64 v[24:25], v24
    s_mov_b64 exec, -1
    v_cmpx_ge_u16 vcc, 0x3fff, v61
    ds_read_b64 v[26:27], v26
    s_mov_b64 exec, -1
    v_cmpx_ge_u16 vcc, 0x3fff, v62
    ds_read_b64 v[28:29], v28
    s_mov_b64 exec, -1
    v_cmpx_ge_u16 vcc, 0x3fff, v63
    ds_read_b64 v[30:31], v30
    s_mov_b64 exec, -1
    v_cmpx_ge_u16 vcc, 0x3fff, v64
    ds_read_b64 v[32:33], v32
    s_mov_b64 exec, -1
    v_cmpx_ge_u16 vcc, 0x3fff, v65
    ds_read_b64 v[34:35], v34
    s_mov_b64 exec, -1
    s_setprio 2
    s_waitcnt lgkmcnt(15)
    v_ashrrev_i32 v122, 5, v66
    v_lshlrev_b16 v123, 2, v66
    v_lshlrev_b32 v124, 16, v36
    v_bitop3_b32 v122, v122, v113, v113 bitop3:0x0c
    v_and_b32 v125, 0xffff0000, v36
    v_lshlrev_b32 v126, 16, v37
    v_mul_f32 v122, v114, v122
    v_and_b32 v127, 0xffff0000, v37
    v_add_u32 v123, v123, v123
    v_pk_fma_f32 v[124:125], v[124:125], v[122:123], s[34:35] op_sel_hi:[1,0,1]
    v_pk_fma_f32 v[126:127], v[126:127], v[122:123], s[34:35] op_sel_hi:[1,0,1]
    v_lshl_add_u32 v124, v125, 16, v124
    v_lshl_add_u32 v125, v127, 16, v126
    s_waitcnt lgkmcnt(8)
    v_bitop3_b32 v115, v115, v116, v117 bitop3:0xfe
    v_lshl_add_u64 v[124:125], v[124:125], 0, s[36:37]
    v_cmpx_le_u32 vcc, 0x1000000, v66
    ds_add_rtn_u64 v[116:117], v123, v[124:125] offset:54272
    s_mov_b64 exec, -1
    v_ashrrev_i32 v122, 5, v67
    v_lshlrev_b16 v123, 2, v67
    v_lshlrev_b32 v124, 16, v38
    v_bitop3_b32 v122, v122, v113, v113 bitop3:0x0c
    v_and_b32 v125, 0xffff0000, v38
    v_lshlrev_b32 v126, 16, v39
    v_mul_f32 v122, v114, v122
    v_and_b32 v127, 0xffff0000, v39
    v_add_u32 v123, v123, v123
    v_pk_fma_f32 v[124:125], v[124:125], v[122:123], s[34:35] op_sel_hi:[1,0,1]
    v_pk_fma_f32 v[126:127], v[126:127], v[122:123], s[34:35] op_sel_hi:[1,0,1]
    v_lshl_add_u32 v124, v125, 16, v124
    v_lshl_add_u32 v125, v127, 16, v126
    s_waitcnt lgkmcnt(8)
    v_bitop3_b32 v115, v115, v118, v119 bitop3:0xfe
    v_lshl_add_u64 v[124:125], v[124:125], 0, s[36:37]
    v_cmpx_le_u32 vcc, 0x1000000, v67
    ds_add_rtn_u64 v[118:119], v123, v[124:125] offset:54272
    s_mov_b64 exec, -1
    v_ashrrev_i32 v122, 5, v68
    v_lshlrev_b16 v123, 2, v68
    v_lshlrev_b32 v124, 16, v40
    v_bitop3_b32 v122, v122, v113, v113 bitop3:0x0c
    v_and_b32 v125, 0xffff0000, v40
    v_lshlrev_b32 v126, 16, v41
    v_mul_f32 v122, v114, v122
    v_and_b32 v127, 0xffff0000, v41
    v_add_u32 v123, v123, v123
    v_pk_fma_f32 v[124:125], v[124:125], v[122:123], s[34:35] op_sel_hi:[1,0,1]
    v_pk_fma_f32 v[126:127], v[126:127], v[122:123], s[34:35] op_sel_hi:[1,0,1]
    v_lshl_add_u32 v124, v125, 16, v124
    v_lshl_add_u32 v125, v127, 16, v126
    s_waitcnt lgkmcnt(8)
    v_bitop3_b32 v115, v115, v120, v121 bitop3:0xfe
    v_lshl_add_u64 v[124:125], v[124:125], 0, s[36:37]
    v_cmpx_le_u32 vcc, 0x1000000, v68
    ds_add_rtn_u64 v[120:121], v123, v[124:125] offset:54272
    s_mov_b64 exec, -1
    s_waitcnt vmcnt(15)
    v_perm_b32 v66, v97, v94, s31
    v_perm_b32 v67, v97, v95, s32
    v_perm_b32 v68, v97, v96, s33
    v_lshlrev_b16 v40, 3, v96
    v_lshlrev_b16 v38, 3, v95
    v_lshlrev_b16 v36, 3, v94
    v_cmpx_ge_u16 vcc, 0x3fff, v66
    ds_read_b64 v[36:37], v36
    s_mov_b64 exec, -1
    v_cmpx_ge_u16 vcc, 0x3fff, v67
    ds_read_b64 v[38:39], v38
    s_mov_b64 exec, -1
    v_cmpx_ge_u16 vcc, 0x3fff, v68
    ds_read_b64 v[40:41], v40
    s_mov_b64 exec, -1
    v_bfe_u32 v90, v107, 14, 4
    v_lshrrev_b32 v91, 18, v107
    v_and_b32 v107, 0x3fff, v107
    v_mad_u32_u24 v90, v90, s63, v91
    v_mad_u32_u24 v107, v90, s65, v107
    buffer_load_dwordx4 v[90:93], v107, s[68:71], 0 offen
    s_setprio 1
    s_waitcnt lgkmcnt(15)
    v_ashrrev_i32 v122, 5, v69
    v_lshlrev_b16 v123, 2, v69
    v_lshlrev_b32 v124, 16, v42
    v_bitop3_b32 v122, v122, v113, v113 bitop3:0x0c
    v_and_b32 v125, 0xffff0000, v42
    v_lshlrev_b32 v126, 16, v43
    v_mul_f32 v122, v114, v122
    v_and_b32 v127, 0xffff0000, v43
    v_add_u32 v123, v123, v123
    v_pk_fma_f32 v[124:125], v[124:125], v[122:123], s[34:35] op_sel_hi:[1,0,1]
    v_pk_fma_f32 v[126:127], v[126:127], v[122:123], s[34:35] op_sel_hi:[1,0,1]
    v_lshl_add_u32 v124, v125, 16, v124
    v_lshl_add_u32 v125, v127, 16, v126
    s_waitcnt lgkmcnt(5)
    v_bitop3_b32 v115, v115, v116, v117 bitop3:0xfe
    v_lshl_add_u64 v[124:125], v[124:125], 0, s[36:37]
    v_cmpx_le_u32 vcc, 0x1000000, v69
    ds_add_rtn_u64 v[116:117], v123, v[124:125] offset:54272
    s_mov_b64 exec, -1
    v_ashrrev_i32 v122, 5, v70
    v_lshlrev_b16 v123, 2, v70
    v_lshlrev_b32 v124, 16, v44
    v_bitop3_b32 v122, v122, v113, v113 bitop3:0x0c
    v_and_b32 v125, 0xffff0000, v44
    v_lshlrev_b32 v126, 16, v45
    v_mul_f32 v122, v114, v122
    v_and_b32 v127, 0xffff0000, v45
    v_add_u32 v123, v123, v123
    v_pk_fma_f32 v[124:125], v[124:125], v[122:123], s[34:35] op_sel_hi:[1,0,1]
    v_pk_fma_f32 v[126:127], v[126:127], v[122:123], s[34:35] op_sel_hi:[1,0,1]
    v_lshl_add_u32 v124, v125, 16, v124
    v_lshl_add_u32 v125, v127, 16, v126
    s_waitcnt lgkmcnt(5)
    v_bitop3_b32 v115, v115, v118, v119 bitop3:0xfe
    v_lshl_add_u64 v[124:125], v[124:125], 0, s[36:37]
    v_cmpx_le_u32 vcc, 0x1000000, v70
    ds_add_rtn_u64 v[118:119], v123, v[124:125] offset:54272
    s_mov_b64 exec, -1
    v_ashrrev_i32 v122, 5, v71
    v_lshlrev_b16 v123, 2, v71
    v_lshlrev_b32 v124, 16, v46
    v_bitop3_b32 v122, v122, v113, v113 bitop3:0x0c
    v_and_b32 v125, 0xffff0000, v46
    v_lshlrev_b32 v126, 16, v47
    v_mul_f32 v122, v114, v122
    v_and_b32 v127, 0xffff0000, v47
    v_add_u32 v123, v123, v123
    v_pk_fma_f32 v[124:125], v[124:125], v[122:123], s[34:35] op_sel_hi:[1,0,1]
    v_pk_fma_f32 v[126:127], v[126:127], v[122:123], s[34:35] op_sel_hi:[1,0,1]
    v_lshl_add_u32 v124, v125, 16, v124
    v_lshl_add_u32 v125, v127, 16, v126
    s_waitcnt lgkmcnt(5)
    v_bitop3_b32 v115, v115, v120, v121 bitop3:0xfe
    v_lshl_add_u64 v[124:125], v[124:125], 0, s[36:37]
    v_cmpx_le_u32 vcc, 0x1000000, v71
    ds_add_rtn_u64 v[120:121], v123, v[124:125] offset:54272
    s_mov_b64 exec, -1
    s_waitcnt vmcnt(12)
    v_perm_b32 v69, v101, v98, s31
    v_perm_b32 v70, v101, v99, s32
    v_perm_b32 v71, v101, v100, s33
    v_lshlrev_b16 v46, 3, v100
    v_lshlrev_b16 v44, 3, v99
    v_lshlrev_b16 v42, 3, v98
    v_cmpx_ge_u16 vcc, 0x3fff, v69
    ds_read_b64 v[42:43], v42
    s_mov_b64 exec, -1
    v_cmpx_ge_u16 vcc, 0x3fff, v70
    ds_read_b64 v[44:45], v44
    s_mov_b64 exec, -1
    v_cmpx_ge_u16 vcc, 0x3fff, v71
    ds_read_b64 v[46:47], v46
    s_mov_b64 exec, -1
    s_waitcnt lgkmcnt(15)
    s_nop 2
    s_nop 1
    v_max_u32_dpp v108, v108, v108 row_shr:1 row_mask:0xf bank_mask:0xf bound_ctrl:0
    v_max_u32_dpp v109, v109, v109 row_shr:1 row_mask:0xf bank_mask:0xf bound_ctrl:0
    s_nop 0
    v_max_u32_dpp v108, v108, v108 row_shr:2 row_mask:0xf bank_mask:0xf bound_ctrl:0
    v_max_u32_dpp v109, v109, v109 row_shr:2 row_mask:0xf bank_mask:0xf bound_ctrl:0
    s_nop 0
    v_max_u32_dpp v108, v108, v108 row_shr:4 row_mask:0xf bank_mask:0xf bound_ctrl:0
    v_max_u32_dpp v109, v109, v109 row_shr:4 row_mask:0xf bank_mask:0xf bound_ctrl:0
    s_nop 0
    v_max_u32_dpp v108, v108, v108 row_shr:8 row_mask:0xf bank_mask:0xf bound_ctrl:0
    v_max_u32_dpp v109, v109, v109 row_shr:8 row_mask:0xf bank_mask:0xf bound_ctrl:0
    s_nop 0
    v_max_u32_dpp v108, v108, v108 row_bcast:15 row_mask:0xa bank_mask:0xf
    v_max_u32_dpp v109, v109, v109 row_bcast:15 row_mask:0xa bank_mask:0xf
    s_nop 0
    v_max_u32_dpp v108, v108, v108 row_bcast:31 row_mask:0xc bank_mask:0xf
    v_max_u32_dpp v109, v109, v109 row_bcast:31 row_mask:0xc bank_mask:0xf
    s_nop 0
    s_nop 0
    v_max_u32 v108, s41, v108
    s_nop 0
    v_readlane_b32 s41, v108, 63
    v_add_u32 v108, v108, v112
    v_add_u32 v108, 4294961152, v108
    v_max_u32 v109, s41, v109
    s_nop 0
    v_readlane_b32 s41, v109, 63
    v_add_u32 v109, v109, v112
    v_add_u32 v109, 4294962176, v109
    v_bfe_u32 v94, v108, 14, 4
    v_lshrrev_b32 v95, 18, v108
    v_and_b32 v108, 0x3fff, v108
    v_mad_u32_u24 v94, v94, s63, v95
    v_mad_u32_u24 v108, v94, s65, v108
    buffer_load_dwordx4 v[94:97], v108, s[68:71], 0 offen
    s_setprio 0
    s_waitcnt vmcnt(9)
    v_perm_b32 v48, v3, v0, s31
    v_perm_b32 v49, v3, v1, s32
    v_perm_b32 v50, v3, v2, s33
    v_lshlrev_b16 v4, 3, v2
    v_lshlrev_b16 v2, 3, v1
    v_lshlrev_b16 v0, 3, v0
    v_cmpx_ge_u16 vcc, 0x3fff, v48
    ds_read_b64 v[0:1], v0
    s_mov_b64 exec, -1
    v_cmpx_ge_u16 vcc, 0x3fff, v49
    ds_read_b64 v[2:3], v2
    s_mov_b64 exec, -1
    v_cmpx_ge_u16 vcc, 0x3fff, v50
    ds_read_b64 v[4:5], v4
    s_mov_b64 exec, -1
    s_waitcnt vmcnt(8)
    v_perm_b32 v51, v9, v6, s31
    v_perm_b32 v52, v9, v7, s32
    v_perm_b32 v53, v9, v8, s33
    v_lshlrev_b16 v10, 3, v8
    v_lshlrev_b16 v8, 3, v7
    v_lshlrev_b16 v6, 3, v6
    v_cmpx_ge_u16 vcc, 0x3fff, v51
    ds_read_b64 v[6:7], v6
    s_mov_b64 exec, -1
    v_cmpx_ge_u16 vcc, 0x3fff, v52
    ds_read_b64 v[8:9], v8
    s_mov_b64 exec, -1
    v_cmpx_ge_u16 vcc, 0x3fff, v53
    ds_read_b64 v[10:11], v10
    s_mov_b64 exec, -1
    s_waitcnt vmcnt(7)
    v_perm_b32 v54, v15, v12, s31
    v_perm_b32 v55, v15, v13, s32
    v_perm_b32 v56, v15, v14, s33
    v_lshlrev_b16 v16, 3, v14
    v_lshlrev_b16 v14, 3, v13
    v_lshlrev_b16 v12, 3, v12
    v_cmpx_ge_u16 vcc, 0x3fff, v54
    ds_read_b64 v[12:13], v12
    s_mov_b64 exec, -1
    v_cmpx_ge_u16 vcc, 0x3fff, v55
    ds_read_b64 v[14:15], v14
    s_mov_b64 exec, -1
    v_cmpx_ge_u16 vcc, 0x3fff, v56
    ds_read_b64 v[16:17], v16
    s_mov_b64 exec, -1
    s_waitcnt vmcnt(6)
    v_perm_b32 v57, v21, v18, s31
    v_perm_b32 v58, v21, v19, s32
    v_perm_b32 v59, v21, v20, s33
    v_lshlrev_b16 v22, 3, v20
    v_lshlrev_b16 v20, 3, v19
    v_lshlrev_b16 v18, 3, v18
    s_cmp_lt_u32 s16, 8
    s_cbranch_scc1 p2_g0r03
    v_cmpx_ge_u16 vcc, 0x3fff, v57
    ds_read_b64 v[18:19], v18
    s_mov_b64 exec, -1
    v_cmpx_ge_u16 vcc, 0x3fff, v58
    ds_read_b64 v[20:21], v20
    s_mov_b64 exec, -1
    v_cmpx_ge_u16 vcc, 0x3fff, v59
    ds_read_b64 v[22:23], v22
    s_mov_b64 exec, -1
p2_g0r03:
    s_waitcnt lgkmcnt(0)
    s_barrier
    s_waitcnt lgkmcnt(15)
    s_branch p2_tail
p2_drain0:
    v_cmpx_gt_i16 vcc, 0, v48
    ds_read_b64 v[0:1], v0
    s_mov_b64 exec, -1
    v_cmpx_gt_i16 vcc, 0, v49
    ds_read_b64 v[2:3], v2
    s_mov_b64 exec, -1
    v_cmpx_gt_i16 vcc, 0, v50
    ds_read_b64 v[4:5], v4
    s_mov_b64 exec, -1
    v_cmpx_gt_i16 vcc, 0, v51
    ds_read_b64 v[6:7], v6
    s_mov_b64 exec, -1
    v_cmpx_gt_i16 vcc, 0, v52
    ds_read_b64 v[8:9], v8
    s_mov_b64 exec, -1
    v_cmpx_gt_i16 vcc, 0, v53
    ds_read_b64 v[10:11], v10
    s_mov_b64 exec, -1
    v_cmpx_gt_i16 vcc, 0, v54
    ds_read_b64 v[12:13], v12
    s_mov_b64 exec, -1
    v_cmpx_gt_i16 vcc, 0, v55
    ds_read_b64 v[14:15], v14
    s_mov_b64 exec, -1
    v_cmpx_gt_i16 vcc, 0, v56
    ds_read_b64 v[16:17], v16
    s_mov_b64 exec, -1
    s_cmp_lt_u32 s15, 8
    s_cbranch_scc1 p2_gd0
    v_cmpx_gt_i16 vcc, 0, v57
    ds_read_b64 v[18:19], v18
    s_mov_b64 exec, -1
    v_cmpx_gt_i16 vcc, 0, v58
    ds_read_b64 v[20:21], v20
    s_mov_b64 exec, -1
    v_cmpx_gt_i16 vcc, 0, v59
    ds_read_b64 v[22:23], v22
    s_mov_b64 exec, -1
p2_gd0:
    v_cmpx_gt_i16 vcc, 0, v60
    ds_read_b64 v[24:25], v24
    s_mov_b64 exec, -1
    v_cmpx_gt_i16 vcc, 0, v61
    ds_read_b64 v[26:27], v26
    s_mov_b64 exec, -1
    v_cmpx_gt_i16 vcc, 0, v62
    ds_read_b64 v[28:29], v28
    s_mov_b64 exec, -1
    v_cmpx_gt_i16 vcc, 0, v63
    ds_read_b64 v[30:31], v30
    s_mov_b64 exec, -1
    v_cmpx_gt_i16 vcc, 0, v64
    ds_read_b64 v[32:33], v32
    s_mov_b64 exec, -1
    v_cmpx_gt_i16 vcc, 0, v65
    ds_read_b64 v[34:35], v34
    s_mov_b64 exec, -1
    v_cmpx_gt_i16 vcc, 0, v66
    ds_read_b64 v[36:37], v36
    s_mov_b64 exec, -1
    v_cmpx_gt_i16 vcc, 0, v67
    ds_read_b64 v[38:39], v38
    s_mov_b64 exec, -1
    v_cmpx_gt_i16 vcc, 0, v68
    ds_read_b64 v[40:41], v40
    s_mov_b64 exec, -1
    v_cmpx_gt_i16 vcc, 0, v69
    ds_read_b64 v[42:43], v42
    s_mov_b64 exec, -1
    v_cmpx_gt_i16 vcc, 0, v70
    ds_read_b64 v[44:45], v44
    s_mov_b64 exec, -1
    v_cmpx_gt_i16 vcc, 0, v71
    ds_read_b64 v[46:47], v46
    s_mov_b64 exec, -1
    s_waitcnt lgkmcnt(15)
    v_ashrrev_i32 v122, 5, v48
    v_lshlrev_b16 v123, 2, v48
    v_lshlrev_b32 v124, 16, v0
    v_bitop3_b32 v122, v122, v113, v113 bitop3:0x0c
    v_and_b32 v125, 0xffff0000, v0
    v_lshlrev_b32 v126, 16, v1
    v_mul_f32 v122, v114, v122
    v_and_b32 v127, 0xffff0000, v1
    v_add_u32 v123, v123, v123
    v_pk_fma_f32 v[124:125], v[124:125], v[122:123], s[34:35] op_sel_hi:[1,0,1]
    v_pk_fma_f32 v[126:127], v[126:127], v[122:123], s[34:35] op_sel_hi:[1,0,1]
    v_lshl_add_u32 v124, v125, 16, v124
    v_lshl_add_u32 v125, v127, 16, v126
    s_waitcnt lgkmcnt(15)
    v_bitop3_b32 v115, v115, v116, v117 bitop3:0xfe
    v_lshl_add_u64 v[124:125], v[124:125], 0, s[36:37]
    v_cmpx_le_u32 vcc, 0x1000000, v48
    ds_add_rtn_u64 v[116:117], v123, v[124:125] offset:54272
    s_mov_b64 exec, -1
    v_ashrrev_i32 v122, 5, v49
    v_lshlrev_b16 v123, 2, v49
    v_lshlrev_b32 v124, 16, v2
    v_bitop3_b32 v122, v122, v113, v113 bitop3:0x0c
    v_and_b32 v125, 0xffff0000, v2
    v_lshlrev_b32 v126, 16, v3
    v_mul_f32 v122, v114, v122
    v_and_b32 v127, 0xffff0000, v3
    v_add_u32 v123, v123, v123
    v_pk_fma_f32 v[124:125], v[124:125], v[122:123], s[34:35] op_sel_hi:[1,0,1]
    v_pk_fma_f32 v[126:127], v[126:127], v[122:123], s[34:35] op_sel_hi:[1,0,1]
    v_lshl_add_u32 v124, v125, 16, v124
    v_lshl_add_u32 v125, v127, 16, v126
    s_waitcnt lgkmcnt(15)
    v_bitop3_b32 v115, v115, v118, v119 bitop3:0xfe
    v_lshl_add_u64 v[124:125], v[124:125], 0, s[36:37]
    v_cmpx_le_u32 vcc, 0x1000000, v49
    ds_add_rtn_u64 v[118:119], v123, v[124:125] offset:54272
    s_mov_b64 exec, -1
    v_ashrrev_i32 v122, 5, v50
    v_lshlrev_b16 v123, 2, v50
    v_lshlrev_b32 v124, 16, v4
    v_bitop3_b32 v122, v122, v113, v113 bitop3:0x0c
    v_and_b32 v125, 0xffff0000, v4
    v_lshlrev_b32 v126, 16, v5
    v_mul_f32 v122, v114, v122
    v_and_b32 v127, 0xffff0000, v5
    v_add_u32 v123, v123, v123
    v_pk_fma_f32 v[124:125], v[124:125], v[122:123], s[34:35] op_sel_hi:[1,0,1]
    v_pk_fma_f32 v[126:127], v[126:127], v[122:123], s[34:35] op_sel_hi:[1,0,1]
    v_lshl_add_u32 v124, v125, 16, v124
    v_lshl_add_u32 v125, v127, 16, v126
    s_waitcnt lgkmcnt(15)
    v_bitop3_b32 v115, v115, v120, v121 bitop3:0xfe
    v_lshl_add_u64 v[124:125], v[124:125], 0, s[36:37]
    v_cmpx_le_u32 vcc, 0x1000000, v50
    ds_add_rtn_u64 v[120:121], v123, v[124:125] offset:54272
    s_mov_b64 exec, -1
    s_waitcnt lgkmcnt(15)
    v_ashrrev_i32 v122, 5, v51
    v_lshlrev_b16 v123, 2, v51
    v_lshlrev_b32 v124, 16, v6
    v_bitop3_b32 v122, v122, v113, v113 bitop3:0x0c
    v_and_b32 v125, 0xffff0000, v6
    v_lshlrev_b32 v126, 16, v7
    v_mul_f32 v122, v114, v122
    v_and_b32 v127, 0xffff0000, v7
    v_add_u32 v123, v123, v123
    v_pk_fma_f32 v[124:125], v[124:125], v[122:123], s[34:35] op_sel_hi:[1,0,1]
    v_pk_fma_f32 v[126:127], v[126:127], v[122:123], s[34:35] op_sel_hi:[1,0,1]
    v_lshl_add_u32 v124, v125, 16, v124
    v_lshl_add_u32 v125, v127, 16, v126
    s_waitcnt lgkmcnt(2)
    v_bitop3_b32 v115, v115, v116, v117 bitop3:0xfe
    v_lshl_add_u64 v[124:125], v[124:125], 0, s[36:37]
    v_cmpx_le_u32 vcc, 0x1000000, v51
    ds_add_rtn_u64 v[116:117], v123, v[124:125] offset:54272
    s_mov_b64 exec, -1
    v_ashrrev_i32 v122, 5, v52
    v_lshlrev_b16 v123, 2, v52
    v_lshlrev_b32 v124, 16, v8
    v_bitop3_b32 v122, v122, v113, v113 bitop3:0x0c
    v_and_b32 v125, 0xffff0000, v8
    v_lshlrev_b32 v126, 16, v9
    v_mul_f32 v122, v114, v122
    v_and_b32 v127, 0xffff0000, v9
    v_add_u32 v123, v123, v123
    v_pk_fma_f32 v[124:125], v[124:125], v[122:123], s[34:35] op_sel_hi:[1,0,1]
    v_pk_fma_f32 v[126:127], v[126:127], v[122:123], s[34:35] op_sel_hi:[1,0,1]
    v_lshl_add_u32 v124, v125, 16, v124
    v_lshl_add_u32 v125, v127, 16, v126
    s_waitcnt lgkmcnt(2)
    v_bitop3_b32 v115, v115, v118, v119 bitop3:0xfe
    v_lshl_add_u64 v[124:125], v[124:125], 0, s[36:37]
    v_cmpx_le_u32 vcc, 0x1000000, v52
    ds_add_rtn_u64 v[118:119], v123, v[124:125] offset:54272
    s_mov_b64 exec, -1
    v_ashrrev_i32 v122, 5, v53
    v_lshlrev_b16 v123, 2, v53
    v_lshlrev_b32 v124, 16, v10
    v_bitop3_b32 v122, v122, v113, v113 bitop3:0x0c
    v_and_b32 v125, 0xffff0000, v10
    v_lshlrev_b32 v126, 16, v11
    v_mul_f32 v122, v114, v122
    v_and_b32 v127, 0xffff0000, v11
    v_add_u32 v123, v123, v123
    v_pk_fma_f32 v[124:125], v[124:125], v[122:123], s[34:35] op_sel_hi:[1,0,1]
    v_pk_fma_f32 v[126:127], v[126:127], v[122:123], s[34:35] op_sel_hi:[1,0,1]
    v_lshl_add_u32 v124, v125, 16, v124
    v_lshl_add_u32 v125, v127, 16, v126
    s_waitcnt lgkmcnt(2)
    v_bitop3_b32 v115, v115, v120, v121 bitop3:0xfe
    v_lshl_add_u64 v[124:125], v[124:125], 0, s[36:37]
    v_cmpx_le_u32 vcc, 0x1000000, v53
    ds_add_rtn_u64 v[120:121], v123, v[124:125] offset:54272
    s_mov_b64 exec, -1
    s_waitcnt lgkmcnt(15)
    v_ashrrev_i32 v122, 5, v54
    v_lshlrev_b16 v123, 2, v54
    v_lshlrev_b32 v124, 16, v12
    v_bitop3_b32 v122, v122, v113, v113 bitop3:0x0c
    v_and_b32 v125, 0xffff0000, v12
    v_lshlrev_b32 v126, 16, v13
    v_mul_f32 v122, v114, v122
    v_and_b32 v127, 0xffff0000, v13
    v_add_u32 v123, v123, v123
    v_pk_fma_f32 v[124:125], v[124:125], v[122:123], s[34:35] op_sel_hi:[1,0,1]
    v_pk_fma_f32 v[126:127], v[126:127], v[122:123], s[34:35] op_sel_hi:[1,0,1]
    v_lshl_add_u32 v124, v125, 16, v124
    v_lshl_add_u32 v125, v127, 16, v126
    s_waitcnt lgkmcnt(2)
    v_bitop3_b32 v115, v115, v116, v117 bitop3:0xfe
    v_lshl_add_u64 v[124:125], v[124:125], 0, s[36:37]
    v_cmpx_le_u32 vcc, 0x1000000, v54
    ds_add_rtn_u64 v[116:117], v123, v[124:125] offset:54272
    s_mov_b64 exec, -1
    v_ashrrev_i32 v122, 5, v55
    v_lshlrev_b16 v123, 2, v55
    v_lshlrev_b32 v124, 16, v14
    v_bitop3_b32 v122, v122, v113, v113 bitop3:0x0c
    v_and_b32 v125, 0xffff0000, v14
    v_lshlrev_b32 v126, 16, v15
    v_mul_f32 v122, v114, v122
    v_and_b32 v127, 0xffff0000, v15
    v_add_u32 v123, v123, v123
    v_pk_fma_f32 v[124:125], v[124:125], v[122:123], s[34:35] op_sel_hi:[1,0,1]
    v_pk_fma_f32 v[126:127], v[126:127], v[122:123], s[34:35] op_sel_hi:[1,0,1]
    v_lshl_add_u32 v124, v125, 16, v124
    v_lshl_add_u32 v125, v127, 16, v126
    s_waitcnt lgkmcnt(2)
    v_bitop3_b32 v115, v115, v118, v119 bitop3:0xfe
    v_lshl_add_u64 v[124:125], v[124:125], 0, s[36:37]
    v_cmpx_le_u32 vcc, 0x1000000, v55
    ds_add_rtn_u64 v[118:119], v123, v[124:125] offset:54272
    s_mov_b64 exec, -1
    v_ashrrev_i32 v122, 5, v56
    v_lshlrev_b16 v123, 2, v56
    v_lshlrev_b32 v124, 16, v16
    v_bitop3_b32 v122, v122, v113, v113 bitop3:0x0c
    v_and_b32 v125, 0xffff0000, v16
    v_lshlrev_b32 v126, 16, v17
    v_mul_f32 v122, v114, v122
    v_and_b32 v127, 0xffff0000, v17
    v_add_u32 v123, v123, v123
    v_pk_fma_f32 v[124:125], v[124:125], v[122:123], s[34:35] op_sel_hi:[1,0,1]
    v_pk_fma_f32 v[126:127], v[126:127], v[122:123], s[34:35] op_sel_hi:[1,0,1]
    v_lshl_add_u32 v124, v125, 16, v124
    v_lshl_add_u32 v125, v127, 16, v126
    s_waitcnt lgkmcnt(2)
    v_bitop3_b32 v115, v115, v120, v121 bitop3:0xfe
    v_lshl_add_u64 v[124:125], v[124:125], 0, s[36:37]
    v_cmpx_le_u32 vcc, 0x1000000, v56
    ds_add_rtn_u64 v[120:121], v123, v[124:125] offset:54272
    s_mov_b64 exec, -1
    s_cmp_lt_u32 s15, 8
    s_cbranch_scc1 p2_nad0
    s_waitcnt lgkmcnt(15)
    v_ashrrev_i32 v122, 5, v57
    v_lshlrev_b16 v123, 2, v57
    v_lshlrev_b32 v124, 16, v18
    v_bitop3_b32 v122, v122, v113, v113 bitop3:0x0c
    v_and_b32 v125, 0xffff0000, v18
    v_lshlrev_b32 v126, 16, v19
    v_mul_f32 v122, v114, v122
    v_and_b32 v127, 0xffff0000, v19
    v_add_u32 v123, v123, v123
    v_pk_fma_f32 v[124:125], v[124:125], v[122:123], s[34:35] op_sel_hi:[1,0,1]
    v_pk_fma_f32 v[126:127], v[126:127], v[122:123], s[34:35] op_sel_hi:[1,0,1]
    v_lshl_add_u32 v124, v125, 16, v124
    v_lshl_add_u32 v125, v127, 16, v126
    s_waitcnt lgkmcnt(2)
    v_bitop3_b32 v115, v115, v116, v117 bitop3:0xfe
    v_lshl_add_u64 v[124:125], v[124:125], 0, s[36:37]
    v_cmpx_le_u32 vcc, 0x1000000, v57
    ds_add_rtn_u64 v[116:117], v123, v[124:125] offset:54272
    s_mov_b64 exec, -1
    v_ashrrev_i32 v122, 5, v58
    v_lshlrev_b16 v123, 2, v58
    v_lshlrev_b32 v124, 16, v20
    v_bitop3_b32 v122, v122, v113, v113 bitop3:0x0c
    v_and_b32 v125, 0xffff0000, v20
    v_lshlrev_b32 v126, 16, v21
    v_mul_f32 v122, v114, v122
    v_and_b32 v127, 0xffff0000, v21
    v_add_u32 v123, v123, v123
    v_pk_fma_f32 v[124:125], v[124:125], v[122:123], s[34:35] op_sel_hi:[1,0,1]
    v_pk_fma_f32 v[126:127], v[126:127], v[122:123], s[34:35] op_sel_hi:[1,0,1]
    v_lshl_add_u32 v124, v125, 16, v124
    v_lshl_add_u32 v125, v127, 16, v126
    s_waitcnt lgkmcnt(2)
    v_bitop3_b32 v115, v115, v118, v119 bitop3:0xfe
    v_lshl_add_u64 v[124:125], v[124:125], 0, s[36:37]
    v_cmpx_le_u32 vcc, 0x1000000, v58
    ds_add_rtn_u64 v[118:119], v123, v[124:125] offset:54272
    s_mov_b64 exec, -1
    v_ashrrev_i32 v122, 5, v59
    v_lshlrev_b16 v123, 2, v59
    v_lshlrev_b32 v124, 16, v22
    v_bitop3_b32 v122, v122, v113, v113 bitop3:0x0c
    v_and_b32 v125, 0xffff0000, v22
    v_lshlrev_b32 v126, 16, v23
    v_mul_f32 v122, v114, v122
    v_and_b32 v127, 0xffff0000, v23
    v_add_u32 v123, v123, v123
    v_pk_fma_f32 v[124:125], v[124:125], v[122:123], s[34:35] op_sel_hi:[1,0,1]
    v_pk_fma_f32 v[126:127], v[126:127], v[122:123], s[34:35] op_sel_hi:[1,0,1]
    v_lshl_add_u32 v124, v125, 16, v124
    v_lshl_add_u32 v125, v127, 16, v126
    s_waitcnt lgkmcnt(2)
    v_bitop3_b32 v115, v115, v120, v121 bitop3:0xfe
    v_lshl_add_u64 v[124:125], v[124:125], 0, s[36:37]
    v_cmpx_le_u32 vcc, 0x1000000, v59
    ds_add_rtn_u64 v[120:121], v123, v[124:125] offset:54272
    s_mov_b64 exec, -1
p2_nad0:
    s_waitcnt lgkmcnt(15)
    v_ashrrev_i32 v122, 5, v60
    v_lshlrev_b16 v123, 2, v60
    v_lshlrev_b32 v124, 16, v24
    v_bitop3_b32 v122, v122, v113, v113 bitop3:0x0c
    v_and_b32 v125, 0xffff0000, v24
    v_lshlrev_b32 v126, 16, v25
    v_mul_f32 v122, v114, v122
    v_and_b32 v127, 0xffff0000, v25
    v_add_u32 v123, v123, v123
    v_pk_fma_f32 v[124:125], v[124:125], v[122:123], s[34:35] op_sel_hi:[1,0,1]
    v_pk_fma_f32 v[126:127], v[126:127], v[122:123], s[34:35] op_sel_hi:[1,0,1]
    v_lshl_add_u32 v124, v125, 16, v124
    v_lshl_add_u32 v125, v127, 16, v126
    s_waitcnt lgkmcnt(2)
    v_bitop3_b32 v115, v115, v116, v117 bitop3:0xfe
    v_lshl_add_u64 v[124:125], v[124:125], 0, s[36:37]
    v_cmpx_le_u32 vcc, 0x1000000, v60
    ds_add_rtn_u64 v[116:117], v123, v[124:125] offset:54272
    s_mov_b64 exec, -1
    v_ashrrev_i32 v122, 5, v61
    v_lshlrev_b16 v123, 2, v61
    v_lshlrev_b32 v124, 16, v26
    v_bitop3_b32 v122, v122, v113, v113 bitop3:0x0c
    v_and_b32 v125, 0xffff0000, v26
    v_lshlrev_b32 v126, 16, v27
    v_mul_f32 v122, v114, v122
    v_and_b32 v127, 0xffff0000, v27
    v_add_u32 v123, v123, v123
    v_pk_fma_f32 v[124:125], v[124:125], v[122:123], s[34:35] op_sel_hi:[1,0,1]
    v_pk_fma_f32 v[126:127], v[126:127], v[122:123], s[34:35] op_sel_hi:[1,0,1]
    v_lshl_add_u32 v124, v125, 16, v124
    v_lshl_add_u32 v125, v127, 16, v126
    s_waitcnt lgkmcnt(2)
    v_bitop3_b32 v115, v115, v118, v119 bitop3:0xfe
    v_lshl_add_u64 v[124:125], v[124:125], 0, s[36:37]
    v_cmpx_le_u32 vcc, 0x1000000, v61
    ds_add_rtn_u64 v[118:119], v123, v[124:125] offset:54272
    s_mov_b64 exec, -1
    v_ashrrev_i32 v122, 5, v62
    v_lshlrev_b16 v123, 2, v62
    v_lshlrev_b32 v124, 16, v28
    v_bitop3_b32 v122, v122, v113, v113 bitop3:0x0c
    v_and_b32 v125, 0xffff0000, v28
    v_lshlrev_b32 v126, 16, v29
    v_mul_f32 v122, v114, v122
    v_and_b32 v127, 0xffff0000, v29
    v_add_u32 v123, v123, v123
    v_pk_fma_f32 v[124:125], v[124:125], v[122:123], s[34:35] op_sel_hi:[1,0,1]
    v_pk_fma_f32 v[126:127], v[126:127], v[122:123], s[34:35] op_sel_hi:[1,0,1]
    v_lshl_add_u32 v124, v125, 16, v124
    v_lshl_add_u32 v125, v127, 16, v126
    s_waitcnt lgkmcnt(2)
    v_bitop3_b32 v115, v115, v120, v121 bitop3:0xfe
    v_lshl_add_u64 v[124:125], v[124:125], 0, s[36:37]
    v_cmpx_le_u32 vcc, 0x1000000, v62
    ds_add_rtn_u64 v[120:121], v123, v[124:125] offset:54272
    s_mov_b64 exec, -1
    s_waitcnt lgkmcnt(15)
    v_ashrrev_i32 v122, 5, v63
    v_lshlrev_b16 v123, 2, v63
    v_lshlrev_b32 v124, 16, v30
    v_bitop3_b32 v122, v122, v113, v113 bitop3:0x0c
    v_and_b32 v125, 0xffff0000, v30
    v_lshlrev_b32 v126, 16, v31
    v_mul_f32 v122, v114, v122
    v_and_b32 v127, 0xffff0000, v31
    v_add_u32 v123, v123, v123
    v_pk_fma_f32 v[124:125], v[124:125], v[122:123], s[34:35] op_sel_hi:[1,0,1]
    v_pk_fma_f32 v[126:127], v[126:127], v[122:123], s[34:35] op_sel_hi:[1,0,1]
    v_lshl_add_u32 v124, v125, 16, v124
    v_lshl_add_u32 v125, v127, 16, v126
    s_waitcnt lgkmcnt(2)
    v_bitop3_b32 v115, v115, v116, v117 bitop3:0xfe
    v_lshl_add_u64 v[124:125], v[124:125], 0, s[36:37]
    v_cmpx_le_u32 vcc, 0x1000000, v63
    ds_add_rtn_u64 v[116:117], v123, v[124:125] offset:54272
    s_mov_b64 exec, -1
    v_ashrrev_i32 v122, 5, v64
    v_lshlrev_b16 v123, 2, v64
    v_lshlrev_b32 v124, 16, v32
    v_bitop3_b32 v122, v122, v113, v113 bitop3:0x0c
    v_and_b32 v125, 0xffff0000, v32
    v_lshlrev_b32 v126, 16, v33
    v_mul_f32 v122, v114, v122
    v_and_b32 v127, 0xffff0000, v33
    v_add_u32 v123, v123, v123
    v_pk_fma_f32 v[124:125], v[124:125], v[122:123], s[34:35] op_sel_hi:[1,0,1]
    v_pk_fma_f32 v[126:127], v[126:127], v[122:123], s[34:35] op_sel_hi:[1,0,1]
    v_lshl_add_u32 v124, v125, 16, v124
    v_lshl_add_u32 v125, v127, 16, v126
    s_waitcnt lgkmcnt(2)
    v_bitop3_b32 v115, v115, v118, v119 bitop3:0xfe
    v_lshl_add_u64 v[124:125], v[124:125], 0, s[36:37]
    v_cmpx_le_u32 vcc, 0x1000000, v64
    ds_add_rtn_u64 v[118:119], v123, v[124:125] offset:54272
    s_mov_b64 exec, -1
    v_ashrrev_i32 v122, 5, v65
    v_lshlrev_b16 v123, 2, v65
    v_lshlrev_b32 v124, 16, v34
    v_bitop3_b32 v122, v122, v113, v113 bitop3:0x0c
    v_and_b32 v125, 0xffff0000, v34
    v_lshlrev_b32 v126, 16, v35
    v_mul_f32 v122, v114, v122
    v_and_b32 v127, 0xffff0000, v35
    v_add_u32 v123, v123, v123
    v_pk_fma_f32 v[124:125], v[124:125], v[122:123], s[34:35] op_sel_hi:[1,0,1]
    v_pk_fma_f32 v[126:127], v[126:127], v[122:123], s[34:35] op_sel_hi:[1,0,1]
    v_lshl_add_u32 v124, v125, 16, v124
    v_lshl_add_u32 v125, v127, 16, v126
    s_waitcnt lgkmcnt(2)
    v_bitop3_b32 v115, v115, v120, v121 bitop3:0xfe
    v_lshl_add_u64 v[124:125], v[124:125], 0, s[36:37]
    v_cmpx_le_u32 vcc, 0x1000000, v65
    ds_add_rtn_u64 v[120:121], v123, v[124:125] offset:54272
    s_mov_b64 exec, -1
    s_waitcnt lgkmcnt(15)
    v_ashrrev_i32 v122, 5, v66
    v_lshlrev_b16 v123, 2, v66
    v_lshlrev_b32 v124, 16, v36
    v_bitop3_b32 v122, v122, v113, v113 bitop3:0x0c
    v_and_b32 v125, 0xffff0000, v36
    v_lshlrev_b32 v126, 16, v37
    v_mul_f32 v122, v114, v122
    v_and_b32 v127, 0xffff0000, v37
    v_add_u32 v123, v123, v123
    v_pk_fma_f32 v[124:125], v[124:125], v[122:123], s[34:35] op_sel_hi:[1,0,1]
    v_pk_fma_f32 v[126:127], v[126:127], v[122:123], s[34:35] op_sel_hi:[1,0,1]
    v_lshl_add_u32 v124, v125, 16, v124
    v_lshl_add_u32 v125, v127, 16, v126
    s_waitcnt lgkmcnt(2)
    v_bitop3_b32 v115, v115, v116, v117 bitop3:0xfe
    v_lshl_add_u64 v[124:125], v[124:125], 0, s[36:37]
    v_cmpx_le_u32 vcc, 0x1000000, v66
    ds_add_rtn_u64 v[116:117], v123, v[124:125] offset:54272
    s_mov_b64 exec, -1
    v_ashrrev_i32 v122, 5, v67
    v_lshlrev_b16 v123, 2, v67
    v_lshlrev_b32 v124, 16, v38
    v_bitop3_b32 v122, v122, v113, v113 bitop3:0x0c
    v_and_b32 v125, 0xffff0000, v38
    v_lshlrev_b32 v126, 16, v39
    v_mul_f32 v122, v114, v122
    v_and_b32 v127, 0xffff0000, v39
    v_add_u32 v123, v123, v123
    v_pk_fma_f32 v[124:125], v[124:125], v[122:123], s[34:35] op_sel_hi:[1,0,1]
    v_pk_fma_f32 v[126:127], v[126:127], v[122:123], s[34:35] op_sel_hi:[1,0,1]
    v_lshl_add_u32 v124, v125, 16, v124
    v_lshl_add_u32 v125, v127, 16, v126
    s_waitcnt lgkmcnt(2)
    v_bitop3_b32 v115, v115, v118, v119 bitop3:0xfe
    v_lshl_add_u64 v[124:125], v[124:125], 0, s[36:37]
    v_cmpx_le_u32 vcc, 0x1000000, v67
    ds_add_rtn_u64 v[118:119], v123, v[124:125] offset:54272
    s_mov_b64 exec, -1
    v_ashrrev_i32 v122, 5, v68
    v_lshlrev_b16 v123, 2, v68
    v_lshlrev_b32 v124, 16, v40
    v_bitop3_b32 v122, v122, v113, v113 bitop3:0x0c
    v_and_b32 v125, 0xffff0000, v40
    v_lshlrev_b32 v126, 16, v41
    v_mul_f32 v122, v114, v122
    v_and_b32 v127, 0xffff0000, v41
    v_add_u32 v123, v123, v123
    v_pk_fma_f32 v[124:125], v[124:125], v[122:123], s[34:35] op_sel_hi:[1,0,1]
    v_pk_fma_f32 v[126:127], v[126:127], v[122:123], s[34:35] op_sel_hi:[1,0,1]
    v_lshl_add_u32 v124, v125, 16, v124
    v_lshl_add_u32 v125, v127, 16, v126
    s_waitcnt lgkmcnt(2)
    v_bitop3_b32 v115, v115, v120, v121 bitop3:0xfe
    v_lshl_add_u64 v[124:125], v[124:125], 0, s[36:37]
    v_cmpx_le_u32 vcc, 0x1000000, v68
    ds_add_rtn_u64 v[120:121], v123, v[124:125] offset:54272
    s_mov_b64 exec, -1
    s_waitcnt lgkmcnt(15)
    v_ashrrev_i32 v122, 5, v69
    v_lshlrev_b16 v123, 2, v69
    v_lshlrev_b32 v124, 16, v42
    v_bitop3_b32 v122, v122, v113, v113 bitop3:0x0c
    v_and_b32 v125, 0xffff0000, v42
    v_lshlrev_b32 v126, 16, v43
    v_mul_f32 v122, v114, v122
    v_and_b32 v127, 0xffff0000, v43
    v_add_u32 v123, v123, v123
    v_pk_fma_f32 v[124:125], v[124:125], v[122:123], s[34:35] op_sel_hi:[1,0,1]
    v_pk_fma_f32 v[126:127], v[126:127], v[122:123], s[34:35] op_sel_hi:[1,0,1]
    v_lshl_add_u32 v124, v125, 16, v124
    v_lshl_add_u32 v125, v127, 16, v126
    s_waitcnt lgkmcnt(2)
    v_bitop3_b32 v115, v115, v116, v117 bitop3:0xfe
    v_lshl_add_u64 v[124:125], v[124:125], 0, s[36:37]
    v_cmpx_le_u32 vcc, 0x1000000, v69
    ds_add_rtn_u64 v[116:117], v123, v[124:125] offset:54272
    s_mov_b64 exec, -1
    v_ashrrev_i32 v122, 5, v70
    v_lshlrev_b16 v123, 2, v70
    v_lshlrev_b32 v124, 16, v44
    v_bitop3_b32 v122, v122, v113, v113 bitop3:0x0c
    v_and_b32 v125, 0xffff0000, v44
    v_lshlrev_b32 v126, 16, v45
    v_mul_f32 v122, v114, v122
    v_and_b32 v127, 0xffff0000, v45
    v_add_u32 v123, v123, v123
    v_pk_fma_f32 v[124:125], v[124:125], v[122:123], s[34:35] op_sel_hi:[1,0,1]
    v_pk_fma_f32 v[126:127], v[126:127], v[122:123], s[34:35] op_sel_hi:[1,0,1]
    v_lshl_add_u32 v124, v125, 16, v124
    v_lshl_add_u32 v125, v127, 16, v126
    s_waitcnt lgkmcnt(2)
    v_bitop3_b32 v115, v115, v118, v119 bitop3:0xfe
    v_lshl_add_u64 v[124:125], v[124:125], 0, s[36:37]
    v_cmpx_le_u32 vcc, 0x1000000, v70
    ds_add_rtn_u64 v[118:119], v123, v[124:125] offset:54272
    s_mov_b64 exec, -1
    v_ashrrev_i32 v122, 5, v71
    v_lshlrev_b16 v123, 2, v71
    v_lshlrev_b32 v124, 16, v46
    v_bitop3_b32 v122, v122, v113, v113 bitop3:0x0c
    v_and_b32 v125, 0xffff0000, v46
    v_lshlrev_b32 v126, 16, v47
    v_mul_f32 v122, v114, v122
    v_and_b32 v127, 0xffff0000, v47
    v_add_u32 v123, v123, v123
    v_pk_fma_f32 v[124:125], v[124:125], v[122:123], s[34:35] op_sel_hi:[1,0,1]
    v_pk_fma_f32 v[126:127], v[126:127], v[122:123], s[34:35] op_sel_hi:[1,0,1]
    v_lshl_add_u32 v124, v125, 16, v124
    v_lshl_add_u32 v125, v127, 16, v126
    s_waitcnt lgkmcnt(2)
    v_bitop3_b32 v115, v115, v120, v121 bitop3:0xfe
    v_lshl_add_u64 v[124:125], v[124:125], 0, s[36:37]
    v_cmpx_le_u32 vcc, 0x1000000, v71
    ds_add_rtn_u64 v[120:121], v123, v[124:125] offset:54272
    s_mov_b64 exec, -1
    s_branch p2_fin
p2_topf:
    s_cmp_eq_u32 s60, 10
    s_cbranch_scc1 p2_drain1
    s_setprio 3
    v_cmpx_gt_i16 vcc, 0, v48
    ds_read_b64 v[0:1], v0
    s_mov_b64 exec, -1
    v_cmpx_gt_i16 vcc, 0, v49
    ds_read_b64 v[2:3], v2
    s_mov_b64 exec, -1
    v_cmpx_gt_i16 vcc, 0, v50
    ds_read_b64 v[4:5], v4
    s_mov_b64 exec, -1
    v_cmpx_gt_i16 vcc, 0, v51
    ds_read_b64 v[6:7], v6
    s_mov_b64 exec, -1
    v_cmpx_gt_i16 vcc, 0, v52
    ds_read_b64 v[8:9], v8
    s_mov_b64 exec, -1
    v_cmpx_gt_i16 vcc, 0, v53
    ds_read_b64 v[10:11], v10
    s_mov_b64 exec, -1
    v_cmpx_gt_i16 vcc, 0, v54
    ds_read_b64 v[12:13], v12
    s_mov_b64 exec, -1
    v_cmpx_gt_i16 vcc, 0, v55
    ds_read_b64 v[14:15], v14
    s_mov_b64 exec, -1
    v_cmpx_gt_i16 vcc, 0, v56
    ds_read_b64 v[16:17], v16
    s_mov_b64 exec, -1
    s_cmp_lt_u32 s15, 8
    s_cbranch_scc1 p2_g1r23
    v_cmpx_gt_i16 vcc, 0, v57
    ds_read_b64 v[18:19], v18
    s_mov_b64 exec, -1
    v_cmpx_gt_i16 vcc, 0, v58
    ds_read_b64 v[20:21], v20
    s_mov_b64 exec, -1
    v_cmpx_gt_i16 vcc, 0, v59
    ds_read_b64 v[22:23], v22
    s_mov_b64 exec, -1
p2_g1r23:
    s_cmp_ge_u32 s10, 9
    s_cbranch_scc1 p2_nm1m0a
    v_lshrrev_b32 v84, 1, v112
    s_add_u32 s44, s20, s42
    buffer_load_dwordx2 v[84:85], v84, s[4:7], s44 offen
p2_nm1m0a:
    buffer_load_dwordx4 v[72:75], v112, s[4:7], s20 offen offset:0
    buffer_load_dwordx4 v[76:79], v112, s[4:7], s20 offen offset:1024
    buffer_load_dwordx4 v[80:83], v112, s[4:7], s20 offen offset:2048
    v_cmpx_gt_i16 vcc, 0, v60
    ds_read_b64 v[24:25], v24
    s_mov_b64 exec, -1
    v_cmpx_gt_i16 vcc, 0, v61
    ds_read_b64 v[26:27], v26
    s_mov_b64 exec, -1
    v_cmpx_gt_i16 vcc, 0, v62
    ds_read_b64 v[28:29], v28
    s_mov_b64 exec, -1
    v_cmpx_gt_i16 vcc, 0, v63
    ds_read_b64 v[30:31], v30
    s_mov_b64 exec, -1
    v_cmpx_gt_i16 vcc, 0, v64
    ds_read_b64 v[32:33], v32
    s_mov_b64 exec, -1
    v_cmpx_gt_i16 vcc, 0, v65
    ds_read_b64 v[34:35], v34
    s_mov_b64 exec, -1
    v_cmpx_gt_i16 vcc, 0, v66
    ds_read_b64 v[36:37], v36
    s_mov_b64 exec, -1
    v_cmpx_gt_i16 vcc, 0, v67
    ds_read_b64 v[38:39], v38
    s_mov_b64 exec, -1
    v_cmpx_gt_i16 vcc, 0, v68
    ds_read_b64 v[40:41], v40
    s_mov_b64 exec, -1
    v_cmpx_gt_i16 vcc, 0, v69
    ds_read_b64 v[42:43], v42
    s_mov_b64 exec, -1
    v_cmpx_gt_i16 vcc, 0, v70
    ds_read_b64 v[44:45], v44
    s_mov_b64 exec, -1
    v_cmpx_gt_i16 vcc, 0, v71
    ds_read_b64 v[46:47], v46
    s_mov_b64 exec, -1
    s_setprio 2
    s_waitcnt lgkmcnt(15)
    v_ashrrev_i32 v122, 5, v48
    v_lshlrev_b16 v123, 2, v48
    v_cndmask_b32 v126, v0, v1, s[66:67]
    v_bitop3_b32 v122, v122, v113, v113 bitop3:0x0c
    v_lshlrev_b32 v124, 16, v126
    v_mul_f32 v122, v114, v122
    v_and_b32 v125, 0xffff0000, v126
    v_add_u32 v123, v123, v123
    v_mul_f32 v124, v122, v124
    v_mul_f32 v125, v122, v125
    v_cmpx_le_u32 vcc, 0x1000000, v48
    ds_add_f32 v123, v124 offset:54272
    ds_add_f32 v123, v125 offset:54276
    s_mov_b64 exec, -1
    v_ashrrev_i32 v122, 5, v49
    v_lshlrev_b16 v123, 2, v49
    v_cndmask_b32 v126, v2, v3, s[66:67]
    v_bitop3_b32 v122, v122, v113, v113 bitop3:0x0c
    v_lshlrev_b32 v124, 16, v126
    v_mul_f32 v122, v114, v122
    v_and_b32 v125, 0xffff0000, v126
    v_add_u32 v123, v123, v123
    v_mul_f32 v124, v122, v124
    v_mul_f32 v125, v122, v125
    v_cmpx_le_u32 vcc, 0x1000000, v49
    ds_add_f32 v123, v124 offset:54272
    ds_add_f32 v123, v125 offset:54276
    s_mov_b64 exec, -1
    v_ashrrev_i32 v122, 5, v50
    v_lshlrev_b16 v123, 2, v50
    v_cndmask_b32 v126, v4, v5, s[66:67]
    v_bitop3_b32 v122, v122, v113, v113 bitop3:0x0c
    v_lshlrev_b32 v124, 16, v126
    v_mul_f32 v122, v114, v122
    v_and_b32 v125, 0xffff0000, v126
    v_add_u32 v123, v123, v123
    v_mul_f32 v124, v122, v124
    v_mul_f32 v125, v122, v125
    v_cmpx_le_u32 vcc, 0x1000000, v50
    ds_add_f32 v123, v124 offset:54272
    ds_add_f32 v123, v125 offset:54276
    s_mov_b64 exec, -1
    v_bfe_u32 v0, v102, 14, 4
    v_lshrrev_b32 v1, 18, v102
    v_and_b32 v102, 0x3fff, v102
    v_mad_u32_u24 v0, v0, s63, v1
    v_mad_u32_u24 v102, v0, s65, v102
    buffer_load_dwordx4 v[0:3], v102, s[68:71], 0 offen
    s_setprio 1
    s_waitcnt lgkmcnt(15)
    v_ashrrev_i32 v122, 5, v51
    v_lshlrev_b16 v123, 2, v51
    v_cndmask_b32 v126, v6, v7, s[66:67]
    v_bitop3_b32 v122, v122, v113, v113 bitop3:0x0c
    v_lshlrev_b32 v124, 16, v126
    v_mul_f32 v122, v114, v122
    v_and_b32 v125, 0xffff0000, v126
    v_add_u32 v123, v123, v123
    v_mul_f32 v124, v122, v124
    v_mul_f32 v125, v122, v125
    v_cmpx_le_u32 vcc, 0x1000000, v51
    ds_add_f32 v123, v124 offset:54272
    ds_add_f32 v123, v125 offset:54276
    s_mov_b64 exec, -1
    v_ashrrev_i32 v122, 5, v52
    v_lshlrev_b16 v123, 2, v52
    v_cndmask_b32 v126, v8, v9, s[66:67]
    v_bitop3_b32 v122, v122, v113, v113 bitop3:0x0c
    v_lshlrev_b32 v124, 16, v126
    v_mul_f32 v122, v114, v122
    v_and_b32 v125, 0xffff0000, v126
    v_add_u32 v123, v123, v123
    v_mul_f32 v124, v122, v124
    v_mul_f32 v125, v122, v125
    v_cmpx_le_u32 vcc, 0x1000000, v52
    ds_add_f32 v123, v124 offset:54272
    ds_add_f32 v123, v125 offset:54276
    s_mov_b64 exec, -1
    v_ashrrev_i32 v122, 5, v53
    v_lshlrev_b16 v123, 2, v53
    v_cndmask_b32 v126, v10, v11, s[66:67]
    v_bitop3_b32 v122, v122, v113, v113 bitop3:0x0c
    v_lshlrev_b32 v124, 16, v126
    v_mul_f32 v122, v114, v122
    v_and_b32 v125, 0xffff0000, v126
    v_add_u32 v123, v123, v123
    v_mul_f32 v124, v122, v124
    v_mul_f32 v125, v122, v125
    v_cmpx_le_u32 vcc, 0x1000000, v53
    ds_add_f32 v123, v124 offset:54272
    ds_add_f32 v123, v125 offset:54276
    s_mov_b64 exec, -1
    v_bfe_u32 v6, v103, 14, 4
    v_lshrrev_b32 v7, 18, v103
    v_and_b32 v103, 0x3fff, v103
    v_mad_u32_u24 v6, v6, s63, v7
    v_mad_u32_u24 v103, v6, s65, v103
    buffer_load_dwordx4 v[6:9], v103, s[68:71], 0 offen
    s_waitcnt lgkmcnt(12)
    s_barrier
    s_setprio 3
    s_waitcnt vmcnt(5)
    s_mov_b32 m0, s23
    v_mov_b32 v53, 0
    s_movk_i32 s44, 512
    v_sub_u32_sdwa v4, v111, v110 dst_sel:DWORD dst_unused:UNUSED_PAD src0_sel:WORD_0 src1_sel:WORD_0
    v_sub_u32_sdwa v5, v111, v110 dst_sel:DWORD dst_unused:UNUSED_PAD src0_sel:WORD_1 src1_sel:WORD_1
    v_med3_i32 v4, v4, 0, s44
    v_med3_i32 v5, v5, 0, s44
    v_add_u32 v48, v4, v5
    ds_write_addtid_b32 v53 offset:0
    ds_write_addtid_b32 v53 offset:256
    ds_write_addtid_b32 v53 offset:512
    ds_write_addtid_b32 v53 offset:768
    ds_write_addtid_b32 v53 offset:1024
    ds_write_addtid_b32 v53 offset:1280
    ds_write_addtid_b32 v53 offset:1536
    ds_write_addtid_b32 v53 offset:1792
    v_bfe_i32 v53, v112, 6, 1
    v_lshrrev_b32 v49, 6, v112
    v_bitop3_b32 v53, v53, 15, s10 bitop3:0x6a
    v_lshl_or_b32 v49, v49, 4, v53
    v_and_b32 v53, 0x30, v112
    v_lshl_or_b32 v53, v49, 6, v53
    v_lshlrev_b32 v53, 15, v53
    s_nop 1
    v_add_u32_dpp v48, v48, v48 row_shr:1 row_mask:0xf bank_mask:0xf bound_ctrl:0
    s_nop 1
    v_add_u32_dpp v48, v48, v48 row_shr:2 row_mask:0xf bank_mask:0xf bound_ctrl:0
    s_nop 1
    v_add_u32_dpp v48, v48, v48 row_shr:4 row_mask:0xf bank_mask:0xf bound_ctrl:0
    s_nop 1
    v_add_u32_dpp v48, v48, v48 row_shr:8 row_mask:0xf bank_mask:0xf bound_ctrl:0
    s_nop 1
    v_add_u32_dpp v48, v48, v48 row_bcast:15 row_mask:0xa bank_mask:0xf
    s_nop 1
    v_add_u32_dpp v48, v48, v48 row_bcast:31 row_mask:0xc bank_mask:0xf
    s_nop 1
    s_nop 0
    v_readlane_b32 s38, v48, 63
    v_sub_u32 v50, v48, v5
    v_sub_u32 v49, v50, v4
    v_writelane_b32 v5, 1, 63
    v_sub_u32 v10, 512, v49
    v_mad_u32_u16 v51, v110, 16, v53
    v_lshl_add_u32 v51, v10, 4, v51
    v_med3_i32 v10, v10, 0, v4
    v_lshl_add_u32 v49, v49, 2, s23
    v_sub_u32 v11, 512, v50
    v_mad_u32_u16 v52, v110, 16, v53 op_sel:[1,0,0,0]
    v_add_u32 v52, 262144, v52
    s_mov_b32 s44, 0x1fffc000
    v_writelane_b32 v52, s44, 63
    v_lshl_add_u32 v52, v11, 4, v52
    v_med3_i32 v11, v11, 0, v5
    v_lshl_add_u32 v50, v50, 2, s23
    v_lshl_add_u32 v48, v11, 16, v10
    v_add_u32 v110, v110, v48
    s_min_u32 s17, s38, 512
    s_add_u32 s17, s17, 63
    s_lshr_b32 s17, s17, 6
    v_cmpx_lt_i32 vcc, 0, v10
    ds_write_b32 v49, v51
    s_mov_b64 exec, -1
    v_cmpx_lt_i32 vcc, 0, v11
    ds_write_b32 v50, v52
    s_mov_b64 exec, -1
    s_cmp_lt_u32 s38, 512
    s_cbranch_scc1 p2_nomore1x
    v_cmp_lt_u32_sdwa s[44:45], v110, v111 src0_sel:WORD_0 src1_sel:WORD_0
    v_cmp_lt_u32_sdwa s[46:47], v110, v111 src0_sel:WORD_1 src1_sel:WORD_1
    s_nop 0
    s_or_b64 s[44:45], s[44:45], s[46:47]
    s_cbranch_scc0 p2_nomore1x
    v_mov_b32 v49, s19
    v_mov_b32 v50, 1
    ds_write_b32 v49, v50 offset:53760
p2_nomore1x:
    s_setprio 2
    s_waitcnt lgkmcnt(15)
    v_ashrrev_i32 v122, 5, v54
    v_lshlrev_b16 v123, 2, v54
    v_cndmask_b32 v126, v12, v13, s[66:67]
    v_bitop3_b32 v122, v122, v113, v113 bitop3:0x0c
    v_lshlrev_b32 v124, 16, v126
    v_mul_f32 v122, v114, v122
    v_and_b32 v125, 0xffff0000, v126
    v_add_u32 v123, v123, v123
    v_mul_f32 v124, v122, v124
    v_mul_f32 v125, v122, v125
    v_cmpx_le_u32 vcc, 0x1000000, v54
    ds_add_f32 v123, v124 offset:54272
    ds_add_f32 v123, v125 offset:54276
    s_mov_b64 exec, -1
    v_ashrrev_i32 v122, 5, v55
    v_lshlrev_b16 v123, 2, v55
    v_cndmask_b32 v126, v14, v15, s[66:67]
    v_bitop3_b32 v122, v122, v113, v113 bitop3:0x0c
    v_lshlrev_b32 v124, 16, v126
    v_mul_f32 v122, v114, v122
    v_and_b32 v125, 0xffff0000, v126
    v_add_u32 v123, v123, v123
    v_mul_f32 v124, v122, v124
    v_mul_f32 v125, v122, v125
    v_cmpx_le_u32 vcc, 0x1000000, v55
    ds_add_f32 v123, v124 offset:54272
    ds_add_f32 v123, v125 offset:54276
    s_mov_b64 exec, -1
    v_ashrrev_i32 v122, 5, v56
    v_lshlrev_b16 v123, 2, v56
    v_cndmask_b32 v126, v16, v17, s[66:67]
    v_bitop3_b32 v122, v122, v113, v113 bitop3:0x0c
    v_lshlrev_b32 v124, 16, v126
    v_mul_f32 v122, v114, v122
    v_and_b32 v125, 0xffff0000, v126
    v_add_u32 v123, v123, v123
    v_mul_f32 v124, v122, v124
    v_mul_f32 v125, v122, v125
    v_cmpx_le_u32 vcc, 0x1000000, v56
    ds_add_f32 v123, v124 offset:54272
    ds_add_f32 v123, v125 offset:54276
    s_mov_b64 exec, -1
    v_bfe_u32 v12, v104, 14, 4
    v_lshrrev_b32 v13, 18, v104
    v_and_b32 v104, 0x3fff, v104
    v_mad_u32_u24 v12, v12, s63, v13
    v_mad_u32_u24 v104, v12, s65, v104
    buffer_load_dwordx4 v[12:15], v104, s[68:71], 0 offen
    s_cmp_lt_u32 s15, 8
    s_cbranch_scc1 p2_na1a3
    s_waitcnt lgkmcnt(15)
    v_ashrrev_i32 v122, 5, v57
    v_lshlrev_b16 v123, 2, v57
    v_cndmask_b32 v126, v18, v19, s[66:67]
    v_bitop3_b32 v122, v122, v113, v113 bitop3:0x0c
    v_lshlrev_b32 v124, 16, v126
    v_mul_f32 v122, v114, v122
    v_and_b32 v125, 0xffff0000, v126
    v_add_u32 v123, v123, v123
    v_mul_f32 v124, v122, v124
    v_mul_f32 v125, v122, v125
    v_cmpx_le_u32 vcc, 0x1000000, v57
    ds_add_f32 v123, v124 offset:54272
    ds_add_f32 v123, v125 offset:54276
    s_mov_b64 exec, -1
    v_ashrrev_i32 v122, 5, v58
    v_lshlrev_b16 v123, 2, v58
    v_cndmask_b32 v126, v20, v21, s[66:67]
    v_bitop3_b32 v122, v122, v113, v113 bitop3:0x0c
    v_lshlrev_b32 v124, 16, v126
    v_mul_f32 v122, v114, v122
    v_and_b32 v125, 0xffff0000, v126
    v_add_u32 v123, v123, v123
    v_mul_f32 v124, v122, v124
    v_mul_f32 v125, v122, v125
    v_cmpx_le_u32 vcc, 0x1000000, v58
    ds_add_f32 v123, v124 offset:54272
    ds_add_f32 v123, v125 offset:54276
    s_mov_b64 exec, -1
    v_ashrrev_i32 v122, 5, v59
    v_lshlrev_b16 v123, 2, v59
    v_cndmask_b32 v126, v22, v23, s[66:67]
    v_bitop3_b32 v122, v122, v113, v113 bitop3:0x0c
    v_lshlrev_b32 v124, 16, v126
    v_mul_f32 v122, v114, v122
    v_and_b32 v125, 0xffff0000, v126
    v_add_u32 v123, v123, v123
    v_mul_f32 v124, v122, v124
    v_mul_f32 v125, v122, v125
    v_cmpx_le_u32 vcc, 0x1000000, v59
    ds_add_f32 v123, v124 offset:54272
    ds_add_f32 v123, v125 offset:54276
    s_mov_b64 exec, -1
p2_na1a3:
    v_bfe_u32 v18, v105, 14, 4
    v_lshrrev_b32 v19, 18, v105
    v_and_b32 v105, 0x3fff, v105
    v_mad_u32_u24 v18, v18, s63, v19
    v_mad_u32_u24 v105, v18, s65, v105
    buffer_load_dwordx4 v[18:21], v105, s[68:71], 0 offen
    s_mov_b32 m0, s23
    s_nop 0
    ds_read_addtid_b32 v102 offset:1024
    ds_read_addtid_b32 v103 offset:1280
    ds_read_addtid_b32 v104 offset:1536
    ds_read_addtid_b32 v105 offset:1792
    ds_read_addtid_b32 v106 offset:0
    ds_read_addtid_b32 v107 offset:256
    ds_read_addtid_b32 v108 offset:512
    ds_read_addtid_b32 v109 offset:768
    s_waitcnt vmcnt(4)
    s_mov_b32 m0, s24
    s_cmp_ge_u32 s10, 9
    s_cbranch_scc1 p2_st1s0
    ds_write_addtid_b32 v84 offset:49152
    ds_write_addtid_b32 v85 offset:49408
p2_st1s0:
    s_mov_b32 m0, s23
    s_add_u32 s20, s20, 53760
    ds_write_addtid_b32 v72 offset:0
    ds_write_addtid_b32 v73 offset:256
    ds_write_addtid_b32 v74 offset:512
    ds_write_addtid_b32 v75 offset:768
    ds_write_addtid_b32 v76 offset:1024
    ds_write_addtid_b32 v77 offset:1280
    ds_write_addtid_b32 v78 offset:1536
    ds_write_addtid_b32 v79 offset:1792
    ds_write_addtid_b32 v80 offset:2048
    ds_write_addtid_b32 v81 offset:2304
    ds_write_addtid_b32 v82 offset:2560
    ds_write_addtid_b32 v83 offset:2816
    s_setprio 1
    s_waitcnt lgkmcnt(15)
    v_ashrrev_i32 v122, 5, v60
    v_lshlrev_b16 v123, 2, v60
    v_cndmask_b32 v126, v24, v25, s[66:67]
    v_bitop3_b32 v122, v122, v113, v113 bitop3:0x0c
    v_lshlrev_b32 v124, 16, v126
    v_mul_f32 v122, v114, v122
    v_and_b32 v125, 0xffff0000, v126
    v_add_u32 v123, v123, v123
    v_mul_f32 v124, v122, v124
    v_mul_f32 v125, v122, v125
    v_cmpx_le_u32 vcc, 0x1000000, v60
    ds_add_f32 v123, v124 offset:54272
    ds_add_f32 v123, v125 offset:54276
    s_mov_b64 exec, -1
    v_ashrrev_i32 v122, 5, v61
    v_lshlrev_b16 v123, 2, v61
    v_cndmask_b32 v126, v26, v27, s[66:67]
    v_bitop3_b32 v122, v122, v113, v113 bitop3:0x0c
    v_lshlrev_b32 v124, 16, v126
    v_mul_f32 v122, v114, v122
    v_and_b32 v125, 0xffff0000, v126
    v_add_u32 v123, v123, v123
    v_mul_f32 v124, v122, v124
    v_mul_f32 v125, v122, v125
    v_cmpx_le_u32 vcc, 0x1000000, v61
    ds_add_f32 v123, v124 offset:54272
    ds_add_f32 v123, v125 offset:54276
    s_mov_b64 exec, -1
    v_ashrrev_i32 v122, 5, v62
    v_lshlrev_b16 v123, 2, v62
    v_cndmask_b32 v126, v28, v29, s[66:67]
    v_bitop3_b32 v122, v122, v113, v113 bitop3:0x0c
    v_lshlrev_b32 v124, 16, v126
    v_mul_f32 v122, v114, v122
    v_and_b32 v125, 0xffff0000, v126
    v_add_u32 v123, v123, v123
    v_mul_f32 v124, v122, v124
    v_mul_f32 v125, v122, v125
    v_cmpx_le_u32 vcc, 0x1000000, v62
    ds_add_f32 v123, v124 offset:54272
    ds_add_f32 v123, v125 offset:54276
    s_mov_b64 exec, -1
    s_waitcnt vmcnt(16)
    v_perm_b32 v60, v89, v86, s31
    v_perm_b32 v61, v89, v87, s32
    v_perm_b32 v62, v89, v88, s33
    v_lshlrev_b16 v28, 3, v88
    v_lshlrev_b16 v26, 3, v87
    v_lshlrev_b16 v24, 3, v86
    s_waitcnt lgkmcnt(15)
    s_nop 2
    s_nop 1
    v_max_u32_dpp v106, v106, v106 row_shr:1 row_mask:0xf bank_mask:0xf bound_ctrl:0
    v_max_u32_dpp v107, v107, v107 row_shr:1 row_mask:0xf bank_mask:0xf bound_ctrl:0
    s_nop 0
    v_max_u32_dpp v106, v106, v106 row_shr:2 row_mask:0xf bank_mask:0xf bound_ctrl:0
    v_max_u32_dpp v107, v107, v107 row_shr:2 row_mask:0xf bank_mask:0xf bound_ctrl:0
    s_nop 0
    v_max_u32_dpp v106, v106, v106 row_shr:4 row_mask:0xf bank_mask:0xf bound_ctrl:0
    v_max_u32_dpp v107, v107, v107 row_shr:4 row_mask:0xf bank_mask:0xf bound_ctrl:0
    s_nop 0
    v_max_u32_dpp v106, v106, v106 row_shr:8 row_mask:0xf bank_mask:0xf bound_ctrl:0
    v_max_u32_dpp v107, v107, v107 row_shr:8 row_mask:0xf bank_mask:0xf bound_ctrl:0
    s_nop 0
    v_max_u32_dpp v106, v106, v106 row_bcast:15 row_mask:0xa bank_mask:0xf
    v_max_u32_dpp v107, v107, v107 row_bcast:15 row_mask:0xa bank_mask:0xf
    s_nop 0
    v_max_u32_dpp v106, v106, v106 row_bcast:31 row_mask:0xc bank_mask:0xf
    v_max_u32_dpp v107, v107, v107 row_bcast:31 row_mask:0xc bank_mask:0xf
    s_nop 0
    s_nop 0
    v_readlane_b32 s41, v106, 63
    v_add_u32 v106, v106, v112
    v_add_u32 v106, 4294959104, v106
    v_max_u32 v107, s41, v107
    s_nop 0
    v_readlane_b32 s41, v107, 63
    v_add_u32 v107, v107, v112
    v_add_u32 v107, 4294960128, v107
    v_bfe_u32 v86, v106, 14, 4
    v_lshrrev_b32 v87, 18, v106
    v_and_b32 v106, 0x3fff, v106
    v_mad_u32_u24 v86, v86, s63, v87
    v_mad_u32_u24 v106, v86, s65, v106
    buffer_load_dwordx4 v[86:89], v106, s[68:71], 0 offen
    s_setprio 0
    s_waitcnt lgkmcnt(15)
    v_ashrrev_i32 v122, 5, v63
    v_lshlrev_b16 v123, 2, v63
    v_cndmask_b32 v126, v30, v31, s[66:67]
    v_bitop3_b32 v122, v122, v113, v113 bitop3:0x0c
    v_lshlrev_b32 v124, 16, v126
    v_mul_f32 v122, v114, v122
    v_and_b32 v125, 0xffff0000, v126
    v_add_u32 v123, v123, v123
    v_mul_f32 v124, v122, v124
    v_mul_f32 v125, v122, v125
    v_cmpx_le_u32 vcc, 0x1000000, v63
    ds_add_f32 v123, v124 offset:54272
    ds_add_f32 v123, v125 offset:54276
    s_mov_b64 exec, -1
    v_ashrrev_i32 v122, 5, v64
    v_lshlrev_b16 v123, 2, v64
    v_cndmask_b32 v126, v32, v33, s[66:67]
    v_bitop3_b32 v122, v122, v113, v113 bitop3:0x0c
    v_lshlrev_b32 v124, 16, v126
    v_mul_f32 v122, v114, v122
    v_and_b32 v125, 0xffff0000, v126
    v_add_u32 v123, v123, v123
    v_mul_f32 v124, v122, v124
    v_mul_f32 v125, v122, v125
    v_cmpx_le_u32 vcc, 0x1000000, v64
    ds_add_f32 v123, v124 offset:54272
    ds_add_f32 v123, v125 offset:54276
    s_mov_b64 exec, -1
    v_ashrrev_i32 v122, 5, v65
    v_lshlrev_b16 v123, 2, v65
    v_cndmask_b32 v126, v34, v35, s[66:67]
    v_bitop3_b32 v122, v122, v113, v113 bitop3:0x0c
    v_lshlrev_b32 v124, 16, v126
    v_mul_f32 v122, v114, v122
    v_and_b32 v125, 0xffff0000, v126
    v_add_u32 v123, v123, v123
    v_mul_f32 v124, v122, v124
    v_mul_f32 v125, v122, v125
    v_cmpx_le_u32 vcc, 0x1000000, v65
    ds_add_f32 v123, v124 offset:54272
    ds_add_f32 v123, v125 offset:54276
    s_mov_b64 exec, -1
    s_waitcnt vmcnt(13)
    v_perm_b32 v63, v93, v90, s31
    v_perm_b32 v64, v93, v91, s32
    v_perm_b32 v65, v93, v92, s33
    v_lshlrev_b16 v34, 3, v92
    v_lshlrev_b16 v32, 3, v91
    v_lshlrev_b16 v30, 3, v90
    s_waitcnt lgkmcnt(12)
    s_barrier
    s_setprio 3
    s_cmp_ge_u32 s10, 9
    s_cbranch_scc1 p2_nm1m1a
    v_lshrrev_b32 v84, 1, v112
    s_add_u32 s44, s20, s42
    buffer_load_dwordx2 v[84:85], v84, s[4:7], s44 offen
p2_nm1m1a:
    buffer_load_dwordx4 v[72:75], v112, s[4:7], s20 offen offset:0
    buffer_load_dwordx4 v[76:79], v112, s[4:7], s20 offen offset:1024
    buffer_load_dwordx4 v[80:83], v112, s[4:7], s20 offen offset:2048
    v_cmpx_ge_u16 vcc, 0x3fff, v60
    ds_read_b64 v[24:25], v24
    s_mov_b64 exec, -1
    v_cmpx_ge_u16 vcc, 0x3fff, v61
    ds_read_b64 v[26:27], v26
    s_mov_b64 exec, -1
    v_cmpx_ge_u16 vcc, 0x3fff, v62
    ds_read_b64 v[28:29], v28
    s_mov_b64 exec, -1
    v_cmpx_ge_u16 vcc, 0x3fff, v63
    ds_read_b64 v[30:31], v30
    s_mov_b64 exec, -1
    v_cmpx_ge_u16 vcc, 0x3fff, v64
    ds_read_b64 v[32:33], v32
    s_mov_b64 exec, -1
    v_cmpx_ge_u16 vcc, 0x3fff, v65
    ds_read_b64 v[34:35], v34
    s_mov_b64 exec, -1
    s_setprio 2
    s_waitcnt lgkmcnt(15)
    v_ashrrev_i32 v122, 5, v66
    v_lshlrev_b16 v123, 2, v66
    v_cndmask_b32 v126, v36, v37, s[66:67]
    v_bitop3_b32 v122, v122, v113, v113 bitop3:0x0c
    v_lshlrev_b32 v124, 16, v126
    v_mul_f32 v122, v114, v122
    v_and_b32 v125, 0xffff0000, v126
    v_add_u32 v123, v123, v123
    v_mul_f32 v124, v122, v124
    v_mul_f32 v125, v122, v125
    v_cmpx_le_u32 vcc, 0x1000000, v66
    ds_add_f32 v123, v124 offset:54272
    ds_add_f32 v123, v125 offset:54276
    s_mov_b64 exec, -1
    v_ashrrev_i32 v122, 5, v67
    v_lshlrev_b16 v123, 2, v67
    v_cndmask_b32 v126, v38, v39, s[66:67]
    v_bitop3_b32 v122, v122, v113, v113 bitop3:0x0c
    v_lshlrev_b32 v124, 16, v126
    v_mul_f32 v122, v114, v122
    v_and_b32 v125, 0xffff0000, v126
    v_add_u32 v123, v123, v123
    v_mul_f32 v124, v122, v124
    v_mul_f32 v125, v122, v125
    v_cmpx_le_u32 vcc, 0x1000000, v67
    ds_add_f32 v123, v124 offset:54272
    ds_add_f32 v123, v125 offset:54276
    s_mov_b64 exec, -1
    v_ashrrev_i32 v122, 5, v68
    v_lshlrev_b16 v123, 2, v68
    v_cndmask_b32 v126, v40, v41, s[66:67]
    v_bitop3_b32 v122, v122, v113, v113 bitop3:0x0c
    v_lshlrev_b32 v124, 16, v126
    v_mul_f32 v122, v114, v122
    v_and_b32 v125, 0xffff0000, v126
    v_add_u32 v123, v123, v123
    v_mul_f32 v124, v122, v124
    v_mul_f32 v125, v122, v125
    v_cmpx_le_u32 vcc, 0x1000000, v68
    ds_add_f32 v123, v124 offset:54272
    ds_add_f32 v123, v125 offset:54276
    s_mov_b64 exec, -1
    s_waitcnt vmcnt(15)
    v_perm_b32 v66, v97, v94, s31
    v_perm_b32 v67, v97, v95, s32
    v_perm_b32 v68, v97, v96, s33
    v_lshlrev_b16 v40, 3, v96
    v_lshlrev_b16 v38, 3, v95
    v_lshlrev_b16 v36, 3, v94
    v_cmpx_ge_u16 vcc, 0x3fff, v66
    ds_read_b64 v[36:37], v36
    s_mov_b64 exec, -1
    v_cmpx_ge_u16 vcc, 0x3fff, v67
    ds_read_b64 v[38:39], v38
    s_mov_b64 exec, -1
    v_cmpx_ge_u16 vcc, 0x3fff, v68
    ds_read_b64 v[40:41], v40
    s_mov_b64 exec, -1
    v_bfe_u32 v90, v107, 14, 4
    v_lshrrev_b32 v91, 18, v107
    v_and_b32 v107, 0x3fff, v107
    v_mad_u32_u24 v90, v90, s63, v91
    v_mad_u32_u24 v107, v90, s65, v107
    buffer_load_dwordx4 v[90:93], v107, s[68:71], 0 offen
    s_setprio 1
    s_waitcnt lgkmcnt(15)
    v_ashrrev_i32 v122, 5, v69
    v_lshlrev_b16 v123, 2, v69
    v_cndmask_b32 v126, v42, v43, s[66:67]
    v_bitop3_b32 v122, v122, v113, v113 bitop3:0x0c
    v_lshlrev_b32 v124, 16, v126
    v_mul_f32 v122, v114, v122
    v_and_b32 v125, 0xffff0000, v126
    v_add_u32 v123, v123, v123
    v_mul_f32 v124, v122, v124
    v_mul_f32 v125, v122, v125
    v_cmpx_le_u32 vcc, 0x1000000, v69
    ds_add_f32 v123, v124 offset:54272
    ds_add_f32 v123, v125 offset:54276
    s_mov_b64 exec, -1
    v_ashrrev_i32 v122, 5, v70
    v_lshlrev_b16 v123, 2, v70
    v_cndmask_b32 v126, v44, v45, s[66:67]
    v_bitop3_b32 v122, v122, v113, v113 bitop3:0x0c
    v_lshlrev_b32 v124, 16, v126
    v_mul_f32 v122, v114, v122
    v_and_b32 v125, 0xffff0000, v126
    v_add_u32 v123, v123, v123
    v_mul_f32 v124, v122, v124
    v_mul_f32 v125, v122, v125
    v_cmpx_le_u32 vcc, 0x1000000, v70
    ds_add_f32 v123, v124 offset:54272
    ds_add_f32 v123, v125 offset:54276
    s_mov_b64 exec, -1
    v_ashrrev_i32 v122, 5, v71
    v_lshlrev_b16 v123, 2, v71
    v_cndmask_b32 v126, v46, v47, s[66:67]
    v_bitop3_b32 v122, v122, v113, v113 bitop3:0x0c
    v_lshlrev_b32 v124, 16, v126
    v_mul_f32 v122, v114, v122
    v_and_b32 v125, 0xffff0000, v126
    v_add_u32 v123, v123, v123
    v_mul_f32 v124, v122, v124
    v_mul_f32 v125, v122, v125
    v_cmpx_le_u32 vcc, 0x1000000, v71
    ds_add_f32 v123, v124 offset:54272
    ds_add_f32 v123, v125 offset:54276
    s_mov_b64 exec, -1
    s_waitcnt vmcnt(12)
    v_perm_b32 v69, v101, v98, s31
    v_perm_b32 v70, v101, v99, s32
    v_perm_b32 v71, v101, v100, s33
    v_lshlrev_b16 v46, 3, v100
    v_lshlrev_b16 v44, 3, v99
    v_lshlrev_b16 v42, 3, v98
    v_cmpx_ge_u16 vcc, 0x3fff, v69
    ds_read_b64 v[42:43], v42
    s_mov_b64 exec, -1
    v_cmpx_ge_u16 vcc, 0x3fff, v70
    ds_read_b64 v[44:45], v44
    s_mov_b64 exec, -1
    v_cmpx_ge_u16 vcc, 0x3fff, v71
    ds_read_b64 v[46:47], v46
    s_mov_b64 exec, -1
    s_waitcnt lgkmcnt(15)
    s_nop 2
    s_nop 1
    v_max_u32_dpp v108, v108, v108 row_shr:1 row_mask:0xf bank_mask:0xf bound_ctrl:0
    v_max_u32_dpp v109, v109, v109 row_shr:1 row_mask:0xf bank_mask:0xf bound_ctrl:0
    s_nop 0
    v_max_u32_dpp v108, v108, v108 row_shr:2 row_mask:0xf bank_mask:0xf bound_ctrl:0
    v_max_u32_dpp v109, v109, v109 row_shr:2 row_mask:0xf bank_mask:0xf bound_ctrl:0
    s_nop 0
    v_max_u32_dpp v108, v108, v108 row_shr:4 row_mask:0xf bank_mask:0xf bound_ctrl:0
    v_max_u32_dpp v109, v109, v109 row_shr:4 row_mask:0xf bank_mask:0xf bound_ctrl:0
    s_nop 0
    v_max_u32_dpp v108, v108, v108 row_shr:8 row_mask:0xf bank_mask:0xf bound_ctrl:0
    v_max_u32_dpp v109, v109, v109 row_shr:8 row_mask:0xf bank_mask:0xf bound_ctrl:0
    s_nop 0
    v_max_u32_dpp v108, v108, v108 row_bcast:15 row_mask:0xa bank_mask:0xf
    v_max_u32_dpp v109, v109, v109 row_bcast:15 row_mask:0xa bank_mask:0xf
    s_nop 0
    v_max_u32_dpp v108, v108, v108 row_bcast:31 row_mask:0xc bank_mask:0xf
    v_max_u32_dpp v109, v109, v109 row_bcast:31 row_mask:0xc bank_mask:0xf
    s_nop 0
    s_nop 0
    v_max_u32 v108, s41, v108
    s_nop 0
    v_readlane_b32 s41, v108, 63
    v_add_u32 v108, v108, v112
    v_add_u32 v108, 4294961152, v108
    v_max_u32 v109, s41, v109
    s_nop 0
    v_readlane_b32 s41, v109, 63
    v_add_u32 v109, v109, v112
    v_add_u32 v109, 4294962176, v109
    v_bfe_u32 v94, v108, 14, 4
    v_lshrrev_b32 v95, 18, v108
    v_and_b32 v108, 0x3fff, v108
    v_mad_u32_u24 v94, v94, s63, v95
    v_mad_u32_u24 v108, v94, s65, v108
    buffer_load_dwordx4 v[94:97], v108, s[68:71], 0 offen
    s_setprio 0
    s_waitcnt vmcnt(9)
    v_perm_b32 v48, v3, v0, s31
    v_perm_b32 v49, v3, v1, s32
    v_perm_b32 v50, v3, v2, s33
    v_lshlrev_b16 v4, 3, v2
    v_lshlrev_b16 v2, 3, v1
    v_lshlrev_b16 v0, 3, v0
    v_cmpx_ge_u16 vcc, 0x3fff, v48
    ds_read_b64 v[0:1], v0
    s_mov_b64 exec, -1
    v_cmpx_ge_u16 vcc, 0x3fff, v49
    ds_read_b64 v[2:3], v2
    s_mov_b64 exec, -1
    v_cmpx_ge_u16 vcc, 0x3fff, v50
    ds_read_b64 v[4:5], v4
    s_mov_b64 exec, -1
    s_waitcnt vmcnt(8)
    v_perm_b32 v51, v9, v6, s31
    v_perm_b32 v52, v9, v7, s32
    v_perm_b32 v53, v9, v8, s33
    v_lshlrev_b16 v10, 3, v8
    v_lshlrev_b16 v8, 3, v7
    v_lshlrev_b16 v6, 3, v6
    v_cmpx_ge_u16 vcc, 0x3fff, v51
    ds_read_b64 v[6:7], v6
    s_mov_b64 exec, -1
    v_cmpx_ge_u16 vcc, 0x3fff, v52
    ds_read_b64 v[8:9], v8
    s_mov_b64 exec, -1
    v_cmpx_ge_u16 vcc, 0x3fff, v53
    ds_read_b64 v[10:11], v10
    s_mov_b64 exec, -1
    s_waitcnt vmcnt(7)
    v_perm_b32 v54, v15, v12, s31
    v_perm_b32 v55, v15, v13, s32
    v_perm_b32 v56, v15, v14, s33
    v_lshlrev_b16 v16, 3, v14
    v_lshlrev_b16 v14, 3, v13
    v_lshlrev_b16 v12, 3, v12
    v_cmpx_ge_u16 vcc, 0x3fff, v54
    ds_read_b64 v[12:13], v12
    s_mov_b64 exec, -1
    v_cmpx_ge_u16 vcc, 0x3fff, v55
    ds_read_b64 v[14:15], v14
    s_mov_b64 exec, -1
    v_cmpx_ge_u16 vcc, 0x3fff, v56
    ds_read_b64 v[16:17], v16
    s_mov_b64 exec, -1
    s_waitcnt vmcnt(6)
    v_perm_b32 v57, v21, v18, s31
    v_perm_b32 v58, v21, v19, s32
    v_perm_b32 v59, v21, v20, s33
    v_lshlrev_b16 v22, 3, v20
    v_lshlrev_b16 v20, 3, v19
    v_lshlrev_b16 v18, 3, v18
    s_cmp_lt_u32 s16, 8
    s_cbranch_scc1 p2_g1r03
    v_cmpx_ge_u16 vcc, 0x3fff, v57
    ds_read_b64 v[18:19], v18
    s_mov_b64 exec, -1
    v_cmpx_ge_u16 vcc, 0x3fff, v58
    ds_read_b64 v[20:21], v20
    s_mov_b64 exec, -1
    v_cmpx_ge_u16 vcc, 0x3fff, v59
    ds_read_b64 v[22:23], v22
    s_mov_b64 exec, -1
p2_g1r03:
    s_waitcnt lgkmcnt(0)
    s_barrier
    s_waitcnt lgkmcnt(15)
    s_branch p2_tail
p2_drain1:
    v_cmpx_gt_i16 vcc, 0, v48
    ds_read_b64 v[0:1], v0
    s_mov_b64 exec, -1
    v_cmpx_gt_i16 vcc, 0, v49
    ds_read_b64 v[2:3], v2
    s_mov_b64 exec, -1
    v_cmpx_gt_i16 vcc, 0, v50
    ds_read_b64 v[4:5], v4
    s_mov_b64 exec, -1
    v_cmpx_gt_i16 vcc, 0, v51
    ds_read_b64 v[6:7], v6
    s_mov_b64 exec, -1
    v_cmpx_gt_i16 vcc, 0, v52
    ds_read_b64 v[8:9], v8
    s_mov_b64 exec, -1
    v_cmpx_gt_i16 vcc, 0, v53
    ds_read_b64 v[10:11], v10
    s_mov_b64 exec, -1
    v_cmpx_gt_i16 vcc, 0, v54
    ds_read_b64 v[12:13], v12
    s_mov_b64 exec, -1
    v_cmpx_gt_i16 vcc, 0, v55
    ds_read_b64 v[14:15], v14
    s_mov_b64 exec, -1
    v_cmpx_gt_i16 vcc, 0, v56
    ds_read_b64 v[16:17], v16
    s_mov_b64 exec, -1
    s_cmp_lt_u32 s15, 8
    s_cbranch_scc1 p2_gd1
    v_cmpx_gt_i16 vcc, 0, v57
    ds_read_b64 v[18:19], v18
    s_mov_b64 exec, -1
    v_cmpx_gt_i16 vcc, 0, v58
    ds_read_b64 v[20:21], v20
    s_mov_b64 exec, -1
    v_cmpx_gt_i16 vcc, 0, v59
    ds_read_b64 v[22:23], v22
    s_mov_b64 exec, -1
p2_gd1:
    v_cmpx_gt_i16 vcc, 0, v60
    ds_read_b64 v[24:25], v24
    s_mov_b64 exec, -1
    v_cmpx_gt_i16 vcc, 0, v61
    ds_read_b64 v[26:27], v26
    s_mov_b64 exec, -1
    v_cmpx_gt_i16 vcc, 0, v62
    ds_read_b64 v[28:29], v28
    s_mov_b64 exec, -1
    v_cmpx_gt_i16 vcc, 0, v63
    ds_read_b64 v[30:31], v30
    s_mov_b64 exec, -1
    v_cmpx_gt_i16 vcc, 0, v64
    ds_read_b64 v[32:33], v32
    s_mov_b64 exec, -1
    v_cmpx_gt_i16 vcc, 0, v65
    ds_read_b64 v[34:35], v34
    s_mov_b64 exec, -1
    v_cmpx_gt_i16 vcc, 0, v66
    ds_read_b64 v[36:37], v36
    s_mov_b64 exec, -1
    v_cmpx_gt_i16 vcc, 0, v67
    ds_read_b64 v[38:39], v38
    s_mov_b64 exec, -1
    v_cmpx_gt_i16 vcc, 0, v68
    ds_read_b64 v[40:41], v40
    s_mov_b64 exec, -1
    v_cmpx_gt_i16 vcc, 0, v69
    ds_read_b64 v[42:43], v42
    s_mov_b64 exec, -1
    v_cmpx_gt_i16 vcc, 0, v70
    ds_read_b64 v[44:45], v44
    s_mov_b64 exec, -1
    v_cmpx_gt_i16 vcc, 0, v71
    ds_read_b64 v[46:47], v46
    s_mov_b64 exec, -1
    s_waitcnt lgkmcnt(15)
    v_ashrrev_i32 v122, 5, v48
    v_lshlrev_b16 v123, 2, v48
    v_cndmask_b32 v126, v0, v1, s[66:67]
    v_bitop3_b32 v122, v122, v113, v113 bitop3:0x0c
    v_lshlrev_b32 v124, 16, v126
    v_mul_f32 v122, v114, v122
    v_and_b32 v125, 0xffff0000, v126
    v_add_u32 v123, v123, v123
    v_mul_f32 v124, v122, v124
    v_mul_f32 v125, v122, v125
    v_cmpx_le_u32 vcc, 0x1000000, v48
    ds_add_f32 v123, v124 offset:54272
    ds_add_f32 v123, v125 offset:54276
    s_mov_b64 exec, -1
    v_ashrrev_i32 v122, 5, v49
    v_lshlrev_b16 v123, 2, v49
    v_cndmask_b32 v126, v2, v3, s[66:67]
    v_bitop3_b32 v122, v122, v113, v113 bitop3:0x0c
    v_lshlrev_b32 v124, 16, v126
    v_mul_f32 v122, v114, v122
    v_and_b32 v125, 0xffff0000, v126
    v_add_u32 v123, v123, v123
    v_mul_f32 v124, v122, v124
    v_mul_f32 v125, v122, v125
    v_cmpx_le_u32 vcc, 0x1000000, v49
    ds_add_f32 v123, v124 offset:54272
    ds_add_f32 v123, v125 offset:54276
    s_mov_b64 exec, -1
    v_ashrrev_i32 v122, 5, v50
    v_lshlrev_b16 v123, 2, v50
    v_cndmask_b32 v126, v4, v5, s[66:67]
    v_bitop3_b32 v122, v122, v113, v113 bitop3:0x0c
    v_lshlrev_b32 v124, 16, v126
    v_mul_f32 v122, v114, v122
    v_and_b32 v125, 0xffff0000, v126
    v_add_u32 v123, v123, v123
    v_mul_f32 v124, v122, v124
    v_mul_f32 v125, v122, v125
    v_cmpx_le_u32 vcc, 0x1000000, v50
    ds_add_f32 v123, v124 offset:54272
    ds_add_f32 v123, v125 offset:54276
    s_mov_b64 exec, -1
    s_waitcnt lgkmcnt(15)
    v_ashrrev_i32 v122, 5, v51
    v_lshlrev_b16 v123, 2, v51
    v_cndmask_b32 v126, v6, v7, s[66:67]
    v_bitop3_b32 v122, v122, v113, v113 bitop3:0x0c
    v_lshlrev_b32 v124, 16, v126
    v_mul_f32 v122, v114, v122
    v_and_b32 v125, 0xffff0000, v126
    v_add_u32 v123, v123, v123
    v_mul_f32 v124, v122, v124
    v_mul_f32 v125, v122, v125
    v_cmpx_le_u32 vcc, 0x1000000, v51
    ds_add_f32 v123, v124 offset:54272
    ds_add_f32 v123, v125 offset:54276
    s_mov_b64 exec, -1
    v_ashrrev_i32 v122, 5, v52
    v_lshlrev_b16 v123, 2, v52
    v_cndmask_b32 v126, v8, v9, s[66:67]
    v_bitop3_b32 v122, v122, v113, v113 bitop3:0x0c
    v_lshlrev_b32 v124, 16, v126
    v_mul_f32 v122, v114, v122
    v_and_b32 v125, 0xffff0000, v126
    v_add_u32 v123, v123, v123
    v_mul_f32 v124, v122, v124
    v_mul_f32 v125, v122, v125
    v_cmpx_le_u32 vcc, 0x1000000, v52
    ds_add_f32 v123, v124 offset:54272
    ds_add_f32 v123, v125 offset:54276
    s_mov_b64 exec, -1
    v_ashrrev_i32 v122, 5, v53
    v_lshlrev_b16 v123, 2, v53
    v_cndmask_b32 v126, v10, v11, s[66:67]
    v_bitop3_b32 v122, v122, v113, v113 bitop3:0x0c
    v_lshlrev_b32 v124, 16, v126
    v_mul_f32 v122, v114, v122
    v_and_b32 v125, 0xffff0000, v126
    v_add_u32 v123, v123, v123
    v_mul_f32 v124, v122, v124
    v_mul_f32 v125, v122, v125
    v_cmpx_le_u32 vcc, 0x1000000, v53
    ds_add_f32 v123, v124 offset:54272
    ds_add_f32 v123, v125 offset:54276
    s_mov_b64 exec, -1
    s_waitcnt lgkmcnt(15)
    v_ashrrev_i32 v122, 5, v54
    v_lshlrev_b16 v123, 2, v54
    v_cndmask_b32 v126, v12, v13, s[66:67]
    v_bitop3_b32 v122, v122, v113, v113 bitop3:0x0c
    v_lshlrev_b32 v124, 16, v126
    v_mul_f32 v122, v114, v122
    v_and_b32 v125, 0xffff0000, v126
    v_add_u32 v123, v123, v123
    v_mul_f32 v124, v122, v124
    v_mul_f32 v125, v122, v125
    v_cmpx_le_u32 vcc, 0x1000000, v54
    ds_add_f32 v123, v124 offset:54272
    ds_add_f32 v123, v125 offset:54276
    s_mov_b64 exec, -1
    v_ashrrev_i32 v122, 5, v55
    v_lshlrev_b16 v123, 2, v55
    v_cndmask_b32 v126, v14, v15, s[66:67]
    v_bitop3_b32 v122, v122, v113, v113 bitop3:0x0c
    v_lshlrev_b32 v124, 16, v126
    v_mul_f32 v122, v114, v122
    v_and_b32 v125, 0xffff0000, v126
    v_add_u32 v123, v123, v123
    v_mul_f32 v124, v122, v124
    v_mul_f32 v125, v122, v125
    v_cmpx_le_u32 vcc, 0x1000000, v55
    ds_add_f32 v123, v124 offset:54272
    ds_add_f32 v123, v125 offset:54276
    s_mov_b64 exec, -1
    v_ashrrev_i32 v122, 5, v56
    v_lshlrev_b16 v123, 2, v56
    v_cndmask_b32 v126, v16, v17, s[66:67]
    v_bitop3_b32 v122, v122, v113, v113 bitop3:0x0c
    v_lshlrev_b32 v124, 16, v126
    v_mul_f32 v122, v114, v122
    v_and_b32 v125, 0xffff0000, v126
    v_add_u32 v123, v123, v123
    v_mul_f32 v124, v122, v124
    v_mul_f32 v125, v122, v125
    v_cmpx_le_u32 vcc, 0x1000000, v56
    ds_add_f32 v123, v124 offset:54272
    ds_add_f32 v123, v125 offset:54276
    s_mov_b64 exec, -1
    s_cmp_lt_u32 s15, 8
    s_cbranch_scc1 p2_nad1
    s_waitcnt lgkmcnt(15)
    v_ashrrev_i32 v122, 5, v57
    v_lshlrev_b16 v123, 2, v57
    v_cndmask_b32 v126, v18, v19, s[66:67]
    v_bitop3_b32 v122, v122, v113, v113 bitop3:0x0c
    v_lshlrev_b32 v124, 16, v126
    v_mul_f32 v122, v114, v122
    v_and_b32 v125, 0xffff0000, v126
    v_add_u32 v123, v123, v123
    v_mul_f32 v124, v122, v124
    v_mul_f32 v125, v122, v125
    v_cmpx_le_u32 vcc, 0x1000000, v57
    ds_add_f32 v123, v124 offset:54272
    ds_add_f32 v123, v125 offset:54276
    s_mov_b64 exec, -1
    v_ashrrev_i32 v122, 5, v58
    v_lshlrev_b16 v123, 2, v58
    v_cndmask_b32 v126, v20, v21, s[66:67]
    v_bitop3_b32 v122, v122, v113, v113 bitop3:0x0c
    v_lshlrev_b32 v124, 16, v126
    v_mul_f32 v122, v114, v122
    v_and_b32 v125, 0xffff0000, v126
    v_add_u32 v123, v123, v123
    v_mul_f32 v124, v122, v124
    v_mul_f32 v125, v122, v125
    v_cmpx_le_u32 vcc, 0x1000000, v58
    ds_add_f32 v123, v124 offset:54272
    ds_add_f32 v123, v125 offset:54276
    s_mov_b64 exec, -1
    v_ashrrev_i32 v122, 5, v59
    v_lshlrev_b16 v123, 2, v59
    v_cndmask_b32 v126, v22, v23, s[66:67]
    v_bitop3_b32 v122, v122, v113, v113 bitop3:0x0c
    v_lshlrev_b32 v124, 16, v126
    v_mul_f32 v122, v114, v122
    v_and_b32 v125, 0xffff0000, v126
    v_add_u32 v123, v123, v123
    v_mul_f32 v124, v122, v124
    v_mul_f32 v125, v122, v125
    v_cmpx_le_u32 vcc, 0x1000000, v59
    ds_add_f32 v123, v124 offset:54272
    ds_add_f32 v123, v125 offset:54276
    s_mov_b64 exec, -1
p2_nad1:
    s_waitcnt lgkmcnt(15)
    v_ashrrev_i32 v122, 5, v60
    v_lshlrev_b16 v123, 2, v60
    v_cndmask_b32 v126, v24, v25, s[66:67]
    v_bitop3_b32 v122, v122, v113, v113 bitop3:0x0c
    v_lshlrev_b32 v124, 16, v126
    v_mul_f32 v122, v114, v122
    v_and_b32 v125, 0xffff0000, v126
    v_add_u32 v123, v123, v123
    v_mul_f32 v124, v122, v124
    v_mul_f32 v125, v122, v125
    v_cmpx_le_u32 vcc, 0x1000000, v60
    ds_add_f32 v123, v124 offset:54272
    ds_add_f32 v123, v125 offset:54276
    s_mov_b64 exec, -1
    v_ashrrev_i32 v122, 5, v61
    v_lshlrev_b16 v123, 2, v61
    v_cndmask_b32 v126, v26, v27, s[66:67]
    v_bitop3_b32 v122, v122, v113, v113 bitop3:0x0c
    v_lshlrev_b32 v124, 16, v126
    v_mul_f32 v122, v114, v122
    v_and_b32 v125, 0xffff0000, v126
    v_add_u32 v123, v123, v123
    v_mul_f32 v124, v122, v124
    v_mul_f32 v125, v122, v125
    v_cmpx_le_u32 vcc, 0x1000000, v61
    ds_add_f32 v123, v124 offset:54272
    ds_add_f32 v123, v125 offset:54276
    s_mov_b64 exec, -1
    v_ashrrev_i32 v122, 5, v62
    v_lshlrev_b16 v123, 2, v62
    v_cndmask_b32 v126, v28, v29, s[66:67]
    v_bitop3_b32 v122, v122, v113, v113 bitop3:0x0c
    v_lshlrev_b32 v124, 16, v126
    v_mul_f32 v122, v114, v122
    v_and_b32 v125, 0xffff0000, v126
    v_add_u32 v123, v123, v123
    v_mul_f32 v124, v122, v124
    v_mul_f32 v125, v122, v125
    v_cmpx_le_u32 vcc, 0x1000000, v62
    ds_add_f32 v123, v124 offset:54272
    ds_add_f32 v123, v125 offset:54276
    s_mov_b64 exec, -1
    s_waitcnt lgkmcnt(15)
    v_ashrrev_i32 v122, 5, v63
    v_lshlrev_b16 v123, 2, v63
    v_cndmask_b32 v126, v30, v31, s[66:67]
    v_bitop3_b32 v122, v122, v113, v113 bitop3:0x0c
    v_lshlrev_b32 v124, 16, v126
    v_mul_f32 v122, v114, v122
    v_and_b32 v125, 0xffff0000, v126
    v_add_u32 v123, v123, v123
    v_mul_f32 v124, v122, v124
    v_mul_f32 v125, v122, v125
    v_cmpx_le_u32 vcc, 0x1000000, v63
    ds_add_f32 v123, v124 offset:54272
    ds_add_f32 v123, v125 offset:54276
    s_mov_b64 exec, -1
    v_ashrrev_i32 v122, 5, v64
    v_lshlrev_b16 v123, 2, v64
    v_cndmask_b32 v126, v32, v33, s[66:67]
    v_bitop3_b32 v122, v122, v113, v113 bitop3:0x0c
    v_lshlrev_b32 v124, 16, v126
    v_mul_f32 v122, v114, v122
    v_and_b32 v125, 0xffff0000, v126
    v_add_u32 v123, v123, v123
    v_mul_f32 v124, v122, v124
    v_mul_f32 v125, v122, v125
    v_cmpx_le_u32 vcc, 0x1000000, v64
    ds_add_f32 v123, v124 offset:54272
    ds_add_f32 v123, v125 offset:54276
    s_mov_b64 exec, -1
    v_ashrrev_i32 v122, 5, v65
    v_lshlrev_b16 v123, 2, v65
    v_cndmask_b32 v126, v34, v35, s[66:67]
    v_bitop3_b32 v122, v122, v113, v113 bitop3:0x0c
    v_lshlrev_b32 v124, 16, v126
    v_mul_f32 v122, v114, v122
    v_and_b32 v125, 0xffff0000, v126
    v_add_u32 v123, v123, v123
    v_mul_f32 v124, v122, v124
    v_mul_f32 v125, v122, v125
    v_cmpx_le_u32 vcc, 0x1000000, v65
    ds_add_f32 v123, v124 offset:54272
    ds_add_f32 v123, v125 offset:54276
    s_mov_b64 exec, -1
    s_waitcnt lgkmcnt(15)
    v_ashrrev_i32 v122, 5, v66
    v_lshlrev_b16 v123, 2, v66
    v_cndmask_b32 v126, v36, v37, s[66:67]
    v_bitop3_b32 v122, v122, v113, v113 bitop3:0x0c
    v_lshlrev_b32 v124, 16, v126
    v_mul_f32 v122, v114, v122
    v_and_b32 v125, 0xffff0000, v126
    v_add_u32 v123, v123, v123
    v_mul_f32 v124, v122, v124
    v_mul_f32 v125, v122, v125
    v_cmpx_le_u32 vcc, 0x1000000, v66
    ds_add_f32 v123, v124 offset:54272
    ds_add_f32 v123, v125 offset:54276
    s_mov_b64 exec, -1
    v_ashrrev_i32 v122, 5, v67
    v_lshlrev_b16 v123, 2, v67
    v_cndmask_b32 v126, v38, v39, s[66:67]
    v_bitop3_b32 v122, v122, v113, v113 bitop3:0x0c
    v_lshlrev_b32 v124, 16, v126
    v_mul_f32 v122, v114, v122
    v_and_b32 v125, 0xffff0000, v126
    v_add_u32 v123, v123, v123
    v_mul_f32 v124, v122, v124
    v_mul_f32 v125, v122, v125
    v_cmpx_le_u32 vcc, 0x1000000, v67
    ds_add_f32 v123, v124 offset:54272
    ds_add_f32 v123, v125 offset:54276
    s_mov_b64 exec, -1
    v_ashrrev_i32 v122, 5, v68
    v_lshlrev_b16 v123, 2, v68
    v_cndmask_b32 v126, v40, v41, s[66:67]
    v_bitop3_b32 v122, v122, v113, v113 bitop3:0x0c
    v_lshlrev_b32 v124, 16, v126
    v_mul_f32 v122, v114, v122
    v_and_b32 v125, 0xffff0000, v126
    v_add_u32 v123, v123, v123
    v_mul_f32 v124, v122, v124
    v_mul_f32 v125, v122, v125
    v_cmpx_le_u32 vcc, 0x1000000, v68
    ds_add_f32 v123, v124 offset:54272
    ds_add_f32 v123, v125 offset:54276
    s_mov_b64 exec, -1
    s_waitcnt lgkmcnt(15)
    v_ashrrev_i32 v122, 5, v69
    v_lshlrev_b16 v123, 2, v69
    v_cndmask_b32 v126, v42, v43, s[66:67]
    v_bitop3_b32 v122, v122, v113, v113 bitop3:0x0c
    v_lshlrev_b32 v124, 16, v126
    v_mul_f32 v122, v114, v122
    v_and_b32 v125, 0xffff0000, v126
    v_add_u32 v123, v123, v123
    v_mul_f32 v124, v122, v124
    v_mul_f32 v125, v122, v125
    v_cmpx_le_u32 vcc, 0x1000000, v69
    ds_add_f32 v123, v124 offset:54272
    ds_add_f32 v123, v125 offset:54276
    s_mov_b64 exec, -1
    v_ashrrev_i32 v122, 5, v70
    v_lshlrev_b16 v123, 2, v70
    v_cndmask_b32 v126, v44, v45, s[66:67]
    v_bitop3_b32 v122, v122, v113, v113 bitop3:0x0c
    v_lshlrev_b32 v124, 16, v126
    v_mul_f32 v122, v114, v122
    v_and_b32 v125, 0xffff0000, v126
    v_add_u32 v123, v123, v123
    v_mul_f32 v124, v122, v124
    v_mul_f32 v125, v122, v125
    v_cmpx_le_u32 vcc, 0x1000000, v70
    ds_add_f32 v123, v124 offset:54272
    ds_add_f32 v123, v125 offset:54276
    s_mov_b64 exec, -1
    v_ashrrev_i32 v122, 5, v71
    v_lshlrev_b16 v123, 2, v71
    v_cndmask_b32 v126, v46, v47, s[66:67]
    v_bitop3_b32 v122, v122, v113, v113 bitop3:0x0c
    v_lshlrev_b32 v124, 16, v126
    v_mul_f32 v122, v114, v122
    v_and_b32 v125, 0xffff0000, v126
    v_add_u32 v123, v123, v123
    v_mul_f32 v124, v122, v124
    v_mul_f32 v125, v122, v125
    v_cmpx_le_u32 vcc, 0x1000000, v71
    ds_add_f32 v123, v124 offset:54272
    ds_add_f32 v123, v125 offset:54276
    s_mov_b64 exec, -1
    s_branch p2_fin
p2_tail:
    s_mov_b32 s60, s61
    s_mov_b32 s15, s16
    s_mov_b32 s16, s17
    v_mov_b32 v122, s19
    s_xor_b32 s19, s19, 4
    ds_read_b32 v125, v122 offset:53760
    v_mov_b32 v123, s19
    v_mov_b32 v124, 0
    ds_write_b32 v123, v124 offset:53760
    s_waitcnt vmcnt(2)
    s_mov_b32 m0, s24
    s_cmp_ge_u32 s10, 9
    s_cbranch_scc1 p2_st2s1
    ds_write_addtid_b32 v84 offset:49152
    ds_write_addtid_b32 v85 offset:49408
p2_st2s1:
    s_mov_b32 m0, s23
    s_add_u32 s20, s20, 53760
    ds_write_addtid_b32 v72 offset:0
    ds_write_addtid_b32 v73 offset:256
    ds_write_addtid_b32 v74 offset:512
    ds_write_addtid_b32 v75 offset:768
    ds_write_addtid_b32 v76 offset:1024
    ds_write_addtid_b32 v77 offset:1280
    ds_write_addtid_b32 v78 offset:1536
    ds_write_addtid_b32 v79 offset:1792
    ds_write_addtid_b32 v80 offset:2048
    ds_write_addtid_b32 v81 offset:2304
    ds_write_addtid_b32 v82 offset:2560
    ds_write_addtid_b32 v83 offset:2816
    s_cmp_ge_u32 s10, 9
    s_cbranch_scc1 p2_nm2m2a
    v_lshrrev_b32 v84, 1, v112
    s_add_u32 s44, s20, s42
    buffer_load_dwordx2 v[84:85], v84, s[4:7], s44 offen
p2_nm2m2a:
    buffer_load_dwordx4 v[72:75], v112, s[4:7], s20 offen offset:0
    buffer_load_dwordx4 v[76:79], v112, s[4:7], s20 offen offset:1024
    buffer_load_dwordx4 v[80:83], v112, s[4:7], s20 offen offset:2048
    s_waitcnt lgkmcnt(0)
    s_barrier
    s_setprio 3
    v_cmpx_lt_i16 vcc, 0x3fff, v48
    ds_read_b64 v[0:1], v0
    s_mov_b64 exec, -1
    v_cmpx_lt_i16 vcc, 0x3fff, v49
    ds_read_b64 v[2:3], v2
    s_mov_b64 exec, -1
    v_cmpx_lt_i16 vcc, 0x3fff, v50
    ds_read_b64 v[4:5], v4
    s_mov_b64 exec, -1
    v_cmpx_lt_i16 vcc, 0x3fff, v51
    ds_read_b64 v[6:7], v6
    s_mov_b64 exec, -1
    v_cmpx_lt_i16 vcc, 0x3fff, v52
    ds_read_b64 v[8:9], v8
    s_mov_b64 exec, -1
    v_cmpx_lt_i16 vcc, 0x3fff, v53
    ds_read_b64 v[10:11], v10
    s_mov_b64 exec, -1
    s_waitcnt lgkmcnt(15)
    s_nop 1
    v_readfirstlane_b32 s44, v125
    s_nop 0
    s_cmp_lg_u32 s44, 0
    s_cbranch_scc1 p2_advb
    s_add_u32 s61, s61, 1
    s_min_u32 s61, s61, 10
    v_mov_b32 v110, 0
    v_mov_b32 v111, 0
    s_cmp_eq_u32 s61, 10
    s_cbranch_scc1 p2_advb
    s_add_u32 s44, s61, s18
    s_cmp_ge_u32 s44, 10
    s_cselect_b32 s53, 10, 0
    s_sub_u32 s44, s44, s53
    s_mul_i32 s44, s44, 4160
    s_add_u32 s44, s44, s40
    v_bfe_i32 v111, v112, 6, 1
    v_lshrrev_b32 v110, 6, v112
    v_bitop3_b32 v111, v111, 15, s10 bitop3:0x6a
    v_lshl_or_b32 v110, v110, 4, v111
    v_add_u32 v111, 64, v110
    v_and_b32 v111, 0x100, v111
    v_lshl_or_b32 v110, v111, 7, v110
    v_bfe_u32 v111, v112, 2, 4
    v_mul_u32_u24 v110, 41600, v110
    v_add_u32 v111, v110, v111
    buffer_load_dword v110, v111, s[4:7], s44 offen
    buffer_load_dword v111, v111, s[4:7], s44 offen offset:16
p2_advb:
    s_cmp_lg_u32 s10, 15
    s_cbranch_scc1 p2_ntg
    s_lshr_b32 s44, s2, 3
    s_mul_i32 s44, s44, 5120
    s_add_u32 s45, s60, s18
    s_cmp_ge_u32 s45, 10
    s_cselect_b32 s53, 10, 0
    s_sub_u32 s45, s45, s53
    s_mul_i32 s45, s45, 645120
    s_add_u32 s44, s44, s45
    s_add_u32 s44, s44, s62
    s_sub_u32 s44, s44, s23
    v_lshlrev_b32 v84, 3, v112
    s_mov_b32 exec_hi, 0xff
    buffer_load_dword v85, v84, s[4:7], s44 offen
    s_mov_b64 exec, -1
p2_ntg:
    v_cmpx_lt_i16 vcc, 0x3fff, v54
    ds_read_b64 v[12:13], v12
    s_mov_b64 exec, -1
    v_cmpx_lt_i16 vcc, 0x3fff, v55
    ds_read_b64 v[14:15], v14
    s_mov_b64 exec, -1
    v_cmpx_lt_i16 vcc, 0x3fff, v56
    ds_read_b64 v[16:17], v16
    s_mov_b64 exec, -1
    s_cmp_lt_u32 s15, 8
    s_cbranch_scc1 p2_g2r13
    v_cmpx_lt_i16 vcc, 0x3fff, v57
    ds_read_b64 v[18:19], v18
    s_mov_b64 exec, -1
    v_cmpx_lt_i16 vcc, 0x3fff, v58
    ds_read_b64 v[20:21], v20
    s_mov_b64 exec, -1
    v_cmpx_lt_i16 vcc, 0x3fff, v59
    ds_read_b64 v[22:23], v22
    s_mov_b64 exec, -1
p2_g2r13:
    v_bfe_u32 v98, v109, 14, 4
    v_lshrrev_b32 v99, 18, v109
    v_and_b32 v109, 0x3fff, v109
    v_mad_u32_u24 v98, v98, s63, v99
    v_mad_u32_u24 v109, v98, s65, v109
    buffer_load_dwordx4 v[98:101], v109, s[68:71], 0 offen
    s_setprio 1
    v_cmpx_lt_i16 vcc, 0x3fff, v60
    ds_read_b64 v[24:25], v24
    s_mov_b64 exec, -1
    v_cmpx_lt_i16 vcc, 0x3fff, v61
    ds_read_b64 v[26:27], v26
    s_mov_b64 exec, -1
    v_cmpx_lt_i16 vcc, 0x3fff, v62
    ds_read_b64 v[28:29], v28
    s_mov_b64 exec, -1
    v_cmpx_lt_i16 vcc, 0x3fff, v63
    ds_read_b64 v[30:31], v30
    s_mov_b64 exec, -1
    v_cmpx_lt_i16 vcc, 0x3fff, v64
    ds_read_b64 v[32:33], v32
    s_mov_b64 exec, -1
    v_cmpx_lt_i16 vcc, 0x3fff, v65
    ds_read_b64 v[34:35], v34
    s_mov_b64 exec, -1
    s_nop 2
    s_nop 1
    v_max_u32_dpp v102, v102, v102 row_shr:1 row_mask:0xf bank_mask:0xf bound_ctrl:0
    v_max_u32_dpp v103, v103, v103 row_shr:1 row_mask:0xf bank_mask:0xf bound_ctrl:0
    s_nop 0
    v_max_u32_dpp v102, v102, v102 row_shr:2 row_mask:0xf bank_mask:0xf bound_ctrl:0
    v_max_u32_dpp v103, v103, v103 row_shr:2 row_mask:0xf bank_mask:0xf bound_ctrl:0
    s_nop 0
    v_max_u32_dpp v102, v102, v102 row_shr:4 row_mask:0xf bank_mask:0xf bound_ctrl:0
    v_max_u32_dpp v103, v103, v103 row_shr:4 row_mask:0xf bank_mask:0xf bound_ctrl:0
    s_nop 0
    v_max_u32_dpp v102, v102, v102 row_shr:8 row_mask:0xf bank_mask:0xf bound_ctrl:0
    v_max_u32_dpp v103, v103, v103 row_shr:8 row_mask:0xf bank_mask:0xf bound_ctrl:0
    s_nop 0
    v_max_u32_dpp v102, v102, v102 row_bcast:15 row_mask:0xa bank_mask:0xf
    v_max_u32_dpp v103, v103, v103 row_bcast:15 row_mask:0xa bank_mask:0xf
    s_nop 0
    v_max_u32_dpp v102, v102, v102 row_bcast:31 row_mask:0xc bank_mask:0xf
    v_max_u32_dpp v103, v103, v103 row_bcast:31 row_mask:0xc bank_mask:0xf
    s_nop 0
    s_nop 0
    v_max_u32 v102, s41, v102
    s_nop 0
    v_readlane_b32 s41, v102, 63
    v_add_u32 v102, v102, v112
    v_add_u32 v102, 4294963200, v102
    v_max_u32 v103, s41, v103
    s_nop 0
    v_readlane_b32 s41, v103, 63
    v_add_u32 v103, v103, v112
    v_add_u32 v103, 4294964224, v103
    v_cmpx_lt_i16 vcc, 0x3fff, v66
    ds_read_b64 v[36:37], v36
    s_mov_b64 exec, -1
    v_cmpx_lt_i16 vcc, 0x3fff, v67
    ds_read_b64 v[38:39], v38
    s_mov_b64 exec, -1
    v_cmpx_lt_i16 vcc, 0x3fff, v68
    ds_read_b64 v[40:41], v40
    s_mov_b64 exec, -1
    v_cmpx_lt_i16 vcc, 0x3fff, v69
    ds_read_b64 v[42:43], v42
    s_mov_b64 exec, -1
    v_cmpx_lt_i16 vcc, 0x3fff, v70
    ds_read_b64 v[44:45], v44
    s_mov_b64 exec, -1
    v_cmpx_lt_i16 vcc, 0x3fff, v71
    ds_read_b64 v[46:47], v46
    s_mov_b64 exec, -1
    s_waitcnt lgkmcnt(0)
    s_barrier
    s_waitcnt vmcnt(1)
    s_mov_b32 m0, s24
    s_cmp_ge_u32 s10, 9
    s_cbranch_scc1 p2_st2s2
    ds_write_addtid_b32 v84 offset:49152
    ds_write_addtid_b32 v85 offset:49408
p2_st2s2:
    s_mov_b32 m0, s23
    s_add_u32 s20, s60, s18
    s_cmp_ge_u32 s20, 10
    s_cselect_b32 s53, 10, 0
    s_sub_u32 s20, s20, s53
    s_mul_i32 s20, s20, 645120
    s_add_u32 s20, s20, s62
    ds_write_addtid_b32 v72 offset:0
    ds_write_addtid_b32 v73 offset:256
    ds_write_addtid_b32 v74 offset:512
    ds_write_addtid_b32 v75 offset:768
    ds_write_addtid_b32 v76 offset:1024
    ds_write_addtid_b32 v77 offset:1280
    ds_write_addtid_b32 v78 offset:1536
    ds_write_addtid_b32 v79 offset:1792
    ds_write_addtid_b32 v80 offset:2048
    ds_write_addtid_b32 v81 offset:2304
    ds_write_addtid_b32 v82 offset:2560
    ds_write_addtid_b32 v83 offset:2816
    s_nop 2
    s_nop 1
    v_max_u32_dpp v104, v104, v104 row_shr:1 row_mask:0xf bank_mask:0xf bound_ctrl:0
    v_max_u32_dpp v105, v105, v105 row_shr:1 row_mask:0xf bank_mask:0xf bound_ctrl:0
    s_nop 0
    v_max_u32_dpp v104, v104, v104 row_shr:2 row_mask:0xf bank_mask:0xf bound_ctrl:0
    v_max_u32_dpp v105, v105, v105 row_shr:2 row_mask:0xf bank_mask:0xf bound_ctrl:0
    s_nop 0
    v_max_u32_dpp v104, v104, v104 row_shr:4 row_mask:0xf bank_mask:0xf bound_ctrl:0
    v_max_u32_dpp v105, v105, v105 row_shr:4 row_mask:0xf bank_mask:0xf bound_ctrl:0
    s_nop 0
    v_max_u32_dpp v104, v104, v104 row_shr:8 row_mask:0xf bank_mask:0xf bound_ctrl:0
    v_max_u32_dpp v105, v105, v105 row_shr:8 row_mask:0xf bank_mask:0xf bound_ctrl:0
    s_nop 0
    v_max_u32_dpp v104, v104, v104 row_bcast:15 row_mask:0xa bank_mask:0xf
    v_max_u32_dpp v105, v105, v105 row_bcast:15 row_mask:0xa bank_mask:0xf
    s_nop 0
    v_max_u32_dpp v104, v104, v104 row_bcast:31 row_mask:0xc bank_mask:0xf
    v_max_u32_dpp v105, v105, v105 row_bcast:31 row_mask:0xc bank_mask:0xf
    s_nop 0
    s_nop 0
    v_max_u32 v104, s41, v104
    s_nop 0
    v_readlane_b32 s41, v104, 63
    v_add_u32 v104, v104, v112
    v_add_u32 v104, 4294965248, v104
    v_max_u32 v105, s41, v105
    s_nop 0
    v_readlane_b32 s41, v105, 63
    v_add_u32 v105, v105, v112
    v_add_u32 v105, 4294966272, v105
    s_waitcnt lgkmcnt(0)
    s_barrier
    s_branch p2_top
p2_fin:
    s_waitcnt vmcnt(0) lgkmcnt(0)
    s_barrier
    s_mov_b32 s48, s11
    s_mul_i32 s44, s48, 800768
    s_mul_i32 s45, s12, 12512
    s_add_u32 s49, s44, s45
    s_lshl_b32 s44, s49, 3
    s_add_u32 s44, s44, 492278784
    s_lshl_b32 s48, s48, 2
    s_lshl_b32 s45, s12, 4
    s_add_u32 s48, s48, s45
    s_add_u32 s48, s48, 492277760
    v_add_u32 v123, s64, v112
    v_add_u32 v122, s25, v123
    v_mov_b32 v24, 0
    v_mov_b32 v25, 0
    v_mov_b32 v26, 0
    v_mov_b32 v27, 0
    v_cmp_gt_u32 vcc, 1792, v123
    v_mov_b32 v124, 0x38000000
    v_mov_b32 v126, 0
    v_cndmask_b32 v124, v124, v123, vcc
    ds_read_b128 v[0:3], v122 offset:0
    ds_read_b128 v[4:7], v122 offset:16384
    ds_read_b128 v[8:11], v122 offset:32768
    v_add_u32 v122, 49152, v122
    ds_read_b128 v[12:15], v122 offset:0
    ds_read_b128 v[16:19], v122 offset:16384
    ds_read_b128 v[20:23], v122 offset:32768
    s_mov_b64 exec, vcc
    ds_read_b128 v[24:27], v122 offset:49152
    s_mov_b64 exec, -1
    s_cmp_lg_u32 s21, 0
    s_cbranch_scc1 p2_finf
    s_waitcnt lgkmcnt(6)
    buffer_store_dwordx4 v[0:3], v123, s[4:7], s44 offen nt
    s_add_u32 s44, s44, 16384
    s_waitcnt lgkmcnt(5)
    buffer_store_dwordx4 v[4:7], v123, s[4:7], s44 offen nt
    s_add_u32 s44, s44, 16384
    s_waitcnt lgkmcnt(4)
    buffer_store_dwordx4 v[8:11], v123, s[4:7], s44 offen nt
    s_add_u32 s44, s44, 16384
    s_waitcnt lgkmcnt(3)
    buffer_store_dwordx4 v[12:15], v123, s[4:7], s44 offen nt
    s_add_u32 s44, s44, 16384
    s_waitcnt lgkmcnt(2)
    buffer_store_dwordx4 v[16:19], v123, s[4:7], s44 offen nt
    s_add_u32 s44, s44, 16384
    s_waitcnt lgkmcnt(1)
    buffer_store_dwordx4 v[20:23], v123, s[4:7], s44 offen nt
    s_add_u32 s44, s44, 16384
    s_waitcnt lgkmcnt(0)
    buffer_store_dwordx4 v[24:27], v124, s[4:7], s44 offen nt
    s_add_u32 s44, s44, 16384
    v_bitop3_b32 v115, v115, v0, v1 bitop3:0xfe
    v_bitop3_b32 v115, v115, v2, v3 bitop3:0xfe
    v_bitop3_b32 v115, v115, v4, v5 bitop3:0xfe
    v_bitop3_b32 v115, v115, v6, v7 bitop3:0xfe
    v_bitop3_b32 v115, v115, v8, v9 bitop3:0xfe
    v_bitop3_b32 v115, v115, v10, v11 bitop3:0xfe
    v_bitop3_b32 v115, v115, v12, v13 bitop3:0xfe
    v_bitop3_b32 v115, v115, v14, v15 bitop3:0xfe
    v_bitop3_b32 v115, v115, v16, v17 bitop3:0xfe
    v_bitop3_b32 v115, v115, v18, v19 bitop3:0xfe
    v_bitop3_b32 v115, v115, v20, v21 bitop3:0xfe
    v_bitop3_b32 v115, v115, v22, v23 bitop3:0xfe
    v_bitop3_b32 v115, v115, v24, v25 bitop3:0xfe
    v_bitop3_b32 v115, v115, v26, v27 bitop3:0xfe
    v_bitop3_b32 v115, v115, v116, v117 bitop3:0xfe
    v_bitop3_b32 v115, v115, v118, v119 bitop3:0xfe
    v_bitop3_b32 v115, v115, v120, v121 bitop3:0xfe
    v_mov_b32 v28, 0
    v_mov_b32 v29, 0
    v_lshrrev_b32 v30, 1, v0
    v_bitop3_b32 v28, v28, v0, v30 bitop3:0xf6
    v_lshrrev_b32 v31, 1, v1
    v_bitop3_b32 v29, v29, v1, v31 bitop3:0xf6
    v_lshrrev_b32 v30, 1, v2
    v_bitop3_b32 v28, v28, v2, v30 bitop3:0xf6
    v_lshrrev_b32 v31, 1, v3
    v_bitop3_b32 v29, v29, v3, v31 bitop3:0xf6
    v_lshrrev_b32 v30, 1, v4
    v_bitop3_b32 v28, v28, v4, v30 bitop3:0xf6
    v_lshrrev_b32 v31, 1, v5
    v_bitop3_b32 v29, v29, v5, v31 bitop3:0xf6
    v_lshrrev_b32 v30, 1, v6
    v_bitop3_b32 v28, v28, v6, v30 bitop3:0xf6
    v_lshrrev_b32 v31, 1, v7
    v_bitop3_b32 v29, v29, v7, v31 bitop3:0xf6
    v_lshrrev_b32 v30, 1, v8
    v_bitop3_b32 v28, v28, v8, v30 bitop3:0xf6
    v_lshrrev_b32 v31, 1, v9
    v_bitop3_b32 v29, v29, v9, v31 bitop3:0xf6
    v_lshrrev_b32 v30, 1, v10
    v_bitop3_b32 v28, v28, v10, v30 bitop3:0xf6
    v_lshrrev_b32 v31, 1, v11
    v_bitop3_b32 v29, v29, v11, v31 bitop3:0xf6
    v_lshrrev_b32 v30, 1, v12
    v_bitop3_b32 v28, v28, v12, v30 bitop3:0xf6
    v_lshrrev_b32 v31, 1, v13
    v_bitop3_b32 v29, v29, v13, v31 bitop3:0xf6
    v_lshrrev_b32 v30, 1, v14
    v_bitop3_b32 v28, v28, v14, v30 bitop3:0xf6
    v_lshrrev_b32 v31, 1, v15
    v_bitop3_b32 v29, v29, v15, v31 bitop3:0xf6
    v_lshrrev_b32 v30, 1, v16
    v_bitop3_b32 v28, v28, v16, v30 bitop3:0xf6
    v_lshrrev_b32 v31, 1, v17
    v_bitop3_b32 v29, v29, v17, v31 bitop3:0xf6
    v_lshrrev_b32 v30, 1, v18
    v_bitop3_b32 v28, v28, v18, v30 bitop3:0xf6
    v_lshrrev_b32 v31, 1, v19
    v_bitop3_b32 v29, v29, v19, v31 bitop3:0xf6
    v_lshrrev_b32 v30, 1, v20
    v_bitop3_b32 v28, v28, v20, v30 bitop3:0xf6
    v_lshrrev_b32 v31, 1, v21
    v_bitop3_b32 v29, v29, v21, v31 bitop3:0xf6
    v_lshrrev_b32 v30, 1, v22
    v_bitop3_b32 v28, v28, v22, v30 bitop3:0xf6
    v_lshrrev_b32 v31, 1, v23
    v_bitop3_b32 v29, v29, v23, v31 bitop3:0xf6
    v_lshrrev_b32 v30, 1, v24
    v_bitop3_b32 v28, v28, v24, v30 bitop3:0xf6
    v_lshrrev_b32 v31, 1, v25
    v_bitop3_b32 v29, v29, v25, v31 bitop3:0xf6
    v_lshrrev_b32 v30, 1, v26
    v_bitop3_b32 v28, v28, v26, v30 bitop3:0xf6
    v_lshrrev_b32 v31, 1, v27
    v_bitop3_b32 v29, v29, v27, v31 bitop3:0xf6
    s_mov_b32 s45, 0
    v_and_b32 v30, 7168, v28
    v_cmp_ne_u32 vcc, 0, v30
    s_nop 0
    s_cmp_lg_u64 vcc, 0
    s_cselect_b32 s46, 1, 0
    s_or_b32 s45, s45, s46
    v_and_b32 v30, 469762048, v28
    v_cmp_ne_u32 vcc, 0, v30
    s_nop 0
    s_cmp_lg_u64 vcc, 0
    s_cselect_b32 s46, 2, 0
    s_or_b32 s45, s45, s46
    v_and_b32 v30, 7168, v29
    v_cmp_ne_u32 vcc, 0, v30
    s_nop 0
    s_cmp_lg_u64 vcc, 0
    s_cselect_b32 s46, 4, 0
    s_or_b32 s45, s45, s46
    v_and_b32 v30, 469762048, v29
    v_cmp_ne_u32 vcc, 0, v30
    s_nop 0
    s_cmp_lg_u64 vcc, 0
    s_cselect_b32 s46, 8, 0
    s_or_b32 s45, s45, s46
    v_and_b32 v30, 2147516416, v115
    v_cmp_ne_u32 vcc, 0, v30
    s_nop 0
    s_cmp_lg_u64 vcc, 0
    s_cselect_b32 s46, 16, 0
    s_or_b32 s45, s45, s46
    v_mov_b32 v30, s45
    s_mov_b64 exec, 1
    ds_or_b32 v126, v30 offset:53768
    s_mov_b64 exec, -1
    s_waitcnt lgkmcnt(0)
    s_barrier
    ds_read_b32 v125, v126 offset:53768
    s_waitcnt lgkmcnt(0)
    v_readfirstlane_b32 s45, v125
    s_nop 0
    s_cmp_eq_u32 s45, 15
    s_cbranch_scc1 p2_done
    s_mov_b32 s21, 1
    s_waitcnt vmcnt(0)
    s_branch p2_restart
p2_finf:
    s_lshl_b32 s49, s49, 4
    s_lshl_b32 s45, s21, 3
    s_add_u32 s49, s49, s45
    s_add_u32 s49, s49, 517903352
    v_mov_b32 v28, 1073758208
    v_mov_b32 v29, 1073758208
    v_mov_b32 v30, 1073758208
    v_mov_b32 v31, 1073758208
    v_lshlrev_b32 v122, 1, v123
    v_lshlrev_b32 v125, 1, v124
    s_waitcnt lgkmcnt(0)
    buffer_store_dwordx4 v[28:31], v123, s[4:7], s44 offen
    s_add_u32 s44, s44, 16384
    buffer_store_dwordx2 v[0:1], v122, s[4:7], s49 offen offset:0
    buffer_store_dwordx2 v[2:3], v122, s[4:7], s49 offen offset:16
    s_add_u32 s49, s49, 32768
    buffer_store_dwordx4 v[28:31], v123, s[4:7], s44 offen
    s_add_u32 s44, s44, 16384
    buffer_store_dwordx2 v[4:5], v122, s[4:7], s49 offen offset:0
    buffer_store_dwordx2 v[6:7], v122, s[4:7], s49 offen offset:16
    s_add_u32 s49, s49, 32768
    buffer_store_dwordx4 v[28:31], v123, s[4:7], s44 offen
    s_add_u32 s44, s44, 16384
    buffer_store_dwordx2 v[8:9], v122, s[4:7], s49 offen offset:0
    buffer_store_dwordx2 v[10:11], v122, s[4:7], s49 offen offset:16
    s_add_u32 s49, s49, 32768
    buffer_store_dwordx4 v[28:31], v123, s[4:7], s44 offen
    s_add_u32 s44, s44, 16384
    buffer_store_dwordx2 v[12:13], v122, s[4:7], s49 offen offset:0
    buffer_store_dwordx2 v[14:15], v122, s[4:7], s49 offen offset:16
    s_add_u32 s49, s49, 32768
    buffer_store_dwordx4 v[28:31], v123, s[4:7], s44 offen
    s_add_u32 s44, s44, 16384
    buffer_store_dwordx2 v[16:17], v122, s[4:7], s49 offen offset:0
    buffer_store_dwordx2 v[18:19], v122, s[4:7], s49 offen offset:16
    s_add_u32 s49, s49, 32768
    buffer_store_dwordx4 v[28:31], v123, s[4:7], s44 offen
    s_add_u32 s44, s44, 16384
    buffer_store_dwordx2 v[20:21], v122, s[4:7], s49 offen offset:0
    buffer_store_dwordx2 v[22:23], v122, s[4:7], s49 offen offset:16
    s_add_u32 s49, s49, 32768
    buffer_store_dwordx4 v[28:31], v124, s[4:7], s44 offen
    s_add_u32 s44, s44, 16384
    buffer_store_dwordx2 v[24:25], v125, s[4:7], s49 offen offset:0
    buffer_store_dwordx2 v[26:27], v125, s[4:7], s49 offen offset:16
    s_add_u32 s49, s49, 32768
    s_add_u32 s21, s21, 1
    s_mov_b32 s30, 0
    s_waitcnt vmcnt(0)
    s_cmp_eq_u32 s21, 2
    s_cbranch_scc1 p2_restart
p2_done:
    v_mov_b32 v125, s30
    buffer_store_dword v125, v126, s[4:7], s48 offen
p2_end:
    s_endpgm
.globl p3_kernel
.p2align 8
.type p3_kernel,@function
p3_kernel:
    s_cmp_ge_u32 s2, 1563
    s_cbranch_scc1 p3_end
    s_load_dwordx2 s[4:5], s[0:1], 0
    s_load_dwordx2 s[6:7], s[0:1], 24
    s_load_dwordx2 s[8:9], s[0:1], 40
    s_load_dwordx8 s[12:19], s[0:1], 56
    s_load_dwordx2 s[10:11], s[0:1], 88
    s_load_dwordx2 s[20:21], s[0:1], 104
    s_lshl_b32 s3, s2, 8
    v_add_u32 v0, s3, v0
    v_lshlrev_b32 v2, 4, v0
    v_lshlrev_b32 v3, 2, v0
    v_add_u32 v0, v0, v0
    v_mul_hi_u32_u24 v1, 343268, v0
    v_lshlrev_b16 v1, 4, v1
    s_waitcnt lgkmcnt(0)
    s_load_dwordx4 s[32:35], s[8:9], 0
    s_load_dwordx16 s[36:51], s[12:13], 0
    s_load_dwordx16 s[52:67], s[14:15], 0
    s_load_dwordx8 s[68:75], s[16:17], 0
    s_load_dwordx8 s[76:83], s[18:19], 0
    s_mov_b32 s24, s6
    s_and_b32 s25, s7, 0xffff
    s_mov_b32 s26, 1600000
    s_mov_b32 s27, 0x20000
    buffer_load_dword v4, v3, s[24:27], 0 offen nt
    s_mov_b32 s28, s20
    s_and_b32 s29, s21, 0xffff
    s_mov_b32 s30, 819200000
    s_mov_b32 s31, 0x20000
    s_mov_b32 s22, 492278784
    buffer_load_dwordx4 v[40:43], v2, s[28:31], s22 offen nt
    s_mov_b32 s22, 498684928
    buffer_load_dwordx4 v[44:47], v2, s[28:31], s22 offen nt
    s_mov_b32 s22, 505091072
    buffer_load_dwordx4 v[48:51], v2, s[28:31], s22 offen nt
    s_mov_b32 s22, 511497216
    buffer_load_dwordx4 v[52:55], v2, s[28:31], s22 offen nt
    s_mov_b32 s22, 492277760
    buffer_load_dwordx4 v[56:59], v1, s[28:31], s22 offen
    s_mov_b32 s24, s4
    s_and_b32 s25, s5, 0xffff
    s_mov_b32 s26, 6400000
    s_mov_b32 s27, 0x20000
    buffer_load_dwordx4 v[60:63], v2, s[24:27], 0 offen nt
    s_mov_b32 s24, s10
    s_and_b32 s25, s11, 0xffff
    s_mov_b32 s26, 6400000
    s_mov_b32 s27, 0x20000
    s_waitcnt vmcnt(6) lgkmcnt(0)
    v_and_b32 v5, 0xffff0000, v4
    v_lshlrev_b32 v4, 16, v4
    s_lshl_b32 s14, s32, 16
    s_and_b32 s15, s32, 0xffff0000
    v_pk_add_f32 v[8:9], v[4:5], s[14:15] op_sel:[0,0] op_sel_hi:[0,1] neg_lo:[0,1] neg_hi:[0,1]
    v_pk_add_f32 v[16:17], v[4:5], s[14:15] op_sel:[1,0] op_sel_hi:[1,1] neg_lo:[0,1] neg_hi:[0,1]
    s_lshl_b32 s16, s33, 16
    s_and_b32 s17, s33, 0xffff0000
    v_pk_add_f32 v[10:11], v[4:5], s[16:17] op_sel:[0,0] op_sel_hi:[0,1] neg_lo:[0,1] neg_hi:[0,1]
    v_pk_add_f32 v[18:19], v[4:5], s[16:17] op_sel:[1,0] op_sel_hi:[1,1] neg_lo:[0,1] neg_hi:[0,1]
    s_lshl_b32 s18, s34, 16
    s_and_b32 s19, s34, 0xffff0000
    v_pk_add_f32 v[12:13], v[4:5], s[18:19] op_sel:[0,0] op_sel_hi:[0,1] neg_lo:[0,1] neg_hi:[0,1]
    v_pk_add_f32 v[20:21], v[4:5], s[18:19] op_sel:[1,0] op_sel_hi:[1,1] neg_lo:[0,1] neg_hi:[0,1]
    s_lshl_b32 s12, s35, 16
    s_and_b32 s13, s35, 0xffff0000
    v_pk_add_f32 v[14:15], v[4:5], s[12:13] op_sel:[0,0] op_sel_hi:[0,1] neg_lo:[0,1] neg_hi:[0,1]
    v_pk_add_f32 v[22:23], v[4:5], s[12:13] op_sel:[1,0] op_sel_hi:[1,1] neg_lo:[0,1] neg_hi:[0,1]
    v_cvt_pk_bf16_f32 v8, v8, v9
    v_cvt_pk_bf16_f32 v10, v10, v11
    v_cvt_pk_bf16_f32 v12, v12, v13
    v_cvt_pk_bf16_f32 v14, v14, v15
    v_cvt_pk_bf16_f32 v16, v16, v17
    v_cvt_pk_bf16_f32 v18, v18, v19
    v_cvt_pk_bf16_f32 v20, v20, v21
    v_cvt_pk_bf16_f32 v22, v22, v23
    v_and_b32 v9, 0xffff0000, v8
    v_lshlrev_b32 v8, 16, v8
    v_and_b32 v11, 0xffff0000, v10
    v_lshlrev_b32 v10, 16, v10
    v_and_b32 v13, 0xffff0000, v12
    v_lshlrev_b32 v12, 16, v12
    v_and_b32 v15, 0xffff0000, v14
    v_lshlrev_b32 v14, 16, v14
    v_and_b32 v17, 0xffff0000, v16
    v_lshlrev_b32 v16, 16, v16
    v_and_b32 v19, 0xffff0000, v18
    v_lshlrev_b32 v18, 16, v18
    v_and_b32 v21, 0xffff0000, v20
    v_lshlrev_b32 v20, 16, v20
    v_and_b32 v23, 0xffff0000, v22
    v_lshlrev_b32 v22, 16, v22
    v_mul_f32 v8, v8, v8
    v_mul_f32 v9, v9, v9
    v_mul_f32 v10, v10, v10
    v_mul_f32 v11, v11, v11
    v_mul_f32 v12, v12, v12
    v_mul_f32 v13, v13, v13
    v_mul_f32 v14, v14, v14
    v_mul_f32 v15, v15, v15
    v_mul_f32 v16, v16, v16
    v_mul_f32 v17, v17, v17
    v_mul_f32 v18, v18, v18
    v_mul_f32 v19, v19, v19
    v_mul_f32 v20, v20, v20
    v_mul_f32 v21, v21, v21
    v_mul_f32 v22, v22, v22
    v_mul_f32 v23, v23, v23
    v_cvt_pk_bf16_f32 v8, v8, v9
    v_cvt_pk_bf16_f32 v10, v10, v11
    v_cvt_pk_bf16_f32 v12, v12, v13
    v_cvt_pk_bf16_f32 v14, v14, v15
    v_cvt_pk_bf16_f32 v16, v16, v17
    v_cvt_pk_bf16_f32 v18, v18, v19
    v_cvt_pk_bf16_f32 v20, v20, v21
    v_cvt_pk_bf16_f32 v22, v22, v23
    v_and_b32 v9, 0xffff0000, v8
    v_lshlrev_b32 v8, 16, v8
    v_and_b32 v11, 0xffff0000, v10
    v_lshlrev_b32 v10, 16, v10
    v_and_b32 v13, 0xffff0000, v12
    v_lshlrev_b32 v12, 16, v12
    v_and_b32 v15, 0xffff0000, v14
    v_lshlrev_b32 v14, 16, v14
    v_and_b32 v17, 0xffff0000, v16
    v_lshlrev_b32 v16, 16, v16
    v_and_b32 v19, 0xffff0000, v18
    v_lshlrev_b32 v18, 16, v18
    v_and_b32 v21, 0xffff0000, v20
    v_lshlrev_b32 v20, 16, v20
    v_and_b32 v23, 0xffff0000, v22
    v_lshlrev_b32 v22, 16, v22
    v_mul_f32 v8, 0xc1200000, v8
    v_mul_f32 v9, 0xc1200000, v9
    v_mul_f32 v10, 0xc1200000, v10
    v_mul_f32 v11, 0xc1200000, v11
    v_mul_f32 v12, 0xc1200000, v12
    v_mul_f32 v13, 0xc1200000, v13
    v_mul_f32 v14, 0xc1200000, v14
    v_mul_f32 v15, 0xc1200000, v15
    v_mul_f32 v16, 0xc1200000, v16
    v_mul_f32 v17, 0xc1200000, v17
    v_mul_f32 v18, 0xc1200000, v18
    v_mul_f32 v19, 0xc1200000, v19
    v_mul_f32 v20, 0xc1200000, v20
    v_mul_f32 v21, 0xc1200000, v21
    v_mul_f32 v22, 0xc1200000, v22
    v_mul_f32 v23, 0xc1200000, v23
    v_cvt_pk_bf16_f32 v8, v8, v9
    v_cvt_pk_bf16_f32 v10, v10, v11
    v_cvt_pk_bf16_f32 v12, v12, v13
    v_cvt_pk_bf16_f32 v14, v14, v15
    v_cvt_pk_bf16_f32 v16, v16, v17
    v_cvt_pk_bf16_f32 v18, v18, v19
    v_cvt_pk_bf16_f32 v20, v20, v21
    v_cvt_pk_bf16_f32 v22, v22, v23
    v_and_b32 v9, 0xffff0000, v8
    v_lshlrev_b32 v8, 16, v8
    v_and_b32 v11, 0xffff0000, v10
    v_lshlrev_b32 v10, 16, v10
    v_and_b32 v13, 0xffff0000, v12
    v_lshlrev_b32 v12, 16, v12
    v_and_b32 v15, 0xffff0000, v14
    v_lshlrev_b32 v14, 16, v14
    v_and_b32 v17, 0xffff0000, v16
    v_lshlrev_b32 v16, 16, v16
    v_and_b32 v19, 0xffff0000, v18
    v_lshlrev_b32 v18, 16, v18
    v_and_b32 v21, 0xffff0000, v20
    v_lshlrev_b32 v20, 16, v20
    v_and_b32 v23, 0xffff0000, v22
    v_lshlrev_b32 v22, 16, v22
    v_mul_f32 v8, 0x3fb8aa3b, v8
    v_mul_f32 v9, 0x3fb8aa3b, v9
    v_mul_f32 v10, 0x3fb8aa3b, v10
    v_mul_f32 v11, 0x3fb8aa3b, v11
    v_mul_f32 v12, 0x3fb8aa3b, v12
    v_mul_f32 v13, 0x3fb8aa3b, v13
    v_mul_f32 v14, 0x3fb8aa3b, v14
    v_mul_f32 v15, 0x3fb8aa3b, v15
    v_mul_f32 v16, 0x3fb8aa3b, v16
    v_mul_f32 v17, 0x3fb8aa3b, v17
    v_mul_f32 v18, 0x3fb8aa3b, v18
    v_mul_f32 v19, 0x3fb8aa3b, v19
    v_mul_f32 v20, 0x3fb8aa3b, v20
    v_mul_f32 v21, 0x3fb8aa3b, v21
    v_mul_f32 v22, 0x3fb8aa3b, v22
    v_mul_f32 v23, 0x3fb8aa3b, v23
    v_exp_f32 v8, v8
    v_exp_f32 v9, v9
    v_exp_f32 v10, v10
    v_exp_f32 v11, v11
    v_exp_f32 v12, v12
    v_exp_f32 v13, v13
    v_exp_f32 v14, v14
    v_exp_f32 v15, v15
    v_exp_f32 v16, v16
    v_exp_f32 v17, v17
    v_exp_f32 v18, v18
    v_exp_f32 v19, v19
    v_exp_f32 v20, v20
    v_exp_f32 v21, v21
    v_exp_f32 v22, v22
    v_exp_f32 v23, v23
    s_nop 0
    v_cvt_pk_bf16_f32 v8, v8, v9
    v_cvt_pk_bf16_f32 v10, v10, v11
    v_cvt_pk_bf16_f32 v12, v12, v13
    v_cvt_pk_bf16_f32 v14, v14, v15
    v_cvt_pk_bf16_f32 v16, v16, v17
    v_cvt_pk_bf16_f32 v18, v18, v19
    v_cvt_pk_bf16_f32 v20, v20, v21
    v_cvt_pk_bf16_f32 v22, v22, v23
    v_and_b32 v9, 0xffff0000, v8
    v_lshlrev_b32 v8, 16, v8
    v_and_b32 v11, 0xffff0000, v10
    v_lshlrev_b32 v10, 16, v10
    v_and_b32 v13, 0xffff0000, v12
    v_lshlrev_b32 v12, 16, v12
    v_and_b32 v15, 0xffff0000, v14
    v_lshlrev_b32 v14, 16, v14
    v_and_b32 v17, 0xffff0000, v16
    v_lshlrev_b32 v16, 16, v16
    v_and_b32 v19, 0xffff0000, v18
    v_lshlrev_b32 v18, 16, v18
    v_and_b32 v21, 0xffff0000, v20
    v_lshlrev_b32 v20, 16, v20
    v_and_b32 v23, 0xffff0000, v22
    v_lshlrev_b32 v22, 16, v22
    s_lshl_b32 s14, s52, 16
    s_and_b32 s15, s52, 0xffff0000
    v_pk_mul_f32 v[24:25], v[8:9], s[14:15] op_sel:[0,0] op_sel_hi:[0,1]
    v_pk_mul_f32 v[28:29], v[16:17], s[14:15] op_sel:[0,0] op_sel_hi:[0,1]
    s_lshl_b32 s16, s53, 16
    s_and_b32 s17, s53, 0xffff0000
    v_pk_mul_f32 v[26:27], v[8:9], s[16:17] op_sel:[0,0] op_sel_hi:[0,1]
    v_pk_mul_f32 v[30:31], v[16:17], s[16:17] op_sel:[0,0] op_sel_hi:[0,1]
    s_lshl_b32 s18, s54, 16
    s_and_b32 s19, s54, 0xffff0000
    v_pk_fma_f32 v[24:25], v[8:9], s[18:19], v[24:25] op_sel:[1,0,0] op_sel_hi:[1,1,1]
    v_pk_fma_f32 v[28:29], v[16:17], s[18:19], v[28:29] op_sel:[1,0,0] op_sel_hi:[1,1,1]
    s_lshl_b32 s12, s55, 16
    s_and_b32 s13, s55, 0xffff0000
    v_pk_fma_f32 v[26:27], v[8:9], s[12:13], v[26:27] op_sel:[1,0,0] op_sel_hi:[1,1,1]
    v_pk_fma_f32 v[30:31], v[16:17], s[12:13], v[30:31] op_sel:[1,0,0] op_sel_hi:[1,1,1]
    s_lshl_b32 s14, s56, 16
    s_and_b32 s15, s56, 0xffff0000
    v_pk_fma_f32 v[24:25], v[10:11], s[14:15], v[24:25] op_sel:[0,0,0] op_sel_hi:[0,1,1]
    v_pk_fma_f32 v[28:29], v[18:19], s[14:15], v[28:29] op_sel:[0,0,0] op_sel_hi:[0,1,1]
    s_lshl_b32 s16, s57, 16
    s_and_b32 s17, s57, 0xffff0000
    v_pk_fma_f32 v[26:27], v[10:11], s[16:17], v[26:27] op_sel:[0,0,0] op_sel_hi:[0,1,1]
    v_pk_fma_f32 v[30:31], v[18:19], s[16:17], v[30:31] op_sel:[0,0,0] op_sel_hi:[0,1,1]
    s_lshl_b32 s18, s58, 16
    s_and_b32 s19, s58, 0xffff0000
    v_pk_fma_f32 v[24:25], v[10:11], s[18:19], v[24:25] op_sel:[1,0,0] op_sel_hi:[1,1,1]
    v_pk_fma_f32 v[28:29], v[18:19], s[18:19], v[28:29] op_sel:[1,0,0] op_sel_hi:[1,1,1]
    s_lshl_b32 s12, s59, 16
    s_and_b32 s13, s59, 0xffff0000
    v_pk_fma_f32 v[26:27], v[10:11], s[12:13], v[26:27] op_sel:[1,0,0] op_sel_hi:[1,1,1]
    v_pk_fma_f32 v[30:31], v[18:19], s[12:13], v[30:31] op_sel:[1,0,0] op_sel_hi:[1,1,1]
    s_lshl_b32 s14, s60, 16
    s_and_b32 s15, s60, 0xffff0000
    v_pk_fma_f32 v[24:25], v[12:13], s[14:15], v[24:25] op_sel:[0,0,0] op_sel_hi:[0,1,1]
    v_pk_fma_f32 v[28:29], v[20:21], s[14:15], v[28:29] op_sel:[0,0,0] op_sel_hi:[0,1,1]
    s_lshl_b32 s16, s61, 16
    s_and_b32 s17, s61, 0xffff0000
    v_pk_fma_f32 v[26:27], v[12:13], s[16:17], v[26:27] op_sel:[0,0,0] op_sel_hi:[0,1,1]
    v_pk_fma_f32 v[30:31], v[20:21], s[16:17], v[30:31] op_sel:[0,0,0] op_sel_hi:[0,1,1]
    s_lshl_b32 s18, s62, 16
    s_and_b32 s19, s62, 0xffff0000
    v_pk_fma_f32 v[24:25], v[12:13], s[18:19], v[24:25] op_sel:[1,0,0] op_sel_hi:[1,1,1]
    v_pk_fma_f32 v[28:29], v[20:21], s[18:19], v[28:29] op_sel:[1,0,0] op_sel_hi:[1,1,1]
    s_lshl_b32 s12, s63, 16
    s_and_b32 s13, s63, 0xffff0000
    v_pk_fma_f32 v[26:27], v[12:13], s[12:13], v[26:27] op_sel:[1,0,0] op_sel_hi:[1,1,1]
    v_pk_fma_f32 v[30:31], v[20:21], s[12:13], v[30:31] op_sel:[1,0,0] op_sel_hi:[1,1,1]
    s_lshl_b32 s14, s64, 16
    s_and_b32 s15, s64, 0xffff0000
    v_pk_fma_f32 v[24:25], v[14:15], s[14:15], v[24:25] op_sel:[0,0,0] op_sel_hi:[0,1,1]
    v_pk_fma_f32 v[28:29], v[22:23], s[14:15], v[28:29] op_sel:[0,0,0] op_sel_hi:[0,1,1]
    s_lshl_b32 s16, s65, 16
    s_and_b32 s17, s65, 0xffff0000
    v_pk_fma_f32 v[26:27], v[14:15], s[16:17], v[26:27] op_sel:[0,0,0] op_sel_hi:[0,1,1]
    v_pk_fma_f32 v[30:31], v[22:23], s[16:17], v[30:31] op_sel:[0,0,0] op_sel_hi:[0,1,1]
    s_lshl_b32 s18, s66, 16
    s_and_b32 s19, s66, 0xffff0000
    v_pk_fma_f32 v[24:25], v[14:15], s[18:19], v[24:25] op_sel:[1,0,0] op_sel_hi:[1,1,1]
    v_pk_fma_f32 v[28:29], v[22:23], s[18:19], v[28:29] op_sel:[1,0,0] op_sel_hi:[1,1,1]
    s_lshl_b32 s12, s67, 16
    s_and_b32 s13, s67, 0xffff0000
    v_pk_fma_f32 v[26:27], v[14:15], s[12:13], v[26:27] op_sel:[1,0,0] op_sel_hi:[1,1,1]
    v_pk_fma_f32 v[30:31], v[22:23], s[12:13], v[30:31] op_sel:[1,0,0] op_sel_hi:[1,1,1]
    s_lshl_b32 s14, s36, 16
    s_and_b32 s15, s36, 0xffff0000
    v_pk_mul_f32 v[32:33], v[8:9], s[14:15] op_sel:[0,0] op_sel_hi:[0,1]
    v_pk_mul_f32 v[36:37], v[16:17], s[14:15] op_sel:[0,0] op_sel_hi:[0,1]
    s_lshl_b32 s16, s37, 16
    s_and_b32 s17, s37, 0xffff0000
    v_pk_mul_f32 v[34:35], v[8:9], s[16:17] op_sel:[0,0] op_sel_hi:[0,1]
    v_pk_mul_f32 v[38:39], v[16:17], s[16:17] op_sel:[0,0] op_sel_hi:[0,1]
    s_lshl_b32 s18, s38, 16
    s_and_b32 s19, s38, 0xffff0000
    v_pk_fma_f32 v[32:33], v[8:9], s[18:19], v[32:33] op_sel:[1,0,0] op_sel_hi:[1,1,1]
    v_pk_fma_f32 v[36:37], v[16:17], s[18:19], v[36:37] op_sel:[1,0,0] op_sel_hi:[1,1,1]
    s_lshl_b32 s12, s39, 16
    s_and_b32 s13, s39, 0xffff0000
    v_pk_fma_f32 v[34:35], v[8:9], s[12:13], v[34:35] op_sel:[1,0,0] op_sel_hi:[1,1,1]
    v_pk_fma_f32 v[38:39], v[16:17], s[12:13], v[38:39] op_sel:[1,0,0] op_sel_hi:[1,1,1]
    s_lshl_b32 s14, s40, 16
    s_and_b32 s15, s40, 0xffff0000
    v_pk_fma_f32 v[32:33], v[10:11], s[14:15], v[32:33] op_sel:[0,0,0] op_sel_hi:[0,1,1]
    v_pk_fma_f32 v[36:37], v[18:19], s[14:15], v[36:37] op_sel:[0,0,0] op_sel_hi:[0,1,1]
    s_lshl_b32 s16, s41, 16
    s_and_b32 s17, s41, 0xffff0000
    v_pk_fma_f32 v[34:35], v[10:11], s[16:17], v[34:35] op_sel:[0,0,0] op_sel_hi:[0,1,1]
    v_pk_fma_f32 v[38:39], v[18:19], s[16:17], v[38:39] op_sel:[0,0,0] op_sel_hi:[0,1,1]
    s_lshl_b32 s18, s42, 16
    s_and_b32 s19, s42, 0xffff0000
    v_pk_fma_f32 v[32:33], v[10:11], s[18:19], v[32:33] op_sel:[1,0,0] op_sel_hi:[1,1,1]
    v_pk_fma_f32 v[36:37], v[18:19], s[18:19], v[36:37] op_sel:[1,0,0] op_sel_hi:[1,1,1]
    s_lshl_b32 s12, s43, 16
    s_and_b32 s13, s43, 0xffff0000
    v_pk_fma_f32 v[34:35], v[10:11], s[12:13], v[34:35] op_sel:[1,0,0] op_sel_hi:[1,1,1]
    v_pk_fma_f32 v[38:39], v[18:19], s[12:13], v[38:39] op_sel:[1,0,0] op_sel_hi:[1,1,1]
    s_lshl_b32 s14, s44, 16
    s_and_b32 s15, s44, 0xffff0000
    v_pk_fma_f32 v[32:33], v[12:13], s[14:15], v[32:33] op_sel:[0,0,0] op_sel_hi:[0,1,1]
    v_pk_fma_f32 v[36:37], v[20:21], s[14:15], v[36:37] op_sel:[0,0,0] op_sel_hi:[0,1,1]
    s_lshl_b32 s16, s45, 16
    s_and_b32 s17, s45, 0xffff0000
    v_pk_fma_f32 v[34:35], v[12:13], s[16:17], v[34:35] op_sel:[0,0,0] op_sel_hi:[0,1,1]
    v_pk_fma_f32 v[38:39], v[20:21], s[16:17], v[38:39] op_sel:[0,0,0] op_sel_hi:[0,1,1]
    s_lshl_b32 s18, s46, 16
    s_and_b32 s19, s46, 0xffff0000
    v_pk_fma_f32 v[32:33], v[12:13], s[18:19], v[32:33] op_sel:[1,0,0] op_sel_hi:[1,1,1]
    v_pk_fma_f32 v[36:37], v[20:21], s[18:19], v[36:37] op_sel:[1,0,0] op_sel_hi:[1,1,1]
    s_lshl_b32 s12, s47, 16
    s_and_b32 s13, s47, 0xffff0000
    v_pk_fma_f32 v[34:35], v[12:13], s[12:13], v[34:35] op_sel:[1,0,0] op_sel_hi:[1,1,1]
    v_pk_fma_f32 v[38:39], v[20:21], s[12:13], v[38:39] op_sel:[1,0,0] op_sel_hi:[1,1,1]
    s_lshl_b32 s14, s48, 16
    s_and_b32 s15, s48, 0xffff0000
    v_pk_fma_f32 v[32:33], v[14:15], s[14:15], v[32:33] op_sel:[0,0,0] op_sel_hi:[0,1,1]
    v_pk_fma_f32 v[36:37], v[22:23], s[14:15], v[36:37] op_sel:[0,0,0] op_sel_hi:[0,1,1]
    s_lshl_b32 s16, s49, 16
    s_and_b32 s17, s49, 0xffff0000
    v_pk_fma_f32 v[34:35], v[14:15], s[16:17], v[34:35] op_sel:[0,0,0] op_sel_hi:[0,1,1]
    v_pk_fma_f32 v[38:39], v[22:23], s[16:17], v[38:39] op_sel:[0,0,0] op_sel_hi:[0,1,1]
    s_lshl_b32 s18, s50, 16
    s_and_b32 s19, s50, 0xffff0000
    v_pk_fma_f32 v[32:33], v[14:15], s[18:19], v[32:33] op_sel:[1,0,0] op_sel_hi:[1,1,1]
    v_pk_fma_f32 v[36:37], v[22:23], s[18:19], v[36:37] op_sel:[1,0,0] op_sel_hi:[1,1,1]
    s_lshl_b32 s12, s51, 16
    s_and_b32 s13, s51, 0xffff0000
    v_pk_fma_f32 v[34:35], v[14:15], s[12:13], v[34:35] op_sel:[1,0,0] op_sel_hi:[1,1,1]
    v_pk_fma_f32 v[38:39], v[22:23], s[12:13], v[38:39] op_sel:[1,0,0] op_sel_hi:[1,1,1]
    v_cvt_pk_bf16_f32 v32, v32, v33
    v_cvt_pk_bf16_f32 v34, v34, v35
    v_cvt_pk_bf16_f32 v36, v36, v37
    v_cvt_pk_bf16_f32 v38, v38, v39
    v_and_b32 v33, 0xffff0000, v32
    v_lshlrev_b32 v32, 16, v32
    v_and_b32 v35, 0xffff0000, v34
    v_lshlrev_b32 v34, 16, v34
    v_and_b32 v37, 0xffff0000, v36
    v_lshlrev_b32 v36, 16, v36
    v_and_b32 v39, 0xffff0000, v38
    v_lshlrev_b32 v38, 16, v38
    s_waitcnt vmcnt(1)
    v_add_u32 v40, v40, v44
    v_add_u32 v48, v48, v52
    v_add_u32 v41, v41, v45
    v_add_u32 v49, v49, v53
    v_add_u32 v42, v42, v46
    v_add_u32 v50, v50, v54
    v_add_u32 v43, v43, v47
    v_add_u32 v51, v51, v55
    v_add_u32_sdwa v8, v40, v48 dst_sel:DWORD dst_unused:UNUSED_PAD src0_sel:WORD_0 src1_sel:WORD_0
    v_add_u32_sdwa v9, v40, v48 dst_sel:DWORD dst_unused:UNUSED_PAD src0_sel:WORD_1 src1_sel:WORD_1
    v_add_u32_sdwa v10, v41, v49 dst_sel:DWORD dst_unused:UNUSED_PAD src0_sel:WORD_0 src1_sel:WORD_0
    v_add_u32_sdwa v11, v41, v49 dst_sel:DWORD dst_unused:UNUSED_PAD src0_sel:WORD_1 src1_sel:WORD_1
    v_add_u32_sdwa v12, v42, v50 dst_sel:DWORD dst_unused:UNUSED_PAD src0_sel:WORD_0 src1_sel:WORD_0
    v_add_u32_sdwa v13, v42, v50 dst_sel:DWORD dst_unused:UNUSED_PAD src0_sel:WORD_1 src1_sel:WORD_1
    v_add_u32_sdwa v14, v43, v51 dst_sel:DWORD dst_unused:UNUSED_PAD src0_sel:WORD_0 src1_sel:WORD_0
    v_add_u32_sdwa v15, v43, v51 dst_sel:DWORD dst_unused:UNUSED_PAD src0_sel:WORD_1 src1_sel:WORD_1
    v_min3_u32 v5, v56, v57, v58
    v_bitop3_b32 v4, v56, v57, v58 bitop3:0xfe
    v_min_u32 v5, v5, v59
    v_or_b32 v4, v4, v59
    v_or_b32 v8, 0x4b000000, v8
    v_or_b32 v9, 0x4b000000, v9
    v_or_b32 v10, 0x4b000000, v10
    v_or_b32 v11, 0x4b000000, v11
    v_or_b32 v12, 0x4b000000, v12
    v_or_b32 v13, 0x4b000000, v13
    v_or_b32 v14, 0x4b000000, v14
    v_or_b32 v15, 0x4b000000, v15
    v_cmp_eq_u32 vcc, 0, v5
    v_add_f32 v8, 0xcb010000, v8
    v_add_f32 v9, 0xcb010000, v9
    v_add_f32 v10, 0xcb010000, v10
    v_add_f32 v11, 0xcb010000, v11
    v_add_f32 v12, 0xcb010000, v12
    v_add_f32 v13, 0xcb010000, v13
    v_add_f32 v14, 0xcb010000, v14
    v_add_f32 v15, 0xcb010000, v15
    v_mul_f32 v8, v4, v8
    v_mul_f32 v9, v4, v9
    v_mul_f32 v10, v4, v10
    v_mul_f32 v11, v4, v11
    v_mul_f32 v12, v4, v12
    v_mul_f32 v13, v4, v13
    v_mul_f32 v14, v4, v14
    v_mul_f32 v15, v4, v15
    s_cbranch_vccz p3_nof
    v_lshlrev_b32 v1, 4, v0
    v_mov_b32 v3, 0x70000000
    v_cmp_eq_u32 vcc, 0, v56
    s_mov_b32 s22, 517903360
    s_nop 0
    v_cndmask_b32 v5, v3, v1, vcc
    buffer_load_dwordx4 v[16:19], v5, s[28:31], s22 offen
    buffer_load_dwordx4 v[20:23], v5, s[28:31], s22 offen offset:16
    s_waitcnt vmcnt(0)
    v_add_f32 v8, v8, v16
    v_add_f32 v9, v9, v17
    v_add_f32 v10, v10, v18
    v_add_f32 v11, v11, v19
    v_add_f32 v12, v12, v20
    v_add_f32 v13, v13, v21
    v_add_f32 v14, v14, v22
    v_add_f32 v15, v15, v23
    v_cmp_eq_u32 vcc, 0, v57
    s_mov_b32 s22, 530715648
    s_nop 0
    v_cndmask_b32 v5, v3, v1, vcc
    buffer_load_dwordx4 v[16:19], v5, s[28:31], s22 offen
    buffer_load_dwordx4 v[20:23], v5, s[28:31], s22 offen offset:16
    s_waitcnt vmcnt(0)
    v_add_f32 v8, v8, v16
    v_add_f32 v9, v9, v17
    v_add_f32 v10, v10, v18
    v_add_f32 v11, v11, v19
    v_add_f32 v12, v12, v20
    v_add_f32 v13, v13, v21
    v_add_f32 v14, v14, v22
    v_add_f32 v15, v15, v23
    v_cmp_eq_u32 vcc, 0, v58
    s_mov_b32 s22, 543527936
    s_nop 0
    v_cndmask_b32 v5, v3, v1, vcc
    buffer_load_dwordx4 v[16:19], v5, s[28:31], s22 offen
    buffer_load_dwordx4 v[20:23], v5, s[28:31], s22 offen offset:16
    s_waitcnt vmcnt(0)
    v_add_f32 v8, v8, v16
    v_add_f32 v9, v9, v17
    v_add_f32 v10, v10, v18
    v_add_f32 v11, v11, v19
    v_add_f32 v12, v12, v20
    v_add_f32 v13, v13, v21
    v_add_f32 v14, v14, v22
    v_add_f32 v15, v15, v23
    v_cmp_eq_u32 vcc, 0, v59
    s_mov_b32 s22, 556340224
    s_nop 0
    v_cndmask_b32 v5, v3, v1, vcc
    buffer_load_dwordx4 v[16:19], v5, s[28:31], s22 offen
    buffer_load_dwordx4 v[20:23], v5, s[28:31], s22 offen offset:16
    s_waitcnt vmcnt(0)
    v_add_f32 v8, v8, v16
    v_add_f32 v9, v9, v17
    v_add_f32 v10, v10, v18
    v_add_f32 v11, v11, v19
    v_add_f32 v12, v12, v20
    v_add_f32 v13, v13, v21
    v_add_f32 v14, v14, v22
    v_add_f32 v15, v15, v23
p3_nof:
    s_lshl_b32 s14, s68, 16
    s_and_b32 s15, s68, 0xffff0000
    v_pk_mul_f32 v[16:17], v[8:9], s[14:15] op_sel:[0,0] op_sel_hi:[0,1]
    v_pk_mul_f32 v[20:21], v[12:13], s[14:15] op_sel:[0,0] op_sel_hi:[0,1]
    s_lshl_b32 s16, s69, 16
    s_and_b32 s17, s69, 0xffff0000
    v_pk_mul_f32 v[18:19], v[8:9], s[16:17] op_sel:[0,0] op_sel_hi:[0,1]
    v_pk_mul_f32 v[22:23], v[12:13], s[16:17] op_sel:[0,0] op_sel_hi:[0,1]
    s_lshl_b32 s18, s70, 16
    s_and_b32 s19, s70, 0xffff0000
    v_pk_fma_f32 v[16:17], v[8:9], s[18:19], v[16:17] op_sel:[1,0,0] op_sel_hi:[1,1,1]
    v_pk_fma_f32 v[20:21], v[12:13], s[18:19], v[20:21] op_sel:[1,0,0] op_sel_hi:[1,1,1]
    s_lshl_b32 s12, s71, 16
    s_and_b32 s13, s71, 0xffff0000
    v_pk_fma_f32 v[18:19], v[8:9], s[12:13], v[18:19] op_sel:[1,0,0] op_sel_hi:[1,1,1]
    v_pk_fma_f32 v[22:23], v[12:13], s[12:13], v[22:23] op_sel:[1,0,0] op_sel_hi:[1,1,1]
    s_lshl_b32 s14, s72, 16
    s_and_b32 s15, s72, 0xffff0000
    v_pk_fma_f32 v[16:17], v[10:11], s[14:15], v[16:17] op_sel:[0,0,0] op_sel_hi:[0,1,1]
    v_pk_fma_f32 v[20:21], v[14:15], s[14:15], v[20:21] op_sel:[0,0,0] op_sel_hi:[0,1,1]
    s_lshl_b32 s16, s73, 16
    s_and_b32 s17, s73, 0xffff0000
    v_pk_fma_f32 v[18:19], v[10:11], s[16:17], v[18:19] op_sel:[0,0,0] op_sel_hi:[0,1,1]
    v_pk_fma_f32 v[22:23], v[14:15], s[16:17], v[22:23] op_sel:[0,0,0] op_sel_hi:[0,1,1]
    s_lshl_b32 s18, s74, 16
    s_and_b32 s19, s74, 0xffff0000
    v_pk_fma_f32 v[16:17], v[10:11], s[18:19], v[16:17] op_sel:[1,0,0] op_sel_hi:[1,1,1]
    v_pk_fma_f32 v[20:21], v[14:15], s[18:19], v[20:21] op_sel:[1,0,0] op_sel_hi:[1,1,1]
    s_lshl_b32 s12, s75, 16
    s_and_b32 s13, s75, 0xffff0000
    v_pk_fma_f32 v[18:19], v[10:11], s[12:13], v[18:19] op_sel:[1,0,0] op_sel_hi:[1,1,1]
    v_pk_fma_f32 v[22:23], v[14:15], s[12:13], v[22:23] op_sel:[1,0,0] op_sel_hi:[1,1,1]
    v_mul_f32 v24, v24, v16
    v_mul_f32 v25, v25, v17
    v_mul_f32 v26, v26, v18
    v_mul_f32 v27, v27, v19
    v_mul_f32 v28, v28, v20
    v_mul_f32 v29, v29, v21
    v_mul_f32 v30, v30, v22
    v_mul_f32 v31, v31, v23
    v_cvt_pk_bf16_f32 v24, v24, v25
    v_cvt_pk_bf16_f32 v26, v26, v27
    v_cvt_pk_bf16_f32 v28, v28, v29
    v_cvt_pk_bf16_f32 v30, v30, v31
    v_and_b32 v25, 0xffff0000, v24
    v_lshlrev_b32 v24, 16, v24
    v_and_b32 v27, 0xffff0000, v26
    v_lshlrev_b32 v26, 16, v26
    v_and_b32 v29, 0xffff0000, v28
    v_lshlrev_b32 v28, 16, v28
    v_and_b32 v31, 0xffff0000, v30
    v_lshlrev_b32 v30, 16, v30
    s_lshl_b32 s14, s76, 16
    s_and_b32 s15, s76, 0xffff0000
    v_pk_mul_f32 v[16:17], v[24:25], s[14:15] op_sel:[0,0] op_sel_hi:[0,1]
    v_pk_mul_f32 v[20:21], v[28:29], s[14:15] op_sel:[0,0] op_sel_hi:[0,1]
    s_lshl_b32 s16, s77, 16
    s_and_b32 s17, s77, 0xffff0000
    v_pk_mul_f32 v[18:19], v[24:25], s[16:17] op_sel:[0,0] op_sel_hi:[0,1]
    v_pk_mul_f32 v[22:23], v[28:29], s[16:17] op_sel:[0,0] op_sel_hi:[0,1]
    s_lshl_b32 s18, s78, 16
    s_and_b32 s19, s78, 0xffff0000
    v_pk_fma_f32 v[16:17], v[24:25], s[18:19], v[16:17] op_sel:[1,0,0] op_sel_hi:[1,1,1]
    v_pk_fma_f32 v[20:21], v[28:29], s[18:19], v[20:21] op_sel:[1,0,0] op_sel_hi:[1,1,1]
    s_lshl_b32 s12, s79, 16
    s_and_b32 s13, s79, 0xffff0000
    v_pk_fma_f32 v[18:19], v[24:25], s[12:13], v[18:19] op_sel:[1,0,0] op_sel_hi:[1,1,1]
    v_pk_fma_f32 v[22:23], v[28:29], s[12:13], v[22:23] op_sel:[1,0,0] op_sel_hi:[1,1,1]
    s_lshl_b32 s14, s80, 16
    s_and_b32 s15, s80, 0xffff0000
    v_pk_fma_f32 v[16:17], v[26:27], s[14:15], v[16:17] op_sel:[0,0,0] op_sel_hi:[0,1,1]
    v_pk_fma_f32 v[20:21], v[30:31], s[14:15], v[20:21] op_sel:[0,0,0] op_sel_hi:[0,1,1]
    s_lshl_b32 s16, s81, 16
    s_and_b32 s17, s81, 0xffff0000
    v_pk_fma_f32 v[18:19], v[26:27], s[16:17], v[18:19] op_sel:[0,0,0] op_sel_hi:[0,1,1]
    v_pk_fma_f32 v[22:23], v[30:31], s[16:17], v[22:23] op_sel:[0,0,0] op_sel_hi:[0,1,1]
    s_lshl_b32 s18, s82, 16
    s_and_b32 s19, s82, 0xffff0000
    v_pk_fma_f32 v[16:17], v[26:27], s[18:19], v[16:17] op_sel:[1,0,0] op_sel_hi:[1,1,1]
    v_pk_fma_f32 v[20:21], v[30:31], s[18:19], v[20:21] op_sel:[1,0,0] op_sel_hi:[1,1,1]
    s_lshl_b32 s12, s83, 16
    s_and_b32 s13, s83, 0xffff0000
    v_pk_fma_f32 v[18:19], v[26:27], s[12:13], v[18:19] op_sel:[1,0,0] op_sel_hi:[1,1,1]
    v_pk_fma_f32 v[22:23], v[30:31], s[12:13], v[22:23] op_sel:[1,0,0] op_sel_hi:[1,1,1]
    v_cvt_pk_bf16_f32 v16, v16, v17
    v_cvt_pk_bf16_f32 v18, v18, v19
    v_cvt_pk_bf16_f32 v20, v20, v21
    v_cvt_pk_bf16_f32 v22, v22, v23
    v_and_b32 v17, 0xffff0000, v16
    v_lshlrev_b32 v16, 16, v16
    v_and_b32 v19, 0xffff0000, v18
    v_lshlrev_b32 v18, 16, v18
    v_and_b32 v21, 0xffff0000, v20
    v_lshlrev_b32 v20, 16, v20
    v_and_b32 v23, 0xffff0000, v22
    v_lshlrev_b32 v22, 16, v22
    v_mul_f32 v16, v16, v32
    v_mul_f32 v17, v17, v33
    v_mul_f32 v18, v18, v34
    v_mul_f32 v19, v19, v35
    v_mul_f32 v20, v20, v36
    v_mul_f32 v21, v21, v37
    v_mul_f32 v22, v22, v38
    v_mul_f32 v23, v23, v39
    v_cvt_pk_bf16_f32 v16, v16, v17
    v_cvt_pk_bf16_f32 v18, v18, v19
    v_cvt_pk_bf16_f32 v20, v20, v21
    v_cvt_pk_bf16_f32 v22, v22, v23
    v_and_b32 v17, 0xffff0000, v16
    v_lshlrev_b32 v16, 16, v16
    v_and_b32 v19, 0xffff0000, v18
    v_lshlrev_b32 v18, 16, v18
    v_and_b32 v21, 0xffff0000, v20
    v_lshlrev_b32 v20, 16, v20
    v_and_b32 v23, 0xffff0000, v22
    v_lshlrev_b32 v22, 16, v22
    s_waitcnt vmcnt(0)
    v_lshlrev_b32 v8, 16, v60
    v_and_b32 v9, 0xffff0000, v60
    v_lshlrev_b32 v10, 16, v61
    v_and_b32 v11, 0xffff0000, v61
    v_lshlrev_b32 v12, 16, v62
    v_and_b32 v13, 0xffff0000, v62
    v_lshlrev_b32 v14, 16, v63
    v_and_b32 v15, 0xffff0000, v63
    v_add_f32 v8, v8, v16
    v_add_f32 v9, v9, v17
    v_add_f32 v10, v10, v18
    v_add_f32 v11, v11, v19
    v_add_f32 v12, v12, v20
    v_add_f32 v13, v13, v21
    v_add_f32 v14, v14, v22
    v_add_f32 v15, v15, v23
    v_cvt_pk_bf16_f32 v4, v8, v9
    v_cvt_pk_bf16_f32 v5, v10, v11
    v_cvt_pk_bf16_f32 v6, v12, v13
    v_cvt_pk_bf16_f32 v7, v14, v15
    buffer_store_dwordx4 v[4:7], v2, s[24:27], 0 offen nt
p3_end:
    s_endpgm
.section .rodata,"a"
.p2align 6
.amdhsa_kernel p1_kernel
  .amdhsa_next_free_vgpr 128
  .amdhsa_next_free_sgpr 72
  .amdhsa_accum_offset 128
  .amdhsa_group_segment_fixed_size 0
  .amdhsa_kernarg_size 112
  .amdhsa_user_sgpr_count 2
  .amdhsa_user_sgpr_kernarg_segment_ptr 1
  .amdhsa_system_sgpr_workgroup_id_x 1
  .amdhsa_float_denorm_mode_32 3
.end_amdhsa_kernel
.p2align 6
.amdhsa_kernel p2_kernel
  .amdhsa_next_free_vgpr 128
  .amdhsa_next_free_sgpr 72
  .amdhsa_accum_offset 128
  .amdhsa_group_segment_fixed_size 0
  .amdhsa_kernarg_size 112
  .amdhsa_user_sgpr_count 2
  .amdhsa_user_sgpr_kernarg_segment_ptr 1
  .amdhsa_system_sgpr_workgroup_id_x 1
  .amdhsa_float_denorm_mode_32 3
.end_amdhsa_kernel
.p2align 6
.amdhsa_kernel p3_kernel
  .amdhsa_next_free_vgpr 64
  .amdhsa_next_free_sgpr 84
  .amdhsa_accum_offset 64
  .amdhsa_group_segment_fixed_size 0
  .amdhsa_kernarg_size 112
  .amdhsa_user_sgpr_count 2
  .amdhsa_user_sgpr_kernarg_segment_ptr 1
  .amdhsa_system_sgpr_workgroup_id_x 1
  .amdhsa_float_denorm_mode_32 3
.end_amdhsa_kernel
```

```asm
; @launch kernel=p1_kernel grid=(256,1,1) block=(1024,1,1) lds=163072
; @launch kernel=p2_kernel grid=(256,1,1) block=(1024,1,1) lds=154368
; @launch kernel=p3_kernel grid=(1563,1,1) block=(256,1,1) lds=0
.amdgcn_target "amdgcn-amd-amdhsa--gfx950"
.text
.globl p1_kernel
.p2align 8
.type p1_kernel,@function
p1_kernel:
    s_cmp_ge_u32 s2, 256
    s_cbranch_scc1 p1_end
    s_load_dwordx2 s[52:53], s[0:1], 0
    s_load_dwordx4 s[56:59], s[0:1], 8
    s_load_dwordx2 s[54:55], s[0:1], 32
    s_load_dwordx2 s[60:61], s[0:1], 48
    s_load_dwordx2 s[48:49], s[0:1], 104
    s_load_dwordx2 s[62:63], s[0:1], 96
    v_lshlrev_b32 v1, 4, v0
    v_lshlrev_b32 v2, 3, v0
    v_mov_b32 v3, 1
    v_lshrrev_b32 v117, 6, v0
    s_nop 0
    v_readfirstlane_b32 s28, v117
    s_waitcnt lgkmcnt(0)
    s_load_dword s45, s[60:61], 0
    s_mov_b32 s4, s56
    s_and_b32 s5, s57, 0xffff
    s_mov_b32 s6, 204800000
    s_mov_b32 s7, 0x20000
    s_mov_b32 s8, s58
    s_and_b32 s9, s59, 0xffff
    s_mov_b32 s10, 204800000
    s_mov_b32 s11, 0x20000
    s_mov_b32 s12, s54
    s_and_b32 s13, s55, 0xffff
    s_mov_b32 s14, 102400000
    s_mov_b32 s15, 0x20000
    s_mov_b32 s16, s48
    s_and_b32 s17, s49, 0xffff
    s_mov_b32 s18, 819200000
    s_mov_b32 s19, 0x20000
    s_mov_b32 s29, s2
    s_mul_i32 s31, s2, 73728
    s_lshl_b32 s30, s31, 1
    s_add_u32 s32, s30, 0
    buffer_load_dwordx4 v[94:97], v1, s[4:7], s32 offen nt
    s_add_u32 s32, s30, 0
    buffer_load_dwordx4 v[102:105], v1, s[8:11], s32 offen nt
    s_add_u32 s32, s31, 0
    buffer_load_dwordx2 v[76:77], v2, s[12:15], s32 offen nt
    s_add_u32 s32, s30, 16384
    buffer_load_dwordx4 v[98:101], v1, s[4:7], s32 offen nt
    s_add_u32 s32, s30, 16384
    buffer_load_dwordx4 v[106:109], v1, s[8:11], s32 offen nt
    s_add_u32 s32, s31, 8192
    buffer_load_dwordx2 v[78:79], v2, s[12:15], s32 offen nt
    s_add_u32 s32, s30, 32768
    buffer_load_dwordx4 v[12:15], v1, s[4:7], s32 offen nt
    s_add_u32 s32, s30, 32768
    buffer_load_dwordx4 v[48:51], v1, s[8:11], s32 offen nt
    s_add_u32 s32, s31, 16384
    buffer_load_dwordx2 v[80:81], v2, s[12:15], s32 offen nt
    s_add_u32 s32, s30, 49152
    buffer_load_dwordx4 v[52:55], v1, s[8:11], s32 offen nt
    s_add_u32 s32, s31, 24576
    buffer_load_dwordx2 v[82:83], v2, s[12:15], s32 offen nt
    s_add_u32 s32, s31, 32768
    buffer_load_dwordx2 v[84:85], v2, s[12:15], s32 offen nt
    s_add_u32 s32, s30, 81920
    buffer_load_dwordx4 v[60:63], v1, s[8:11], s32 offen nt
    s_add_u32 s32, s31, 40960
    buffer_load_dwordx2 v[86:87], v2, s[12:15], s32 offen nt
    s_add_u32 s32, s31, 49152
    buffer_load_dwordx2 v[88:89], v2, s[12:15], s32 offen nt
    s_add_u32 s32, s30, 114688
    buffer_load_dwordx4 v[68:71], v1, s[8:11], s32 offen nt
    s_add_u32 s32, s31, 57344
    buffer_load_dwordx2 v[90:91], v2, s[12:15], s32 offen nt
    s_add_u32 s32, s31, 65536
    buffer_load_dwordx2 v[92:93], v2, s[12:15], s32 offen nt
    s_mov_b32 s24, s52
    s_and_b32 s25, s53, 0xffff
    s_mov_b32 s26, 6400000
    s_mov_b32 s27, 0x20000
    s_mov_b32 s20, s48
    s_and_b32 s21, s49, 0xffff
    s_mov_b32 s22, 0
    s_mov_b32 s23, 0x20000
    s_mov_b32 s40, s62
    s_and_b32 s41, s63, 0xffff
    s_mov_b32 s42, 256
    s_mov_b32 s43, 0x20000
    s_mov_b32 s36, 643827
    s_mov_b32 s37, 214609
    s_mov_b32 s38, 343268
    s_mov_b32 s39, -6671
    s_mov_b32 s44, -12512
    s_mov_b32 s34, 1
    v_mov_b32 v122, 0
    v_mov_b32 v123, 0
    v_mov_b32 v124, 0
    v_mov_b32 v125, 0
    ds_write_b128 v1, v[122:125] offset:0
    s_waitcnt lgkmcnt(0)
    s_barrier
    s_lshl_b32 s45, s45, 16
p1_tile:
    v_mov_b32 v122, 0
    v_mov_b32 v123, 0
    v_mov_b32 v124, 0
    v_mov_b32 v125, 0
    ds_write_b128 v1, v[122:125] offset:10496
    ds_write_b128 v1, v[122:125] offset:26880
    ds_write_b128 v1, v[122:125] offset:43264
    s_cmp_lg_u32 s28, 15
    s_cbranch_scc1 p1_tk0
    v_mov_b32 v127, 1
    s_mov_b64 exec, 1
    buffer_atomic_add v127, off, s[40:43], 0 offset:128 sc0 sc1
    s_mov_b64 exec, -1
p1_tk0:
    v_mov_b32 v123, s45
    v_mov_b32 v124, 0x007f007f
    v_mov_b32 v125, 0xe000
    v_mov_b32 v126, 0xffff0000
    s_cmp_lt_u32 s29, 1419
    s_cselect_b32 s6, 204800000, 0
    s_add_u32 s32, s30, 49152
    buffer_load_dwordx4 v[16:19], v1, s[4:7], s32 offen nt
    s_cmp_lg_u32 s34, 0
    s_cbranch_scc1 p1_w1
    s_waitcnt vmcnt(15)
p1_w1:
    s_waitcnt vmcnt(16)
    v_lshlrev_b32 v117, 16, v76
    v_and_b32 v118, v126, v76
    v_mul_f32 v117, v123, v117
    v_mul_f32 v118, v123, v118
    v_cvt_pk_bf16_f32 v117, v117, v118
    v_and_b32 v118, v126, v117
    v_lshlrev_b32 v117, 16, v117
    v_mul_f32 v117, 0.15915494, v117
    v_mul_f32 v118, 0.15915494, v118
    v_fract_f32 v117, v117
    v_fract_f32 v118, v118
    v_cos_f32 v117, v117
    v_cos_f32 v118, v118
    v_mul_hi_u32_u24 v122, s38, v102
    v_mul_hi_u32_u24 v121, s37, v94
    v_mul_hi_u32_u24 v120, s36, v94
    v_mad_i32_i24 v110, v122, s44, v102
    v_mad_u32_u24 v40, v122, 40, v121
    v_mad_i32_i24 v4, v120, s39, v94
    v_lshlrev_b16 v40, 2, v40
    v_mad_i32_i24 v120, v121, -3, v120
    ds_add_u32 v40, v3 offset:0
    v_lshl_or_b32 v4, v110, 16, v4
    v_lshl_or_b32 v4, v120, 30, v4
    v_mul_f32 v117, 0x03800000, v117
    v_mul_f32 v118, 0x03800000, v118
    v_cvt_pk_bf16_f32 v117, v117, v118
    v_mul_hi_u32_u24 v122, s38, v103
    v_mul_hi_u32_u24 v121, s37, v95
    v_mul_hi_u32_u24 v120, s36, v95
    v_mad_i32_i24 v110, v122, s44, v103
    v_mad_u32_u24 v41, v122, 40, v121
    v_mad_i32_i24 v5, v120, s39, v95
    v_lshlrev_b16 v41, 2, v41
    v_mad_i32_i24 v120, v121, -3, v120
    ds_add_u32 v41, v3 offset:0
    v_lshl_or_b32 v5, v110, 16, v5
    v_lshl_or_b32 v5, v120, 30, v5
    v_lshrrev_b32 v118, 3, v117
    v_lshrrev_b32 v119, 8, v117
    v_lshlrev_b16 v117, 13, v117
    v_bitop3_b32 v119, v118, v119, v124 bitop3:0x1b
    v_bitop3_b32 v4, v117, v125, v4 bitop3:0xae
    v_lshl_or_b32 v40, v119, 16, v40
    v_bitop3_b32 v5, v118, v125, v5 bitop3:0xae
    v_bitop3_b32 v41, v119, v126, v41 bitop3:0xea
    v_lshlrev_b32 v117, 16, v77
    v_and_b32 v118, v126, v77
    v_mul_f32 v117, v123, v117
    v_mul_f32 v118, v123, v118
    v_cvt_pk_bf16_f32 v117, v117, v118
    v_and_b32 v118, v126, v117
    v_lshlrev_b32 v117, 16, v117
    v_mul_f32 v117, 0.15915494, v117
    v_mul_f32 v118, 0.15915494, v118
    v_fract_f32 v117, v117
    v_fract_f32 v118, v118
    v_cos_f32 v117, v117
    v_cos_f32 v118, v118
    v_mul_hi_u32_u24 v122, s38, v104
    v_mul_hi_u32_u24 v121, s37, v96
    v_mul_hi_u32_u24 v120, s36, v96
    v_mad_i32_i24 v110, v122, s44, v104
    v_mad_u32_u24 v42, v122, 40, v121
    v_mad_i32_i24 v6, v120, s39, v96
    v_lshlrev_b16 v42, 2, v42
    v_mad_i32_i24 v120, v121, -3, v120
    ds_add_u32 v42, v3 offset:0
    v_lshl_or_b32 v6, v110, 16, v6
    v_lshl_or_b32 v6, v120, 30, v6
    v_mul_f32 v117, 0x03800000, v117
    v_mul_f32 v118, 0x03800000, v118
    v_cvt_pk_bf16_f32 v117, v117, v118
    v_mul_hi_u32_u24 v122, s38, v105
    v_mul_hi_u32_u24 v121, s37, v97
    v_mul_hi_u32_u24 v120, s36, v97
    v_mad_i32_i24 v110, v122, s44, v105
    v_mad_u32_u24 v43, v122, 40, v121
    v_mad_i32_i24 v7, v120, s39, v97
    v_lshlrev_b16 v43, 2, v43
    v_mad_i32_i24 v120, v121, -3, v120
    ds_add_u32 v43, v3 offset:0
    v_lshl_or_b32 v7, v110, 16, v7
    v_lshl_or_b32 v7, v120, 30, v7
    v_lshrrev_b32 v118, 3, v117
    v_lshrrev_b32 v119, 8, v117
    v_lshlrev_b16 v117, 13, v117
    v_bitop3_b32 v119, v118, v119, v124 bitop3:0x1b
    v_bitop3_b32 v6, v117, v125, v6 bitop3:0xae
    v_lshl_or_b32 v42, v119, 16, v42
    v_bitop3_b32 v7, v118, v125, v7 bitop3:0xae
    v_bitop3_b32 v43, v119, v126, v43 bitop3:0xea
    s_cmp_lt_u32 s29, 1392
    s_cselect_b32 s6, 204800000, 0
    s_add_u32 s32, s30, 65536
    buffer_load_dwordx4 v[20:23], v1, s[4:7], s32 offen nt
    s_cmp_lt_u32 s29, 1392
    s_cselect_b32 s10, 204800000, 0
    s_add_u32 s32, s30, 65536
    buffer_load_dwordx4 v[56:59], v1, s[8:11], s32 offen nt
    s_cmp_lg_u32 s34, 0
    s_cbranch_scc1 p1_w2
    s_waitcnt vmcnt(6)
p1_w2:
    s_waitcnt vmcnt(15)
    v_lshlrev_b32 v117, 16, v78
    v_and_b32 v118, v126, v78
    v_mul_f32 v117, v123, v117
    v_mul_f32 v118, v123, v118
    v_cvt_pk_bf16_f32 v117, v117, v118
    v_and_b32 v118, v126, v117
    v_lshlrev_b32 v117, 16, v117
    v_mul_f32 v117, 0.15915494, v117
    v_mul_f32 v118, 0.15915494, v118
    v_fract_f32 v117, v117
    v_fract_f32 v118, v118
    v_cos_f32 v117, v117
    v_cos_f32 v118, v118
    v_mul_hi_u32_u24 v122, s38, v106
    v_mul_hi_u32_u24 v121, s37, v98
    v_mul_hi_u32_u24 v120, s36, v98
    v_mad_i32_i24 v110, v122, s44, v106
    v_mad_u32_u24 v44, v122, 40, v121
    v_mad_i32_i24 v8, v120, s39, v98
    v_lshlrev_b16 v44, 2, v44
    v_mad_i32_i24 v120, v121, -3, v120
    ds_add_u32 v44, v3 offset:0
    v_lshl_or_b32 v8, v110, 16, v8
    v_lshl_or_b32 v8, v120, 30, v8
    v_mul_f32 v117, 0x03800000, v117
    v_mul_f32 v118, 0x03800000, v118
    v_cvt_pk_bf16_f32 v117, v117, v118
    v_mul_hi_u32_u24 v122, s38, v107
    v_mul_hi_u32_u24 v121, s37, v99
    v_mul_hi_u32_u24 v120, s36, v99
    v_mad_i32_i24 v110, v122, s44, v107
    v_mad_u32_u24 v45, v122, 40, v121
    v_mad_i32_i24 v9, v120, s39, v99
    v_lshlrev_b16 v45, 2, v45
    v_mad_i32_i24 v120, v121, -3, v120
    ds_add_u32 v45, v3 offset:0
    v_lshl_or_b32 v9, v110, 16, v9
    v_lshl_or_b32 v9, v120, 30, v9
    v_lshrrev_b32 v118, 3, v117
    v_lshrrev_b32 v119, 8, v117
    v_lshlrev_b16 v117, 13, v117
    v_bitop3_b32 v119, v118, v119, v124 bitop3:0x1b
    v_bitop3_b32 v8, v117, v125, v8 bitop3:0xae
    v_lshl_or_b32 v44, v119, 16, v44
    v_bitop3_b32 v9, v118, v125, v9 bitop3:0xae
    v_bitop3_b32 v45, v119, v126, v45 bitop3:0xea
    v_lshlrev_b32 v117, 16, v79
    v_and_b32 v118, v126, v79
    v_mul_f32 v117, v123, v117
    v_mul_f32 v118, v123, v118
    v_cvt_pk_bf16_f32 v117, v117, v118
    v_and_b32 v118, v126, v117
    v_lshlrev_b32 v117, 16, v117
    v_mul_f32 v117, 0.15915494, v117
    v_mul_f32 v118, 0.15915494, v118
    v_fract_f32 v117, v117
    v_fract_f32 v118, v118
    v_cos_f32 v117, v117
    v_cos_f32 v118, v118
    v_mul_hi_u32_u24 v122, s38, v108
    v_mul_hi_u32_u24 v121, s37, v100
    v_mul_hi_u32_u24 v120, s36, v100
    v_mad_i32_i24 v110, v122, s44, v108
    v_mad_u32_u24 v46, v122, 40, v121
    v_mad_i32_i24 v10, v120, s39, v100
    v_lshlrev_b16 v46, 2, v46
    v_mad_i32_i24 v120, v121, -3, v120
    ds_add_u32 v46, v3 offset:0
    v_lshl_or_b32 v10, v110, 16, v10
    v_lshl_or_b32 v10, v120, 30, v10
    v_mul_f32 v117, 0x03800000, v117
    v_mul_f32 v118, 0x03800000, v118
    v_cvt_pk_bf16_f32 v117, v117, v118
    v_mul_hi_u32_u24 v122, s38, v109
    v_mul_hi_u32_u24 v121, s37, v101
    v_mul_hi_u32_u24 v120, s36, v101
    v_mad_i32_i24 v110, v122, s44, v109
    v_mad_u32_u24 v47, v122, 40, v121
    v_mad_i32_i24 v11, v120, s39, v101
    v_lshlrev_b16 v47, 2, v47
    v_mad_i32_i24 v120, v121, -3, v120
    ds_add_u32 v47, v3 offset:0
    v_lshl_or_b32 v11, v110, 16, v11
    v_lshl_or_b32 v11, v120, 30, v11
    v_lshrrev_b32 v118, 3, v117
    v_lshrrev_b32 v119, 8, v117
    v_lshlrev_b16 v117, 13, v117
    v_bitop3_b32 v119, v118, v119, v124 bitop3:0x1b
    v_bitop3_b32 v10, v117, v125, v10 bitop3:0xae
    v_lshl_or_b32 v46, v119, 16, v46
    v_bitop3_b32 v11, v118, v125, v11 bitop3:0xae
    v_bitop3_b32 v47, v119, v126, v47 bitop3:0xea
    s_cmp_lt_u32 s29, 1365
    s_cselect_b32 s6, 204800000, 0
    s_add_u32 s32, s30, 81920
    buffer_load_dwordx4 v[24:27], v1, s[4:7], s32 offen nt
    s_cmp_ge_u32 s29, 1445
    s_cbranch_scc1 p1_k3
    s_cmp_lg_u32 s34, 0
    s_cbranch_scc1 p1_w4
    s_waitcnt vmcnt(4)
p1_w4:
    s_waitcnt vmcnt(9)
    v_lshlrev_b32 v117, 16, v80
    v_and_b32 v118, v126, v80
    v_mul_f32 v117, v123, v117
    v_mul_f32 v118, v123, v118
    v_cvt_pk_bf16_f32 v117, v117, v118
    v_and_b32 v118, v126, v117
    v_lshlrev_b32 v117, 16, v117
    v_mul_f32 v117, 0.15915494, v117
    v_mul_f32 v118, 0.15915494, v118
    v_fract_f32 v117, v117
    v_fract_f32 v118, v118
    v_cos_f32 v117, v117
    v_cos_f32 v118, v118
    v_mul_hi_u32_u24 v122, s38, v48
    v_mul_hi_u32_u24 v121, s37, v12
    v_mul_hi_u32_u24 v120, s36, v12
    v_mad_i32_i24 v110, v122, s44, v48
    v_mad_u32_u24 v48, v122, 40, v121
    v_mad_i32_i24 v12, v120, s39, v12
    v_lshlrev_b16 v48, 2, v48
    v_mad_i32_i24 v120, v121, -3, v120
    ds_add_u32 v48, v3 offset:0
    v_lshl_or_b32 v12, v110, 16, v12
    v_lshl_or_b32 v12, v120, 30, v12
    v_mul_f32 v117, 0x03800000, v117
    v_mul_f32 v118, 0x03800000, v118
    v_cvt_pk_bf16_f32 v117, v117, v118
    v_mul_hi_u32_u24 v122, s38, v49
    v_mul_hi_u32_u24 v121, s37, v13
    v_mul_hi_u32_u24 v120, s36, v13
    v_mad_i32_i24 v110, v122, s44, v49
    v_mad_u32_u24 v49, v122, 40, v121
    v_mad_i32_i24 v13, v120, s39, v13
    v_lshlrev_b16 v49, 2, v49
    v_mad_i32_i24 v120, v121, -3, v120
    ds_add_u32 v49, v3 offset:0
    v_lshl_or_b32 v13, v110, 16, v13
    v_lshl_or_b32 v13, v120, 30, v13
    v_lshrrev_b32 v118, 3, v117
    v_lshrrev_b32 v119, 8, v117
    v_lshlrev_b16 v117, 13, v117
    v_bitop3_b32 v119, v118, v119, v124 bitop3:0x1b
    v_bitop3_b32 v12, v117, v125, v12 bitop3:0xae
    v_lshl_or_b32 v48, v119, 16, v48
    v_bitop3_b32 v13, v118, v125, v13 bitop3:0xae
    v_bitop3_b32 v49, v119, v126, v49 bitop3:0xea
    v_lshlrev_b32 v117, 16, v81
    v_and_b32 v118, v126, v81
    v_mul_f32 v117, v123, v117
    v_mul_f32 v118, v123, v118
    v_cvt_pk_bf16_f32 v117, v117, v118
    v_and_b32 v118, v126, v117
    v_lshlrev_b32 v117, 16, v117
    v_mul_f32 v117, 0.15915494, v117
    v_mul_f32 v118, 0.15915494, v118
    v_fract_f32 v117, v117
    v_fract_f32 v118, v118
    v_cos_f32 v117, v117
    v_cos_f32 v118, v118
    v_mul_hi_u32_u24 v122, s38, v50
    v_mul_hi_u32_u24 v121, s37, v14
    v_mul_hi_u32_u24 v120, s36, v14
    v_mad_i32_i24 v110, v122, s44, v50
    v_mad_u32_u24 v50, v122, 40, v121
    v_mad_i32_i24 v14, v120, s39, v14
    v_lshlrev_b16 v50, 2, v50
    v_mad_i32_i24 v120, v121, -3, v120
    ds_add_u32 v50, v3 offset:0
    v_lshl_or_b32 v14, v110, 16, v14
    v_lshl_or_b32 v14, v120, 30, v14
    v_mul_f32 v117, 0x03800000, v117
    v_mul_f32 v118, 0x03800000, v118
    v_cvt_pk_bf16_f32 v117, v117, v118
    v_mul_hi_u32_u24 v122, s38, v51
    v_mul_hi_u32_u24 v121, s37, v15
    v_mul_hi_u32_u24 v120, s36, v15
    v_mad_i32_i24 v110, v122, s44, v51
    v_mad_u32_u24 v51, v122, 40, v121
    v_mad_i32_i24 v15, v120, s39, v15
    v_lshlrev_b16 v51, 2, v51
    v_mad_i32_i24 v120, v121, -3, v120
    ds_add_u32 v51, v3 offset:0
    v_lshl_or_b32 v15, v110, 16, v15
    v_lshl_or_b32 v15, v120, 30, v15
    v_lshrrev_b32 v118, 3, v117
    v_lshrrev_b32 v119, 8, v117
    v_lshlrev_b16 v117, 13, v117
    v_bitop3_b32 v119, v118, v119, v124 bitop3:0x1b
    v_bitop3_b32 v14, v117, v125, v14 bitop3:0xae
    v_lshl_or_b32 v50, v119, 16, v50
    v_bitop3_b32 v15, v118, v125, v15 bitop3:0xae
    v_bitop3_b32 v51, v119, v126, v51 bitop3:0xea
p1_k3:
    s_cmp_lt_u32 s29, 1338
    s_cselect_b32 s6, 204800000, 0
    s_add_u32 s32, s30, 98304
    buffer_load_dwordx4 v[28:31], v1, s[4:7], s32 offen nt
    s_cmp_lt_u32 s29, 1338
    s_cselect_b32 s10, 204800000, 0
    s_add_u32 s32, s30, 98304
    buffer_load_dwordx4 v[64:67], v1, s[8:11], s32 offen nt
    s_cmp_ge_u32 s29, 1419
    s_cbranch_scc1 p1_k5
    s_waitcnt vmcnt(5)
    v_lshlrev_b32 v117, 16, v82
    v_and_b32 v118, v126, v82
    v_mul_f32 v117, v123, v117
    v_mul_f32 v118, v123, v118
    v_cvt_pk_bf16_f32 v117, v117, v118
    v_and_b32 v118, v126, v117
    v_lshlrev_b32 v117, 16, v117
    v_mul_f32 v117, 0.15915494, v117
    v_mul_f32 v118, 0.15915494, v118
    v_fract_f32 v117, v117
    v_fract_f32 v118, v118
    v_cos_f32 v117, v117
    v_cos_f32 v118, v118
    v_mul_hi_u32_u24 v122, s38, v52
    v_mul_hi_u32_u24 v121, s37, v16
    v_mul_hi_u32_u24 v120, s36, v16
    v_mad_i32_i24 v110, v122, s44, v52
    v_mad_u32_u24 v52, v122, 40, v121
    v_mad_i32_i24 v16, v120, s39, v16
    v_lshlrev_b16 v52, 2, v52
    v_mad_i32_i24 v120, v121, -3, v120
    ds_add_u32 v52, v3 offset:0
    v_lshl_or_b32 v16, v110, 16, v16
    v_lshl_or_b32 v16, v120, 30, v16
    v_mul_f32 v117, 0x03800000, v117
    v_mul_f32 v118, 0x03800000, v118
    v_cvt_pk_bf16_f32 v117, v117, v118
    v_mul_hi_u32_u24 v122, s38, v53
    v_mul_hi_u32_u24 v121, s37, v17
    v_mul_hi_u32_u24 v120, s36, v17
    v_mad_i32_i24 v110, v122, s44, v53
    v_mad_u32_u24 v53, v122, 40, v121
    v_mad_i32_i24 v17, v120, s39, v17
    v_lshlrev_b16 v53, 2, v53
    v_mad_i32_i24 v120, v121, -3, v120
    ds_add_u32 v53, v3 offset:0
    v_lshl_or_b32 v17, v110, 16, v17
    v_lshl_or_b32 v17, v120, 30, v17
    v_lshrrev_b32 v118, 3, v117
    v_lshrrev_b32 v119, 8, v117
    v_lshlrev_b16 v117, 13, v117
    v_bitop3_b32 v119, v118, v119, v124 bitop3:0x1b
    v_bitop3_b32 v16, v117, v125, v16 bitop3:0xae
    v_lshl_or_b32 v52, v119, 16, v52
    v_bitop3_b32 v17, v118, v125, v17 bitop3:0xae
    v_bitop3_b32 v53, v119, v126, v53 bitop3:0xea
    v_lshlrev_b32 v117, 16, v83
    v_and_b32 v118, v126, v83
    v_mul_f32 v117, v123, v117
    v_mul_f32 v118, v123, v118
    v_cvt_pk_bf16_f32 v117, v117, v118
    v_and_b32 v118, v126, v117
    v_lshlrev_b32 v117, 16, v117
    v_mul_f32 v117, 0.15915494, v117
    v_mul_f32 v118, 0.15915494, v118
    v_fract_f32 v117, v117
    v_fract_f32 v118, v118
    v_cos_f32 v117, v117
    v_cos_f32 v118, v118
    v_mul_hi_u32_u24 v122, s38, v54
    v_mul_hi_u32_u24 v121, s37, v18
    v_mul_hi_u32_u24 v120, s36, v18
    v_mad_i32_i24 v110, v122, s44, v54
    v_mad_u32_u24 v54, v122, 40, v121
    v_mad_i32_i24 v18, v120, s39, v18
    v_lshlrev_b16 v54, 2, v54
    v_mad_i32_i24 v120, v121, -3, v120
    ds_add_u32 v54, v3 offset:0
    v_lshl_or_b32 v18, v110, 16, v18
    v_lshl_or_b32 v18, v120, 30, v18
    v_mul_f32 v117, 0x03800000, v117
    v_mul_f32 v118, 0x03800000, v118
    v_cvt_pk_bf16_f32 v117, v117, v118
    v_mul_hi_u32_u24 v122, s38, v55
    v_mul_hi_u32_u24 v121, s37, v19
    v_mul_hi_u32_u24 v120, s36, v19
    v_mad_i32_i24 v110, v122, s44, v55
    v_mad_u32_u24 v55, v122, 40, v121
    v_mad_i32_i24 v19, v120, s39, v19
    v_lshlrev_b16 v55, 2, v55
    v_mad_i32_i24 v120, v121, -3, v120
    ds_add_u32 v55, v3 offset:0
    v_lshl_or_b32 v19, v110, 16, v19
    v_lshl_or_b32 v19, v120, 30, v19
    v_lshrrev_b32 v118, 3, v117
    v_lshrrev_b32 v119, 8, v117
    v_lshlrev_b16 v117, 13, v117
    v_bitop3_b32 v119, v118, v119, v124 bitop3:0x1b
    v_bitop3_b32 v18, v117, v125, v18 bitop3:0xae
    v_lshl_or_b32 v54, v119, 16, v54
    v_bitop3_b32 v19, v118, v125, v19 bitop3:0xae
    v_bitop3_b32 v55, v119, v126, v55 bitop3:0xea
p1_k5:
    s_cmp_lt_u32 s29, 1312
    s_cselect_b32 s6, 204800000, 0
    s_add_u32 s32, s30, 114688
    buffer_load_dwordx4 v[32:35], v1, s[4:7], s32 offen nt
    s_cmp_ge_u32 s29, 1392
    s_cbranch_scc1 p1_k7
    s_waitcnt vmcnt(4)
    v_lshlrev_b32 v117, 16, v84
    v_and_b32 v118, v126, v84
    v_mul_f32 v117, v123, v117
    v_mul_f32 v118, v123, v118
    v_cvt_pk_bf16_f32 v117, v117, v118
    v_and_b32 v118, v126, v117
    v_lshlrev_b32 v117, 16, v117
    v_mul_f32 v117, 0.15915494, v117
    v_mul_f32 v118, 0.15915494, v118
    v_fract_f32 v117, v117
    v_fract_f32 v118, v118
    v_cos_f32 v117, v117
    v_cos_f32 v118, v118
    v_mul_hi_u32_u24 v122, s38, v56
    v_mul_hi_u32_u24 v121, s37, v20
    v_mul_hi_u32_u24 v120, s36, v20
    v_mad_i32_i24 v110, v122, s44, v56
    v_mad_u32_u24 v56, v122, 40, v121
    v_mad_i32_i24 v20, v120, s39, v20
    v_lshlrev_b16 v56, 2, v56
    v_mad_i32_i24 v120, v121, -3, v120
    ds_add_u32 v56, v3 offset:0
    v_lshl_or_b32 v20, v110, 16, v20
    v_lshl_or_b32 v20, v120, 30, v20
    v_mul_f32 v117, 0x03800000, v117
    v_mul_f32 v118, 0x03800000, v118
    v_cvt_pk_bf16_f32 v117, v117, v118
    v_mul_hi_u32_u24 v122, s38, v57
    v_mul_hi_u32_u24 v121, s37, v21
    v_mul_hi_u32_u24 v120, s36, v21
    v_mad_i32_i24 v110, v122, s44, v57
    v_mad_u32_u24 v57, v122, 40, v121
    v_mad_i32_i24 v21, v120, s39, v21
    v_lshlrev_b16 v57, 2, v57
    v_mad_i32_i24 v120, v121, -3, v120
    ds_add_u32 v57, v3 offset:0
    v_lshl_or_b32 v21, v110, 16, v21
    v_lshl_or_b32 v21, v120, 30, v21
    v_lshrrev_b32 v118, 3, v117
    v_lshrrev_b32 v119, 8, v117
    v_lshlrev_b16 v117, 13, v117
    v_bitop3_b32 v119, v118, v119, v124 bitop3:0x1b
    v_bitop3_b32 v20, v117, v125, v20 bitop3:0xae
    v_lshl_or_b32 v56, v119, 16, v56
    v_bitop3_b32 v21, v118, v125, v21 bitop3:0xae
    v_bitop3_b32 v57, v119, v126, v57 bitop3:0xea
    v_lshlrev_b32 v117, 16, v85
    v_and_b32 v118, v126, v85
    v_mul_f32 v117, v123, v117
    v_mul_f32 v118, v123, v118
    v_cvt_pk_bf16_f32 v117, v117, v118
    v_and_b32 v118, v126, v117
    v_lshlrev_b32 v117, 16, v117
    v_mul_f32 v117, 0.15915494, v117
    v_mul_f32 v118, 0.15915494, v118
    v_fract_f32 v117, v117
    v_fract_f32 v118, v118
    v_cos_f32 v117, v117
    v_cos_f32 v118, v118
    v_mul_hi_u32_u24 v122, s38, v58
    v_mul_hi_u32_u24 v121, s37, v22
    v_mul_hi_u32_u24 v120, s36, v22
    v_mad_i32_i24 v110, v122, s44, v58
    v_mad_u32_u24 v58, v122, 40, v121
    v_mad_i32_i24 v22, v120, s39, v22
    v_lshlrev_b16 v58, 2, v58
    v_mad_i32_i24 v120, v121, -3, v120
    ds_add_u32 v58, v3 offset:0
    v_lshl_or_b32 v22, v110, 16, v22
    v_lshl_or_b32 v22, v120, 30, v22
    v_mul_f32 v117, 0x03800000, v117
    v_mul_f32 v118, 0x03800000, v118
    v_cvt_pk_bf16_f32 v117, v117, v118
    v_mul_hi_u32_u24 v122, s38, v59
    v_mul_hi_u32_u24 v121, s37, v23
    v_mul_hi_u32_u24 v120, s36, v23
    v_mad_i32_i24 v110, v122, s44, v59
    v_mad_u32_u24 v59, v122, 40, v121
    v_mad_i32_i24 v23, v120, s39, v23
    v_lshlrev_b16 v59, 2, v59
    v_mad_i32_i24 v120, v121, -3, v120
    ds_add_u32 v59, v3 offset:0
    v_lshl_or_b32 v23, v110, 16, v23
    v_lshl_or_b32 v23, v120, 30, v23
    v_lshrrev_b32 v118, 3, v117
    v_lshrrev_b32 v119, 8, v117
    v_lshlrev_b16 v117, 13, v117
    v_bitop3_b32 v119, v118, v119, v124 bitop3:0x1b
    v_bitop3_b32 v22, v117, v125, v22 bitop3:0xae
    v_lshl_or_b32 v58, v119, 16, v58
    v_bitop3_b32 v23, v118, v125, v23 bitop3:0xae
    v_bitop3_b32 v59, v119, v126, v59 bitop3:0xea
p1_k7:
    s_cmp_lt_u32 s29, 1285
    s_cselect_b32 s6, 204800000, 0
    s_add_u32 s32, s30, 131072
    buffer_load_dwordx4 v[36:39], v1, s[4:7], s32 offen nt
    s_cmp_lt_u32 s29, 1285
    s_cselect_b32 s10, 204800000, 0
    s_add_u32 s32, s30, 131072
    buffer_load_dwordx4 v[72:75], v1, s[8:11], s32 offen nt
    s_cmp_ge_u32 s29, 1365
    s_cbranch_scc1 p1_k9
    s_waitcnt vmcnt(5)
    v_lshlrev_b32 v117, 16, v86
    v_and_b32 v118, v126, v86
    v_mul_f32 v117, v123, v117
    v_mul_f32 v118, v123, v118
    v_cvt_pk_bf16_f32 v117, v117, v118
    v_and_b32 v118, v126, v117
    v_lshlrev_b32 v117, 16, v117
    v_mul_f32 v117, 0.15915494, v117
    v_mul_f32 v118, 0.15915494, v118
    v_fract_f32 v117, v117
    v_fract_f32 v118, v118
    v_cos_f32 v117, v117
    v_cos_f32 v118, v118
    v_mul_hi_u32_u24 v122, s38, v60
    v_mul_hi_u32_u24 v121, s37, v24
    v_mul_hi_u32_u24 v120, s36, v24
    v_mad_i32_i24 v110, v122, s44, v60
    v_mad_u32_u24 v60, v122, 40, v121
    v_mad_i32_i24 v24, v120, s39, v24
    v_lshlrev_b16 v60, 2, v60
    v_mad_i32_i24 v120, v121, -3, v120
    ds_add_u32 v60, v3 offset:0
    v_lshl_or_b32 v24, v110, 16, v24
    v_lshl_or_b32 v24, v120, 30, v24
    v_mul_f32 v117, 0x03800000, v117
    v_mul_f32 v118, 0x03800000, v118
    v_cvt_pk_bf16_f32 v117, v117, v118
    v_mul_hi_u32_u24 v122, s38, v61
    v_mul_hi_u32_u24 v121, s37, v25
    v_mul_hi_u32_u24 v120, s36, v25
    v_mad_i32_i24 v110, v122, s44, v61
    v_mad_u32_u24 v61, v122, 40, v121
    v_mad_i32_i24 v25, v120, s39, v25
    v_lshlrev_b16 v61, 2, v61
    v_mad_i32_i24 v120, v121, -3, v120
    ds_add_u32 v61, v3 offset:0
    v_lshl_or_b32 v25, v110, 16, v25
    v_lshl_or_b32 v25, v120, 30, v25
    v_lshrrev_b32 v118, 3, v117
    v_lshrrev_b32 v119, 8, v117
    v_lshlrev_b16 v117, 13, v117
    v_bitop3_b32 v119, v118, v119, v124 bitop3:0x1b
    v_bitop3_b32 v24, v117, v125, v24 bitop3:0xae
    v_lshl_or_b32 v60, v119, 16, v60
    v_bitop3_b32 v25, v118, v125, v25 bitop3:0xae
    v_bitop3_b32 v61, v119, v126, v61 bitop3:0xea
    v_lshlrev_b32 v117, 16, v87
    v_and_b32 v118, v126, v87
    v_mul_f32 v117, v123, v117
    v_mul_f32 v118, v123, v118
    v_cvt_pk_bf16_f32 v117, v117, v118
    v_and_b32 v118, v126, v117
    v_lshlrev_b32 v117, 16, v117
    v_mul_f32 v117, 0.15915494, v117
    v_mul_f32 v118, 0.15915494, v118
    v_fract_f32 v117, v117
    v_fract_f32 v118, v118
    v_cos_f32 v117, v117
    v_cos_f32 v118, v118
    v_mul_hi_u32_u24 v122, s38, v62
    v_mul_hi_u32_u24 v121, s37, v26
    v_mul_hi_u32_u24 v120, s36, v26
    v_mad_i32_i24 v110, v122, s44, v62
    v_mad_u32_u24 v62, v122, 40, v121
    v_mad_i32_i24 v26, v120, s39, v26
    v_lshlrev_b16 v62, 2, v62
    v_mad_i32_i24 v120, v121, -3, v120
    ds_add_u32 v62, v3 offset:0
    v_lshl_or_b32 v26, v110, 16, v26
    v_lshl_or_b32 v26, v120, 30, v26
    v_mul_f32 v117, 0x03800000, v117
    v_mul_f32 v118, 0x03800000, v118
    v_cvt_pk_bf16_f32 v117, v117, v118
    v_mul_hi_u32_u24 v122, s38, v63
    v_mul_hi_u32_u24 v121, s37, v27
    v_mul_hi_u32_u24 v120, s36, v27
    v_mad_i32_i24 v110, v122, s44, v63
    v_mad_u32_u24 v63, v122, 40, v121
    v_mad_i32_i24 v27, v120, s39, v27
    v_lshlrev_b16 v63, 2, v63
    v_mad_i32_i24 v120, v121, -3, v120
    ds_add_u32 v63, v3 offset:0
    v_lshl_or_b32 v27, v110, 16, v27
    v_lshl_or_b32 v27, v120, 30, v27
    v_lshrrev_b32 v118, 3, v117
    v_lshrrev_b32 v119, 8, v117
    v_lshlrev_b16 v117, 13, v117
    v_bitop3_b32 v119, v118, v119, v124 bitop3:0x1b
    v_bitop3_b32 v26, v117, v125, v26 bitop3:0xae
    v_lshl_or_b32 v62, v119, 16, v62
    v_bitop3_b32 v27, v118, v125, v27 bitop3:0xae
    v_bitop3_b32 v63, v119, v126, v63 bitop3:0xea
p1_k9:
    s_cmp_ge_u32 s29, 1338
    s_cbranch_scc1 p1_k11
    s_waitcnt vmcnt(3)
    v_lshlrev_b32 v117, 16, v88
    v_and_b32 v118, v126, v88
    v_mul_f32 v117, v123, v117
    v_mul_f32 v118, v123, v118
    v_cvt_pk_bf16_f32 v117, v117, v118
    v_and_b32 v118, v126, v117
    v_lshlrev_b32 v117, 16, v117
    v_mul_f32 v117, 0.15915494, v117
    v_mul_f32 v118, 0.15915494, v118
    v_fract_f32 v117, v117
    v_fract_f32 v118, v118
    v_cos_f32 v117, v117
    v_cos_f32 v118, v118
    v_mul_hi_u32_u24 v122, s38, v64
    v_mul_hi_u32_u24 v121, s37, v28
    v_mul_hi_u32_u24 v120, s36, v28
    v_mad_i32_i24 v110, v122, s44, v64
    v_mad_u32_u24 v64, v122, 40, v121
    v_mad_i32_i24 v28, v120, s39, v28
    v_lshlrev_b16 v64, 2, v64
    v_mad_i32_i24 v120, v121, -3, v120
    ds_add_u32 v64, v3 offset:0
    v_lshl_or_b32 v28, v110, 16, v28
    v_lshl_or_b32 v28, v120, 30, v28
    v_mul_f32 v117, 0x03800000, v117
    v_mul_f32 v118, 0x03800000, v118
    v_cvt_pk_bf16_f32 v117, v117, v118
    v_mul_hi_u32_u24 v122, s38, v65
    v_mul_hi_u32_u24 v121, s37, v29
    v_mul_hi_u32_u24 v120, s36, v29
    v_mad_i32_i24 v110, v122, s44, v65
    v_mad_u32_u24 v65, v122, 40, v121
    v_mad_i32_i24 v29, v120, s39, v29
    v_lshlrev_b16 v65, 2, v65
    v_mad_i32_i24 v120, v121, -3, v120
    ds_add_u32 v65, v3 offset:0
    v_lshl_or_b32 v29, v110, 16, v29
    v_lshl_or_b32 v29, v120, 30, v29
    v_lshrrev_b32 v118, 3, v117
    v_lshrrev_b32 v119, 8, v117
    v_lshlrev_b16 v117, 13, v117
    v_bitop3_b32 v119, v118, v119, v124 bitop3:0x1b
    v_bitop3_b32 v28, v117, v125, v28 bitop3:0xae
    v_lshl_or_b32 v64, v119, 16, v64
    v_bitop3_b32 v29, v118, v125, v29 bitop3:0xae
    v_bitop3_b32 v65, v119, v126, v65 bitop3:0xea
    v_lshlrev_b32 v117, 16, v89
    v_and_b32 v118, v126, v89
    v_mul_f32 v117, v123, v117
    v_mul_f32 v118, v123, v118
    v_cvt_pk_bf16_f32 v117, v117, v118
    v_and_b32 v118, v126, v117
    v_lshlrev_b32 v117, 16, v117
    v_mul_f32 v117, 0.15915494, v117
    v_mul_f32 v118, 0.15915494, v118
    v_fract_f32 v117, v117
    v_fract_f32 v118, v118
    v_cos_f32 v117, v117
    v_cos_f32 v118, v118
    v_mul_hi_u32_u24 v122, s38, v66
    v_mul_hi_u32_u24 v121, s37, v30
    v_mul_hi_u32_u24 v120, s36, v30
    v_mad_i32_i24 v110, v122, s44, v66
    v_mad_u32_u24 v66, v122, 40, v121
    v_mad_i32_i24 v30, v120, s39, v30
    v_lshlrev_b16 v66, 2, v66
    v_mad_i32_i24 v120, v121, -3, v120
    ds_add_u32 v66, v3 offset:0
    v_lshl_or_b32 v30, v110, 16, v30
    v_lshl_or_b32 v30, v120, 30, v30
    v_mul_f32 v117, 0x03800000, v117
    v_mul_f32 v118, 0x03800000, v118
    v_cvt_pk_bf16_f32 v117, v117, v118
    v_mul_hi_u32_u24 v122, s38, v67
    v_mul_hi_u32_u24 v121, s37, v31
    v_mul_hi_u32_u24 v120, s36, v31
    v_mad_i32_i24 v110, v122, s44, v67
    v_mad_u32_u24 v67, v122, 40, v121
    v_mad_i32_i24 v31, v120, s39, v31
    v_lshlrev_b16 v67, 2, v67
    v_mad_i32_i24 v120, v121, -3, v120
    ds_add_u32 v67, v3 offset:0
    v_lshl_or_b32 v31, v110, 16, v31
    v_lshl_or_b32 v31, v120, 30, v31
    v_lshrrev_b32 v118, 3, v117
    v_lshrrev_b32 v119, 8, v117
    v_lshlrev_b16 v117, 13, v117
    v_bitop3_b32 v119, v118, v119, v124 bitop3:0x1b
    v_bitop3_b32 v30, v117, v125, v30 bitop3:0xae
    v_lshl_or_b32 v66, v119, 16, v66
    v_bitop3_b32 v31, v118, v125, v31 bitop3:0xae
    v_bitop3_b32 v67, v119, v126, v67 bitop3:0xea
p1_k11:
    s_cmp_ge_u32 s29, 1312
    s_cbranch_scc1 p1_k13
    s_waitcnt vmcnt(2)
    v_lshlrev_b32 v117, 16, v90
    v_and_b32 v118, v126, v90
    v_mul_f32 v117, v123, v117
    v_mul_f32 v118, v123, v118
    v_cvt_pk_bf16_f32 v117, v117, v118
    v_and_b32 v118, v126, v117
    v_lshlrev_b32 v117, 16, v117
    v_mul_f32 v117, 0.15915494, v117
    v_mul_f32 v118, 0.15915494, v118
    v_fract_f32 v117, v117
    v_fract_f32 v118, v118
    v_cos_f32 v117, v117
    v_cos_f32 v118, v118
    v_mul_hi_u32_u24 v122, s38, v68
    v_mul_hi_u32_u24 v121, s37, v32
    v_mul_hi_u32_u24 v120, s36, v32
    v_mad_i32_i24 v110, v122, s44, v68
    v_mad_u32_u24 v68, v122, 40, v121
    v_mad_i32_i24 v32, v120, s39, v32
    v_lshlrev_b16 v68, 2, v68
    v_mad_i32_i24 v120, v121, -3, v120
    ds_add_u32 v68, v3 offset:0
    v_lshl_or_b32 v32, v110, 16, v32
    v_lshl_or_b32 v32, v120, 30, v32
    v_mul_f32 v117, 0x03800000, v117
    v_mul_f32 v118, 0x03800000, v118
    v_cvt_pk_bf16_f32 v117, v117, v118
    v_mul_hi_u32_u24 v122, s38, v69
    v_mul_hi_u32_u24 v121, s37, v33
    v_mul_hi_u32_u24 v120, s36, v33
    v_mad_i32_i24 v110, v122, s44, v69
    v_mad_u32_u24 v69, v122, 40, v121
    v_mad_i32_i24 v33, v120, s39, v33
    v_lshlrev_b16 v69, 2, v69
    v_mad_i32_i24 v120, v121, -3, v120
    ds_add_u32 v69, v3 offset:0
    v_lshl_or_b32 v33, v110, 16, v33
    v_lshl_or_b32 v33, v120, 30, v33
    v_lshrrev_b32 v118, 3, v117
    v_lshrrev_b32 v119, 8, v117
    v_lshlrev_b16 v117, 13, v117
    v_bitop3_b32 v119, v118, v119, v124 bitop3:0x1b
    v_bitop3_b32 v32, v117, v125, v32 bitop3:0xae
    v_lshl_or_b32 v68, v119, 16, v68
    v_bitop3_b32 v33, v118, v125, v33 bitop3:0xae
    v_bitop3_b32 v69, v119, v126, v69 bitop3:0xea
    v_lshlrev_b32 v117, 16, v91
    v_and_b32 v118, v126, v91
    v_mul_f32 v117, v123, v117
    v_mul_f32 v118, v123, v118
    v_cvt_pk_bf16_f32 v117, v117, v118
    v_and_b32 v118, v126, v117
    v_lshlrev_b32 v117, 16, v117
    v_mul_f32 v117, 0.15915494, v117
    v_mul_f32 v118, 0.15915494, v118
    v_fract_f32 v117, v117
    v_fract_f32 v118, v118
    v_cos_f32 v117, v117
    v_cos_f32 v118, v118
    v_mul_hi_u32_u24 v122, s38, v70
    v_mul_hi_u32_u24 v121, s37, v34
    v_mul_hi_u32_u24 v120, s36, v34
    v_mad_i32_i24 v110, v122, s44, v70
    v_mad_u32_u24 v70, v122, 40, v121
    v_mad_i32_i24 v34, v120, s39, v34
    v_lshlrev_b16 v70, 2, v70
    v_mad_i32_i24 v120, v121, -3, v120
    ds_add_u32 v70, v3 offset:0
    v_lshl_or_b32 v34, v110, 16, v34
    v_lshl_or_b32 v34, v120, 30, v34
    v_mul_f32 v117, 0x03800000, v117
    v_mul_f32 v118, 0x03800000, v118
    v_cvt_pk_bf16_f32 v117, v117, v118
    v_mul_hi_u32_u24 v122, s38, v71
    v_mul_hi_u32_u24 v121, s37, v35
    v_mul_hi_u32_u24 v120, s36, v35
    v_mad_i32_i24 v110, v122, s44, v71
    v_mad_u32_u24 v71, v122, 40, v121
    v_mad_i32_i24 v35, v120, s39, v35
    v_lshlrev_b16 v71, 2, v71
    v_mad_i32_i24 v120, v121, -3, v120
    ds_add_u32 v71, v3 offset:0
    v_lshl_or_b32 v35, v110, 16, v35
    v_lshl_or_b32 v35, v120, 30, v35
    v_lshrrev_b32 v118, 3, v117
    v_lshrrev_b32 v119, 8, v117
    v_lshlrev_b16 v117, 13, v117
    v_bitop3_b32 v119, v118, v119, v124 bitop3:0x1b
    v_bitop3_b32 v34, v117, v125, v34 bitop3:0xae
    v_lshl_or_b32 v70, v119, 16, v70
    v_bitop3_b32 v35, v118, v125, v35 bitop3:0xae
    v_bitop3_b32 v71, v119, v126, v71 bitop3:0xea
p1_k13:
    s_cmp_ge_u32 s29, 1285
    s_cbranch_scc1 p1_k15
    s_waitcnt vmcnt(0)
    v_lshlrev_b32 v117, 16, v92
    v_and_b32 v118, v126, v92
    v_mul_f32 v117, v123, v117
    v_mul_f32 v118, v123, v118
    v_cvt_pk_bf16_f32 v117, v117, v118
    v_and_b32 v118, v126, v117
    v_lshlrev_b32 v117, 16, v117
    v_mul_f32 v117, 0.15915494, v117
    v_mul_f32 v118, 0.15915494, v118
    v_fract_f32 v117, v117
    v_fract_f32 v118, v118
    v_cos_f32 v117, v117
    v_cos_f32 v118, v118
    v_mul_hi_u32_u24 v122, s38, v72
    v_mul_hi_u32_u24 v121, s37, v36
    v_mul_hi_u32_u24 v120, s36, v36
    v_mad_i32_i24 v110, v122, s44, v72
    v_mad_u32_u24 v72, v122, 40, v121
    v_mad_i32_i24 v36, v120, s39, v36
    v_lshlrev_b16 v72, 2, v72
    v_mad_i32_i24 v120, v121, -3, v120
    ds_add_u32 v72, v3 offset:0
    v_lshl_or_b32 v36, v110, 16, v36
    v_lshl_or_b32 v36, v120, 30, v36
    v_mul_f32 v117, 0x03800000, v117
    v_mul_f32 v118, 0x03800000, v118
    v_cvt_pk_bf16_f32 v117, v117, v118
    v_mul_hi_u32_u24 v122, s38, v73
    v_mul_hi_u32_u24 v121, s37, v37
    v_mul_hi_u32_u24 v120, s36, v37
    v_mad_i32_i24 v110, v122, s44, v73
    v_mad_u32_u24 v73, v122, 40, v121
    v_mad_i32_i24 v37, v120, s39, v37
    v_lshlrev_b16 v73, 2, v73
    v_mad_i32_i24 v120, v121, -3, v120
    ds_add_u32 v73, v3 offset:0
    v_lshl_or_b32 v37, v110, 16, v37
    v_lshl_or_b32 v37, v120, 30, v37
    v_lshrrev_b32 v118, 3, v117
    v_lshrrev_b32 v119, 8, v117
    v_lshlrev_b16 v117, 13, v117
    v_bitop3_b32 v119, v118, v119, v124 bitop3:0x1b
    v_bitop3_b32 v36, v117, v125, v36 bitop3:0xae
    v_lshl_or_b32 v72, v119, 16, v72
    v_bitop3_b32 v37, v118, v125, v37 bitop3:0xae
    v_bitop3_b32 v73, v119, v126, v73 bitop3:0xea
    v_lshlrev_b32 v117, 16, v93
    v_and_b32 v118, v126, v93
    v_mul_f32 v117, v123, v117
    v_mul_f32 v118, v123, v118
    v_cvt_pk_bf16_f32 v117, v117, v118
    v_and_b32 v118, v126, v117
    v_lshlrev_b32 v117, 16, v117
    v_mul_f32 v117, 0.15915494, v117
    v_mul_f32 v118, 0.15915494, v118
    v_fract_f32 v117, v117
    v_fract_f32 v118, v118
    v_cos_f32 v117, v117
    v_cos_f32 v118, v118
    v_mul_hi_u32_u24 v122, s38, v74
    v_mul_hi_u32_u24 v121, s37, v38
    v_mul_hi_u32_u24 v120, s36, v38
    v_mad_i32_i24 v110, v122, s44, v74
    v_mad_u32_u24 v74, v122, 40, v121
    v_mad_i32_i24 v38, v120, s39, v38
    v_lshlrev_b16 v74, 2, v74
    v_mad_i32_i24 v120, v121, -3, v120
    ds_add_u32 v74, v3 offset:0
    v_lshl_or_b32 v38, v110, 16, v38
    v_lshl_or_b32 v38, v120, 30, v38
    v_mul_f32 v117, 0x03800000, v117
    v_mul_f32 v118, 0x03800000, v118
    v_cvt_pk_bf16_f32 v117, v117, v118
    v_mul_hi_u32_u24 v122, s38, v75
    v_mul_hi_u32_u24 v121, s37, v39
    v_mul_hi_u32_u24 v120, s36, v39
    v_mad_i32_i24 v110, v122, s44, v75
    v_mad_u32_u24 v75, v122, 40, v121
    v_mad_i32_i24 v39, v120, s39, v39
    v_lshlrev_b16 v75, 2, v75
    v_mad_i32_i24 v120, v121, -3, v120
    ds_add_u32 v75, v3 offset:0
    v_lshl_or_b32 v39, v110, 16, v39
    v_lshl_or_b32 v39, v120, 30, v39
    v_lshrrev_b32 v118, 3, v117
    v_lshrrev_b32 v119, 8, v117
    v_lshlrev_b16 v117, 13, v117
    v_bitop3_b32 v119, v118, v119, v124 bitop3:0x1b
    v_bitop3_b32 v38, v117, v125, v38 bitop3:0xae
    v_lshl_or_b32 v74, v119, 16, v74
    v_bitop3_b32 v39, v118, v125, v39 bitop3:0xae
    v_bitop3_b32 v75, v119, v126, v75 bitop3:0xea
p1_k15:
    s_waitcnt vmcnt(0)
    s_cmp_lg_u32 s28, 15
    s_cbranch_scc1 p1_tk1
    v_mov_b32 v126, 0
    s_mov_b64 exec, 1
    ds_write_b32 v126, v127 offset:10456
    s_mov_b64 exec, -1
p1_tk1:
    s_waitcnt lgkmcnt(0)
    s_barrier
    s_cmp_ge_u32 s28, 10
    s_cbranch_scc1 p1_s1_skip
    v_and_b32 v126, 63, v0
    s_lshl_b32 s54, s28, 4
    v_mul_u32_u24 v117, 160, v126
    v_add_u32 v117, s54, v117
    ds_read_b128 v[118:121], v117 offset:0
    s_waitcnt lgkmcnt(0)
    v_add_u32 v118, 2, v118
    v_add_u32 v119, 2, v119
    v_add_u32 v120, 2, v120
    v_add_u32 v121, 2, v121
    v_mul_u32_u24 v118, 43691, v118
    v_mul_u32_u24 v119, 43691, v119
    v_mul_u32_u24 v120, 43691, v120
    v_mul_u32_u24 v121, 43691, v121
    v_lshrrev_b32 v118, 17, v118
    v_lshrrev_b32 v119, 17, v119
    v_lshrrev_b32 v120, 17, v120
    v_lshrrev_b32 v121, 17, v121
    v_lshl_or_b32 v122, v119, 16, v118
    v_lshl_or_b32 v123, v121, 16, v120
    v_mov_b32 v124, v122
    v_mov_b32 v125, v123
    s_nop 1
    v_add_u32_dpp v124, v124, v124 row_shr:1 row_mask:0xf bank_mask:0xf bound_ctrl:0
    v_add_u32_dpp v125, v125, v125 row_shr:1 row_mask:0xf bank_mask:0xf bound_ctrl:0
    s_nop 0
    v_add_u32_dpp v124, v124, v124 row_shr:2 row_mask:0xf bank_mask:0xf bound_ctrl:0
    v_add_u32_dpp v125, v125, v125 row_shr:2 row_mask:0xf bank_mask:0xf bound_ctrl:0
    s_nop 0
    v_add_u32_dpp v124, v124, v124 row_shr:4 row_mask:0xf bank_mask:0xf bound_ctrl:0
    v_add_u32_dpp v125, v125, v125 row_shr:4 row_mask:0xf bank_mask:0xf bound_ctrl:0
    s_nop 0
    v_add_u32_dpp v124, v124, v124 row_shr:8 row_mask:0xf bank_mask:0xf bound_ctrl:0
    v_add_u32_dpp v125, v125, v125 row_shr:8 row_mask:0xf bank_mask:0xf bound_ctrl:0
    s_nop 0
    v_add_u32_dpp v124, v124, v124 row_bcast:15 row_mask:0xa bank_mask:0xf
    v_add_u32_dpp v125, v125, v125 row_bcast:15 row_mask:0xa bank_mask:0xf
    s_nop 0
    v_add_u32_dpp v124, v124, v124 row_bcast:31 row_mask:0xc bank_mask:0xf
    v_add_u32_dpp v125, v125, v125 row_bcast:31 row_mask:0xc bank_mask:0xf
    s_nop 0
    s_nop 0
    v_mov_b32 v127, s54
    v_and_b32 v118, 0xffff, v124
    v_lshrrev_b32 v119, 16, v124
    v_and_b32 v120, 0xffff, v125
    v_lshrrev_b32 v121, 16, v125
    s_mov_b64 exec, 1
    s_lshl_b64 exec, exec, 63
    ds_write_b128 v127, v[118:121] offset:10240
    s_mov_b64 exec, -1
p1_s1_skip:
    s_waitcnt lgkmcnt(0)
    s_barrier
    v_and_b32 v127, 63, v0
    v_lshlrev_b32 v118, 2, v127
    v_cmp_gt_u32 vcc, 40, v127
    ds_read_b32 v119, v118 offset:10240
    s_waitcnt lgkmcnt(0)
    v_readlane_b32 s33, v119, 54
    v_cndmask_b32 v119, 0, v119, vcc
    v_mov_b32 v120, v119
    s_nop 1
    v_add_u32_dpp v120, v120, v120 row_shr:1 row_mask:0xf bank_mask:0xf bound_ctrl:0
    s_nop 1
    v_add_u32_dpp v120, v120, v120 row_shr:2 row_mask:0xf bank_mask:0xf bound_ctrl:0
    s_nop 1
    v_add_u32_dpp v120, v120, v120 row_shr:4 row_mask:0xf bank_mask:0xf bound_ctrl:0
    s_nop 1
    v_add_u32_dpp v120, v120, v120 row_shr:8 row_mask:0xf bank_mask:0xf bound_ctrl:0
    s_nop 1
    v_add_u32_dpp v120, v120, v120 row_bcast:15 row_mask:0xa bank_mask:0xf
    s_nop 1
    v_add_u32_dpp v120, v120, v120 row_bcast:31 row_mask:0xc bank_mask:0xf
    s_nop 1
    s_nop 0
    v_sub_u32 v119, v120, v119
    v_readlane_b32 s35, v120, 63
    s_add_u32 s33, s33, 256
    s_mul_i32 s46, s33, 2
    s_min_u32 s47, s33, 1445
    s_add_u32 s46, s46, s47
    s_min_u32 s47, s33, 1419
    s_add_u32 s46, s46, s47
    s_min_u32 s47, s33, 1392
    s_add_u32 s46, s46, s47
    s_min_u32 s47, s33, 1365
    s_add_u32 s46, s46, s47
    s_min_u32 s47, s33, 1338
    s_add_u32 s46, s46, s47
    s_min_u32 s47, s33, 1312
    s_add_u32 s46, s46, s47
    s_min_u32 s47, s33, 1285
    s_add_u32 s46, s46, s47
    s_lshl_b32 s30, s46, 14
    s_lshl_b32 s31, s46, 13
    s_cmp_ge_u32 s28, 10
    s_cbranch_scc1 p1_s2_skip
    s_lshl_b32 s54, s28, 2
    s_add_u32 s55, s54, 0
    v_readlane_b32 s56, v119, s55
    s_add_u32 s55, s54, 1
    v_readlane_b32 s57, v119, s55
    s_add_u32 s55, s54, 2
    v_readlane_b32 s58, v119, s55
    s_add_u32 s55, s54, 3
    v_readlane_b32 s59, v119, s55
    s_nop 0
    s_lshl_b32 s57, s57, 16
    s_or_b32 s56, s56, s57
    s_lshl_b32 s59, s59, 16
    s_or_b32 s58, s58, s59
    v_add_u32 v124, s56, v124
    v_add_u32 v125, s58, v125
    v_sub_u32 v122, v124, v122
    v_sub_u32 v123, v125, v123
    v_and_b32 v118, 0xffff, v122
    v_lshrrev_b32 v119, 16, v122
    v_and_b32 v120, 0xffff, v123
    v_lshrrev_b32 v121, 16, v123
    v_mul_u32_u24 v118, 3, v118
    v_mul_u32_u24 v119, 3, v119
    v_mul_u32_u24 v120, 3, v120
    v_mul_u32_u24 v121, 3, v121
    ds_write_b128 v117, v[118:121] offset:0
    s_mul_i32 s55, s29, 5248
    s_mul_i32 s56, s28, 520
    s_add_u32 s55, s55, s56
    s_add_u32 s55, s55, 469762048
    v_lshlrev_b32 v127, 3, v126
    buffer_store_dwordx2 v[122:123], v127, s[16:19], s55 offen sc1
    s_mov_b64 exec, 1
    s_lshl_b64 exec, exec, 63
    buffer_store_dwordx2 v[124:125], v127, s[16:19], s55 offen offset:8 sc1
    s_mov_b64 exec, -1
p1_s2_skip:
    s_mul_i32 s50, s29, 16384
    s_lshr_b32 s52, s35, 10
    s_mul_i32 s52, s52, 33554432
    s_and_b32 s53, s35, 1023
    s_lshl_b32 s53, s53, 4
    s_add_u32 s52, s52, s53
    s_add_u32 s52, s52, s50
    s_min_u32 s22, s52, 469762048
    s_mov_b32 s68, 0
    s_cmp_lt_u32 s28, 2
    s_cselect_b32 s71, 10, 9
    s_cmp_lt_u32 s29, 1285
    s_cselect_b32 s35, 13994, s35
    s_waitcnt lgkmcnt(0)
    s_barrier
    s_cmp_lt_u32 s33, 1472
    s_cbranch_scc1 p1_f0
    s_cmp_lg_u32 s28, 15
    s_cbranch_scc1 p1_hv0
    s_sub_u32 s52, s33, 1472
    s_and_b32 s52, s52, 255
    s_lshl_b32 s58, s52, 2
    s_and_b32 s58, s58, 28
    s_lshl_b32 s53, 1, s58
    v_mov_b32 v127, s53
    s_lshr_b32 s52, s52, 3
    s_lshl_b32 s52, s52, 2
    s_mov_b64 exec, 1
    buffer_atomic_add v127, off, s[40:43], s52 sc0 sc1
    s_mov_b64 exec, -1
p1_hv0:
    s_cmp_ge_u32 s33, 1592
    s_cbranch_scc1 p1_f0
    s_sub_u32 s52, s33, 1472
    s_mul_i32 s52, s52, 53368
    s_mul_i32 s53, s28, 3072
    s_add_u32 s53, s53, s52
    v_and_b32 v92, 63, v0
    v_lshl_add_u32 v93, v92, 2, s53
    s_lshl_b32 s53, s28, 9
    s_add_u32 s53, s53, s52
    s_add_u32 s53, s53, 49152
    s_cmp_lt_u32 s28, 9
    s_cselect_b32 s53, s53, 0x40000000
    v_lshl_add_u32 v94, v92, 2, s53
    buffer_load_dword v76, v93, s[24:27], 0 offen offset:0
    buffer_load_dword v77, v93, s[24:27], 0 offen offset:256
    buffer_load_dword v78, v93, s[24:27], 0 offen offset:512
    buffer_load_dword v79, v93, s[24:27], 0 offen offset:768
    buffer_load_dword v80, v93, s[24:27], 0 offen offset:1024
    buffer_load_dword v81, v93, s[24:27], 0 offen offset:1280
    buffer_load_dword v82, v93, s[24:27], 0 offen offset:1536
    buffer_load_dword v83, v93, s[24:27], 0 offen offset:1792
    buffer_load_dword v84, v93, s[24:27], 0 offen offset:2048
    buffer_load_dword v85, v93, s[24:27], 0 offen offset:2304
    buffer_load_dword v86, v93, s[24:27], 0 offen offset:2560
    buffer_load_dword v87, v93, s[24:27], 0 offen offset:2816
    buffer_load_dword v88, v94, s[24:27], 0 offen offset:0
    buffer_load_dword v89, v94, s[24:27], 0 offen offset:256
p1_f0:
    v_and_b32 v117, 0xffff, v40
    ds_add_rtn_u32 v117, v117, v3 offset:0
    v_and_b32 v118, 0xffff, v41
    ds_add_rtn_u32 v118, v118, v3 offset:0
    v_and_b32 v119, 0xffff, v42
    ds_add_rtn_u32 v119, v119, v3 offset:0
    v_and_b32 v120, 0xffff, v43
    ds_add_rtn_u32 v120, v120, v3 offset:0
    s_cmp_ge_u32 s33, 1472
    s_cbranch_scc1 p1_k17
    s_cmp_lt_u32 s33, 1472
    s_cselect_b32 s6, 204800000, 0
    s_add_u32 s32, s30, 0
    buffer_load_dwordx4 v[94:97], v1, s[4:7], s32 offen nt
p1_k17:
    s_cmp_ge_u32 s33, 1472
    s_cbranch_scc1 p1_k18
    s_cmp_lt_u32 s33, 1472
    s_cselect_b32 s14, 102400000, 0
    s_add_u32 s32, s31, 0
    buffer_load_dwordx2 v[76:77], v2, s[12:15], s32 offen nt
p1_k18:
    s_cmp_ge_u32 s33, 1472
    s_cbranch_scc1 p1_k19
    s_cmp_lt_u32 s33, 1472
    s_cselect_b32 s14, 102400000, 0
    s_add_u32 s32, s31, 8192
    buffer_load_dwordx2 v[78:79], v2, s[12:15], s32 offen nt
p1_k19:
    s_cmp_lt_u32 s29, 1445
    s_cbranch_scc1 p1_pa0
    s_waitcnt lgkmcnt(0)
    s_branch p1_pb0
p1_pa0:
    v_and_b32 v121, 0xffff, v48
    ds_add_rtn_u32 v121, v121, v3 offset:0
    v_and_b32 v122, 0xffff, v49
    ds_add_rtn_u32 v122, v122, v3 offset:0
    v_and_b32 v123, 0xffff, v50
    ds_add_rtn_u32 v123, v123, v3 offset:0
    v_and_b32 v124, 0xffff, v51
    ds_add_rtn_u32 v124, v124, v3 offset:0
    s_waitcnt lgkmcnt(4)
p1_pb0:
    ds_write_b8_d16_hi v117, v40 offset:10496
    v_sub_u32 v40, 55295, v117
    v_lshlrev_b32 v117, 2, v117
    ds_write_b32 v117, v4 offset:52480
    ds_write_b8_d16_hi v118, v41 offset:10496
    v_sub_u32 v41, 55295, v118
    v_lshlrev_b32 v118, 2, v118
    ds_write_b32 v118, v5 offset:52480
    ds_write_b8_d16_hi v119, v42 offset:10496
    v_sub_u32 v42, 55295, v119
    v_lshlrev_b32 v119, 2, v119
    ds_write_b32 v119, v6 offset:52480
    ds_write_b8_d16_hi v120, v43 offset:10496
    v_sub_u32 v43, 55295, v120
    v_lshlrev_b32 v120, 2, v120
    ds_write_b32 v120, v7 offset:52480
    s_cmp_ge_u32 s33, 1472
    s_cbranch_scc1 p1_k20
    s_cmp_lt_u32 s33, 1472
    s_cselect_b32 s10, 204800000, 0
    s_add_u32 s32, s30, 0
    buffer_load_dwordx4 v[102:105], v1, s[8:11], s32 offen nt
p1_k20:
    s_cmp_ge_u32 s33, 1472
    s_cbranch_scc1 p1_k21
    s_cmp_lt_u32 s33, 1445
    s_cselect_b32 s14, 102400000, 0
    s_add_u32 s32, s31, 16384
    buffer_load_dwordx2 v[80:81], v2, s[12:15], s32 offen nt
p1_k21:
    s_cmp_ge_u32 s33, 1472
    s_cbranch_scc1 p1_k22
    s_cmp_lt_u32 s33, 1419
    s_cselect_b32 s14, 102400000, 0
    s_add_u32 s32, s31, 24576
    buffer_load_dwordx2 v[82:83], v2, s[12:15], s32 offen nt
p1_k22:
    v_and_b32 v117, 0xffff, v44
    ds_add_rtn_u32 v117, v117, v3 offset:0
    v_and_b32 v118, 0xffff, v45
    ds_add_rtn_u32 v118, v118, v3 offset:0
    v_and_b32 v119, 0xffff, v46
    ds_add_rtn_u32 v119, v119, v3 offset:0
    v_and_b32 v120, 0xffff, v47
    ds_add_rtn_u32 v120, v120, v3 offset:0
    s_waitcnt lgkmcnt(4)
    s_cmp_ge_u32 s29, 1445
    s_cbranch_scc1 p1_k23
    ds_write_b8_d16_hi v121, v48 offset:10496
    v_sub_u32 v48, 55295, v121
    v_lshlrev_b32 v121, 2, v121
    v_lshl_or_b32 v40, v48, 16, v40
    ds_write_b32 v121, v12 offset:52480
    ds_write_b8_d16_hi v122, v49 offset:10496
    v_sub_u32 v49, 55295, v122
    v_lshlrev_b32 v122, 2, v122
    v_lshl_or_b32 v41, v49, 16, v41
    ds_write_b32 v122, v13 offset:52480
    ds_write_b8_d16_hi v123, v50 offset:10496
    v_sub_u32 v50, 55295, v123
    v_lshlrev_b32 v123, 2, v123
    v_lshl_or_b32 v42, v50, 16, v42
    ds_write_b32 v123, v14 offset:52480
    ds_write_b8_d16_hi v124, v51 offset:10496
    v_sub_u32 v51, 55295, v124
    v_lshlrev_b32 v124, 2, v124
    v_lshl_or_b32 v43, v51, 16, v43
    ds_write_b32 v124, v15 offset:52480
p1_k23:
    s_cmp_ge_u32 s33, 1472
    s_cbranch_scc1 p1_k24
    s_cmp_lt_u32 s33, 1445
    s_cselect_b32 s10, 204800000, 0
    s_add_u32 s32, s30, 32768
    buffer_load_dwordx4 v[48:51], v1, s[8:11], s32 offen nt
p1_k24:
    s_cmp_ge_u32 s33, 1472
    s_cbranch_scc1 p1_k25
    s_cmp_lt_u32 s33, 1392
    s_cselect_b32 s14, 102400000, 0
    s_add_u32 s32, s31, 32768
    buffer_load_dwordx2 v[84:85], v2, s[12:15], s32 offen nt
p1_k25:
    s_cmp_ge_u32 s33, 1472
    s_cbranch_scc1 p1_k26
    s_cmp_lt_u32 s33, 1365
    s_cselect_b32 s14, 102400000, 0
    s_add_u32 s32, s31, 40960
    buffer_load_dwordx2 v[86:87], v2, s[12:15], s32 offen nt
p1_k26:
    s_cmp_lt_u32 s29, 1419
    s_cbranch_scc1 p1_pa2
    s_waitcnt lgkmcnt(0)
    s_branch p1_pb2
p1_pa2:
    v_and_b32 v121, 0xffff, v52
    ds_add_rtn_u32 v121, v121, v3 offset:0
    v_and_b32 v122, 0xffff, v53
    ds_add_rtn_u32 v122, v122, v3 offset:0
    v_and_b32 v123, 0xffff, v54
    ds_add_rtn_u32 v123, v123, v3 offset:0
    v_and_b32 v124, 0xffff, v55
    ds_add_rtn_u32 v124, v124, v3 offset:0
    s_waitcnt lgkmcnt(4)
p1_pb2:
    ds_write_b8_d16_hi v117, v44 offset:10496
    v_sub_u32 v44, 55295, v117
    v_lshlrev_b32 v117, 2, v117
    ds_write_b32 v117, v8 offset:52480
    ds_write_b8_d16_hi v118, v45 offset:10496
    v_sub_u32 v45, 55295, v118
    v_lshlrev_b32 v118, 2, v118
    ds_write_b32 v118, v9 offset:52480
    ds_write_b8_d16_hi v119, v46 offset:10496
    v_sub_u32 v46, 55295, v119
    v_lshlrev_b32 v119, 2, v119
    ds_write_b32 v119, v10 offset:52480
    ds_write_b8_d16_hi v120, v47 offset:10496
    v_sub_u32 v47, 55295, v120
    v_lshlrev_b32 v120, 2, v120
    ds_write_b32 v120, v11 offset:52480
    s_cmp_ge_u32 s28, 10
    s_cbranch_scc1 p1_jn
    s_waitcnt vmcnt(0)
    v_mov_b32 v125, 0
    s_mov_b64 exec, 1
    ds_add_rtn_u32 v125, v125, v3 offset:10432
    s_waitcnt lgkmcnt(0)
    v_readfirstlane_b32 s52, v125
    s_lshr_b32 s53, s29, 1
    s_and_b32 s53, s53, 28
    s_cmp_lg_u32 s52, 9
    s_cbranch_scc1 p1_jn1
    s_lshl_b32 s54, 1, s53
    v_mov_b32 v127, s54
    s_lshr_b32 s54, s29, 6
    s_lshl_b32 s54, s54, 2
    s_mov_b32 s68, 1
    buffer_atomic_add v127, off, s[40:43], s54 sc0 sc1
p1_jn1:
    s_mov_b64 exec, -1
p1_jn:
    s_cmp_ge_u32 s33, 1472
    s_cbranch_scc1 p1_k27
    s_cmp_lt_u32 s33, 1472
    s_cselect_b32 s6, 204800000, 0
    s_add_u32 s32, s30, 16384
    buffer_load_dwordx4 v[98:101], v1, s[4:7], s32 offen nt
p1_k27:
    s_cmp_ge_u32 s33, 1472
    s_cbranch_scc1 p1_k28
    s_cmp_lt_u32 s33, 1338
    s_cselect_b32 s14, 102400000, 0
    s_add_u32 s32, s31, 49152
    buffer_load_dwordx2 v[88:89], v2, s[12:15], s32 offen nt
p1_k28:
    s_cmp_ge_u32 s33, 1472
    s_cbranch_scc1 p1_k29
    s_cmp_lt_u32 s33, 1312
    s_cselect_b32 s14, 102400000, 0
    s_add_u32 s32, s31, 57344
    buffer_load_dwordx2 v[90:91], v2, s[12:15], s32 offen nt
p1_k29:
    s_cmp_lt_u32 s29, 1392
    s_cbranch_scc1 p1_pa3
    s_waitcnt lgkmcnt(0)
    s_branch p1_pb3
p1_pa3:
    v_and_b32 v117, 0xffff, v56
    ds_add_rtn_u32 v117, v117, v3 offset:0
    v_and_b32 v118, 0xffff, v57
    ds_add_rtn_u32 v118, v118, v3 offset:0
    v_and_b32 v119, 0xffff, v58
    ds_add_rtn_u32 v119, v119, v3 offset:0
    v_and_b32 v120, 0xffff, v59
    ds_add_rtn_u32 v120, v120, v3 offset:0
    s_waitcnt lgkmcnt(4)
p1_pb3:
    s_cmp_ge_u32 s29, 1419
    s_cbranch_scc1 p1_k30
    ds_write_b8_d16_hi v121, v52 offset:10496
    v_sub_u32 v52, 55295, v121
    v_lshlrev_b32 v121, 2, v121
    v_lshl_or_b32 v44, v52, 16, v44
    ds_write_b32 v121, v16 offset:52480
    ds_write_b8_d16_hi v122, v53 offset:10496
    v_sub_u32 v53, 55295, v122
    v_lshlrev_b32 v122, 2, v122
    v_lshl_or_b32 v45, v53, 16, v45
    ds_write_b32 v122, v17 offset:52480
    ds_write_b8_d16_hi v123, v54 offset:10496
    v_sub_u32 v54, 55295, v123
    v_lshlrev_b32 v123, 2, v123
    v_lshl_or_b32 v46, v54, 16, v46
    ds_write_b32 v123, v18 offset:52480
    ds_write_b8_d16_hi v124, v55 offset:10496
    v_sub_u32 v55, 55295, v124
    v_lshlrev_b32 v124, 2, v124
    v_lshl_or_b32 v47, v55, 16, v47
    ds_write_b32 v124, v19 offset:52480
p1_k30:
    s_cmp_ge_u32 s33, 1472
    s_cbranch_scc1 p1_k31
    s_cmp_lt_u32 s33, 1419
    s_cselect_b32 s10, 204800000, 0
    s_add_u32 s32, s30, 49152
    buffer_load_dwordx4 v[52:55], v1, s[8:11], s32 offen nt
p1_k31:
    s_cmp_ge_u32 s33, 1472
    s_cbranch_scc1 p1_k32
    s_cmp_lt_u32 s33, 1285
    s_cselect_b32 s14, 102400000, 0
    s_add_u32 s32, s31, 65536
    buffer_load_dwordx2 v[92:93], v2, s[12:15], s32 offen nt
p1_k32:
    s_cmp_lt_u32 s29, 1365
    s_cbranch_scc1 p1_pa4
    s_waitcnt lgkmcnt(0)
    s_branch p1_pb4
p1_pa4:
    v_and_b32 v121, 0xffff, v60
    ds_add_rtn_u32 v121, v121, v3 offset:0
    v_and_b32 v122, 0xffff, v61
    ds_add_rtn_u32 v122, v122, v3 offset:0
    v_and_b32 v123, 0xffff, v62
    ds_add_rtn_u32 v123, v123, v3 offset:0
    v_and_b32 v124, 0xffff, v63
    ds_add_rtn_u32 v124, v124, v3 offset:0
    s_waitcnt lgkmcnt(4)
p1_pb4:
    s_cmp_ge_u32 s29, 1392
    s_cbranch_scc1 p1_k33
    ds_write_b8_d16_hi v117, v56 offset:10496
    v_sub_u32 v56, 55295, v117
    v_lshlrev_b32 v117, 2, v117
    ds_write_b32 v117, v20 offset:52480
    ds_write_b8_d16_hi v118, v57 offset:10496
    v_sub_u32 v57, 55295, v118
    v_lshlrev_b32 v118, 2, v118
    ds_write_b32 v118, v21 offset:52480
    ds_write_b8_d16_hi v119, v58 offset:10496
    v_sub_u32 v58, 55295, v119
    v_lshlrev_b32 v119, 2, v119
    ds_write_b32 v119, v22 offset:52480
    ds_write_b8_d16_hi v120, v59 offset:10496
    v_sub_u32 v59, 55295, v120
    v_lshlrev_b32 v120, 2, v120
    ds_write_b32 v120, v23 offset:52480
p1_k33:
    s_cmp_ge_u32 s33, 1472
    s_cbranch_scc1 p1_k34
    s_cmp_lt_u32 s33, 1472
    s_cselect_b32 s10, 204800000, 0
    s_add_u32 s32, s30, 16384
    buffer_load_dwordx4 v[106:109], v1, s[8:11], s32 offen nt
p1_k34:
    s_cmp_lt_u32 s29, 1338
    s_cbranch_scc1 p1_pa5
    s_waitcnt lgkmcnt(0)
    s_branch p1_pb5
p1_pa5:
    v_and_b32 v117, 0xffff, v64
    ds_add_rtn_u32 v117, v117, v3 offset:0
    v_and_b32 v118, 0xffff, v65
    ds_add_rtn_u32 v118, v118, v3 offset:0
    v_and_b32 v119, 0xffff, v66
    ds_add_rtn_u32 v119, v119, v3 offset:0
    v_and_b32 v120, 0xffff, v67
    ds_add_rtn_u32 v120, v120, v3 offset:0
    s_waitcnt lgkmcnt(4)
p1_pb5:
    s_cmp_ge_u32 s29, 1365
    s_cbranch_scc1 p1_k35
    ds_write_b8_d16_hi v121, v60 offset:10496
    v_sub_u32 v60, 55295, v121
    v_lshlrev_b32 v121, 2, v121
    v_lshl_or_b32 v56, v60, 16, v56
    ds_write_b32 v121, v24 offset:52480
    ds_write_b8_d16_hi v122, v61 offset:10496
    v_sub_u32 v61, 55295, v122
    v_lshlrev_b32 v122, 2, v122
    v_lshl_or_b32 v57, v61, 16, v57
    ds_write_b32 v122, v25 offset:52480
    ds_write_b8_d16_hi v123, v62 offset:10496
    v_sub_u32 v62, 55295, v123
    v_lshlrev_b32 v123, 2, v123
    v_lshl_or_b32 v58, v62, 16, v58
    ds_write_b32 v123, v26 offset:52480
    ds_write_b8_d16_hi v124, v63 offset:10496
    v_sub_u32 v63, 55295, v124
    v_lshlrev_b32 v124, 2, v124
    v_lshl_or_b32 v59, v63, 16, v59
    ds_write_b32 v124, v27 offset:52480
p1_k35:
    s_cmp_ge_u32 s33, 1472
    s_cbranch_scc1 p1_k36
    s_cmp_lt_u32 s33, 1365
    s_cselect_b32 s10, 204800000, 0
    s_add_u32 s32, s30, 81920
    buffer_load_dwordx4 v[60:63], v1, s[8:11], s32 offen nt
p1_k36:
    s_cmp_lt_u32 s29, 1312
    s_cbranch_scc1 p1_pa6
    s_waitcnt lgkmcnt(0)
    s_branch p1_pb6
p1_pa6:
    v_and_b32 v121, 0xffff, v68
    ds_add_rtn_u32 v121, v121, v3 offset:0
    v_and_b32 v122, 0xffff, v69
    ds_add_rtn_u32 v122, v122, v3 offset:0
    v_and_b32 v123, 0xffff, v70
    ds_add_rtn_u32 v123, v123, v3 offset:0
    v_and_b32 v124, 0xffff, v71
    ds_add_rtn_u32 v124, v124, v3 offset:0
    s_waitcnt lgkmcnt(4)
p1_pb6:
    s_cmp_ge_u32 s29, 1338
    s_cbranch_scc1 p1_k37
    ds_write_b8_d16_hi v117, v64 offset:10496
    v_sub_u32 v64, 55295, v117
    v_lshlrev_b32 v117, 2, v117
    ds_write_b32 v117, v28 offset:52480
    ds_write_b8_d16_hi v118, v65 offset:10496
    v_sub_u32 v65, 55295, v118
    v_lshlrev_b32 v118, 2, v118
    ds_write_b32 v118, v29 offset:52480
    ds_write_b8_d16_hi v119, v66 offset:10496
    v_sub_u32 v66, 55295, v119
    v_lshlrev_b32 v119, 2, v119
    ds_write_b32 v119, v30 offset:52480
    ds_write_b8_d16_hi v120, v67 offset:10496
    v_sub_u32 v67, 55295, v120
    v_lshlrev_b32 v120, 2, v120
    ds_write_b32 v120, v31 offset:52480
p1_k37:
    s_cmp_lt_u32 s29, 1285
    s_cbranch_scc1 p1_pa7
    s_waitcnt lgkmcnt(0)
    s_branch p1_pb7
p1_pa7:
    v_and_b32 v117, 0xffff, v72
    ds_add_rtn_u32 v117, v117, v3 offset:0
    v_and_b32 v118, 0xffff, v73
    ds_add_rtn_u32 v118, v118, v3 offset:0
    v_and_b32 v119, 0xffff, v74
    ds_add_rtn_u32 v119, v119, v3 offset:0
    v_and_b32 v120, 0xffff, v75
    ds_add_rtn_u32 v120, v120, v3 offset:0
    s_waitcnt lgkmcnt(4)
p1_pb7:
    s_cmp_ge_u32 s29, 1312
    s_cbranch_scc1 p1_k38
    ds_write_b8_d16_hi v121, v68 offset:10496
    v_sub_u32 v68, 55295, v121
    v_lshlrev_b32 v121, 2, v121
    v_lshl_or_b32 v64, v68, 16, v64
    ds_write_b32 v121, v32 offset:52480
    ds_write_b8_d16_hi v122, v69 offset:10496
    v_sub_u32 v69, 55295, v122
    v_lshlrev_b32 v122, 2, v122
    v_lshl_or_b32 v65, v69, 16, v65
    ds_write_b32 v122, v33 offset:52480
    ds_write_b8_d16_hi v123, v70 offset:10496
    v_sub_u32 v70, 55295, v123
    v_lshlrev_b32 v123, 2, v123
    v_lshl_or_b32 v66, v70, 16, v66
    ds_write_b32 v123, v34 offset:52480
    ds_write_b8_d16_hi v124, v71 offset:10496
    v_sub_u32 v71, 55295, v124
    v_lshlrev_b32 v124, 2, v124
    v_lshl_or_b32 v67, v71, 16, v67
    ds_write_b32 v124, v35 offset:52480
p1_k38:
    s_cmp_ge_u32 s33, 1472
    s_cbranch_scc1 p1_k39
    s_cmp_lt_u32 s33, 1312
    s_cselect_b32 s10, 204800000, 0
    s_add_u32 s32, s30, 114688
    buffer_load_dwordx4 v[68:71], v1, s[8:11], s32 offen nt
p1_k39:
    s_waitcnt lgkmcnt(0)
    s_cmp_ge_u32 s29, 1285
    s_cbranch_scc1 p1_k40
    ds_write_b8_d16_hi v117, v72 offset:10496
    v_sub_u32 v72, 55295, v117
    v_lshlrev_b32 v117, 2, v117
    ds_write_b32 v117, v36 offset:52480
    ds_write_b8_d16_hi v118, v73 offset:10496
    v_sub_u32 v73, 55295, v118
    v_lshlrev_b32 v118, 2, v118
    ds_write_b32 v118, v37 offset:52480
    ds_write_b8_d16_hi v119, v74 offset:10496
    v_sub_u32 v74, 55295, v119
    v_lshlrev_b32 v119, 2, v119
    ds_write_b32 v119, v38 offset:52480
    ds_write_b8_d16_hi v120, v75 offset:10496
    v_sub_u32 v75, 55295, v120
    v_lshlrev_b32 v120, 2, v120
    ds_write_b32 v120, v39 offset:52480
p1_k40:
    s_cmp_eq_u32 s68, 0
    s_cbranch_scc1 p1_sg
    s_cmp_lt_u32 s33, 1472
    s_cbranch_scc1 p1_w41
    s_waitcnt vmcnt(0)
p1_w41:
    s_waitcnt vmcnt(8)
    v_bfe_u32 v127, v127, s53, 4
    v_mov_b32 v125, 0
    s_mov_b64 exec, 1
    ds_write_b32 v125, v127 offset:10452
    s_mov_b64 exec, -1
p1_sg:
    s_cmp_lt_u32 s33, 1472
    s_cbranch_scc1 p1_f1
    s_cmp_lg_u32 s28, 15
    s_cbranch_scc1 p1_hv1
    s_waitcnt vmcnt(0)
    v_bfe_u32 v127, v127, s58, 4
    v_mov_b32 v125, 0
    s_mov_b64 exec, 1
    ds_write_b32 v125, v127 offset:10448
    s_mov_b64 exec, -1
p1_hv1:
    s_cmp_ge_u32 s33, 1592
    s_cbranch_scc1 p1_f1
    s_sub_u32 s52, s33, 1472
    s_mul_i32 s53, s52, 53760
    s_add_u32 s53, s53, 485141504
    s_mul_i32 s54, s28, 3072
    v_lshl_add_u32 v93, v92, 4, s54
    s_lshl_b32 s54, s28, 9
    s_add_u32 s54, s54, 49152
    s_cmp_lt_u32 s28, 9
    s_cselect_b32 s54, s54, 0x40000000
    v_lshl_add_u32 v94, v92, 3, s54
    v_mov_b32 v96, 0
    v_mov_b32 v97, 0
    s_waitcnt vmcnt(0)
    buffer_store_dwordx4 v[76:79], v93, s[16:19], s53 offen offset:0
    buffer_store_dwordx4 v[80:83], v93, s[16:19], s53 offen offset:1024
    buffer_store_dwordx4 v[84:87], v93, s[16:19], s53 offen offset:2048
    buffer_store_dwordx2 v[88:89], v94, s[16:19], s53 offen
    v_and_b32 v98, 0x7fff7fff, v76
    v_pk_max_u16 v96, v96, v98
    v_lshlrev_b32 v99, 16, v98
    v_and_b32 v98, 0xffff0000, v98
    v_fmac_f32 v97, v99, v99
    v_fmac_f32 v97, v98, v98
    v_and_b32 v98, 0x7fff7fff, v77
    v_pk_max_u16 v96, v96, v98
    v_lshlrev_b32 v99, 16, v98
    v_and_b32 v98, 0xffff0000, v98
    v_fmac_f32 v97, v99, v99
    v_fmac_f32 v97, v98, v98
    v_and_b32 v98, 0x7fff7fff, v78
    v_pk_max_u16 v96, v96, v98
    v_lshlrev_b32 v99, 16, v98
    v_and_b32 v98, 0xffff0000, v98
    v_fmac_f32 v97, v99, v99
    v_fmac_f32 v97, v98, v98
    v_and_b32 v98, 0x7fff7fff, v79
    v_pk_max_u16 v96, v96, v98
    v_lshlrev_b32 v99, 16, v98
    v_and_b32 v98, 0xffff0000, v98
    v_fmac_f32 v97, v99, v99
    v_fmac_f32 v97, v98, v98
    v_and_b32 v98, 0x7fff7fff, v80
    v_pk_max_u16 v96, v96, v98
    v_lshlrev_b32 v99, 16, v98
    v_and_b32 v98, 0xffff0000, v98
    v_fmac_f32 v97, v99, v99
    v_fmac_f32 v97, v98, v98
    v_and_b32 v98, 0x7fff7fff, v81
    v_pk_max_u16 v96, v96, v98
    v_lshlrev_b32 v99, 16, v98
    v_and_b32 v98, 0xffff0000, v98
    v_fmac_f32 v97, v99, v99
    v_fmac_f32 v97, v98, v98
    v_and_b32 v98, 0x7fff7fff, v82
    v_pk_max_u16 v96, v96, v98
    v_lshlrev_b32 v99, 16, v98
    v_and_b32 v98, 0xffff0000, v98
    v_fmac_f32 v97, v99, v99
    v_fmac_f32 v97, v98, v98
    v_and_b32 v98, 0x7fff7fff, v83
    v_pk_max_u16 v96, v96, v98
    v_lshlrev_b32 v99, 16, v98
    v_and_b32 v98, 0xffff0000, v98
    v_fmac_f32 v97, v99, v99
    v_fmac_f32 v97, v98, v98
    v_and_b32 v98, 0x7fff7fff, v84
    v_pk_max_u16 v96, v96, v98
    v_lshlrev_b32 v99, 16, v98
    v_and_b32 v98, 0xffff0000, v98
    v_fmac_f32 v97, v99, v99
    v_fmac_f32 v97, v98, v98
    v_and_b32 v98, 0x7fff7fff, v85
    v_pk_max_u16 v96, v96, v98
    v_lshlrev_b32 v99, 16, v98
    v_and_b32 v98, 0xffff0000, v98
    v_fmac_f32 v97, v99, v99
    v_fmac_f32 v97, v98, v98
    v_and_b32 v98, 0x7fff7fff, v86
    v_pk_max_u16 v96, v96, v98
    v_lshlrev_b32 v99, 16, v98
    v_and_b32 v98, 0xffff0000, v98
    v_fmac_f32 v97, v99, v99
    v_fmac_f32 v97, v98, v98
    v_and_b32 v98, 0x7fff7fff, v87
    v_pk_max_u16 v96, v96, v98
    v_lshlrev_b32 v99, 16, v98
    v_and_b32 v98, 0xffff0000, v98
    v_fmac_f32 v97, v99, v99
    v_fmac_f32 v97, v98, v98
    v_and_b32 v98, 0x7fff7fff, v88
    v_pk_max_u16 v96, v96, v98
    v_lshlrev_b32 v99, 16, v98
    v_and_b32 v98, 0xffff0000, v98
    v_fmac_f32 v97, v99, v99
    v_fmac_f32 v97, v98, v98
    v_and_b32 v98, 0x7fff7fff, v89
    v_pk_max_u16 v96, v96, v98
    v_lshlrev_b32 v99, 16, v98
    v_and_b32 v98, 0xffff0000, v98
    v_fmac_f32 v97, v99, v99
    v_fmac_f32 v97, v98, v98
    v_lshrrev_b32 v98, 16, v96
    v_and_b32 v96, 0xffff, v96
    v_max_u32 v96, v96, v98
    s_nop 1
    v_max_u32_dpp v96, v96, v96 row_shr:1 row_mask:0xf bank_mask:0xf bound_ctrl:0
    v_add_f32_dpp v97, v97, v97 row_shr:1 row_mask:0xf bank_mask:0xf bound_ctrl:0
    s_nop 0
    v_max_u32_dpp v96, v96, v96 row_shr:2 row_mask:0xf bank_mask:0xf bound_ctrl:0
    v_add_f32_dpp v97, v97, v97 row_shr:2 row_mask:0xf bank_mask:0xf bound_ctrl:0
    s_nop 0
    v_max_u32_dpp v96, v96, v96 row_shr:4 row_mask:0xf bank_mask:0xf bound_ctrl:0
    v_add_f32_dpp v97, v97, v97 row_shr:4 row_mask:0xf bank_mask:0xf bound_ctrl:0
    s_nop 0
    v_max_u32_dpp v96, v96, v96 row_shr:8 row_mask:0xf bank_mask:0xf bound_ctrl:0
    v_add_f32_dpp v97, v97, v97 row_shr:8 row_mask:0xf bank_mask:0xf bound_ctrl:0
    s_nop 0
    v_max_u32_dpp v96, v96, v96 row_bcast:15 row_mask:0xa bank_mask:0xf
    v_add_f32_dpp v97, v97, v97 row_bcast:15 row_mask:0xa bank_mask:0xf
    s_nop 0
    v_max_u32_dpp v96, v96, v96 row_bcast:31 row_mask:0xc bank_mask:0xf
    v_add_f32_dpp v97, v97, v97 row_bcast:31 row_mask:0xc bank_mask:0xf
    s_nop 0
    s_nop 0
    s_lshl_b32 s52, s52, 4
    s_add_u32 s52, s52, s28
    s_lshl_b32 s52, s52, 3
    s_add_u32 s52, s52, 491592704
    s_mov_b64 exec, 1
    s_lshl_b64 exec, exec, 63
    buffer_store_dwordx2 v[96:97], off, s[16:19], s52
    s_mov_b64 exec, -1
p1_f1:
    s_waitcnt lgkmcnt(0)
    s_barrier
    v_mul_u32_u24 v119, 3, v0
    v_and_b32 v118, -4, v119
    v_add_u32 v120, s50, v1
    v_mov_b32 v122, 0
    v_mov_b32 v123, 0
    v_mov_b32 v124, 0
    v_mov_b32 v125, 0
    ds_read_b64 v[126:127], v122 offset:10448
    ds_write_b32 v122, v122 offset:10432
    v_cmp_gt_u32 vcc, 640, v0
    s_and_saveexec_b64 s[52:53], vcc
    ds_write_b128 v1, v[122:125] offset:0
    s_mov_b64 exec, -1
    s_waitcnt lgkmcnt(2)
    v_readfirstlane_b32 s70, v126
    v_readfirstlane_b32 s69, v127
    s_cmp_ge_u32 s33, 1472
    s_cselect_b32 s70, s70, 0
    s_cmp_gt_u32 s28, 10
    s_cselect_b32 s69, 0, s69
    s_cselect_b32 s70, 0, s70
    s_cmp_lg_u32 s70, 8
    s_cbranch_scc1 p1_h0
    s_sub_u32 s52, s33, 1472
    v_and_b32 v102, 63, v0
    s_cmp_eq_u32 s28, 10
    s_cbranch_scc1 p1_tr10
    s_mul_i32 s53, s28, 520
    v_lshl_add_u32 v100, v102, 3, s53
    s_mul_i32 s53, s28, 4160
    v_lshl_add_u32 v101, v102, 4, s53
    s_branch p1_tr20
p1_tr10:
    v_mul_u32_u24 v100, 520, v102
    v_add_u32 v100, 512, v100
    v_mul_u32_u24 v101, 4160, v102
    v_add_u32 v101, 1024, v101
    v_cmp_gt_u32 vcc, 10, v102
    v_mov_b32 v102, 0x40000000
    s_nop 0
    v_cndmask_b32 v100, v102, v100, vcc
    v_cndmask_b32 v101, v102, v101, vcc
p1_tr20:
    s_mul_i32 s52, s52, 41984
    s_add_u32 s52, s52, 469762048
    buffer_load_dwordx2 v[76:77], v100, s[16:19], s52 offen sc1
    s_add_u32 s52, s52, 5248
    buffer_load_dwordx2 v[78:79], v100, s[16:19], s52 offen sc1
    s_add_u32 s52, s52, 5248
    buffer_load_dwordx2 v[80:81], v100, s[16:19], s52 offen sc1
    s_add_u32 s52, s52, 5248
    buffer_load_dwordx2 v[82:83], v100, s[16:19], s52 offen sc1
    s_add_u32 s52, s52, 5248
    buffer_load_dwordx2 v[84:85], v100, s[16:19], s52 offen sc1
    s_add_u32 s52, s52, 5248
    buffer_load_dwordx2 v[86:87], v100, s[16:19], s52 offen sc1
    s_add_u32 s52, s52, 5248
    buffer_load_dwordx2 v[88:89], v100, s[16:19], s52 offen sc1
    s_add_u32 s52, s52, 5248
    buffer_load_dwordx2 v[90:91], v100, s[16:19], s52 offen sc1
    s_add_u32 s52, s52, 5248
p1_h0:
    v_lshlrev_b32 v117, 2, v119
    v_add_u32 v117, 52480, v117
    ds_read_b32 v110, v117 offset:0
    ds_read_b32 v111, v117 offset:4
    ds_read_b32 v112, v117 offset:8
    ds_read_b32 v113, v118 offset:10496
    ds_read_b32 v114, v118 offset:10500
    ds_read_b32 v122, v117 offset:12288
    ds_read_b32 v123, v117 offset:12292
    ds_read_b32 v124, v117 offset:12296
    ds_read_b32 v125, v118 offset:13568
    ds_read_b32 v121, v118 offset:13572
    s_waitcnt lgkmcnt(5)
    v_alignbyte_b32 v113, v114, v113, v119
    buffer_store_dwordx4 v[110:113], v120, s[20:23], 0 offen
    v_add_u32 v120, 33554432, v120
    s_nop 0
    ds_read_b32 v110, v117 offset:24576
    ds_read_b32 v111, v117 offset:24580
    ds_read_b32 v112, v117 offset:24584
    ds_read_b32 v113, v118 offset:16640
    ds_read_b32 v114, v118 offset:16644
    s_cmp_le_u32 s35, 1024
    s_cbranch_scc1 p1_ce0
    s_waitcnt lgkmcnt(5)
    v_alignbyte_b32 v125, v121, v125, v119
    buffer_store_dwordx4 v[122:125], v120, s[20:23], 0 offen
    v_add_u32 v120, 33554432, v120
    s_nop 0
    ds_read_b32 v122, v117 offset:36864
    ds_read_b32 v123, v117 offset:36868
    ds_read_b32 v124, v117 offset:36872
    ds_read_b32 v125, v118 offset:19712
    ds_read_b32 v121, v118 offset:19716
    s_cmp_le_u32 s35, 2048
    s_cbranch_scc1 p1_ce0
    s_waitcnt lgkmcnt(5)
    v_alignbyte_b32 v113, v114, v113, v119
    buffer_store_dwordx4 v[110:113], v120, s[20:23], 0 offen
    v_add_u32 v120, 33554432, v120
    s_nop 0
    ds_read_b32 v110, v117 offset:49152
    ds_read_b32 v111, v117 offset:49156
    ds_read_b32 v112, v117 offset:49160
    ds_read_b32 v113, v118 offset:22784
    ds_read_b32 v114, v118 offset:22788
    s_cmp_le_u32 s35, 3072
    s_cbranch_scc1 p1_ce0
    s_waitcnt lgkmcnt(5)
    v_alignbyte_b32 v125, v121, v125, v119
    buffer_store_dwordx4 v[122:125], v120, s[20:23], 0 offen
    v_add_u32 v120, 33554432, v120
    s_nop 0
    v_lshlrev_b32 v117, 2, v119
    v_add_u32 v117, 113920, v117
    ds_read_b32 v122, v117 offset:0
    ds_read_b32 v123, v117 offset:4
    ds_read_b32 v124, v117 offset:8
    ds_read_b32 v125, v118 offset:25856
    ds_read_b32 v121, v118 offset:25860
    s_cmp_le_u32 s35, 4096
    s_cbranch_scc1 p1_ce0
    s_waitcnt lgkmcnt(5)
    v_alignbyte_b32 v113, v114, v113, v119
    buffer_store_dwordx4 v[110:113], v120, s[20:23], 0 offen
    v_add_u32 v120, 33554432, v120
    s_nop 0
    ds_read_b32 v110, v117 offset:12288
    ds_read_b32 v111, v117 offset:12292
    ds_read_b32 v112, v117 offset:12296
    ds_read_b32 v113, v118 offset:28928
    ds_read_b32 v114, v118 offset:28932
    s_cmp_le_u32 s35, 5120
    s_cbranch_scc1 p1_ce0
    s_waitcnt lgkmcnt(5)
    v_alignbyte_b32 v125, v121, v125, v119
    buffer_store_dwordx4 v[122:125], v120, s[20:23], 0 offen
    v_add_u32 v120, 33554432, v120
    s_nop 0
    ds_read_b32 v122, v117 offset:24576
    ds_read_b32 v123, v117 offset:24580
    ds_read_b32 v124, v117 offset:24584
    ds_read_b32 v125, v118 offset:32000
    ds_read_b32 v121, v118 offset:32004
    s_cmp_le_u32 s35, 6144
    s_cbranch_scc1 p1_ce0
    s_waitcnt lgkmcnt(5)
    v_alignbyte_b32 v113, v114, v113, v119
    buffer_store_dwordx4 v[110:113], v120, s[20:23], 0 offen
    v_add_u32 v120, 33554432, v120
    s_nop 0
    ds_read_b32 v110, v117 offset:36864
    ds_read_b32 v111, v117 offset:36868
    ds_read_b32 v112, v117 offset:36872
    ds_read_b32 v113, v118 offset:35072
    ds_read_b32 v114, v118 offset:35076
    s_cmp_le_u32 s35, 7168
    s_cbranch_scc1 p1_ce0
    s_waitcnt lgkmcnt(5)
    v_alignbyte_b32 v125, v121, v125, v119
    buffer_store_dwordx4 v[122:125], v120, s[20:23], 0 offen
    v_add_u32 v120, 33554432, v120
    s_nop 0
    s_cmp_le_u32 s35, 8192
    s_cbranch_scc1 p1_ce0
    s_waitcnt lgkmcnt(0)
    v_alignbyte_b32 v113, v114, v113, v119
    buffer_store_dwordx4 v[110:113], v120, s[20:23], 0 offen
    v_add_u32 v120, 33554432, v120
    s_nop 0
p1_ce0:
    s_waitcnt lgkmcnt(0)
    s_cmp_lg_u32 s70, 8
    s_cbranch_scc1 p1_h1
    s_sub_u32 s52, s33, 1472
    s_mul_i32 s52, s52, 41600
    s_add_u32 s52, s52, 477487104
    s_mov_b32 s54, 0x05040100
    s_mov_b32 s55, 0x07060302
    s_waitcnt vmcnt(1)
    v_perm_b32 v92, v78, v76, s54
    v_perm_b32 v93, v82, v80, s54
    v_perm_b32 v94, v86, v84, s54
    v_perm_b32 v95, v90, v88, s54
    buffer_store_dwordx4 v[92:95], v101, s[16:19], s52 offen offset:0
    v_perm_b32 v96, v78, v76, s55
    v_perm_b32 v97, v82, v80, s55
    v_perm_b32 v98, v86, v84, s55
    v_perm_b32 v99, v90, v88, s55
    buffer_store_dwordx4 v[96:99], v101, s[16:19], s52 offen offset:1040
    v_perm_b32 v92, v79, v77, s54
    v_perm_b32 v93, v83, v81, s54
    v_perm_b32 v94, v87, v85, s54
    v_perm_b32 v95, v91, v89, s54
    buffer_store_dwordx4 v[92:95], v101, s[16:19], s52 offen offset:2080
    v_perm_b32 v96, v79, v77, s55
    v_perm_b32 v97, v83, v81, s55
    v_perm_b32 v98, v87, v85, s55
    v_perm_b32 v99, v91, v89, s55
    buffer_store_dwordx4 v[96:99], v101, s[16:19], s52 offen offset:3120
p1_h1:
    s_barrier
    s_cmp_ge_u32 s29, 1445
    s_cbranch_scc1 p1_k42
    s_cmp_le_u32 s35, 9216
    s_cbranch_scc1 p1_s1k2
    v_lshlrev_b32_sdwa v122, 2, v40 dst_sel:DWORD dst_unused:UNUSED_PAD src0_sel:DWORD src1_sel:WORD_1
    ds_write_b32 v122, v12 offset:52480
    v_lshlrev_b32_sdwa v123, 2, v41 dst_sel:DWORD dst_unused:UNUSED_PAD src0_sel:DWORD src1_sel:WORD_1
    ds_write_b32 v123, v13 offset:52480
    v_lshlrev_b32_sdwa v124, 2, v42 dst_sel:DWORD dst_unused:UNUSED_PAD src0_sel:DWORD src1_sel:WORD_1
    ds_write_b32 v124, v14 offset:52480
    v_lshlrev_b32_sdwa v125, 2, v43 dst_sel:DWORD dst_unused:UNUSED_PAD src0_sel:DWORD src1_sel:WORD_1
    ds_write_b32 v125, v15 offset:52480
p1_s1k2:
p1_k42:
    s_cmp_ge_u32 s33, 1472
    s_cbranch_scc1 p1_k43
    s_cmp_lt_u32 s33, 1445
    s_cselect_b32 s6, 204800000, 0
    s_add_u32 s32, s30, 32768
    buffer_load_dwordx4 v[12:15], v1, s[4:7], s32 offen nt
p1_k43:
    s_cmp_ge_u32 s29, 1419
    s_cbranch_scc1 p1_k44
    s_cmp_le_u32 s35, 9216
    s_cbranch_scc1 p1_s1k3
    v_lshlrev_b32_sdwa v122, 2, v44 dst_sel:DWORD dst_unused:UNUSED_PAD src0_sel:DWORD src1_sel:WORD_1
    ds_write_b32 v122, v16 offset:52480
    v_lshlrev_b32_sdwa v123, 2, v45 dst_sel:DWORD dst_unused:UNUSED_PAD src0_sel:DWORD src1_sel:WORD_1
    ds_write_b32 v123, v17 offset:52480
    v_lshlrev_b32_sdwa v124, 2, v46 dst_sel:DWORD dst_unused:UNUSED_PAD src0_sel:DWORD src1_sel:WORD_1
    ds_write_b32 v124, v18 offset:52480
    v_lshlrev_b32_sdwa v125, 2, v47 dst_sel:DWORD dst_unused:UNUSED_PAD src0_sel:DWORD src1_sel:WORD_1
    ds_write_b32 v125, v19 offset:52480
p1_s1k3:
p1_k44:
    s_cmp_ge_u32 s29, 1365
    s_cbranch_scc1 p1_k45
    s_cmp_le_u32 s35, 9216
    s_cbranch_scc1 p1_s1k5
    v_lshlrev_b32_sdwa v122, 2, v56 dst_sel:DWORD dst_unused:UNUSED_PAD src0_sel:DWORD src1_sel:WORD_1
    ds_write_b32 v122, v24 offset:52480
    v_lshlrev_b32_sdwa v123, 2, v57 dst_sel:DWORD dst_unused:UNUSED_PAD src0_sel:DWORD src1_sel:WORD_1
    ds_write_b32 v123, v25 offset:52480
    v_lshlrev_b32_sdwa v124, 2, v58 dst_sel:DWORD dst_unused:UNUSED_PAD src0_sel:DWORD src1_sel:WORD_1
    ds_write_b32 v124, v26 offset:52480
    v_lshlrev_b32_sdwa v125, 2, v59 dst_sel:DWORD dst_unused:UNUSED_PAD src0_sel:DWORD src1_sel:WORD_1
    ds_write_b32 v125, v27 offset:52480
p1_s1k5:
p1_k45:
    s_cmp_ge_u32 s29, 1312
    s_cbranch_scc1 p1_k46
    s_cmp_le_u32 s35, 9216
    s_cbranch_scc1 p1_s1k7
    v_lshlrev_b32_sdwa v122, 2, v64 dst_sel:DWORD dst_unused:UNUSED_PAD src0_sel:DWORD src1_sel:WORD_1
    ds_write_b32 v122, v32 offset:52480
    v_lshlrev_b32_sdwa v123, 2, v65 dst_sel:DWORD dst_unused:UNUSED_PAD src0_sel:DWORD src1_sel:WORD_1
    ds_write_b32 v123, v33 offset:52480
    v_lshlrev_b32_sdwa v124, 2, v66 dst_sel:DWORD dst_unused:UNUSED_PAD src0_sel:DWORD src1_sel:WORD_1
    ds_write_b32 v124, v34 offset:52480
    v_lshlrev_b32_sdwa v125, 2, v67 dst_sel:DWORD dst_unused:UNUSED_PAD src0_sel:DWORD src1_sel:WORD_1
    ds_write_b32 v125, v35 offset:52480
p1_s1k7:
p1_k46:
    s_cmp_ge_u32 s29, 1392
    s_cbranch_scc1 p1_k47
    s_cmp_le_u32 s35, 9216
    s_cbranch_scc1 p1_s1k4
    v_lshlrev_b32_sdwa v122, 2, v56 dst_sel:DWORD dst_unused:UNUSED_PAD src0_sel:DWORD src1_sel:WORD_0
    ds_write_b32 v122, v20 offset:52480
    v_lshlrev_b32_sdwa v123, 2, v57 dst_sel:DWORD dst_unused:UNUSED_PAD src0_sel:DWORD src1_sel:WORD_0
    ds_write_b32 v123, v21 offset:52480
    v_lshlrev_b32_sdwa v124, 2, v58 dst_sel:DWORD dst_unused:UNUSED_PAD src0_sel:DWORD src1_sel:WORD_0
    ds_write_b32 v124, v22 offset:52480
    v_lshlrev_b32_sdwa v125, 2, v59 dst_sel:DWORD dst_unused:UNUSED_PAD src0_sel:DWORD src1_sel:WORD_0
    ds_write_b32 v125, v23 offset:52480
p1_s1k4:
p1_k47:
    s_cmp_ge_u32 s29, 1338
    s_cbranch_scc1 p1_k48
    s_cmp_le_u32 s35, 9216
    s_cbranch_scc1 p1_s1k6
    v_lshlrev_b32_sdwa v122, 2, v64 dst_sel:DWORD dst_unused:UNUSED_PAD src0_sel:DWORD src1_sel:WORD_0
    ds_write_b32 v122, v28 offset:52480
    v_lshlrev_b32_sdwa v123, 2, v65 dst_sel:DWORD dst_unused:UNUSED_PAD src0_sel:DWORD src1_sel:WORD_0
    ds_write_b32 v123, v29 offset:52480
    v_lshlrev_b32_sdwa v124, 2, v66 dst_sel:DWORD dst_unused:UNUSED_PAD src0_sel:DWORD src1_sel:WORD_0
    ds_write_b32 v124, v30 offset:52480
    v_lshlrev_b32_sdwa v125, 2, v67 dst_sel:DWORD dst_unused:UNUSED_PAD src0_sel:DWORD src1_sel:WORD_0
    ds_write_b32 v125, v31 offset:52480
p1_s1k6:
p1_k48:
    s_cmp_ge_u32 s29, 1285
    s_cbranch_scc1 p1_k49
    s_cmp_le_u32 s35, 9216
    s_cbranch_scc1 p1_s1k8
    v_lshlrev_b32_sdwa v122, 2, v72 dst_sel:DWORD dst_unused:UNUSED_PAD src0_sel:DWORD src1_sel:WORD_0
    ds_write_b32 v122, v36 offset:52480
    v_lshlrev_b32_sdwa v123, 2, v73 dst_sel:DWORD dst_unused:UNUSED_PAD src0_sel:DWORD src1_sel:WORD_0
    ds_write_b32 v123, v37 offset:52480
    v_lshlrev_b32_sdwa v124, 2, v74 dst_sel:DWORD dst_unused:UNUSED_PAD src0_sel:DWORD src1_sel:WORD_0
    ds_write_b32 v124, v38 offset:52480
    v_lshlrev_b32_sdwa v125, 2, v75 dst_sel:DWORD dst_unused:UNUSED_PAD src0_sel:DWORD src1_sel:WORD_0
    ds_write_b32 v125, v39 offset:52480
p1_s1k8:
p1_k49:
    s_cmp_le_u32 s35, 9216
    s_cbranch_scc1 p1_s1k0
    v_lshlrev_b32_sdwa v122, 2, v40 dst_sel:DWORD dst_unused:UNUSED_PAD src0_sel:DWORD src1_sel:WORD_0
    ds_write_b32 v122, v4 offset:52480
    v_lshlrev_b32_sdwa v123, 2, v41 dst_sel:DWORD dst_unused:UNUSED_PAD src0_sel:DWORD src1_sel:WORD_0
    ds_write_b32 v123, v5 offset:52480
    v_lshlrev_b32_sdwa v124, 2, v42 dst_sel:DWORD dst_unused:UNUSED_PAD src0_sel:DWORD src1_sel:WORD_0
    ds_write_b32 v124, v6 offset:52480
    v_lshlrev_b32_sdwa v125, 2, v43 dst_sel:DWORD dst_unused:UNUSED_PAD src0_sel:DWORD src1_sel:WORD_0
    ds_write_b32 v125, v7 offset:52480
p1_s1k0:
    s_cmp_le_u32 s35, 9216
    s_cbranch_scc1 p1_s1k1
    v_lshlrev_b32_sdwa v122, 2, v44 dst_sel:DWORD dst_unused:UNUSED_PAD src0_sel:DWORD src1_sel:WORD_0
    ds_write_b32 v122, v8 offset:52480
    v_lshlrev_b32_sdwa v123, 2, v45 dst_sel:DWORD dst_unused:UNUSED_PAD src0_sel:DWORD src1_sel:WORD_0
    ds_write_b32 v123, v9 offset:52480
    v_lshlrev_b32_sdwa v124, 2, v46 dst_sel:DWORD dst_unused:UNUSED_PAD src0_sel:DWORD src1_sel:WORD_0
    ds_write_b32 v124, v10 offset:52480
    v_lshlrev_b32_sdwa v125, 2, v47 dst_sel:DWORD dst_unused:UNUSED_PAD src0_sel:DWORD src1_sel:WORD_0
    ds_write_b32 v125, v11 offset:52480
p1_s1k1:
    s_cmp_lg_u32 s69, 8
    s_cbranch_scc1 p1_o1
    s_lshr_b32 s52, s29, 3
    v_and_b32 v6, 63, v0
    s_cmp_eq_u32 s28, 10
    s_cbranch_scc1 p1_tr11
    s_mul_i32 s53, s28, 520
    v_lshl_add_u32 v4, v6, 3, s53
    s_mul_i32 s53, s28, 4160
    v_lshl_add_u32 v5, v6, 4, s53
    s_branch p1_tr21
p1_tr11:
    v_mul_u32_u24 v4, 520, v6
    v_add_u32 v4, 512, v4
    v_mul_u32_u24 v5, 4160, v6
    v_add_u32 v5, 1024, v5
    v_cmp_gt_u32 vcc, 10, v6
    v_mov_b32 v6, 0x40000000
    s_nop 0
    v_cndmask_b32 v4, v6, v4, vcc
    v_cndmask_b32 v5, v6, v5, vcc
p1_tr21:
    s_mul_i32 s52, s52, 41984
    s_add_u32 s52, s52, 469762048
    buffer_load_dwordx2 v[16:17], v4, s[16:19], s52 offen sc1
    s_add_u32 s52, s52, 5248
    buffer_load_dwordx2 v[18:19], v4, s[16:19], s52 offen sc1
    s_add_u32 s52, s52, 5248
    buffer_load_dwordx2 v[20:21], v4, s[16:19], s52 offen sc1
    s_add_u32 s52, s52, 5248
    buffer_load_dwordx2 v[22:23], v4, s[16:19], s52 offen sc1
    s_add_u32 s52, s52, 5248
    buffer_load_dwordx2 v[24:25], v4, s[16:19], s52 offen sc1
    s_add_u32 s52, s52, 5248
    buffer_load_dwordx2 v[26:27], v4, s[16:19], s52 offen sc1
    s_add_u32 s52, s52, 5248
    buffer_load_dwordx2 v[28:29], v4, s[16:19], s52 offen sc1
    s_add_u32 s52, s52, 5248
    buffer_load_dwordx2 v[30:31], v4, s[16:19], s52 offen sc1
    s_add_u32 s52, s52, 5248
    s_cmp_ge_u32 s33, 1472
    s_cbranch_scc1 p1_o1
    s_lshr_b32 s52, s29, 3
    s_mul_i32 s52, s52, 41600
    s_add_u32 s52, s52, 477487104
    s_mov_b32 s54, 0x05040100
    s_mov_b32 s55, 0x07060302
    s_waitcnt vmcnt(0)
    v_perm_b32 v32, v18, v16, s54
    v_perm_b32 v33, v22, v20, s54
    v_perm_b32 v34, v26, v24, s54
    v_perm_b32 v35, v30, v28, s54
    buffer_store_dwordx4 v[32:35], v5, s[16:19], s52 offen offset:0
    v_perm_b32 v36, v18, v16, s55
    v_perm_b32 v37, v22, v20, s55
    v_perm_b32 v38, v26, v24, s55
    v_perm_b32 v39, v30, v28, s55
    buffer_store_dwordx4 v[36:39], v5, s[16:19], s52 offen offset:1040
    v_perm_b32 v32, v19, v17, s54
    v_perm_b32 v33, v23, v21, s54
    v_perm_b32 v34, v27, v25, s54
    v_perm_b32 v35, v31, v29, s54
    buffer_store_dwordx4 v[32:35], v5, s[16:19], s52 offen offset:2080
    v_perm_b32 v36, v19, v17, s55
    v_perm_b32 v37, v23, v21, s55
    v_perm_b32 v38, v27, v25, s55
    v_perm_b32 v39, v31, v29, s55
    buffer_store_dwordx4 v[36:39], v5, s[16:19], s52 offen offset:3120
    s_mov_b32 s69, 0
p1_o1:
    s_waitcnt lgkmcnt(0)
    s_barrier
    s_cmp_le_u32 s35, 9216
    s_cbranch_scc1 p1_ce1
    v_lshlrev_b32 v117, 2, v119
    v_sub_u32 v117, 113908, v117
    ds_read_b32 v122, v117 offset:49160
    ds_read_b32 v123, v117 offset:49156
    ds_read_b32 v124, v117 offset:49152
    ds_read_b32 v125, v118 offset:38144
    ds_read_b32 v121, v118 offset:38148
    ds_read_b32 v110, v117 offset:36872
    ds_read_b32 v111, v117 offset:36868
    ds_read_b32 v112, v117 offset:36864
    ds_read_b32 v113, v118 offset:41216
    ds_read_b32 v114, v118 offset:41220
    s_waitcnt lgkmcnt(5)
    v_alignbyte_b32 v125, v121, v125, v119
    s_cmp_le_u32 s71, 9
    s_cbranch_scc1 p1_pw9
    buffer_store_dwordx4 v[122:125], v120, s[20:23], 0 offen
    s_branch p1_px9
p1_pw9:
    buffer_store_dwordx4 v[122:125], v120, s[20:23], 0 offen nt
p1_px9:
    v_add_u32 v120, 33554432, v120
    s_nop 0
    ds_read_b32 v122, v117 offset:24584
    ds_read_b32 v123, v117 offset:24580
    ds_read_b32 v124, v117 offset:24576
    ds_read_b32 v125, v118 offset:44288
    ds_read_b32 v121, v118 offset:44292
    s_cmp_le_u32 s35, 10240
    s_cbranch_scc1 p1_ce1
    s_waitcnt lgkmcnt(5)
    v_alignbyte_b32 v113, v114, v113, v119
    buffer_store_dwordx4 v[110:113], v120, s[20:23], 0 offen nt
    v_add_u32 v120, 33554432, v120
    s_nop 0
    ds_read_b32 v110, v117 offset:12296
    ds_read_b32 v111, v117 offset:12292
    ds_read_b32 v112, v117 offset:12288
    ds_read_b32 v113, v118 offset:47360
    ds_read_b32 v114, v118 offset:47364
    s_cmp_le_u32 s35, 11264
    s_cbranch_scc1 p1_ce1
    s_waitcnt lgkmcnt(5)
    v_alignbyte_b32 v125, v121, v125, v119
    buffer_store_dwordx4 v[122:125], v120, s[20:23], 0 offen nt
    v_add_u32 v120, 33554432, v120
    s_nop 0
    ds_read_b32 v122, v117 offset:8
    ds_read_b32 v123, v117 offset:4
    ds_read_b32 v124, v117 offset:0
    ds_read_b32 v125, v118 offset:50432
    ds_read_b32 v121, v118 offset:50436
    s_cmp_le_u32 s35, 12288
    s_cbranch_scc1 p1_ce1
    s_waitcnt lgkmcnt(5)
    v_alignbyte_b32 v113, v114, v113, v119
    buffer_store_dwordx4 v[110:113], v120, s[20:23], 0 offen nt
    v_add_u32 v120, 33554432, v120
    s_nop 0
    s_cmp_le_u32 s35, 13312
    s_cbranch_scc1 p1_ce1
    s_waitcnt lgkmcnt(0)
    v_alignbyte_b32 v125, v121, v125, v119
    buffer_store_dwordx4 v[122:125], v120, s[20:23], 0 offen nt
    v_add_u32 v120, 33554432, v120
    s_nop 0
p1_ce1:
    s_waitcnt lgkmcnt(0)
    s_cmp_lg_u32 s69, 8
    s_cbranch_scc1 p1_o2
    s_lshr_b32 s52, s29, 3
    s_mul_i32 s52, s52, 41600
    s_add_u32 s52, s52, 477487104
    s_mov_b32 s54, 0x05040100
    s_mov_b32 s55, 0x07060302
    s_waitcnt vmcnt(0)
    v_perm_b32 v32, v18, v16, s54
    v_perm_b32 v33, v22, v20, s54
    v_perm_b32 v34, v26, v24, s54
    v_perm_b32 v35, v30, v28, s54
    buffer_store_dwordx4 v[32:35], v5, s[16:19], s52 offen offset:0
    v_perm_b32 v36, v18, v16, s55
    v_perm_b32 v37, v22, v20, s55
    v_perm_b32 v38, v26, v24, s55
    v_perm_b32 v39, v30, v28, s55
    buffer_store_dwordx4 v[36:39], v5, s[16:19], s52 offen offset:1040
    v_perm_b32 v32, v19, v17, s54
    v_perm_b32 v33, v23, v21, s54
    v_perm_b32 v34, v27, v25, s54
    v_perm_b32 v35, v31, v29, s54
    buffer_store_dwordx4 v[32:35], v5, s[16:19], s52 offen offset:2080
    v_perm_b32 v36, v19, v17, s55
    v_perm_b32 v37, v23, v21, s55
    v_perm_b32 v38, v27, v25, s55
    v_perm_b32 v39, v31, v29, s55
    buffer_store_dwordx4 v[36:39], v5, s[16:19], s52 offen offset:3120
p1_o2:
    s_barrier
    s_mov_b32 s29, s33
    s_cmp_lt_u32 s29, 1285
    s_cselect_b32 s34, 1, 0
    s_cmp_lt_u32 s29, 1472
    s_cbranch_scc1 p1_tile
p1_end:
    s_endpgm
.globl p2_kernel
.p2align 8
.type p2_kernel,@function
p2_kernel:
    s_cmp_ge_u32 s2, 256
    s_cbranch_scc1 p2_end
    s_load_dwordx2 s[8:9], s[0:1], 104
    v_and_b32 v112, 63, v0
    v_lshrrev_b32 v122, 6, v0
    v_lshlrev_b32 v112, 4, v112
    v_readfirstlane_b32 s10, v122
    v_mov_b32 v113, 0x83ff0000
    s_and_b32 s44, s2, 7
    s_lshr_b32 s11, s44, 1
    s_and_b32 s44, s44, 1
    s_lshl_b32 s12, s44, 5
    s_lshr_b32 s44, s2, 3
    s_add_u32 s12, s12, s44
    s_mov_b32 s25, 54272
    s_mov_b32 s31, 67175170
    s_mov_b32 s32, 83952386
    s_mov_b32 s33, 100729602
    s_mov_b32 s21, 0
    s_mul_i32 s23, s10, 3072
    s_lshl_b32 s24, s10, 9
    s_lshl_b32 s64, s10, 10
    s_sub_u32 s42, s24, s23
    s_add_u32 s42, s42, 49152
    s_movk_i32 s63, 2048
    s_movk_i32 s65, 16384
    s_mul_i32 s62, s11, 161280
    s_add_u32 s62, s62, 485141504
    s_add_u32 s62, s62, s23
    s_mov_b32 s40, 477487104
    s_mul_i32 s44, s11, 1040
    s_add_u32 s40, s40, s44
    s_lshl_b32 s44, s12, 4
    s_add_u32 s40, s40, s44
    s_waitcnt lgkmcnt(0)
    s_mov_b32 s4, s8
    s_and_b32 s5, s9, 0xffff
    s_mov_b32 s6, 819200000
    s_mov_b32 s7, 0x20000
    s_mov_b32 s68, s8
    s_and_b32 s69, s9, 0xffff
    s_mov_b32 s70, 469762048
    s_mov_b32 s71, 0x20000
    s_and_b32 s44, s2, 7
    s_lshl_b32 s44, s44, 2
    s_lshr_b32 s18, 0x00000000, s44
    s_and_b32 s18, s18, 15
p2_restart:
    s_mov_b32 s61, 0
    s_add_u32 s44, s61, s18
    s_cmp_ge_u32 s44, 10
    s_cselect_b32 s53, 10, 0
    s_sub_u32 s44, s44, s53
    s_mul_i32 s44, s44, 4160
    s_add_u32 s44, s44, s40
    v_bfe_i32 v111, v112, 6, 1
    v_lshrrev_b32 v110, 6, v112
    v_bitop3_b32 v111, v111, 15, s10 bitop3:0x6a
    v_lshl_or_b32 v110, v110, 4, v111
    v_add_u32 v111, 72, v110
    v_and_b32 v111, 0x100, v111
    v_lshl_or_b32 v110, v111, 7, v110
    v_bfe_u32 v111, v112, 2, 4
    v_mul_u32_u24 v110, 41600, v110
    v_add_u32 v111, v110, v111
    buffer_load_dword v110, v111, s[4:7], s44 offen
    buffer_load_dword v111, v111, s[4:7], s44 offen offset:16
    s_mov_b32 s61, 1
    s_add_u32 s44, s61, s18
    s_cmp_ge_u32 s44, 10
    s_cselect_b32 s53, 10, 0
    s_sub_u32 s44, s44, s53
    s_mul_i32 s44, s44, 4160
    s_add_u32 s44, s44, s40
    v_bfe_i32 v67, v112, 6, 1
    v_lshrrev_b32 v66, 6, v112
    v_bitop3_b32 v67, v67, 15, s10 bitop3:0x6a
    v_lshl_or_b32 v66, v66, 4, v67
    v_add_u32 v67, 72, v66
    v_and_b32 v67, 0x100, v67
    v_lshl_or_b32 v66, v67, 7, v66
    v_bfe_u32 v67, v112, 2, 4
    v_mul_u32_u24 v66, 41600, v66
    v_add_u32 v67, v66, v67
    buffer_load_dword v66, v67, s[4:7], s44 offen
    buffer_load_dword v67, v67, s[4:7], s44 offen offset:16
    s_mov_b32 s61, 0
    s_cmp_lt_u32 s10, 15
    s_cselect_b32 s44, s64, 0x40000000
    v_add_u32 v58, s44, v112
    s_mov_b32 s44, 491592704
    buffer_load_dwordx4 v[58:61], v58, s[4:7], s44 offen
    s_mul_i32 s20, s18, 645120
    s_add_u32 s20, s20, s62
    s_cmp_ge_u32 s10, 9
    s_cbranch_scc1 p2_nmp
    v_lshrrev_b32 v84, 1, v112
    s_add_u32 s44, s20, s42
    buffer_load_dwordx2 v[84:85], v84, s[4:7], s44 offen
p2_nmp:
    buffer_load_dwordx4 v[72:75], v112, s[4:7], s20 offen offset:0
    buffer_load_dwordx4 v[76:79], v112, s[4:7], s20 offen offset:1024
    buffer_load_dwordx4 v[80:83], v112, s[4:7], s20 offen offset:2048
    s_barrier
    v_mov_b32 v115, 0
    v_mov_b32 v116, 0
    v_mov_b32 v117, 0
    v_mov_b32 v118, 0
    v_mov_b32 v119, 0
    v_mov_b32 v120, 0
    v_mov_b32 v121, 0
    ds_write_b128 v115, v[116:119] offset:53760
    s_mov_b32 s19, 0
    s_cmp_eq_u32 s21, 2
    s_cselect_b64 s[66:67], -1, 0
    s_waitcnt lgkmcnt(0)
    s_barrier
    s_waitcnt vmcnt(6)
    s_mov_b32 m0, s23
    v_mov_b32 v53, 0
    s_movk_i32 s44, 512
    v_sub_u32_sdwa v4, v111, v110 dst_sel:DWORD dst_unused:UNUSED_PAD src0_sel:WORD_0 src1_sel:WORD_0
    v_sub_u32_sdwa v5, v111, v110 dst_sel:DWORD dst_unused:UNUSED_PAD src0_sel:WORD_1 src1_sel:WORD_1
    v_med3_i32 v4, v4, 0, s44
    v_med3_i32 v5, v5, 0, s44
    v_add_u32 v48, v4, v5
    ds_write_addtid_b32 v53 offset:0
    ds_write_addtid_b32 v53 offset:256
    ds_write_addtid_b32 v53 offset:512
    ds_write_addtid_b32 v53 offset:768
    ds_write_addtid_b32 v53 offset:1024
    ds_write_addtid_b32 v53 offset:1280
    ds_write_addtid_b32 v53 offset:1536
    ds_write_addtid_b32 v53 offset:1792
    v_bfe_i32 v53, v112, 6, 1
    v_lshrrev_b32 v49, 6, v112
    v_bitop3_b32 v53, v53, 15, s10 bitop3:0x6a
    v_lshl_or_b32 v49, v49, 4, v53
    v_and_b32 v53, 0x30, v112
    v_lshl_or_b32 v53, v49, 6, v53
    v_lshlrev_b32 v53, 15, v53
    s_nop 1
    v_add_u32_dpp v48, v48, v48 row_shr:1 row_mask:0xf bank_mask:0xf bound_ctrl:0
    s_nop 1
    v_add_u32_dpp v48, v48, v48 row_shr:2 row_mask:0xf bank_mask:0xf bound_ctrl:0
    s_nop 1
    v_add_u32_dpp v48, v48, v48 row_shr:4 row_mask:0xf bank_mask:0xf bound_ctrl:0
    s_nop 1
    v_add_u32_dpp v48, v48, v48 row_shr:8 row_mask:0xf bank_mask:0xf bound_ctrl:0
    s_nop 1
    v_add_u32_dpp v48, v48, v48 row_bcast:15 row_mask:0xa bank_mask:0xf
    s_nop 1
    v_add_u32_dpp v48, v48, v48 row_bcast:31 row_mask:0xc bank_mask:0xf
    s_nop 1
    s_nop 0
    v_readlane_b32 s38, v48, 63
    v_sub_u32 v50, v48, v5
    v_sub_u32 v49, v50, v4
    v_writelane_b32 v5, 1, 63
    v_sub_u32 v10, 512, v49
    v_mad_u32_u16 v51, v110, 16, v53
    v_lshl_add_u32 v51, v10, 4, v51
    v_med3_i32 v10, v10, 0, v4
    v_lshl_add_u32 v49, v49, 2, s23
    v_sub_u32 v11, 512, v50
    v_mad_u32_u16 v52, v110, 16, v53 op_sel:[1,0,0,0]
    v_add_u32 v52, 262144, v52
    s_mov_b32 s44, 0x1fffc000
    v_writelane_b32 v52, s44, 63
    v_lshl_add_u32 v52, v11, 4, v52
    v_med3_i32 v11, v11, 0, v5
    v_lshl_add_u32 v50, v50, 2, s23
    v_lshl_add_u32 v48, v11, 16, v10
    v_add_u32 v110, v110, v48
    s_min_u32 s17, s38, 512
    s_add_u32 s17, s17, 63
    s_lshr_b32 s17, s17, 6
    v_cmpx_lt_i32 vcc, 0, v10
    ds_write_b32 v49, v51
    s_mov_b64 exec, -1
    v_cmpx_lt_i32 vcc, 0, v11
    ds_write_b32 v50, v52
    s_mov_b64 exec, -1
    s_cmp_lt_u32 s38, 512
    s_cbranch_scc1 p2_nomorea
    v_cmp_lt_u32_sdwa s[44:45], v110, v111 src0_sel:WORD_0 src1_sel:WORD_0
    v_cmp_lt_u32_sdwa s[46:47], v110, v111 src0_sel:WORD_1 src1_sel:WORD_1
    s_nop 0
    s_or_b64 s[44:45], s[44:45], s[46:47]
    s_cbranch_scc0 p2_nomorea
    v_mov_b32 v49, s19
    v_mov_b32 v50, 1
    ds_write_b32 v49, v50 offset:53760
p2_nomorea:
    s_mov_b32 m0, s23
    s_nop 0
    ds_read_addtid_b32 v2 offset:1024
    ds_read_addtid_b32 v8 offset:1280
    ds_read_addtid_b32 v14 offset:1536
    ds_read_addtid_b32 v20 offset:1792
    ds_read_addtid_b32 v88 offset:0
    ds_read_addtid_b32 v92 offset:256
    ds_read_addtid_b32 v96 offset:512
    ds_read_addtid_b32 v100 offset:768
    s_waitcnt lgkmcnt(0)
    s_nop 2
    s_nop 1
    v_max_u32_dpp v88, v88, v88 row_shr:1 row_mask:0xf bank_mask:0xf bound_ctrl:0
    v_max_u32_dpp v92, v92, v92 row_shr:1 row_mask:0xf bank_mask:0xf bound_ctrl:0
    v_max_u32_dpp v96, v96, v96 row_shr:1 row_mask:0xf bank_mask:0xf bound_ctrl:0
    v_max_u32_dpp v100, v100, v100 row_shr:1 row_mask:0xf bank_mask:0xf bound_ctrl:0
    v_max_u32_dpp v2, v2, v2 row_shr:1 row_mask:0xf bank_mask:0xf bound_ctrl:0
    v_max_u32_dpp v8, v8, v8 row_shr:1 row_mask:0xf bank_mask:0xf bound_ctrl:0
    v_max_u32_dpp v14, v14, v14 row_shr:1 row_mask:0xf bank_mask:0xf bound_ctrl:0
    v_max_u32_dpp v20, v20, v20 row_shr:1 row_mask:0xf bank_mask:0xf bound_ctrl:0
    v_max_u32_dpp v88, v88, v88 row_shr:2 row_mask:0xf bank_mask:0xf bound_ctrl:0
    v_max_u32_dpp v92, v92, v92 row_shr:2 row_mask:0xf bank_mask:0xf bound_ctrl:0
    v_max_u32_dpp v96, v96, v96 row_shr:2 row_mask:0xf bank_mask:0xf bound_ctrl:0
    v_max_u32_dpp v100, v100, v100 row_shr:2 row_mask:0xf bank_mask:0xf bound_ctrl:0
    v_max_u32_dpp v2, v2, v2 row_shr:2 row_mask:0xf bank_mask:0xf bound_ctrl:0
    v_max_u32_dpp v8, v8, v8 row_shr:2 row_mask:0xf bank_mask:0xf bound_ctrl:0
    v_max_u32_dpp v14, v14, v14 row_shr:2 row_mask:0xf bank_mask:0xf bound_ctrl:0
    v_max_u32_dpp v20, v20, v20 row_shr:2 row_mask:0xf bank_mask:0xf bound_ctrl:0
    v_max_u32_dpp v88, v88, v88 row_shr:4 row_mask:0xf bank_mask:0xf bound_ctrl:0
    v_max_u32_dpp v92, v92, v92 row_shr:4 row_mask:0xf bank_mask:0xf bound_ctrl:0
    v_max_u32_dpp v96, v96, v96 row_shr:4 row_mask:0xf bank_mask:0xf bound_ctrl:0
    v_max_u32_dpp v100, v100, v100 row_shr:4 row_mask:0xf bank_mask:0xf bound_ctrl:0
    v_max_u32_dpp v2, v2, v2 row_shr:4 row_mask:0xf bank_mask:0xf bound_ctrl:0
    v_max_u32_dpp v8, v8, v8 row_shr:4 row_mask:0xf bank_mask:0xf bound_ctrl:0
    v_max_u32_dpp v14, v14, v14 row_shr:4 row_mask:0xf bank_mask:0xf bound_ctrl:0
    v_max_u32_dpp v20, v20, v20 row_shr:4 row_mask:0xf bank_mask:0xf bound_ctrl:0
    v_max_u32_dpp v88, v88, v88 row_shr:8 row_mask:0xf bank_mask:0xf bound_ctrl:0
    v_max_u32_dpp v92, v92, v92 row_shr:8 row_mask:0xf bank_mask:0xf bound_ctrl:0
    v_max_u32_dpp v96, v96, v96 row_shr:8 row_mask:0xf bank_mask:0xf bound_ctrl:0
    v_max_u32_dpp v100, v100, v100 row_shr:8 row_mask:0xf bank_mask:0xf bound_ctrl:0
    v_max_u32_dpp v2, v2, v2 row_shr:8 row_mask:0xf bank_mask:0xf bound_ctrl:0
    v_max_u32_dpp v8, v8, v8 row_shr:8 row_mask:0xf bank_mask:0xf bound_ctrl:0
    v_max_u32_dpp v14, v14, v14 row_shr:8 row_mask:0xf bank_mask:0xf bound_ctrl:0
    v_max_u32_dpp v20, v20, v20 row_shr:8 row_mask:0xf bank_mask:0xf bound_ctrl:0
    v_max_u32_dpp v88, v88, v88 row_bcast:15 row_mask:0xa bank_mask:0xf
    v_max_u32_dpp v92, v92, v92 row_bcast:15 row_mask:0xa bank_mask:0xf
    v_max_u32_dpp v96, v96, v96 row_bcast:15 row_mask:0xa bank_mask:0xf
    v_max_u32_dpp v100, v100, v100 row_bcast:15 row_mask:0xa bank_mask:0xf
    v_max_u32_dpp v2, v2, v2 row_bcast:15 row_mask:0xa bank_mask:0xf
    v_max_u32_dpp v8, v8, v8 row_bcast:15 row_mask:0xa bank_mask:0xf
    v_max_u32_dpp v14, v14, v14 row_bcast:15 row_mask:0xa bank_mask:0xf
    v_max_u32_dpp v20, v20, v20 row_bcast:15 row_mask:0xa bank_mask:0xf
    v_max_u32_dpp v88, v88, v88 row_bcast:31 row_mask:0xc bank_mask:0xf
    v_max_u32_dpp v92, v92, v92 row_bcast:31 row_mask:0xc bank_mask:0xf
    v_max_u32_dpp v96, v96, v96 row_bcast:31 row_mask:0xc bank_mask:0xf
    v_max_u32_dpp v100, v100, v100 row_bcast:31 row_mask:0xc bank_mask:0xf
    v_max_u32_dpp v2, v2, v2 row_bcast:31 row_mask:0xc bank_mask:0xf
    v_max_u32_dpp v8, v8, v8 row_bcast:31 row_mask:0xc bank_mask:0xf
    v_max_u32_dpp v14, v14, v14 row_bcast:31 row_mask:0xc bank_mask:0xf
    v_max_u32_dpp v20, v20, v20 row_bcast:31 row_mask:0xc bank_mask:0xf
    s_nop 0
    v_readlane_b32 s41, v88, 63
    v_add_u32 v88, v88, v112
    v_add_u32 v88, 4294959104, v88
    v_max_u32 v92, s41, v92
    s_nop 0
    v_readlane_b32 s41, v92, 63
    v_add_u32 v92, v92, v112
    v_add_u32 v92, 4294960128, v92
    v_max_u32 v96, s41, v96
    s_nop 0
    v_readlane_b32 s41, v96, 63
    v_add_u32 v96, v96, v112
    v_add_u32 v96, 4294961152, v96
    v_max_u32 v100, s41, v100
    s_nop 0
    v_readlane_b32 s41, v100, 63
    v_add_u32 v100, v100, v112
    v_add_u32 v100, 4294962176, v100
    v_max_u32 v2, s41, v2
    s_nop 0
    v_readlane_b32 s41, v2, 63
    v_add_u32 v2, v2, v112
    v_add_u32 v2, 4294963200, v2
    v_max_u32 v8, s41, v8
    s_nop 0
    v_readlane_b32 s41, v8, 63
    v_add_u32 v8, v8, v112
    v_add_u32 v8, 4294964224, v8
    v_max_u32 v14, s41, v14
    s_nop 0
    v_readlane_b32 s41, v14, 63
    v_add_u32 v14, v14, v112
    v_add_u32 v14, 4294965248, v14
    v_max_u32 v20, s41, v20
    s_nop 0
    v_readlane_b32 s41, v20, 63
    v_add_u32 v20, v20, v112
    v_add_u32 v20, 4294966272, v20
    v_bfe_u32 v0, v2, 14, 4
    v_lshrrev_b32 v1, 18, v2
    v_and_b32 v2, 0x3fff, v2
    v_mad_u32_u24 v0, v0, s63, v1
    v_mad_u32_u24 v2, v0, s65, v2
    buffer_load_dwordx4 v[0:3], v2, s[68:71], 0 offen
    v_bfe_u32 v6, v8, 14, 4
    v_lshrrev_b32 v7, 18, v8
    v_and_b32 v8, 0x3fff, v8
    v_mad_u32_u24 v6, v6, s63, v7
    v_mad_u32_u24 v8, v6, s65, v8
    buffer_load_dwordx4 v[6:9], v8, s[68:71], 0 offen
    s_cmp_eq_u32 s21, 0
    s_cselect_b32 s44, 1073758208, 0
    v_mov_b32 v124, s44
    v_mov_b32 v125, s44
    v_mov_b32 v126, s44
    v_mov_b32 v127, s44
    v_add_u32 v123, s64, v112
    v_add_u32 v122, s25, v123
    ds_write_b128 v122, v[124:127] offset:0
    ds_write_b128 v122, v[124:127] offset:16384
    ds_write_b128 v122, v[124:127] offset:32768
    v_add_u32 v122, 49152, v122
    ds_write_b128 v122, v[124:127] offset:0
    ds_write_b128 v122, v[124:127] offset:16384
    ds_write_b128 v122, v[124:127] offset:32768
    v_cmpx_gt_u32 vcc, 1792, v123
    ds_write_b128 v122, v[124:127] offset:49152
    s_mov_b64 exec, -1
    v_bfe_u32 v12, v14, 14, 4
    v_lshrrev_b32 v13, 18, v14
    v_and_b32 v14, 0x3fff, v14
    v_mad_u32_u24 v12, v12, s63, v13
    v_mad_u32_u24 v14, v12, s65, v14
    buffer_load_dwordx4 v[12:15], v14, s[68:71], 0 offen
    s_mov_b32 s16, s17
    s_waitcnt vmcnt(6)
    s_cmp_lg_u32 s21, 0
    s_cbranch_scc1 p2_nostat1
    v_max_u32 v58, v58, v60
    v_add_f32 v59, v59, v61
    s_nop 1
    v_max_u32_dpp v58, v58, v58 row_shr:1 row_mask:0xf bank_mask:0xf bound_ctrl:0
    v_add_f32_dpp v59, v59, v59 row_shr:1 row_mask:0xf bank_mask:0xf bound_ctrl:0
    s_nop 0
    v_max_u32_dpp v58, v58, v58 row_shr:2 row_mask:0xf bank_mask:0xf bound_ctrl:0
    v_add_f32_dpp v59, v59, v59 row_shr:2 row_mask:0xf bank_mask:0xf bound_ctrl:0
    s_nop 0
    v_max_u32_dpp v58, v58, v58 row_shr:4 row_mask:0xf bank_mask:0xf bound_ctrl:0
    v_add_f32_dpp v59, v59, v59 row_shr:4 row_mask:0xf bank_mask:0xf bound_ctrl:0
    s_nop 0
    v_max_u32_dpp v58, v58, v58 row_shr:8 row_mask:0xf bank_mask:0xf bound_ctrl:0
    v_add_f32_dpp v59, v59, v59 row_shr:8 row_mask:0xf bank_mask:0xf bound_ctrl:0
    s_nop 0
    v_max_u32_dpp v58, v58, v58 row_bcast:15 row_mask:0xa bank_mask:0xf
    v_add_f32_dpp v59, v59, v59 row_bcast:15 row_mask:0xa bank_mask:0xf
    s_nop 0
    v_max_u32_dpp v58, v58, v58 row_bcast:31 row_mask:0xc bank_mask:0xf
    v_add_f32_dpp v59, v59, v59 row_bcast:31 row_mask:0xc bank_mask:0xf
    s_nop 0
    s_nop 0
    s_lshl_b32 s44, s10, 3
    v_mov_b32 v60, s44
    s_mov_b64 exec, 1
    s_lshl_b64 exec, exec, 63
    ds_write_b64 v60, v[58:59] offset:53824
    s_mov_b64 exec, -1
p2_nostat1:
    s_waitcnt lgkmcnt(0)
    s_barrier
    v_bfe_u32 v18, v20, 14, 4
    v_lshrrev_b32 v19, 18, v20
    v_and_b32 v20, 0x3fff, v20
    v_mad_u32_u24 v18, v18, s63, v19
    v_mad_u32_u24 v20, v18, s65, v20
    buffer_load_dwordx4 v[18:21], v20, s[68:71], 0 offen
    v_mov_b32 v122, s19
    s_xor_b32 s19, s19, 4
    ds_read_b32 v125, v122 offset:53760
    s_cmp_lg_u32 s21, 0
    s_cbranch_scc1 p2_nostat2
    v_bfe_u32 v60, v112, 1, 7
    ds_read_b64 v[58:59], v60 offset:53824
    s_waitcnt lgkmcnt(0)
    s_nop 1
    v_max_u32_dpp v58, v58, v58 row_shr:1 row_mask:0xf bank_mask:0xf bound_ctrl:0
    v_add_f32_dpp v59, v59, v59 row_shr:1 row_mask:0xf bank_mask:0xf bound_ctrl:0
    s_nop 0
    v_max_u32_dpp v58, v58, v58 row_shr:2 row_mask:0xf bank_mask:0xf bound_ctrl:0
    v_add_f32_dpp v59, v59, v59 row_shr:2 row_mask:0xf bank_mask:0xf bound_ctrl:0
    s_nop 0
    v_max_u32_dpp v58, v58, v58 row_shr:4 row_mask:0xf bank_mask:0xf bound_ctrl:0
    v_add_f32_dpp v59, v59, v59 row_shr:4 row_mask:0xf bank_mask:0xf bound_ctrl:0
    s_nop 0
    v_max_u32_dpp v58, v58, v58 row_shr:8 row_mask:0xf bank_mask:0xf bound_ctrl:0
    v_add_f32_dpp v59, v59, v59 row_shr:8 row_mask:0xf bank_mask:0xf bound_ctrl:0
    s_nop 0
    v_max_u32_dpp v58, v58, v58 row_bcast:15 row_mask:0xa bank_mask:0xf
    v_add_f32_dpp v59, v59, v59 row_bcast:15 row_mask:0xa bank_mask:0xf
    s_nop 0
    v_max_u32_dpp v58, v58, v58 row_bcast:31 row_mask:0xc bank_mask:0xf
    v_add_f32_dpp v59, v59, v59 row_bcast:31 row_mask:0xc bank_mask:0xf
    s_nop 0
    s_nop 0
    v_readlane_b32 s44, v58, 15
    v_readlane_b32 s45, v59, 15
    s_nop 1
    s_lshl_b32 s44, s44, 16
    s_lshr_b32 s46, s44, 23
    s_sub_u32 s47, s46, 80
    s_cmp_lt_u32 s47, 100
    s_cselect_b32 s21, 0, 1
    v_mov_b32 v58, s45
    v_mul_f32 v58, 0x34a7c5ac, v58
    v_sqrt_f32 v58, v58
    v_mov_b32 v59, s44
    v_mul_f32 v60, 0x41800000, v58
    v_cmp_nle_f32 vcc, v59, v60
    v_mul_f32 v58, 0x3ac00000, v58
    v_mul_f32 v59, 0x3901742e, v59
    v_max_f32 v58, v58, v59
    s_cmp_lg_u64 vcc, 0
    s_cselect_b32 s21, 1, s21
    v_readfirstlane_b32 s44, v58
    s_nop 0
    s_and_b32 s47, s44, 0x7fffff
    s_or_b32 s47, s47, 0x3f000000
    s_and_b32 s48, s44, 0x7f800000
    s_add_u32 s48, s48, 0x800000
    v_rcp_f32 v58, s47
    s_nop 0
    v_rcp_f32 v59, v58
    v_mul_f32 v58, 0x7b800000, v58
    v_mul_f32 v59, s48, v59
    s_nop 0
    v_readfirstlane_b32 s26, v58
    v_readfirstlane_b32 s30, v59
    s_add_u32 s34, s48, 197132288
    s_mov_b32 s35, s34
    s_sub_u32 s36, 0, s34
    s_subb_u32 s37, 0, s34
    s_cmp_eq_u32 s21, 0
    s_cbranch_scc1 p2_nostat2
    s_waitcnt vmcnt(0) lgkmcnt(0)
    s_branch p2_restart
p2_nostat2:
    s_cmp_eq_u32 s21, 0
    s_cselect_b32 s26, s26, 0x7b800000
    v_mov_b32 v114, s26
    s_waitcnt lgkmcnt(0)
    v_readfirstlane_b32 s44, v125
    s_nop 0
    s_cmp_lg_u32 s44, 0
    s_cbranch_scc1 p2_adva
    s_mov_b32 s61, 1
    v_mov_b32 v110, v66
    v_mov_b32 v111, v67
p2_adva:
    v_bfe_u32 v86, v88, 14, 4
    v_lshrrev_b32 v87, 18, v88
    v_and_b32 v88, 0x3fff, v88
    v_mad_u32_u24 v86, v86, s63, v87
    v_mad_u32_u24 v88, v86, s65, v88
    buffer_load_dwordx4 v[86:89], v88, s[68:71], 0 offen
    s_mov_b32 m0, s23
    v_mov_b32 v53, 0
    s_movk_i32 s44, 512
    v_sub_u32_sdwa v4, v111, v110 dst_sel:DWORD dst_unused:UNUSED_PAD src0_sel:WORD_0 src1_sel:WORD_0
    v_sub_u32_sdwa v5, v111, v110 dst_sel:DWORD dst_unused:UNUSED_PAD src0_sel:WORD_1 src1_sel:WORD_1
    v_med3_i32 v4, v4, 0, s44
    v_med3_i32 v5, v5, 0, s44
    v_add_u32 v48, v4, v5
    ds_write_addtid_b32 v53 offset:0
    ds_write_addtid_b32 v53 offset:256
    ds_write_addtid_b32 v53 offset:512
    ds_write_addtid_b32 v53 offset:768
    ds_write_addtid_b32 v53 offset:1024
    ds_write_addtid_b32 v53 offset:1280
    ds_write_addtid_b32 v53 offset:1536
    ds_write_addtid_b32 v53 offset:1792
    v_bfe_i32 v53, v112, 6, 1
    v_lshrrev_b32 v49, 6, v112
    v_bitop3_b32 v53, v53, 15, s10 bitop3:0x6a
    v_lshl_or_b32 v49, v49, 4, v53
    v_and_b32 v53, 0x30, v112
    v_lshl_or_b32 v53, v49, 6, v53
    v_lshlrev_b32 v53, 15, v53
    s_nop 1
    v_add_u32_dpp v48, v48, v48 row_shr:1 row_mask:0xf bank_mask:0xf bound_ctrl:0
    s_nop 1
    v_add_u32_dpp v48, v48, v48 row_shr:2 row_mask:0xf bank_mask:0xf bound_ctrl:0
    s_nop 1
    v_add_u32_dpp v48, v48, v48 row_shr:4 row_mask:0xf bank_mask:0xf bound_ctrl:0
    s_nop 1
    v_add_u32_dpp v48, v48, v48 row_shr:8 row_mask:0xf bank_mask:0xf bound_ctrl:0
    s_nop 1
    v_add_u32_dpp v48, v48, v48 row_bcast:15 row_mask:0xa bank_mask:0xf
    s_nop 1
    v_add_u32_dpp v48, v48, v48 row_bcast:31 row_mask:0xc bank_mask:0xf
    s_nop 1
    s_nop 0
    v_readlane_b32 s38, v48, 63
    v_sub_u32 v50, v48, v5
    v_sub_u32 v49, v50, v4
    v_writelane_b32 v5, 1, 63
    v_sub_u32 v10, 512, v49
    v_mad_u32_u16 v51, v110, 16, v53
    v_lshl_add_u32 v51, v10, 4, v51
    v_med3_i32 v10, v10, 0, v4
    v_lshl_add_u32 v49, v49, 2, s23
    v_sub_u32 v11, 512, v50
    v_mad_u32_u16 v52, v110, 16, v53 op_sel:[1,0,0,0]
    v_add_u32 v52, 262144, v52
    s_mov_b32 s44, 0x1fffc000
    v_writelane_b32 v52, s44, 63
    v_lshl_add_u32 v52, v11, 4, v52
    v_med3_i32 v11, v11, 0, v5
    v_lshl_add_u32 v50, v50, 2, s23
    v_lshl_add_u32 v48, v11, 16, v10
    v_add_u32 v110, v110, v48
    s_min_u32 s17, s38, 512
    s_add_u32 s17, s17, 63
    s_lshr_b32 s17, s17, 6
    v_cmpx_lt_i32 vcc, 0, v10
    ds_write_b32 v49, v51
    s_mov_b64 exec, -1
    v_cmpx_lt_i32 vcc, 0, v11
    ds_write_b32 v50, v52
    s_mov_b64 exec, -1
    s_cmp_lt_u32 s38, 512
    s_cbranch_scc1 p2_nomoreb
    v_cmp_lt_u32_sdwa s[44:45], v110, v111 src0_sel:WORD_0 src1_sel:WORD_0
    v_cmp_lt_u32_sdwa s[46:47], v110, v111 src0_sel:WORD_1 src1_sel:WORD_1
    s_nop 0
    s_or_b64 s[44:45], s[44:45], s[46:47]
    s_cbranch_scc0 p2_nomoreb
    v_mov_b32 v49, s19
    v_mov_b32 v50, 1
    ds_write_b32 v49, v50 offset:53760
p2_nomoreb:
    s_mov_b32 m0, s23
    s_nop 0
    ds_read_addtid_b32 v102 offset:1024
    ds_read_addtid_b32 v103 offset:1280
    ds_read_addtid_b32 v104 offset:1536
    ds_read_addtid_b32 v105 offset:1792
    ds_read_addtid_b32 v106 offset:0
    ds_read_addtid_b32 v107 offset:256
    ds_read_addtid_b32 v108 offset:512
    ds_read_addtid_b32 v109 offset:768
    v_bfe_u32 v90, v92, 14, 4
    v_lshrrev_b32 v91, 18, v92
    v_and_b32 v92, 0x3fff, v92
    v_mad_u32_u24 v90, v90, s63, v91
    v_mad_u32_u24 v92, v90, s65, v92
    buffer_load_dwordx4 v[90:93], v92, s[68:71], 0 offen
    s_waitcnt vmcnt(6)
    s_mov_b32 m0, s24
    s_cmp_ge_u32 s10, 9
    s_cbranch_scc1 p2_stp
    ds_write_addtid_b32 v84 offset:49152
    ds_write_addtid_b32 v85 offset:49408
p2_stp:
    s_mov_b32 m0, s23
    s_add_u32 s20, s20, 53760
    ds_write_addtid_b32 v72 offset:0
    ds_write_addtid_b32 v73 offset:256
    ds_write_addtid_b32 v74 offset:512
    ds_write_addtid_b32 v75 offset:768
    ds_write_addtid_b32 v76 offset:1024
    ds_write_addtid_b32 v77 offset:1280
    ds_write_addtid_b32 v78 offset:1536
    ds_write_addtid_b32 v79 offset:1792
    ds_write_addtid_b32 v80 offset:2048
    ds_write_addtid_b32 v81 offset:2304
    ds_write_addtid_b32 v82 offset:2560
    ds_write_addtid_b32 v83 offset:2816
    s_waitcnt lgkmcnt(0)
    s_barrier
    v_bfe_u32 v94, v96, 14, 4
    v_lshrrev_b32 v95, 18, v96
    v_and_b32 v96, 0x3fff, v96
    v_mad_u32_u24 v94, v94, s63, v95
    v_mad_u32_u24 v96, v94, s65, v96
    buffer_load_dwordx4 v[94:97], v96, s[68:71], 0 offen
    v_bfe_u32 v98, v100, 14, 4
    v_lshrrev_b32 v99, 18, v100
    v_and_b32 v100, 0x3fff, v100
    v_mad_u32_u24 v98, v98, s63, v99
    v_mad_u32_u24 v100, v98, s65, v100
    buffer_load_dwordx4 v[98:101], v100, s[68:71], 0 offen
    s_nop 2
    s_nop 1
    v_max_u32_dpp v106, v106, v106 row_shr:1 row_mask:0xf bank_mask:0xf bound_ctrl:0
    v_max_u32_dpp v107, v107, v107 row_shr:1 row_mask:0xf bank_mask:0xf bound_ctrl:0
    v_max_u32_dpp v108, v108, v108 row_shr:1 row_mask:0xf bank_mask:0xf bound_ctrl:0
    v_max_u32_dpp v109, v109, v109 row_shr:1 row_mask:0xf bank_mask:0xf bound_ctrl:0
    v_max_u32_dpp v106, v106, v106 row_shr:2 row_mask:0xf bank_mask:0xf bound_ctrl:0
    v_max_u32_dpp v107, v107, v107 row_shr:2 row_mask:0xf bank_mask:0xf bound_ctrl:0
    v_max_u32_dpp v108, v108, v108 row_shr:2 row_mask:0xf bank_mask:0xf bound_ctrl:0
    v_max_u32_dpp v109, v109, v109 row_shr:2 row_mask:0xf bank_mask:0xf bound_ctrl:0
    v_max_u32_dpp v106, v106, v106 row_shr:4 row_mask:0xf bank_mask:0xf bound_ctrl:0
    v_max_u32_dpp v107, v107, v107 row_shr:4 row_mask:0xf bank_mask:0xf bound_ctrl:0
    v_max_u32_dpp v108, v108, v108 row_shr:4 row_mask:0xf bank_mask:0xf bound_ctrl:0
    v_max_u32_dpp v109, v109, v109 row_shr:4 row_mask:0xf bank_mask:0xf bound_ctrl:0
    v_max_u32_dpp v106, v106, v106 row_shr:8 row_mask:0xf bank_mask:0xf bound_ctrl:0
    v_max_u32_dpp v107, v107, v107 row_shr:8 row_mask:0xf bank_mask:0xf bound_ctrl:0
    v_max_u32_dpp v108, v108, v108 row_shr:8 row_mask:0xf bank_mask:0xf bound_ctrl:0
    v_max_u32_dpp v109, v109, v109 row_shr:8 row_mask:0xf bank_mask:0xf bound_ctrl:0
    v_max_u32_dpp v106, v106, v106 row_bcast:15 row_mask:0xa bank_mask:0xf
    v_max_u32_dpp v107, v107, v107 row_bcast:15 row_mask:0xa bank_mask:0xf
    v_max_u32_dpp v108, v108, v108 row_bcast:15 row_mask:0xa bank_mask:0xf
    v_max_u32_dpp v109, v109, v109 row_bcast:15 row_mask:0xa bank_mask:0xf
    v_max_u32_dpp v106, v106, v106 row_bcast:31 row_mask:0xc bank_mask:0xf
    v_max_u32_dpp v107, v107, v107 row_bcast:31 row_mask:0xc bank_mask:0xf
    v_max_u32_dpp v108, v108, v108 row_bcast:31 row_mask:0xc bank_mask:0xf
    v_max_u32_dpp v109, v109, v109 row_bcast:31 row_mask:0xc bank_mask:0xf
    s_nop 0
    v_readlane_b32 s41, v106, 63
    v_add_u32 v106, v106, v112
    v_add_u32 v106, 4294959104, v106
    v_max_u32 v107, s41, v107
    s_nop 0
    v_readlane_b32 s41, v107, 63
    v_add_u32 v107, v107, v112
    v_add_u32 v107, 4294960128, v107
    v_max_u32 v108, s41, v108
    s_nop 0
    v_readlane_b32 s41, v108, 63
    v_add_u32 v108, v108, v112
    v_add_u32 v108, 4294961152, v108
    v_max_u32 v109, s41, v109
    s_nop 0
    v_readlane_b32 s41, v109, 63
    v_add_u32 v109, v109, v112
    v_add_u32 v109, 4294962176, v109
    s_waitcnt vmcnt(7)
    v_perm_b32 v48, v3, v0, s31
    v_perm_b32 v49, v3, v1, s32
    v_perm_b32 v50, v3, v2, s33
    v_lshlrev_b16 v4, 3, v2
    v_lshlrev_b16 v2, 3, v1
    v_lshlrev_b16 v0, 3, v0
    v_cmpx_ge_u16 vcc, 0x3fff, v48
    ds_read_b64 v[0:1], v0
    s_mov_b64 exec, -1
    v_cmpx_ge_u16 vcc, 0x3fff, v49
    ds_read_b64 v[2:3], v2
    s_mov_b64 exec, -1
    v_cmpx_ge_u16 vcc, 0x3fff, v50
    ds_read_b64 v[4:5], v4
    s_mov_b64 exec, -1
    s_waitcnt vmcnt(6)
    v_perm_b32 v51, v9, v6, s31
    v_perm_b32 v52, v9, v7, s32
    v_perm_b32 v53, v9, v8, s33
    v_lshlrev_b16 v10, 3, v8
    v_lshlrev_b16 v8, 3, v7
    v_lshlrev_b16 v6, 3, v6
    v_cmpx_ge_u16 vcc, 0x3fff, v51
    ds_read_b64 v[6:7], v6
    s_mov_b64 exec, -1
    v_cmpx_ge_u16 vcc, 0x3fff, v52
    ds_read_b64 v[8:9], v8
    s_mov_b64 exec, -1
    v_cmpx_ge_u16 vcc, 0x3fff, v53
    ds_read_b64 v[10:11], v10
    s_mov_b64 exec, -1
    s_waitcnt vmcnt(5)
    v_perm_b32 v54, v15, v12, s31
    v_perm_b32 v55, v15, v13, s32
    v_perm_b32 v56, v15, v14, s33
    v_lshlrev_b16 v16, 3, v14
    v_lshlrev_b16 v14, 3, v13
    v_lshlrev_b16 v12, 3, v12
    v_cmpx_ge_u16 vcc, 0x3fff, v54
    ds_read_b64 v[12:13], v12
    s_mov_b64 exec, -1
    v_cmpx_ge_u16 vcc, 0x3fff, v55
    ds_read_b64 v[14:15], v14
    s_mov_b64 exec, -1
    v_cmpx_ge_u16 vcc, 0x3fff, v56
    ds_read_b64 v[16:17], v16
    s_mov_b64 exec, -1
    s_waitcnt vmcnt(4)
    v_perm_b32 v57, v21, v18, s31
    v_perm_b32 v58, v21, v19, s32
    v_perm_b32 v59, v21, v20, s33
    v_lshlrev_b16 v22, 3, v20
    v_lshlrev_b16 v20, 3, v19
    v_lshlrev_b16 v18, 3, v18
    s_cmp_lt_u32 s16, 8
    s_cbranch_scc1 p2_gp
    v_cmpx_ge_u16 vcc, 0x3fff, v57
    ds_read_b64 v[18:19], v18
    s_mov_b64 exec, -1
    v_cmpx_ge_u16 vcc, 0x3fff, v58
    ds_read_b64 v[20:21], v20
    s_mov_b64 exec, -1
    v_cmpx_ge_u16 vcc, 0x3fff, v59
    ds_read_b64 v[22:23], v22
    s_mov_b64 exec, -1
p2_gp:
    s_waitcnt vmcnt(3)
    v_perm_b32 v60, v89, v86, s31
    v_perm_b32 v61, v89, v87, s32
    v_perm_b32 v62, v89, v88, s33
    v_lshlrev_b16 v28, 3, v88
    v_lshlrev_b16 v26, 3, v87
    v_lshlrev_b16 v24, 3, v86
    v_cmpx_ge_u16 vcc, 0x3fff, v60
    ds_read_b64 v[24:25], v24
    s_mov_b64 exec, -1
    v_cmpx_ge_u16 vcc, 0x3fff, v61
    ds_read_b64 v[26:27], v26
    s_mov_b64 exec, -1
    v_cmpx_ge_u16 vcc, 0x3fff, v62
    ds_read_b64 v[28:29], v28
    s_mov_b64 exec, -1
    v_bfe_u32 v86, v106, 14, 4
    v_lshrrev_b32 v87, 18, v106
    v_and_b32 v106, 0x3fff, v106
    v_mad_u32_u24 v86, v86, s63, v87
    v_mad_u32_u24 v106, v86, s65, v106
    buffer_load_dwordx4 v[86:89], v106, s[68:71], 0 offen
    s_cmp_ge_u32 s10, 9
    s_cbranch_scc1 p2_nmq
    v_lshrrev_b32 v84, 1, v112
    s_add_u32 s44, s20, s42
    buffer_load_dwordx2 v[84:85], v84, s[4:7], s44 offen
p2_nmq:
    buffer_load_dwordx4 v[72:75], v112, s[4:7], s20 offen offset:0
    buffer_load_dwordx4 v[76:79], v112, s[4:7], s20 offen offset:1024
    buffer_load_dwordx4 v[80:83], v112, s[4:7], s20 offen offset:2048
    s_waitcnt vmcnt(6)
    v_perm_b32 v63, v93, v90, s31
    v_perm_b32 v64, v93, v91, s32
    v_perm_b32 v65, v93, v92, s33
    v_lshlrev_b16 v34, 3, v92
    v_lshlrev_b16 v32, 3, v91
    v_lshlrev_b16 v30, 3, v90
    v_cmpx_ge_u16 vcc, 0x3fff, v63
    ds_read_b64 v[30:31], v30
    s_mov_b64 exec, -1
    v_cmpx_ge_u16 vcc, 0x3fff, v64
    ds_read_b64 v[32:33], v32
    s_mov_b64 exec, -1
    v_cmpx_ge_u16 vcc, 0x3fff, v65
    ds_read_b64 v[34:35], v34
    s_mov_b64 exec, -1
    v_bfe_u32 v90, v107, 14, 4
    v_lshrrev_b32 v91, 18, v107
    v_and_b32 v107, 0x3fff, v107
    v_mad_u32_u24 v90, v90, s63, v91
    v_mad_u32_u24 v107, v90, s65, v107
    buffer_load_dwordx4 v[90:93], v107, s[68:71], 0 offen
    s_waitcnt vmcnt(6)
    v_perm_b32 v66, v97, v94, s31
    v_perm_b32 v67, v97, v95, s32
    v_perm_b32 v68, v97, v96, s33
    v_lshlrev_b16 v40, 3, v96
    v_lshlrev_b16 v38, 3, v95
    v_lshlrev_b16 v36, 3, v94
    v_cmpx_ge_u16 vcc, 0x3fff, v66
    ds_read_b64 v[36:37], v36
    s_mov_b64 exec, -1
    v_cmpx_ge_u16 vcc, 0x3fff, v67
    ds_read_b64 v[38:39], v38
    s_mov_b64 exec, -1
    v_cmpx_ge_u16 vcc, 0x3fff, v68
    ds_read_b64 v[40:41], v40
    s_mov_b64 exec, -1
    v_bfe_u32 v94, v108, 14, 4
    v_lshrrev_b32 v95, 18, v108
    v_and_b32 v108, 0x3fff, v108
    v_mad_u32_u24 v94, v94, s63, v95
    v_mad_u32_u24 v108, v94, s65, v108
    buffer_load_dwordx4 v[94:97], v108, s[68:71], 0 offen
    s_waitcnt vmcnt(6)
    v_perm_b32 v69, v101, v98, s31
    v_perm_b32 v70, v101, v99, s32
    v_perm_b32 v71, v101, v100, s33
    v_lshlrev_b16 v46, 3, v100
    v_lshlrev_b16 v44, 3, v99
    v_lshlrev_b16 v42, 3, v98
    v_cmpx_ge_u16 vcc, 0x3fff, v69
    ds_read_b64 v[42:43], v42
    s_mov_b64 exec, -1
    v_cmpx_ge_u16 vcc, 0x3fff, v70
    ds_read_b64 v[44:45], v44
    s_mov_b64 exec, -1
    v_cmpx_ge_u16 vcc, 0x3fff, v71
    ds_read_b64 v[46:47], v46
    s_mov_b64 exec, -1
    s_waitcnt lgkmcnt(0)
    s_barrier
    s_branch p2_tail
p2_top:
    s_cmp_lg_u32 s21, 0
    s_cbranch_scc1 p2_topf
    s_cmp_eq_u32 s60, 10
    s_cbranch_scc1 p2_drain0
    s_setprio 3
    v_cmpx_gt_i16 vcc, 0, v48
    ds_read_b64 v[0:1], v0
    s_mov_b64 exec, -1
    v_cmpx_gt_i16 vcc, 0, v49
    ds_read_b64 v[2:3], v2
    s_mov_b64 exec, -1
    v_cmpx_gt_i16 vcc, 0, v50
    ds_read_b64 v[4:5], v4
    s_mov_b64 exec, -1
    v_cmpx_gt_i16 vcc, 0, v51
    ds_read_b64 v[6:7], v6
    s_mov_b64 exec, -1
    v_cmpx_gt_i16 vcc, 0, v52
    ds_read_b64 v[8:9], v8
    s_mov_b64 exec, -1
    v_cmpx_gt_i16 vcc, 0, v53
    ds_read_b64 v[10:11], v10
    s_mov_b64 exec, -1
    v_cmpx_gt_i16 vcc, 0, v54
    ds_read_b64 v[12:13], v12
    s_mov_b64 exec, -1
    v_cmpx_gt_i16 vcc, 0, v55
    ds_read_b64 v[14:15], v14
    s_mov_b64 exec, -1
    v_cmpx_gt_i16 vcc, 0, v56
    ds_read_b64 v[16:17], v16
    s_mov_b64 exec, -1
    s_cmp_lt_u32 s15, 8
    s_cbranch_scc1 p2_g0r23
    v_cmpx_gt_i16 vcc, 0, v57
    ds_read_b64 v[18:19], v18
    s_mov_b64 exec, -1
    v_cmpx_gt_i16 vcc, 0, v58
    ds_read_b64 v[20:21], v20
    s_mov_b64 exec, -1
    v_cmpx_gt_i16 vcc, 0, v59
    ds_read_b64 v[22:23], v22
    s_mov_b64 exec, -1
p2_g0r23:
    s_cmp_ge_u32 s10, 9
    s_cbranch_scc1 p2_nm0m0a
    v_lshrrev_b32 v84, 1, v112
    s_add_u32 s44, s20, s42
    buffer_load_dwordx2 v[84:85], v84, s[4:7], s44 offen
p2_nm0m0a:
    buffer_load_dwordx4 v[72:75], v112, s[4:7], s20 offen offset:0
    buffer_load_dwordx4 v[76:79], v112, s[4:7], s20 offen offset:1024
    buffer_load_dwordx4 v[80:83], v112, s[4:7], s20 offen offset:2048
    v_cmpx_gt_i16 vcc, 0, v60
    ds_read_b64 v[24:25], v24
    s_mov_b64 exec, -1
    v_cmpx_gt_i16 vcc, 0, v61
    ds_read_b64 v[26:27], v26
    s_mov_b64 exec, -1
    v_cmpx_gt_i16 vcc, 0, v62
    ds_read_b64 v[28:29], v28
    s_mov_b64 exec, -1
    v_cmpx_gt_i16 vcc, 0, v63
    ds_read_b64 v[30:31], v30
    s_mov_b64 exec, -1
    v_cmpx_gt_i16 vcc, 0, v64
    ds_read_b64 v[32:33], v32
    s_mov_b64 exec, -1
    v_cmpx_gt_i16 vcc, 0, v65
    ds_read_b64 v[34:35], v34
    s_mov_b64 exec, -1
    v_cmpx_gt_i16 vcc, 0, v66
    ds_read_b64 v[36:37], v36
    s_mov_b64 exec, -1
    v_cmpx_gt_i16 vcc, 0, v67
    ds_read_b64 v[38:39], v38
    s_mov_b64 exec, -1
    v_cmpx_gt_i16 vcc, 0, v68
    ds_read_b64 v[40:41], v40
    s_mov_b64 exec, -1
    v_cmpx_gt_i16 vcc, 0, v69
    ds_read_b64 v[42:43], v42
    s_mov_b64 exec, -1
    v_cmpx_gt_i16 vcc, 0, v70
    ds_read_b64 v[44:45], v44
    s_mov_b64 exec, -1
    v_cmpx_gt_i16 vcc, 0, v71
    ds_read_b64 v[46:47], v46
    s_mov_b64 exec, -1
    s_setprio 2
    s_waitcnt lgkmcnt(15)
    v_ashrrev_i32 v122, 5, v48
    v_lshlrev_b16 v123, 2, v48
    v_lshlrev_b32 v124, 16, v0
    v_bitop3_b32 v122, v122, v113, v113 bitop3:0x0c
    v_and_b32 v125, 0xffff0000, v0
    v_lshlrev_b32 v126, 16, v1
    v_mul_f32 v122, v114, v122
    v_and_b32 v127, 0xffff0000, v1
    v_add_u32 v123, v123, v123
    v_pk_fma_f32 v[124:125], v[124:125], v[122:123], s[34:35] op_sel_hi:[1,0,1]
    v_pk_fma_f32 v[126:127], v[126:127], v[122:123], s[34:35] op_sel_hi:[1,0,1]
    v_lshl_add_u32 v124, v125, 16, v124
    v_lshl_add_u32 v125, v127, 16, v126
    s_waitcnt lgkmcnt(15)
    v_bitop3_b32 v115, v115, v116, v117 bitop3:0xfe
    v_lshl_add_u64 v[124:125], v[124:125], 0, s[36:37]
    v_cmpx_le_u32 vcc, 0x1000000, v48
    ds_add_rtn_u64 v[116:117], v123, v[124:125] offset:54272
    s_mov_b64 exec, -1
    v_ashrrev_i32 v122, 5, v49
    v_lshlrev_b16 v123, 2, v49
    v_lshlrev_b32 v124, 16, v2
    v_bitop3_b32 v122, v122, v113, v113 bitop3:0x0c
    v_and_b32 v125, 0xffff0000, v2
    v_lshlrev_b32 v126, 16, v3
    v_mul_f32 v122, v114, v122
    v_and_b32 v127, 0xffff0000, v3
    v_add_u32 v123, v123, v123
    v_pk_fma_f32 v[124:125], v[124:125], v[122:123], s[34:35] op_sel_hi:[1,0,1]
    v_pk_fma_f32 v[126:127], v[126:127], v[122:123], s[34:35] op_sel_hi:[1,0,1]
    v_lshl_add_u32 v124, v125, 16, v124
    v_lshl_add_u32 v125, v127, 16, v126
    s_waitcnt lgkmcnt(15)
    v_bitop3_b32 v115, v115, v118, v119 bitop3:0xfe
    v_lshl_add_u64 v[124:125], v[124:125], 0, s[36:37]
    v_cmpx_le_u32 vcc, 0x1000000, v49
    ds_add_rtn_u64 v[118:119], v123, v[124:125] offset:54272
    s_mov_b64 exec, -1
    v_ashrrev_i32 v122, 5, v50
    v_lshlrev_b16 v123, 2, v50
    v_lshlrev_b32 v124, 16, v4
    v_bitop3_b32 v122, v122, v113, v113 bitop3:0x0c
    v_and_b32 v125, 0xffff0000, v4
    v_lshlrev_b32 v126, 16, v5
    v_mul_f32 v122, v114, v122
    v_and_b32 v127, 0xffff0000, v5
    v_add_u32 v123, v123, v123
    v_pk_fma_f32 v[124:125], v[124:125], v[122:123], s[34:35] op_sel_hi:[1,0,1]
    v_pk_fma_f32 v[126:127], v[126:127], v[122:123], s[34:35] op_sel_hi:[1,0,1]
    v_lshl_add_u32 v124, v125, 16, v124
    v_lshl_add_u32 v125, v127, 16, v126
    s_waitcnt lgkmcnt(15)
    v_bitop3_b32 v115, v115, v120, v121 bitop3:0xfe
    v_lshl_add_u64 v[124:125], v[124:125], 0, s[36:37]
    v_cmpx_le_u32 vcc, 0x1000000, v50
    ds_add_rtn_u64 v[120:121], v123, v[124:125] offset:54272
    s_mov_b64 exec, -1
    v_bfe_u32 v0, v102, 14, 4
    v_lshrrev_b32 v1, 18, v102
    v_and_b32 v102, 0x3fff, v102
    v_mad_u32_u24 v0, v0, s63, v1
    v_mad_u32_u24 v102, v0, s65, v102
    buffer_load_dwordx4 v[0:3], v102, s[68:71], 0 offen
    s_setprio 1
    s_waitcnt lgkmcnt(15)
    v_ashrrev_i32 v122, 5, v51
    v_lshlrev_b16 v123, 2, v51
    v_lshlrev_b32 v124, 16, v6
    v_bitop3_b32 v122, v122, v113, v113 bitop3:0x0c
    v_and_b32 v125, 0xffff0000, v6
    v_lshlrev_b32 v126, 16, v7
    v_mul_f32 v122, v114, v122
    v_and_b32 v127, 0xffff0000, v7
    v_add_u32 v123, v123, v123
    v_pk_fma_f32 v[124:125], v[124:125], v[122:123], s[34:35] op_sel_hi:[1,0,1]
    v_pk_fma_f32 v[126:127], v[126:127], v[122:123], s[34:35] op_sel_hi:[1,0,1]
    v_lshl_add_u32 v124, v125, 16, v124
    v_lshl_add_u32 v125, v127, 16, v126
    s_waitcnt lgkmcnt(2)
    v_bitop3_b32 v115, v115, v116, v117 bitop3:0xfe
    v_lshl_add_u64 v[124:125], v[124:125], 0, s[36:37]
    v_cmpx_le_u32 vcc, 0x1000000, v51
    ds_add_rtn_u64 v[116:117], v123, v[124:125] offset:54272
    s_mov_b64 exec, -1
    v_ashrrev_i32 v122, 5, v52
    v_lshlrev_b16 v123, 2, v52
    v_lshlrev_b32 v124, 16, v8
    v_bitop3_b32 v122, v122, v113, v113 bitop3:0x0c
    v_and_b32 v125, 0xffff0000, v8
    v_lshlrev_b32 v126, 16, v9
    v_mul_f32 v122, v114, v122
    v_and_b32 v127, 0xffff0000, v9
    v_add_u32 v123, v123, v123
    v_pk_fma_f32 v[124:125], v[124:125], v[122:123], s[34:35] op_sel_hi:[1,0,1]
    v_pk_fma_f32 v[126:127], v[126:127], v[122:123], s[34:35] op_sel_hi:[1,0,1]
    v_lshl_add_u32 v124, v125, 16, v124
    v_lshl_add_u32 v125, v127, 16, v126
    s_waitcnt lgkmcnt(2)
    v_bitop3_b32 v115, v115, v118, v119 bitop3:0xfe
    v_lshl_add_u64 v[124:125], v[124:125], 0, s[36:37]
    v_cmpx_le_u32 vcc, 0x1000000, v52
    ds_add_rtn_u64 v[118:119], v123, v[124:125] offset:54272
    s_mov_b64 exec, -1
    v_ashrrev_i32 v122, 5, v53
    v_lshlrev_b16 v123, 2, v53
    v_lshlrev_b32 v124, 16, v10
    v_bitop3_b32 v122, v122, v113, v113 bitop3:0x0c
    v_and_b32 v125, 0xffff0000, v10
    v_lshlrev_b32 v126, 16, v11
    v_mul_f32 v122, v114, v122
    v_and_b32 v127, 0xffff0000, v11
    v_add_u32 v123, v123, v123
    v_pk_fma_f32 v[124:125], v[124:125], v[122:123], s[34:35] op_sel_hi:[1,0,1]
    v_pk_fma_f32 v[126:127], v[126:127], v[122:123], s[34:35] op_sel_hi:[1,0,1]
    v_lshl_add_u32 v124, v125, 16, v124
    v_lshl_add_u32 v125, v127, 16, v126
    s_waitcnt lgkmcnt(2)
    v_bitop3_b32 v115, v115, v120, v121 bitop3:0xfe
    v_lshl_add_u64 v[124:125], v[124:125], 0, s[36:37]
    v_cmpx_le_u32 vcc, 0x1000000, v53
    ds_add_rtn_u64 v[120:121], v123, v[124:125] offset:54272
    s_mov_b64 exec, -1
    v_bfe_u32 v6, v103, 14, 4
    v_lshrrev_b32 v7, 18, v103
    v_and_b32 v103, 0x3fff, v103
    v_mad_u32_u24 v6, v6, s63, v7
    v_mad_u32_u24 v103, v6, s65, v103
    buffer_load_dwordx4 v[6:9], v103, s[68:71], 0 offen
    s_waitcnt lgkmcnt(6)
    s_barrier
    s_setprio 3
    s_waitcnt vmcnt(5)
    s_mov_b32 m0, s23
    v_mov_b32 v53, 0
    s_movk_i32 s44, 512
    v_sub_u32_sdwa v4, v111, v110 dst_sel:DWORD dst_unused:UNUSED_PAD src0_sel:WORD_0 src1_sel:WORD_0
    v_sub_u32_sdwa v5, v111, v110 dst_sel:DWORD dst_unused:UNUSED_PAD src0_sel:WORD_1 src1_sel:WORD_1
    v_med3_i32 v4, v4, 0, s44
    v_med3_i32 v5, v5, 0, s44
    v_add_u32 v48, v4, v5
    ds_write_addtid_b32 v53 offset:0
    ds_write_addtid_b32 v53 offset:256
    ds_write_addtid_b32 v53 offset:512
    ds_write_addtid_b32 v53 offset:768
    ds_write_addtid_b32 v53 offset:1024
    ds_write_addtid_b32 v53 offset:1280
    ds_write_addtid_b32 v53 offset:1536
    ds_write_addtid_b32 v53 offset:1792
    v_bfe_i32 v53, v112, 6, 1
    v_lshrrev_b32 v49, 6, v112
    v_bitop3_b32 v53, v53, 15, s10 bitop3:0x6a
    v_lshl_or_b32 v49, v49, 4, v53
    v_and_b32 v53, 0x30, v112
    v_lshl_or_b32 v53, v49, 6, v53
    v_lshlrev_b32 v53, 15, v53
    s_nop 1
    v_add_u32_dpp v48, v48, v48 row_shr:1 row_mask:0xf bank_mask:0xf bound_ctrl:0
    s_nop 1
    v_add_u32_dpp v48, v48, v48 row_shr:2 row_mask:0xf bank_mask:0xf bound_ctrl:0
    s_nop 1
    v_add_u32_dpp v48, v48, v48 row_shr:4 row_mask:0xf bank_mask:0xf bound_ctrl:0
    s_nop 1
    v_add_u32_dpp v48, v48, v48 row_shr:8 row_mask:0xf bank_mask:0xf bound_ctrl:0
    s_nop 1
    v_add_u32_dpp v48, v48, v48 row_bcast:15 row_mask:0xa bank_mask:0xf
    s_nop 1
    v_add_u32_dpp v48, v48, v48 row_bcast:31 row_mask:0xc bank_mask:0xf
    s_nop 1
    s_nop 0
    v_readlane_b32 s38, v48, 63
    v_sub_u32 v50, v48, v5
    v_sub_u32 v49, v50, v4
    v_writelane_b32 v5, 1, 63
    v_sub_u32 v10, 512, v49
    v_mad_u32_u16 v51, v110, 16, v53
    v_lshl_add_u32 v51, v10, 4, v51
    v_med3_i32 v10, v10, 0, v4
    v_lshl_add_u32 v49, v49, 2, s23
    v_sub_u32 v11, 512, v50
    v_mad_u32_u16 v52, v110, 16, v53 op_sel:[1,0,0,0]
    v_add_u32 v52, 262144, v52
    s_mov_b32 s44, 0x1fffc000
    v_writelane_b32 v52, s44, 63
    v_lshl_add_u32 v52, v11, 4, v52
    v_med3_i32 v11, v11, 0, v5
    v_lshl_add_u32 v50, v50, 2, s23
    v_lshl_add_u32 v48, v11, 16, v10
    v_add_u32 v110, v110, v48
    s_min_u32 s17, s38, 512
    s_add_u32 s17, s17, 63
    s_lshr_b32 s17, s17, 6
    v_cmpx_lt_i32 vcc, 0, v10
    ds_write_b32 v49, v51
    s_mov_b64 exec, -1
    v_cmpx_lt_i32 vcc, 0, v11
    ds_write_b32 v50, v52
    s_mov_b64 exec, -1
    s_cmp_lt_u32 s38, 512
    s_cbranch_scc1 p2_nomore0x
    v_cmp_lt_u32_sdwa s[44:45], v110, v111 src0_sel:WORD_0 src1_sel:WORD_0
    v_cmp_lt_u32_sdwa s[46:47], v110, v111 src0_sel:WORD_1 src1_sel:WORD_1
    s_nop 0
    s_or_b64 s[44:45], s[44:45], s[46:47]
    s_cbranch_scc0 p2_nomore0x
    v_mov_b32 v49, s19
    v_mov_b32 v50, 1
    ds_write_b32 v49, v50 offset:53760
p2_nomore0x:
    s_setprio 2
    s_waitcnt lgkmcnt(15)
    v_ashrrev_i32 v122, 5, v54
    v_lshlrev_b16 v123, 2, v54
    v_lshlrev_b32 v124, 16, v12
    v_bitop3_b32 v122, v122, v113, v113 bitop3:0x0c
    v_and_b32 v125, 0xffff0000, v12
    v_lshlrev_b32 v126, 16, v13
    v_mul_f32 v122, v114, v122
    v_and_b32 v127, 0xffff0000, v13
    v_add_u32 v123, v123, v123
    v_pk_fma_f32 v[124:125], v[124:125], v[122:123], s[34:35] op_sel_hi:[1,0,1]
    v_pk_fma_f32 v[126:127], v[126:127], v[122:123], s[34:35] op_sel_hi:[1,0,1]
    v_lshl_add_u32 v124, v125, 16, v124
    v_lshl_add_u32 v125, v127, 16, v126
    s_waitcnt lgkmcnt(12)
    v_bitop3_b32 v115, v115, v116, v117 bitop3:0xfe
    v_lshl_add_u64 v[124:125], v[124:125], 0, s[36:37]
    v_cmpx_le_u32 vcc, 0x1000000, v54
    ds_add_rtn_u64 v[116:117], v123, v[124:125] offset:54272
    s_mov_b64 exec, -1
    v_ashrrev_i32 v122, 5, v55
    v_lshlrev_b16 v123, 2, v55
    v_lshlrev_b32 v124, 16, v14
    v_bitop3_b32 v122, v122, v113, v113 bitop3:0x0c
    v_and_b32 v125, 0xffff0000, v14
    v_lshlrev_b32 v126, 16, v15
    v_mul_f32 v122, v114, v122
    v_and_b32 v127, 0xffff0000, v15
    v_add_u32 v123, v123, v123
    v_pk_fma_f32 v[124:125], v[124:125], v[122:123], s[34:35] op_sel_hi:[1,0,1]
    v_pk_fma_f32 v[126:127], v[126:127], v[122:123], s[34:35] op_sel_hi:[1,0,1]
    v_lshl_add_u32 v124, v125, 16, v124
    v_lshl_add_u32 v125, v127, 16, v126
    s_waitcnt lgkmcnt(12)
    v_bitop3_b32 v115, v115, v118, v119 bitop3:0xfe
    v_lshl_add_u64 v[124:125], v[124:125], 0, s[36:37]
    v_cmpx_le_u32 vcc, 0x1000000, v55
    ds_add_rtn_u64 v[118:119], v123, v[124:125] offset:54272
    s_mov_b64 exec, -1
    v_ashrrev_i32 v122, 5, v56
    v_lshlrev_b16 v123, 2, v56
    v_lshlrev_b32 v124, 16, v16
    v_bitop3_b32 v122, v122, v113, v113 bitop3:0x0c
    v_and_b32 v125, 0xffff0000, v16
    v_lshlrev_b32 v126, 16, v17
    v_mul_f32 v122, v114, v122
    v_and_b32 v127, 0xffff0000, v17
    v_add_u32 v123, v123, v123
    v_pk_fma_f32 v[124:125], v[124:125], v[122:123], s[34:35] op_sel_hi:[1,0,1]
    v_pk_fma_f32 v[126:127], v[126:127], v[122:123], s[34:35] op_sel_hi:[1,0,1]
    v_lshl_add_u32 v124, v125, 16, v124
    v_lshl_add_u32 v125, v127, 16, v126
    s_waitcnt lgkmcnt(12)
    v_bitop3_b32 v115, v115, v120, v121 bitop3:0xfe
    v_lshl_add_u64 v[124:125], v[124:125], 0, s[36:37]
    v_cmpx_le_u32 vcc, 0x1000000, v56
    ds_add_rtn_u64 v[120:121], v123, v[124:125] offset:54272
    s_mov_b64 exec, -1
    v_bfe_u32 v12, v104, 14, 4
    v_lshrrev_b32 v13, 18, v104
    v_and_b32 v104, 0x3fff, v104
    v_mad_u32_u24 v12, v12, s63, v13
    v_mad_u32_u24 v104, v12, s65, v104
    buffer_load_dwordx4 v[12:15], v104, s[68:71], 0 offen
    s_cmp_lt_u32 s15, 8
    s_cbranch_scc1 p2_na0a3
    s_waitcnt lgkmcnt(15)
    v_ashrrev_i32 v122, 5, v57
    v_lshlrev_b16 v123, 2, v57
    v_lshlrev_b32 v124, 16, v18
    v_bitop3_b32 v122, v122, v113, v113 bitop3:0x0c
    v_and_b32 v125, 0xffff0000, v18
    v_lshlrev_b32 v126, 16, v19
    v_mul_f32 v122, v114, v122
    v_and_b32 v127, 0xffff0000, v19
    v_add_u32 v123, v123, v123
    v_pk_fma_f32 v[124:125], v[124:125], v[122:123], s[34:35] op_sel_hi:[1,0,1]
    v_pk_fma_f32 v[126:127], v[126:127], v[122:123], s[34:35] op_sel_hi:[1,0,1]
    v_lshl_add_u32 v124, v125, 16, v124
    v_lshl_add_u32 v125, v127, 16, v126
    s_waitcnt lgkmcnt(2)
    v_bitop3_b32 v115, v115, v116, v117 bitop3:0xfe
    v_lshl_add_u64 v[124:125], v[124:125], 0, s[36:37]
    v_cmpx_le_u32 vcc, 0x1000000, v57
    ds_add_rtn_u64 v[116:117], v123, v[124:125] offset:54272
    s_mov_b64 exec, -1
    v_ashrrev_i32 v122, 5, v58
    v_lshlrev_b16 v123, 2, v58
    v_lshlrev_b32 v124, 16, v20
    v_bitop3_b32 v122, v122, v113, v113 bitop3:0x0c
    v_and_b32 v125, 0xffff0000, v20
    v_lshlrev_b32 v126, 16, v21
    v_mul_f32 v122, v114, v122
    v_and_b32 v127, 0xffff0000, v21
    v_add_u32 v123, v123, v123
    v_pk_fma_f32 v[124:125], v[124:125], v[122:123], s[34:35] op_sel_hi:[1,0,1]
    v_pk_fma_f32 v[126:127], v[126:127], v[122:123], s[34:35] op_sel_hi:[1,0,1]
    v_lshl_add_u32 v124, v125, 16, v124
    v_lshl_add_u32 v125, v127, 16, v126
    s_waitcnt lgkmcnt(2)
    v_bitop3_b32 v115, v115, v118, v119 bitop3:0xfe
    v_lshl_add_u64 v[124:125], v[124:125], 0, s[36:37]
    v_cmpx_le_u32 vcc, 0x1000000, v58
    ds_add_rtn_u64 v[118:119], v123, v[124:125] offset:54272
    s_mov_b64 exec, -1
    v_ashrrev_i32 v122, 5, v59
    v_lshlrev_b16 v123, 2, v59
    v_lshlrev_b32 v124, 16, v22
    v_bitop3_b32 v122, v122, v113, v113 bitop3:0x0c
    v_and_b32 v125, 0xffff0000, v22
    v_lshlrev_b32 v126, 16, v23
    v_mul_f32 v122, v114, v122
    v_and_b32 v127, 0xffff0000, v23
    v_add_u32 v123, v123, v123
    v_pk_fma_f32 v[124:125], v[124:125], v[122:123], s[34:35] op_sel_hi:[1,0,1]
    v_pk_fma_f32 v[126:127], v[126:127], v[122:123], s[34:35] op_sel_hi:[1,0,1]
    v_lshl_add_u32 v124, v125, 16, v124
    v_lshl_add_u32 v125, v127, 16, v126
    s_waitcnt lgkmcnt(2)
    v_bitop3_b32 v115, v115, v120, v121 bitop3:0xfe
    v_lshl_add_u64 v[124:125], v[124:125], 0, s[36:37]
    v_cmpx_le_u32 vcc, 0x1000000, v59
    ds_add_rtn_u64 v[120:121], v123, v[124:125] offset:54272
    s_mov_b64 exec, -1
p2_na0a3:
    v_bfe_u32 v18, v105, 14, 4
    v_lshrrev_b32 v19, 18, v105
    v_and_b32 v105, 0x3fff, v105
    v_mad_u32_u24 v18, v18, s63, v19
    v_mad_u32_u24 v105, v18, s65, v105
    buffer_load_dwordx4 v[18:21], v105, s[68:71], 0 offen
    s_mov_b32 m0, s23
    s_nop 0
    ds_read_addtid_b32 v102 offset:1024
    ds_read_addtid_b32 v103 offset:1280
    ds_read_addtid_b32 v104 offset:1536
    ds_read_addtid_b32 v105 offset:1792
    ds_read_addtid_b32 v106 offset:0
    ds_read_addtid_b32 v107 offset:256
    ds_read_addtid_b32 v108 offset:512
    ds_read_addtid_b32 v109 offset:768
    s_waitcnt vmcnt(4)
    s_mov_b32 m0, s24
    s_cmp_ge_u32 s10, 9
    s_cbranch_scc1 p2_st0s0
    ds_write_addtid_b32 v84 offset:49152
    ds_write_addtid_b32 v85 offset:49408
p2_st0s0:
    s_mov_b32 m0, s23
    s_add_u32 s20, s20, 53760
    ds_write_addtid_b32 v72 offset:0
    ds_write_addtid_b32 v73 offset:256
    ds_write_addtid_b32 v74 offset:512
    ds_write_addtid_b32 v75 offset:768
    ds_write_addtid_b32 v76 offset:1024
    ds_write_addtid_b32 v77 offset:1280
    ds_write_addtid_b32 v78 offset:1536
    ds_write_addtid_b32 v79 offset:1792
    ds_write_addtid_b32 v80 offset:2048
    ds_write_addtid_b32 v81 offset:2304
    ds_write_addtid_b32 v82 offset:2560
    ds_write_addtid_b32 v83 offset:2816
    s_setprio 1
    s_waitcnt lgkmcnt(15)
    v_ashrrev_i32 v122, 5, v60
    v_lshlrev_b16 v123, 2, v60
    v_lshlrev_b32 v124, 16, v24
    v_bitop3_b32 v122, v122, v113, v113 bitop3:0x0c
    v_and_b32 v125, 0xffff0000, v24
    v_lshlrev_b32 v126, 16, v25
    v_mul_f32 v122, v114, v122
    v_and_b32 v127, 0xffff0000, v25
    v_add_u32 v123, v123, v123
    v_pk_fma_f32 v[124:125], v[124:125], v[122:123], s[34:35] op_sel_hi:[1,0,1]
    v_pk_fma_f32 v[126:127], v[126:127], v[122:123], s[34:35] op_sel_hi:[1,0,1]
    v_lshl_add_u32 v124, v125, 16, v124
    v_lshl_add_u32 v125, v127, 16, v126
    s_waitcnt lgkmcnt(15)
    v_bitop3_b32 v115, v115, v116, v117 bitop3:0xfe
    v_lshl_add_u64 v[124:125], v[124:125], 0, s[36:37]
    v_cmpx_le_u32 vcc, 0x1000000, v60
    ds_add_rtn_u64 v[116:117], v123, v[124:125] offset:54272
    s_mov_b64 exec, -1
    v_ashrrev_i32 v122, 5, v61
    v_lshlrev_b16 v123, 2, v61
    v_lshlrev_b32 v124, 16, v26
    v_bitop3_b32 v122, v122, v113, v113 bitop3:0x0c
    v_and_b32 v125, 0xffff0000, v26
    v_lshlrev_b32 v126, 16, v27
    v_mul_f32 v122, v114, v122
    v_and_b32 v127, 0xffff0000, v27
    v_add_u32 v123, v123, v123
    v_pk_fma_f32 v[124:125], v[124:125], v[122:123], s[34:35] op_sel_hi:[1,0,1]
    v_pk_fma_f32 v[126:127], v[126:127], v[122:123], s[34:35] op_sel_hi:[1,0,1]
    v_lshl_add_u32 v124, v125, 16, v124
    v_lshl_add_u32 v125, v127, 16, v126
    s_waitcnt lgkmcnt(15)
    v_bitop3_b32 v115, v115, v118, v119 bitop3:0xfe
    v_lshl_add_u64 v[124:125], v[124:125], 0, s[36:37]
    v_cmpx_le_u32 vcc, 0x1000000, v61
    ds_add_rtn_u64 v[118:119], v123, v[124:125] offset:54272
    s_mov_b64 exec, -1
    v_ashrrev_i32 v122, 5, v62
    v_lshlrev_b16 v123, 2, v62
    v_lshlrev_b32 v124, 16, v28
    v_bitop3_b32 v122, v122, v113, v113 bitop3:0x0c
    v_and_b32 v125, 0xffff0000, v28
    v_lshlrev_b32 v126, 16, v29
    v_mul_f32 v122, v114, v122
    v_and_b32 v127, 0xffff0000, v29
    v_add_u32 v123, v123, v123
    v_pk_fma_f32 v[124:125], v[124:125], v[122:123], s[34:35] op_sel_hi:[1,0,1]
    v_pk_fma_f32 v[126:127], v[126:127], v[122:123], s[34:35] op_sel_hi:[1,0,1]
    v_lshl_add_u32 v124, v125, 16, v124
    v_lshl_add_u32 v125, v127, 16, v126
    s_waitcnt lgkmcnt(15)
    v_bitop3_b32 v115, v115, v120, v121 bitop3:0xfe
    v_lshl_add_u64 v[124:125], v[124:125], 0, s[36:37]
    v_cmpx_le_u32 vcc, 0x1000000, v62
    ds_add_rtn_u64 v[120:121], v123, v[124:125] offset:54272
    s_mov_b64 exec, -1
    s_waitcnt vmcnt(16)
    v_perm_b32 v60, v89, v86, s31
    v_perm_b32 v61, v89, v87, s32
    v_perm_b32 v62, v89, v88, s33
    v_lshlrev_b16 v28, 3, v88
    v_lshlrev_b16 v26, 3, v87
    v_lshlrev_b16 v24, 3, v86
    s_waitcnt lgkmcnt(15)
    s_nop 2
    s_nop 1
    v_max_u32_dpp v106, v106, v106 row_shr:1 row_mask:0xf bank_mask:0xf bound_ctrl:0
    v_max_u32_dpp v107, v107, v107 row_shr:1 row_mask:0xf bank_mask:0xf bound_ctrl:0
    s_nop 0
    v_max_u32_dpp v106, v106, v106 row_shr:2 row_mask:0xf bank_mask:0xf bound_ctrl:0
    v_max_u32_dpp v107, v107, v107 row_shr:2 row_mask:0xf bank_mask:0xf bound_ctrl:0
    s_nop 0
    v_max_u32_dpp v106, v106, v106 row_shr:4 row_mask:0xf bank_mask:0xf bound_ctrl:0
    v_max_u32_dpp v107, v107, v107 row_shr:4 row_mask:0xf bank_mask:0xf bound_ctrl:0
    s_nop 0
    v_max_u32_dpp v106, v106, v106 row_shr:8 row_mask:0xf bank_mask:0xf bound_ctrl:0
    v_max_u32_dpp v107, v107, v107 row_shr:8 row_mask:0xf bank_mask:0xf bound_ctrl:0
    s_nop 0
    v_max_u32_dpp v106, v106, v106 row_bcast:15 row_mask:0xa bank_mask:0xf
    v_max_u32_dpp v107, v107, v107 row_bcast:15 row_mask:0xa bank_mask:0xf
    s_nop 0
    v_max_u32_dpp v106, v106, v106 row_bcast:31 row_mask:0xc bank_mask:0xf
    v_max_u32_dpp v107, v107, v107 row_bcast:31 row_mask:0xc bank_mask:0xf
    s_nop 0
    s_nop 0
    v_readlane_b32 s41, v106, 63
    v_add_u32 v106, v106, v112
    v_add_u32 v106, 4294959104, v106
    v_max_u32 v107, s41, v107
    s_nop 0
    v_readlane_b32 s41, v107, 63
    v_add_u32 v107, v107, v112
    v_add_u32 v107, 4294960128, v107
    v_bfe_u32 v86, v106, 14, 4
    v_lshrrev_b32 v87, 18, v106
    v_and_b32 v106, 0x3fff, v106
    v_mad_u32_u24 v86, v86, s63, v87
    v_mad_u32_u24 v106, v86, s65, v106
    buffer_load_dwordx4 v[86:89], v106, s[68:71], 0 offen
    s_setprio 0
    s_waitcnt lgkmcnt(15)
    v_ashrrev_i32 v122, 5, v63
    v_lshlrev_b16 v123, 2, v63
    v_lshlrev_b32 v124, 16, v30
    v_bitop3_b32 v122, v122, v113, v113 bitop3:0x0c
    v_and_b32 v125, 0xffff0000, v30
    v_lshlrev_b32 v126, 16, v31
    v_mul_f32 v122, v114, v122
    v_and_b32 v127, 0xffff0000, v31
    v_add_u32 v123, v123, v123
    v_pk_fma_f32 v[124:125], v[124:125], v[122:123], s[34:35] op_sel_hi:[1,0,1]
    v_pk_fma_f32 v[126:127], v[126:127], v[122:123], s[34:35] op_sel_hi:[1,0,1]
    v_lshl_add_u32 v124, v125, 16, v124
    v_lshl_add_u32 v125, v127, 16, v126
    s_waitcnt lgkmcnt(2)
    v_bitop3_b32 v115, v115, v116, v117 bitop3:0xfe
    v_lshl_add_u64 v[124:125], v[124:125], 0, s[36:37]
    v_cmpx_le_u32 vcc, 0x1000000, v63
    ds_add_rtn_u64 v[116:117], v123, v[124:125] offset:54272
    s_mov_b64 exec, -1
    v_ashrrev_i32 v122, 5, v64
    v_lshlrev_b16 v123, 2, v64
    v_lshlrev_b32 v124, 16, v32
    v_bitop3_b32 v122, v122, v113, v113 bitop3:0x0c
    v_and_b32 v125, 0xffff0000, v32
    v_lshlrev_b32 v126, 16, v33
    v_mul_f32 v122, v114, v122
    v_and_b32 v127, 0xffff0000, v33
    v_add_u32 v123, v123, v123
    v_pk_fma_f32 v[124:125], v[124:125], v[122:123], s[34:35] op_sel_hi:[1,0,1]
    v_pk_fma_f32 v[126:127], v[126:127], v[122:123], s[34:35] op_sel_hi:[1,0,1]
    v_lshl_add_u32 v124, v125, 16, v124
    v_lshl_add_u32 v125, v127, 16, v126
    s_waitcnt lgkmcnt(2)
    v_bitop3_b32 v115, v115, v118, v119 bitop3:0xfe
    v_lshl_add_u64 v[124:125], v[124:125], 0, s[36:37]
    v_cmpx_le_u32 vcc, 0x1000000, v64
    ds_add_rtn_u64 v[118:119], v123, v[124:125] offset:54272
    s_mov_b64 exec, -1
    v_ashrrev_i32 v122, 5, v65
    v_lshlrev_b16 v123, 2, v65
    v_lshlrev_b32 v124, 16, v34
    v_bitop3_b32 v122, v122, v113, v113 bitop3:0x0c
    v_and_b32 v125, 0xffff0000, v34
    v_lshlrev_b32 v126, 16, v35
    v_mul_f32 v122, v114, v122
    v_and_b32 v127, 0xffff0000, v35
    v_add_u32 v123, v123, v123
    v_pk_fma_f32 v[124:125], v[124:125], v[122:123], s[34:35] op_sel_hi:[1,0,1]
    v_pk_fma_f32 v[126:127], v[126:127], v[122:123], s[34:35] op_sel_hi:[1,0,1]
    v_lshl_add_u32 v124, v125, 16, v124
    v_lshl_add_u32 v125, v127, 16, v126
    s_waitcnt lgkmcnt(2)
    v_bitop3_b32 v115, v115, v120, v121 bitop3:0xfe
    v_lshl_add_u64 v[124:125], v[124:125], 0, s[36:37]
    v_cmpx_le_u32 vcc, 0x1000000, v65
    ds_add_rtn_u64 v[120:121], v123, v[124:125] offset:54272
    s_mov_b64 exec, -1
    s_waitcnt vmcnt(13)
    v_perm_b32 v63, v93, v90, s31
    v_perm_b32 v64, v93, v91, s32
    v_perm_b32 v65, v93, v92, s33
    v_lshlrev_b16 v34, 3, v92
    v_lshlrev_b16 v32, 3, v91
    v_lshlrev_b16 v30, 3, v90
    s_waitcnt lgkmcnt(6)
    s_barrier
    s_setprio 3
    s_cmp_ge_u32 s10, 9
    s_cbranch_scc1 p2_nm0m1a
    v_lshrrev_b32 v84, 1, v112
    s_add_u32 s44, s20, s42
    buffer_load_dwordx2 v[84:85], v84, s[4:7], s44 offen
p2_nm0m1a:
    buffer_load_dwordx4 v[72:75], v112, s[4:7], s20 offen offset:0
    buffer_load_dwordx4 v[76:79], v112, s[4:7], s20 offen offset:1024
    buffer_load_dwordx4 v[80:83], v112, s[4:7], s20 offen offset:2048
    v_cmpx_ge_u16 vcc, 0x3fff, v60
    ds_read_b64 v[24:25], v24
    s_mov_b64 exec, -1
    v_cmpx_ge_u16 vcc, 0x3fff, v61
    ds_read_b64 v[26:27], v26
    s_mov_b64 exec, -1
    v_cmpx_ge_u16 vcc, 0x3fff, v62
    ds_read_b64 v[28:29], v28
    s_mov_b64 exec, -1
    v_cmpx_ge_u16 vcc, 0x3fff, v63
    ds_read_b64 v[30:31], v30
    s_mov_b64 exec, -1
    v_cmpx_ge_u16 vcc, 0x3fff, v64
    ds_read_b64 v[32:33], v32
    s_mov_b64 exec, -1
    v_cmpx_ge_u16 vcc, 0x3fff, v65
    ds_read_b64 v[34:35], v34
    s_mov_b64 exec, -1
    s_setprio 2
    s_waitcnt lgkmcnt(15)
    v_ashrrev_i32 v122, 5, v66
    v_lshlrev_b16 v123, 2, v66
    v_lshlrev_b32 v124, 16, v36
    v_bitop3_b32 v122, v122, v113, v113 bitop3:0x0c
    v_and_b32 v125, 0xffff0000, v36
    v_lshlrev_b32 v126, 16, v37
    v_mul_f32 v122, v114, v122
    v_and_b32 v127, 0xffff0000, v37
    v_add_u32 v123, v123, v123
    v_pk_fma_f32 v[124:125], v[124:125], v[122:123], s[34:35] op_sel_hi:[1,0,1]
    v_pk_fma_f32 v[126:127], v[126:127], v[122:123], s[34:35] op_sel_hi:[1,0,1]
    v_lshl_add_u32 v124, v125, 16, v124
    v_lshl_add_u32 v125, v127, 16, v126
    s_waitcnt lgkmcnt(8)
    v_bitop3_b32 v115, v115, v116, v117 bitop3:0xfe
    v_lshl_add_u64 v[124:125], v[124:125], 0, s[36:37]
    v_cmpx_le_u32 vcc, 0x1000000, v66
    ds_add_rtn_u64 v[116:117], v123, v[124:125] offset:54272
    s_mov_b64 exec, -1
    v_ashrrev_i32 v122, 5, v67
    v_lshlrev_b16 v123, 2, v67
    v_lshlrev_b32 v124, 16, v38
    v_bitop3_b32 v122, v122, v113, v113 bitop3:0x0c
    v_and_b32 v125, 0xffff0000, v38
    v_lshlrev_b32 v126, 16, v39
    v_mul_f32 v122, v114, v122
    v_and_b32 v127, 0xffff0000, v39
    v_add_u32 v123, v123, v123
    v_pk_fma_f32 v[124:125], v[124:125], v[122:123], s[34:35] op_sel_hi:[1,0,1]
    v_pk_fma_f32 v[126:127], v[126:127], v[122:123], s[34:35] op_sel_hi:[1,0,1]
    v_lshl_add_u32 v124, v125, 16, v124
    v_lshl_add_u32 v125, v127, 16, v126
    s_waitcnt lgkmcnt(8)
    v_bitop3_b32 v115, v115, v118, v119 bitop3:0xfe
    v_lshl_add_u64 v[124:125], v[124:125], 0, s[36:37]
    v_cmpx_le_u32 vcc, 0x1000000, v67
    ds_add_rtn_u64 v[118:119], v123, v[124:125] offset:54272
    s_mov_b64 exec, -1
    v_ashrrev_i32 v122, 5, v68
    v_lshlrev_b16 v123, 2, v68
    v_lshlrev_b32 v124, 16, v40
    v_bitop3_b32 v122, v122, v113, v113 bitop3:0x0c
    v_and_b32 v125, 0xffff0000, v40
    v_lshlrev_b32 v126, 16, v41
    v_mul_f32 v122, v114, v122
    v_and_b32 v127, 0xffff0000, v41
    v_add_u32 v123, v123, v123
    v_pk_fma_f32 v[124:125], v[124:125], v[122:123], s[34:35] op_sel_hi:[1,0,1]
    v_pk_fma_f32 v[126:127], v[126:127], v[122:123], s[34:35] op_sel_hi:[1,0,1]
    v_lshl_add_u32 v124, v125, 16, v124
    v_lshl_add_u32 v125, v127, 16, v126
    s_waitcnt lgkmcnt(8)
    v_bitop3_b32 v115, v115, v120, v121 bitop3:0xfe
    v_lshl_add_u64 v[124:125], v[124:125], 0, s[36:37]
    v_cmpx_le_u32 vcc, 0x1000000, v68
    ds_add_rtn_u64 v[120:121], v123, v[124:125] offset:54272
    s_mov_b64 exec, -1
    s_waitcnt vmcnt(15)
    v_perm_b32 v66, v97, v94, s31
    v_perm_b32 v67, v97, v95, s32
    v_perm_b32 v68, v97, v96, s33
    v_lshlrev_b16 v40, 3, v96
    v_lshlrev_b16 v38, 3, v95
    v_lshlrev_b16 v36, 3, v94
    v_cmpx_ge_u16 vcc, 0x3fff, v66
    ds_read_b64 v[36:37], v36
    s_mov_b64 exec, -1
    v_cmpx_ge_u16 vcc, 0x3fff, v67
    ds_read_b64 v[38:39], v38
    s_mov_b64 exec, -1
    v_cmpx_ge_u16 vcc, 0x3fff, v68
    ds_read_b64 v[40:41], v40
    s_mov_b64 exec, -1
    v_bfe_u32 v90, v107, 14, 4
    v_lshrrev_b32 v91, 18, v107
    v_and_b32 v107, 0x3fff, v107
    v_mad_u32_u24 v90, v90, s63, v91
    v_mad_u32_u24 v107, v90, s65, v107
    buffer_load_dwordx4 v[90:93], v107, s[68:71], 0 offen
    s_setprio 1
    s_waitcnt lgkmcnt(15)
    v_ashrrev_i32 v122, 5, v69
    v_lshlrev_b16 v123, 2, v69
    v_lshlrev_b32 v124, 16, v42
    v_bitop3_b32 v122, v122, v113, v113 bitop3:0x0c
    v_and_b32 v125, 0xffff0000, v42
    v_lshlrev_b32 v126, 16, v43
    v_mul_f32 v122, v114, v122
    v_and_b32 v127, 0xffff0000, v43
    v_add_u32 v123, v123, v123
    v_pk_fma_f32 v[124:125], v[124:125], v[122:123], s[34:35] op_sel_hi:[1,0,1]
    v_pk_fma_f32 v[126:127], v[126:127], v[122:123], s[34:35] op_sel_hi:[1,0,1]
    v_lshl_add_u32 v124, v125, 16, v124
    v_lshl_add_u32 v125, v127, 16, v126
    s_waitcnt lgkmcnt(5)
    v_bitop3_b32 v115, v115, v116, v117 bitop3:0xfe
    v_lshl_add_u64 v[124:125], v[124:125], 0, s[36:37]
    v_cmpx_le_u32 vcc, 0x1000000, v69
    ds_add_rtn_u64 v[116:117], v123, v[124:125] offset:54272
    s_mov_b64 exec, -1
    v_ashrrev_i32 v122, 5, v70
    v_lshlrev_b16 v123, 2, v70
    v_lshlrev_b32 v124, 16, v44
    v_bitop3_b32 v122, v122, v113, v113 bitop3:0x0c
    v_and_b32 v125, 0xffff0000, v44
    v_lshlrev_b32 v126, 16, v45
    v_mul_f32 v122, v114, v122
    v_and_b32 v127, 0xffff0000, v45
    v_add_u32 v123, v123, v123
    v_pk_fma_f32 v[124:125], v[124:125], v[122:123], s[34:35] op_sel_hi:[1,0,1]
    v_pk_fma_f32 v[126:127], v[126:127], v[122:123], s[34:35] op_sel_hi:[1,0,1]
    v_lshl_add_u32 v124, v125, 16, v124
    v_lshl_add_u32 v125, v127, 16, v126
    s_waitcnt lgkmcnt(5)
    v_bitop3_b32 v115, v115, v118, v119 bitop3:0xfe
    v_lshl_add_u64 v[124:125], v[124:125], 0, s[36:37]
    v_cmpx_le_u32 vcc, 0x1000000, v70
    ds_add_rtn_u64 v[118:119], v123, v[124:125] offset:54272
    s_mov_b64 exec, -1
    v_ashrrev_i32 v122, 5, v71
    v_lshlrev_b16 v123, 2, v71
    v_lshlrev_b32 v124, 16, v46
    v_bitop3_b32 v122, v122, v113, v113 bitop3:0x0c
    v_and_b32 v125, 0xffff0000, v46
    v_lshlrev_b32 v126, 16, v47
    v_mul_f32 v122, v114, v122
    v_and_b32 v127, 0xffff0000, v47
    v_add_u32 v123, v123, v123
    v_pk_fma_f32 v[124:125], v[124:125], v[122:123], s[34:35] op_sel_hi:[1,0,1]
    v_pk_fma_f32 v[126:127], v[126:127], v[122:123], s[34:35] op_sel_hi:[1,0,1]
    v_lshl_add_u32 v124, v125, 16, v124
    v_lshl_add_u32 v125, v127, 16, v126
    s_waitcnt lgkmcnt(5)
    v_bitop3_b32 v115, v115, v120, v121 bitop3:0xfe
    v_lshl_add_u64 v[124:125], v[124:125], 0, s[36:37]
    v_cmpx_le_u32 vcc, 0x1000000, v71
    ds_add_rtn_u64 v[120:121], v123, v[124:125] offset:54272
    s_mov_b64 exec, -1
    s_waitcnt vmcnt(12)
    v_perm_b32 v69, v101, v98, s31
    v_perm_b32 v70, v101, v99, s32
    v_perm_b32 v71, v101, v100, s33
    v_lshlrev_b16 v46, 3, v100
    v_lshlrev_b16 v44, 3, v99
    v_lshlrev_b16 v42, 3, v98
    v_cmpx_ge_u16 vcc, 0x3fff, v69
    ds_read_b64 v[42:43], v42
    s_mov_b64 exec, -1
    v_cmpx_ge_u16 vcc, 0x3fff, v70
    ds_read_b64 v[44:45], v44
    s_mov_b64 exec, -1
    v_cmpx_ge_u16 vcc, 0x3fff, v71
    ds_read_b64 v[46:47], v46
    s_mov_b64 exec, -1
    s_waitcnt lgkmcnt(15)
    s_nop 2
    s_nop 1
    v_max_u32_dpp v108, v108, v108 row_shr:1 row_mask:0xf bank_mask:0xf bound_ctrl:0
    v_max_u32_dpp v109, v109, v109 row_shr:1 row_mask:0xf bank_mask:0xf bound_ctrl:0
    s_nop 0
    v_max_u32_dpp v108, v108, v108 row_shr:2 row_mask:0xf bank_mask:0xf bound_ctrl:0
    v_max_u32_dpp v109, v109, v109 row_shr:2 row_mask:0xf bank_mask:0xf bound_ctrl:0
    s_nop 0
    v_max_u32_dpp v108, v108, v108 row_shr:4 row_mask:0xf bank_mask:0xf bound_ctrl:0
    v_max_u32_dpp v109, v109, v109 row_shr:4 row_mask:0xf bank_mask:0xf bound_ctrl:0
    s_nop 0
    v_max_u32_dpp v108, v108, v108 row_shr:8 row_mask:0xf bank_mask:0xf bound_ctrl:0
    v_max_u32_dpp v109, v109, v109 row_shr:8 row_mask:0xf bank_mask:0xf bound_ctrl:0
    s_nop 0
    v_max_u32_dpp v108, v108, v108 row_bcast:15 row_mask:0xa bank_mask:0xf
    v_max_u32_dpp v109, v109, v109 row_bcast:15 row_mask:0xa bank_mask:0xf
    s_nop 0
    v_max_u32_dpp v108, v108, v108 row_bcast:31 row_mask:0xc bank_mask:0xf
    v_max_u32_dpp v109, v109, v109 row_bcast:31 row_mask:0xc bank_mask:0xf
    s_nop 0
    s_nop 0
    v_max_u32 v108, s41, v108
    s_nop 0
    v_readlane_b32 s41, v108, 63
    v_add_u32 v108, v108, v112
    v_add_u32 v108, 4294961152, v108
    v_max_u32 v109, s41, v109
    s_nop 0
    v_readlane_b32 s41, v109, 63
    v_add_u32 v109, v109, v112
    v_add_u32 v109, 4294962176, v109
    v_bfe_u32 v94, v108, 14, 4
    v_lshrrev_b32 v95, 18, v108
    v_and_b32 v108, 0x3fff, v108
    v_mad_u32_u24 v94, v94, s63, v95
    v_mad_u32_u24 v108, v94, s65, v108
    buffer_load_dwordx4 v[94:97], v108, s[68:71], 0 offen
    s_setprio 0
    s_waitcnt vmcnt(9)
    v_perm_b32 v48, v3, v0, s31
    v_perm_b32 v49, v3, v1, s32
    v_perm_b32 v50, v3, v2, s33
    v_lshlrev_b16 v4, 3, v2
    v_lshlrev_b16 v2, 3, v1
    v_lshlrev_b16 v0, 3, v0
    v_cmpx_ge_u16 vcc, 0x3fff, v48
    ds_read_b64 v[0:1], v0
    s_mov_b64 exec, -1
    v_cmpx_ge_u16 vcc, 0x3fff, v49
    ds_read_b64 v[2:3], v2
    s_mov_b64 exec, -1
    v_cmpx_ge_u16 vcc, 0x3fff, v50
    ds_read_b64 v[4:5], v4
    s_mov_b64 exec, -1
    s_waitcnt vmcnt(8)
    v_perm_b32 v51, v9, v6, s31
    v_perm_b32 v52, v9, v7, s32
    v_perm_b32 v53, v9, v8, s33
    v_lshlrev_b16 v10, 3, v8
    v_lshlrev_b16 v8, 3, v7
    v_lshlrev_b16 v6, 3, v6
    v_cmpx_ge_u16 vcc, 0x3fff, v51
    ds_read_b64 v[6:7], v6
    s_mov_b64 exec, -1
    v_cmpx_ge_u16 vcc, 0x3fff, v52
    ds_read_b64 v[8:9], v8
    s_mov_b64 exec, -1
    v_cmpx_ge_u16 vcc, 0x3fff, v53
    ds_read_b64 v[10:11], v10
    s_mov_b64 exec, -1
    s_waitcnt vmcnt(7)
    v_perm_b32 v54, v15, v12, s31
    v_perm_b32 v55, v15, v13, s32
    v_perm_b32 v56, v15, v14, s33
    v_lshlrev_b16 v16, 3, v14
    v_lshlrev_b16 v14, 3, v13
    v_lshlrev_b16 v12, 3, v12
    v_cmpx_ge_u16 vcc, 0x3fff, v54
    ds_read_b64 v[12:13], v12
    s_mov_b64 exec, -1
    v_cmpx_ge_u16 vcc, 0x3fff, v55
    ds_read_b64 v[14:15], v14
    s_mov_b64 exec, -1
    v_cmpx_ge_u16 vcc, 0x3fff, v56
    ds_read_b64 v[16:17], v16
    s_mov_b64 exec, -1
    s_waitcnt vmcnt(6)
    v_perm_b32 v57, v21, v18, s31
    v_perm_b32 v58, v21, v19, s32
    v_perm_b32 v59, v21, v20, s33
    v_lshlrev_b16 v22, 3, v20
    v_lshlrev_b16 v20, 3, v19
    v_lshlrev_b16 v18, 3, v18
    s_cmp_lt_u32 s16, 8
    s_cbranch_scc1 p2_g0r03
    v_cmpx_ge_u16 vcc, 0x3fff, v57
    ds_read_b64 v[18:19], v18
    s_mov_b64 exec, -1
    v_cmpx_ge_u16 vcc, 0x3fff, v58
    ds_read_b64 v[20:21], v20
    s_mov_b64 exec, -1
    v_cmpx_ge_u16 vcc, 0x3fff, v59
    ds_read_b64 v[22:23], v22
    s_mov_b64 exec, -1
p2_g0r03:
    s_waitcnt lgkmcnt(0)
    s_barrier
    s_waitcnt lgkmcnt(15)
    s_branch p2_tail
p2_drain0:
    v_cmpx_gt_i16 vcc, 0, v48
    ds_read_b64 v[0:1], v0
    s_mov_b64 exec, -1
    v_cmpx_gt_i16 vcc, 0, v49
    ds_read_b64 v[2:3], v2
    s_mov_b64 exec, -1
    v_cmpx_gt_i16 vcc, 0, v50
    ds_read_b64 v[4:5], v4
    s_mov_b64 exec, -1
    v_cmpx_gt_i16 vcc, 0, v51
    ds_read_b64 v[6:7], v6
    s_mov_b64 exec, -1
    v_cmpx_gt_i16 vcc, 0, v52
    ds_read_b64 v[8:9], v8
    s_mov_b64 exec, -1
    v_cmpx_gt_i16 vcc, 0, v53
    ds_read_b64 v[10:11], v10
    s_mov_b64 exec, -1
    v_cmpx_gt_i16 vcc, 0, v54
    ds_read_b64 v[12:13], v12
    s_mov_b64 exec, -1
    v_cmpx_gt_i16 vcc, 0, v55
    ds_read_b64 v[14:15], v14
    s_mov_b64 exec, -1
    v_cmpx_gt_i16 vcc, 0, v56
    ds_read_b64 v[16:17], v16
    s_mov_b64 exec, -1
    s_cmp_lt_u32 s15, 8
    s_cbranch_scc1 p2_gd0
    v_cmpx_gt_i16 vcc, 0, v57
    ds_read_b64 v[18:19], v18
    s_mov_b64 exec, -1
    v_cmpx_gt_i16 vcc, 0, v58
    ds_read_b64 v[20:21], v20
    s_mov_b64 exec, -1
    v_cmpx_gt_i16 vcc, 0, v59
    ds_read_b64 v[22:23], v22
    s_mov_b64 exec, -1
p2_gd0:
    v_cmpx_gt_i16 vcc, 0, v60
    ds_read_b64 v[24:25], v24
    s_mov_b64 exec, -1
    v_cmpx_gt_i16 vcc, 0, v61
    ds_read_b64 v[26:27], v26
    s_mov_b64 exec, -1
    v_cmpx_gt_i16 vcc, 0, v62
    ds_read_b64 v[28:29], v28
    s_mov_b64 exec, -1
    v_cmpx_gt_i16 vcc, 0, v63
    ds_read_b64 v[30:31], v30
    s_mov_b64 exec, -1
    v_cmpx_gt_i16 vcc, 0, v64
    ds_read_b64 v[32:33], v32
    s_mov_b64 exec, -1
    v_cmpx_gt_i16 vcc, 0, v65
    ds_read_b64 v[34:35], v34
    s_mov_b64 exec, -1
    v_cmpx_gt_i16 vcc, 0, v66
    ds_read_b64 v[36:37], v36
    s_mov_b64 exec, -1
    v_cmpx_gt_i16 vcc, 0, v67
    ds_read_b64 v[38:39], v38
    s_mov_b64 exec, -1
    v_cmpx_gt_i16 vcc, 0, v68
    ds_read_b64 v[40:41], v40
    s_mov_b64 exec, -1
    v_cmpx_gt_i16 vcc, 0, v69
    ds_read_b64 v[42:43], v42
    s_mov_b64 exec, -1
    v_cmpx_gt_i16 vcc, 0, v70
    ds_read_b64 v[44:45], v44
    s_mov_b64 exec, -1
    v_cmpx_gt_i16 vcc, 0, v71
    ds_read_b64 v[46:47], v46
    s_mov_b64 exec, -1
    s_waitcnt lgkmcnt(15)
    v_ashrrev_i32 v122, 5, v48
    v_lshlrev_b16 v123, 2, v48
    v_lshlrev_b32 v124, 16, v0
    v_bitop3_b32 v122, v122, v113, v113 bitop3:0x0c
    v_and_b32 v125, 0xffff0000, v0
    v_lshlrev_b32 v126, 16, v1
    v_mul_f32 v122, v114, v122
    v_and_b32 v127, 0xffff0000, v1
    v_add_u32 v123, v123, v123
    v_pk_fma_f32 v[124:125], v[124:125], v[122:123], s[34:35] op_sel_hi:[1,0,1]
    v_pk_fma_f32 v[126:127], v[126:127], v[122:123], s[34:35] op_sel_hi:[1,0,1]
    v_lshl_add_u32 v124, v125, 16, v124
    v_lshl_add_u32 v125, v127, 16, v126
    s_waitcnt lgkmcnt(15)
    v_bitop3_b32 v115, v115, v116, v117 bitop3:0xfe
    v_lshl_add_u64 v[124:125], v[124:125], 0, s[36:37]
    v_cmpx_le_u32 vcc, 0x1000000, v48
    ds_add_rtn_u64 v[116:117], v123, v[124:125] offset:54272
    s_mov_b64 exec, -1
    v_ashrrev_i32 v122, 5, v49
    v_lshlrev_b16 v123, 2, v49
    v_lshlrev_b32 v124, 16, v2
    v_bitop3_b32 v122, v122, v113, v113 bitop3:0x0c
    v_and_b32 v125, 0xffff0000, v2
    v_lshlrev_b32 v126, 16, v3
    v_mul_f32 v122, v114, v122
    v_and_b32 v127, 0xffff0000, v3
    v_add_u32 v123, v123, v123
    v_pk_fma_f32 v[124:125], v[124:125], v[122:123], s[34:35] op_sel_hi:[1,0,1]
    v_pk_fma_f32 v[126:127], v[126:127], v[122:123], s[34:35] op_sel_hi:[1,0,1]
    v_lshl_add_u32 v124, v125, 16, v124
    v_lshl_add_u32 v125, v127, 16, v126
    s_waitcnt lgkmcnt(15)
    v_bitop3_b32 v115, v115, v118, v119 bitop3:0xfe
    v_lshl_add_u64 v[124:125], v[124:125], 0, s[36:37]
    v_cmpx_le_u32 vcc, 0x1000000, v49
    ds_add_rtn_u64 v[118:119], v123, v[124:125] offset:54272
    s_mov_b64 exec, -1
    v_ashrrev_i32 v122, 5, v50
    v_lshlrev_b16 v123, 2, v50
    v_lshlrev_b32 v124, 16, v4
    v_bitop3_b32 v122, v122, v113, v113 bitop3:0x0c
    v_and_b32 v125, 0xffff0000, v4
    v_lshlrev_b32 v126, 16, v5
    v_mul_f32 v122, v114, v122
    v_and_b32 v127, 0xffff0000, v5
    v_add_u32 v123, v123, v123
    v_pk_fma_f32 v[124:125], v[124:125], v[122:123], s[34:35] op_sel_hi:[1,0,1]
    v_pk_fma_f32 v[126:127], v[126:127], v[122:123], s[34:35] op_sel_hi:[1,0,1]
    v_lshl_add_u32 v124, v125, 16, v124
    v_lshl_add_u32 v125, v127, 16, v126
    s_waitcnt lgkmcnt(15)
    v_bitop3_b32 v115, v115, v120, v121 bitop3:0xfe
    v_lshl_add_u64 v[124:125], v[124:125], 0, s[36:37]
    v_cmpx_le_u32 vcc, 0x1000000, v50
    ds_add_rtn_u64 v[120:121], v123, v[124:125] offset:54272
    s_mov_b64 exec, -1
    s_waitcnt lgkmcnt(15)
    v_ashrrev_i32 v122, 5, v51
    v_lshlrev_b16 v123, 2, v51
    v_lshlrev_b32 v124, 16, v6
    v_bitop3_b32 v122, v122, v113, v113 bitop3:0x0c
    v_and_b32 v125, 0xffff0000, v6
    v_lshlrev_b32 v126, 16, v7
    v_mul_f32 v122, v114, v122
    v_and_b32 v127, 0xffff0000, v7
    v_add_u32 v123, v123, v123
    v_pk_fma_f32 v[124:125], v[124:125], v[122:123], s[34:35] op_sel_hi:[1,0,1]
    v_pk_fma_f32 v[126:127], v[126:127], v[122:123], s[34:35] op_sel_hi:[1,0,1]
    v_lshl_add_u32 v124, v125, 16, v124
    v_lshl_add_u32 v125, v127, 16, v126
    s_waitcnt lgkmcnt(2)
    v_bitop3_b32 v115, v115, v116, v117 bitop3:0xfe
    v_lshl_add_u64 v[124:125], v[124:125], 0, s[36:37]
    v_cmpx_le_u32 vcc, 0x1000000, v51
    ds_add_rtn_u64 v[116:117], v123, v[124:125] offset:54272
    s_mov_b64 exec, -1
    v_ashrrev_i32 v122, 5, v52
    v_lshlrev_b16 v123, 2, v52
    v_lshlrev_b32 v124, 16, v8
    v_bitop3_b32 v122, v122, v113, v113 bitop3:0x0c
    v_and_b32 v125, 0xffff0000, v8
    v_lshlrev_b32 v126, 16, v9
    v_mul_f32 v122, v114, v122
    v_and_b32 v127, 0xffff0000, v9
    v_add_u32 v123, v123, v123
    v_pk_fma_f32 v[124:125], v[124:125], v[122:123], s[34:35] op_sel_hi:[1,0,1]
    v_pk_fma_f32 v[126:127], v[126:127], v[122:123], s[34:35] op_sel_hi:[1,0,1]
    v_lshl_add_u32 v124, v125, 16, v124
    v_lshl_add_u32 v125, v127, 16, v126
    s_waitcnt lgkmcnt(2)
    v_bitop3_b32 v115, v115, v118, v119 bitop3:0xfe
    v_lshl_add_u64 v[124:125], v[124:125], 0, s[36:37]
    v_cmpx_le_u32 vcc, 0x1000000, v52
    ds_add_rtn_u64 v[118:119], v123, v[124:125] offset:54272
    s_mov_b64 exec, -1
    v_ashrrev_i32 v122, 5, v53
    v_lshlrev_b16 v123, 2, v53
    v_lshlrev_b32 v124, 16, v10
    v_bitop3_b32 v122, v122, v113, v113 bitop3:0x0c
    v_and_b32 v125, 0xffff0000, v10
    v_lshlrev_b32 v126, 16, v11
    v_mul_f32 v122, v114, v122
    v_and_b32 v127, 0xffff0000, v11
    v_add_u32 v123, v123, v123
    v_pk_fma_f32 v[124:125], v[124:125], v[122:123], s[34:35] op_sel_hi:[1,0,1]
    v_pk_fma_f32 v[126:127], v[126:127], v[122:123], s[34:35] op_sel_hi:[1,0,1]
    v_lshl_add_u32 v124, v125, 16, v124
    v_lshl_add_u32 v125, v127, 16, v126
    s_waitcnt lgkmcnt(2)
    v_bitop3_b32 v115, v115, v120, v121 bitop3:0xfe
    v_lshl_add_u64 v[124:125], v[124:125], 0, s[36:37]
    v_cmpx_le_u32 vcc, 0x1000000, v53
    ds_add_rtn_u64 v[120:121], v123, v[124:125] offset:54272
    s_mov_b64 exec, -1
    s_waitcnt lgkmcnt(15)
    v_ashrrev_i32 v122, 5, v54
    v_lshlrev_b16 v123, 2, v54
    v_lshlrev_b32 v124, 16, v12
    v_bitop3_b32 v122, v122, v113, v113 bitop3:0x0c
    v_and_b32 v125, 0xffff0000, v12
    v_lshlrev_b32 v126, 16, v13
    v_mul_f32 v122, v114, v122
    v_and_b32 v127, 0xffff0000, v13
    v_add_u32 v123, v123, v123
    v_pk_fma_f32 v[124:125], v[124:125], v[122:123], s[34:35] op_sel_hi:[1,0,1]
    v_pk_fma_f32 v[126:127], v[126:127], v[122:123], s[34:35] op_sel_hi:[1,0,1]
    v_lshl_add_u32 v124, v125, 16, v124
    v_lshl_add_u32 v125, v127, 16, v126
    s_waitcnt lgkmcnt(2)
    v_bitop3_b32 v115, v115, v116, v117 bitop3:0xfe
    v_lshl_add_u64 v[124:125], v[124:125], 0, s[36:37]
    v_cmpx_le_u32 vcc, 0x1000000, v54
    ds_add_rtn_u64 v[116:117], v123, v[124:125] offset:54272
    s_mov_b64 exec, -1
    v_ashrrev_i32 v122, 5, v55
    v_lshlrev_b16 v123, 2, v55
    v_lshlrev_b32 v124, 16, v14
    v_bitop3_b32 v122, v122, v113, v113 bitop3:0x0c
    v_and_b32 v125, 0xffff0000, v14
    v_lshlrev_b32 v126, 16, v15
    v_mul_f32 v122, v114, v122
    v_and_b32 v127, 0xffff0000, v15
    v_add_u32 v123, v123, v123
    v_pk_fma_f32 v[124:125], v[124:125], v[122:123], s[34:35] op_sel_hi:[1,0,1]
    v_pk_fma_f32 v[126:127], v[126:127], v[122:123], s[34:35] op_sel_hi:[1,0,1]
    v_lshl_add_u32 v124, v125, 16, v124
    v_lshl_add_u32 v125, v127, 16, v126
    s_waitcnt lgkmcnt(2)
    v_bitop3_b32 v115, v115, v118, v119 bitop3:0xfe
    v_lshl_add_u64 v[124:125], v[124:125], 0, s[36:37]
    v_cmpx_le_u32 vcc, 0x1000000, v55
    ds_add_rtn_u64 v[118:119], v123, v[124:125] offset:54272
    s_mov_b64 exec, -1
    v_ashrrev_i32 v122, 5, v56
    v_lshlrev_b16 v123, 2, v56
    v_lshlrev_b32 v124, 16, v16
    v_bitop3_b32 v122, v122, v113, v113 bitop3:0x0c
    v_and_b32 v125, 0xffff0000, v16
    v_lshlrev_b32 v126, 16, v17
    v_mul_f32 v122, v114, v122
    v_and_b32 v127, 0xffff0000, v17
    v_add_u32 v123, v123, v123
    v_pk_fma_f32 v[124:125], v[124:125], v[122:123], s[34:35] op_sel_hi:[1,0,1]
    v_pk_fma_f32 v[126:127], v[126:127], v[122:123], s[34:35] op_sel_hi:[1,0,1]
    v_lshl_add_u32 v124, v125, 16, v124
    v_lshl_add_u32 v125, v127, 16, v126
    s_waitcnt lgkmcnt(2)
    v_bitop3_b32 v115, v115, v120, v121 bitop3:0xfe
    v_lshl_add_u64 v[124:125], v[124:125], 0, s[36:37]
    v_cmpx_le_u32 vcc, 0x1000000, v56
    ds_add_rtn_u64 v[120:121], v123, v[124:125] offset:54272
    s_mov_b64 exec, -1
    s_cmp_lt_u32 s15, 8
    s_cbranch_scc1 p2_nad0
    s_waitcnt lgkmcnt(15)
    v_ashrrev_i32 v122, 5, v57
    v_lshlrev_b16 v123, 2, v57
    v_lshlrev_b32 v124, 16, v18
    v_bitop3_b32 v122, v122, v113, v113 bitop3:0x0c
    v_and_b32 v125, 0xffff0000, v18
    v_lshlrev_b32 v126, 16, v19
    v_mul_f32 v122, v114, v122
    v_and_b32 v127, 0xffff0000, v19
    v_add_u32 v123, v123, v123
    v_pk_fma_f32 v[124:125], v[124:125], v[122:123], s[34:35] op_sel_hi:[1,0,1]
    v_pk_fma_f32 v[126:127], v[126:127], v[122:123], s[34:35] op_sel_hi:[1,0,1]
    v_lshl_add_u32 v124, v125, 16, v124
    v_lshl_add_u32 v125, v127, 16, v126
    s_waitcnt lgkmcnt(2)
    v_bitop3_b32 v115, v115, v116, v117 bitop3:0xfe
    v_lshl_add_u64 v[124:125], v[124:125], 0, s[36:37]
    v_cmpx_le_u32 vcc, 0x1000000, v57
    ds_add_rtn_u64 v[116:117], v123, v[124:125] offset:54272
    s_mov_b64 exec, -1
    v_ashrrev_i32 v122, 5, v58
    v_lshlrev_b16 v123, 2, v58
    v_lshlrev_b32 v124, 16, v20
    v_bitop3_b32 v122, v122, v113, v113 bitop3:0x0c
    v_and_b32 v125, 0xffff0000, v20
    v_lshlrev_b32 v126, 16, v21
    v_mul_f32 v122, v114, v122
    v_and_b32 v127, 0xffff0000, v21
    v_add_u32 v123, v123, v123
    v_pk_fma_f32 v[124:125], v[124:125], v[122:123], s[34:35] op_sel_hi:[1,0,1]
    v_pk_fma_f32 v[126:127], v[126:127], v[122:123], s[34:35] op_sel_hi:[1,0,1]
    v_lshl_add_u32 v124, v125, 16, v124
    v_lshl_add_u32 v125, v127, 16, v126
    s_waitcnt lgkmcnt(2)
    v_bitop3_b32 v115, v115, v118, v119 bitop3:0xfe
    v_lshl_add_u64 v[124:125], v[124:125], 0, s[36:37]
    v_cmpx_le_u32 vcc, 0x1000000, v58
    ds_add_rtn_u64 v[118:119], v123, v[124:125] offset:54272
    s_mov_b64 exec, -1
    v_ashrrev_i32 v122, 5, v59
    v_lshlrev_b16 v123, 2, v59
    v_lshlrev_b32 v124, 16, v22
    v_bitop3_b32 v122, v122, v113, v113 bitop3:0x0c
    v_and_b32 v125, 0xffff0000, v22
    v_lshlrev_b32 v126, 16, v23
    v_mul_f32 v122, v114, v122
    v_and_b32 v127, 0xffff0000, v23
    v_add_u32 v123, v123, v123
    v_pk_fma_f32 v[124:125], v[124:125], v[122:123], s[34:35] op_sel_hi:[1,0,1]
    v_pk_fma_f32 v[126:127], v[126:127], v[122:123], s[34:35] op_sel_hi:[1,0,1]
    v_lshl_add_u32 v124, v125, 16, v124
    v_lshl_add_u32 v125, v127, 16, v126
    s_waitcnt lgkmcnt(2)
    v_bitop3_b32 v115, v115, v120, v121 bitop3:0xfe
    v_lshl_add_u64 v[124:125], v[124:125], 0, s[36:37]
    v_cmpx_le_u32 vcc, 0x1000000, v59
    ds_add_rtn_u64 v[120:121], v123, v[124:125] offset:54272
    s_mov_b64 exec, -1
p2_nad0:
    s_waitcnt lgkmcnt(15)
    v_ashrrev_i32 v122, 5, v60
    v_lshlrev_b16 v123, 2, v60
    v_lshlrev_b32 v124, 16, v24
    v_bitop3_b32 v122, v122, v113, v113 bitop3:0x0c
    v_and_b32 v125, 0xffff0000, v24
    v_lshlrev_b32 v126, 16, v25
    v_mul_f32 v122, v114, v122
    v_and_b32 v127, 0xffff0000, v25
    v_add_u32 v123, v123, v123
    v_pk_fma_f32 v[124:125], v[124:125], v[122:123], s[34:35] op_sel_hi:[1,0,1]
    v_pk_fma_f32 v[126:127], v[126:127], v[122:123], s[34:35] op_sel_hi:[1,0,1]
    v_lshl_add_u32 v124, v125, 16, v124
    v_lshl_add_u32 v125, v127, 16, v126
    s_waitcnt lgkmcnt(2)
    v_bitop3_b32 v115, v115, v116, v117 bitop3:0xfe
    v_lshl_add_u64 v[124:125], v[124:125], 0, s[36:37]
    v_cmpx_le_u32 vcc, 0x1000000, v60
    ds_add_rtn_u64 v[116:117], v123, v[124:125] offset:54272
    s_mov_b64 exec, -1
    v_ashrrev_i32 v122, 5, v61
    v_lshlrev_b16 v123, 2, v61
    v_lshlrev_b32 v124, 16, v26
    v_bitop3_b32 v122, v122, v113, v113 bitop3:0x0c
    v_and_b32 v125, 0xffff0000, v26
    v_lshlrev_b32 v126, 16, v27
    v_mul_f32 v122, v114, v122
    v_and_b32 v127, 0xffff0000, v27
    v_add_u32 v123, v123, v123
    v_pk_fma_f32 v[124:125], v[124:125], v[122:123], s[34:35] op_sel_hi:[1,0,1]
    v_pk_fma_f32 v[126:127], v[126:127], v[122:123], s[34:35] op_sel_hi:[1,0,1]
    v_lshl_add_u32 v124, v125, 16, v124
    v_lshl_add_u32 v125, v127, 16, v126
    s_waitcnt lgkmcnt(2)
    v_bitop3_b32 v115, v115, v118, v119 bitop3:0xfe
    v_lshl_add_u64 v[124:125], v[124:125], 0, s[36:37]
    v_cmpx_le_u32 vcc, 0x1000000, v61
    ds_add_rtn_u64 v[118:119], v123, v[124:125] offset:54272
    s_mov_b64 exec, -1
    v_ashrrev_i32 v122, 5, v62
    v_lshlrev_b16 v123, 2, v62
    v_lshlrev_b32 v124, 16, v28
    v_bitop3_b32 v122, v122, v113, v113 bitop3:0x0c
    v_and_b32 v125, 0xffff0000, v28
    v_lshlrev_b32 v126, 16, v29
    v_mul_f32 v122, v114, v122
    v_and_b32 v127, 0xffff0000, v29
    v_add_u32 v123, v123, v123
    v_pk_fma_f32 v[124:125], v[124:125], v[122:123], s[34:35] op_sel_hi:[1,0,1]
    v_pk_fma_f32 v[126:127], v[126:127], v[122:123], s[34:35] op_sel_hi:[1,0,1]
    v_lshl_add_u32 v124, v125, 16, v124
    v_lshl_add_u32 v125, v127, 16, v126
    s_waitcnt lgkmcnt(2)
    v_bitop3_b32 v115, v115, v120, v121 bitop3:0xfe
    v_lshl_add_u64 v[124:125], v[124:125], 0, s[36:37]
    v_cmpx_le_u32 vcc, 0x1000000, v62
    ds_add_rtn_u64 v[120:121], v123, v[124:125] offset:54272
    s_mov_b64 exec, -1
    s_waitcnt lgkmcnt(15)
    v_ashrrev_i32 v122, 5, v63
    v_lshlrev_b16 v123, 2, v63
    v_lshlrev_b32 v124, 16, v30
    v_bitop3_b32 v122, v122, v113, v113 bitop3:0x0c
    v_and_b32 v125, 0xffff0000, v30
    v_lshlrev_b32 v126, 16, v31
    v_mul_f32 v122, v114, v122
    v_and_b32 v127, 0xffff0000, v31
    v_add_u32 v123, v123, v123
    v_pk_fma_f32 v[124:125], v[124:125], v[122:123], s[34:35] op_sel_hi:[1,0,1]
    v_pk_fma_f32 v[126:127], v[126:127], v[122:123], s[34:35] op_sel_hi:[1,0,1]
    v_lshl_add_u32 v124, v125, 16, v124
    v_lshl_add_u32 v125, v127, 16, v126
    s_waitcnt lgkmcnt(2)
    v_bitop3_b32 v115, v115, v116, v117 bitop3:0xfe
    v_lshl_add_u64 v[124:125], v[124:125], 0, s[36:37]
    v_cmpx_le_u32 vcc, 0x1000000, v63
    ds_add_rtn_u64 v[116:117], v123, v[124:125] offset:54272
    s_mov_b64 exec, -1
    v_ashrrev_i32 v122, 5, v64
    v_lshlrev_b16 v123, 2, v64
    v_lshlrev_b32 v124, 16, v32
    v_bitop3_b32 v122, v122, v113, v113 bitop3:0x0c
    v_and_b32 v125, 0xffff0000, v32
    v_lshlrev_b32 v126, 16, v33
    v_mul_f32 v122, v114, v122
    v_and_b32 v127, 0xffff0000, v33
    v_add_u32 v123, v123, v123
    v_pk_fma_f32 v[124:125], v[124:125], v[122:123], s[34:35] op_sel_hi:[1,0,1]
    v_pk_fma_f32 v[126:127], v[126:127], v[122:123], s[34:35] op_sel_hi:[1,0,1]
    v_lshl_add_u32 v124, v125, 16, v124
    v_lshl_add_u32 v125, v127, 16, v126
    s_waitcnt lgkmcnt(2)
    v_bitop3_b32 v115, v115, v118, v119 bitop3:0xfe
    v_lshl_add_u64 v[124:125], v[124:125], 0, s[36:37]
    v_cmpx_le_u32 vcc, 0x1000000, v64
    ds_add_rtn_u64 v[118:119], v123, v[124:125] offset:54272
    s_mov_b64 exec, -1
    v_ashrrev_i32 v122, 5, v65
    v_lshlrev_b16 v123, 2, v65
    v_lshlrev_b32 v124, 16, v34
    v_bitop3_b32 v122, v122, v113, v113 bitop3:0x0c
    v_and_b32 v125, 0xffff0000, v34
    v_lshlrev_b32 v126, 16, v35
    v_mul_f32 v122, v114, v122
    v_and_b32 v127, 0xffff0000, v35
    v_add_u32 v123, v123, v123
    v_pk_fma_f32 v[124:125], v[124:125], v[122:123], s[34:35] op_sel_hi:[1,0,1]
    v_pk_fma_f32 v[126:127], v[126:127], v[122:123], s[34:35] op_sel_hi:[1,0,1]
    v_lshl_add_u32 v124, v125, 16, v124
    v_lshl_add_u32 v125, v127, 16, v126
    s_waitcnt lgkmcnt(2)
    v_bitop3_b32 v115, v115, v120, v121 bitop3:0xfe
    v_lshl_add_u64 v[124:125], v[124:125], 0, s[36:37]
    v_cmpx_le_u32 vcc, 0x1000000, v65
    ds_add_rtn_u64 v[120:121], v123, v[124:125] offset:54272
    s_mov_b64 exec, -1
    s_waitcnt lgkmcnt(15)
    v_ashrrev_i32 v122, 5, v66
    v_lshlrev_b16 v123, 2, v66
    v_lshlrev_b32 v124, 16, v36
    v_bitop3_b32 v122, v122, v113, v113 bitop3:0x0c
    v_and_b32 v125, 0xffff0000, v36
    v_lshlrev_b32 v126, 16, v37
    v_mul_f32 v122, v114, v122
    v_and_b32 v127, 0xffff0000, v37
    v_add_u32 v123, v123, v123
    v_pk_fma_f32 v[124:125], v[124:125], v[122:123], s[34:35] op_sel_hi:[1,0,1]
    v_pk_fma_f32 v[126:127], v[126:127], v[122:123], s[34:35] op_sel_hi:[1,0,1]
    v_lshl_add_u32 v124, v125, 16, v124
    v_lshl_add_u32 v125, v127, 16, v126
    s_waitcnt lgkmcnt(2)
    v_bitop3_b32 v115, v115, v116, v117 bitop3:0xfe
    v_lshl_add_u64 v[124:125], v[124:125], 0, s[36:37]
    v_cmpx_le_u32 vcc, 0x1000000, v66
    ds_add_rtn_u64 v[116:117], v123, v[124:125] offset:54272
    s_mov_b64 exec, -1
    v_ashrrev_i32 v122, 5, v67
    v_lshlrev_b16 v123, 2, v67
    v_lshlrev_b32 v124, 16, v38
    v_bitop3_b32 v122, v122, v113, v113 bitop3:0x0c
    v_and_b32 v125, 0xffff0000, v38
    v_lshlrev_b32 v126, 16, v39
    v_mul_f32 v122, v114, v122
    v_and_b32 v127, 0xffff0000, v39
    v_add_u32 v123, v123, v123
    v_pk_fma_f32 v[124:125], v[124:125], v[122:123], s[34:35] op_sel_hi:[1,0,1]
    v_pk_fma_f32 v[126:127], v[126:127], v[122:123], s[34:35] op_sel_hi:[1,0,1]
    v_lshl_add_u32 v124, v125, 16, v124
    v_lshl_add_u32 v125, v127, 16, v126
    s_waitcnt lgkmcnt(2)
    v_bitop3_b32 v115, v115, v118, v119 bitop3:0xfe
    v_lshl_add_u64 v[124:125], v[124:125], 0, s[36:37]
    v_cmpx_le_u32 vcc, 0x1000000, v67
    ds_add_rtn_u64 v[118:119], v123, v[124:125] offset:54272
    s_mov_b64 exec, -1
    v_ashrrev_i32 v122, 5, v68
    v_lshlrev_b16 v123, 2, v68
    v_lshlrev_b32 v124, 16, v40
    v_bitop3_b32 v122, v122, v113, v113 bitop3:0x0c
    v_and_b32 v125, 0xffff0000, v40
    v_lshlrev_b32 v126, 16, v41
    v_mul_f32 v122, v114, v122
    v_and_b32 v127, 0xffff0000, v41
    v_add_u32 v123, v123, v123
    v_pk_fma_f32 v[124:125], v[124:125], v[122:123], s[34:35] op_sel_hi:[1,0,1]
    v_pk_fma_f32 v[126:127], v[126:127], v[122:123], s[34:35] op_sel_hi:[1,0,1]
    v_lshl_add_u32 v124, v125, 16, v124
    v_lshl_add_u32 v125, v127, 16, v126
    s_waitcnt lgkmcnt(2)
    v_bitop3_b32 v115, v115, v120, v121 bitop3:0xfe
    v_lshl_add_u64 v[124:125], v[124:125], 0, s[36:37]
    v_cmpx_le_u32 vcc, 0x1000000, v68
    ds_add_rtn_u64 v[120:121], v123, v[124:125] offset:54272
    s_mov_b64 exec, -1
    s_waitcnt lgkmcnt(15)
    v_ashrrev_i32 v122, 5, v69
    v_lshlrev_b16 v123, 2, v69
    v_lshlrev_b32 v124, 16, v42
    v_bitop3_b32 v122, v122, v113, v113 bitop3:0x0c
    v_and_b32 v125, 0xffff0000, v42
    v_lshlrev_b32 v126, 16, v43
    v_mul_f32 v122, v114, v122
    v_and_b32 v127, 0xffff0000, v43
    v_add_u32 v123, v123, v123
    v_pk_fma_f32 v[124:125], v[124:125], v[122:123], s[34:35] op_sel_hi:[1,0,1]
    v_pk_fma_f32 v[126:127], v[126:127], v[122:123], s[34:35] op_sel_hi:[1,0,1]
    v_lshl_add_u32 v124, v125, 16, v124
    v_lshl_add_u32 v125, v127, 16, v126
    s_waitcnt lgkmcnt(2)
    v_bitop3_b32 v115, v115, v116, v117 bitop3:0xfe
    v_lshl_add_u64 v[124:125], v[124:125], 0, s[36:37]
    v_cmpx_le_u32 vcc, 0x1000000, v69
    ds_add_rtn_u64 v[116:117], v123, v[124:125] offset:54272
    s_mov_b64 exec, -1
    v_ashrrev_i32 v122, 5, v70
    v_lshlrev_b16 v123, 2, v70
    v_lshlrev_b32 v124, 16, v44
    v_bitop3_b32 v122, v122, v113, v113 bitop3:0x0c
    v_and_b32 v125, 0xffff0000, v44
    v_lshlrev_b32 v126, 16, v45
    v_mul_f32 v122, v114, v122
    v_and_b32 v127, 0xffff0000, v45
    v_add_u32 v123, v123, v123
    v_pk_fma_f32 v[124:125], v[124:125], v[122:123], s[34:35] op_sel_hi:[1,0,1]
    v_pk_fma_f32 v[126:127], v[126:127], v[122:123], s[34:35] op_sel_hi:[1,0,1]
    v_lshl_add_u32 v124, v125, 16, v124
    v_lshl_add_u32 v125, v127, 16, v126
    s_waitcnt lgkmcnt(2)
    v_bitop3_b32 v115, v115, v118, v119 bitop3:0xfe
    v_lshl_add_u64 v[124:125], v[124:125], 0, s[36:37]
    v_cmpx_le_u32 vcc, 0x1000000, v70
    ds_add_rtn_u64 v[118:119], v123, v[124:125] offset:54272
    s_mov_b64 exec, -1
    v_ashrrev_i32 v122, 5, v71
    v_lshlrev_b16 v123, 2, v71
    v_lshlrev_b32 v124, 16, v46
    v_bitop3_b32 v122, v122, v113, v113 bitop3:0x0c
    v_and_b32 v125, 0xffff0000, v46
    v_lshlrev_b32 v126, 16, v47
    v_mul_f32 v122, v114, v122
    v_and_b32 v127, 0xffff0000, v47
    v_add_u32 v123, v123, v123
    v_pk_fma_f32 v[124:125], v[124:125], v[122:123], s[34:35] op_sel_hi:[1,0,1]
    v_pk_fma_f32 v[126:127], v[126:127], v[122:123], s[34:35] op_sel_hi:[1,0,1]
    v_lshl_add_u32 v124, v125, 16, v124
    v_lshl_add_u32 v125, v127, 16, v126
    s_waitcnt lgkmcnt(2)
    v_bitop3_b32 v115, v115, v120, v121 bitop3:0xfe
    v_lshl_add_u64 v[124:125], v[124:125], 0, s[36:37]
    v_cmpx_le_u32 vcc, 0x1000000, v71
    ds_add_rtn_u64 v[120:121], v123, v[124:125] offset:54272
    s_mov_b64 exec, -1
    s_branch p2_fin
p2_topf:
    s_cmp_eq_u32 s60, 10
    s_cbranch_scc1 p2_drain1
    s_setprio 3
    v_cmpx_gt_i16 vcc, 0, v48
    ds_read_b64 v[0:1], v0
    s_mov_b64 exec, -1
    v_cmpx_gt_i16 vcc, 0, v49
    ds_read_b64 v[2:3], v2
    s_mov_b64 exec, -1
    v_cmpx_gt_i16 vcc, 0, v50
    ds_read_b64 v[4:5], v4
    s_mov_b64 exec, -1
    v_cmpx_gt_i16 vcc, 0, v51
    ds_read_b64 v[6:7], v6
    s_mov_b64 exec, -1
    v_cmpx_gt_i16 vcc, 0, v52
    ds_read_b64 v[8:9], v8
    s_mov_b64 exec, -1
    v_cmpx_gt_i16 vcc, 0, v53
    ds_read_b64 v[10:11], v10
    s_mov_b64 exec, -1
    v_cmpx_gt_i16 vcc, 0, v54
    ds_read_b64 v[12:13], v12
    s_mov_b64 exec, -1
    v_cmpx_gt_i16 vcc, 0, v55
    ds_read_b64 v[14:15], v14
    s_mov_b64 exec, -1
    v_cmpx_gt_i16 vcc, 0, v56
    ds_read_b64 v[16:17], v16
    s_mov_b64 exec, -1
    s_cmp_lt_u32 s15, 8
    s_cbranch_scc1 p2_g1r23
    v_cmpx_gt_i16 vcc, 0, v57
    ds_read_b64 v[18:19], v18
    s_mov_b64 exec, -1
    v_cmpx_gt_i16 vcc, 0, v58
    ds_read_b64 v[20:21], v20
    s_mov_b64 exec, -1
    v_cmpx_gt_i16 vcc, 0, v59
    ds_read_b64 v[22:23], v22
    s_mov_b64 exec, -1
p2_g1r23:
    s_cmp_ge_u32 s10, 9
    s_cbranch_scc1 p2_nm1m0a
    v_lshrrev_b32 v84, 1, v112
    s_add_u32 s44, s20, s42
    buffer_load_dwordx2 v[84:85], v84, s[4:7], s44 offen
p2_nm1m0a:
    buffer_load_dwordx4 v[72:75], v112, s[4:7], s20 offen offset:0
    buffer_load_dwordx4 v[76:79], v112, s[4:7], s20 offen offset:1024
    buffer_load_dwordx4 v[80:83], v112, s[4:7], s20 offen offset:2048
    v_cmpx_gt_i16 vcc, 0, v60
    ds_read_b64 v[24:25], v24
    s_mov_b64 exec, -1
    v_cmpx_gt_i16 vcc, 0, v61
    ds_read_b64 v[26:27], v26
    s_mov_b64 exec, -1
    v_cmpx_gt_i16 vcc, 0, v62
    ds_read_b64 v[28:29], v28
    s_mov_b64 exec, -1
    v_cmpx_gt_i16 vcc, 0, v63
    ds_read_b64 v[30:31], v30
    s_mov_b64 exec, -1
    v_cmpx_gt_i16 vcc, 0, v64
    ds_read_b64 v[32:33], v32
    s_mov_b64 exec, -1
    v_cmpx_gt_i16 vcc, 0, v65
    ds_read_b64 v[34:35], v34
    s_mov_b64 exec, -1
    v_cmpx_gt_i16 vcc, 0, v66
    ds_read_b64 v[36:37], v36
    s_mov_b64 exec, -1
    v_cmpx_gt_i16 vcc, 0, v67
    ds_read_b64 v[38:39], v38
    s_mov_b64 exec, -1
    v_cmpx_gt_i16 vcc, 0, v68
    ds_read_b64 v[40:41], v40
    s_mov_b64 exec, -1
    v_cmpx_gt_i16 vcc, 0, v69
    ds_read_b64 v[42:43], v42
    s_mov_b64 exec, -1
    v_cmpx_gt_i16 vcc, 0, v70
    ds_read_b64 v[44:45], v44
    s_mov_b64 exec, -1
    v_cmpx_gt_i16 vcc, 0, v71
    ds_read_b64 v[46:47], v46
    s_mov_b64 exec, -1
    s_setprio 2
    s_waitcnt lgkmcnt(15)
    v_ashrrev_i32 v122, 5, v48
    v_lshlrev_b16 v123, 2, v48
    v_cndmask_b32 v126, v0, v1, s[66:67]
    v_bitop3_b32 v122, v122, v113, v113 bitop3:0x0c
    v_lshlrev_b32 v124, 16, v126
    v_mul_f32 v122, v114, v122
    v_and_b32 v125, 0xffff0000, v126
    v_add_u32 v123, v123, v123
    v_mul_f32 v124, v122, v124
    v_mul_f32 v125, v122, v125
    v_cmpx_le_u32 vcc, 0x1000000, v48
    ds_add_f32 v123, v124 offset:54272
    ds_add_f32 v123, v125 offset:54276
    s_mov_b64 exec, -1
    v_ashrrev_i32 v122, 5, v49
    v_lshlrev_b16 v123, 2, v49
    v_cndmask_b32 v126, v2, v3, s[66:67]
    v_bitop3_b32 v122, v122, v113, v113 bitop3:0x0c
    v_lshlrev_b32 v124, 16, v126
    v_mul_f32 v122, v114, v122
    v_and_b32 v125, 0xffff0000, v126
    v_add_u32 v123, v123, v123
    v_mul_f32 v124, v122, v124
    v_mul_f32 v125, v122, v125
    v_cmpx_le_u32 vcc, 0x1000000, v49
    ds_add_f32 v123, v124 offset:54272
    ds_add_f32 v123, v125 offset:54276
    s_mov_b64 exec, -1
    v_ashrrev_i32 v122, 5, v50
    v_lshlrev_b16 v123, 2, v50
    v_cndmask_b32 v126, v4, v5, s[66:67]
    v_bitop3_b32 v122, v122, v113, v113 bitop3:0x0c
    v_lshlrev_b32 v124, 16, v126
    v_mul_f32 v122, v114, v122
    v_and_b32 v125, 0xffff0000, v126
    v_add_u32 v123, v123, v123
    v_mul_f32 v124, v122, v124
    v_mul_f32 v125, v122, v125
    v_cmpx_le_u32 vcc, 0x1000000, v50
    ds_add_f32 v123, v124 offset:54272
    ds_add_f32 v123, v125 offset:54276
    s_mov_b64 exec, -1
    v_bfe_u32 v0, v102, 14, 4
    v_lshrrev_b32 v1, 18, v102
    v_and_b32 v102, 0x3fff, v102
    v_mad_u32_u24 v0, v0, s63, v1
    v_mad_u32_u24 v102, v0, s65, v102
    buffer_load_dwordx4 v[0:3], v102, s[68:71], 0 offen
    s_setprio 1
    s_waitcnt lgkmcnt(15)
    v_ashrrev_i32 v122, 5, v51
    v_lshlrev_b16 v123, 2, v51
    v_cndmask_b32 v126, v6, v7, s[66:67]
    v_bitop3_b32 v122, v122, v113, v113 bitop3:0x0c
    v_lshlrev_b32 v124, 16, v126
    v_mul_f32 v122, v114, v122
    v_and_b32 v125, 0xffff0000, v126
    v_add_u32 v123, v123, v123
    v_mul_f32 v124, v122, v124
    v_mul_f32 v125, v122, v125
    v_cmpx_le_u32 vcc, 0x1000000, v51
    ds_add_f32 v123, v124 offset:54272
    ds_add_f32 v123, v125 offset:54276
    s_mov_b64 exec, -1
    v_ashrrev_i32 v122, 5, v52
    v_lshlrev_b16 v123, 2, v52
    v_cndmask_b32 v126, v8, v9, s[66:67]
    v_bitop3_b32 v122, v122, v113, v113 bitop3:0x0c
    v_lshlrev_b32 v124, 16, v126
    v_mul_f32 v122, v114, v122
    v_and_b32 v125, 0xffff0000, v126
    v_add_u32 v123, v123, v123
    v_mul_f32 v124, v122, v124
    v_mul_f32 v125, v122, v125
    v_cmpx_le_u32 vcc, 0x1000000, v52
    ds_add_f32 v123, v124 offset:54272
    ds_add_f32 v123, v125 offset:54276
    s_mov_b64 exec, -1
    v_ashrrev_i32 v122, 5, v53
    v_lshlrev_b16 v123, 2, v53
    v_cndmask_b32 v126, v10, v11, s[66:67]
    v_bitop3_b32 v122, v122, v113, v113 bitop3:0x0c
    v_lshlrev_b32 v124, 16, v126
    v_mul_f32 v122, v114, v122
    v_and_b32 v125, 0xffff0000, v126
    v_add_u32 v123, v123, v123
    v_mul_f32 v124, v122, v124
    v_mul_f32 v125, v122, v125
    v_cmpx_le_u32 vcc, 0x1000000, v53
    ds_add_f32 v123, v124 offset:54272
    ds_add_f32 v123, v125 offset:54276
    s_mov_b64 exec, -1
    v_bfe_u32 v6, v103, 14, 4
    v_lshrrev_b32 v7, 18, v103
    v_and_b32 v103, 0x3fff, v103
    v_mad_u32_u24 v6, v6, s63, v7
    v_mad_u32_u24 v103, v6, s65, v103
    buffer_load_dwordx4 v[6:9], v103, s[68:71], 0 offen
    s_waitcnt lgkmcnt(12)
    s_barrier
    s_setprio 3
    s_waitcnt vmcnt(5)
    s_mov_b32 m0, s23
    v_mov_b32 v53, 0
    s_movk_i32 s44, 512
    v_sub_u32_sdwa v4, v111, v110 dst_sel:DWORD dst_unused:UNUSED_PAD src0_sel:WORD_0 src1_sel:WORD_0
    v_sub_u32_sdwa v5, v111, v110 dst_sel:DWORD dst_unused:UNUSED_PAD src0_sel:WORD_1 src1_sel:WORD_1
    v_med3_i32 v4, v4, 0, s44
    v_med3_i32 v5, v5, 0, s44
    v_add_u32 v48, v4, v5
    ds_write_addtid_b32 v53 offset:0
    ds_write_addtid_b32 v53 offset:256
    ds_write_addtid_b32 v53 offset:512
    ds_write_addtid_b32 v53 offset:768
    ds_write_addtid_b32 v53 offset:1024
    ds_write_addtid_b32 v53 offset:1280
    ds_write_addtid_b32 v53 offset:1536
    ds_write_addtid_b32 v53 offset:1792
    v_bfe_i32 v53, v112, 6, 1
    v_lshrrev_b32 v49, 6, v112
    v_bitop3_b32 v53, v53, 15, s10 bitop3:0x6a
    v_lshl_or_b32 v49, v49, 4, v53
    v_and_b32 v53, 0x30, v112
    v_lshl_or_b32 v53, v49, 6, v53
    v_lshlrev_b32 v53, 15, v53
    s_nop 1
    v_add_u32_dpp v48, v48, v48 row_shr:1 row_mask:0xf bank_mask:0xf bound_ctrl:0
    s_nop 1
    v_add_u32_dpp v48, v48, v48 row_shr:2 row_mask:0xf bank_mask:0xf bound_ctrl:0
    s_nop 1
    v_add_u32_dpp v48, v48, v48 row_shr:4 row_mask:0xf bank_mask:0xf bound_ctrl:0
    s_nop 1
    v_add_u32_dpp v48, v48, v48 row_shr:8 row_mask:0xf bank_mask:0xf bound_ctrl:0
    s_nop 1
    v_add_u32_dpp v48, v48, v48 row_bcast:15 row_mask:0xa bank_mask:0xf
    s_nop 1
    v_add_u32_dpp v48, v48, v48 row_bcast:31 row_mask:0xc bank_mask:0xf
    s_nop 1
    s_nop 0
    v_readlane_b32 s38, v48, 63
    v_sub_u32 v50, v48, v5
    v_sub_u32 v49, v50, v4
    v_writelane_b32 v5, 1, 63
    v_sub_u32 v10, 512, v49
    v_mad_u32_u16 v51, v110, 16, v53
    v_lshl_add_u32 v51, v10, 4, v51
    v_med3_i32 v10, v10, 0, v4
    v_lshl_add_u32 v49, v49, 2, s23
    v_sub_u32 v11, 512, v50
    v_mad_u32_u16 v52, v110, 16, v53 op_sel:[1,0,0,0]
    v_add_u32 v52, 262144, v52
    s_mov_b32 s44, 0x1fffc000
    v_writelane_b32 v52, s44, 63
    v_lshl_add_u32 v52, v11, 4, v52
    v_med3_i32 v11, v11, 0, v5
    v_lshl_add_u32 v50, v50, 2, s23
    v_lshl_add_u32 v48, v11, 16, v10
    v_add_u32 v110, v110, v48
    s_min_u32 s17, s38, 512
    s_add_u32 s17, s17, 63
    s_lshr_b32 s17, s17, 6
    v_cmpx_lt_i32 vcc, 0, v10
    ds_write_b32 v49, v51
    s_mov_b64 exec, -1
    v_cmpx_lt_i32 vcc, 0, v11
    ds_write_b32 v50, v52
    s_mov_b64 exec, -1
    s_cmp_lt_u32 s38, 512
    s_cbranch_scc1 p2_nomore1x
    v_cmp_lt_u32_sdwa s[44:45], v110, v111 src0_sel:WORD_0 src1_sel:WORD_0
    v_cmp_lt_u32_sdwa s[46:47], v110, v111 src0_sel:WORD_1 src1_sel:WORD_1
    s_nop 0
    s_or_b64 s[44:45], s[44:45], s[46:47]
    s_cbranch_scc0 p2_nomore1x
    v_mov_b32 v49, s19
    v_mov_b32 v50, 1
    ds_write_b32 v49, v50 offset:53760
p2_nomore1x:
    s_setprio 2
    s_waitcnt lgkmcnt(15)
    v_ashrrev_i32 v122, 5, v54
    v_lshlrev_b16 v123, 2, v54
    v_cndmask_b32 v126, v12, v13, s[66:67]
    v_bitop3_b32 v122, v122, v113, v113 bitop3:0x0c
    v_lshlrev_b32 v124, 16, v126
    v_mul_f32 v122, v114, v122
    v_and_b32 v125, 0xffff0000, v126
    v_add_u32 v123, v123, v123
    v_mul_f32 v124, v122, v124
    v_mul_f32 v125, v122, v125
    v_cmpx_le_u32 vcc, 0x1000000, v54
    ds_add_f32 v123, v124 offset:54272
    ds_add_f32 v123, v125 offset:54276
    s_mov_b64 exec, -1
    v_ashrrev_i32 v122, 5, v55
    v_lshlrev_b16 v123, 2, v55
    v_cndmask_b32 v126, v14, v15, s[66:67]
    v_bitop3_b32 v122, v122, v113, v113 bitop3:0x0c
    v_lshlrev_b32 v124, 16, v126
    v_mul_f32 v122, v114, v122
    v_and_b32 v125, 0xffff0000, v126
    v_add_u32 v123, v123, v123
    v_mul_f32 v124, v122, v124
    v_mul_f32 v125, v122, v125
    v_cmpx_le_u32 vcc, 0x1000000, v55
    ds_add_f32 v123, v124 offset:54272
    ds_add_f32 v123, v125 offset:54276
    s_mov_b64 exec, -1
    v_ashrrev_i32 v122, 5, v56
    v_lshlrev_b16 v123, 2, v56
    v_cndmask_b32 v126, v16, v17, s[66:67]
    v_bitop3_b32 v122, v122, v113, v113 bitop3:0x0c
    v_lshlrev_b32 v124, 16, v126
    v_mul_f32 v122, v114, v122
    v_and_b32 v125, 0xffff0000, v126
    v_add_u32 v123, v123, v123
    v_mul_f32 v124, v122, v124
    v_mul_f32 v125, v122, v125
    v_cmpx_le_u32 vcc, 0x1000000, v56
    ds_add_f32 v123, v124 offset:54272
    ds_add_f32 v123, v125 offset:54276
    s_mov_b64 exec, -1
    v_bfe_u32 v12, v104, 14, 4
    v_lshrrev_b32 v13, 18, v104
    v_and_b32 v104, 0x3fff, v104
    v_mad_u32_u24 v12, v12, s63, v13
    v_mad_u32_u24 v104, v12, s65, v104
    buffer_load_dwordx4 v[12:15], v104, s[68:71], 0 offen
    s_cmp_lt_u32 s15, 8
    s_cbranch_scc1 p2_na1a3
    s_waitcnt lgkmcnt(15)
    v_ashrrev_i32 v122, 5, v57
    v_lshlrev_b16 v123, 2, v57
    v_cndmask_b32 v126, v18, v19, s[66:67]
    v_bitop3_b32 v122, v122, v113, v113 bitop3:0x0c
    v_lshlrev_b32 v124, 16, v126
    v_mul_f32 v122, v114, v122
    v_and_b32 v125, 0xffff0000, v126
    v_add_u32 v123, v123, v123
    v_mul_f32 v124, v122, v124
    v_mul_f32 v125, v122, v125
    v_cmpx_le_u32 vcc, 0x1000000, v57
    ds_add_f32 v123, v124 offset:54272
    ds_add_f32 v123, v125 offset:54276
    s_mov_b64 exec, -1
    v_ashrrev_i32 v122, 5, v58
    v_lshlrev_b16 v123, 2, v58
    v_cndmask_b32 v126, v20, v21, s[66:67]
    v_bitop3_b32 v122, v122, v113, v113 bitop3:0x0c
    v_lshlrev_b32 v124, 16, v126
    v_mul_f32 v122, v114, v122
    v_and_b32 v125, 0xffff0000, v126
    v_add_u32 v123, v123, v123
    v_mul_f32 v124, v122, v124
    v_mul_f32 v125, v122, v125
    v_cmpx_le_u32 vcc, 0x1000000, v58
    ds_add_f32 v123, v124 offset:54272
    ds_add_f32 v123, v125 offset:54276
    s_mov_b64 exec, -1
    v_ashrrev_i32 v122, 5, v59
    v_lshlrev_b16 v123, 2, v59
    v_cndmask_b32 v126, v22, v23, s[66:67]
    v_bitop3_b32 v122, v122, v113, v113 bitop3:0x0c
    v_lshlrev_b32 v124, 16, v126
    v_mul_f32 v122, v114, v122
    v_and_b32 v125, 0xffff0000, v126
    v_add_u32 v123, v123, v123
    v_mul_f32 v124, v122, v124
    v_mul_f32 v125, v122, v125
    v_cmpx_le_u32 vcc, 0x1000000, v59
    ds_add_f32 v123, v124 offset:54272
    ds_add_f32 v123, v125 offset:54276
    s_mov_b64 exec, -1
p2_na1a3:
    v_bfe_u32 v18, v105, 14, 4
    v_lshrrev_b32 v19, 18, v105
    v_and_b32 v105, 0x3fff, v105
    v_mad_u32_u24 v18, v18, s63, v19
    v_mad_u32_u24 v105, v18, s65, v105
    buffer_load_dwordx4 v[18:21], v105, s[68:71], 0 offen
    s_mov_b32 m0, s23
    s_nop 0
    ds_read_addtid_b32 v102 offset:1024
    ds_read_addtid_b32 v103 offset:1280
    ds_read_addtid_b32 v104 offset:1536
    ds_read_addtid_b32 v105 offset:1792
    ds_read_addtid_b32 v106 offset:0
    ds_read_addtid_b32 v107 offset:256
    ds_read_addtid_b32 v108 offset:512
    ds_read_addtid_b32 v109 offset:768
    s_waitcnt vmcnt(4)
    s_mov_b32 m0, s24
    s_cmp_ge_u32 s10, 9
    s_cbranch_scc1 p2_st1s0
    ds_write_addtid_b32 v84 offset:49152
    ds_write_addtid_b32 v85 offset:49408
p2_st1s0:
    s_mov_b32 m0, s23
    s_add_u32 s20, s20, 53760
    ds_write_addtid_b32 v72 offset:0
    ds_write_addtid_b32 v73 offset:256
    ds_write_addtid_b32 v74 offset:512
    ds_write_addtid_b32 v75 offset:768
    ds_write_addtid_b32 v76 offset:1024
    ds_write_addtid_b32 v77 offset:1280
    ds_write_addtid_b32 v78 offset:1536
    ds_write_addtid_b32 v79 offset:1792
    ds_write_addtid_b32 v80 offset:2048
    ds_write_addtid_b32 v81 offset:2304
    ds_write_addtid_b32 v82 offset:2560
    ds_write_addtid_b32 v83 offset:2816
    s_setprio 1
    s_waitcnt lgkmcnt(15)
    v_ashrrev_i32 v122, 5, v60
    v_lshlrev_b16 v123, 2, v60
    v_cndmask_b32 v126, v24, v25, s[66:67]
    v_bitop3_b32 v122, v122, v113, v113 bitop3:0x0c
    v_lshlrev_b32 v124, 16, v126
    v_mul_f32 v122, v114, v122
    v_and_b32 v125, 0xffff0000, v126
    v_add_u32 v123, v123, v123
    v_mul_f32 v124, v122, v124
    v_mul_f32 v125, v122, v125
    v_cmpx_le_u32 vcc, 0x1000000, v60
    ds_add_f32 v123, v124 offset:54272
    ds_add_f32 v123, v125 offset:54276
    s_mov_b64 exec, -1
    v_ashrrev_i32 v122, 5, v61
    v_lshlrev_b16 v123, 2, v61
    v_cndmask_b32 v126, v26, v27, s[66:67]
    v_bitop3_b32 v122, v122, v113, v113 bitop3:0x0c
    v_lshlrev_b32 v124, 16, v126
    v_mul_f32 v122, v114, v122
    v_and_b32 v125, 0xffff0000, v126
    v_add_u32 v123, v123, v123
    v_mul_f32 v124, v122, v124
    v_mul_f32 v125, v122, v125
    v_cmpx_le_u32 vcc, 0x1000000, v61
    ds_add_f32 v123, v124 offset:54272
    ds_add_f32 v123, v125 offset:54276
    s_mov_b64 exec, -1
    v_ashrrev_i32 v122, 5, v62
    v_lshlrev_b16 v123, 2, v62
    v_cndmask_b32 v126, v28, v29, s[66:67]
    v_bitop3_b32 v122, v122, v113, v113 bitop3:0x0c
    v_lshlrev_b32 v124, 16, v126
    v_mul_f32 v122, v114, v122
    v_and_b32 v125, 0xffff0000, v126
    v_add_u32 v123, v123, v123
    v_mul_f32 v124, v122, v124
    v_mul_f32 v125, v122, v125
    v_cmpx_le_u32 vcc, 0x1000000, v62
    ds_add_f32 v123, v124 offset:54272
    ds_add_f32 v123, v125 offset:54276
    s_mov_b64 exec, -1
    s_waitcnt vmcnt(16)
    v_perm_b32 v60, v89, v86, s31
    v_perm_b32 v61, v89, v87, s32
    v_perm_b32 v62, v89, v88, s33
    v_lshlrev_b16 v28, 3, v88
    v_lshlrev_b16 v26, 3, v87
    v_lshlrev_b16 v24, 3, v86
    s_waitcnt lgkmcnt(15)
    s_nop 2
    s_nop 1
    v_max_u32_dpp v106, v106, v106 row_shr:1 row_mask:0xf bank_mask:0xf bound_ctrl:0
    v_max_u32_dpp v107, v107, v107 row_shr:1 row_mask:0xf bank_mask:0xf bound_ctrl:0
    s_nop 0
    v_max_u32_dpp v106, v106, v106 row_shr:2 row_mask:0xf bank_mask:0xf bound_ctrl:0
    v_max_u32_dpp v107, v107, v107 row_shr:2 row_mask:0xf bank_mask:0xf bound_ctrl:0
    s_nop 0
    v_max_u32_dpp v106, v106, v106 row_shr:4 row_mask:0xf bank_mask:0xf bound_ctrl:0
    v_max_u32_dpp v107, v107, v107 row_shr:4 row_mask:0xf bank_mask:0xf bound_ctrl:0
    s_nop 0
    v_max_u32_dpp v106, v106, v106 row_shr:8 row_mask:0xf bank_mask:0xf bound_ctrl:0
    v_max_u32_dpp v107, v107, v107 row_shr:8 row_mask:0xf bank_mask:0xf bound_ctrl:0
    s_nop 0
    v_max_u32_dpp v106, v106, v106 row_bcast:15 row_mask:0xa bank_mask:0xf
    v_max_u32_dpp v107, v107, v107 row_bcast:15 row_mask:0xa bank_mask:0xf
    s_nop 0
    v_max_u32_dpp v106, v106, v106 row_bcast:31 row_mask:0xc bank_mask:0xf
    v_max_u32_dpp v107, v107, v107 row_bcast:31 row_mask:0xc bank_mask:0xf
    s_nop 0
    s_nop 0
    v_readlane_b32 s41, v106, 63
    v_add_u32 v106, v106, v112
    v_add_u32 v106, 4294959104, v106
    v_max_u32 v107, s41, v107
    s_nop 0
    v_readlane_b32 s41, v107, 63
    v_add_u32 v107, v107, v112
    v_add_u32 v107, 4294960128, v107
    v_bfe_u32 v86, v106, 14, 4
    v_lshrrev_b32 v87, 18, v106
    v_and_b32 v106, 0x3fff, v106
    v_mad_u32_u24 v86, v86, s63, v87
    v_mad_u32_u24 v106, v86, s65, v106
    buffer_load_dwordx4 v[86:89], v106, s[68:71], 0 offen
    s_setprio 0
    s_waitcnt lgkmcnt(15)
    v_ashrrev_i32 v122, 5, v63
    v_lshlrev_b16 v123, 2, v63
    v_cndmask_b32 v126, v30, v31, s[66:67]
    v_bitop3_b32 v122, v122, v113, v113 bitop3:0x0c
    v_lshlrev_b32 v124, 16, v126
    v_mul_f32 v122, v114, v122
    v_and_b32 v125, 0xffff0000, v126
    v_add_u32 v123, v123, v123
    v_mul_f32 v124, v122, v124
    v_mul_f32 v125, v122, v125
    v_cmpx_le_u32 vcc, 0x1000000, v63
    ds_add_f32 v123, v124 offset:54272
    ds_add_f32 v123, v125 offset:54276
    s_mov_b64 exec, -1
    v_ashrrev_i32 v122, 5, v64
    v_lshlrev_b16 v123, 2, v64
    v_cndmask_b32 v126, v32, v33, s[66:67]
    v_bitop3_b32 v122, v122, v113, v113 bitop3:0x0c
    v_lshlrev_b32 v124, 16, v126
    v_mul_f32 v122, v114, v122
    v_and_b32 v125, 0xffff0000, v126
    v_add_u32 v123, v123, v123
    v_mul_f32 v124, v122, v124
    v_mul_f32 v125, v122, v125
    v_cmpx_le_u32 vcc, 0x1000000, v64
    ds_add_f32 v123, v124 offset:54272
    ds_add_f32 v123, v125 offset:54276
    s_mov_b64 exec, -1
    v_ashrrev_i32 v122, 5, v65
    v_lshlrev_b16 v123, 2, v65
    v_cndmask_b32 v126, v34, v35, s[66:67]
    v_bitop3_b32 v122, v122, v113, v113 bitop3:0x0c
    v_lshlrev_b32 v124, 16, v126
    v_mul_f32 v122, v114, v122
    v_and_b32 v125, 0xffff0000, v126
    v_add_u32 v123, v123, v123
    v_mul_f32 v124, v122, v124
    v_mul_f32 v125, v122, v125
    v_cmpx_le_u32 vcc, 0x1000000, v65
    ds_add_f32 v123, v124 offset:54272
    ds_add_f32 v123, v125 offset:54276
    s_mov_b64 exec, -1
    s_waitcnt vmcnt(13)
    v_perm_b32 v63, v93, v90, s31
    v_perm_b32 v64, v93, v91, s32
    v_perm_b32 v65, v93, v92, s33
    v_lshlrev_b16 v34, 3, v92
    v_lshlrev_b16 v32, 3, v91
    v_lshlrev_b16 v30, 3, v90
    s_waitcnt lgkmcnt(12)
    s_barrier
    s_setprio 3
    s_cmp_ge_u32 s10, 9
    s_cbranch_scc1 p2_nm1m1a
    v_lshrrev_b32 v84, 1, v112
    s_add_u32 s44, s20, s42
    buffer_load_dwordx2 v[84:85], v84, s[4:7], s44 offen
p2_nm1m1a:
    buffer_load_dwordx4 v[72:75], v112, s[4:7], s20 offen offset:0
    buffer_load_dwordx4 v[76:79], v112, s[4:7], s20 offen offset:1024
    buffer_load_dwordx4 v[80:83], v112, s[4:7], s20 offen offset:2048
    v_cmpx_ge_u16 vcc, 0x3fff, v60
    ds_read_b64 v[24:25], v24
    s_mov_b64 exec, -1
    v_cmpx_ge_u16 vcc, 0x3fff, v61
    ds_read_b64 v[26:27], v26
    s_mov_b64 exec, -1
    v_cmpx_ge_u16 vcc, 0x3fff, v62
    ds_read_b64 v[28:29], v28
    s_mov_b64 exec, -1
    v_cmpx_ge_u16 vcc, 0x3fff, v63
    ds_read_b64 v[30:31], v30
    s_mov_b64 exec, -1
    v_cmpx_ge_u16 vcc, 0x3fff, v64
    ds_read_b64 v[32:33], v32
    s_mov_b64 exec, -1
    v_cmpx_ge_u16 vcc, 0x3fff, v65
    ds_read_b64 v[34:35], v34
    s_mov_b64 exec, -1
    s_setprio 2
    s_waitcnt lgkmcnt(15)
    v_ashrrev_i32 v122, 5, v66
    v_lshlrev_b16 v123, 2, v66
    v_cndmask_b32 v126, v36, v37, s[66:67]
    v_bitop3_b32 v122, v122, v113, v113 bitop3:0x0c
    v_lshlrev_b32 v124, 16, v126
    v_mul_f32 v122, v114, v122
    v_and_b32 v125, 0xffff0000, v126
    v_add_u32 v123, v123, v123
    v_mul_f32 v124, v122, v124
    v_mul_f32 v125, v122, v125
    v_cmpx_le_u32 vcc, 0x1000000, v66
    ds_add_f32 v123, v124 offset:54272
    ds_add_f32 v123, v125 offset:54276
    s_mov_b64 exec, -1
    v_ashrrev_i32 v122, 5, v67
    v_lshlrev_b16 v123, 2, v67
    v_cndmask_b32 v126, v38, v39, s[66:67]
    v_bitop3_b32 v122, v122, v113, v113 bitop3:0x0c
    v_lshlrev_b32 v124, 16, v126
    v_mul_f32 v122, v114, v122
    v_and_b32 v125, 0xffff0000, v126
    v_add_u32 v123, v123, v123
    v_mul_f32 v124, v122, v124
    v_mul_f32 v125, v122, v125
    v_cmpx_le_u32 vcc, 0x1000000, v67
    ds_add_f32 v123, v124 offset:54272
    ds_add_f32 v123, v125 offset:54276
    s_mov_b64 exec, -1
    v_ashrrev_i32 v122, 5, v68
    v_lshlrev_b16 v123, 2, v68
    v_cndmask_b32 v126, v40, v41, s[66:67]
    v_bitop3_b32 v122, v122, v113, v113 bitop3:0x0c
    v_lshlrev_b32 v124, 16, v126
    v_mul_f32 v122, v114, v122
    v_and_b32 v125, 0xffff0000, v126
    v_add_u32 v123, v123, v123
    v_mul_f32 v124, v122, v124
    v_mul_f32 v125, v122, v125
    v_cmpx_le_u32 vcc, 0x1000000, v68
    ds_add_f32 v123, v124 offset:54272
    ds_add_f32 v123, v125 offset:54276
    s_mov_b64 exec, -1
    s_waitcnt vmcnt(15)
    v_perm_b32 v66, v97, v94, s31
    v_perm_b32 v67, v97, v95, s32
    v_perm_b32 v68, v97, v96, s33
    v_lshlrev_b16 v40, 3, v96
    v_lshlrev_b16 v38, 3, v95
    v_lshlrev_b16 v36, 3, v94
    v_cmpx_ge_u16 vcc, 0x3fff, v66
    ds_read_b64 v[36:37], v36
    s_mov_b64 exec, -1
    v_cmpx_ge_u16 vcc, 0x3fff, v67
    ds_read_b64 v[38:39], v38
    s_mov_b64 exec, -1
    v_cmpx_ge_u16 vcc, 0x3fff, v68
    ds_read_b64 v[40:41], v40
    s_mov_b64 exec, -1
    v_bfe_u32 v90, v107, 14, 4
    v_lshrrev_b32 v91, 18, v107
    v_and_b32 v107, 0x3fff, v107
    v_mad_u32_u24 v90, v90, s63, v91
    v_mad_u32_u24 v107, v90, s65, v107
    buffer_load_dwordx4 v[90:93], v107, s[68:71], 0 offen
    s_setprio 1
    s_waitcnt lgkmcnt(15)
    v_ashrrev_i32 v122, 5, v69
    v_lshlrev_b16 v123, 2, v69
    v_cndmask_b32 v126, v42, v43, s[66:67]
    v_bitop3_b32 v122, v122, v113, v113 bitop3:0x0c
    v_lshlrev_b32 v124, 16, v126
    v_mul_f32 v122, v114, v122
    v_and_b32 v125, 0xffff0000, v126
    v_add_u32 v123, v123, v123
    v_mul_f32 v124, v122, v124
    v_mul_f32 v125, v122, v125
    v_cmpx_le_u32 vcc, 0x1000000, v69
    ds_add_f32 v123, v124 offset:54272
    ds_add_f32 v123, v125 offset:54276
    s_mov_b64 exec, -1
    v_ashrrev_i32 v122, 5, v70
    v_lshlrev_b16 v123, 2, v70
    v_cndmask_b32 v126, v44, v45, s[66:67]
    v_bitop3_b32 v122, v122, v113, v113 bitop3:0x0c
    v_lshlrev_b32 v124, 16, v126
    v_mul_f32 v122, v114, v122
    v_and_b32 v125, 0xffff0000, v126
    v_add_u32 v123, v123, v123
    v_mul_f32 v124, v122, v124
    v_mul_f32 v125, v122, v125
    v_cmpx_le_u32 vcc, 0x1000000, v70
    ds_add_f32 v123, v124 offset:54272
    ds_add_f32 v123, v125 offset:54276
    s_mov_b64 exec, -1
    v_ashrrev_i32 v122, 5, v71
    v_lshlrev_b16 v123, 2, v71
    v_cndmask_b32 v126, v46, v47, s[66:67]
    v_bitop3_b32 v122, v122, v113, v113 bitop3:0x0c
    v_lshlrev_b32 v124, 16, v126
    v_mul_f32 v122, v114, v122
    v_and_b32 v125, 0xffff0000, v126
    v_add_u32 v123, v123, v123
    v_mul_f32 v124, v122, v124
    v_mul_f32 v125, v122, v125
    v_cmpx_le_u32 vcc, 0x1000000, v71
    ds_add_f32 v123, v124 offset:54272
    ds_add_f32 v123, v125 offset:54276
    s_mov_b64 exec, -1
    s_waitcnt vmcnt(12)
    v_perm_b32 v69, v101, v98, s31
    v_perm_b32 v70, v101, v99, s32
    v_perm_b32 v71, v101, v100, s33
    v_lshlrev_b16 v46, 3, v100
    v_lshlrev_b16 v44, 3, v99
    v_lshlrev_b16 v42, 3, v98
    v_cmpx_ge_u16 vcc, 0x3fff, v69
    ds_read_b64 v[42:43], v42
    s_mov_b64 exec, -1
    v_cmpx_ge_u16 vcc, 0x3fff, v70
    ds_read_b64 v[44:45], v44
    s_mov_b64 exec, -1
    v_cmpx_ge_u16 vcc, 0x3fff, v71
    ds_read_b64 v[46:47], v46
    s_mov_b64 exec, -1
    s_waitcnt lgkmcnt(15)
    s_nop 2
    s_nop 1
    v_max_u32_dpp v108, v108, v108 row_shr:1 row_mask:0xf bank_mask:0xf bound_ctrl:0
    v_max_u32_dpp v109, v109, v109 row_shr:1 row_mask:0xf bank_mask:0xf bound_ctrl:0
    s_nop 0
    v_max_u32_dpp v108, v108, v108 row_shr:2 row_mask:0xf bank_mask:0xf bound_ctrl:0
    v_max_u32_dpp v109, v109, v109 row_shr:2 row_mask:0xf bank_mask:0xf bound_ctrl:0
    s_nop 0
    v_max_u32_dpp v108, v108, v108 row_shr:4 row_mask:0xf bank_mask:0xf bound_ctrl:0
    v_max_u32_dpp v109, v109, v109 row_shr:4 row_mask:0xf bank_mask:0xf bound_ctrl:0
    s_nop 0
    v_max_u32_dpp v108, v108, v108 row_shr:8 row_mask:0xf bank_mask:0xf bound_ctrl:0
    v_max_u32_dpp v109, v109, v109 row_shr:8 row_mask:0xf bank_mask:0xf bound_ctrl:0
    s_nop 0
    v_max_u32_dpp v108, v108, v108 row_bcast:15 row_mask:0xa bank_mask:0xf
    v_max_u32_dpp v109, v109, v109 row_bcast:15 row_mask:0xa bank_mask:0xf
    s_nop 0
    v_max_u32_dpp v108, v108, v108 row_bcast:31 row_mask:0xc bank_mask:0xf
    v_max_u32_dpp v109, v109, v109 row_bcast:31 row_mask:0xc bank_mask:0xf
    s_nop 0
    s_nop 0
    v_max_u32 v108, s41, v108
    s_nop 0
    v_readlane_b32 s41, v108, 63
    v_add_u32 v108, v108, v112
    v_add_u32 v108, 4294961152, v108
    v_max_u32 v109, s41, v109
    s_nop 0
    v_readlane_b32 s41, v109, 63
    v_add_u32 v109, v109, v112
    v_add_u32 v109, 4294962176, v109
    v_bfe_u32 v94, v108, 14, 4
    v_lshrrev_b32 v95, 18, v108
    v_and_b32 v108, 0x3fff, v108
    v_mad_u32_u24 v94, v94, s63, v95
    v_mad_u32_u24 v108, v94, s65, v108
    buffer_load_dwordx4 v[94:97], v108, s[68:71], 0 offen
    s_setprio 0
    s_waitcnt vmcnt(9)
    v_perm_b32 v48, v3, v0, s31
    v_perm_b32 v49, v3, v1, s32
    v_perm_b32 v50, v3, v2, s33
    v_lshlrev_b16 v4, 3, v2
    v_lshlrev_b16 v2, 3, v1
    v_lshlrev_b16 v0, 3, v0
    v_cmpx_ge_u16 vcc, 0x3fff, v48
    ds_read_b64 v[0:1], v0
    s_mov_b64 exec, -1
    v_cmpx_ge_u16 vcc, 0x3fff, v49
    ds_read_b64 v[2:3], v2
    s_mov_b64 exec, -1
    v_cmpx_ge_u16 vcc, 0x3fff, v50
    ds_read_b64 v[4:5], v4
    s_mov_b64 exec, -1
    s_waitcnt vmcnt(8)
    v_perm_b32 v51, v9, v6, s31
    v_perm_b32 v52, v9, v7, s32
    v_perm_b32 v53, v9, v8, s33
    v_lshlrev_b16 v10, 3, v8
    v_lshlrev_b16 v8, 3, v7
    v_lshlrev_b16 v6, 3, v6
    v_cmpx_ge_u16 vcc, 0x3fff, v51
    ds_read_b64 v[6:7], v6
    s_mov_b64 exec, -1
    v_cmpx_ge_u16 vcc, 0x3fff, v52
    ds_read_b64 v[8:9], v8
    s_mov_b64 exec, -1
    v_cmpx_ge_u16 vcc, 0x3fff, v53
    ds_read_b64 v[10:11], v10
    s_mov_b64 exec, -1
    s_waitcnt vmcnt(7)
    v_perm_b32 v54, v15, v12, s31
    v_perm_b32 v55, v15, v13, s32
    v_perm_b32 v56, v15, v14, s33
    v_lshlrev_b16 v16, 3, v14
    v_lshlrev_b16 v14, 3, v13
    v_lshlrev_b16 v12, 3, v12
    v_cmpx_ge_u16 vcc, 0x3fff, v54
    ds_read_b64 v[12:13], v12
    s_mov_b64 exec, -1
    v_cmpx_ge_u16 vcc, 0x3fff, v55
    ds_read_b64 v[14:15], v14
    s_mov_b64 exec, -1
    v_cmpx_ge_u16 vcc, 0x3fff, v56
    ds_read_b64 v[16:17], v16
    s_mov_b64 exec, -1
    s_waitcnt vmcnt(6)
    v_perm_b32 v57, v21, v18, s31
    v_perm_b32 v58, v21, v19, s32
    v_perm_b32 v59, v21, v20, s33
    v_lshlrev_b16 v22, 3, v20
    v_lshlrev_b16 v20, 3, v19
    v_lshlrev_b16 v18, 3, v18
    s_cmp_lt_u32 s16, 8
    s_cbranch_scc1 p2_g1r03
    v_cmpx_ge_u16 vcc, 0x3fff, v57
    ds_read_b64 v[18:19], v18
    s_mov_b64 exec, -1
    v_cmpx_ge_u16 vcc, 0x3fff, v58
    ds_read_b64 v[20:21], v20
    s_mov_b64 exec, -1
    v_cmpx_ge_u16 vcc, 0x3fff, v59
    ds_read_b64 v[22:23], v22
    s_mov_b64 exec, -1
p2_g1r03:
    s_waitcnt lgkmcnt(0)
    s_barrier
    s_waitcnt lgkmcnt(15)
    s_branch p2_tail
p2_drain1:
    v_cmpx_gt_i16 vcc, 0, v48
    ds_read_b64 v[0:1], v0
    s_mov_b64 exec, -1
    v_cmpx_gt_i16 vcc, 0, v49
    ds_read_b64 v[2:3], v2
    s_mov_b64 exec, -1
    v_cmpx_gt_i16 vcc, 0, v50
    ds_read_b64 v[4:5], v4
    s_mov_b64 exec, -1
    v_cmpx_gt_i16 vcc, 0, v51
    ds_read_b64 v[6:7], v6
    s_mov_b64 exec, -1
    v_cmpx_gt_i16 vcc, 0, v52
    ds_read_b64 v[8:9], v8
    s_mov_b64 exec, -1
    v_cmpx_gt_i16 vcc, 0, v53
    ds_read_b64 v[10:11], v10
    s_mov_b64 exec, -1
    v_cmpx_gt_i16 vcc, 0, v54
    ds_read_b64 v[12:13], v12
    s_mov_b64 exec, -1
    v_cmpx_gt_i16 vcc, 0, v55
    ds_read_b64 v[14:15], v14
    s_mov_b64 exec, -1
    v_cmpx_gt_i16 vcc, 0, v56
    ds_read_b64 v[16:17], v16
    s_mov_b64 exec, -1
    s_cmp_lt_u32 s15, 8
    s_cbranch_scc1 p2_gd1
    v_cmpx_gt_i16 vcc, 0, v57
    ds_read_b64 v[18:19], v18
    s_mov_b64 exec, -1
    v_cmpx_gt_i16 vcc, 0, v58
    ds_read_b64 v[20:21], v20
    s_mov_b64 exec, -1
    v_cmpx_gt_i16 vcc, 0, v59
    ds_read_b64 v[22:23], v22
    s_mov_b64 exec, -1
p2_gd1:
    v_cmpx_gt_i16 vcc, 0, v60
    ds_read_b64 v[24:25], v24
    s_mov_b64 exec, -1
    v_cmpx_gt_i16 vcc, 0, v61
    ds_read_b64 v[26:27], v26
    s_mov_b64 exec, -1
    v_cmpx_gt_i16 vcc, 0, v62
    ds_read_b64 v[28:29], v28
    s_mov_b64 exec, -1
    v_cmpx_gt_i16 vcc, 0, v63
    ds_read_b64 v[30:31], v30
    s_mov_b64 exec, -1
    v_cmpx_gt_i16 vcc, 0, v64
    ds_read_b64 v[32:33], v32
    s_mov_b64 exec, -1
    v_cmpx_gt_i16 vcc, 0, v65
    ds_read_b64 v[34:35], v34
    s_mov_b64 exec, -1
    v_cmpx_gt_i16 vcc, 0, v66
    ds_read_b64 v[36:37], v36
    s_mov_b64 exec, -1
    v_cmpx_gt_i16 vcc, 0, v67
    ds_read_b64 v[38:39], v38
    s_mov_b64 exec, -1
    v_cmpx_gt_i16 vcc, 0, v68
    ds_read_b64 v[40:41], v40
    s_mov_b64 exec, -1
    v_cmpx_gt_i16 vcc, 0, v69
    ds_read_b64 v[42:43], v42
    s_mov_b64 exec, -1
    v_cmpx_gt_i16 vcc, 0, v70
    ds_read_b64 v[44:45], v44
    s_mov_b64 exec, -1
    v_cmpx_gt_i16 vcc, 0, v71
    ds_read_b64 v[46:47], v46
    s_mov_b64 exec, -1
    s_waitcnt lgkmcnt(15)
    v_ashrrev_i32 v122, 5, v48
    v_lshlrev_b16 v123, 2, v48
    v_cndmask_b32 v126, v0, v1, s[66:67]
    v_bitop3_b32 v122, v122, v113, v113 bitop3:0x0c
    v_lshlrev_b32 v124, 16, v126
    v_mul_f32 v122, v114, v122
    v_and_b32 v125, 0xffff0000, v126
    v_add_u32 v123, v123, v123
    v_mul_f32 v124, v122, v124
    v_mul_f32 v125, v122, v125
    v_cmpx_le_u32 vcc, 0x1000000, v48
    ds_add_f32 v123, v124 offset:54272
    ds_add_f32 v123, v125 offset:54276
    s_mov_b64 exec, -1
    v_ashrrev_i32 v122, 5, v49
    v_lshlrev_b16 v123, 2, v49
    v_cndmask_b32 v126, v2, v3, s[66:67]
    v_bitop3_b32 v122, v122, v113, v113 bitop3:0x0c
    v_lshlrev_b32 v124, 16, v126
    v_mul_f32 v122, v114, v122
    v_and_b32 v125, 0xffff0000, v126
    v_add_u32 v123, v123, v123
    v_mul_f32 v124, v122, v124
    v_mul_f32 v125, v122, v125
    v_cmpx_le_u32 vcc, 0x1000000, v49
    ds_add_f32 v123, v124 offset:54272
    ds_add_f32 v123, v125 offset:54276
    s_mov_b64 exec, -1
    v_ashrrev_i32 v122, 5, v50
    v_lshlrev_b16 v123, 2, v50
    v_cndmask_b32 v126, v4, v5, s[66:67]
    v_bitop3_b32 v122, v122, v113, v113 bitop3:0x0c
    v_lshlrev_b32 v124, 16, v126
    v_mul_f32 v122, v114, v122
    v_and_b32 v125, 0xffff0000, v126
    v_add_u32 v123, v123, v123
    v_mul_f32 v124, v122, v124
    v_mul_f32 v125, v122, v125
    v_cmpx_le_u32 vcc, 0x1000000, v50
    ds_add_f32 v123, v124 offset:54272
    ds_add_f32 v123, v125 offset:54276
    s_mov_b64 exec, -1
    s_waitcnt lgkmcnt(15)
    v_ashrrev_i32 v122, 5, v51
    v_lshlrev_b16 v123, 2, v51
    v_cndmask_b32 v126, v6, v7, s[66:67]
    v_bitop3_b32 v122, v122, v113, v113 bitop3:0x0c
    v_lshlrev_b32 v124, 16, v126
    v_mul_f32 v122, v114, v122
    v_and_b32 v125, 0xffff0000, v126
    v_add_u32 v123, v123, v123
    v_mul_f32 v124, v122, v124
    v_mul_f32 v125, v122, v125
    v_cmpx_le_u32 vcc, 0x1000000, v51
    ds_add_f32 v123, v124 offset:54272
    ds_add_f32 v123, v125 offset:54276
    s_mov_b64 exec, -1
    v_ashrrev_i32 v122, 5, v52
    v_lshlrev_b16 v123, 2, v52
    v_cndmask_b32 v126, v8, v9, s[66:67]
    v_bitop3_b32 v122, v122, v113, v113 bitop3:0x0c
    v_lshlrev_b32 v124, 16, v126
    v_mul_f32 v122, v114, v122
    v_and_b32 v125, 0xffff0000, v126
    v_add_u32 v123, v123, v123
    v_mul_f32 v124, v122, v124
    v_mul_f32 v125, v122, v125
    v_cmpx_le_u32 vcc, 0x1000000, v52
    ds_add_f32 v123, v124 offset:54272
    ds_add_f32 v123, v125 offset:54276
    s_mov_b64 exec, -1
    v_ashrrev_i32 v122, 5, v53
    v_lshlrev_b16 v123, 2, v53
    v_cndmask_b32 v126, v10, v11, s[66:67]
    v_bitop3_b32 v122, v122, v113, v113 bitop3:0x0c
    v_lshlrev_b32 v124, 16, v126
    v_mul_f32 v122, v114, v122
    v_and_b32 v125, 0xffff0000, v126
    v_add_u32 v123, v123, v123
    v_mul_f32 v124, v122, v124
    v_mul_f32 v125, v122, v125
    v_cmpx_le_u32 vcc, 0x1000000, v53
    ds_add_f32 v123, v124 offset:54272
    ds_add_f32 v123, v125 offset:54276
    s_mov_b64 exec, -1
    s_waitcnt lgkmcnt(15)
    v_ashrrev_i32 v122, 5, v54
    v_lshlrev_b16 v123, 2, v54
    v_cndmask_b32 v126, v12, v13, s[66:67]
    v_bitop3_b32 v122, v122, v113, v113 bitop3:0x0c
    v_lshlrev_b32 v124, 16, v126
    v_mul_f32 v122, v114, v122
    v_and_b32 v125, 0xffff0000, v126
    v_add_u32 v123, v123, v123
    v_mul_f32 v124, v122, v124
    v_mul_f32 v125, v122, v125
    v_cmpx_le_u32 vcc, 0x1000000, v54
    ds_add_f32 v123, v124 offset:54272
    ds_add_f32 v123, v125 offset:54276
    s_mov_b64 exec, -1
    v_ashrrev_i32 v122, 5, v55
    v_lshlrev_b16 v123, 2, v55
    v_cndmask_b32 v126, v14, v15, s[66:67]
    v_bitop3_b32 v122, v122, v113, v113 bitop3:0x0c
    v_lshlrev_b32 v124, 16, v126
    v_mul_f32 v122, v114, v122
    v_and_b32 v125, 0xffff0000, v126
    v_add_u32 v123, v123, v123
    v_mul_f32 v124, v122, v124
    v_mul_f32 v125, v122, v125
    v_cmpx_le_u32 vcc, 0x1000000, v55
    ds_add_f32 v123, v124 offset:54272
    ds_add_f32 v123, v125 offset:54276
    s_mov_b64 exec, -1
    v_ashrrev_i32 v122, 5, v56
    v_lshlrev_b16 v123, 2, v56
    v_cndmask_b32 v126, v16, v17, s[66:67]
    v_bitop3_b32 v122, v122, v113, v113 bitop3:0x0c
    v_lshlrev_b32 v124, 16, v126
    v_mul_f32 v122, v114, v122
    v_and_b32 v125, 0xffff0000, v126
    v_add_u32 v123, v123, v123
    v_mul_f32 v124, v122, v124
    v_mul_f32 v125, v122, v125
    v_cmpx_le_u32 vcc, 0x1000000, v56
    ds_add_f32 v123, v124 offset:54272
    ds_add_f32 v123, v125 offset:54276
    s_mov_b64 exec, -1
    s_cmp_lt_u32 s15, 8
    s_cbranch_scc1 p2_nad1
    s_waitcnt lgkmcnt(15)
    v_ashrrev_i32 v122, 5, v57
    v_lshlrev_b16 v123, 2, v57
    v_cndmask_b32 v126, v18, v19, s[66:67]
    v_bitop3_b32 v122, v122, v113, v113 bitop3:0x0c
    v_lshlrev_b32 v124, 16, v126
    v_mul_f32 v122, v114, v122
    v_and_b32 v125, 0xffff0000, v126
    v_add_u32 v123, v123, v123
    v_mul_f32 v124, v122, v124
    v_mul_f32 v125, v122, v125
    v_cmpx_le_u32 vcc, 0x1000000, v57
    ds_add_f32 v123, v124 offset:54272
    ds_add_f32 v123, v125 offset:54276
    s_mov_b64 exec, -1
    v_ashrrev_i32 v122, 5, v58
    v_lshlrev_b16 v123, 2, v58
    v_cndmask_b32 v126, v20, v21, s[66:67]
    v_bitop3_b32 v122, v122, v113, v113 bitop3:0x0c
    v_lshlrev_b32 v124, 16, v126
    v_mul_f32 v122, v114, v122
    v_and_b32 v125, 0xffff0000, v126
    v_add_u32 v123, v123, v123
    v_mul_f32 v124, v122, v124
    v_mul_f32 v125, v122, v125
    v_cmpx_le_u32 vcc, 0x1000000, v58
    ds_add_f32 v123, v124 offset:54272
    ds_add_f32 v123, v125 offset:54276
    s_mov_b64 exec, -1
    v_ashrrev_i32 v122, 5, v59
    v_lshlrev_b16 v123, 2, v59
    v_cndmask_b32 v126, v22, v23, s[66:67]
    v_bitop3_b32 v122, v122, v113, v113 bitop3:0x0c
    v_lshlrev_b32 v124, 16, v126
    v_mul_f32 v122, v114, v122
    v_and_b32 v125, 0xffff0000, v126
    v_add_u32 v123, v123, v123
    v_mul_f32 v124, v122, v124
    v_mul_f32 v125, v122, v125
    v_cmpx_le_u32 vcc, 0x1000000, v59
    ds_add_f32 v123, v124 offset:54272
    ds_add_f32 v123, v125 offset:54276
    s_mov_b64 exec, -1
p2_nad1:
    s_waitcnt lgkmcnt(15)
    v_ashrrev_i32 v122, 5, v60
    v_lshlrev_b16 v123, 2, v60
    v_cndmask_b32 v126, v24, v25, s[66:67]
    v_bitop3_b32 v122, v122, v113, v113 bitop3:0x0c
    v_lshlrev_b32 v124, 16, v126
    v_mul_f32 v122, v114, v122
    v_and_b32 v125, 0xffff0000, v126
    v_add_u32 v123, v123, v123
    v_mul_f32 v124, v122, v124
    v_mul_f32 v125, v122, v125
    v_cmpx_le_u32 vcc, 0x1000000, v60
    ds_add_f32 v123, v124 offset:54272
    ds_add_f32 v123, v125 offset:54276
    s_mov_b64 exec, -1
    v_ashrrev_i32 v122, 5, v61
    v_lshlrev_b16 v123, 2, v61
    v_cndmask_b32 v126, v26, v27, s[66:67]
    v_bitop3_b32 v122, v122, v113, v113 bitop3:0x0c
    v_lshlrev_b32 v124, 16, v126
    v_mul_f32 v122, v114, v122
    v_and_b32 v125, 0xffff0000, v126
    v_add_u32 v123, v123, v123
    v_mul_f32 v124, v122, v124
    v_mul_f32 v125, v122, v125
    v_cmpx_le_u32 vcc, 0x1000000, v61
    ds_add_f32 v123, v124 offset:54272
    ds_add_f32 v123, v125 offset:54276
    s_mov_b64 exec, -1
    v_ashrrev_i32 v122, 5, v62
    v_lshlrev_b16 v123, 2, v62
    v_cndmask_b32 v126, v28, v29, s[66:67]
    v_bitop3_b32 v122, v122, v113, v113 bitop3:0x0c
    v_lshlrev_b32 v124, 16, v126
    v_mul_f32 v122, v114, v122
    v_and_b32 v125, 0xffff0000, v126
    v_add_u32 v123, v123, v123
    v_mul_f32 v124, v122, v124
    v_mul_f32 v125, v122, v125
    v_cmpx_le_u32 vcc, 0x1000000, v62
    ds_add_f32 v123, v124 offset:54272
    ds_add_f32 v123, v125 offset:54276
    s_mov_b64 exec, -1
    s_waitcnt lgkmcnt(15)
    v_ashrrev_i32 v122, 5, v63
    v_lshlrev_b16 v123, 2, v63
    v_cndmask_b32 v126, v30, v31, s[66:67]
    v_bitop3_b32 v122, v122, v113, v113 bitop3:0x0c
    v_lshlrev_b32 v124, 16, v126
    v_mul_f32 v122, v114, v122
    v_and_b32 v125, 0xffff0000, v126
    v_add_u32 v123, v123, v123
    v_mul_f32 v124, v122, v124
    v_mul_f32 v125, v122, v125
    v_cmpx_le_u32 vcc, 0x1000000, v63
    ds_add_f32 v123, v124 offset:54272
    ds_add_f32 v123, v125 offset:54276
    s_mov_b64 exec, -1
    v_ashrrev_i32 v122, 5, v64
    v_lshlrev_b16 v123, 2, v64
    v_cndmask_b32 v126, v32, v33, s[66:67]
    v_bitop3_b32 v122, v122, v113, v113 bitop3:0x0c
    v_lshlrev_b32 v124, 16, v126
    v_mul_f32 v122, v114, v122
    v_and_b32 v125, 0xffff0000, v126
    v_add_u32 v123, v123, v123
    v_mul_f32 v124, v122, v124
    v_mul_f32 v125, v122, v125
    v_cmpx_le_u32 vcc, 0x1000000, v64
    ds_add_f32 v123, v124 offset:54272
    ds_add_f32 v123, v125 offset:54276
    s_mov_b64 exec, -1
    v_ashrrev_i32 v122, 5, v65
    v_lshlrev_b16 v123, 2, v65
    v_cndmask_b32 v126, v34, v35, s[66:67]
    v_bitop3_b32 v122, v122, v113, v113 bitop3:0x0c
    v_lshlrev_b32 v124, 16, v126
    v_mul_f32 v122, v114, v122
    v_and_b32 v125, 0xffff0000, v126
    v_add_u32 v123, v123, v123
    v_mul_f32 v124, v122, v124
    v_mul_f32 v125, v122, v125
    v_cmpx_le_u32 vcc, 0x1000000, v65
    ds_add_f32 v123, v124 offset:54272
    ds_add_f32 v123, v125 offset:54276
    s_mov_b64 exec, -1
    s_waitcnt lgkmcnt(15)
    v_ashrrev_i32 v122, 5, v66
    v_lshlrev_b16 v123, 2, v66
    v_cndmask_b32 v126, v36, v37, s[66:67]
    v_bitop3_b32 v122, v122, v113, v113 bitop3:0x0c
    v_lshlrev_b32 v124, 16, v126
    v_mul_f32 v122, v114, v122
    v_and_b32 v125, 0xffff0000, v126
    v_add_u32 v123, v123, v123
    v_mul_f32 v124, v122, v124
    v_mul_f32 v125, v122, v125
    v_cmpx_le_u32 vcc, 0x1000000, v66
    ds_add_f32 v123, v124 offset:54272
    ds_add_f32 v123, v125 offset:54276
    s_mov_b64 exec, -1
    v_ashrrev_i32 v122, 5, v67
    v_lshlrev_b16 v123, 2, v67
    v_cndmask_b32 v126, v38, v39, s[66:67]
    v_bitop3_b32 v122, v122, v113, v113 bitop3:0x0c
    v_lshlrev_b32 v124, 16, v126
    v_mul_f32 v122, v114, v122
    v_and_b32 v125, 0xffff0000, v126
    v_add_u32 v123, v123, v123
    v_mul_f32 v124, v122, v124
    v_mul_f32 v125, v122, v125
    v_cmpx_le_u32 vcc, 0x1000000, v67
    ds_add_f32 v123, v124 offset:54272
    ds_add_f32 v123, v125 offset:54276
    s_mov_b64 exec, -1
    v_ashrrev_i32 v122, 5, v68
    v_lshlrev_b16 v123, 2, v68
    v_cndmask_b32 v126, v40, v41, s[66:67]
    v_bitop3_b32 v122, v122, v113, v113 bitop3:0x0c
    v_lshlrev_b32 v124, 16, v126
    v_mul_f32 v122, v114, v122
    v_and_b32 v125, 0xffff0000, v126
    v_add_u32 v123, v123, v123
    v_mul_f32 v124, v122, v124
    v_mul_f32 v125, v122, v125
    v_cmpx_le_u32 vcc, 0x1000000, v68
    ds_add_f32 v123, v124 offset:54272
    ds_add_f32 v123, v125 offset:54276
    s_mov_b64 exec, -1
    s_waitcnt lgkmcnt(15)
    v_ashrrev_i32 v122, 5, v69
    v_lshlrev_b16 v123, 2, v69
    v_cndmask_b32 v126, v42, v43, s[66:67]
    v_bitop3_b32 v122, v122, v113, v113 bitop3:0x0c
    v_lshlrev_b32 v124, 16, v126
    v_mul_f32 v122, v114, v122
    v_and_b32 v125, 0xffff0000, v126
    v_add_u32 v123, v123, v123
    v_mul_f32 v124, v122, v124
    v_mul_f32 v125, v122, v125
    v_cmpx_le_u32 vcc, 0x1000000, v69
    ds_add_f32 v123, v124 offset:54272
    ds_add_f32 v123, v125 offset:54276
    s_mov_b64 exec, -1
    v_ashrrev_i32 v122, 5, v70
    v_lshlrev_b16 v123, 2, v70
    v_cndmask_b32 v126, v44, v45, s[66:67]
    v_bitop3_b32 v122, v122, v113, v113 bitop3:0x0c
    v_lshlrev_b32 v124, 16, v126
    v_mul_f32 v122, v114, v122
    v_and_b32 v125, 0xffff0000, v126
    v_add_u32 v123, v123, v123
    v_mul_f32 v124, v122, v124
    v_mul_f32 v125, v122, v125
    v_cmpx_le_u32 vcc, 0x1000000, v70
    ds_add_f32 v123, v124 offset:54272
    ds_add_f32 v123, v125 offset:54276
    s_mov_b64 exec, -1
    v_ashrrev_i32 v122, 5, v71
    v_lshlrev_b16 v123, 2, v71
    v_cndmask_b32 v126, v46, v47, s[66:67]
    v_bitop3_b32 v122, v122, v113, v113 bitop3:0x0c
    v_lshlrev_b32 v124, 16, v126
    v_mul_f32 v122, v114, v122
    v_and_b32 v125, 0xffff0000, v126
    v_add_u32 v123, v123, v123
    v_mul_f32 v124, v122, v124
    v_mul_f32 v125, v122, v125
    v_cmpx_le_u32 vcc, 0x1000000, v71
    ds_add_f32 v123, v124 offset:54272
    ds_add_f32 v123, v125 offset:54276
    s_mov_b64 exec, -1
    s_branch p2_fin
p2_tail:
    s_mov_b32 s60, s61
    s_mov_b32 s15, s16
    s_mov_b32 s16, s17
    v_mov_b32 v122, s19
    s_xor_b32 s19, s19, 4
    ds_read_b32 v125, v122 offset:53760
    v_mov_b32 v123, s19
    v_mov_b32 v124, 0
    ds_write_b32 v123, v124 offset:53760
    s_waitcnt vmcnt(2)
    s_mov_b32 m0, s24
    s_cmp_ge_u32 s10, 9
    s_cbranch_scc1 p2_st2s1
    ds_write_addtid_b32 v84 offset:49152
    ds_write_addtid_b32 v85 offset:49408
p2_st2s1:
    s_mov_b32 m0, s23
    s_add_u32 s20, s20, 53760
    ds_write_addtid_b32 v72 offset:0
    ds_write_addtid_b32 v73 offset:256
    ds_write_addtid_b32 v74 offset:512
    ds_write_addtid_b32 v75 offset:768
    ds_write_addtid_b32 v76 offset:1024
    ds_write_addtid_b32 v77 offset:1280
    ds_write_addtid_b32 v78 offset:1536
    ds_write_addtid_b32 v79 offset:1792
    ds_write_addtid_b32 v80 offset:2048
    ds_write_addtid_b32 v81 offset:2304
    ds_write_addtid_b32 v82 offset:2560
    ds_write_addtid_b32 v83 offset:2816
    s_cmp_ge_u32 s10, 9
    s_cbranch_scc1 p2_nm2m2a
    v_lshrrev_b32 v84, 1, v112
    s_add_u32 s44, s20, s42
    buffer_load_dwordx2 v[84:85], v84, s[4:7], s44 offen
p2_nm2m2a:
    buffer_load_dwordx4 v[72:75], v112, s[4:7], s20 offen offset:0
    buffer_load_dwordx4 v[76:79], v112, s[4:7], s20 offen offset:1024
    buffer_load_dwordx4 v[80:83], v112, s[4:7], s20 offen offset:2048
    s_waitcnt lgkmcnt(0)
    s_barrier
    s_setprio 3
    v_cmpx_lt_i16 vcc, 0x3fff, v48
    ds_read_b64 v[0:1], v0
    s_mov_b64 exec, -1
    v_cmpx_lt_i16 vcc, 0x3fff, v49
    ds_read_b64 v[2:3], v2
    s_mov_b64 exec, -1
    v_cmpx_lt_i16 vcc, 0x3fff, v50
    ds_read_b64 v[4:5], v4
    s_mov_b64 exec, -1
    v_cmpx_lt_i16 vcc, 0x3fff, v51
    ds_read_b64 v[6:7], v6
    s_mov_b64 exec, -1
    v_cmpx_lt_i16 vcc, 0x3fff, v52
    ds_read_b64 v[8:9], v8
    s_mov_b64 exec, -1
    v_cmpx_lt_i16 vcc, 0x3fff, v53
    ds_read_b64 v[10:11], v10
    s_mov_b64 exec, -1
    s_waitcnt lgkmcnt(15)
    s_nop 1
    v_readfirstlane_b32 s44, v125
    s_nop 0
    s_cmp_lg_u32 s44, 0
    s_cbranch_scc1 p2_advb
    s_add_u32 s61, s61, 1
    s_min_u32 s61, s61, 10
    v_mov_b32 v110, 0
    v_mov_b32 v111, 0
    s_cmp_eq_u32 s61, 10
    s_cbranch_scc1 p2_advb
    s_add_u32 s44, s61, s18
    s_cmp_ge_u32 s44, 10
    s_cselect_b32 s53, 10, 0
    s_sub_u32 s44, s44, s53
    s_mul_i32 s44, s44, 4160
    s_add_u32 s44, s44, s40
    v_bfe_i32 v111, v112, 6, 1
    v_lshrrev_b32 v110, 6, v112
    v_bitop3_b32 v111, v111, 15, s10 bitop3:0x6a
    v_lshl_or_b32 v110, v110, 4, v111
    v_add_u32 v111, 72, v110
    v_and_b32 v111, 0x100, v111
    v_lshl_or_b32 v110, v111, 7, v110
    v_bfe_u32 v111, v112, 2, 4
    v_mul_u32_u24 v110, 41600, v110
    v_add_u32 v111, v110, v111
    buffer_load_dword v110, v111, s[4:7], s44 offen
    buffer_load_dword v111, v111, s[4:7], s44 offen offset:16
p2_advb:
    s_cmp_lg_u32 s10, 15
    s_cbranch_scc1 p2_ntg
    s_lshr_b32 s44, s2, 3
    s_mul_i32 s44, s44, 5120
    s_add_u32 s45, s60, s18
    s_cmp_ge_u32 s45, 10
    s_cselect_b32 s53, 10, 0
    s_sub_u32 s45, s45, s53
    s_mul_i32 s45, s45, 645120
    s_add_u32 s44, s44, s45
    s_add_u32 s44, s44, s62
    s_sub_u32 s44, s44, s23
    v_lshlrev_b32 v84, 3, v112
    s_mov_b32 exec_hi, 0xff
    buffer_load_dword v85, v84, s[4:7], s44 offen
    s_mov_b64 exec, -1
p2_ntg:
    v_cmpx_lt_i16 vcc, 0x3fff, v54
    ds_read_b64 v[12:13], v12
    s_mov_b64 exec, -1
    v_cmpx_lt_i16 vcc, 0x3fff, v55
    ds_read_b64 v[14:15], v14
    s_mov_b64 exec, -1
    v_cmpx_lt_i16 vcc, 0x3fff, v56
    ds_read_b64 v[16:17], v16
    s_mov_b64 exec, -1
    s_cmp_lt_u32 s15, 8
    s_cbranch_scc1 p2_g2r13
    v_cmpx_lt_i16 vcc, 0x3fff, v57
    ds_read_b64 v[18:19], v18
    s_mov_b64 exec, -1
    v_cmpx_lt_i16 vcc, 0x3fff, v58
    ds_read_b64 v[20:21], v20
    s_mov_b64 exec, -1
    v_cmpx_lt_i16 vcc, 0x3fff, v59
    ds_read_b64 v[22:23], v22
    s_mov_b64 exec, -1
p2_g2r13:
    v_bfe_u32 v98, v109, 14, 4
    v_lshrrev_b32 v99, 18, v109
    v_and_b32 v109, 0x3fff, v109
    v_mad_u32_u24 v98, v98, s63, v99
    v_mad_u32_u24 v109, v98, s65, v109
    buffer_load_dwordx4 v[98:101], v109, s[68:71], 0 offen
    s_setprio 1
    v_cmpx_lt_i16 vcc, 0x3fff, v60
    ds_read_b64 v[24:25], v24
    s_mov_b64 exec, -1
    v_cmpx_lt_i16 vcc, 0x3fff, v61
    ds_read_b64 v[26:27], v26
    s_mov_b64 exec, -1
    v_cmpx_lt_i16 vcc, 0x3fff, v62
    ds_read_b64 v[28:29], v28
    s_mov_b64 exec, -1
    v_cmpx_lt_i16 vcc, 0x3fff, v63
    ds_read_b64 v[30:31], v30
    s_mov_b64 exec, -1
    v_cmpx_lt_i16 vcc, 0x3fff, v64
    ds_read_b64 v[32:33], v32
    s_mov_b64 exec, -1
    v_cmpx_lt_i16 vcc, 0x3fff, v65
    ds_read_b64 v[34:35], v34
    s_mov_b64 exec, -1
    s_nop 2
    s_nop 1
    v_max_u32_dpp v102, v102, v102 row_shr:1 row_mask:0xf bank_mask:0xf bound_ctrl:0
    v_max_u32_dpp v103, v103, v103 row_shr:1 row_mask:0xf bank_mask:0xf bound_ctrl:0
    s_nop 0
    v_max_u32_dpp v102, v102, v102 row_shr:2 row_mask:0xf bank_mask:0xf bound_ctrl:0
    v_max_u32_dpp v103, v103, v103 row_shr:2 row_mask:0xf bank_mask:0xf bound_ctrl:0
    s_nop 0
    v_max_u32_dpp v102, v102, v102 row_shr:4 row_mask:0xf bank_mask:0xf bound_ctrl:0
    v_max_u32_dpp v103, v103, v103 row_shr:4 row_mask:0xf bank_mask:0xf bound_ctrl:0
    s_nop 0
    v_max_u32_dpp v102, v102, v102 row_shr:8 row_mask:0xf bank_mask:0xf bound_ctrl:0
    v_max_u32_dpp v103, v103, v103 row_shr:8 row_mask:0xf bank_mask:0xf bound_ctrl:0
    s_nop 0
    v_max_u32_dpp v102, v102, v102 row_bcast:15 row_mask:0xa bank_mask:0xf
    v_max_u32_dpp v103, v103, v103 row_bcast:15 row_mask:0xa bank_mask:0xf
    s_nop 0
    v_max_u32_dpp v102, v102, v102 row_bcast:31 row_mask:0xc bank_mask:0xf
    v_max_u32_dpp v103, v103, v103 row_bcast:31 row_mask:0xc bank_mask:0xf
    s_nop 0
    s_nop 0
    v_max_u32 v102, s41, v102
    s_nop 0
    v_readlane_b32 s41, v102, 63
    v_add_u32 v102, v102, v112
    v_add_u32 v102, 4294963200, v102
    v_max_u32 v103, s41, v103
    s_nop 0
    v_readlane_b32 s41, v103, 63
    v_add_u32 v103, v103, v112
    v_add_u32 v103, 4294964224, v103
    v_cmpx_lt_i16 vcc, 0x3fff, v66
    ds_read_b64 v[36:37], v36
    s_mov_b64 exec, -1
    v_cmpx_lt_i16 vcc, 0x3fff, v67
    ds_read_b64 v[38:39], v38
    s_mov_b64 exec, -1
    v_cmpx_lt_i16 vcc, 0x3fff, v68
    ds_read_b64 v[40:41], v40
    s_mov_b64 exec, -1
    v_cmpx_lt_i16 vcc, 0x3fff, v69
    ds_read_b64 v[42:43], v42
    s_mov_b64 exec, -1
    v_cmpx_lt_i16 vcc, 0x3fff, v70
    ds_read_b64 v[44:45], v44
    s_mov_b64 exec, -1
    v_cmpx_lt_i16 vcc, 0x3fff, v71
    ds_read_b64 v[46:47], v46
    s_mov_b64 exec, -1
    s_waitcnt lgkmcnt(0)
    s_barrier
    s_waitcnt vmcnt(1)
    s_mov_b32 m0, s24
    s_cmp_ge_u32 s10, 9
    s_cbranch_scc1 p2_st2s2
    ds_write_addtid_b32 v84 offset:49152
    ds_write_addtid_b32 v85 offset:49408
p2_st2s2:
    s_mov_b32 m0, s23
    s_add_u32 s20, s60, s18
    s_cmp_ge_u32 s20, 10
    s_cselect_b32 s53, 10, 0
    s_sub_u32 s20, s20, s53
    s_mul_i32 s20, s20, 645120
    s_add_u32 s20, s20, s62
    ds_write_addtid_b32 v72 offset:0
    ds_write_addtid_b32 v73 offset:256
    ds_write_addtid_b32 v74 offset:512
    ds_write_addtid_b32 v75 offset:768
    ds_write_addtid_b32 v76 offset:1024
    ds_write_addtid_b32 v77 offset:1280
    ds_write_addtid_b32 v78 offset:1536
    ds_write_addtid_b32 v79 offset:1792
    ds_write_addtid_b32 v80 offset:2048
    ds_write_addtid_b32 v81 offset:2304
    ds_write_addtid_b32 v82 offset:2560
    ds_write_addtid_b32 v83 offset:2816
    s_nop 2
    s_nop 1
    v_max_u32_dpp v104, v104, v104 row_shr:1 row_mask:0xf bank_mask:0xf bound_ctrl:0
    v_max_u32_dpp v105, v105, v105 row_shr:1 row_mask:0xf bank_mask:0xf bound_ctrl:0
    s_nop 0
    v_max_u32_dpp v104, v104, v104 row_shr:2 row_mask:0xf bank_mask:0xf bound_ctrl:0
    v_max_u32_dpp v105, v105, v105 row_shr:2 row_mask:0xf bank_mask:0xf bound_ctrl:0
    s_nop 0
    v_max_u32_dpp v104, v104, v104 row_shr:4 row_mask:0xf bank_mask:0xf bound_ctrl:0
    v_max_u32_dpp v105, v105, v105 row_shr:4 row_mask:0xf bank_mask:0xf bound_ctrl:0
    s_nop 0
    v_max_u32_dpp v104, v104, v104 row_shr:8 row_mask:0xf bank_mask:0xf bound_ctrl:0
    v_max_u32_dpp v105, v105, v105 row_shr:8 row_mask:0xf bank_mask:0xf bound_ctrl:0
    s_nop 0
    v_max_u32_dpp v104, v104, v104 row_bcast:15 row_mask:0xa bank_mask:0xf
    v_max_u32_dpp v105, v105, v105 row_bcast:15 row_mask:0xa bank_mask:0xf
    s_nop 0
    v_max_u32_dpp v104, v104, v104 row_bcast:31 row_mask:0xc bank_mask:0xf
    v_max_u32_dpp v105, v105, v105 row_bcast:31 row_mask:0xc bank_mask:0xf
    s_nop 0
    s_nop 0
    v_max_u32 v104, s41, v104
    s_nop 0
    v_readlane_b32 s41, v104, 63
    v_add_u32 v104, v104, v112
    v_add_u32 v104, 4294965248, v104
    v_max_u32 v105, s41, v105
    s_nop 0
    v_readlane_b32 s41, v105, 63
    v_add_u32 v105, v105, v112
    v_add_u32 v105, 4294966272, v105
    s_waitcnt lgkmcnt(0)
    s_barrier
    s_branch p2_top
p2_fin:
    s_waitcnt vmcnt(0) lgkmcnt(0)
    s_barrier
    s_mov_b32 s48, s11
    s_mul_i32 s44, s48, 800768
    s_mul_i32 s45, s12, 12512
    s_add_u32 s49, s44, s45
    s_lshl_b32 s44, s49, 3
    s_add_u32 s44, s44, 491610112
    s_lshl_b32 s48, s48, 2
    s_lshl_b32 s45, s12, 4
    s_add_u32 s48, s48, s45
    s_add_u32 s48, s48, 491609088
    v_add_u32 v123, s64, v112
    v_add_u32 v122, s25, v123
    v_mov_b32 v24, 0
    v_mov_b32 v25, 0
    v_mov_b32 v26, 0
    v_mov_b32 v27, 0
    v_cmp_gt_u32 vcc, 1792, v123
    v_mov_b32 v124, 0x38000000
    v_mov_b32 v126, 0
    v_cndmask_b32 v124, v124, v123, vcc
    ds_read_b128 v[0:3], v122 offset:0
    ds_read_b128 v[4:7], v122 offset:16384
    ds_read_b128 v[8:11], v122 offset:32768
    v_add_u32 v122, 49152, v122
    ds_read_b128 v[12:15], v122 offset:0
    ds_read_b128 v[16:19], v122 offset:16384
    ds_read_b128 v[20:23], v122 offset:32768
    s_mov_b64 exec, vcc
    ds_read_b128 v[24:27], v122 offset:49152
    s_mov_b64 exec, -1
    s_cmp_lg_u32 s21, 0
    s_cbranch_scc1 p2_finf
    s_waitcnt lgkmcnt(6)
    buffer_store_dwordx4 v[0:3], v123, s[4:7], s44 offen nt
    s_add_u32 s44, s44, 16384
    s_waitcnt lgkmcnt(5)
    buffer_store_dwordx4 v[4:7], v123, s[4:7], s44 offen nt
    s_add_u32 s44, s44, 16384
    s_waitcnt lgkmcnt(4)
    buffer_store_dwordx4 v[8:11], v123, s[4:7], s44 offen nt
    s_add_u32 s44, s44, 16384
    s_waitcnt lgkmcnt(3)
    buffer_store_dwordx4 v[12:15], v123, s[4:7], s44 offen nt
    s_add_u32 s44, s44, 16384
    s_waitcnt lgkmcnt(2)
    buffer_store_dwordx4 v[16:19], v123, s[4:7], s44 offen nt
    s_add_u32 s44, s44, 16384
    s_waitcnt lgkmcnt(1)
    buffer_store_dwordx4 v[20:23], v123, s[4:7], s44 offen nt
    s_add_u32 s44, s44, 16384
    s_waitcnt lgkmcnt(0)
    buffer_store_dwordx4 v[24:27], v124, s[4:7], s44 offen nt
    s_add_u32 s44, s44, 16384
    v_bitop3_b32 v115, v115, v0, v1 bitop3:0xfe
    v_bitop3_b32 v115, v115, v2, v3 bitop3:0xfe
    v_bitop3_b32 v115, v115, v4, v5 bitop3:0xfe
    v_bitop3_b32 v115, v115, v6, v7 bitop3:0xfe
    v_bitop3_b32 v115, v115, v8, v9 bitop3:0xfe
    v_bitop3_b32 v115, v115, v10, v11 bitop3:0xfe
    v_bitop3_b32 v115, v115, v12, v13 bitop3:0xfe
    v_bitop3_b32 v115, v115, v14, v15 bitop3:0xfe
    v_bitop3_b32 v115, v115, v16, v17 bitop3:0xfe
    v_bitop3_b32 v115, v115, v18, v19 bitop3:0xfe
    v_bitop3_b32 v115, v115, v20, v21 bitop3:0xfe
    v_bitop3_b32 v115, v115, v22, v23 bitop3:0xfe
    v_bitop3_b32 v115, v115, v24, v25 bitop3:0xfe
    v_bitop3_b32 v115, v115, v26, v27 bitop3:0xfe
    v_bitop3_b32 v115, v115, v116, v117 bitop3:0xfe
    v_bitop3_b32 v115, v115, v118, v119 bitop3:0xfe
    v_bitop3_b32 v115, v115, v120, v121 bitop3:0xfe
    v_mov_b32 v28, 0
    v_mov_b32 v29, 0
    v_lshrrev_b32 v30, 1, v0
    v_bitop3_b32 v28, v28, v0, v30 bitop3:0xf6
    v_lshrrev_b32 v31, 1, v1
    v_bitop3_b32 v29, v29, v1, v31 bitop3:0xf6
    v_lshrrev_b32 v30, 1, v2
    v_bitop3_b32 v28, v28, v2, v30 bitop3:0xf6
    v_lshrrev_b32 v31, 1, v3
    v_bitop3_b32 v29, v29, v3, v31 bitop3:0xf6
    v_lshrrev_b32 v30, 1, v4
    v_bitop3_b32 v28, v28, v4, v30 bitop3:0xf6
    v_lshrrev_b32 v31, 1, v5
    v_bitop3_b32 v29, v29, v5, v31 bitop3:0xf6
    v_lshrrev_b32 v30, 1, v6
    v_bitop3_b32 v28, v28, v6, v30 bitop3:0xf6
    v_lshrrev_b32 v31, 1, v7
    v_bitop3_b32 v29, v29, v7, v31 bitop3:0xf6
    v_lshrrev_b32 v30, 1, v8
    v_bitop3_b32 v28, v28, v8, v30 bitop3:0xf6
    v_lshrrev_b32 v31, 1, v9
    v_bitop3_b32 v29, v29, v9, v31 bitop3:0xf6
    v_lshrrev_b32 v30, 1, v10
    v_bitop3_b32 v28, v28, v10, v30 bitop3:0xf6
    v_lshrrev_b32 v31, 1, v11
    v_bitop3_b32 v29, v29, v11, v31 bitop3:0xf6
    v_lshrrev_b32 v30, 1, v12
    v_bitop3_b32 v28, v28, v12, v30 bitop3:0xf6
    v_lshrrev_b32 v31, 1, v13
    v_bitop3_b32 v29, v29, v13, v31 bitop3:0xf6
    v_lshrrev_b32 v30, 1, v14
    v_bitop3_b32 v28, v28, v14, v30 bitop3:0xf6
    v_lshrrev_b32 v31, 1, v15
    v_bitop3_b32 v29, v29, v15, v31 bitop3:0xf6
    v_lshrrev_b32 v30, 1, v16
    v_bitop3_b32 v28, v28, v16, v30 bitop3:0xf6
    v_lshrrev_b32 v31, 1, v17
    v_bitop3_b32 v29, v29, v17, v31 bitop3:0xf6
    v_lshrrev_b32 v30, 1, v18
    v_bitop3_b32 v28, v28, v18, v30 bitop3:0xf6
    v_lshrrev_b32 v31, 1, v19
    v_bitop3_b32 v29, v29, v19, v31 bitop3:0xf6
    v_lshrrev_b32 v30, 1, v20
    v_bitop3_b32 v28, v28, v20, v30 bitop3:0xf6
    v_lshrrev_b32 v31, 1, v21
    v_bitop3_b32 v29, v29, v21, v31 bitop3:0xf6
    v_lshrrev_b32 v30, 1, v22
    v_bitop3_b32 v28, v28, v22, v30 bitop3:0xf6
    v_lshrrev_b32 v31, 1, v23
    v_bitop3_b32 v29, v29, v23, v31 bitop3:0xf6
    v_lshrrev_b32 v30, 1, v24
    v_bitop3_b32 v28, v28, v24, v30 bitop3:0xf6
    v_lshrrev_b32 v31, 1, v25
    v_bitop3_b32 v29, v29, v25, v31 bitop3:0xf6
    v_lshrrev_b32 v30, 1, v26
    v_bitop3_b32 v28, v28, v26, v30 bitop3:0xf6
    v_lshrrev_b32 v31, 1, v27
    v_bitop3_b32 v29, v29, v27, v31 bitop3:0xf6
    s_mov_b32 s45, 0
    v_and_b32 v30, 7168, v28
    v_cmp_ne_u32 vcc, 0, v30
    s_nop 0
    s_cmp_lg_u64 vcc, 0
    s_cselect_b32 s46, 1, 0
    s_or_b32 s45, s45, s46
    v_and_b32 v30, 469762048, v28
    v_cmp_ne_u32 vcc, 0, v30
    s_nop 0
    s_cmp_lg_u64 vcc, 0
    s_cselect_b32 s46, 2, 0
    s_or_b32 s45, s45, s46
    v_and_b32 v30, 7168, v29
    v_cmp_ne_u32 vcc, 0, v30
    s_nop 0
    s_cmp_lg_u64 vcc, 0
    s_cselect_b32 s46, 4, 0
    s_or_b32 s45, s45, s46
    v_and_b32 v30, 469762048, v29
    v_cmp_ne_u32 vcc, 0, v30
    s_nop 0
    s_cmp_lg_u64 vcc, 0
    s_cselect_b32 s46, 8, 0
    s_or_b32 s45, s45, s46
    v_and_b32 v30, 2147516416, v115
    v_cmp_ne_u32 vcc, 0, v30
    s_nop 0
    s_cmp_lg_u64 vcc, 0
    s_cselect_b32 s46, 16, 0
    s_or_b32 s45, s45, s46
    v_mov_b32 v30, s45
    s_mov_b64 exec, 1
    ds_or_b32 v126, v30 offset:53768
    s_mov_b64 exec, -1
    s_waitcnt lgkmcnt(0)
    s_barrier
    ds_read_b32 v125, v126 offset:53768
    s_waitcnt lgkmcnt(0)
    v_readfirstlane_b32 s45, v125
    s_nop 0
    s_cmp_eq_u32 s45, 15
    s_cbranch_scc1 p2_done
    s_mov_b32 s21, 1
    s_waitcnt vmcnt(0)
    s_branch p2_restart
p2_finf:
    s_lshl_b32 s49, s49, 4
    s_lshl_b32 s45, s21, 3
    s_add_u32 s49, s49, s45
    s_add_u32 s49, s49, 517234680
    v_mov_b32 v28, 1073758208
    v_mov_b32 v29, 1073758208
    v_mov_b32 v30, 1073758208
    v_mov_b32 v31, 1073758208
    v_lshlrev_b32 v122, 1, v123
    v_lshlrev_b32 v125, 1, v124
    s_waitcnt lgkmcnt(0)
    buffer_store_dwordx4 v[28:31], v123, s[4:7], s44 offen
    s_add_u32 s44, s44, 16384
    buffer_store_dwordx2 v[0:1], v122, s[4:7], s49 offen offset:0
    buffer_store_dwordx2 v[2:3], v122, s[4:7], s49 offen offset:16
    s_add_u32 s49, s49, 32768
    buffer_store_dwordx4 v[28:31], v123, s[4:7], s44 offen
    s_add_u32 s44, s44, 16384
    buffer_store_dwordx2 v[4:5], v122, s[4:7], s49 offen offset:0
    buffer_store_dwordx2 v[6:7], v122, s[4:7], s49 offen offset:16
    s_add_u32 s49, s49, 32768
    buffer_store_dwordx4 v[28:31], v123, s[4:7], s44 offen
    s_add_u32 s44, s44, 16384
    buffer_store_dwordx2 v[8:9], v122, s[4:7], s49 offen offset:0
    buffer_store_dwordx2 v[10:11], v122, s[4:7], s49 offen offset:16
    s_add_u32 s49, s49, 32768
    buffer_store_dwordx4 v[28:31], v123, s[4:7], s44 offen
    s_add_u32 s44, s44, 16384
    buffer_store_dwordx2 v[12:13], v122, s[4:7], s49 offen offset:0
    buffer_store_dwordx2 v[14:15], v122, s[4:7], s49 offen offset:16
    s_add_u32 s49, s49, 32768
    buffer_store_dwordx4 v[28:31], v123, s[4:7], s44 offen
    s_add_u32 s44, s44, 16384
    buffer_store_dwordx2 v[16:17], v122, s[4:7], s49 offen offset:0
    buffer_store_dwordx2 v[18:19], v122, s[4:7], s49 offen offset:16
    s_add_u32 s49, s49, 32768
    buffer_store_dwordx4 v[28:31], v123, s[4:7], s44 offen
    s_add_u32 s44, s44, 16384
    buffer_store_dwordx2 v[20:21], v122, s[4:7], s49 offen offset:0
    buffer_store_dwordx2 v[22:23], v122, s[4:7], s49 offen offset:16
    s_add_u32 s49, s49, 32768
    buffer_store_dwordx4 v[28:31], v124, s[4:7], s44 offen
    s_add_u32 s44, s44, 16384
    buffer_store_dwordx2 v[24:25], v125, s[4:7], s49 offen offset:0
    buffer_store_dwordx2 v[26:27], v125, s[4:7], s49 offen offset:16
    s_add_u32 s49, s49, 32768
    s_add_u32 s21, s21, 1
    s_mov_b32 s30, 0
    s_waitcnt vmcnt(0)
    s_cmp_eq_u32 s21, 2
    s_cbranch_scc1 p2_restart
p2_done:
    v_mov_b32 v125, s30
    buffer_store_dword v125, v126, s[4:7], s48 offen
p2_end:
    s_endpgm
.globl p3_kernel
.p2align 8
.type p3_kernel,@function
p3_kernel:
    s_cmp_ge_u32 s2, 1563
    s_cbranch_scc1 p3_end
    s_load_dwordx2 s[4:5], s[0:1], 0
    s_load_dwordx2 s[6:7], s[0:1], 24
    s_load_dwordx2 s[8:9], s[0:1], 40
    s_load_dwordx8 s[12:19], s[0:1], 56
    s_load_dwordx2 s[10:11], s[0:1], 88
    s_load_dwordx2 s[20:21], s[0:1], 104
    s_lshl_b32 s3, s2, 8
    v_add_u32 v0, s3, v0
    v_lshlrev_b32 v2, 4, v0
    v_lshlrev_b32 v3, 2, v0
    v_add_u32 v0, v0, v0
    v_mul_hi_u32_u24 v1, 343268, v0
    v_lshlrev_b16 v1, 4, v1
    s_waitcnt lgkmcnt(0)
    s_load_dwordx4 s[32:35], s[8:9], 0
    s_load_dwordx16 s[36:51], s[12:13], 0
    s_load_dwordx16 s[52:67], s[14:15], 0
    s_load_dwordx8 s[68:75], s[16:17], 0
    s_load_dwordx8 s[76:83], s[18:19], 0
    s_mov_b32 s24, s6
    s_and_b32 s25, s7, 0xffff
    s_mov_b32 s26, 1600000
    s_mov_b32 s27, 0x20000
    buffer_load_dword v4, v3, s[24:27], 0 offen nt
    s_mov_b32 s28, s20
    s_and_b32 s29, s21, 0xffff
    s_mov_b32 s30, 819200000
    s_mov_b32 s31, 0x20000
    s_mov_b32 s22, 491610112
    buffer_load_dwordx4 v[40:43], v2, s[28:31], s22 offen nt
    s_mov_b32 s22, 498016256
    buffer_load_dwordx4 v[44:47], v2, s[28:31], s22 offen nt
    s_mov_b32 s22, 504422400
    buffer_load_dwordx4 v[48:51], v2, s[28:31], s22 offen nt
    s_mov_b32 s22, 510828544
    buffer_load_dwordx4 v[52:55], v2, s[28:31], s22 offen nt
    s_mov_b32 s22, 491609088
    buffer_load_dwordx4 v[56:59], v1, s[28:31], s22 offen
    s_mov_b32 s24, s4
    s_and_b32 s25, s5, 0xffff
    s_mov_b32 s26, 6400000
    s_mov_b32 s27, 0x20000
    buffer_load_dwordx4 v[60:63], v2, s[24:27], 0 offen nt
    s_mov_b32 s24, s10
    s_and_b32 s25, s11, 0xffff
    s_mov_b32 s26, 6400000
    s_mov_b32 s27, 0x20000
    s_waitcnt vmcnt(6) lgkmcnt(0)
    v_and_b32 v5, 0xffff0000, v4
    v_lshlrev_b32 v4, 16, v4
    s_lshl_b32 s14, s32, 16
    s_and_b32 s15, s32, 0xffff0000
    v_pk_add_f32 v[8:9], v[4:5], s[14:15] op_sel:[0,0] op_sel_hi:[0,1] neg_lo:[0,1] neg_hi:[0,1]
    v_pk_add_f32 v[16:17], v[4:5], s[14:15] op_sel:[1,0] op_sel_hi:[1,1] neg_lo:[0,1] neg_hi:[0,1]
    s_lshl_b32 s16, s33, 16
    s_and_b32 s17, s33, 0xffff0000
    v_pk_add_f32 v[10:11], v[4:5], s[16:17] op_sel:[0,0] op_sel_hi:[0,1] neg_lo:[0,1] neg_hi:[0,1]
    v_pk_add_f32 v[18:19], v[4:5], s[16:17] op_sel:[1,0] op_sel_hi:[1,1] neg_lo:[0,1] neg_hi:[0,1]
    s_lshl_b32 s18, s34, 16
    s_and_b32 s19, s34, 0xffff0000
    v_pk_add_f32 v[12:13], v[4:5], s[18:19] op_sel:[0,0] op_sel_hi:[0,1] neg_lo:[0,1] neg_hi:[0,1]
    v_pk_add_f32 v[20:21], v[4:5], s[18:19] op_sel:[1,0] op_sel_hi:[1,1] neg_lo:[0,1] neg_hi:[0,1]
    s_lshl_b32 s12, s35, 16
    s_and_b32 s13, s35, 0xffff0000
    v_pk_add_f32 v[14:15], v[4:5], s[12:13] op_sel:[0,0] op_sel_hi:[0,1] neg_lo:[0,1] neg_hi:[0,1]
    v_pk_add_f32 v[22:23], v[4:5], s[12:13] op_sel:[1,0] op_sel_hi:[1,1] neg_lo:[0,1] neg_hi:[0,1]
    v_cvt_pk_bf16_f32 v8, v8, v9
    v_cvt_pk_bf16_f32 v10, v10, v11
    v_cvt_pk_bf16_f32 v12, v12, v13
    v_cvt_pk_bf16_f32 v14, v14, v15
    v_cvt_pk_bf16_f32 v16, v16, v17
    v_cvt_pk_bf16_f32 v18, v18, v19
    v_cvt_pk_bf16_f32 v20, v20, v21
    v_cvt_pk_bf16_f32 v22, v22, v23
    v_and_b32 v9, 0xffff0000, v8
    v_lshlrev_b32 v8, 16, v8
    v_and_b32 v11, 0xffff0000, v10
    v_lshlrev_b32 v10, 16, v10
    v_and_b32 v13, 0xffff0000, v12
    v_lshlrev_b32 v12, 16, v12
    v_and_b32 v15, 0xffff0000, v14
    v_lshlrev_b32 v14, 16, v14
    v_and_b32 v17, 0xffff0000, v16
    v_lshlrev_b32 v16, 16, v16
    v_and_b32 v19, 0xffff0000, v18
    v_lshlrev_b32 v18, 16, v18
    v_and_b32 v21, 0xffff0000, v20
    v_lshlrev_b32 v20, 16, v20
    v_and_b32 v23, 0xffff0000, v22
    v_lshlrev_b32 v22, 16, v22
    v_mul_f32 v8, v8, v8
    v_mul_f32 v9, v9, v9
    v_mul_f32 v10, v10, v10
    v_mul_f32 v11, v11, v11
    v_mul_f32 v12, v12, v12
    v_mul_f32 v13, v13, v13
    v_mul_f32 v14, v14, v14
    v_mul_f32 v15, v15, v15
    v_mul_f32 v16, v16, v16
    v_mul_f32 v17, v17, v17
    v_mul_f32 v18, v18, v18
    v_mul_f32 v19, v19, v19
    v_mul_f32 v20, v20, v20
    v_mul_f32 v21, v21, v21
    v_mul_f32 v22, v22, v22
    v_mul_f32 v23, v23, v23
    v_cvt_pk_bf16_f32 v8, v8, v9
    v_cvt_pk_bf16_f32 v10, v10, v11
    v_cvt_pk_bf16_f32 v12, v12, v13
    v_cvt_pk_bf16_f32 v14, v14, v15
    v_cvt_pk_bf16_f32 v16, v16, v17
    v_cvt_pk_bf16_f32 v18, v18, v19
    v_cvt_pk_bf16_f32 v20, v20, v21
    v_cvt_pk_bf16_f32 v22, v22, v23
    v_and_b32 v9, 0xffff0000, v8
    v_lshlrev_b32 v8, 16, v8
    v_and_b32 v11, 0xffff0000, v10
    v_lshlrev_b32 v10, 16, v10
    v_and_b32 v13, 0xffff0000, v12
    v_lshlrev_b32 v12, 16, v12
    v_and_b32 v15, 0xffff0000, v14
    v_lshlrev_b32 v14, 16, v14
    v_and_b32 v17, 0xffff0000, v16
    v_lshlrev_b32 v16, 16, v16
    v_and_b32 v19, 0xffff0000, v18
    v_lshlrev_b32 v18, 16, v18
    v_and_b32 v21, 0xffff0000, v20
    v_lshlrev_b32 v20, 16, v20
    v_and_b32 v23, 0xffff0000, v22
    v_lshlrev_b32 v22, 16, v22
    v_mul_f32 v8, 0xc1200000, v8
    v_mul_f32 v9, 0xc1200000, v9
    v_mul_f32 v10, 0xc1200000, v10
    v_mul_f32 v11, 0xc1200000, v11
    v_mul_f32 v12, 0xc1200000, v12
    v_mul_f32 v13, 0xc1200000, v13
    v_mul_f32 v14, 0xc1200000, v14
    v_mul_f32 v15, 0xc1200000, v15
    v_mul_f32 v16, 0xc1200000, v16
    v_mul_f32 v17, 0xc1200000, v17
    v_mul_f32 v18, 0xc1200000, v18
    v_mul_f32 v19, 0xc1200000, v19
    v_mul_f32 v20, 0xc1200000, v20
    v_mul_f32 v21, 0xc1200000, v21
    v_mul_f32 v22, 0xc1200000, v22
    v_mul_f32 v23, 0xc1200000, v23
    v_cvt_pk_bf16_f32 v8, v8, v9
    v_cvt_pk_bf16_f32 v10, v10, v11
    v_cvt_pk_bf16_f32 v12, v12, v13
    v_cvt_pk_bf16_f32 v14, v14, v15
    v_cvt_pk_bf16_f32 v16, v16, v17
    v_cvt_pk_bf16_f32 v18, v18, v19
    v_cvt_pk_bf16_f32 v20, v20, v21
    v_cvt_pk_bf16_f32 v22, v22, v23
    v_and_b32 v9, 0xffff0000, v8
    v_lshlrev_b32 v8, 16, v8
    v_and_b32 v11, 0xffff0000, v10
    v_lshlrev_b32 v10, 16, v10
    v_and_b32 v13, 0xffff0000, v12
    v_lshlrev_b32 v12, 16, v12
    v_and_b32 v15, 0xffff0000, v14
    v_lshlrev_b32 v14, 16, v14
    v_and_b32 v17, 0xffff0000, v16
    v_lshlrev_b32 v16, 16, v16
    v_and_b32 v19, 0xffff0000, v18
    v_lshlrev_b32 v18, 16, v18
    v_and_b32 v21, 0xffff0000, v20
    v_lshlrev_b32 v20, 16, v20
    v_and_b32 v23, 0xffff0000, v22
    v_lshlrev_b32 v22, 16, v22
    v_mul_f32 v8, 0x3fb8aa3b, v8
    v_mul_f32 v9, 0x3fb8aa3b, v9
    v_mul_f32 v10, 0x3fb8aa3b, v10
    v_mul_f32 v11, 0x3fb8aa3b, v11
    v_mul_f32 v12, 0x3fb8aa3b, v12
    v_mul_f32 v13, 0x3fb8aa3b, v13
    v_mul_f32 v14, 0x3fb8aa3b, v14
    v_mul_f32 v15, 0x3fb8aa3b, v15
    v_mul_f32 v16, 0x3fb8aa3b, v16
    v_mul_f32 v17, 0x3fb8aa3b, v17
    v_mul_f32 v18, 0x3fb8aa3b, v18
    v_mul_f32 v19, 0x3fb8aa3b, v19
    v_mul_f32 v20, 0x3fb8aa3b, v20
    v_mul_f32 v21, 0x3fb8aa3b, v21
    v_mul_f32 v22, 0x3fb8aa3b, v22
    v_mul_f32 v23, 0x3fb8aa3b, v23
    v_exp_f32 v8, v8
    v_exp_f32 v9, v9
    v_exp_f32 v10, v10
    v_exp_f32 v11, v11
    v_exp_f32 v12, v12
    v_exp_f32 v13, v13
    v_exp_f32 v14, v14
    v_exp_f32 v15, v15
    v_exp_f32 v16, v16
    v_exp_f32 v17, v17
    v_exp_f32 v18, v18
    v_exp_f32 v19, v19
    v_exp_f32 v20, v20
    v_exp_f32 v21, v21
    v_exp_f32 v22, v22
    v_exp_f32 v23, v23
    s_nop 0
    v_cvt_pk_bf16_f32 v8, v8, v9
    v_cvt_pk_bf16_f32 v10, v10, v11
    v_cvt_pk_bf16_f32 v12, v12, v13
    v_cvt_pk_bf16_f32 v14, v14, v15
    v_cvt_pk_bf16_f32 v16, v16, v17
    v_cvt_pk_bf16_f32 v18, v18, v19
    v_cvt_pk_bf16_f32 v20, v20, v21
    v_cvt_pk_bf16_f32 v22, v22, v23
    v_and_b32 v9, 0xffff0000, v8
    v_lshlrev_b32 v8, 16, v8
    v_and_b32 v11, 0xffff0000, v10
    v_lshlrev_b32 v10, 16, v10
    v_and_b32 v13, 0xffff0000, v12
    v_lshlrev_b32 v12, 16, v12
    v_and_b32 v15, 0xffff0000, v14
    v_lshlrev_b32 v14, 16, v14
    v_and_b32 v17, 0xffff0000, v16
    v_lshlrev_b32 v16, 16, v16
    v_and_b32 v19, 0xffff0000, v18
    v_lshlrev_b32 v18, 16, v18
    v_and_b32 v21, 0xffff0000, v20
    v_lshlrev_b32 v20, 16, v20
    v_and_b32 v23, 0xffff0000, v22
    v_lshlrev_b32 v22, 16, v22
    s_lshl_b32 s14, s52, 16
    s_and_b32 s15, s52, 0xffff0000
    v_pk_mul_f32 v[24:25], v[8:9], s[14:15] op_sel:[0,0] op_sel_hi:[0,1]
    v_pk_mul_f32 v[28:29], v[16:17], s[14:15] op_sel:[0,0] op_sel_hi:[0,1]
    s_lshl_b32 s16, s53, 16
    s_and_b32 s17, s53, 0xffff0000
    v_pk_mul_f32 v[26:27], v[8:9], s[16:17] op_sel:[0,0] op_sel_hi:[0,1]
    v_pk_mul_f32 v[30:31], v[16:17], s[16:17] op_sel:[0,0] op_sel_hi:[0,1]
    s_lshl_b32 s18, s54, 16
    s_and_b32 s19, s54, 0xffff0000
    v_pk_fma_f32 v[24:25], v[8:9], s[18:19], v[24:25] op_sel:[1,0,0] op_sel_hi:[1,1,1]
    v_pk_fma_f32 v[28:29], v[16:17], s[18:19], v[28:29] op_sel:[1,0,0] op_sel_hi:[1,1,1]
    s_lshl_b32 s12, s55, 16
    s_and_b32 s13, s55, 0xffff0000
    v_pk_fma_f32 v[26:27], v[8:9], s[12:13], v[26:27] op_sel:[1,0,0] op_sel_hi:[1,1,1]
    v_pk_fma_f32 v[30:31], v[16:17], s[12:13], v[30:31] op_sel:[1,0,0] op_sel_hi:[1,1,1]
    s_lshl_b32 s14, s56, 16
    s_and_b32 s15, s56, 0xffff0000
    v_pk_fma_f32 v[24:25], v[10:11], s[14:15], v[24:25] op_sel:[0,0,0] op_sel_hi:[0,1,1]
    v_pk_fma_f32 v[28:29], v[18:19], s[14:15], v[28:29] op_sel:[0,0,0] op_sel_hi:[0,1,1]
    s_lshl_b32 s16, s57, 16
    s_and_b32 s17, s57, 0xffff0000
    v_pk_fma_f32 v[26:27], v[10:11], s[16:17], v[26:27] op_sel:[0,0,0] op_sel_hi:[0,1,1]
    v_pk_fma_f32 v[30:31], v[18:19], s[16:17], v[30:31] op_sel:[0,0,0] op_sel_hi:[0,1,1]
    s_lshl_b32 s18, s58, 16
    s_and_b32 s19, s58, 0xffff0000
    v_pk_fma_f32 v[24:25], v[10:11], s[18:19], v[24:25] op_sel:[1,0,0] op_sel_hi:[1,1,1]
    v_pk_fma_f32 v[28:29], v[18:19], s[18:19], v[28:29] op_sel:[1,0,0] op_sel_hi:[1,1,1]
    s_lshl_b32 s12, s59, 16
    s_and_b32 s13, s59, 0xffff0000
    v_pk_fma_f32 v[26:27], v[10:11], s[12:13], v[26:27] op_sel:[1,0,0] op_sel_hi:[1,1,1]
    v_pk_fma_f32 v[30:31], v[18:19], s[12:13], v[30:31] op_sel:[1,0,0] op_sel_hi:[1,1,1]
    s_lshl_b32 s14, s60, 16
    s_and_b32 s15, s60, 0xffff0000
    v_pk_fma_f32 v[24:25], v[12:13], s[14:15], v[24:25] op_sel:[0,0,0] op_sel_hi:[0,1,1]
    v_pk_fma_f32 v[28:29], v[20:21], s[14:15], v[28:29] op_sel:[0,0,0] op_sel_hi:[0,1,1]
    s_lshl_b32 s16, s61, 16
    s_and_b32 s17, s61, 0xffff0000
    v_pk_fma_f32 v[26:27], v[12:13], s[16:17], v[26:27] op_sel:[0,0,0] op_sel_hi:[0,1,1]
    v_pk_fma_f32 v[30:31], v[20:21], s[16:17], v[30:31] op_sel:[0,0,0] op_sel_hi:[0,1,1]
    s_lshl_b32 s18, s62, 16
    s_and_b32 s19, s62, 0xffff0000
    v_pk_fma_f32 v[24:25], v[12:13], s[18:19], v[24:25] op_sel:[1,0,0] op_sel_hi:[1,1,1]
    v_pk_fma_f32 v[28:29], v[20:21], s[18:19], v[28:29] op_sel:[1,0,0] op_sel_hi:[1,1,1]
    s_lshl_b32 s12, s63, 16
    s_and_b32 s13, s63, 0xffff0000
    v_pk_fma_f32 v[26:27], v[12:13], s[12:13], v[26:27] op_sel:[1,0,0] op_sel_hi:[1,1,1]
    v_pk_fma_f32 v[30:31], v[20:21], s[12:13], v[30:31] op_sel:[1,0,0] op_sel_hi:[1,1,1]
    s_lshl_b32 s14, s64, 16
    s_and_b32 s15, s64, 0xffff0000
    v_pk_fma_f32 v[24:25], v[14:15], s[14:15], v[24:25] op_sel:[0,0,0] op_sel_hi:[0,1,1]
    v_pk_fma_f32 v[28:29], v[22:23], s[14:15], v[28:29] op_sel:[0,0,0] op_sel_hi:[0,1,1]
    s_lshl_b32 s16, s65, 16
    s_and_b32 s17, s65, 0xffff0000
    v_pk_fma_f32 v[26:27], v[14:15], s[16:17], v[26:27] op_sel:[0,0,0] op_sel_hi:[0,1,1]
    v_pk_fma_f32 v[30:31], v[22:23], s[16:17], v[30:31] op_sel:[0,0,0] op_sel_hi:[0,1,1]
    s_lshl_b32 s18, s66, 16
    s_and_b32 s19, s66, 0xffff0000
    v_pk_fma_f32 v[24:25], v[14:15], s[18:19], v[24:25] op_sel:[1,0,0] op_sel_hi:[1,1,1]
    v_pk_fma_f32 v[28:29], v[22:23], s[18:19], v[28:29] op_sel:[1,0,0] op_sel_hi:[1,1,1]
    s_lshl_b32 s12, s67, 16
    s_and_b32 s13, s67, 0xffff0000
    v_pk_fma_f32 v[26:27], v[14:15], s[12:13], v[26:27] op_sel:[1,0,0] op_sel_hi:[1,1,1]
    v_pk_fma_f32 v[30:31], v[22:23], s[12:13], v[30:31] op_sel:[1,0,0] op_sel_hi:[1,1,1]
    s_lshl_b32 s14, s36, 16
    s_and_b32 s15, s36, 0xffff0000
    v_pk_mul_f32 v[32:33], v[8:9], s[14:15] op_sel:[0,0] op_sel_hi:[0,1]
    v_pk_mul_f32 v[36:37], v[16:17], s[14:15] op_sel:[0,0] op_sel_hi:[0,1]
    s_lshl_b32 s16, s37, 16
    s_and_b32 s17, s37, 0xffff0000
    v_pk_mul_f32 v[34:35], v[8:9], s[16:17] op_sel:[0,0] op_sel_hi:[0,1]
    v_pk_mul_f32 v[38:39], v[16:17], s[16:17] op_sel:[0,0] op_sel_hi:[0,1]
    s_lshl_b32 s18, s38, 16
    s_and_b32 s19, s38, 0xffff0000
    v_pk_fma_f32 v[32:33], v[8:9], s[18:19], v[32:33] op_sel:[1,0,0] op_sel_hi:[1,1,1]
    v_pk_fma_f32 v[36:37], v[16:17], s[18:19], v[36:37] op_sel:[1,0,0] op_sel_hi:[1,1,1]
    s_lshl_b32 s12, s39, 16
    s_and_b32 s13, s39, 0xffff0000
    v_pk_fma_f32 v[34:35], v[8:9], s[12:13], v[34:35] op_sel:[1,0,0] op_sel_hi:[1,1,1]
    v_pk_fma_f32 v[38:39], v[16:17], s[12:13], v[38:39] op_sel:[1,0,0] op_sel_hi:[1,1,1]
    s_lshl_b32 s14, s40, 16
    s_and_b32 s15, s40, 0xffff0000
    v_pk_fma_f32 v[32:33], v[10:11], s[14:15], v[32:33] op_sel:[0,0,0] op_sel_hi:[0,1,1]
    v_pk_fma_f32 v[36:37], v[18:19], s[14:15], v[36:37] op_sel:[0,0,0] op_sel_hi:[0,1,1]
    s_lshl_b32 s16, s41, 16
    s_and_b32 s17, s41, 0xffff0000
    v_pk_fma_f32 v[34:35], v[10:11], s[16:17], v[34:35] op_sel:[0,0,0] op_sel_hi:[0,1,1]
    v_pk_fma_f32 v[38:39], v[18:19], s[16:17], v[38:39] op_sel:[0,0,0] op_sel_hi:[0,1,1]
    s_lshl_b32 s18, s42, 16
    s_and_b32 s19, s42, 0xffff0000
    v_pk_fma_f32 v[32:33], v[10:11], s[18:19], v[32:33] op_sel:[1,0,0] op_sel_hi:[1,1,1]
    v_pk_fma_f32 v[36:37], v[18:19], s[18:19], v[36:37] op_sel:[1,0,0] op_sel_hi:[1,1,1]
    s_lshl_b32 s12, s43, 16
    s_and_b32 s13, s43, 0xffff0000
    v_pk_fma_f32 v[34:35], v[10:11], s[12:13], v[34:35] op_sel:[1,0,0] op_sel_hi:[1,1,1]
    v_pk_fma_f32 v[38:39], v[18:19], s[12:13], v[38:39] op_sel:[1,0,0] op_sel_hi:[1,1,1]
    s_lshl_b32 s14, s44, 16
    s_and_b32 s15, s44, 0xffff0000
    v_pk_fma_f32 v[32:33], v[12:13], s[14:15], v[32:33] op_sel:[0,0,0] op_sel_hi:[0,1,1]
    v_pk_fma_f32 v[36:37], v[20:21], s[14:15], v[36:37] op_sel:[0,0,0] op_sel_hi:[0,1,1]
    s_lshl_b32 s16, s45, 16
    s_and_b32 s17, s45, 0xffff0000
    v_pk_fma_f32 v[34:35], v[12:13], s[16:17], v[34:35] op_sel:[0,0,0] op_sel_hi:[0,1,1]
    v_pk_fma_f32 v[38:39], v[20:21], s[16:17], v[38:39] op_sel:[0,0,0] op_sel_hi:[0,1,1]
    s_lshl_b32 s18, s46, 16
    s_and_b32 s19, s46, 0xffff0000
    v_pk_fma_f32 v[32:33], v[12:13], s[18:19], v[32:33] op_sel:[1,0,0] op_sel_hi:[1,1,1]
    v_pk_fma_f32 v[36:37], v[20:21], s[18:19], v[36:37] op_sel:[1,0,0] op_sel_hi:[1,1,1]
    s_lshl_b32 s12, s47, 16
    s_and_b32 s13, s47, 0xffff0000
    v_pk_fma_f32 v[34:35], v[12:13], s[12:13], v[34:35] op_sel:[1,0,0] op_sel_hi:[1,1,1]
    v_pk_fma_f32 v[38:39], v[20:21], s[12:13], v[38:39] op_sel:[1,0,0] op_sel_hi:[1,1,1]
    s_lshl_b32 s14, s48, 16
    s_and_b32 s15, s48, 0xffff0000
    v_pk_fma_f32 v[32:33], v[14:15], s[14:15], v[32:33] op_sel:[0,0,0] op_sel_hi:[0,1,1]
    v_pk_fma_f32 v[36:37], v[22:23], s[14:15], v[36:37] op_sel:[0,0,0] op_sel_hi:[0,1,1]
    s_lshl_b32 s16, s49, 16
    s_and_b32 s17, s49, 0xffff0000
    v_pk_fma_f32 v[34:35], v[14:15], s[16:17], v[34:35] op_sel:[0,0,0] op_sel_hi:[0,1,1]
    v_pk_fma_f32 v[38:39], v[22:23], s[16:17], v[38:39] op_sel:[0,0,0] op_sel_hi:[0,1,1]
    s_lshl_b32 s18, s50, 16
    s_and_b32 s19, s50, 0xffff0000
    v_pk_fma_f32 v[32:33], v[14:15], s[18:19], v[32:33] op_sel:[1,0,0] op_sel_hi:[1,1,1]
    v_pk_fma_f32 v[36:37], v[22:23], s[18:19], v[36:37] op_sel:[1,0,0] op_sel_hi:[1,1,1]
    s_lshl_b32 s12, s51, 16
    s_and_b32 s13, s51, 0xffff0000
    v_pk_fma_f32 v[34:35], v[14:15], s[12:13], v[34:35] op_sel:[1,0,0] op_sel_hi:[1,1,1]
    v_pk_fma_f32 v[38:39], v[22:23], s[12:13], v[38:39] op_sel:[1,0,0] op_sel_hi:[1,1,1]
    v_cvt_pk_bf16_f32 v32, v32, v33
    v_cvt_pk_bf16_f32 v34, v34, v35
    v_cvt_pk_bf16_f32 v36, v36, v37
    v_cvt_pk_bf16_f32 v38, v38, v39
    v_and_b32 v33, 0xffff0000, v32
    v_lshlrev_b32 v32, 16, v32
    v_and_b32 v35, 0xffff0000, v34
    v_lshlrev_b32 v34, 16, v34
    v_and_b32 v37, 0xffff0000, v36
    v_lshlrev_b32 v36, 16, v36
    v_and_b32 v39, 0xffff0000, v38
    v_lshlrev_b32 v38, 16, v38
    s_waitcnt vmcnt(1)
    v_add_u32 v40, v40, v44
    v_add_u32 v48, v48, v52
    v_add_u32 v41, v41, v45
    v_add_u32 v49, v49, v53
    v_add_u32 v42, v42, v46
    v_add_u32 v50, v50, v54
    v_add_u32 v43, v43, v47
    v_add_u32 v51, v51, v55
    v_add_u32_sdwa v8, v40, v48 dst_sel:DWORD dst_unused:UNUSED_PAD src0_sel:WORD_0 src1_sel:WORD_0
    v_add_u32_sdwa v9, v40, v48 dst_sel:DWORD dst_unused:UNUSED_PAD src0_sel:WORD_1 src1_sel:WORD_1
    v_add_u32_sdwa v10, v41, v49 dst_sel:DWORD dst_unused:UNUSED_PAD src0_sel:WORD_0 src1_sel:WORD_0
    v_add_u32_sdwa v11, v41, v49 dst_sel:DWORD dst_unused:UNUSED_PAD src0_sel:WORD_1 src1_sel:WORD_1
    v_add_u32_sdwa v12, v42, v50 dst_sel:DWORD dst_unused:UNUSED_PAD src0_sel:WORD_0 src1_sel:WORD_0
    v_add_u32_sdwa v13, v42, v50 dst_sel:DWORD dst_unused:UNUSED_PAD src0_sel:WORD_1 src1_sel:WORD_1
    v_add_u32_sdwa v14, v43, v51 dst_sel:DWORD dst_unused:UNUSED_PAD src0_sel:WORD_0 src1_sel:WORD_0
    v_add_u32_sdwa v15, v43, v51 dst_sel:DWORD dst_unused:UNUSED_PAD src0_sel:WORD_1 src1_sel:WORD_1
    v_min3_u32 v5, v56, v57, v58
    v_bitop3_b32 v4, v56, v57, v58 bitop3:0xfe
    v_min_u32 v5, v5, v59
    v_or_b32 v4, v4, v59
    v_or_b32 v8, 0x4b000000, v8
    v_or_b32 v9, 0x4b000000, v9
    v_or_b32 v10, 0x4b000000, v10
    v_or_b32 v11, 0x4b000000, v11
    v_or_b32 v12, 0x4b000000, v12
    v_or_b32 v13, 0x4b000000, v13
    v_or_b32 v14, 0x4b000000, v14
    v_or_b32 v15, 0x4b000000, v15
    v_cmp_eq_u32 vcc, 0, v5
    v_add_f32 v8, 0xcb010000, v8
    v_add_f32 v9, 0xcb010000, v9
    v_add_f32 v10, 0xcb010000, v10
    v_add_f32 v11, 0xcb010000, v11
    v_add_f32 v12, 0xcb010000, v12
    v_add_f32 v13, 0xcb010000, v13
    v_add_f32 v14, 0xcb010000, v14
    v_add_f32 v15, 0xcb010000, v15
    v_mul_f32 v8, v4, v8
    v_mul_f32 v9, v4, v9
    v_mul_f32 v10, v4, v10
    v_mul_f32 v11, v4, v11
    v_mul_f32 v12, v4, v12
    v_mul_f32 v13, v4, v13
    v_mul_f32 v14, v4, v14
    v_mul_f32 v15, v4, v15
    s_cbranch_vccz p3_nof
    v_lshlrev_b32 v1, 4, v0
    v_mov_b32 v3, 0x70000000
    v_cmp_eq_u32 vcc, 0, v56
    s_mov_b32 s22, 517234688
    s_nop 0
    v_cndmask_b32 v5, v3, v1, vcc
    buffer_load_dwordx4 v[16:19], v5, s[28:31], s22 offen
    buffer_load_dwordx4 v[20:23], v5, s[28:31], s22 offen offset:16
    s_waitcnt vmcnt(0)
    v_add_f32 v8, v8, v16
    v_add_f32 v9, v9, v17
    v_add_f32 v10, v10, v18
    v_add_f32 v11, v11, v19
    v_add_f32 v12, v12, v20
    v_add_f32 v13, v13, v21
    v_add_f32 v14, v14, v22
    v_add_f32 v15, v15, v23
    v_cmp_eq_u32 vcc, 0, v57
    s_mov_b32 s22, 530046976
    s_nop 0
    v_cndmask_b32 v5, v3, v1, vcc
    buffer_load_dwordx4 v[16:19], v5, s[28:31], s22 offen
    buffer_load_dwordx4 v[20:23], v5, s[28:31], s22 offen offset:16
    s_waitcnt vmcnt(0)
    v_add_f32 v8, v8, v16
    v_add_f32 v9, v9, v17
    v_add_f32 v10, v10, v18
    v_add_f32 v11, v11, v19
    v_add_f32 v12, v12, v20
    v_add_f32 v13, v13, v21
    v_add_f32 v14, v14, v22
    v_add_f32 v15, v15, v23
    v_cmp_eq_u32 vcc, 0, v58
    s_mov_b32 s22, 542859264
    s_nop 0
    v_cndmask_b32 v5, v3, v1, vcc
    buffer_load_dwordx4 v[16:19], v5, s[28:31], s22 offen
    buffer_load_dwordx4 v[20:23], v5, s[28:31], s22 offen offset:16
    s_waitcnt vmcnt(0)
    v_add_f32 v8, v8, v16
    v_add_f32 v9, v9, v17
    v_add_f32 v10, v10, v18
    v_add_f32 v11, v11, v19
    v_add_f32 v12, v12, v20
    v_add_f32 v13, v13, v21
    v_add_f32 v14, v14, v22
    v_add_f32 v15, v15, v23
    v_cmp_eq_u32 vcc, 0, v59
    s_mov_b32 s22, 555671552
    s_nop 0
    v_cndmask_b32 v5, v3, v1, vcc
    buffer_load_dwordx4 v[16:19], v5, s[28:31], s22 offen
    buffer_load_dwordx4 v[20:23], v5, s[28:31], s22 offen offset:16
    s_waitcnt vmcnt(0)
    v_add_f32 v8, v8, v16
    v_add_f32 v9, v9, v17
    v_add_f32 v10, v10, v18
    v_add_f32 v11, v11, v19
    v_add_f32 v12, v12, v20
    v_add_f32 v13, v13, v21
    v_add_f32 v14, v14, v22
    v_add_f32 v15, v15, v23
p3_nof:
    s_lshl_b32 s14, s68, 16
    s_and_b32 s15, s68, 0xffff0000
    v_pk_mul_f32 v[16:17], v[8:9], s[14:15] op_sel:[0,0] op_sel_hi:[0,1]
    v_pk_mul_f32 v[20:21], v[12:13], s[14:15] op_sel:[0,0] op_sel_hi:[0,1]
    s_lshl_b32 s16, s69, 16
    s_and_b32 s17, s69, 0xffff0000
    v_pk_mul_f32 v[18:19], v[8:9], s[16:17] op_sel:[0,0] op_sel_hi:[0,1]
    v_pk_mul_f32 v[22:23], v[12:13], s[16:17] op_sel:[0,0] op_sel_hi:[0,1]
    s_lshl_b32 s18, s70, 16
    s_and_b32 s19, s70, 0xffff0000
    v_pk_fma_f32 v[16:17], v[8:9], s[18:19], v[16:17] op_sel:[1,0,0] op_sel_hi:[1,1,1]
    v_pk_fma_f32 v[20:21], v[12:13], s[18:19], v[20:21] op_sel:[1,0,0] op_sel_hi:[1,1,1]
    s_lshl_b32 s12, s71, 16
    s_and_b32 s13, s71, 0xffff0000
    v_pk_fma_f32 v[18:19], v[8:9], s[12:13], v[18:19] op_sel:[1,0,0] op_sel_hi:[1,1,1]
    v_pk_fma_f32 v[22:23], v[12:13], s[12:13], v[22:23] op_sel:[1,0,0] op_sel_hi:[1,1,1]
    s_lshl_b32 s14, s72, 16
    s_and_b32 s15, s72, 0xffff0000
    v_pk_fma_f32 v[16:17], v[10:11], s[14:15], v[16:17] op_sel:[0,0,0] op_sel_hi:[0,1,1]
    v_pk_fma_f32 v[20:21], v[14:15], s[14:15], v[20:21] op_sel:[0,0,0] op_sel_hi:[0,1,1]
    s_lshl_b32 s16, s73, 16
    s_and_b32 s17, s73, 0xffff0000
    v_pk_fma_f32 v[18:19], v[10:11], s[16:17], v[18:19] op_sel:[0,0,0] op_sel_hi:[0,1,1]
    v_pk_fma_f32 v[22:23], v[14:15], s[16:17], v[22:23] op_sel:[0,0,0] op_sel_hi:[0,1,1]
    s_lshl_b32 s18, s74, 16
    s_and_b32 s19, s74, 0xffff0000
    v_pk_fma_f32 v[16:17], v[10:11], s[18:19], v[16:17] op_sel:[1,0,0] op_sel_hi:[1,1,1]
    v_pk_fma_f32 v[20:21], v[14:15], s[18:19], v[20:21] op_sel:[1,0,0] op_sel_hi:[1,1,1]
    s_lshl_b32 s12, s75, 16
    s_and_b32 s13, s75, 0xffff0000
    v_pk_fma_f32 v[18:19], v[10:11], s[12:13], v[18:19] op_sel:[1,0,0] op_sel_hi:[1,1,1]
    v_pk_fma_f32 v[22:23], v[14:15], s[12:13], v[22:23] op_sel:[1,0,0] op_sel_hi:[1,1,1]
    v_mul_f32 v24, v24, v16
    v_mul_f32 v25, v25, v17
    v_mul_f32 v26, v26, v18
    v_mul_f32 v27, v27, v19
    v_mul_f32 v28, v28, v20
    v_mul_f32 v29, v29, v21
    v_mul_f32 v30, v30, v22
    v_mul_f32 v31, v31, v23
    v_cvt_pk_bf16_f32 v24, v24, v25
    v_cvt_pk_bf16_f32 v26, v26, v27
    v_cvt_pk_bf16_f32 v28, v28, v29
    v_cvt_pk_bf16_f32 v30, v30, v31
    v_and_b32 v25, 0xffff0000, v24
    v_lshlrev_b32 v24, 16, v24
    v_and_b32 v27, 0xffff0000, v26
    v_lshlrev_b32 v26, 16, v26
    v_and_b32 v29, 0xffff0000, v28
    v_lshlrev_b32 v28, 16, v28
    v_and_b32 v31, 0xffff0000, v30
    v_lshlrev_b32 v30, 16, v30
    s_lshl_b32 s14, s76, 16
    s_and_b32 s15, s76, 0xffff0000
    v_pk_mul_f32 v[16:17], v[24:25], s[14:15] op_sel:[0,0] op_sel_hi:[0,1]
    v_pk_mul_f32 v[20:21], v[28:29], s[14:15] op_sel:[0,0] op_sel_hi:[0,1]
    s_lshl_b32 s16, s77, 16
    s_and_b32 s17, s77, 0xffff0000
    v_pk_mul_f32 v[18:19], v[24:25], s[16:17] op_sel:[0,0] op_sel_hi:[0,1]
    v_pk_mul_f32 v[22:23], v[28:29], s[16:17] op_sel:[0,0] op_sel_hi:[0,1]
    s_lshl_b32 s18, s78, 16
    s_and_b32 s19, s78, 0xffff0000
    v_pk_fma_f32 v[16:17], v[24:25], s[18:19], v[16:17] op_sel:[1,0,0] op_sel_hi:[1,1,1]
    v_pk_fma_f32 v[20:21], v[28:29], s[18:19], v[20:21] op_sel:[1,0,0] op_sel_hi:[1,1,1]
    s_lshl_b32 s12, s79, 16
    s_and_b32 s13, s79, 0xffff0000
    v_pk_fma_f32 v[18:19], v[24:25], s[12:13], v[18:19] op_sel:[1,0,0] op_sel_hi:[1,1,1]
    v_pk_fma_f32 v[22:23], v[28:29], s[12:13], v[22:23] op_sel:[1,0,0] op_sel_hi:[1,1,1]
    s_lshl_b32 s14, s80, 16
    s_and_b32 s15, s80, 0xffff0000
    v_pk_fma_f32 v[16:17], v[26:27], s[14:15], v[16:17] op_sel:[0,0,0] op_sel_hi:[0,1,1]
    v_pk_fma_f32 v[20:21], v[30:31], s[14:15], v[20:21] op_sel:[0,0,0] op_sel_hi:[0,1,1]
    s_lshl_b32 s16, s81, 16
    s_and_b32 s17, s81, 0xffff0000
    v_pk_fma_f32 v[18:19], v[26:27], s[16:17], v[18:19] op_sel:[0,0,0] op_sel_hi:[0,1,1]
    v_pk_fma_f32 v[22:23], v[30:31], s[16:17], v[22:23] op_sel:[0,0,0] op_sel_hi:[0,1,1]
    s_lshl_b32 s18, s82, 16
    s_and_b32 s19, s82, 0xffff0000
    v_pk_fma_f32 v[16:17], v[26:27], s[18:19], v[16:17] op_sel:[1,0,0] op_sel_hi:[1,1,1]
    v_pk_fma_f32 v[20:21], v[30:31], s[18:19], v[20:21] op_sel:[1,0,0] op_sel_hi:[1,1,1]
    s_lshl_b32 s12, s83, 16
    s_and_b32 s13, s83, 0xffff0000
    v_pk_fma_f32 v[18:19], v[26:27], s[12:13], v[18:19] op_sel:[1,0,0] op_sel_hi:[1,1,1]
    v_pk_fma_f32 v[22:23], v[30:31], s[12:13], v[22:23] op_sel:[1,0,0] op_sel_hi:[1,1,1]
    v_cvt_pk_bf16_f32 v16, v16, v17
    v_cvt_pk_bf16_f32 v18, v18, v19
    v_cvt_pk_bf16_f32 v20, v20, v21
    v_cvt_pk_bf16_f32 v22, v22, v23
    v_and_b32 v17, 0xffff0000, v16
    v_lshlrev_b32 v16, 16, v16
    v_and_b32 v19, 0xffff0000, v18
    v_lshlrev_b32 v18, 16, v18
    v_and_b32 v21, 0xffff0000, v20
    v_lshlrev_b32 v20, 16, v20
    v_and_b32 v23, 0xffff0000, v22
    v_lshlrev_b32 v22, 16, v22
    v_mul_f32 v16, v16, v32
    v_mul_f32 v17, v17, v33
    v_mul_f32 v18, v18, v34
    v_mul_f32 v19, v19, v35
    v_mul_f32 v20, v20, v36
    v_mul_f32 v21, v21, v37
    v_mul_f32 v22, v22, v38
    v_mul_f32 v23, v23, v39
    v_cvt_pk_bf16_f32 v16, v16, v17
    v_cvt_pk_bf16_f32 v18, v18, v19
    v_cvt_pk_bf16_f32 v20, v20, v21
    v_cvt_pk_bf16_f32 v22, v22, v23
    v_and_b32 v17, 0xffff0000, v16
    v_lshlrev_b32 v16, 16, v16
    v_and_b32 v19, 0xffff0000, v18
    v_lshlrev_b32 v18, 16, v18
    v_and_b32 v21, 0xffff0000, v20
    v_lshlrev_b32 v20, 16, v20
    v_and_b32 v23, 0xffff0000, v22
    v_lshlrev_b32 v22, 16, v22
    s_waitcnt vmcnt(0)
    v_lshlrev_b32 v8, 16, v60
    v_and_b32 v9, 0xffff0000, v60
    v_lshlrev_b32 v10, 16, v61
    v_and_b32 v11, 0xffff0000, v61
    v_lshlrev_b32 v12, 16, v62
    v_and_b32 v13, 0xffff0000, v62
    v_lshlrev_b32 v14, 16, v63
    v_and_b32 v15, 0xffff0000, v63
    v_add_f32 v8, v8, v16
    v_add_f32 v9, v9, v17
    v_add_f32 v10, v10, v18
    v_add_f32 v11, v11, v19
    v_add_f32 v12, v12, v20
    v_add_f32 v13, v13, v21
    v_add_f32 v14, v14, v22
    v_add_f32 v15, v15, v23
    v_cvt_pk_bf16_f32 v4, v8, v9
    v_cvt_pk_bf16_f32 v5, v10, v11
    v_cvt_pk_bf16_f32 v6, v12, v13
    v_cvt_pk_bf16_f32 v7, v14, v15
    buffer_store_dwordx4 v[4:7], v2, s[24:27], 0 offen nt
p3_end:
    s_endpgm
.section .rodata,"a"
.p2align 6
.amdhsa_kernel p1_kernel
  .amdhsa_next_free_vgpr 128
  .amdhsa_next_free_sgpr 72
  .amdhsa_accum_offset 128
  .amdhsa_group_segment_fixed_size 0
  .amdhsa_kernarg_size 112
  .amdhsa_user_sgpr_count 2
  .amdhsa_user_sgpr_kernarg_segment_ptr 1
  .amdhsa_system_sgpr_workgroup_id_x 1
  .amdhsa_float_denorm_mode_32 3
.end_amdhsa_kernel
.p2align 6
.amdhsa_kernel p2_kernel
  .amdhsa_next_free_vgpr 128
  .amdhsa_next_free_sgpr 72
  .amdhsa_accum_offset 128
  .amdhsa_group_segment_fixed_size 0
  .amdhsa_kernarg_size 112
  .amdhsa_user_sgpr_count 2
  .amdhsa_user_sgpr_kernarg_segment_ptr 1
  .amdhsa_system_sgpr_workgroup_id_x 1
  .amdhsa_float_denorm_mode_32 3
.end_amdhsa_kernel
.p2align 6
.amdhsa_kernel p3_kernel
  .amdhsa_next_free_vgpr 64
  .amdhsa_next_free_sgpr 84
  .amdhsa_accum_offset 64
  .amdhsa_group_segment_fixed_size 0
  .amdhsa_kernarg_size 112
  .amdhsa_user_sgpr_count 2
  .amdhsa_user_sgpr_kernarg_segment_ptr 1
  .amdhsa_system_sgpr_workgroup_id_x 1
  .amdhsa_float_denorm_mode_32 3
.end_amdhsa_kernel
```

```asm
; @launch kernel=p1_kernel grid=(256,1,1) block=(1024,1,1) lds=163072
; @launch kernel=p2_kernel grid=(256,1,1) block=(1024,1,1) lds=154368
; @launch kernel=p3_kernel grid=(1563,1,1) block=(256,1,1) lds=0
.amdgcn_target "amdgcn-amd-amdhsa--gfx950"
.text
.globl p1_kernel
.p2align 8
.type p1_kernel,@function
p1_kernel:
    s_cmp_ge_u32 s2, 256
    s_cbranch_scc1 p1_end
    s_load_dwordx2 s[52:53], s[0:1], 0
    s_load_dwordx4 s[56:59], s[0:1], 8
    s_load_dwordx2 s[54:55], s[0:1], 32
    s_load_dwordx2 s[60:61], s[0:1], 48
    s_load_dwordx2 s[48:49], s[0:1], 104
    s_load_dwordx2 s[62:63], s[0:1], 96
    v_lshlrev_b32 v1, 4, v0
    v_lshlrev_b32 v2, 3, v0
    v_mov_b32 v3, 1
    v_lshrrev_b32 v117, 6, v0
    s_nop 0
    v_readfirstlane_b32 s28, v117
    s_waitcnt lgkmcnt(0)
    s_load_dword s45, s[60:61], 0
    s_mov_b32 s4, s56
    s_and_b32 s5, s57, 0xffff
    s_mov_b32 s6, 204800000
    s_mov_b32 s7, 0x20000
    s_mov_b32 s8, s58
    s_and_b32 s9, s59, 0xffff
    s_mov_b32 s10, 204800000
    s_mov_b32 s11, 0x20000
    s_mov_b32 s12, s54
    s_and_b32 s13, s55, 0xffff
    s_mov_b32 s14, 102400000
    s_mov_b32 s15, 0x20000
    s_mov_b32 s16, s48
    s_and_b32 s17, s49, 0xffff
    s_mov_b32 s18, 819200000
    s_mov_b32 s19, 0x20000
    s_mov_b32 s29, s2
    s_mul_i32 s31, s2, 73728
    s_lshl_b32 s30, s31, 1
    s_add_u32 s32, s30, 0
    buffer_load_dwordx4 v[94:97], v1, s[4:7], s32 offen nt
    s_add_u32 s32, s30, 0
    buffer_load_dwordx4 v[102:105], v1, s[8:11], s32 offen nt
    s_add_u32 s32, s31, 0
    buffer_load_dwordx2 v[76:77], v2, s[12:15], s32 offen nt
    s_add_u32 s32, s30, 16384
    buffer_load_dwordx4 v[98:101], v1, s[4:7], s32 offen nt
    s_add_u32 s32, s30, 16384
    buffer_load_dwordx4 v[106:109], v1, s[8:11], s32 offen nt
    s_add_u32 s32, s31, 8192
    buffer_load_dwordx2 v[78:79], v2, s[12:15], s32 offen nt
    s_add_u32 s32, s30, 32768
    buffer_load_dwordx4 v[12:15], v1, s[4:7], s32 offen nt
    s_add_u32 s32, s30, 32768
    buffer_load_dwordx4 v[48:51], v1, s[8:11], s32 offen nt
    s_add_u32 s32, s31, 16384
    buffer_load_dwordx2 v[80:81], v2, s[12:15], s32 offen nt
    s_add_u32 s32, s30, 49152
    buffer_load_dwordx4 v[52:55], v1, s[8:11], s32 offen nt
    s_add_u32 s32, s31, 24576
    buffer_load_dwordx2 v[82:83], v2, s[12:15], s32 offen nt
    s_add_u32 s32, s31, 32768
    buffer_load_dwordx2 v[84:85], v2, s[12:15], s32 offen nt
    s_add_u32 s32, s30, 81920
    buffer_load_dwordx4 v[60:63], v1, s[8:11], s32 offen nt
    s_add_u32 s32, s31, 40960
    buffer_load_dwordx2 v[86:87], v2, s[12:15], s32 offen nt
    s_add_u32 s32, s31, 49152
    buffer_load_dwordx2 v[88:89], v2, s[12:15], s32 offen nt
    s_add_u32 s32, s30, 114688
    buffer_load_dwordx4 v[68:71], v1, s[8:11], s32 offen nt
    s_add_u32 s32, s31, 57344
    buffer_load_dwordx2 v[90:91], v2, s[12:15], s32 offen nt
    s_add_u32 s32, s31, 65536
    buffer_load_dwordx2 v[92:93], v2, s[12:15], s32 offen nt
    s_mov_b32 s24, s52
    s_and_b32 s25, s53, 0xffff
    s_mov_b32 s26, 6400000
    s_mov_b32 s27, 0x20000
    s_mov_b32 s20, s48
    s_and_b32 s21, s49, 0xffff
    s_mov_b32 s22, 0
    s_mov_b32 s23, 0x20000
    s_mov_b32 s40, s62
    s_and_b32 s41, s63, 0xffff
    s_mov_b32 s42, 256
    s_mov_b32 s43, 0x20000
    s_mov_b32 s36, 643827
    s_mov_b32 s37, 214609
    s_mov_b32 s38, 343268
    s_mov_b32 s39, -6671
    s_mov_b32 s44, -12512
    s_mov_b32 s34, 1
    v_mov_b32 v122, 0
    v_mov_b32 v123, 0
    v_mov_b32 v124, 0
    v_mov_b32 v125, 0
    ds_write_b128 v1, v[122:125] offset:0
    s_waitcnt lgkmcnt(0)
    s_barrier
    s_lshl_b32 s45, s45, 16
p1_tile:
    v_mov_b32 v122, 0
    v_mov_b32 v123, 0
    v_mov_b32 v124, 0
    v_mov_b32 v125, 0
    ds_write_b128 v1, v[122:125] offset:10496
    ds_write_b128 v1, v[122:125] offset:26880
    ds_write_b128 v1, v[122:125] offset:43264
    s_cmp_lg_u32 s28, 15
    s_cbranch_scc1 p1_tk0
    v_mov_b32 v127, 1
    s_mov_b64 exec, 1
    buffer_atomic_add v127, off, s[40:43], 0 offset:128 sc0 sc1
    s_mov_b64 exec, -1
p1_tk0:
    v_mov_b32 v123, s45
    v_mov_b32 v124, 0x007f007f
    v_mov_b32 v125, 0xe000
    v_mov_b32 v126, 0xffff0000
    s_cmp_lt_u32 s29, 1419
    s_cselect_b32 s6, 204800000, 0
    s_add_u32 s32, s30, 49152
    buffer_load_dwordx4 v[16:19], v1, s[4:7], s32 offen nt
    s_cmp_lg_u32 s34, 0
    s_cbranch_scc1 p1_w1
    s_waitcnt vmcnt(15)
p1_w1:
    s_waitcnt vmcnt(16)
    v_lshlrev_b32 v117, 16, v76
    v_and_b32 v118, v126, v76
    v_mul_f32 v117, v123, v117
    v_mul_f32 v118, v123, v118
    v_cvt_pk_bf16_f32 v117, v117, v118
    v_and_b32 v118, v126, v117
    v_lshlrev_b32 v117, 16, v117
    v_mul_f32 v117, 0.15915494, v117
    v_mul_f32 v118, 0.15915494, v118
    v_fract_f32 v117, v117
    v_fract_f32 v118, v118
    v_cos_f32 v117, v117
    v_cos_f32 v118, v118
    v_mul_hi_u32_u24 v122, s38, v102
    v_mul_hi_u32_u24 v121, s37, v94
    v_mul_hi_u32_u24 v120, s36, v94
    v_mad_i32_i24 v110, v122, s44, v102
    v_mad_u32_u24 v40, v122, 40, v121
    v_mad_i32_i24 v4, v120, s39, v94
    v_lshlrev_b16 v40, 2, v40
    v_mad_i32_i24 v120, v121, -3, v120
    ds_add_u32 v40, v3 offset:0
    v_lshl_or_b32 v4, v110, 16, v4
    v_lshl_or_b32 v4, v120, 30, v4
    v_mul_f32 v117, 0x03800000, v117
    v_mul_f32 v118, 0x03800000, v118
    v_cvt_pk_bf16_f32 v117, v117, v118
    v_mul_hi_u32_u24 v122, s38, v103
    v_mul_hi_u32_u24 v121, s37, v95
    v_mul_hi_u32_u24 v120, s36, v95
    v_mad_i32_i24 v110, v122, s44, v103
    v_mad_u32_u24 v41, v122, 40, v121
    v_mad_i32_i24 v5, v120, s39, v95
    v_lshlrev_b16 v41, 2, v41
    v_mad_i32_i24 v120, v121, -3, v120
    ds_add_u32 v41, v3 offset:0
    v_lshl_or_b32 v5, v110, 16, v5
    v_lshl_or_b32 v5, v120, 30, v5
    v_lshrrev_b32 v118, 3, v117
    v_lshrrev_b32 v119, 8, v117
    v_lshlrev_b16 v117, 13, v117
    v_bitop3_b32 v119, v118, v119, v124 bitop3:0x1b
    v_bitop3_b32 v4, v117, v125, v4 bitop3:0xae
    v_lshl_or_b32 v40, v119, 16, v40
    v_bitop3_b32 v5, v118, v125, v5 bitop3:0xae
    v_bitop3_b32 v41, v119, v126, v41 bitop3:0xea
    v_lshlrev_b32 v117, 16, v77
    v_and_b32 v118, v126, v77
    v_mul_f32 v117, v123, v117
    v_mul_f32 v118, v123, v118
    v_cvt_pk_bf16_f32 v117, v117, v118
    v_and_b32 v118, v126, v117
    v_lshlrev_b32 v117, 16, v117
    v_mul_f32 v117, 0.15915494, v117
    v_mul_f32 v118, 0.15915494, v118
    v_fract_f32 v117, v117
    v_fract_f32 v118, v118
    v_cos_f32 v117, v117
    v_cos_f32 v118, v118
    v_mul_hi_u32_u24 v122, s38, v104
    v_mul_hi_u32_u24 v121, s37, v96
    v_mul_hi_u32_u24 v120, s36, v96
    v_mad_i32_i24 v110, v122, s44, v104
    v_mad_u32_u24 v42, v122, 40, v121
    v_mad_i32_i24 v6, v120, s39, v96
    v_lshlrev_b16 v42, 2, v42
    v_mad_i32_i24 v120, v121, -3, v120
    ds_add_u32 v42, v3 offset:0
    v_lshl_or_b32 v6, v110, 16, v6
    v_lshl_or_b32 v6, v120, 30, v6
    v_mul_f32 v117, 0x03800000, v117
    v_mul_f32 v118, 0x03800000, v118
    v_cvt_pk_bf16_f32 v117, v117, v118
    v_mul_hi_u32_u24 v122, s38, v105
    v_mul_hi_u32_u24 v121, s37, v97
    v_mul_hi_u32_u24 v120, s36, v97
    v_mad_i32_i24 v110, v122, s44, v105
    v_mad_u32_u24 v43, v122, 40, v121
    v_mad_i32_i24 v7, v120, s39, v97
    v_lshlrev_b16 v43, 2, v43
    v_mad_i32_i24 v120, v121, -3, v120
    ds_add_u32 v43, v3 offset:0
    v_lshl_or_b32 v7, v110, 16, v7
    v_lshl_or_b32 v7, v120, 30, v7
    v_lshrrev_b32 v118, 3, v117
    v_lshrrev_b32 v119, 8, v117
    v_lshlrev_b16 v117, 13, v117
    v_bitop3_b32 v119, v118, v119, v124 bitop3:0x1b
    v_bitop3_b32 v6, v117, v125, v6 bitop3:0xae
    v_lshl_or_b32 v42, v119, 16, v42
    v_bitop3_b32 v7, v118, v125, v7 bitop3:0xae
    v_bitop3_b32 v43, v119, v126, v43 bitop3:0xea
    s_cmp_lt_u32 s29, 1392
    s_cselect_b32 s6, 204800000, 0
    s_add_u32 s32, s30, 65536
    buffer_load_dwordx4 v[20:23], v1, s[4:7], s32 offen nt
    s_cmp_lt_u32 s29, 1392
    s_cselect_b32 s10, 204800000, 0
    s_add_u32 s32, s30, 65536
    buffer_load_dwordx4 v[56:59], v1, s[8:11], s32 offen nt
    s_cmp_lg_u32 s34, 0
    s_cbranch_scc1 p1_w2
    s_waitcnt vmcnt(6)
p1_w2:
    s_waitcnt vmcnt(15)
    v_lshlrev_b32 v117, 16, v78
    v_and_b32 v118, v126, v78
    v_mul_f32 v117, v123, v117
    v_mul_f32 v118, v123, v118
    v_cvt_pk_bf16_f32 v117, v117, v118
    v_and_b32 v118, v126, v117
    v_lshlrev_b32 v117, 16, v117
    v_mul_f32 v117, 0.15915494, v117
    v_mul_f32 v118, 0.15915494, v118
    v_fract_f32 v117, v117
    v_fract_f32 v118, v118
    v_cos_f32 v117, v117
    v_cos_f32 v118, v118
    v_mul_hi_u32_u24 v122, s38, v106
    v_mul_hi_u32_u24 v121, s37, v98
    v_mul_hi_u32_u24 v120, s36, v98
    v_mad_i32_i24 v110, v122, s44, v106
    v_mad_u32_u24 v44, v122, 40, v121
    v_mad_i32_i24 v8, v120, s39, v98
    v_lshlrev_b16 v44, 2, v44
    v_mad_i32_i24 v120, v121, -3, v120
    ds_add_u32 v44, v3 offset:0
    v_lshl_or_b32 v8, v110, 16, v8
    v_lshl_or_b32 v8, v120, 30, v8
    v_mul_f32 v117, 0x03800000, v117
    v_mul_f32 v118, 0x03800000, v118
    v_cvt_pk_bf16_f32 v117, v117, v118
    v_mul_hi_u32_u24 v122, s38, v107
    v_mul_hi_u32_u24 v121, s37, v99
    v_mul_hi_u32_u24 v120, s36, v99
    v_mad_i32_i24 v110, v122, s44, v107
    v_mad_u32_u24 v45, v122, 40, v121
    v_mad_i32_i24 v9, v120, s39, v99
    v_lshlrev_b16 v45, 2, v45
    v_mad_i32_i24 v120, v121, -3, v120
    ds_add_u32 v45, v3 offset:0
    v_lshl_or_b32 v9, v110, 16, v9
    v_lshl_or_b32 v9, v120, 30, v9
    v_lshrrev_b32 v118, 3, v117
    v_lshrrev_b32 v119, 8, v117
    v_lshlrev_b16 v117, 13, v117
    v_bitop3_b32 v119, v118, v119, v124 bitop3:0x1b
    v_bitop3_b32 v8, v117, v125, v8 bitop3:0xae
    v_lshl_or_b32 v44, v119, 16, v44
    v_bitop3_b32 v9, v118, v125, v9 bitop3:0xae
    v_bitop3_b32 v45, v119, v126, v45 bitop3:0xea
    v_lshlrev_b32 v117, 16, v79
    v_and_b32 v118, v126, v79
    v_mul_f32 v117, v123, v117
    v_mul_f32 v118, v123, v118
    v_cvt_pk_bf16_f32 v117, v117, v118
    v_and_b32 v118, v126, v117
    v_lshlrev_b32 v117, 16, v117
    v_mul_f32 v117, 0.15915494, v117
    v_mul_f32 v118, 0.15915494, v118
    v_fract_f32 v117, v117
    v_fract_f32 v118, v118
    v_cos_f32 v117, v117
    v_cos_f32 v118, v118
    v_mul_hi_u32_u24 v122, s38, v108
    v_mul_hi_u32_u24 v121, s37, v100
    v_mul_hi_u32_u24 v120, s36, v100
    v_mad_i32_i24 v110, v122, s44, v108
    v_mad_u32_u24 v46, v122, 40, v121
    v_mad_i32_i24 v10, v120, s39, v100
    v_lshlrev_b16 v46, 2, v46
    v_mad_i32_i24 v120, v121, -3, v120
    ds_add_u32 v46, v3 offset:0
    v_lshl_or_b32 v10, v110, 16, v10
    v_lshl_or_b32 v10, v120, 30, v10
    v_mul_f32 v117, 0x03800000, v117
    v_mul_f32 v118, 0x03800000, v118
    v_cvt_pk_bf16_f32 v117, v117, v118
    v_mul_hi_u32_u24 v122, s38, v109
    v_mul_hi_u32_u24 v121, s37, v101
    v_mul_hi_u32_u24 v120, s36, v101
    v_mad_i32_i24 v110, v122, s44, v109
    v_mad_u32_u24 v47, v122, 40, v121
    v_mad_i32_i24 v11, v120, s39, v101
    v_lshlrev_b16 v47, 2, v47
    v_mad_i32_i24 v120, v121, -3, v120
    ds_add_u32 v47, v3 offset:0
    v_lshl_or_b32 v11, v110, 16, v11
    v_lshl_or_b32 v11, v120, 30, v11
    v_lshrrev_b32 v118, 3, v117
    v_lshrrev_b32 v119, 8, v117
    v_lshlrev_b16 v117, 13, v117
    v_bitop3_b32 v119, v118, v119, v124 bitop3:0x1b
    v_bitop3_b32 v10, v117, v125, v10 bitop3:0xae
    v_lshl_or_b32 v46, v119, 16, v46
    v_bitop3_b32 v11, v118, v125, v11 bitop3:0xae
    v_bitop3_b32 v47, v119, v126, v47 bitop3:0xea
    s_cmp_lt_u32 s29, 1365
    s_cselect_b32 s6, 204800000, 0
    s_add_u32 s32, s30, 81920
    buffer_load_dwordx4 v[24:27], v1, s[4:7], s32 offen nt
    s_cmp_ge_u32 s29, 1445
    s_cbranch_scc1 p1_k3
    s_cmp_lg_u32 s34, 0
    s_cbranch_scc1 p1_w4
    s_waitcnt vmcnt(4)
p1_w4:
    s_waitcnt vmcnt(9)
    v_lshlrev_b32 v117, 16, v80
    v_and_b32 v118, v126, v80
    v_mul_f32 v117, v123, v117
    v_mul_f32 v118, v123, v118
    v_cvt_pk_bf16_f32 v117, v117, v118
    v_and_b32 v118, v126, v117
    v_lshlrev_b32 v117, 16, v117
    v_mul_f32 v117, 0.15915494, v117
    v_mul_f32 v118, 0.15915494, v118
    v_fract_f32 v117, v117
    v_fract_f32 v118, v118
    v_cos_f32 v117, v117
    v_cos_f32 v118, v118
    v_mul_hi_u32_u24 v122, s38, v48
    v_mul_hi_u32_u24 v121, s37, v12
    v_mul_hi_u32_u24 v120, s36, v12
    v_mad_i32_i24 v110, v122, s44, v48
    v_mad_u32_u24 v48, v122, 40, v121
    v_mad_i32_i24 v12, v120, s39, v12
    v_lshlrev_b16 v48, 2, v48
    v_mad_i32_i24 v120, v121, -3, v120
    ds_add_u32 v48, v3 offset:0
    v_lshl_or_b32 v12, v110, 16, v12
    v_lshl_or_b32 v12, v120, 30, v12
    v_mul_f32 v117, 0x03800000, v117
    v_mul_f32 v118, 0x03800000, v118
    v_cvt_pk_bf16_f32 v117, v117, v118
    v_mul_hi_u32_u24 v122, s38, v49
    v_mul_hi_u32_u24 v121, s37, v13
    v_mul_hi_u32_u24 v120, s36, v13
    v_mad_i32_i24 v110, v122, s44, v49
    v_mad_u32_u24 v49, v122, 40, v121
    v_mad_i32_i24 v13, v120, s39, v13
    v_lshlrev_b16 v49, 2, v49
    v_mad_i32_i24 v120, v121, -3, v120
    ds_add_u32 v49, v3 offset:0
    v_lshl_or_b32 v13, v110, 16, v13
    v_lshl_or_b32 v13, v120, 30, v13
    v_lshrrev_b32 v118, 3, v117
    v_lshrrev_b32 v119, 8, v117
    v_lshlrev_b16 v117, 13, v117
    v_bitop3_b32 v119, v118, v119, v124 bitop3:0x1b
    v_bitop3_b32 v12, v117, v125, v12 bitop3:0xae
    v_lshl_or_b32 v48, v119, 16, v48
    v_bitop3_b32 v13, v118, v125, v13 bitop3:0xae
    v_bitop3_b32 v49, v119, v126, v49 bitop3:0xea
    v_lshlrev_b32 v117, 16, v81
    v_and_b32 v118, v126, v81
    v_mul_f32 v117, v123, v117
    v_mul_f32 v118, v123, v118
    v_cvt_pk_bf16_f32 v117, v117, v118
    v_and_b32 v118, v126, v117
    v_lshlrev_b32 v117, 16, v117
    v_mul_f32 v117, 0.15915494, v117
    v_mul_f32 v118, 0.15915494, v118
    v_fract_f32 v117, v117
    v_fract_f32 v118, v118
    v_cos_f32 v117, v117
    v_cos_f32 v118, v118
    v_mul_hi_u32_u24 v122, s38, v50
    v_mul_hi_u32_u24 v121, s37, v14
    v_mul_hi_u32_u24 v120, s36, v14
    v_mad_i32_i24 v110, v122, s44, v50
    v_mad_u32_u24 v50, v122, 40, v121
    v_mad_i32_i24 v14, v120, s39, v14
    v_lshlrev_b16 v50, 2, v50
    v_mad_i32_i24 v120, v121, -3, v120
    ds_add_u32 v50, v3 offset:0
    v_lshl_or_b32 v14, v110, 16, v14
    v_lshl_or_b32 v14, v120, 30, v14
    v_mul_f32 v117, 0x03800000, v117
    v_mul_f32 v118, 0x03800000, v118
    v_cvt_pk_bf16_f32 v117, v117, v118
    v_mul_hi_u32_u24 v122, s38, v51
    v_mul_hi_u32_u24 v121, s37, v15
    v_mul_hi_u32_u24 v120, s36, v15
    v_mad_i32_i24 v110, v122, s44, v51
    v_mad_u32_u24 v51, v122, 40, v121
    v_mad_i32_i24 v15, v120, s39, v15
    v_lshlrev_b16 v51, 2, v51
    v_mad_i32_i24 v120, v121, -3, v120
    ds_add_u32 v51, v3 offset:0
    v_lshl_or_b32 v15, v110, 16, v15
    v_lshl_or_b32 v15, v120, 30, v15
    v_lshrrev_b32 v118, 3, v117
    v_lshrrev_b32 v119, 8, v117
    v_lshlrev_b16 v117, 13, v117
    v_bitop3_b32 v119, v118, v119, v124 bitop3:0x1b
    v_bitop3_b32 v14, v117, v125, v14 bitop3:0xae
    v_lshl_or_b32 v50, v119, 16, v50
    v_bitop3_b32 v15, v118, v125, v15 bitop3:0xae
    v_bitop3_b32 v51, v119, v126, v51 bitop3:0xea
p1_k3:
    s_cmp_lt_u32 s29, 1338
    s_cselect_b32 s6, 204800000, 0
    s_add_u32 s32, s30, 98304
    buffer_load_dwordx4 v[28:31], v1, s[4:7], s32 offen nt
    s_cmp_lt_u32 s29, 1338
    s_cselect_b32 s10, 204800000, 0
    s_add_u32 s32, s30, 98304
    buffer_load_dwordx4 v[64:67], v1, s[8:11], s32 offen nt
    s_cmp_ge_u32 s29, 1419
    s_cbranch_scc1 p1_k5
    s_waitcnt vmcnt(5)
    v_lshlrev_b32 v117, 16, v82
    v_and_b32 v118, v126, v82
    v_mul_f32 v117, v123, v117
    v_mul_f32 v118, v123, v118
    v_cvt_pk_bf16_f32 v117, v117, v118
    v_and_b32 v118, v126, v117
    v_lshlrev_b32 v117, 16, v117
    v_mul_f32 v117, 0.15915494, v117
    v_mul_f32 v118, 0.15915494, v118
    v_fract_f32 v117, v117
    v_fract_f32 v118, v118
    v_cos_f32 v117, v117
    v_cos_f32 v118, v118
    v_mul_hi_u32_u24 v122, s38, v52
    v_mul_hi_u32_u24 v121, s37, v16
    v_mul_hi_u32_u24 v120, s36, v16
    v_mad_i32_i24 v110, v122, s44, v52
    v_mad_u32_u24 v52, v122, 40, v121
    v_mad_i32_i24 v16, v120, s39, v16
    v_lshlrev_b16 v52, 2, v52
    v_mad_i32_i24 v120, v121, -3, v120
    ds_add_u32 v52, v3 offset:0
    v_lshl_or_b32 v16, v110, 16, v16
    v_lshl_or_b32 v16, v120, 30, v16
    v_mul_f32 v117, 0x03800000, v117
    v_mul_f32 v118, 0x03800000, v118
    v_cvt_pk_bf16_f32 v117, v117, v118
    v_mul_hi_u32_u24 v122, s38, v53
    v_mul_hi_u32_u24 v121, s37, v17
    v_mul_hi_u32_u24 v120, s36, v17
    v_mad_i32_i24 v110, v122, s44, v53
    v_mad_u32_u24 v53, v122, 40, v121
    v_mad_i32_i24 v17, v120, s39, v17
    v_lshlrev_b16 v53, 2, v53
    v_mad_i32_i24 v120, v121, -3, v120
    ds_add_u32 v53, v3 offset:0
    v_lshl_or_b32 v17, v110, 16, v17
    v_lshl_or_b32 v17, v120, 30, v17
    v_lshrrev_b32 v118, 3, v117
    v_lshrrev_b32 v119, 8, v117
    v_lshlrev_b16 v117, 13, v117
    v_bitop3_b32 v119, v118, v119, v124 bitop3:0x1b
    v_bitop3_b32 v16, v117, v125, v16 bitop3:0xae
    v_lshl_or_b32 v52, v119, 16, v52
    v_bitop3_b32 v17, v118, v125, v17 bitop3:0xae
    v_bitop3_b32 v53, v119, v126, v53 bitop3:0xea
    v_lshlrev_b32 v117, 16, v83
    v_and_b32 v118, v126, v83
    v_mul_f32 v117, v123, v117
    v_mul_f32 v118, v123, v118
    v_cvt_pk_bf16_f32 v117, v117, v118
    v_and_b32 v118, v126, v117
    v_lshlrev_b32 v117, 16, v117
    v_mul_f32 v117, 0.15915494, v117
    v_mul_f32 v118, 0.15915494, v118
    v_fract_f32 v117, v117
    v_fract_f32 v118, v118
    v_cos_f32 v117, v117
    v_cos_f32 v118, v118
    v_mul_hi_u32_u24 v122, s38, v54
    v_mul_hi_u32_u24 v121, s37, v18
    v_mul_hi_u32_u24 v120, s36, v18
    v_mad_i32_i24 v110, v122, s44, v54
    v_mad_u32_u24 v54, v122, 40, v121
    v_mad_i32_i24 v18, v120, s39, v18
    v_lshlrev_b16 v54, 2, v54
    v_mad_i32_i24 v120, v121, -3, v120
    ds_add_u32 v54, v3 offset:0
    v_lshl_or_b32 v18, v110, 16, v18
    v_lshl_or_b32 v18, v120, 30, v18
    v_mul_f32 v117, 0x03800000, v117
    v_mul_f32 v118, 0x03800000, v118
    v_cvt_pk_bf16_f32 v117, v117, v118
    v_mul_hi_u32_u24 v122, s38, v55
    v_mul_hi_u32_u24 v121, s37, v19
    v_mul_hi_u32_u24 v120, s36, v19
    v_mad_i32_i24 v110, v122, s44, v55
    v_mad_u32_u24 v55, v122, 40, v121
    v_mad_i32_i24 v19, v120, s39, v19
    v_lshlrev_b16 v55, 2, v55
    v_mad_i32_i24 v120, v121, -3, v120
    ds_add_u32 v55, v3 offset:0
    v_lshl_or_b32 v19, v110, 16, v19
    v_lshl_or_b32 v19, v120, 30, v19
    v_lshrrev_b32 v118, 3, v117
    v_lshrrev_b32 v119, 8, v117
    v_lshlrev_b16 v117, 13, v117
    v_bitop3_b32 v119, v118, v119, v124 bitop3:0x1b
    v_bitop3_b32 v18, v117, v125, v18 bitop3:0xae
    v_lshl_or_b32 v54, v119, 16, v54
    v_bitop3_b32 v19, v118, v125, v19 bitop3:0xae
    v_bitop3_b32 v55, v119, v126, v55 bitop3:0xea
p1_k5:
    s_cmp_lt_u32 s29, 1312
    s_cselect_b32 s6, 204800000, 0
    s_add_u32 s32, s30, 114688
    buffer_load_dwordx4 v[32:35], v1, s[4:7], s32 offen nt
    s_cmp_ge_u32 s29, 1392
    s_cbranch_scc1 p1_k7
    s_waitcnt vmcnt(4)
    v_lshlrev_b32 v117, 16, v84
    v_and_b32 v118, v126, v84
    v_mul_f32 v117, v123, v117
    v_mul_f32 v118, v123, v118
    v_cvt_pk_bf16_f32 v117, v117, v118
    v_and_b32 v118, v126, v117
    v_lshlrev_b32 v117, 16, v117
    v_mul_f32 v117, 0.15915494, v117
    v_mul_f32 v118, 0.15915494, v118
    v_fract_f32 v117, v117
    v_fract_f32 v118, v118
    v_cos_f32 v117, v117
    v_cos_f32 v118, v118
    v_mul_hi_u32_u24 v122, s38, v56
    v_mul_hi_u32_u24 v121, s37, v20
    v_mul_hi_u32_u24 v120, s36, v20
    v_mad_i32_i24 v110, v122, s44, v56
    v_mad_u32_u24 v56, v122, 40, v121
    v_mad_i32_i24 v20, v120, s39, v20
    v_lshlrev_b16 v56, 2, v56
    v_mad_i32_i24 v120, v121, -3, v120
    ds_add_u32 v56, v3 offset:0
    v_lshl_or_b32 v20, v110, 16, v20
    v_lshl_or_b32 v20, v120, 30, v20
    v_mul_f32 v117, 0x03800000, v117
    v_mul_f32 v118, 0x03800000, v118
    v_cvt_pk_bf16_f32 v117, v117, v118
    v_mul_hi_u32_u24 v122, s38, v57
    v_mul_hi_u32_u24 v121, s37, v21
    v_mul_hi_u32_u24 v120, s36, v21
    v_mad_i32_i24 v110, v122, s44, v57
    v_mad_u32_u24 v57, v122, 40, v121
    v_mad_i32_i24 v21, v120, s39, v21
    v_lshlrev_b16 v57, 2, v57
    v_mad_i32_i24 v120, v121, -3, v120
    ds_add_u32 v57, v3 offset:0
    v_lshl_or_b32 v21, v110, 16, v21
    v_lshl_or_b32 v21, v120, 30, v21
    v_lshrrev_b32 v118, 3, v117
    v_lshrrev_b32 v119, 8, v117
    v_lshlrev_b16 v117, 13, v117
    v_bitop3_b32 v119, v118, v119, v124 bitop3:0x1b
    v_bitop3_b32 v20, v117, v125, v20 bitop3:0xae
    v_lshl_or_b32 v56, v119, 16, v56
    v_bitop3_b32 v21, v118, v125, v21 bitop3:0xae
    v_bitop3_b32 v57, v119, v126, v57 bitop3:0xea
    v_lshlrev_b32 v117, 16, v85
    v_and_b32 v118, v126, v85
    v_mul_f32 v117, v123, v117
    v_mul_f32 v118, v123, v118
    v_cvt_pk_bf16_f32 v117, v117, v118
    v_and_b32 v118, v126, v117
    v_lshlrev_b32 v117, 16, v117
    v_mul_f32 v117, 0.15915494, v117
    v_mul_f32 v118, 0.15915494, v118
    v_fract_f32 v117, v117
    v_fract_f32 v118, v118
    v_cos_f32 v117, v117
    v_cos_f32 v118, v118
    v_mul_hi_u32_u24 v122, s38, v58
    v_mul_hi_u32_u24 v121, s37, v22
    v_mul_hi_u32_u24 v120, s36, v22
    v_mad_i32_i24 v110, v122, s44, v58
    v_mad_u32_u24 v58, v122, 40, v121
    v_mad_i32_i24 v22, v120, s39, v22
    v_lshlrev_b16 v58, 2, v58
    v_mad_i32_i24 v120, v121, -3, v120
    ds_add_u32 v58, v3 offset:0
    v_lshl_or_b32 v22, v110, 16, v22
    v_lshl_or_b32 v22, v120, 30, v22
    v_mul_f32 v117, 0x03800000, v117
    v_mul_f32 v118, 0x03800000, v118
    v_cvt_pk_bf16_f32 v117, v117, v118
    v_mul_hi_u32_u24 v122, s38, v59
    v_mul_hi_u32_u24 v121, s37, v23
    v_mul_hi_u32_u24 v120, s36, v23
    v_mad_i32_i24 v110, v122, s44, v59
    v_mad_u32_u24 v59, v122, 40, v121
    v_mad_i32_i24 v23, v120, s39, v23
    v_lshlrev_b16 v59, 2, v59
    v_mad_i32_i24 v120, v121, -3, v120
    ds_add_u32 v59, v3 offset:0
    v_lshl_or_b32 v23, v110, 16, v23
    v_lshl_or_b32 v23, v120, 30, v23
    v_lshrrev_b32 v118, 3, v117
    v_lshrrev_b32 v119, 8, v117
    v_lshlrev_b16 v117, 13, v117
    v_bitop3_b32 v119, v118, v119, v124 bitop3:0x1b
    v_bitop3_b32 v22, v117, v125, v22 bitop3:0xae
    v_lshl_or_b32 v58, v119, 16, v58
    v_bitop3_b32 v23, v118, v125, v23 bitop3:0xae
    v_bitop3_b32 v59, v119, v126, v59 bitop3:0xea
p1_k7:
    s_cmp_lt_u32 s29, 1285
    s_cselect_b32 s6, 204800000, 0
    s_add_u32 s32, s30, 131072
    buffer_load_dwordx4 v[36:39], v1, s[4:7], s32 offen nt
    s_cmp_lt_u32 s29, 1285
    s_cselect_b32 s10, 204800000, 0
    s_add_u32 s32, s30, 131072
    buffer_load_dwordx4 v[72:75], v1, s[8:11], s32 offen nt
    s_cmp_ge_u32 s29, 1365
    s_cbranch_scc1 p1_k9
    s_waitcnt vmcnt(5)
    v_lshlrev_b32 v117, 16, v86
    v_and_b32 v118, v126, v86
    v_mul_f32 v117, v123, v117
    v_mul_f32 v118, v123, v118
    v_cvt_pk_bf16_f32 v117, v117, v118
    v_and_b32 v118, v126, v117
    v_lshlrev_b32 v117, 16, v117
    v_mul_f32 v117, 0.15915494, v117
    v_mul_f32 v118, 0.15915494, v118
    v_fract_f32 v117, v117
    v_fract_f32 v118, v118
    v_cos_f32 v117, v117
    v_cos_f32 v118, v118
    v_mul_hi_u32_u24 v122, s38, v60
    v_mul_hi_u32_u24 v121, s37, v24
    v_mul_hi_u32_u24 v120, s36, v24
    v_mad_i32_i24 v110, v122, s44, v60
    v_mad_u32_u24 v60, v122, 40, v121
    v_mad_i32_i24 v24, v120, s39, v24
    v_lshlrev_b16 v60, 2, v60
    v_mad_i32_i24 v120, v121, -3, v120
    ds_add_u32 v60, v3 offset:0
    v_lshl_or_b32 v24, v110, 16, v24
    v_lshl_or_b32 v24, v120, 30, v24
    v_mul_f32 v117, 0x03800000, v117
    v_mul_f32 v118, 0x03800000, v118
    v_cvt_pk_bf16_f32 v117, v117, v118
    v_mul_hi_u32_u24 v122, s38, v61
    v_mul_hi_u32_u24 v121, s37, v25
    v_mul_hi_u32_u24 v120, s36, v25
    v_mad_i32_i24 v110, v122, s44, v61
    v_mad_u32_u24 v61, v122, 40, v121
    v_mad_i32_i24 v25, v120, s39, v25
    v_lshlrev_b16 v61, 2, v61
    v_mad_i32_i24 v120, v121, -3, v120
    ds_add_u32 v61, v3 offset:0
    v_lshl_or_b32 v25, v110, 16, v25
    v_lshl_or_b32 v25, v120, 30, v25
    v_lshrrev_b32 v118, 3, v117
    v_lshrrev_b32 v119, 8, v117
    v_lshlrev_b16 v117, 13, v117
    v_bitop3_b32 v119, v118, v119, v124 bitop3:0x1b
    v_bitop3_b32 v24, v117, v125, v24 bitop3:0xae
    v_lshl_or_b32 v60, v119, 16, v60
    v_bitop3_b32 v25, v118, v125, v25 bitop3:0xae
    v_bitop3_b32 v61, v119, v126, v61 bitop3:0xea
    v_lshlrev_b32 v117, 16, v87
    v_and_b32 v118, v126, v87
    v_mul_f32 v117, v123, v117
    v_mul_f32 v118, v123, v118
    v_cvt_pk_bf16_f32 v117, v117, v118
    v_and_b32 v118, v126, v117
    v_lshlrev_b32 v117, 16, v117
    v_mul_f32 v117, 0.15915494, v117
    v_mul_f32 v118, 0.15915494, v118
    v_fract_f32 v117, v117
    v_fract_f32 v118, v118
    v_cos_f32 v117, v117
    v_cos_f32 v118, v118
    v_mul_hi_u32_u24 v122, s38, v62
    v_mul_hi_u32_u24 v121, s37, v26
    v_mul_hi_u32_u24 v120, s36, v26
    v_mad_i32_i24 v110, v122, s44, v62
    v_mad_u32_u24 v62, v122, 40, v121
    v_mad_i32_i24 v26, v120, s39, v26
    v_lshlrev_b16 v62, 2, v62
    v_mad_i32_i24 v120, v121, -3, v120
    ds_add_u32 v62, v3 offset:0
    v_lshl_or_b32 v26, v110, 16, v26
    v_lshl_or_b32 v26, v120, 30, v26
    v_mul_f32 v117, 0x03800000, v117
    v_mul_f32 v118, 0x03800000, v118
    v_cvt_pk_bf16_f32 v117, v117, v118
    v_mul_hi_u32_u24 v122, s38, v63
    v_mul_hi_u32_u24 v121, s37, v27
    v_mul_hi_u32_u24 v120, s36, v27
    v_mad_i32_i24 v110, v122, s44, v63
    v_mad_u32_u24 v63, v122, 40, v121
    v_mad_i32_i24 v27, v120, s39, v27
    v_lshlrev_b16 v63, 2, v63
    v_mad_i32_i24 v120, v121, -3, v120
    ds_add_u32 v63, v3 offset:0
    v_lshl_or_b32 v27, v110, 16, v27
    v_lshl_or_b32 v27, v120, 30, v27
    v_lshrrev_b32 v118, 3, v117
    v_lshrrev_b32 v119, 8, v117
    v_lshlrev_b16 v117, 13, v117
    v_bitop3_b32 v119, v118, v119, v124 bitop3:0x1b
    v_bitop3_b32 v26, v117, v125, v26 bitop3:0xae
    v_lshl_or_b32 v62, v119, 16, v62
    v_bitop3_b32 v27, v118, v125, v27 bitop3:0xae
    v_bitop3_b32 v63, v119, v126, v63 bitop3:0xea
p1_k9:
    s_cmp_ge_u32 s29, 1338
    s_cbranch_scc1 p1_k11
    s_waitcnt vmcnt(3)
    v_lshlrev_b32 v117, 16, v88
    v_and_b32 v118, v126, v88
    v_mul_f32 v117, v123, v117
    v_mul_f32 v118, v123, v118
    v_cvt_pk_bf16_f32 v117, v117, v118
    v_and_b32 v118, v126, v117
    v_lshlrev_b32 v117, 16, v117
    v_mul_f32 v117, 0.15915494, v117
    v_mul_f32 v118, 0.15915494, v118
    v_fract_f32 v117, v117
    v_fract_f32 v118, v118
    v_cos_f32 v117, v117
    v_cos_f32 v118, v118
    v_mul_hi_u32_u24 v122, s38, v64
    v_mul_hi_u32_u24 v121, s37, v28
    v_mul_hi_u32_u24 v120, s36, v28
    v_mad_i32_i24 v110, v122, s44, v64
    v_mad_u32_u24 v64, v122, 40, v121
    v_mad_i32_i24 v28, v120, s39, v28
    v_lshlrev_b16 v64, 2, v64
    v_mad_i32_i24 v120, v121, -3, v120
    ds_add_u32 v64, v3 offset:0
    v_lshl_or_b32 v28, v110, 16, v28
    v_lshl_or_b32 v28, v120, 30, v28
    v_mul_f32 v117, 0x03800000, v117
    v_mul_f32 v118, 0x03800000, v118
    v_cvt_pk_bf16_f32 v117, v117, v118
    v_mul_hi_u32_u24 v122, s38, v65
    v_mul_hi_u32_u24 v121, s37, v29
    v_mul_hi_u32_u24 v120, s36, v29
    v_mad_i32_i24 v110, v122, s44, v65
    v_mad_u32_u24 v65, v122, 40, v121
    v_mad_i32_i24 v29, v120, s39, v29
    v_lshlrev_b16 v65, 2, v65
    v_mad_i32_i24 v120, v121, -3, v120
    ds_add_u32 v65, v3 offset:0
    v_lshl_or_b32 v29, v110, 16, v29
    v_lshl_or_b32 v29, v120, 30, v29
    v_lshrrev_b32 v118, 3, v117
    v_lshrrev_b32 v119, 8, v117
    v_lshlrev_b16 v117, 13, v117
    v_bitop3_b32 v119, v118, v119, v124 bitop3:0x1b
    v_bitop3_b32 v28, v117, v125, v28 bitop3:0xae
    v_lshl_or_b32 v64, v119, 16, v64
    v_bitop3_b32 v29, v118, v125, v29 bitop3:0xae
    v_bitop3_b32 v65, v119, v126, v65 bitop3:0xea
    v_lshlrev_b32 v117, 16, v89
    v_and_b32 v118, v126, v89
    v_mul_f32 v117, v123, v117
    v_mul_f32 v118, v123, v118
    v_cvt_pk_bf16_f32 v117, v117, v118
    v_and_b32 v118, v126, v117
    v_lshlrev_b32 v117, 16, v117
    v_mul_f32 v117, 0.15915494, v117
    v_mul_f32 v118, 0.15915494, v118
    v_fract_f32 v117, v117
    v_fract_f32 v118, v118
    v_cos_f32 v117, v117
    v_cos_f32 v118, v118
    v_mul_hi_u32_u24 v122, s38, v66
    v_mul_hi_u32_u24 v121, s37, v30
    v_mul_hi_u32_u24 v120, s36, v30
    v_mad_i32_i24 v110, v122, s44, v66
    v_mad_u32_u24 v66, v122, 40, v121
    v_mad_i32_i24 v30, v120, s39, v30
    v_lshlrev_b16 v66, 2, v66
    v_mad_i32_i24 v120, v121, -3, v120
    ds_add_u32 v66, v3 offset:0
    v_lshl_or_b32 v30, v110, 16, v30
    v_lshl_or_b32 v30, v120, 30, v30
    v_mul_f32 v117, 0x03800000, v117
    v_mul_f32 v118, 0x03800000, v118
    v_cvt_pk_bf16_f32 v117, v117, v118
    v_mul_hi_u32_u24 v122, s38, v67
    v_mul_hi_u32_u24 v121, s37, v31
    v_mul_hi_u32_u24 v120, s36, v31
    v_mad_i32_i24 v110, v122, s44, v67
    v_mad_u32_u24 v67, v122, 40, v121
    v_mad_i32_i24 v31, v120, s39, v31
    v_lshlrev_b16 v67, 2, v67
    v_mad_i32_i24 v120, v121, -3, v120
    ds_add_u32 v67, v3 offset:0
    v_lshl_or_b32 v31, v110, 16, v31
    v_lshl_or_b32 v31, v120, 30, v31
    v_lshrrev_b32 v118, 3, v117
    v_lshrrev_b32 v119, 8, v117
    v_lshlrev_b16 v117, 13, v117
    v_bitop3_b32 v119, v118, v119, v124 bitop3:0x1b
    v_bitop3_b32 v30, v117, v125, v30 bitop3:0xae
    v_lshl_or_b32 v66, v119, 16, v66
    v_bitop3_b32 v31, v118, v125, v31 bitop3:0xae
    v_bitop3_b32 v67, v119, v126, v67 bitop3:0xea
p1_k11:
    s_cmp_ge_u32 s29, 1312
    s_cbranch_scc1 p1_k13
    s_waitcnt vmcnt(2)
    v_lshlrev_b32 v117, 16, v90
    v_and_b32 v118, v126, v90
    v_mul_f32 v117, v123, v117
    v_mul_f32 v118, v123, v118
    v_cvt_pk_bf16_f32 v117, v117, v118
    v_and_b32 v118, v126, v117
    v_lshlrev_b32 v117, 16, v117
    v_mul_f32 v117, 0.15915494, v117
    v_mul_f32 v118, 0.15915494, v118
    v_fract_f32 v117, v117
    v_fract_f32 v118, v118
    v_cos_f32 v117, v117
    v_cos_f32 v118, v118
    v_mul_hi_u32_u24 v122, s38, v68
    v_mul_hi_u32_u24 v121, s37, v32
    v_mul_hi_u32_u24 v120, s36, v32
    v_mad_i32_i24 v110, v122, s44, v68
    v_mad_u32_u24 v68, v122, 40, v121
    v_mad_i32_i24 v32, v120, s39, v32
    v_lshlrev_b16 v68, 2, v68
    v_mad_i32_i24 v120, v121, -3, v120
    ds_add_u32 v68, v3 offset:0
    v_lshl_or_b32 v32, v110, 16, v32
    v_lshl_or_b32 v32, v120, 30, v32
    v_mul_f32 v117, 0x03800000, v117
    v_mul_f32 v118, 0x03800000, v118
    v_cvt_pk_bf16_f32 v117, v117, v118
    v_mul_hi_u32_u24 v122, s38, v69
    v_mul_hi_u32_u24 v121, s37, v33
    v_mul_hi_u32_u24 v120, s36, v33
    v_mad_i32_i24 v110, v122, s44, v69
    v_mad_u32_u24 v69, v122, 40, v121
    v_mad_i32_i24 v33, v120, s39, v33
    v_lshlrev_b16 v69, 2, v69
    v_mad_i32_i24 v120, v121, -3, v120
    ds_add_u32 v69, v3 offset:0
    v_lshl_or_b32 v33, v110, 16, v33
    v_lshl_or_b32 v33, v120, 30, v33
    v_lshrrev_b32 v118, 3, v117
    v_lshrrev_b32 v119, 8, v117
    v_lshlrev_b16 v117, 13, v117
    v_bitop3_b32 v119, v118, v119, v124 bitop3:0x1b
    v_bitop3_b32 v32, v117, v125, v32 bitop3:0xae
    v_lshl_or_b32 v68, v119, 16, v68
    v_bitop3_b32 v33, v118, v125, v33 bitop3:0xae
    v_bitop3_b32 v69, v119, v126, v69 bitop3:0xea
    v_lshlrev_b32 v117, 16, v91
    v_and_b32 v118, v126, v91
    v_mul_f32 v117, v123, v117
    v_mul_f32 v118, v123, v118
    v_cvt_pk_bf16_f32 v117, v117, v118
    v_and_b32 v118, v126, v117
    v_lshlrev_b32 v117, 16, v117
    v_mul_f32 v117, 0.15915494, v117
    v_mul_f32 v118, 0.15915494, v118
    v_fract_f32 v117, v117
    v_fract_f32 v118, v118
    v_cos_f32 v117, v117
    v_cos_f32 v118, v118
    v_mul_hi_u32_u24 v122, s38, v70
    v_mul_hi_u32_u24 v121, s37, v34
    v_mul_hi_u32_u24 v120, s36, v34
    v_mad_i32_i24 v110, v122, s44, v70
    v_mad_u32_u24 v70, v122, 40, v121
    v_mad_i32_i24 v34, v120, s39, v34
    v_lshlrev_b16 v70, 2, v70
    v_mad_i32_i24 v120, v121, -3, v120
    ds_add_u32 v70, v3 offset:0
    v_lshl_or_b32 v34, v110, 16, v34
    v_lshl_or_b32 v34, v120, 30, v34
    v_mul_f32 v117, 0x03800000, v117
    v_mul_f32 v118, 0x03800000, v118
    v_cvt_pk_bf16_f32 v117, v117, v118
    v_mul_hi_u32_u24 v122, s38, v71
    v_mul_hi_u32_u24 v121, s37, v35
    v_mul_hi_u32_u24 v120, s36, v35
    v_mad_i32_i24 v110, v122, s44, v71
    v_mad_u32_u24 v71, v122, 40, v121
    v_mad_i32_i24 v35, v120, s39, v35
    v_lshlrev_b16 v71, 2, v71
    v_mad_i32_i24 v120, v121, -3, v120
    ds_add_u32 v71, v3 offset:0
    v_lshl_or_b32 v35, v110, 16, v35
    v_lshl_or_b32 v35, v120, 30, v35
    v_lshrrev_b32 v118, 3, v117
    v_lshrrev_b32 v119, 8, v117
    v_lshlrev_b16 v117, 13, v117
    v_bitop3_b32 v119, v118, v119, v124 bitop3:0x1b
    v_bitop3_b32 v34, v117, v125, v34 bitop3:0xae
    v_lshl_or_b32 v70, v119, 16, v70
    v_bitop3_b32 v35, v118, v125, v35 bitop3:0xae
    v_bitop3_b32 v71, v119, v126, v71 bitop3:0xea
p1_k13:
    s_cmp_ge_u32 s29, 1285
    s_cbranch_scc1 p1_k15
    s_waitcnt vmcnt(0)
    v_lshlrev_b32 v117, 16, v92
    v_and_b32 v118, v126, v92
    v_mul_f32 v117, v123, v117
    v_mul_f32 v118, v123, v118
    v_cvt_pk_bf16_f32 v117, v117, v118
    v_and_b32 v118, v126, v117
    v_lshlrev_b32 v117, 16, v117
    v_mul_f32 v117, 0.15915494, v117
    v_mul_f32 v118, 0.15915494, v118
    v_fract_f32 v117, v117
    v_fract_f32 v118, v118
    v_cos_f32 v117, v117
    v_cos_f32 v118, v118
    v_mul_hi_u32_u24 v122, s38, v72
    v_mul_hi_u32_u24 v121, s37, v36
    v_mul_hi_u32_u24 v120, s36, v36
    v_mad_i32_i24 v110, v122, s44, v72
    v_mad_u32_u24 v72, v122, 40, v121
    v_mad_i32_i24 v36, v120, s39, v36
    v_lshlrev_b16 v72, 2, v72
    v_mad_i32_i24 v120, v121, -3, v120
    ds_add_u32 v72, v3 offset:0
    v_lshl_or_b32 v36, v110, 16, v36
    v_lshl_or_b32 v36, v120, 30, v36
    v_mul_f32 v117, 0x03800000, v117
    v_mul_f32 v118, 0x03800000, v118
    v_cvt_pk_bf16_f32 v117, v117, v118
    v_mul_hi_u32_u24 v122, s38, v73
    v_mul_hi_u32_u24 v121, s37, v37
    v_mul_hi_u32_u24 v120, s36, v37
    v_mad_i32_i24 v110, v122, s44, v73
    v_mad_u32_u24 v73, v122, 40, v121
    v_mad_i32_i24 v37, v120, s39, v37
    v_lshlrev_b16 v73, 2, v73
    v_mad_i32_i24 v120, v121, -3, v120
    ds_add_u32 v73, v3 offset:0
    v_lshl_or_b32 v37, v110, 16, v37
    v_lshl_or_b32 v37, v120, 30, v37
    v_lshrrev_b32 v118, 3, v117
    v_lshrrev_b32 v119, 8, v117
    v_lshlrev_b16 v117, 13, v117
    v_bitop3_b32 v119, v118, v119, v124 bitop3:0x1b
    v_bitop3_b32 v36, v117, v125, v36 bitop3:0xae
    v_lshl_or_b32 v72, v119, 16, v72
    v_bitop3_b32 v37, v118, v125, v37 bitop3:0xae
    v_bitop3_b32 v73, v119, v126, v73 bitop3:0xea
    v_lshlrev_b32 v117, 16, v93
    v_and_b32 v118, v126, v93
    v_mul_f32 v117, v123, v117
    v_mul_f32 v118, v123, v118
    v_cvt_pk_bf16_f32 v117, v117, v118
    v_and_b32 v118, v126, v117
    v_lshlrev_b32 v117, 16, v117
    v_mul_f32 v117, 0.15915494, v117
    v_mul_f32 v118, 0.15915494, v118
    v_fract_f32 v117, v117
    v_fract_f32 v118, v118
    v_cos_f32 v117, v117
    v_cos_f32 v118, v118
    v_mul_hi_u32_u24 v122, s38, v74
    v_mul_hi_u32_u24 v121, s37, v38
    v_mul_hi_u32_u24 v120, s36, v38
    v_mad_i32_i24 v110, v122, s44, v74
    v_mad_u32_u24 v74, v122, 40, v121
    v_mad_i32_i24 v38, v120, s39, v38
    v_lshlrev_b16 v74, 2, v74
    v_mad_i32_i24 v120, v121, -3, v120
    ds_add_u32 v74, v3 offset:0
    v_lshl_or_b32 v38, v110, 16, v38
    v_lshl_or_b32 v38, v120, 30, v38
    v_mul_f32 v117, 0x03800000, v117
    v_mul_f32 v118, 0x03800000, v118
    v_cvt_pk_bf16_f32 v117, v117, v118
    v_mul_hi_u32_u24 v122, s38, v75
    v_mul_hi_u32_u24 v121, s37, v39
    v_mul_hi_u32_u24 v120, s36, v39
    v_mad_i32_i24 v110, v122, s44, v75
    v_mad_u32_u24 v75, v122, 40, v121
    v_mad_i32_i24 v39, v120, s39, v39
    v_lshlrev_b16 v75, 2, v75
    v_mad_i32_i24 v120, v121, -3, v120
    ds_add_u32 v75, v3 offset:0
    v_lshl_or_b32 v39, v110, 16, v39
    v_lshl_or_b32 v39, v120, 30, v39
    v_lshrrev_b32 v118, 3, v117
    v_lshrrev_b32 v119, 8, v117
    v_lshlrev_b16 v117, 13, v117
    v_bitop3_b32 v119, v118, v119, v124 bitop3:0x1b
    v_bitop3_b32 v38, v117, v125, v38 bitop3:0xae
    v_lshl_or_b32 v74, v119, 16, v74
    v_bitop3_b32 v39, v118, v125, v39 bitop3:0xae
    v_bitop3_b32 v75, v119, v126, v75 bitop3:0xea
p1_k15:
    s_waitcnt vmcnt(0)
    s_cmp_lg_u32 s28, 15
    s_cbranch_scc1 p1_tk1
    v_mov_b32 v126, 0
    s_mov_b64 exec, 1
    ds_write_b32 v126, v127 offset:10456
    s_mov_b64 exec, -1
p1_tk1:
    s_waitcnt lgkmcnt(0)
    s_barrier
    s_cmp_ge_u32 s28, 10
    s_cbranch_scc1 p1_s1_skip
    v_and_b32 v126, 63, v0
    s_lshl_b32 s54, s28, 4
    v_mul_u32_u24 v117, 160, v126
    v_add_u32 v117, s54, v117
    ds_read_b128 v[118:121], v117 offset:0
    s_waitcnt lgkmcnt(0)
    v_add_u32 v118, 2, v118
    v_add_u32 v119, 2, v119
    v_add_u32 v120, 2, v120
    v_add_u32 v121, 2, v121
    v_mul_u32_u24 v118, 43691, v118
    v_mul_u32_u24 v119, 43691, v119
    v_mul_u32_u24 v120, 43691, v120
    v_mul_u32_u24 v121, 43691, v121
    v_lshrrev_b32 v118, 17, v118
    v_lshrrev_b32 v119, 17, v119
    v_lshrrev_b32 v120, 17, v120
    v_lshrrev_b32 v121, 17, v121
    v_lshl_or_b32 v122, v119, 16, v118
    v_lshl_or_b32 v123, v121, 16, v120
    v_mov_b32 v124, v122
    v_mov_b32 v125, v123
    s_nop 1
    v_add_u32_dpp v124, v124, v124 row_shr:1 row_mask:0xf bank_mask:0xf bound_ctrl:0
    v_add_u32_dpp v125, v125, v125 row_shr:1 row_mask:0xf bank_mask:0xf bound_ctrl:0
    s_nop 0
    v_add_u32_dpp v124, v124, v124 row_shr:2 row_mask:0xf bank_mask:0xf bound_ctrl:0
    v_add_u32_dpp v125, v125, v125 row_shr:2 row_mask:0xf bank_mask:0xf bound_ctrl:0
    s_nop 0
    v_add_u32_dpp v124, v124, v124 row_shr:4 row_mask:0xf bank_mask:0xf bound_ctrl:0
    v_add_u32_dpp v125, v125, v125 row_shr:4 row_mask:0xf bank_mask:0xf bound_ctrl:0
    s_nop 0
    v_add_u32_dpp v124, v124, v124 row_shr:8 row_mask:0xf bank_mask:0xf bound_ctrl:0
    v_add_u32_dpp v125, v125, v125 row_shr:8 row_mask:0xf bank_mask:0xf bound_ctrl:0
    s_nop 0
    v_add_u32_dpp v124, v124, v124 row_bcast:15 row_mask:0xa bank_mask:0xf
    v_add_u32_dpp v125, v125, v125 row_bcast:15 row_mask:0xa bank_mask:0xf
    s_nop 0
    v_add_u32_dpp v124, v124, v124 row_bcast:31 row_mask:0xc bank_mask:0xf
    v_add_u32_dpp v125, v125, v125 row_bcast:31 row_mask:0xc bank_mask:0xf
    s_nop 0
    s_nop 0
    v_mov_b32 v127, s54
    v_and_b32 v118, 0xffff, v124
    v_lshrrev_b32 v119, 16, v124
    v_and_b32 v120, 0xffff, v125
    v_lshrrev_b32 v121, 16, v125
    s_mov_b64 exec, 1
    s_lshl_b64 exec, exec, 63
    ds_write_b128 v127, v[118:121] offset:10240
    s_mov_b64 exec, -1
p1_s1_skip:
    s_waitcnt lgkmcnt(0)
    s_barrier
    v_and_b32 v127, 63, v0
    v_lshlrev_b32 v118, 2, v127
    v_cmp_gt_u32 vcc, 40, v127
    ds_read_b32 v119, v118 offset:10240
    s_waitcnt lgkmcnt(0)
    v_readlane_b32 s33, v119, 54
    v_cndmask_b32 v119, 0, v119, vcc
    v_mov_b32 v120, v119
    s_nop 1
    v_add_u32_dpp v120, v120, v120 row_shr:1 row_mask:0xf bank_mask:0xf bound_ctrl:0
    s_nop 1
    v_add_u32_dpp v120, v120, v120 row_shr:2 row_mask:0xf bank_mask:0xf bound_ctrl:0
    s_nop 1
    v_add_u32_dpp v120, v120, v120 row_shr:4 row_mask:0xf bank_mask:0xf bound_ctrl:0
    s_nop 1
    v_add_u32_dpp v120, v120, v120 row_shr:8 row_mask:0xf bank_mask:0xf bound_ctrl:0
    s_nop 1
    v_add_u32_dpp v120, v120, v120 row_bcast:15 row_mask:0xa bank_mask:0xf
    s_nop 1
    v_add_u32_dpp v120, v120, v120 row_bcast:31 row_mask:0xc bank_mask:0xf
    s_nop 1
    s_nop 0
    v_sub_u32 v119, v120, v119
    v_readlane_b32 s35, v120, 63
    s_add_u32 s33, s33, 256
    s_mul_i32 s46, s33, 2
    s_min_u32 s47, s33, 1445
    s_add_u32 s46, s46, s47
    s_min_u32 s47, s33, 1419
    s_add_u32 s46, s46, s47
    s_min_u32 s47, s33, 1392
    s_add_u32 s46, s46, s47
    s_min_u32 s47, s33, 1365
    s_add_u32 s46, s46, s47
    s_min_u32 s47, s33, 1338
    s_add_u32 s46, s46, s47
    s_min_u32 s47, s33, 1312
    s_add_u32 s46, s46, s47
    s_min_u32 s47, s33, 1285
    s_add_u32 s46, s46, s47
    s_lshl_b32 s30, s46, 14
    s_lshl_b32 s31, s46, 13
    s_cmp_ge_u32 s28, 10
    s_cbranch_scc1 p1_s2_skip
    s_lshl_b32 s54, s28, 2
    s_add_u32 s55, s54, 0
    v_readlane_b32 s56, v119, s55
    s_add_u32 s55, s54, 1
    v_readlane_b32 s57, v119, s55
    s_add_u32 s55, s54, 2
    v_readlane_b32 s58, v119, s55
    s_add_u32 s55, s54, 3
    v_readlane_b32 s59, v119, s55
    s_nop 0
    s_lshl_b32 s57, s57, 16
    s_or_b32 s56, s56, s57
    s_lshl_b32 s59, s59, 16
    s_or_b32 s58, s58, s59
    v_add_u32 v124, s56, v124
    v_add_u32 v125, s58, v125
    v_sub_u32 v122, v124, v122
    v_sub_u32 v123, v125, v123
    v_and_b32 v118, 0xffff, v122
    v_lshrrev_b32 v119, 16, v122
    v_and_b32 v120, 0xffff, v123
    v_lshrrev_b32 v121, 16, v123
    v_mul_u32_u24 v118, 3, v118
    v_mul_u32_u24 v119, 3, v119
    v_mul_u32_u24 v120, 3, v120
    v_mul_u32_u24 v121, 3, v121
    ds_write_b128 v117, v[118:121] offset:0
    s_mul_i32 s55, s29, 5248
    s_mul_i32 s56, s28, 520
    s_add_u32 s55, s55, s56
    s_add_u32 s55, s55, 469745664
    v_lshlrev_b32 v127, 3, v126
    buffer_store_dwordx2 v[122:123], v127, s[16:19], s55 offen sc1
    s_mov_b64 exec, 1
    s_lshl_b64 exec, exec, 63
    buffer_store_dwordx2 v[124:125], v127, s[16:19], s55 offen offset:8 sc1
    s_mov_b64 exec, -1
p1_s2_skip:
    s_mul_i32 s50, s29, 16384
    s_lshr_b32 s52, s35, 10
    s_mul_i32 s52, s52, 33554432
    s_and_b32 s53, s35, 1023
    s_lshl_b32 s53, s53, 4
    s_add_u32 s52, s52, s53
    s_add_u32 s52, s52, s50
    s_min_u32 s22, s52, 469745664
    s_mov_b32 s68, 0
    s_cmp_lt_u32 s28, 2
    s_cselect_b32 s71, 10, 9
    s_cmp_lt_u32 s29, 1285
    s_cselect_b32 s35, 13994, s35
    s_waitcnt lgkmcnt(0)
    s_barrier
    s_cmp_lt_u32 s33, 1472
    s_cbranch_scc1 p1_f0
    s_cmp_lg_u32 s28, 15
    s_cbranch_scc1 p1_hv0
    s_sub_u32 s52, s33, 1472
    s_and_b32 s52, s52, 255
    s_lshl_b32 s58, s52, 2
    s_and_b32 s58, s58, 28
    s_lshl_b32 s53, 1, s58
    v_mov_b32 v127, s53
    s_lshr_b32 s52, s52, 3
    s_lshl_b32 s52, s52, 2
    s_mov_b64 exec, 1
    buffer_atomic_add v127, off, s[40:43], s52 sc0 sc1
    s_mov_b64 exec, -1
p1_hv0:
    s_cmp_ge_u32 s33, 1592
    s_cbranch_scc1 p1_f0
    s_sub_u32 s52, s33, 1472
    s_mul_i32 s52, s52, 53368
    s_mul_i32 s53, s28, 3072
    s_add_u32 s53, s53, s52
    v_and_b32 v92, 63, v0
    v_lshl_add_u32 v93, v92, 2, s53
    s_lshl_b32 s53, s28, 9
    s_add_u32 s53, s53, s52
    s_add_u32 s53, s53, 49152
    s_cmp_lt_u32 s28, 9
    s_cselect_b32 s53, s53, 0x40000000
    v_lshl_add_u32 v94, v92, 2, s53
    buffer_load_dword v76, v93, s[24:27], 0 offen offset:0
    buffer_load_dword v77, v93, s[24:27], 0 offen offset:256
    buffer_load_dword v78, v93, s[24:27], 0 offen offset:512
    buffer_load_dword v79, v93, s[24:27], 0 offen offset:768
    buffer_load_dword v80, v93, s[24:27], 0 offen offset:1024
    buffer_load_dword v81, v93, s[24:27], 0 offen offset:1280
    buffer_load_dword v82, v93, s[24:27], 0 offen offset:1536
    buffer_load_dword v83, v93, s[24:27], 0 offen offset:1792
    buffer_load_dword v84, v93, s[24:27], 0 offen offset:2048
    buffer_load_dword v85, v93, s[24:27], 0 offen offset:2304
    buffer_load_dword v86, v93, s[24:27], 0 offen offset:2560
    buffer_load_dword v87, v93, s[24:27], 0 offen offset:2816
    buffer_load_dword v88, v94, s[24:27], 0 offen offset:0
    buffer_load_dword v89, v94, s[24:27], 0 offen offset:256
p1_f0:
    v_and_b32 v117, 0xffff, v40
    ds_add_rtn_u32 v117, v117, v3 offset:0
    v_and_b32 v118, 0xffff, v41
    ds_add_rtn_u32 v118, v118, v3 offset:0
    v_and_b32 v119, 0xffff, v42
    ds_add_rtn_u32 v119, v119, v3 offset:0
    v_and_b32 v120, 0xffff, v43
    ds_add_rtn_u32 v120, v120, v3 offset:0
    s_cmp_ge_u32 s33, 1472
    s_cbranch_scc1 p1_k17
    s_cmp_lt_u32 s33, 1472
    s_cselect_b32 s6, 204800000, 0
    s_add_u32 s32, s30, 0
    buffer_load_dwordx4 v[94:97], v1, s[4:7], s32 offen nt
p1_k17:
    s_cmp_ge_u32 s33, 1472
    s_cbranch_scc1 p1_k18
    s_cmp_lt_u32 s33, 1472
    s_cselect_b32 s14, 102400000, 0
    s_add_u32 s32, s31, 0
    buffer_load_dwordx2 v[76:77], v2, s[12:15], s32 offen nt
p1_k18:
    s_cmp_ge_u32 s33, 1472
    s_cbranch_scc1 p1_k19
    s_cmp_lt_u32 s33, 1472
    s_cselect_b32 s14, 102400000, 0
    s_add_u32 s32, s31, 8192
    buffer_load_dwordx2 v[78:79], v2, s[12:15], s32 offen nt
p1_k19:
    s_cmp_lt_u32 s29, 1445
    s_cbranch_scc1 p1_pa0
    s_waitcnt lgkmcnt(0)
    s_branch p1_pb0
p1_pa0:
    v_and_b32 v121, 0xffff, v48
    ds_add_rtn_u32 v121, v121, v3 offset:0
    v_and_b32 v122, 0xffff, v49
    ds_add_rtn_u32 v122, v122, v3 offset:0
    v_and_b32 v123, 0xffff, v50
    ds_add_rtn_u32 v123, v123, v3 offset:0
    v_and_b32 v124, 0xffff, v51
    ds_add_rtn_u32 v124, v124, v3 offset:0
    s_waitcnt lgkmcnt(4)
p1_pb0:
    ds_write_b8_d16_hi v117, v40 offset:10496
    v_sub_u32 v40, 55295, v117
    v_lshlrev_b32 v117, 2, v117
    ds_write_b32 v117, v4 offset:52480
    ds_write_b8_d16_hi v118, v41 offset:10496
    v_sub_u32 v41, 55295, v118
    v_lshlrev_b32 v118, 2, v118
    ds_write_b32 v118, v5 offset:52480
    ds_write_b8_d16_hi v119, v42 offset:10496
    v_sub_u32 v42, 55295, v119
    v_lshlrev_b32 v119, 2, v119
    ds_write_b32 v119, v6 offset:52480
    ds_write_b8_d16_hi v120, v43 offset:10496
    v_sub_u32 v43, 55295, v120
    v_lshlrev_b32 v120, 2, v120
    ds_write_b32 v120, v7 offset:52480
    s_cmp_ge_u32 s33, 1472
    s_cbranch_scc1 p1_k20
    s_cmp_lt_u32 s33, 1472
    s_cselect_b32 s10, 204800000, 0
    s_add_u32 s32, s30, 0
    buffer_load_dwordx4 v[102:105], v1, s[8:11], s32 offen nt
p1_k20:
    s_cmp_ge_u32 s33, 1472
    s_cbranch_scc1 p1_k21
    s_cmp_lt_u32 s33, 1445
    s_cselect_b32 s14, 102400000, 0
    s_add_u32 s32, s31, 16384
    buffer_load_dwordx2 v[80:81], v2, s[12:15], s32 offen nt
p1_k21:
    s_cmp_ge_u32 s33, 1472
    s_cbranch_scc1 p1_k22
    s_cmp_lt_u32 s33, 1419
    s_cselect_b32 s14, 102400000, 0
    s_add_u32 s32, s31, 24576
    buffer_load_dwordx2 v[82:83], v2, s[12:15], s32 offen nt
p1_k22:
    v_and_b32 v117, 0xffff, v44
    ds_add_rtn_u32 v117, v117, v3 offset:0
    v_and_b32 v118, 0xffff, v45
    ds_add_rtn_u32 v118, v118, v3 offset:0
    v_and_b32 v119, 0xffff, v46
    ds_add_rtn_u32 v119, v119, v3 offset:0
    v_and_b32 v120, 0xffff, v47
    ds_add_rtn_u32 v120, v120, v3 offset:0
    s_waitcnt lgkmcnt(4)
    s_cmp_ge_u32 s29, 1445
    s_cbranch_scc1 p1_k23
    ds_write_b8_d16_hi v121, v48 offset:10496
    v_sub_u32 v48, 55295, v121
    v_lshlrev_b32 v121, 2, v121
    v_lshl_or_b32 v40, v48, 16, v40
    ds_write_b32 v121, v12 offset:52480
    ds_write_b8_d16_hi v122, v49 offset:10496
    v_sub_u32 v49, 55295, v122
    v_lshlrev_b32 v122, 2, v122
    v_lshl_or_b32 v41, v49, 16, v41
    ds_write_b32 v122, v13 offset:52480
    ds_write_b8_d16_hi v123, v50 offset:10496
    v_sub_u32 v50, 55295, v123
    v_lshlrev_b32 v123, 2, v123
    v_lshl_or_b32 v42, v50, 16, v42
    ds_write_b32 v123, v14 offset:52480
    ds_write_b8_d16_hi v124, v51 offset:10496
    v_sub_u32 v51, 55295, v124
    v_lshlrev_b32 v124, 2, v124
    v_lshl_or_b32 v43, v51, 16, v43
    ds_write_b32 v124, v15 offset:52480
p1_k23:
    s_cmp_ge_u32 s33, 1472
    s_cbranch_scc1 p1_k24
    s_cmp_lt_u32 s33, 1445
    s_cselect_b32 s10, 204800000, 0
    s_add_u32 s32, s30, 32768
    buffer_load_dwordx4 v[48:51], v1, s[8:11], s32 offen nt
p1_k24:
    s_cmp_ge_u32 s33, 1472
    s_cbranch_scc1 p1_k25
    s_cmp_lt_u32 s33, 1392
    s_cselect_b32 s14, 102400000, 0
    s_add_u32 s32, s31, 32768
    buffer_load_dwordx2 v[84:85], v2, s[12:15], s32 offen nt
p1_k25:
    s_cmp_ge_u32 s33, 1472
    s_cbranch_scc1 p1_k26
    s_cmp_lt_u32 s33, 1365
    s_cselect_b32 s14, 102400000, 0
    s_add_u32 s32, s31, 40960
    buffer_load_dwordx2 v[86:87], v2, s[12:15], s32 offen nt
p1_k26:
    s_cmp_lt_u32 s29, 1419
    s_cbranch_scc1 p1_pa2
    s_waitcnt lgkmcnt(0)
    s_branch p1_pb2
p1_pa2:
    v_and_b32 v121, 0xffff, v52
    ds_add_rtn_u32 v121, v121, v3 offset:0
    v_and_b32 v122, 0xffff, v53
    ds_add_rtn_u32 v122, v122, v3 offset:0
    v_and_b32 v123, 0xffff, v54
    ds_add_rtn_u32 v123, v123, v3 offset:0
    v_and_b32 v124, 0xffff, v55
    ds_add_rtn_u32 v124, v124, v3 offset:0
    s_waitcnt lgkmcnt(4)
p1_pb2:
    ds_write_b8_d16_hi v117, v44 offset:10496
    v_sub_u32 v44, 55295, v117
    v_lshlrev_b32 v117, 2, v117
    ds_write_b32 v117, v8 offset:52480
    ds_write_b8_d16_hi v118, v45 offset:10496
    v_sub_u32 v45, 55295, v118
    v_lshlrev_b32 v118, 2, v118
    ds_write_b32 v118, v9 offset:52480
    ds_write_b8_d16_hi v119, v46 offset:10496
    v_sub_u32 v46, 55295, v119
    v_lshlrev_b32 v119, 2, v119
    ds_write_b32 v119, v10 offset:52480
    ds_write_b8_d16_hi v120, v47 offset:10496
    v_sub_u32 v47, 55295, v120
    v_lshlrev_b32 v120, 2, v120
    ds_write_b32 v120, v11 offset:52480
    s_cmp_ge_u32 s28, 10
    s_cbranch_scc1 p1_jn
    s_waitcnt vmcnt(0)
    v_mov_b32 v125, 0
    s_mov_b64 exec, 1
    ds_add_rtn_u32 v125, v125, v3 offset:10432
    s_waitcnt lgkmcnt(0)
    v_readfirstlane_b32 s52, v125
    s_lshr_b32 s53, s29, 1
    s_and_b32 s53, s53, 28
    s_cmp_lg_u32 s52, 9
    s_cbranch_scc1 p1_jn1
    s_lshl_b32 s54, 1, s53
    v_mov_b32 v127, s54
    s_lshr_b32 s54, s29, 6
    s_lshl_b32 s54, s54, 2
    s_mov_b32 s68, 1
    buffer_atomic_add v127, off, s[40:43], s54 sc0 sc1
p1_jn1:
    s_mov_b64 exec, -1
p1_jn:
    s_cmp_ge_u32 s33, 1472
    s_cbranch_scc1 p1_k27
    s_cmp_lt_u32 s33, 1472
    s_cselect_b32 s6, 204800000, 0
    s_add_u32 s32, s30, 16384
    buffer_load_dwordx4 v[98:101], v1, s[4:7], s32 offen nt
p1_k27:
    s_cmp_ge_u32 s33, 1472
    s_cbranch_scc1 p1_k28
    s_cmp_lt_u32 s33, 1338
    s_cselect_b32 s14, 102400000, 0
    s_add_u32 s32, s31, 49152
    buffer_load_dwordx2 v[88:89], v2, s[12:15], s32 offen nt
p1_k28:
    s_cmp_ge_u32 s33, 1472
    s_cbranch_scc1 p1_k29
    s_cmp_lt_u32 s33, 1312
    s_cselect_b32 s14, 102400000, 0
    s_add_u32 s32, s31, 57344
    buffer_load_dwordx2 v[90:91], v2, s[12:15], s32 offen nt
p1_k29:
    s_cmp_lt_u32 s29, 1392
    s_cbranch_scc1 p1_pa3
    s_waitcnt lgkmcnt(0)
    s_branch p1_pb3
p1_pa3:
    v_and_b32 v117, 0xffff, v56
    ds_add_rtn_u32 v117, v117, v3 offset:0
    v_and_b32 v118, 0xffff, v57
    ds_add_rtn_u32 v118, v118, v3 offset:0
    v_and_b32 v119, 0xffff, v58
    ds_add_rtn_u32 v119, v119, v3 offset:0
    v_and_b32 v120, 0xffff, v59
    ds_add_rtn_u32 v120, v120, v3 offset:0
    s_waitcnt lgkmcnt(4)
p1_pb3:
    s_cmp_ge_u32 s29, 1419
    s_cbranch_scc1 p1_k30
    ds_write_b8_d16_hi v121, v52 offset:10496
    v_sub_u32 v52, 55295, v121
    v_lshlrev_b32 v121, 2, v121
    v_lshl_or_b32 v44, v52, 16, v44
    ds_write_b32 v121, v16 offset:52480
    ds_write_b8_d16_hi v122, v53 offset:10496
    v_sub_u32 v53, 55295, v122
    v_lshlrev_b32 v122, 2, v122
    v_lshl_or_b32 v45, v53, 16, v45
    ds_write_b32 v122, v17 offset:52480
    ds_write_b8_d16_hi v123, v54 offset:10496
    v_sub_u32 v54, 55295, v123
    v_lshlrev_b32 v123, 2, v123
    v_lshl_or_b32 v46, v54, 16, v46
    ds_write_b32 v123, v18 offset:52480
    ds_write_b8_d16_hi v124, v55 offset:10496
    v_sub_u32 v55, 55295, v124
    v_lshlrev_b32 v124, 2, v124
    v_lshl_or_b32 v47, v55, 16, v47
    ds_write_b32 v124, v19 offset:52480
p1_k30:
    s_cmp_ge_u32 s33, 1472
    s_cbranch_scc1 p1_k31
    s_cmp_lt_u32 s33, 1419
    s_cselect_b32 s10, 204800000, 0
    s_add_u32 s32, s30, 49152
    buffer_load_dwordx4 v[52:55], v1, s[8:11], s32 offen nt
p1_k31:
    s_cmp_ge_u32 s33, 1472
    s_cbranch_scc1 p1_k32
    s_cmp_lt_u32 s33, 1285
    s_cselect_b32 s14, 102400000, 0
    s_add_u32 s32, s31, 65536
    buffer_load_dwordx2 v[92:93], v2, s[12:15], s32 offen nt
p1_k32:
    s_cmp_lt_u32 s29, 1365
    s_cbranch_scc1 p1_pa4
    s_waitcnt lgkmcnt(0)
    s_branch p1_pb4
p1_pa4:
    v_and_b32 v121, 0xffff, v60
    ds_add_rtn_u32 v121, v121, v3 offset:0
    v_and_b32 v122, 0xffff, v61
    ds_add_rtn_u32 v122, v122, v3 offset:0
    v_and_b32 v123, 0xffff, v62
    ds_add_rtn_u32 v123, v123, v3 offset:0
    v_and_b32 v124, 0xffff, v63
    ds_add_rtn_u32 v124, v124, v3 offset:0
    s_waitcnt lgkmcnt(4)
p1_pb4:
    s_cmp_ge_u32 s29, 1392
    s_cbranch_scc1 p1_k33
    ds_write_b8_d16_hi v117, v56 offset:10496
    v_sub_u32 v56, 55295, v117
    v_lshlrev_b32 v117, 2, v117
    ds_write_b32 v117, v20 offset:52480
    ds_write_b8_d16_hi v118, v57 offset:10496
    v_sub_u32 v57, 55295, v118
    v_lshlrev_b32 v118, 2, v118
    ds_write_b32 v118, v21 offset:52480
    ds_write_b8_d16_hi v119, v58 offset:10496
    v_sub_u32 v58, 55295, v119
    v_lshlrev_b32 v119, 2, v119
    ds_write_b32 v119, v22 offset:52480
    ds_write_b8_d16_hi v120, v59 offset:10496
    v_sub_u32 v59, 55295, v120
    v_lshlrev_b32 v120, 2, v120
    ds_write_b32 v120, v23 offset:52480
p1_k33:
    s_cmp_ge_u32 s33, 1472
    s_cbranch_scc1 p1_k34
    s_cmp_lt_u32 s33, 1472
    s_cselect_b32 s10, 204800000, 0
    s_add_u32 s32, s30, 16384
    buffer_load_dwordx4 v[106:109], v1, s[8:11], s32 offen nt
p1_k34:
    s_cmp_lt_u32 s29, 1338
    s_cbranch_scc1 p1_pa5
    s_waitcnt lgkmcnt(0)
    s_branch p1_pb5
p1_pa5:
    v_and_b32 v117, 0xffff, v64
    ds_add_rtn_u32 v117, v117, v3 offset:0
    v_and_b32 v118, 0xffff, v65
    ds_add_rtn_u32 v118, v118, v3 offset:0
    v_and_b32 v119, 0xffff, v66
    ds_add_rtn_u32 v119, v119, v3 offset:0
    v_and_b32 v120, 0xffff, v67
    ds_add_rtn_u32 v120, v120, v3 offset:0
    s_waitcnt lgkmcnt(4)
p1_pb5:
    s_cmp_ge_u32 s29, 1365
    s_cbranch_scc1 p1_k35
    ds_write_b8_d16_hi v121, v60 offset:10496
    v_sub_u32 v60, 55295, v121
    v_lshlrev_b32 v121, 2, v121
    v_lshl_or_b32 v56, v60, 16, v56
    ds_write_b32 v121, v24 offset:52480
    ds_write_b8_d16_hi v122, v61 offset:10496
    v_sub_u32 v61, 55295, v122
    v_lshlrev_b32 v122, 2, v122
    v_lshl_or_b32 v57, v61, 16, v57
    ds_write_b32 v122, v25 offset:52480
    ds_write_b8_d16_hi v123, v62 offset:10496
    v_sub_u32 v62, 55295, v123
    v_lshlrev_b32 v123, 2, v123
    v_lshl_or_b32 v58, v62, 16, v58
    ds_write_b32 v123, v26 offset:52480
    ds_write_b8_d16_hi v124, v63 offset:10496
    v_sub_u32 v63, 55295, v124
    v_lshlrev_b32 v124, 2, v124
    v_lshl_or_b32 v59, v63, 16, v59
    ds_write_b32 v124, v27 offset:52480
p1_k35:
    s_cmp_ge_u32 s33, 1472
    s_cbranch_scc1 p1_k36
    s_cmp_lt_u32 s33, 1365
    s_cselect_b32 s10, 204800000, 0
    s_add_u32 s32, s30, 81920
    buffer_load_dwordx4 v[60:63], v1, s[8:11], s32 offen nt
p1_k36:
    s_cmp_lt_u32 s29, 1312
    s_cbranch_scc1 p1_pa6
    s_waitcnt lgkmcnt(0)
    s_branch p1_pb6
p1_pa6:
    v_and_b32 v121, 0xffff, v68
    ds_add_rtn_u32 v121, v121, v3 offset:0
    v_and_b32 v122, 0xffff, v69
    ds_add_rtn_u32 v122, v122, v3 offset:0
    v_and_b32 v123, 0xffff, v70
    ds_add_rtn_u32 v123, v123, v3 offset:0
    v_and_b32 v124, 0xffff, v71
    ds_add_rtn_u32 v124, v124, v3 offset:0
    s_waitcnt lgkmcnt(4)
p1_pb6:
    s_cmp_ge_u32 s29, 1338
    s_cbranch_scc1 p1_k37
    ds_write_b8_d16_hi v117, v64 offset:10496
    v_sub_u32 v64, 55295, v117
    v_lshlrev_b32 v117, 2, v117
    ds_write_b32 v117, v28 offset:52480
    ds_write_b8_d16_hi v118, v65 offset:10496
    v_sub_u32 v65, 55295, v118
    v_lshlrev_b32 v118, 2, v118
    ds_write_b32 v118, v29 offset:52480
    ds_write_b8_d16_hi v119, v66 offset:10496
    v_sub_u32 v66, 55295, v119
    v_lshlrev_b32 v119, 2, v119
    ds_write_b32 v119, v30 offset:52480
    ds_write_b8_d16_hi v120, v67 offset:10496
    v_sub_u32 v67, 55295, v120
    v_lshlrev_b32 v120, 2, v120
    ds_write_b32 v120, v31 offset:52480
p1_k37:
    s_cmp_lt_u32 s29, 1285
    s_cbranch_scc1 p1_pa7
    s_waitcnt lgkmcnt(0)
    s_branch p1_pb7
p1_pa7:
    v_and_b32 v117, 0xffff, v72
    ds_add_rtn_u32 v117, v117, v3 offset:0
    v_and_b32 v118, 0xffff, v73
    ds_add_rtn_u32 v118, v118, v3 offset:0
    v_and_b32 v119, 0xffff, v74
    ds_add_rtn_u32 v119, v119, v3 offset:0
    v_and_b32 v120, 0xffff, v75
    ds_add_rtn_u32 v120, v120, v3 offset:0
    s_waitcnt lgkmcnt(4)
p1_pb7:
    s_cmp_ge_u32 s29, 1312
    s_cbranch_scc1 p1_k38
    ds_write_b8_d16_hi v121, v68 offset:10496
    v_sub_u32 v68, 55295, v121
    v_lshlrev_b32 v121, 2, v121
    v_lshl_or_b32 v64, v68, 16, v64
    ds_write_b32 v121, v32 offset:52480
    ds_write_b8_d16_hi v122, v69 offset:10496
    v_sub_u32 v69, 55295, v122
    v_lshlrev_b32 v122, 2, v122
    v_lshl_or_b32 v65, v69, 16, v65
    ds_write_b32 v122, v33 offset:52480
    ds_write_b8_d16_hi v123, v70 offset:10496
    v_sub_u32 v70, 55295, v123
    v_lshlrev_b32 v123, 2, v123
    v_lshl_or_b32 v66, v70, 16, v66
    ds_write_b32 v123, v34 offset:52480
    ds_write_b8_d16_hi v124, v71 offset:10496
    v_sub_u32 v71, 55295, v124
    v_lshlrev_b32 v124, 2, v124
    v_lshl_or_b32 v67, v71, 16, v67
    ds_write_b32 v124, v35 offset:52480
p1_k38:
    s_cmp_ge_u32 s33, 1472
    s_cbranch_scc1 p1_k39
    s_cmp_lt_u32 s33, 1312
    s_cselect_b32 s10, 204800000, 0
    s_add_u32 s32, s30, 114688
    buffer_load_dwordx4 v[68:71], v1, s[8:11], s32 offen nt
p1_k39:
    s_waitcnt lgkmcnt(0)
    s_cmp_ge_u32 s29, 1285
    s_cbranch_scc1 p1_k40
    ds_write_b8_d16_hi v117, v72 offset:10496
    v_sub_u32 v72, 55295, v117
    v_lshlrev_b32 v117, 2, v117
    ds_write_b32 v117, v36 offset:52480
    ds_write_b8_d16_hi v118, v73 offset:10496
    v_sub_u32 v73, 55295, v118
    v_lshlrev_b32 v118, 2, v118
    ds_write_b32 v118, v37 offset:52480
    ds_write_b8_d16_hi v119, v74 offset:10496
    v_sub_u32 v74, 55295, v119
    v_lshlrev_b32 v119, 2, v119
    ds_write_b32 v119, v38 offset:52480
    ds_write_b8_d16_hi v120, v75 offset:10496
    v_sub_u32 v75, 55295, v120
    v_lshlrev_b32 v120, 2, v120
    ds_write_b32 v120, v39 offset:52480
p1_k40:
    s_cmp_eq_u32 s68, 0
    s_cbranch_scc1 p1_sg
    s_cmp_lt_u32 s33, 1472
    s_cbranch_scc1 p1_w41
    s_waitcnt vmcnt(0)
p1_w41:
    s_waitcnt vmcnt(8)
    v_bfe_u32 v127, v127, s53, 4
    v_mov_b32 v125, 0
    s_mov_b64 exec, 1
    ds_write_b32 v125, v127 offset:10452
    s_mov_b64 exec, -1
p1_sg:
    s_cmp_lt_u32 s33, 1472
    s_cbranch_scc1 p1_f1
    s_cmp_lg_u32 s28, 15
    s_cbranch_scc1 p1_hv1
    s_waitcnt vmcnt(0)
    v_bfe_u32 v127, v127, s58, 4
    v_mov_b32 v125, 0
    s_mov_b64 exec, 1
    ds_write_b32 v125, v127 offset:10448
    s_mov_b64 exec, -1
p1_hv1:
    s_cmp_ge_u32 s33, 1592
    s_cbranch_scc1 p1_f1
    s_sub_u32 s52, s33, 1472
    s_mul_i32 s53, s52, 53760
    s_add_u32 s53, s53, 485125120
    s_mul_i32 s54, s28, 3072
    v_lshl_add_u32 v93, v92, 4, s54
    s_lshl_b32 s54, s28, 9
    s_add_u32 s54, s54, 49152
    s_cmp_lt_u32 s28, 9
    s_cselect_b32 s54, s54, 0x40000000
    v_lshl_add_u32 v94, v92, 3, s54
    v_mov_b32 v96, 0
    v_mov_b32 v97, 0
    s_waitcnt vmcnt(0)
    buffer_store_dwordx4 v[76:79], v93, s[16:19], s53 offen offset:0
    buffer_store_dwordx4 v[80:83], v93, s[16:19], s53 offen offset:1024
    buffer_store_dwordx4 v[84:87], v93, s[16:19], s53 offen offset:2048
    buffer_store_dwordx2 v[88:89], v94, s[16:19], s53 offen
    v_and_b32 v98, 0x7fff7fff, v76
    v_pk_max_u16 v96, v96, v98
    v_lshlrev_b32 v99, 16, v98
    v_and_b32 v98, 0xffff0000, v98
    v_fmac_f32 v97, v99, v99
    v_fmac_f32 v97, v98, v98
    v_and_b32 v98, 0x7fff7fff, v77
    v_pk_max_u16 v96, v96, v98
    v_lshlrev_b32 v99, 16, v98
    v_and_b32 v98, 0xffff0000, v98
    v_fmac_f32 v97, v99, v99
    v_fmac_f32 v97, v98, v98
    v_and_b32 v98, 0x7fff7fff, v78
    v_pk_max_u16 v96, v96, v98
    v_lshlrev_b32 v99, 16, v98
    v_and_b32 v98, 0xffff0000, v98
    v_fmac_f32 v97, v99, v99
    v_fmac_f32 v97, v98, v98
    v_and_b32 v98, 0x7fff7fff, v79
    v_pk_max_u16 v96, v96, v98
    v_lshlrev_b32 v99, 16, v98
    v_and_b32 v98, 0xffff0000, v98
    v_fmac_f32 v97, v99, v99
    v_fmac_f32 v97, v98, v98
    v_and_b32 v98, 0x7fff7fff, v80
    v_pk_max_u16 v96, v96, v98
    v_lshlrev_b32 v99, 16, v98
    v_and_b32 v98, 0xffff0000, v98
    v_fmac_f32 v97, v99, v99
    v_fmac_f32 v97, v98, v98
    v_and_b32 v98, 0x7fff7fff, v81
    v_pk_max_u16 v96, v96, v98
    v_lshlrev_b32 v99, 16, v98
    v_and_b32 v98, 0xffff0000, v98
    v_fmac_f32 v97, v99, v99
    v_fmac_f32 v97, v98, v98
    v_and_b32 v98, 0x7fff7fff, v82
    v_pk_max_u16 v96, v96, v98
    v_lshlrev_b32 v99, 16, v98
    v_and_b32 v98, 0xffff0000, v98
    v_fmac_f32 v97, v99, v99
    v_fmac_f32 v97, v98, v98
    v_and_b32 v98, 0x7fff7fff, v83
    v_pk_max_u16 v96, v96, v98
    v_lshlrev_b32 v99, 16, v98
    v_and_b32 v98, 0xffff0000, v98
    v_fmac_f32 v97, v99, v99
    v_fmac_f32 v97, v98, v98
    v_and_b32 v98, 0x7fff7fff, v84
    v_pk_max_u16 v96, v96, v98
    v_lshlrev_b32 v99, 16, v98
    v_and_b32 v98, 0xffff0000, v98
    v_fmac_f32 v97, v99, v99
    v_fmac_f32 v97, v98, v98
    v_and_b32 v98, 0x7fff7fff, v85
    v_pk_max_u16 v96, v96, v98
    v_lshlrev_b32 v99, 16, v98
    v_and_b32 v98, 0xffff0000, v98
    v_fmac_f32 v97, v99, v99
    v_fmac_f32 v97, v98, v98
    v_and_b32 v98, 0x7fff7fff, v86
    v_pk_max_u16 v96, v96, v98
    v_lshlrev_b32 v99, 16, v98
    v_and_b32 v98, 0xffff0000, v98
    v_fmac_f32 v97, v99, v99
    v_fmac_f32 v97, v98, v98
    v_and_b32 v98, 0x7fff7fff, v87
    v_pk_max_u16 v96, v96, v98
    v_lshlrev_b32 v99, 16, v98
    v_and_b32 v98, 0xffff0000, v98
    v_fmac_f32 v97, v99, v99
    v_fmac_f32 v97, v98, v98
    v_and_b32 v98, 0x7fff7fff, v88
    v_pk_max_u16 v96, v96, v98
    v_lshlrev_b32 v99, 16, v98
    v_and_b32 v98, 0xffff0000, v98
    v_fmac_f32 v97, v99, v99
    v_fmac_f32 v97, v98, v98
    v_and_b32 v98, 0x7fff7fff, v89
    v_pk_max_u16 v96, v96, v98
    v_lshlrev_b32 v99, 16, v98
    v_and_b32 v98, 0xffff0000, v98
    v_fmac_f32 v97, v99, v99
    v_fmac_f32 v97, v98, v98
    v_lshrrev_b32 v98, 16, v96
    v_and_b32 v96, 0xffff, v96
    v_max_u32 v96, v96, v98
    s_nop 1
    v_max_u32_dpp v96, v96, v96 row_shr:1 row_mask:0xf bank_mask:0xf bound_ctrl:0
    v_add_f32_dpp v97, v97, v97 row_shr:1 row_mask:0xf bank_mask:0xf bound_ctrl:0
    s_nop 0
    v_max_u32_dpp v96, v96, v96 row_shr:2 row_mask:0xf bank_mask:0xf bound_ctrl:0
    v_add_f32_dpp v97, v97, v97 row_shr:2 row_mask:0xf bank_mask:0xf bound_ctrl:0
    s_nop 0
    v_max_u32_dpp v96, v96, v96 row_shr:4 row_mask:0xf bank_mask:0xf bound_ctrl:0
    v_add_f32_dpp v97, v97, v97 row_shr:4 row_mask:0xf bank_mask:0xf bound_ctrl:0
    s_nop 0
    v_max_u32_dpp v96, v96, v96 row_shr:8 row_mask:0xf bank_mask:0xf bound_ctrl:0
    v_add_f32_dpp v97, v97, v97 row_shr:8 row_mask:0xf bank_mask:0xf bound_ctrl:0
    s_nop 0
    v_max_u32_dpp v96, v96, v96 row_bcast:15 row_mask:0xa bank_mask:0xf
    v_add_f32_dpp v97, v97, v97 row_bcast:15 row_mask:0xa bank_mask:0xf
    s_nop 0
    v_max_u32_dpp v96, v96, v96 row_bcast:31 row_mask:0xc bank_mask:0xf
    v_add_f32_dpp v97, v97, v97 row_bcast:31 row_mask:0xc bank_mask:0xf
    s_nop 0
    s_nop 0
    s_lshl_b32 s52, s52, 4
    s_add_u32 s52, s52, s28
    s_lshl_b32 s52, s52, 3
    s_add_u32 s52, s52, 491576320
    s_mov_b64 exec, 1
    s_lshl_b64 exec, exec, 63
    buffer_store_dwordx2 v[96:97], off, s[16:19], s52
    s_mov_b64 exec, -1
p1_f1:
    s_waitcnt lgkmcnt(0)
    s_barrier
    v_mul_u32_u24 v119, 3, v0
    v_and_b32 v118, -4, v119
    v_add_u32 v120, s50, v1
    v_mov_b32 v122, 0
    v_mov_b32 v123, 0
    v_mov_b32 v124, 0
    v_mov_b32 v125, 0
    ds_read_b64 v[126:127], v122 offset:10448
    ds_write_b32 v122, v122 offset:10432
    v_cmp_gt_u32 vcc, 640, v0
    s_and_saveexec_b64 s[52:53], vcc
    ds_write_b128 v1, v[122:125] offset:0
    s_mov_b64 exec, -1
    s_waitcnt lgkmcnt(2)
    v_readfirstlane_b32 s70, v126
    v_readfirstlane_b32 s69, v127
    s_cmp_ge_u32 s33, 1472
    s_cselect_b32 s70, s70, 0
    s_cmp_gt_u32 s28, 10
    s_cselect_b32 s69, 0, s69
    s_cselect_b32 s70, 0, s70
    s_cmp_lg_u32 s70, 8
    s_cbranch_scc1 p1_h0
    s_sub_u32 s52, s33, 1472
    v_and_b32 v102, 63, v0
    s_cmp_eq_u32 s28, 10
    s_cbranch_scc1 p1_tr10
    s_mul_i32 s53, s28, 520
    v_lshl_add_u32 v100, v102, 3, s53
    s_mul_i32 s53, s28, 4160
    v_lshl_add_u32 v101, v102, 4, s53
    s_branch p1_tr20
p1_tr10:
    v_mul_u32_u24 v100, 520, v102
    v_add_u32 v100, 512, v100
    v_mul_u32_u24 v101, 4160, v102
    v_add_u32 v101, 1024, v101
    v_cmp_gt_u32 vcc, 10, v102
    v_mov_b32 v102, 0x40000000
    s_nop 0
    v_cndmask_b32 v100, v102, v100, vcc
    v_cndmask_b32 v101, v102, v101, vcc
p1_tr20:
    s_mul_i32 s52, s52, 41984
    s_add_u32 s52, s52, 469745664
    buffer_load_dwordx2 v[76:77], v100, s[16:19], s52 offen sc1
    s_add_u32 s52, s52, 5248
    buffer_load_dwordx2 v[78:79], v100, s[16:19], s52 offen sc1
    s_add_u32 s52, s52, 5248
    buffer_load_dwordx2 v[80:81], v100, s[16:19], s52 offen sc1
    s_add_u32 s52, s52, 5248
    buffer_load_dwordx2 v[82:83], v100, s[16:19], s52 offen sc1
    s_add_u32 s52, s52, 5248
    buffer_load_dwordx2 v[84:85], v100, s[16:19], s52 offen sc1
    s_add_u32 s52, s52, 5248
    buffer_load_dwordx2 v[86:87], v100, s[16:19], s52 offen sc1
    s_add_u32 s52, s52, 5248
    buffer_load_dwordx2 v[88:89], v100, s[16:19], s52 offen sc1
    s_add_u32 s52, s52, 5248
    buffer_load_dwordx2 v[90:91], v100, s[16:19], s52 offen sc1
    s_add_u32 s52, s52, 5248
p1_h0:
    v_lshlrev_b32 v117, 2, v119
    v_add_u32 v117, 52480, v117
    ds_read_b32 v110, v117 offset:0
    ds_read_b32 v111, v117 offset:4
    ds_read_b32 v112, v117 offset:8
    ds_read_b32 v113, v118 offset:10496
    ds_read_b32 v114, v118 offset:10500
    ds_read_b32 v122, v117 offset:12288
    ds_read_b32 v123, v117 offset:12292
    ds_read_b32 v124, v117 offset:12296
    ds_read_b32 v125, v118 offset:13568
    ds_read_b32 v121, v118 offset:13572
    s_waitcnt lgkmcnt(5)
    v_alignbyte_b32 v113, v114, v113, v119
    buffer_store_dwordx4 v[110:113], v120, s[20:23], 0 offen
    v_add_u32 v120, 33554432, v120
    s_nop 0
    ds_read_b32 v110, v117 offset:24576
    ds_read_b32 v111, v117 offset:24580
    ds_read_b32 v112, v117 offset:24584
    ds_read_b32 v113, v118 offset:16640
    ds_read_b32 v114, v118 offset:16644
    s_cmp_le_u32 s35, 1024
    s_cbranch_scc1 p1_ce0
    s_waitcnt lgkmcnt(5)
    v_alignbyte_b32 v125, v121, v125, v119
    buffer_store_dwordx4 v[122:125], v120, s[20:23], 0 offen
    v_add_u32 v120, 33554432, v120
    s_nop 0
    ds_read_b32 v122, v117 offset:36864
    ds_read_b32 v123, v117 offset:36868
    ds_read_b32 v124, v117 offset:36872
    ds_read_b32 v125, v118 offset:19712
    ds_read_b32 v121, v118 offset:19716
    s_cmp_le_u32 s35, 2048
    s_cbranch_scc1 p1_ce0
    s_waitcnt lgkmcnt(5)
    v_alignbyte_b32 v113, v114, v113, v119
    buffer_store_dwordx4 v[110:113], v120, s[20:23], 0 offen
    v_add_u32 v120, 33554432, v120
    s_nop 0
    ds_read_b32 v110, v117 offset:49152
    ds_read_b32 v111, v117 offset:49156
    ds_read_b32 v112, v117 offset:49160
    ds_read_b32 v113, v118 offset:22784
    ds_read_b32 v114, v118 offset:22788
    s_cmp_le_u32 s35, 3072
    s_cbranch_scc1 p1_ce0
    s_waitcnt lgkmcnt(5)
    v_alignbyte_b32 v125, v121, v125, v119
    buffer_store_dwordx4 v[122:125], v120, s[20:23], 0 offen
    v_add_u32 v120, 33554432, v120
    s_nop 0
    v_lshlrev_b32 v117, 2, v119
    v_add_u32 v117, 113920, v117
    ds_read_b32 v122, v117 offset:0
    ds_read_b32 v123, v117 offset:4
    ds_read_b32 v124, v117 offset:8
    ds_read_b32 v125, v118 offset:25856
    ds_read_b32 v121, v118 offset:25860
    s_cmp_le_u32 s35, 4096
    s_cbranch_scc1 p1_ce0
    s_waitcnt lgkmcnt(5)
    v_alignbyte_b32 v113, v114, v113, v119
    buffer_store_dwordx4 v[110:113], v120, s[20:23], 0 offen
    v_add_u32 v120, 33554432, v120
    s_nop 0
    ds_read_b32 v110, v117 offset:12288
    ds_read_b32 v111, v117 offset:12292
    ds_read_b32 v112, v117 offset:12296
    ds_read_b32 v113, v118 offset:28928
    ds_read_b32 v114, v118 offset:28932
    s_cmp_le_u32 s35, 5120
    s_cbranch_scc1 p1_ce0
    s_waitcnt lgkmcnt(5)
    v_alignbyte_b32 v125, v121, v125, v119
    buffer_store_dwordx4 v[122:125], v120, s[20:23], 0 offen
    v_add_u32 v120, 33554432, v120
    s_nop 0
    ds_read_b32 v122, v117 offset:24576
    ds_read_b32 v123, v117 offset:24580
    ds_read_b32 v124, v117 offset:24584
    ds_read_b32 v125, v118 offset:32000
    ds_read_b32 v121, v118 offset:32004
    s_cmp_le_u32 s35, 6144
    s_cbranch_scc1 p1_ce0
    s_waitcnt lgkmcnt(5)
    v_alignbyte_b32 v113, v114, v113, v119
    buffer_store_dwordx4 v[110:113], v120, s[20:23], 0 offen
    v_add_u32 v120, 33554432, v120
    s_nop 0
    ds_read_b32 v110, v117 offset:36864
    ds_read_b32 v111, v117 offset:36868
    ds_read_b32 v112, v117 offset:36872
    ds_read_b32 v113, v118 offset:35072
    ds_read_b32 v114, v118 offset:35076
    s_cmp_le_u32 s35, 7168
    s_cbranch_scc1 p1_ce0
    s_waitcnt lgkmcnt(5)
    v_alignbyte_b32 v125, v121, v125, v119
    buffer_store_dwordx4 v[122:125], v120, s[20:23], 0 offen
    v_add_u32 v120, 33554432, v120
    s_nop 0
    s_cmp_le_u32 s35, 8192
    s_cbranch_scc1 p1_ce0
    s_waitcnt lgkmcnt(0)
    v_alignbyte_b32 v113, v114, v113, v119
    buffer_store_dwordx4 v[110:113], v120, s[20:23], 0 offen
    v_add_u32 v120, 33554432, v120
    s_nop 0
p1_ce0:
    s_waitcnt lgkmcnt(0)
    s_cmp_lg_u32 s70, 8
    s_cbranch_scc1 p1_h1
    s_sub_u32 s52, s33, 1472
    s_mul_i32 s52, s52, 41600
    s_add_u32 s52, s52, 477470720
    s_mov_b32 s54, 0x05040100
    s_mov_b32 s55, 0x07060302
    s_waitcnt vmcnt(1)
    v_perm_b32 v92, v78, v76, s54
    v_perm_b32 v93, v82, v80, s54
    v_perm_b32 v94, v86, v84, s54
    v_perm_b32 v95, v90, v88, s54
    buffer_store_dwordx4 v[92:95], v101, s[16:19], s52 offen offset:0
    v_perm_b32 v96, v78, v76, s55
    v_perm_b32 v97, v82, v80, s55
    v_perm_b32 v98, v86, v84, s55
    v_perm_b32 v99, v90, v88, s55
    buffer_store_dwordx4 v[96:99], v101, s[16:19], s52 offen offset:1040
    v_perm_b32 v92, v79, v77, s54
    v_perm_b32 v93, v83, v81, s54
    v_perm_b32 v94, v87, v85, s54
    v_perm_b32 v95, v91, v89, s54
    buffer_store_dwordx4 v[92:95], v101, s[16:19], s52 offen offset:2080
    v_perm_b32 v96, v79, v77, s55
    v_perm_b32 v97, v83, v81, s55
    v_perm_b32 v98, v87, v85, s55
    v_perm_b32 v99, v91, v89, s55
    buffer_store_dwordx4 v[96:99], v101, s[16:19], s52 offen offset:3120
p1_h1:
    s_barrier
    s_cmp_ge_u32 s29, 1445
    s_cbranch_scc1 p1_k42
    s_cmp_le_u32 s35, 9216
    s_cbranch_scc1 p1_s1k2
    v_lshlrev_b32_sdwa v122, 2, v40 dst_sel:DWORD dst_unused:UNUSED_PAD src0_sel:DWORD src1_sel:WORD_1
    ds_write_b32 v122, v12 offset:52480
    v_lshlrev_b32_sdwa v123, 2, v41 dst_sel:DWORD dst_unused:UNUSED_PAD src0_sel:DWORD src1_sel:WORD_1
    ds_write_b32 v123, v13 offset:52480
    v_lshlrev_b32_sdwa v124, 2, v42 dst_sel:DWORD dst_unused:UNUSED_PAD src0_sel:DWORD src1_sel:WORD_1
    ds_write_b32 v124, v14 offset:52480
    v_lshlrev_b32_sdwa v125, 2, v43 dst_sel:DWORD dst_unused:UNUSED_PAD src0_sel:DWORD src1_sel:WORD_1
    ds_write_b32 v125, v15 offset:52480
p1_s1k2:
p1_k42:
    s_cmp_ge_u32 s33, 1472
    s_cbranch_scc1 p1_k43
    s_cmp_lt_u32 s33, 1445
    s_cselect_b32 s6, 204800000, 0
    s_add_u32 s32, s30, 32768
    buffer_load_dwordx4 v[12:15], v1, s[4:7], s32 offen nt
p1_k43:
    s_cmp_ge_u32 s29, 1419
    s_cbranch_scc1 p1_k44
    s_cmp_le_u32 s35, 9216
    s_cbranch_scc1 p1_s1k3
    v_lshlrev_b32_sdwa v122, 2, v44 dst_sel:DWORD dst_unused:UNUSED_PAD src0_sel:DWORD src1_sel:WORD_1
    ds_write_b32 v122, v16 offset:52480
    v_lshlrev_b32_sdwa v123, 2, v45 dst_sel:DWORD dst_unused:UNUSED_PAD src0_sel:DWORD src1_sel:WORD_1
    ds_write_b32 v123, v17 offset:52480
    v_lshlrev_b32_sdwa v124, 2, v46 dst_sel:DWORD dst_unused:UNUSED_PAD src0_sel:DWORD src1_sel:WORD_1
    ds_write_b32 v124, v18 offset:52480
    v_lshlrev_b32_sdwa v125, 2, v47 dst_sel:DWORD dst_unused:UNUSED_PAD src0_sel:DWORD src1_sel:WORD_1
    ds_write_b32 v125, v19 offset:52480
p1_s1k3:
p1_k44:
    s_cmp_ge_u32 s29, 1365
    s_cbranch_scc1 p1_k45
    s_cmp_le_u32 s35, 9216
    s_cbranch_scc1 p1_s1k5
    v_lshlrev_b32_sdwa v122, 2, v56 dst_sel:DWORD dst_unused:UNUSED_PAD src0_sel:DWORD src1_sel:WORD_1
    ds_write_b32 v122, v24 offset:52480
    v_lshlrev_b32_sdwa v123, 2, v57 dst_sel:DWORD dst_unused:UNUSED_PAD src0_sel:DWORD src1_sel:WORD_1
    ds_write_b32 v123, v25 offset:52480
    v_lshlrev_b32_sdwa v124, 2, v58 dst_sel:DWORD dst_unused:UNUSED_PAD src0_sel:DWORD src1_sel:WORD_1
    ds_write_b32 v124, v26 offset:52480
    v_lshlrev_b32_sdwa v125, 2, v59 dst_sel:DWORD dst_unused:UNUSED_PAD src0_sel:DWORD src1_sel:WORD_1
    ds_write_b32 v125, v27 offset:52480
p1_s1k5:
p1_k45:
    s_cmp_ge_u32 s29, 1312
    s_cbranch_scc1 p1_k46
    s_cmp_le_u32 s35, 9216
    s_cbranch_scc1 p1_s1k7
    v_lshlrev_b32_sdwa v122, 2, v64 dst_sel:DWORD dst_unused:UNUSED_PAD src0_sel:DWORD src1_sel:WORD_1
    ds_write_b32 v122, v32 offset:52480
    v_lshlrev_b32_sdwa v123, 2, v65 dst_sel:DWORD dst_unused:UNUSED_PAD src0_sel:DWORD src1_sel:WORD_1
    ds_write_b32 v123, v33 offset:52480
    v_lshlrev_b32_sdwa v124, 2, v66 dst_sel:DWORD dst_unused:UNUSED_PAD src0_sel:DWORD src1_sel:WORD_1
    ds_write_b32 v124, v34 offset:52480
    v_lshlrev_b32_sdwa v125, 2, v67 dst_sel:DWORD dst_unused:UNUSED_PAD src0_sel:DWORD src1_sel:WORD_1
    ds_write_b32 v125, v35 offset:52480
p1_s1k7:
p1_k46:
    s_cmp_ge_u32 s29, 1392
    s_cbranch_scc1 p1_k47
    s_cmp_le_u32 s35, 9216
    s_cbranch_scc1 p1_s1k4
    v_lshlrev_b32_sdwa v122, 2, v56 dst_sel:DWORD dst_unused:UNUSED_PAD src0_sel:DWORD src1_sel:WORD_0
    ds_write_b32 v122, v20 offset:52480
    v_lshlrev_b32_sdwa v123, 2, v57 dst_sel:DWORD dst_unused:UNUSED_PAD src0_sel:DWORD src1_sel:WORD_0
    ds_write_b32 v123, v21 offset:52480
    v_lshlrev_b32_sdwa v124, 2, v58 dst_sel:DWORD dst_unused:UNUSED_PAD src0_sel:DWORD src1_sel:WORD_0
    ds_write_b32 v124, v22 offset:52480
    v_lshlrev_b32_sdwa v125, 2, v59 dst_sel:DWORD dst_unused:UNUSED_PAD src0_sel:DWORD src1_sel:WORD_0
    ds_write_b32 v125, v23 offset:52480
p1_s1k4:
p1_k47:
    s_cmp_ge_u32 s29, 1338
    s_cbranch_scc1 p1_k48
    s_cmp_le_u32 s35, 9216
    s_cbranch_scc1 p1_s1k6
    v_lshlrev_b32_sdwa v122, 2, v64 dst_sel:DWORD dst_unused:UNUSED_PAD src0_sel:DWORD src1_sel:WORD_0
    ds_write_b32 v122, v28 offset:52480
    v_lshlrev_b32_sdwa v123, 2, v65 dst_sel:DWORD dst_unused:UNUSED_PAD src0_sel:DWORD src1_sel:WORD_0
    ds_write_b32 v123, v29 offset:52480
    v_lshlrev_b32_sdwa v124, 2, v66 dst_sel:DWORD dst_unused:UNUSED_PAD src0_sel:DWORD src1_sel:WORD_0
    ds_write_b32 v124, v30 offset:52480
    v_lshlrev_b32_sdwa v125, 2, v67 dst_sel:DWORD dst_unused:UNUSED_PAD src0_sel:DWORD src1_sel:WORD_0
    ds_write_b32 v125, v31 offset:52480
p1_s1k6:
p1_k48:
    s_cmp_ge_u32 s29, 1285
    s_cbranch_scc1 p1_k49
    s_cmp_le_u32 s35, 9216
    s_cbranch_scc1 p1_s1k8
    v_lshlrev_b32_sdwa v122, 2, v72 dst_sel:DWORD dst_unused:UNUSED_PAD src0_sel:DWORD src1_sel:WORD_0
    ds_write_b32 v122, v36 offset:52480
    v_lshlrev_b32_sdwa v123, 2, v73 dst_sel:DWORD dst_unused:UNUSED_PAD src0_sel:DWORD src1_sel:WORD_0
    ds_write_b32 v123, v37 offset:52480
    v_lshlrev_b32_sdwa v124, 2, v74 dst_sel:DWORD dst_unused:UNUSED_PAD src0_sel:DWORD src1_sel:WORD_0
    ds_write_b32 v124, v38 offset:52480
    v_lshlrev_b32_sdwa v125, 2, v75 dst_sel:DWORD dst_unused:UNUSED_PAD src0_sel:DWORD src1_sel:WORD_0
    ds_write_b32 v125, v39 offset:52480
p1_s1k8:
p1_k49:
    s_cmp_le_u32 s35, 9216
    s_cbranch_scc1 p1_s1k0
    v_lshlrev_b32_sdwa v122, 2, v40 dst_sel:DWORD dst_unused:UNUSED_PAD src0_sel:DWORD src1_sel:WORD_0
    ds_write_b32 v122, v4 offset:52480
    v_lshlrev_b32_sdwa v123, 2, v41 dst_sel:DWORD dst_unused:UNUSED_PAD src0_sel:DWORD src1_sel:WORD_0
    ds_write_b32 v123, v5 offset:52480
    v_lshlrev_b32_sdwa v124, 2, v42 dst_sel:DWORD dst_unused:UNUSED_PAD src0_sel:DWORD src1_sel:WORD_0
    ds_write_b32 v124, v6 offset:52480
    v_lshlrev_b32_sdwa v125, 2, v43 dst_sel:DWORD dst_unused:UNUSED_PAD src0_sel:DWORD src1_sel:WORD_0
    ds_write_b32 v125, v7 offset:52480
p1_s1k0:
    s_cmp_le_u32 s35, 9216
    s_cbranch_scc1 p1_s1k1
    v_lshlrev_b32_sdwa v122, 2, v44 dst_sel:DWORD dst_unused:UNUSED_PAD src0_sel:DWORD src1_sel:WORD_0
    ds_write_b32 v122, v8 offset:52480
    v_lshlrev_b32_sdwa v123, 2, v45 dst_sel:DWORD dst_unused:UNUSED_PAD src0_sel:DWORD src1_sel:WORD_0
    ds_write_b32 v123, v9 offset:52480
    v_lshlrev_b32_sdwa v124, 2, v46 dst_sel:DWORD dst_unused:UNUSED_PAD src0_sel:DWORD src1_sel:WORD_0
    ds_write_b32 v124, v10 offset:52480
    v_lshlrev_b32_sdwa v125, 2, v47 dst_sel:DWORD dst_unused:UNUSED_PAD src0_sel:DWORD src1_sel:WORD_0
    ds_write_b32 v125, v11 offset:52480
p1_s1k1:
    s_cmp_lg_u32 s69, 8
    s_cbranch_scc1 p1_o1
    s_lshr_b32 s52, s29, 3
    v_and_b32 v6, 63, v0
    s_cmp_eq_u32 s28, 10
    s_cbranch_scc1 p1_tr11
    s_mul_i32 s53, s28, 520
    v_lshl_add_u32 v4, v6, 3, s53
    s_mul_i32 s53, s28, 4160
    v_lshl_add_u32 v5, v6, 4, s53
    s_branch p1_tr21
p1_tr11:
    v_mul_u32_u24 v4, 520, v6
    v_add_u32 v4, 512, v4
    v_mul_u32_u24 v5, 4160, v6
    v_add_u32 v5, 1024, v5
    v_cmp_gt_u32 vcc, 10, v6
    v_mov_b32 v6, 0x40000000
    s_nop 0
    v_cndmask_b32 v4, v6, v4, vcc
    v_cndmask_b32 v5, v6, v5, vcc
p1_tr21:
    s_mul_i32 s52, s52, 41984
    s_add_u32 s52, s52, 469745664
    buffer_load_dwordx2 v[16:17], v4, s[16:19], s52 offen sc1
    s_add_u32 s52, s52, 5248
    buffer_load_dwordx2 v[18:19], v4, s[16:19], s52 offen sc1
    s_add_u32 s52, s52, 5248
    buffer_load_dwordx2 v[20:21], v4, s[16:19], s52 offen sc1
    s_add_u32 s52, s52, 5248
    buffer_load_dwordx2 v[22:23], v4, s[16:19], s52 offen sc1
    s_add_u32 s52, s52, 5248
    buffer_load_dwordx2 v[24:25], v4, s[16:19], s52 offen sc1
    s_add_u32 s52, s52, 5248
    buffer_load_dwordx2 v[26:27], v4, s[16:19], s52 offen sc1
    s_add_u32 s52, s52, 5248
    buffer_load_dwordx2 v[28:29], v4, s[16:19], s52 offen sc1
    s_add_u32 s52, s52, 5248
    buffer_load_dwordx2 v[30:31], v4, s[16:19], s52 offen sc1
    s_add_u32 s52, s52, 5248
    s_cmp_ge_u32 s33, 1472
    s_cbranch_scc1 p1_o1
    s_lshr_b32 s52, s29, 3
    s_mul_i32 s52, s52, 41600
    s_add_u32 s52, s52, 477470720
    s_mov_b32 s54, 0x05040100
    s_mov_b32 s55, 0x07060302
    s_waitcnt vmcnt(0)
    v_perm_b32 v32, v18, v16, s54
    v_perm_b32 v33, v22, v20, s54
    v_perm_b32 v34, v26, v24, s54
    v_perm_b32 v35, v30, v28, s54
    buffer_store_dwordx4 v[32:35], v5, s[16:19], s52 offen offset:0
    v_perm_b32 v36, v18, v16, s55
    v_perm_b32 v37, v22, v20, s55
    v_perm_b32 v38, v26, v24, s55
    v_perm_b32 v39, v30, v28, s55
    buffer_store_dwordx4 v[36:39], v5, s[16:19], s52 offen offset:1040
    v_perm_b32 v32, v19, v17, s54
    v_perm_b32 v33, v23, v21, s54
    v_perm_b32 v34, v27, v25, s54
    v_perm_b32 v35, v31, v29, s54
    buffer_store_dwordx4 v[32:35], v5, s[16:19], s52 offen offset:2080
    v_perm_b32 v36, v19, v17, s55
    v_perm_b32 v37, v23, v21, s55
    v_perm_b32 v38, v27, v25, s55
    v_perm_b32 v39, v31, v29, s55
    buffer_store_dwordx4 v[36:39], v5, s[16:19], s52 offen offset:3120
    s_mov_b32 s69, 0
p1_o1:
    s_waitcnt lgkmcnt(0)
    s_barrier
    s_cmp_le_u32 s35, 9216
    s_cbranch_scc1 p1_ce1
    v_lshlrev_b32 v117, 2, v119
    v_sub_u32 v117, 113908, v117
    ds_read_b32 v122, v117 offset:49160
    ds_read_b32 v123, v117 offset:49156
    ds_read_b32 v124, v117 offset:49152
    ds_read_b32 v125, v118 offset:38144
    ds_read_b32 v121, v118 offset:38148
    ds_read_b32 v110, v117 offset:36872
    ds_read_b32 v111, v117 offset:36868
    ds_read_b32 v112, v117 offset:36864
    ds_read_b32 v113, v118 offset:41216
    ds_read_b32 v114, v118 offset:41220
    s_waitcnt lgkmcnt(5)
    v_alignbyte_b32 v125, v121, v125, v119
    s_cmp_le_u32 s71, 9
    s_cbranch_scc1 p1_pw9
    buffer_store_dwordx4 v[122:125], v120, s[20:23], 0 offen
    s_branch p1_px9
p1_pw9:
    buffer_store_dwordx4 v[122:125], v120, s[20:23], 0 offen nt
p1_px9:
    v_add_u32 v120, 33554432, v120
    s_nop 0
    ds_read_b32 v122, v117 offset:24584
    ds_read_b32 v123, v117 offset:24580
    ds_read_b32 v124, v117 offset:24576
    ds_read_b32 v125, v118 offset:44288
    ds_read_b32 v121, v118 offset:44292
    s_cmp_le_u32 s35, 10240
    s_cbranch_scc1 p1_ce1
    s_waitcnt lgkmcnt(5)
    v_alignbyte_b32 v113, v114, v113, v119
    buffer_store_dwordx4 v[110:113], v120, s[20:23], 0 offen nt
    v_add_u32 v120, 33554432, v120
    s_nop 0
    ds_read_b32 v110, v117 offset:12296
    ds_read_b32 v111, v117 offset:12292
    ds_read_b32 v112, v117 offset:12288
    ds_read_b32 v113, v118 offset:47360
    ds_read_b32 v114, v118 offset:47364
    s_cmp_le_u32 s35, 11264
    s_cbranch_scc1 p1_ce1
    s_waitcnt lgkmcnt(5)
    v_alignbyte_b32 v125, v121, v125, v119
    buffer_store_dwordx4 v[122:125], v120, s[20:23], 0 offen nt
    v_add_u32 v120, 33554432, v120
    s_nop 0
    ds_read_b32 v122, v117 offset:8
    ds_read_b32 v123, v117 offset:4
    ds_read_b32 v124, v117 offset:0
    ds_read_b32 v125, v118 offset:50432
    ds_read_b32 v121, v118 offset:50436
    s_cmp_le_u32 s35, 12288
    s_cbranch_scc1 p1_ce1
    s_waitcnt lgkmcnt(5)
    v_alignbyte_b32 v113, v114, v113, v119
    buffer_store_dwordx4 v[110:113], v120, s[20:23], 0 offen nt
    v_add_u32 v120, 33554432, v120
    s_nop 0
    s_cmp_le_u32 s35, 13312
    s_cbranch_scc1 p1_ce1
    s_waitcnt lgkmcnt(0)
    v_alignbyte_b32 v125, v121, v125, v119
    buffer_store_dwordx4 v[122:125], v120, s[20:23], 0 offen nt
    v_add_u32 v120, 33554432, v120
    s_nop 0
p1_ce1:
    s_waitcnt lgkmcnt(0)
    s_cmp_lg_u32 s69, 8
    s_cbranch_scc1 p1_o2
    s_lshr_b32 s52, s29, 3
    s_mul_i32 s52, s52, 41600
    s_add_u32 s52, s52, 477470720
    s_mov_b32 s54, 0x05040100
    s_mov_b32 s55, 0x07060302
    s_waitcnt vmcnt(0)
    v_perm_b32 v32, v18, v16, s54
    v_perm_b32 v33, v22, v20, s54
    v_perm_b32 v34, v26, v24, s54
    v_perm_b32 v35, v30, v28, s54
    buffer_store_dwordx4 v[32:35], v5, s[16:19], s52 offen offset:0
    v_perm_b32 v36, v18, v16, s55
    v_perm_b32 v37, v22, v20, s55
    v_perm_b32 v38, v26, v24, s55
    v_perm_b32 v39, v30, v28, s55
    buffer_store_dwordx4 v[36:39], v5, s[16:19], s52 offen offset:1040
    v_perm_b32 v32, v19, v17, s54
    v_perm_b32 v33, v23, v21, s54
    v_perm_b32 v34, v27, v25, s54
    v_perm_b32 v35, v31, v29, s54
    buffer_store_dwordx4 v[32:35], v5, s[16:19], s52 offen offset:2080
    v_perm_b32 v36, v19, v17, s55
    v_perm_b32 v37, v23, v21, s55
    v_perm_b32 v38, v27, v25, s55
    v_perm_b32 v39, v31, v29, s55
    buffer_store_dwordx4 v[36:39], v5, s[16:19], s52 offen offset:3120
p1_o2:
    s_barrier
    s_mov_b32 s29, s33
    s_cmp_lt_u32 s29, 1285
    s_cselect_b32 s34, 1, 0
    s_cmp_lt_u32 s29, 1472
    s_cbranch_scc1 p1_tile
p1_end:
    s_endpgm
.globl p2_kernel
.p2align 8
.type p2_kernel,@function
p2_kernel:
    s_cmp_ge_u32 s2, 256
    s_cbranch_scc1 p2_end
    s_load_dwordx2 s[8:9], s[0:1], 104
    v_and_b32 v112, 63, v0
    v_lshrrev_b32 v122, 6, v0
    v_lshlrev_b32 v112, 4, v112
    v_readfirstlane_b32 s10, v122
    v_mov_b32 v113, 0x83ff0000
    s_and_b32 s44, s2, 7
    s_lshr_b32 s11, s44, 1
    s_and_b32 s44, s44, 1
    s_lshl_b32 s12, s44, 5
    s_lshr_b32 s44, s2, 3
    s_add_u32 s12, s12, s44
    s_mov_b32 s25, 54272
    s_mov_b32 s31, 67175170
    s_mov_b32 s32, 83952386
    s_mov_b32 s33, 100729602
    s_mov_b32 s21, 0
    s_mul_i32 s23, s10, 3072
    s_lshl_b32 s24, s10, 9
    s_lshl_b32 s64, s10, 10
    s_sub_u32 s42, s24, s23
    s_add_u32 s42, s42, 49152
    s_movk_i32 s63, 2048
    s_mov_b32 s65, 16384
    s_mul_i32 s62, s11, 161280
    s_add_u32 s62, s62, 485125120
    s_add_u32 s62, s62, s23
    s_mov_b32 s40, 477470720
    s_mul_i32 s44, s11, 1040
    s_add_u32 s40, s40, s44
    s_lshl_b32 s44, s12, 4
    s_add_u32 s40, s40, s44
    s_waitcnt lgkmcnt(0)
    s_mov_b32 s4, s8
    s_and_b32 s5, s9, 0xffff
    s_mov_b32 s6, 819200000
    s_mov_b32 s7, 0x20000
    s_mov_b32 s68, s8
    s_and_b32 s69, s9, 0xffff
    s_mov_b32 s70, 469745664
    s_mov_b32 s71, 0x20000
    s_and_b32 s44, s2, 7
    s_lshl_b32 s44, s44, 2
    s_lshr_b32 s18, 0x00000000, s44
    s_and_b32 s18, s18, 15
p2_restart:
    s_mov_b32 s61, 0
    s_add_u32 s44, s61, s18
    s_cmp_ge_u32 s44, 10
    s_cselect_b32 s53, 10, 0
    s_sub_u32 s44, s44, s53
    s_mul_i32 s44, s44, 4160
    s_add_u32 s44, s44, s40
    v_bfe_i32 v111, v112, 6, 1
    v_lshrrev_b32 v110, 6, v112
    v_bitop3_b32 v111, v111, 15, s10 bitop3:0x6a
    v_lshl_or_b32 v110, v110, 4, v111
    v_add_u32 v111, 72, v110
    v_and_b32 v111, 0x100, v111
    v_lshl_or_b32 v110, v111, 7, v110
    v_bfe_u32 v111, v112, 2, 4
    v_mul_u32_u24 v110, 41600, v110
    v_add_u32 v111, v110, v111
    buffer_load_dword v110, v111, s[4:7], s44 offen
    buffer_load_dword v111, v111, s[4:7], s44 offen offset:16
    s_mov_b32 s61, 1
    s_add_u32 s44, s61, s18
    s_cmp_ge_u32 s44, 10
    s_cselect_b32 s53, 10, 0
    s_sub_u32 s44, s44, s53
    s_mul_i32 s44, s44, 4160
    s_add_u32 s44, s44, s40
    v_bfe_i32 v67, v112, 6, 1
    v_lshrrev_b32 v66, 6, v112
    v_bitop3_b32 v67, v67, 15, s10 bitop3:0x6a
    v_lshl_or_b32 v66, v66, 4, v67
    v_add_u32 v67, 72, v66
    v_and_b32 v67, 0x100, v67
    v_lshl_or_b32 v66, v67, 7, v66
    v_bfe_u32 v67, v112, 2, 4
    v_mul_u32_u24 v66, 41600, v66
    v_add_u32 v67, v66, v67
    buffer_load_dword v66, v67, s[4:7], s44 offen
    buffer_load_dword v67, v67, s[4:7], s44 offen offset:16
    s_mov_b32 s61, 0
    s_cmp_lt_u32 s10, 15
    s_cselect_b32 s44, s64, 0x40000000
    v_add_u32 v58, s44, v112
    s_mov_b32 s44, 491576320
    buffer_load_dwordx4 v[58:61], v58, s[4:7], s44 offen
    s_mul_i32 s20, s18, 645120
    s_add_u32 s20, s20, s62
    s_cmp_ge_u32 s10, 9
    s_cbranch_scc1 p2_nmp
    v_lshrrev_b32 v84, 1, v112
    s_add_u32 s44, s20, s42
    buffer_load_dwordx2 v[84:85], v84, s[4:7], s44 offen
p2_nmp:
    buffer_load_dwordx4 v[72:75], v112, s[4:7], s20 offen offset:0
    buffer_load_dwordx4 v[76:79], v112, s[4:7], s20 offen offset:1024
    buffer_load_dwordx4 v[80:83], v112, s[4:7], s20 offen offset:2048
    s_barrier
    v_mov_b32 v115, 0
    v_mov_b32 v116, 0
    v_mov_b32 v117, 0
    v_mov_b32 v118, 0
    v_mov_b32 v119, 0
    v_mov_b32 v120, 0
    v_mov_b32 v121, 0
    ds_write_b128 v115, v[116:119] offset:53760
    s_mov_b32 s19, 0
    s_cmp_eq_u32 s21, 2
    s_cselect_b64 s[66:67], -1, 0
    s_waitcnt lgkmcnt(0)
    s_barrier
    s_waitcnt vmcnt(6)
    s_mov_b32 m0, s23
    v_mov_b32 v53, 0
    s_movk_i32 s44, 512
    v_sub_u32_sdwa v4, v111, v110 dst_sel:DWORD dst_unused:UNUSED_PAD src0_sel:WORD_0 src1_sel:WORD_0
    v_sub_u32_sdwa v5, v111, v110 dst_sel:DWORD dst_unused:UNUSED_PAD src0_sel:WORD_1 src1_sel:WORD_1
    v_med3_i32 v4, v4, 0, s44
    v_med3_i32 v5, v5, 0, s44
    v_add_u32 v48, v4, v5
    ds_write_addtid_b32 v53 offset:0
    ds_write_addtid_b32 v53 offset:256
    ds_write_addtid_b32 v53 offset:512
    ds_write_addtid_b32 v53 offset:768
    ds_write_addtid_b32 v53 offset:1024
    ds_write_addtid_b32 v53 offset:1280
    ds_write_addtid_b32 v53 offset:1536
    ds_write_addtid_b32 v53 offset:1792
    v_bfe_i32 v53, v112, 6, 1
    v_lshrrev_b32 v49, 6, v112
    v_bitop3_b32 v53, v53, 15, s10 bitop3:0x6a
    v_lshl_or_b32 v49, v49, 4, v53
    v_and_b32 v53, 0x30, v112
    v_lshl_or_b32 v53, v49, 6, v53
    v_lshlrev_b32 v53, 15, v53
    s_nop 1
    v_add_u32_dpp v48, v48, v48 row_shr:1 row_mask:0xf bank_mask:0xf bound_ctrl:0
    s_nop 1
    v_add_u32_dpp v48, v48, v48 row_shr:2 row_mask:0xf bank_mask:0xf bound_ctrl:0
    s_nop 1
    v_add_u32_dpp v48, v48, v48 row_shr:4 row_mask:0xf bank_mask:0xf bound_ctrl:0
    s_nop 1
    v_add_u32_dpp v48, v48, v48 row_shr:8 row_mask:0xf bank_mask:0xf bound_ctrl:0
    s_nop 1
    v_add_u32_dpp v48, v48, v48 row_bcast:15 row_mask:0xa bank_mask:0xf
    s_nop 1
    v_add_u32_dpp v48, v48, v48 row_bcast:31 row_mask:0xc bank_mask:0xf
    s_nop 1
    s_nop 0
    v_readlane_b32 s38, v48, 63
    v_sub_u32 v50, v48, v5
    v_sub_u32 v49, v50, v4
    v_writelane_b32 v5, 1, 63
    v_sub_u32 v10, 512, v49
    v_mad_u32_u16 v51, v110, 16, v53
    v_lshl_add_u32 v51, v10, 4, v51
    v_med3_i32 v10, v10, 0, v4
    v_lshl_add_u32 v49, v49, 2, s23
    v_sub_u32 v11, 512, v50
    v_mad_u32_u16 v52, v110, 16, v53 op_sel:[1,0,0,0]
    v_add_u32 v52, 262144, v52
    s_mov_b32 s44, 0x1fffc000
    v_writelane_b32 v52, s44, 63
    v_lshl_add_u32 v52, v11, 4, v52
    v_med3_i32 v11, v11, 0, v5
    v_lshl_add_u32 v50, v50, 2, s23
    v_lshl_add_u32 v48, v11, 16, v10
    v_add_u32 v110, v110, v48
    s_min_u32 s17, s38, 512
    s_add_u32 s17, s17, 63
    s_lshr_b32 s17, s17, 6
    v_cmpx_lt_i32 vcc, 0, v10
    ds_write_b32 v49, v51
    s_mov_b64 exec, -1
    v_cmpx_lt_i32 vcc, 0, v11
    ds_write_b32 v50, v52
    s_mov_b64 exec, -1
    s_cmp_lt_u32 s38, 512
    s_cbranch_scc1 p2_nomorea
    v_cmp_lt_u32_sdwa s[44:45], v110, v111 src0_sel:WORD_0 src1_sel:WORD_0
    v_cmp_lt_u32_sdwa s[46:47], v110, v111 src0_sel:WORD_1 src1_sel:WORD_1
    s_nop 0
    s_or_b64 s[44:45], s[44:45], s[46:47]
    s_cbranch_scc0 p2_nomorea
    v_mov_b32 v49, s19
    v_mov_b32 v50, 1
    ds_write_b32 v49, v50 offset:53760
p2_nomorea:
    s_mov_b32 m0, s23
    s_nop 0
    ds_read_addtid_b32 v2 offset:1024
    ds_read_addtid_b32 v8 offset:1280
    ds_read_addtid_b32 v14 offset:1536
    ds_read_addtid_b32 v20 offset:1792
    ds_read_addtid_b32 v88 offset:0
    ds_read_addtid_b32 v92 offset:256
    ds_read_addtid_b32 v96 offset:512
    ds_read_addtid_b32 v100 offset:768
    s_waitcnt lgkmcnt(0)
    s_nop 2
    s_nop 1
    v_max_u32_dpp v88, v88, v88 row_shr:1 row_mask:0xf bank_mask:0xf bound_ctrl:0
    v_max_u32_dpp v92, v92, v92 row_shr:1 row_mask:0xf bank_mask:0xf bound_ctrl:0
    v_max_u32_dpp v96, v96, v96 row_shr:1 row_mask:0xf bank_mask:0xf bound_ctrl:0
    v_max_u32_dpp v100, v100, v100 row_shr:1 row_mask:0xf bank_mask:0xf bound_ctrl:0
    v_max_u32_dpp v2, v2, v2 row_shr:1 row_mask:0xf bank_mask:0xf bound_ctrl:0
    v_max_u32_dpp v8, v8, v8 row_shr:1 row_mask:0xf bank_mask:0xf bound_ctrl:0
    v_max_u32_dpp v14, v14, v14 row_shr:1 row_mask:0xf bank_mask:0xf bound_ctrl:0
    v_max_u32_dpp v20, v20, v20 row_shr:1 row_mask:0xf bank_mask:0xf bound_ctrl:0
    v_max_u32_dpp v88, v88, v88 row_shr:2 row_mask:0xf bank_mask:0xf bound_ctrl:0
    v_max_u32_dpp v92, v92, v92 row_shr:2 row_mask:0xf bank_mask:0xf bound_ctrl:0
    v_max_u32_dpp v96, v96, v96 row_shr:2 row_mask:0xf bank_mask:0xf bound_ctrl:0
    v_max_u32_dpp v100, v100, v100 row_shr:2 row_mask:0xf bank_mask:0xf bound_ctrl:0
    v_max_u32_dpp v2, v2, v2 row_shr:2 row_mask:0xf bank_mask:0xf bound_ctrl:0
    v_max_u32_dpp v8, v8, v8 row_shr:2 row_mask:0xf bank_mask:0xf bound_ctrl:0
    v_max_u32_dpp v14, v14, v14 row_shr:2 row_mask:0xf bank_mask:0xf bound_ctrl:0
    v_max_u32_dpp v20, v20, v20 row_shr:2 row_mask:0xf bank_mask:0xf bound_ctrl:0
    v_max_u32_dpp v88, v88, v88 row_shr:4 row_mask:0xf bank_mask:0xf bound_ctrl:0
    v_max_u32_dpp v92, v92, v92 row_shr:4 row_mask:0xf bank_mask:0xf bound_ctrl:0
    v_max_u32_dpp v96, v96, v96 row_shr:4 row_mask:0xf bank_mask:0xf bound_ctrl:0
    v_max_u32_dpp v100, v100, v100 row_shr:4 row_mask:0xf bank_mask:0xf bound_ctrl:0
    v_max_u32_dpp v2, v2, v2 row_shr:4 row_mask:0xf bank_mask:0xf bound_ctrl:0
    v_max_u32_dpp v8, v8, v8 row_shr:4 row_mask:0xf bank_mask:0xf bound_ctrl:0
    v_max_u32_dpp v14, v14, v14 row_shr:4 row_mask:0xf bank_mask:0xf bound_ctrl:0
    v_max_u32_dpp v20, v20, v20 row_shr:4 row_mask:0xf bank_mask:0xf bound_ctrl:0
    v_max_u32_dpp v88, v88, v88 row_shr:8 row_mask:0xf bank_mask:0xf bound_ctrl:0
    v_max_u32_dpp v92, v92, v92 row_shr:8 row_mask:0xf bank_mask:0xf bound_ctrl:0
    v_max_u32_dpp v96, v96, v96 row_shr:8 row_mask:0xf bank_mask:0xf bound_ctrl:0
    v_max_u32_dpp v100, v100, v100 row_shr:8 row_mask:0xf bank_mask:0xf bound_ctrl:0
    v_max_u32_dpp v2, v2, v2 row_shr:8 row_mask:0xf bank_mask:0xf bound_ctrl:0
    v_max_u32_dpp v8, v8, v8 row_shr:8 row_mask:0xf bank_mask:0xf bound_ctrl:0
    v_max_u32_dpp v14, v14, v14 row_shr:8 row_mask:0xf bank_mask:0xf bound_ctrl:0
    v_max_u32_dpp v20, v20, v20 row_shr:8 row_mask:0xf bank_mask:0xf bound_ctrl:0
    v_max_u32_dpp v88, v88, v88 row_bcast:15 row_mask:0xa bank_mask:0xf
    v_max_u32_dpp v92, v92, v92 row_bcast:15 row_mask:0xa bank_mask:0xf
    v_max_u32_dpp v96, v96, v96 row_bcast:15 row_mask:0xa bank_mask:0xf
    v_max_u32_dpp v100, v100, v100 row_bcast:15 row_mask:0xa bank_mask:0xf
    v_max_u32_dpp v2, v2, v2 row_bcast:15 row_mask:0xa bank_mask:0xf
    v_max_u32_dpp v8, v8, v8 row_bcast:15 row_mask:0xa bank_mask:0xf
    v_max_u32_dpp v14, v14, v14 row_bcast:15 row_mask:0xa bank_mask:0xf
    v_max_u32_dpp v20, v20, v20 row_bcast:15 row_mask:0xa bank_mask:0xf
    v_max_u32_dpp v88, v88, v88 row_bcast:31 row_mask:0xc bank_mask:0xf
    v_max_u32_dpp v92, v92, v92 row_bcast:31 row_mask:0xc bank_mask:0xf
    v_max_u32_dpp v96, v96, v96 row_bcast:31 row_mask:0xc bank_mask:0xf
    v_max_u32_dpp v100, v100, v100 row_bcast:31 row_mask:0xc bank_mask:0xf
    v_max_u32_dpp v2, v2, v2 row_bcast:31 row_mask:0xc bank_mask:0xf
    v_max_u32_dpp v8, v8, v8 row_bcast:31 row_mask:0xc bank_mask:0xf
    v_max_u32_dpp v14, v14, v14 row_bcast:31 row_mask:0xc bank_mask:0xf
    v_max_u32_dpp v20, v20, v20 row_bcast:31 row_mask:0xc bank_mask:0xf
    s_nop 0
    v_readlane_b32 s41, v88, 63
    v_add_u32 v88, v88, v112
    v_add_u32 v88, 4294959104, v88
    v_max_u32 v92, s41, v92
    s_nop 0
    v_readlane_b32 s41, v92, 63
    v_add_u32 v92, v92, v112
    v_add_u32 v92, 4294960128, v92
    v_max_u32 v96, s41, v96
    s_nop 0
    v_readlane_b32 s41, v96, 63
    v_add_u32 v96, v96, v112
    v_add_u32 v96, 4294961152, v96
    v_max_u32 v100, s41, v100
    s_nop 0
    v_readlane_b32 s41, v100, 63
    v_add_u32 v100, v100, v112
    v_add_u32 v100, 4294962176, v100
    v_max_u32 v2, s41, v2
    s_nop 0
    v_readlane_b32 s41, v2, 63
    v_add_u32 v2, v2, v112
    v_add_u32 v2, 4294963200, v2
    v_max_u32 v8, s41, v8
    s_nop 0
    v_readlane_b32 s41, v8, 63
    v_add_u32 v8, v8, v112
    v_add_u32 v8, 4294964224, v8
    v_max_u32 v14, s41, v14
    s_nop 0
    v_readlane_b32 s41, v14, 63
    v_add_u32 v14, v14, v112
    v_add_u32 v14, 4294965248, v14
    v_max_u32 v20, s41, v20
    s_nop 0
    v_readlane_b32 s41, v20, 63
    v_add_u32 v20, v20, v112
    v_add_u32 v20, 4294966272, v20
    v_bfe_u32 v0, v2, 14, 4
    v_lshrrev_b32 v1, 18, v2
    v_and_b32 v2, 16383, v2
    v_mad_u32_u24 v0, v0, s63, v1
    v_mad_u32_u24 v2, v0, s65, v2
    buffer_load_dwordx4 v[0:3], v2, s[68:71], 0 offen
    v_bfe_u32 v6, v8, 14, 4
    v_lshrrev_b32 v7, 18, v8
    v_and_b32 v8, 16383, v8
    v_mad_u32_u24 v6, v6, s63, v7
    v_mad_u32_u24 v8, v6, s65, v8
    buffer_load_dwordx4 v[6:9], v8, s[68:71], 0 offen
    s_cmp_eq_u32 s21, 0
    s_cselect_b32 s44, 1073758208, 0
    v_mov_b32 v124, s44
    v_mov_b32 v125, s44
    v_mov_b32 v126, s44
    v_mov_b32 v127, s44
    v_add_u32 v123, s64, v112
    v_add_u32 v122, s25, v123
    ds_write_b128 v122, v[124:127] offset:0
    ds_write_b128 v122, v[124:127] offset:16384
    ds_write_b128 v122, v[124:127] offset:32768
    v_add_u32 v122, 49152, v122
    ds_write_b128 v122, v[124:127] offset:0
    ds_write_b128 v122, v[124:127] offset:16384
    ds_write_b128 v122, v[124:127] offset:32768
    v_cmpx_gt_u32 vcc, 1792, v123
    ds_write_b128 v122, v[124:127] offset:49152
    s_mov_b64 exec, -1
    v_bfe_u32 v12, v14, 14, 4
    v_lshrrev_b32 v13, 18, v14
    v_and_b32 v14, 16383, v14
    v_mad_u32_u24 v12, v12, s63, v13
    v_mad_u32_u24 v14, v12, s65, v14
    buffer_load_dwordx4 v[12:15], v14, s[68:71], 0 offen
    s_mov_b32 s16, s17
    s_waitcnt vmcnt(6)
    s_cmp_lg_u32 s21, 0
    s_cbranch_scc1 p2_nostat1
    v_max_u32 v58, v58, v60
    v_add_f32 v59, v59, v61
    s_nop 1
    v_max_u32_dpp v58, v58, v58 row_shr:1 row_mask:0xf bank_mask:0xf bound_ctrl:0
    v_add_f32_dpp v59, v59, v59 row_shr:1 row_mask:0xf bank_mask:0xf bound_ctrl:0
    s_nop 0
    v_max_u32_dpp v58, v58, v58 row_shr:2 row_mask:0xf bank_mask:0xf bound_ctrl:0
    v_add_f32_dpp v59, v59, v59 row_shr:2 row_mask:0xf bank_mask:0xf bound_ctrl:0
    s_nop 0
    v_max_u32_dpp v58, v58, v58 row_shr:4 row_mask:0xf bank_mask:0xf bound_ctrl:0
    v_add_f32_dpp v59, v59, v59 row_shr:4 row_mask:0xf bank_mask:0xf bound_ctrl:0
    s_nop 0
    v_max_u32_dpp v58, v58, v58 row_shr:8 row_mask:0xf bank_mask:0xf bound_ctrl:0
    v_add_f32_dpp v59, v59, v59 row_shr:8 row_mask:0xf bank_mask:0xf bound_ctrl:0
    s_nop 0
    v_max_u32_dpp v58, v58, v58 row_bcast:15 row_mask:0xa bank_mask:0xf
    v_add_f32_dpp v59, v59, v59 row_bcast:15 row_mask:0xa bank_mask:0xf
    s_nop 0
    v_max_u32_dpp v58, v58, v58 row_bcast:31 row_mask:0xc bank_mask:0xf
    v_add_f32_dpp v59, v59, v59 row_bcast:31 row_mask:0xc bank_mask:0xf
    s_nop 0
    s_nop 0
    s_lshl_b32 s44, s10, 3
    v_mov_b32 v60, s44
    s_mov_b64 exec, 1
    s_lshl_b64 exec, exec, 63
    ds_write_b64 v60, v[58:59] offset:53824
    s_mov_b64 exec, -1
p2_nostat1:
    s_waitcnt lgkmcnt(0)
    s_barrier
    v_bfe_u32 v18, v20, 14, 4
    v_lshrrev_b32 v19, 18, v20
    v_and_b32 v20, 16383, v20
    v_mad_u32_u24 v18, v18, s63, v19
    v_mad_u32_u24 v20, v18, s65, v20
    buffer_load_dwordx4 v[18:21], v20, s[68:71], 0 offen
    v_mov_b32 v122, s19
    s_xor_b32 s19, s19, 4
    ds_read_b32 v125, v122 offset:53760
    s_cmp_lg_u32 s21, 0
    s_cbranch_scc1 p2_nostat2
    v_bfe_u32 v60, v112, 1, 7
    ds_read_b64 v[58:59], v60 offset:53824
    s_waitcnt lgkmcnt(0)
    s_nop 1
    v_max_u32_dpp v58, v58, v58 row_shr:1 row_mask:0xf bank_mask:0xf bound_ctrl:0
    v_add_f32_dpp v59, v59, v59 row_shr:1 row_mask:0xf bank_mask:0xf bound_ctrl:0
    s_nop 0
    v_max_u32_dpp v58, v58, v58 row_shr:2 row_mask:0xf bank_mask:0xf bound_ctrl:0
    v_add_f32_dpp v59, v59, v59 row_shr:2 row_mask:0xf bank_mask:0xf bound_ctrl:0
    s_nop 0
    v_max_u32_dpp v58, v58, v58 row_shr:4 row_mask:0xf bank_mask:0xf bound_ctrl:0
    v_add_f32_dpp v59, v59, v59 row_shr:4 row_mask:0xf bank_mask:0xf bound_ctrl:0
    s_nop 0
    v_max_u32_dpp v58, v58, v58 row_shr:8 row_mask:0xf bank_mask:0xf bound_ctrl:0
    v_add_f32_dpp v59, v59, v59 row_shr:8 row_mask:0xf bank_mask:0xf bound_ctrl:0
    s_nop 0
    v_max_u32_dpp v58, v58, v58 row_bcast:15 row_mask:0xa bank_mask:0xf
    v_add_f32_dpp v59, v59, v59 row_bcast:15 row_mask:0xa bank_mask:0xf
    s_nop 0
    v_max_u32_dpp v58, v58, v58 row_bcast:31 row_mask:0xc bank_mask:0xf
    v_add_f32_dpp v59, v59, v59 row_bcast:31 row_mask:0xc bank_mask:0xf
    s_nop 0
    s_nop 0
    v_readlane_b32 s44, v58, 15
    v_readlane_b32 s45, v59, 15
    s_nop 1
    s_lshl_b32 s44, s44, 16
    s_lshr_b32 s46, s44, 23
    s_sub_u32 s47, s46, 80
    s_cmp_lt_u32 s47, 100
    s_cselect_b32 s21, 0, 1
    v_mov_b32 v58, s45
    v_mul_f32 v58, 0x34a7c5ac, v58
    v_sqrt_f32 v58, v58
    v_mov_b32 v59, s44
    v_mul_f32 v60, 0x41800000, v58
    v_cmp_nle_f32 vcc, v59, v60
    v_mul_f32 v58, 0x3ac00000, v58
    v_mul_f32 v59, 0x3901742e, v59
    v_max_f32 v58, v58, v59
    s_cmp_lg_u64 vcc, 0
    s_cselect_b32 s21, 1, s21
    v_readfirstlane_b32 s44, v58
    s_nop 0
    s_and_b32 s47, s44, 0x7fffff
    s_or_b32 s47, s47, 0x3f000000
    s_and_b32 s48, s44, 0x7f800000
    s_add_u32 s48, s48, 0x800000
    v_rcp_f32 v58, s47
    s_nop 0
    v_rcp_f32 v59, v58
    v_mul_f32 v58, 0x7b800000, v58
    v_mul_f32 v59, s48, v59
    s_nop 0
    v_readfirstlane_b32 s26, v58
    v_readfirstlane_b32 s30, v59
    s_add_u32 s34, s48, 197132288
    s_mov_b32 s35, s34
    s_sub_u32 s36, 0, s34
    s_subb_u32 s37, 0, s34
    s_cmp_eq_u32 s21, 0
    s_cbranch_scc1 p2_nostat2
    s_waitcnt vmcnt(0) lgkmcnt(0)
    s_branch p2_restart
p2_nostat2:
    s_cmp_eq_u32 s21, 0
    s_cselect_b32 s26, s26, 0x7b800000
    v_mov_b32 v114, s26
    s_waitcnt lgkmcnt(0)
    v_readfirstlane_b32 s44, v125
    s_nop 0
    s_cmp_lg_u32 s44, 0
    s_cbranch_scc1 p2_adva
    s_mov_b32 s61, 1
    v_mov_b32 v110, v66
    v_mov_b32 v111, v67
p2_adva:
    v_bfe_u32 v86, v88, 14, 4
    v_lshrrev_b32 v87, 18, v88
    v_and_b32 v88, 16383, v88
    v_mad_u32_u24 v86, v86, s63, v87
    v_mad_u32_u24 v88, v86, s65, v88
    buffer_load_dwordx4 v[86:89], v88, s[68:71], 0 offen
    s_mov_b32 m0, s23
    v_mov_b32 v53, 0
    s_movk_i32 s44, 512
    v_sub_u32_sdwa v4, v111, v110 dst_sel:DWORD dst_unused:UNUSED_PAD src0_sel:WORD_0 src1_sel:WORD_0
    v_sub_u32_sdwa v5, v111, v110 dst_sel:DWORD dst_unused:UNUSED_PAD src0_sel:WORD_1 src1_sel:WORD_1
    v_med3_i32 v4, v4, 0, s44
    v_med3_i32 v5, v5, 0, s44
    v_add_u32 v48, v4, v5
    ds_write_addtid_b32 v53 offset:0
    ds_write_addtid_b32 v53 offset:256
    ds_write_addtid_b32 v53 offset:512
    ds_write_addtid_b32 v53 offset:768
    ds_write_addtid_b32 v53 offset:1024
    ds_write_addtid_b32 v53 offset:1280
    ds_write_addtid_b32 v53 offset:1536
    ds_write_addtid_b32 v53 offset:1792
    v_bfe_i32 v53, v112, 6, 1
    v_lshrrev_b32 v49, 6, v112
    v_bitop3_b32 v53, v53, 15, s10 bitop3:0x6a
    v_lshl_or_b32 v49, v49, 4, v53
    v_and_b32 v53, 0x30, v112
    v_lshl_or_b32 v53, v49, 6, v53
    v_lshlrev_b32 v53, 15, v53
    s_nop 1
    v_add_u32_dpp v48, v48, v48 row_shr:1 row_mask:0xf bank_mask:0xf bound_ctrl:0
    s_nop 1
    v_add_u32_dpp v48, v48, v48 row_shr:2 row_mask:0xf bank_mask:0xf bound_ctrl:0
    s_nop 1
    v_add_u32_dpp v48, v48, v48 row_shr:4 row_mask:0xf bank_mask:0xf bound_ctrl:0
    s_nop 1
    v_add_u32_dpp v48, v48, v48 row_shr:8 row_mask:0xf bank_mask:0xf bound_ctrl:0
    s_nop 1
    v_add_u32_dpp v48, v48, v48 row_bcast:15 row_mask:0xa bank_mask:0xf
    s_nop 1
    v_add_u32_dpp v48, v48, v48 row_bcast:31 row_mask:0xc bank_mask:0xf
    s_nop 1
    s_nop 0
    v_readlane_b32 s38, v48, 63
    v_sub_u32 v50, v48, v5
    v_sub_u32 v49, v50, v4
    v_writelane_b32 v5, 1, 63
    v_sub_u32 v10, 512, v49
    v_mad_u32_u16 v51, v110, 16, v53
    v_lshl_add_u32 v51, v10, 4, v51
    v_med3_i32 v10, v10, 0, v4
    v_lshl_add_u32 v49, v49, 2, s23
    v_sub_u32 v11, 512, v50
    v_mad_u32_u16 v52, v110, 16, v53 op_sel:[1,0,0,0]
    v_add_u32 v52, 262144, v52
    s_mov_b32 s44, 0x1fffc000
    v_writelane_b32 v52, s44, 63
    v_lshl_add_u32 v52, v11, 4, v52
    v_med3_i32 v11, v11, 0, v5
    v_lshl_add_u32 v50, v50, 2, s23
    v_lshl_add_u32 v48, v11, 16, v10
    v_add_u32 v110, v110, v48
    s_min_u32 s17, s38, 512
    s_add_u32 s17, s17, 63
    s_lshr_b32 s17, s17, 6
    v_cmpx_lt_i32 vcc, 0, v10
    ds_write_b32 v49, v51
    s_mov_b64 exec, -1
    v_cmpx_lt_i32 vcc, 0, v11
    ds_write_b32 v50, v52
    s_mov_b64 exec, -1
    s_cmp_lt_u32 s38, 512
    s_cbranch_scc1 p2_nomoreb
    v_cmp_lt_u32_sdwa s[44:45], v110, v111 src0_sel:WORD_0 src1_sel:WORD_0
    v_cmp_lt_u32_sdwa s[46:47], v110, v111 src0_sel:WORD_1 src1_sel:WORD_1
    s_nop 0
    s_or_b64 s[44:45], s[44:45], s[46:47]
    s_cbranch_scc0 p2_nomoreb
    v_mov_b32 v49, s19
    v_mov_b32 v50, 1
    ds_write_b32 v49, v50 offset:53760
p2_nomoreb:
    s_mov_b32 m0, s23
    s_nop 0
    ds_read_addtid_b32 v102 offset:1024
    ds_read_addtid_b32 v103 offset:1280
    ds_read_addtid_b32 v104 offset:1536
    ds_read_addtid_b32 v105 offset:1792
    ds_read_addtid_b32 v106 offset:0
    ds_read_addtid_b32 v107 offset:256
    ds_read_addtid_b32 v108 offset:512
    ds_read_addtid_b32 v109 offset:768
    v_bfe_u32 v90, v92, 14, 4
    v_lshrrev_b32 v91, 18, v92
    v_and_b32 v92, 16383, v92
    v_mad_u32_u24 v90, v90, s63, v91
    v_mad_u32_u24 v92, v90, s65, v92
    buffer_load_dwordx4 v[90:93], v92, s[68:71], 0 offen
    s_waitcnt vmcnt(6)
    s_mov_b32 m0, s24
    s_cmp_ge_u32 s10, 9
    s_cbranch_scc1 p2_stp
    ds_write_addtid_b32 v84 offset:49152
    ds_write_addtid_b32 v85 offset:49408
p2_stp:
    s_mov_b32 m0, s23
    s_add_u32 s20, s20, 53760
    ds_write_addtid_b32 v72 offset:0
    ds_write_addtid_b32 v73 offset:256
    ds_write_addtid_b32 v74 offset:512
    ds_write_addtid_b32 v75 offset:768
    ds_write_addtid_b32 v76 offset:1024
    ds_write_addtid_b32 v77 offset:1280
    ds_write_addtid_b32 v78 offset:1536
    ds_write_addtid_b32 v79 offset:1792
    ds_write_addtid_b32 v80 offset:2048
    ds_write_addtid_b32 v81 offset:2304
    ds_write_addtid_b32 v82 offset:2560
    ds_write_addtid_b32 v83 offset:2816
    s_waitcnt lgkmcnt(0)
    s_barrier
    v_bfe_u32 v94, v96, 14, 4
    v_lshrrev_b32 v95, 18, v96
    v_and_b32 v96, 16383, v96
    v_mad_u32_u24 v94, v94, s63, v95
    v_mad_u32_u24 v96, v94, s65, v96
    buffer_load_dwordx4 v[94:97], v96, s[68:71], 0 offen
    v_bfe_u32 v98, v100, 14, 4
    v_lshrrev_b32 v99, 18, v100
    v_and_b32 v100, 16383, v100
    v_mad_u32_u24 v98, v98, s63, v99
    v_mad_u32_u24 v100, v98, s65, v100
    buffer_load_dwordx4 v[98:101], v100, s[68:71], 0 offen
    s_nop 2
    s_nop 1
    v_max_u32_dpp v106, v106, v106 row_shr:1 row_mask:0xf bank_mask:0xf bound_ctrl:0
    v_max_u32_dpp v107, v107, v107 row_shr:1 row_mask:0xf bank_mask:0xf bound_ctrl:0
    v_max_u32_dpp v108, v108, v108 row_shr:1 row_mask:0xf bank_mask:0xf bound_ctrl:0
    v_max_u32_dpp v109, v109, v109 row_shr:1 row_mask:0xf bank_mask:0xf bound_ctrl:0
    v_max_u32_dpp v106, v106, v106 row_shr:2 row_mask:0xf bank_mask:0xf bound_ctrl:0
    v_max_u32_dpp v107, v107, v107 row_shr:2 row_mask:0xf bank_mask:0xf bound_ctrl:0
    v_max_u32_dpp v108, v108, v108 row_shr:2 row_mask:0xf bank_mask:0xf bound_ctrl:0
    v_max_u32_dpp v109, v109, v109 row_shr:2 row_mask:0xf bank_mask:0xf bound_ctrl:0
    v_max_u32_dpp v106, v106, v106 row_shr:4 row_mask:0xf bank_mask:0xf bound_ctrl:0
    v_max_u32_dpp v107, v107, v107 row_shr:4 row_mask:0xf bank_mask:0xf bound_ctrl:0
    v_max_u32_dpp v108, v108, v108 row_shr:4 row_mask:0xf bank_mask:0xf bound_ctrl:0
    v_max_u32_dpp v109, v109, v109 row_shr:4 row_mask:0xf bank_mask:0xf bound_ctrl:0
    v_max_u32_dpp v106, v106, v106 row_shr:8 row_mask:0xf bank_mask:0xf bound_ctrl:0
    v_max_u32_dpp v107, v107, v107 row_shr:8 row_mask:0xf bank_mask:0xf bound_ctrl:0
    v_max_u32_dpp v108, v108, v108 row_shr:8 row_mask:0xf bank_mask:0xf bound_ctrl:0
    v_max_u32_dpp v109, v109, v109 row_shr:8 row_mask:0xf bank_mask:0xf bound_ctrl:0
    v_max_u32_dpp v106, v106, v106 row_bcast:15 row_mask:0xa bank_mask:0xf
    v_max_u32_dpp v107, v107, v107 row_bcast:15 row_mask:0xa bank_mask:0xf
    v_max_u32_dpp v108, v108, v108 row_bcast:15 row_mask:0xa bank_mask:0xf
    v_max_u32_dpp v109, v109, v109 row_bcast:15 row_mask:0xa bank_mask:0xf
    v_max_u32_dpp v106, v106, v106 row_bcast:31 row_mask:0xc bank_mask:0xf
    v_max_u32_dpp v107, v107, v107 row_bcast:31 row_mask:0xc bank_mask:0xf
    v_max_u32_dpp v108, v108, v108 row_bcast:31 row_mask:0xc bank_mask:0xf
    v_max_u32_dpp v109, v109, v109 row_bcast:31 row_mask:0xc bank_mask:0xf
    s_nop 0
    v_readlane_b32 s41, v106, 63
    v_add_u32 v106, v106, v112
    v_add_u32 v106, 4294959104, v106
    v_max_u32 v107, s41, v107
    s_nop 0
    v_readlane_b32 s41, v107, 63
    v_add_u32 v107, v107, v112
    v_add_u32 v107, 4294960128, v107
    v_max_u32 v108, s41, v108
    s_nop 0
    v_readlane_b32 s41, v108, 63
    v_add_u32 v108, v108, v112
    v_add_u32 v108, 4294961152, v108
    v_max_u32 v109, s41, v109
    s_nop 0
    v_readlane_b32 s41, v109, 63
    v_add_u32 v109, v109, v112
    v_add_u32 v109, 4294962176, v109
    s_waitcnt vmcnt(7)
    v_perm_b32 v48, v3, v0, s31
    v_perm_b32 v49, v3, v1, s32
    v_perm_b32 v50, v3, v2, s33
    v_lshlrev_b16 v4, 3, v2
    v_lshlrev_b16 v2, 3, v1
    v_lshlrev_b16 v0, 3, v0
    v_cmpx_ge_u16 vcc, 0x3fff, v48
    ds_read_b64 v[0:1], v0
    s_mov_b64 exec, -1
    v_cmpx_ge_u16 vcc, 0x3fff, v49
    ds_read_b64 v[2:3], v2
    s_mov_b64 exec, -1
    v_cmpx_ge_u16 vcc, 0x3fff, v50
    ds_read_b64 v[4:5], v4
    s_mov_b64 exec, -1
    s_waitcnt vmcnt(6)
    v_perm_b32 v51, v9, v6, s31
    v_perm_b32 v52, v9, v7, s32
    v_perm_b32 v53, v9, v8, s33
    v_lshlrev_b16 v10, 3, v8
    v_lshlrev_b16 v8, 3, v7
    v_lshlrev_b16 v6, 3, v6
    v_cmpx_ge_u16 vcc, 0x3fff, v51
    ds_read_b64 v[6:7], v6
    s_mov_b64 exec, -1
    v_cmpx_ge_u16 vcc, 0x3fff, v52
    ds_read_b64 v[8:9], v8
    s_mov_b64 exec, -1
    v_cmpx_ge_u16 vcc, 0x3fff, v53
    ds_read_b64 v[10:11], v10
    s_mov_b64 exec, -1
    s_waitcnt vmcnt(5)
    v_perm_b32 v54, v15, v12, s31
    v_perm_b32 v55, v15, v13, s32
    v_perm_b32 v56, v15, v14, s33
    v_lshlrev_b16 v16, 3, v14
    v_lshlrev_b16 v14, 3, v13
    v_lshlrev_b16 v12, 3, v12
    v_cmpx_ge_u16 vcc, 0x3fff, v54
    ds_read_b64 v[12:13], v12
    s_mov_b64 exec, -1
    v_cmpx_ge_u16 vcc, 0x3fff, v55
    ds_read_b64 v[14:15], v14
    s_mov_b64 exec, -1
    v_cmpx_ge_u16 vcc, 0x3fff, v56
    ds_read_b64 v[16:17], v16
    s_mov_b64 exec, -1
    s_waitcnt vmcnt(4)
    v_perm_b32 v57, v21, v18, s31
    v_perm_b32 v58, v21, v19, s32
    v_perm_b32 v59, v21, v20, s33
    v_lshlrev_b16 v22, 3, v20
    v_lshlrev_b16 v20, 3, v19
    v_lshlrev_b16 v18, 3, v18
    s_cmp_lt_u32 s16, 8
    s_cbranch_scc1 p2_gp
    v_cmpx_ge_u16 vcc, 0x3fff, v57
    ds_read_b64 v[18:19], v18
    s_mov_b64 exec, -1
    v_cmpx_ge_u16 vcc, 0x3fff, v58
    ds_read_b64 v[20:21], v20
    s_mov_b64 exec, -1
    v_cmpx_ge_u16 vcc, 0x3fff, v59
    ds_read_b64 v[22:23], v22
    s_mov_b64 exec, -1
p2_gp:
    s_waitcnt vmcnt(3)
    v_perm_b32 v60, v89, v86, s31
    v_perm_b32 v61, v89, v87, s32
    v_perm_b32 v62, v89, v88, s33
    v_lshlrev_b16 v28, 3, v88
    v_lshlrev_b16 v26, 3, v87
    v_lshlrev_b16 v24, 3, v86
    v_cmpx_ge_u16 vcc, 0x3fff, v60
    ds_read_b64 v[24:25], v24
    s_mov_b64 exec, -1
    v_cmpx_ge_u16 vcc, 0x3fff, v61
    ds_read_b64 v[26:27], v26
    s_mov_b64 exec, -1
    v_cmpx_ge_u16 vcc, 0x3fff, v62
    ds_read_b64 v[28:29], v28
    s_mov_b64 exec, -1
    v_bfe_u32 v86, v106, 14, 4
    v_lshrrev_b32 v87, 18, v106
    v_and_b32 v106, 16383, v106
    v_mad_u32_u24 v86, v86, s63, v87
    v_mad_u32_u24 v106, v86, s65, v106
    buffer_load_dwordx4 v[86:89], v106, s[68:71], 0 offen
    s_cmp_ge_u32 s10, 9
    s_cbranch_scc1 p2_nmq
    v_lshrrev_b32 v84, 1, v112
    s_add_u32 s44, s20, s42
    buffer_load_dwordx2 v[84:85], v84, s[4:7], s44 offen
p2_nmq:
    buffer_load_dwordx4 v[72:75], v112, s[4:7], s20 offen offset:0
    buffer_load_dwordx4 v[76:79], v112, s[4:7], s20 offen offset:1024
    buffer_load_dwordx4 v[80:83], v112, s[4:7], s20 offen offset:2048
    s_waitcnt vmcnt(6)
    v_perm_b32 v63, v93, v90, s31
    v_perm_b32 v64, v93, v91, s32
    v_perm_b32 v65, v93, v92, s33
    v_lshlrev_b16 v34, 3, v92
    v_lshlrev_b16 v32, 3, v91
    v_lshlrev_b16 v30, 3, v90
    v_cmpx_ge_u16 vcc, 0x3fff, v63
    ds_read_b64 v[30:31], v30
    s_mov_b64 exec, -1
    v_cmpx_ge_u16 vcc, 0x3fff, v64
    ds_read_b64 v[32:33], v32
    s_mov_b64 exec, -1
    v_cmpx_ge_u16 vcc, 0x3fff, v65
    ds_read_b64 v[34:35], v34
    s_mov_b64 exec, -1
    v_bfe_u32 v90, v107, 14, 4
    v_lshrrev_b32 v91, 18, v107
    v_and_b32 v107, 16383, v107
    v_mad_u32_u24 v90, v90, s63, v91
    v_mad_u32_u24 v107, v90, s65, v107
    buffer_load_dwordx4 v[90:93], v107, s[68:71], 0 offen
    s_waitcnt vmcnt(6)
    v_perm_b32 v66, v97, v94, s31
    v_perm_b32 v67, v97, v95, s32
    v_perm_b32 v68, v97, v96, s33
    v_lshlrev_b16 v40, 3, v96
    v_lshlrev_b16 v38, 3, v95
    v_lshlrev_b16 v36, 3, v94
    v_cmpx_ge_u16 vcc, 0x3fff, v66
    ds_read_b64 v[36:37], v36
    s_mov_b64 exec, -1
    v_cmpx_ge_u16 vcc, 0x3fff, v67
    ds_read_b64 v[38:39], v38
    s_mov_b64 exec, -1
    v_cmpx_ge_u16 vcc, 0x3fff, v68
    ds_read_b64 v[40:41], v40
    s_mov_b64 exec, -1
    v_bfe_u32 v94, v108, 14, 4
    v_lshrrev_b32 v95, 18, v108
    v_and_b32 v108, 16383, v108
    v_mad_u32_u24 v94, v94, s63, v95
    v_mad_u32_u24 v108, v94, s65, v108
    buffer_load_dwordx4 v[94:97], v108, s[68:71], 0 offen
    s_waitcnt vmcnt(6)
    v_perm_b32 v69, v101, v98, s31
    v_perm_b32 v70, v101, v99, s32
    v_perm_b32 v71, v101, v100, s33
    v_lshlrev_b16 v46, 3, v100
    v_lshlrev_b16 v44, 3, v99
    v_lshlrev_b16 v42, 3, v98
    v_cmpx_ge_u16 vcc, 0x3fff, v69
    ds_read_b64 v[42:43], v42
    s_mov_b64 exec, -1
    v_cmpx_ge_u16 vcc, 0x3fff, v70
    ds_read_b64 v[44:45], v44
    s_mov_b64 exec, -1
    v_cmpx_ge_u16 vcc, 0x3fff, v71
    ds_read_b64 v[46:47], v46
    s_mov_b64 exec, -1
    s_waitcnt lgkmcnt(0)
    s_barrier
    s_branch p2_tail
p2_top:
    s_cmp_lg_u32 s21, 0
    s_cbranch_scc1 p2_topf
    s_cmp_eq_u32 s60, 10
    s_cbranch_scc1 p2_drain0
    s_setprio 3
    v_cmpx_gt_i16 vcc, 0, v48
    ds_read_b64 v[0:1], v0
    s_mov_b64 exec, -1
    v_cmpx_gt_i16 vcc, 0, v49
    ds_read_b64 v[2:3], v2
    s_mov_b64 exec, -1
    v_cmpx_gt_i16 vcc, 0, v50
    ds_read_b64 v[4:5], v4
    s_mov_b64 exec, -1
    v_cmpx_gt_i16 vcc, 0, v51
    ds_read_b64 v[6:7], v6
    s_mov_b64 exec, -1
    v_cmpx_gt_i16 vcc, 0, v52
    ds_read_b64 v[8:9], v8
    s_mov_b64 exec, -1
    v_cmpx_gt_i16 vcc, 0, v53
    ds_read_b64 v[10:11], v10
    s_mov_b64 exec, -1
    v_cmpx_gt_i16 vcc, 0, v54
    ds_read_b64 v[12:13], v12
    s_mov_b64 exec, -1
    v_cmpx_gt_i16 vcc, 0, v55
    ds_read_b64 v[14:15], v14
    s_mov_b64 exec, -1
    v_cmpx_gt_i16 vcc, 0, v56
    ds_read_b64 v[16:17], v16
    s_mov_b64 exec, -1
    s_cmp_lt_u32 s15, 8
    s_cbranch_scc1 p2_g0r23
    v_cmpx_gt_i16 vcc, 0, v57
    ds_read_b64 v[18:19], v18
    s_mov_b64 exec, -1
    v_cmpx_gt_i16 vcc, 0, v58
    ds_read_b64 v[20:21], v20
    s_mov_b64 exec, -1
    v_cmpx_gt_i16 vcc, 0, v59
    ds_read_b64 v[22:23], v22
    s_mov_b64 exec, -1
p2_g0r23:
    s_cmp_ge_u32 s10, 9
    s_cbranch_scc1 p2_nm0m0a
    v_lshrrev_b32 v84, 1, v112
    s_add_u32 s44, s20, s42
    buffer_load_dwordx2 v[84:85], v84, s[4:7], s44 offen
p2_nm0m0a:
    buffer_load_dwordx4 v[72:75], v112, s[4:7], s20 offen offset:0
    buffer_load_dwordx4 v[76:79], v112, s[4:7], s20 offen offset:1024
    buffer_load_dwordx4 v[80:83], v112, s[4:7], s20 offen offset:2048
    v_cmpx_gt_i16 vcc, 0, v60
    ds_read_b64 v[24:25], v24
    s_mov_b64 exec, -1
    v_cmpx_gt_i16 vcc, 0, v61
    ds_read_b64 v[26:27], v26
    s_mov_b64 exec, -1
    v_cmpx_gt_i16 vcc, 0, v62
    ds_read_b64 v[28:29], v28
    s_mov_b64 exec, -1
    v_cmpx_gt_i16 vcc, 0, v63
    ds_read_b64 v[30:31], v30
    s_mov_b64 exec, -1
    v_cmpx_gt_i16 vcc, 0, v64
    ds_read_b64 v[32:33], v32
    s_mov_b64 exec, -1
    v_cmpx_gt_i16 vcc, 0, v65
    ds_read_b64 v[34:35], v34
    s_mov_b64 exec, -1
    v_cmpx_gt_i16 vcc, 0, v66
    ds_read_b64 v[36:37], v36
    s_mov_b64 exec, -1
    v_cmpx_gt_i16 vcc, 0, v67
    ds_read_b64 v[38:39], v38
    s_mov_b64 exec, -1
    v_cmpx_gt_i16 vcc, 0, v68
    ds_read_b64 v[40:41], v40
    s_mov_b64 exec, -1
    v_cmpx_gt_i16 vcc, 0, v69
    ds_read_b64 v[42:43], v42
    s_mov_b64 exec, -1
    v_cmpx_gt_i16 vcc, 0, v70
    ds_read_b64 v[44:45], v44
    s_mov_b64 exec, -1
    v_cmpx_gt_i16 vcc, 0, v71
    ds_read_b64 v[46:47], v46
    s_mov_b64 exec, -1
    s_setprio 2
    s_waitcnt lgkmcnt(15)
    v_ashrrev_i32 v122, 5, v48
    v_lshlrev_b16 v123, 2, v48
    v_lshlrev_b32 v124, 16, v0
    v_bitop3_b32 v122, v122, v113, v113 bitop3:0x0c
    v_and_b32 v125, 0xffff0000, v0
    v_lshlrev_b32 v126, 16, v1
    v_mul_f32 v122, v114, v122
    v_and_b32 v127, 0xffff0000, v1
    v_add_u32 v123, v123, v123
    v_pk_fma_f32 v[124:125], v[124:125], v[122:123], s[34:35] op_sel_hi:[1,0,1]
    v_pk_fma_f32 v[126:127], v[126:127], v[122:123], s[34:35] op_sel_hi:[1,0,1]
    v_lshl_add_u32 v124, v125, 16, v124
    v_lshl_add_u32 v125, v127, 16, v126
    s_waitcnt lgkmcnt(15)
    v_bitop3_b32 v115, v115, v116, v117 bitop3:0xfe
    v_lshl_add_u64 v[124:125], v[124:125], 0, s[36:37]
    v_cmpx_le_u32 vcc, 0x1000000, v48
    ds_add_rtn_u64 v[116:117], v123, v[124:125] offset:54272
    s_mov_b64 exec, -1
    v_ashrrev_i32 v122, 5, v49
    v_lshlrev_b16 v123, 2, v49
    v_lshlrev_b32 v124, 16, v2
    v_bitop3_b32 v122, v122, v113, v113 bitop3:0x0c
    v_and_b32 v125, 0xffff0000, v2
    v_lshlrev_b32 v126, 16, v3
    v_mul_f32 v122, v114, v122
    v_and_b32 v127, 0xffff0000, v3
    v_add_u32 v123, v123, v123
    v_pk_fma_f32 v[124:125], v[124:125], v[122:123], s[34:35] op_sel_hi:[1,0,1]
    v_pk_fma_f32 v[126:127], v[126:127], v[122:123], s[34:35] op_sel_hi:[1,0,1]
    v_lshl_add_u32 v124, v125, 16, v124
    v_lshl_add_u32 v125, v127, 16, v126
    s_waitcnt lgkmcnt(15)
    v_bitop3_b32 v115, v115, v118, v119 bitop3:0xfe
    v_lshl_add_u64 v[124:125], v[124:125], 0, s[36:37]
    v_cmpx_le_u32 vcc, 0x1000000, v49
    ds_add_rtn_u64 v[118:119], v123, v[124:125] offset:54272
    s_mov_b64 exec, -1
    v_ashrrev_i32 v122, 5, v50
    v_lshlrev_b16 v123, 2, v50
    v_lshlrev_b32 v124, 16, v4
    v_bitop3_b32 v122, v122, v113, v113 bitop3:0x0c
    v_and_b32 v125, 0xffff0000, v4
    v_lshlrev_b32 v126, 16, v5
    v_mul_f32 v122, v114, v122
    v_and_b32 v127, 0xffff0000, v5
    v_add_u32 v123, v123, v123
    v_pk_fma_f32 v[124:125], v[124:125], v[122:123], s[34:35] op_sel_hi:[1,0,1]
    v_pk_fma_f32 v[126:127], v[126:127], v[122:123], s[34:35] op_sel_hi:[1,0,1]
    v_lshl_add_u32 v124, v125, 16, v124
    v_lshl_add_u32 v125, v127, 16, v126
    s_waitcnt lgkmcnt(15)
    v_bitop3_b32 v115, v115, v120, v121 bitop3:0xfe
    v_lshl_add_u64 v[124:125], v[124:125], 0, s[36:37]
    v_cmpx_le_u32 vcc, 0x1000000, v50
    ds_add_rtn_u64 v[120:121], v123, v[124:125] offset:54272
    s_mov_b64 exec, -1
    v_bfe_u32 v0, v102, 14, 4
    v_lshrrev_b32 v1, 18, v102
    v_and_b32 v102, 16383, v102
    v_mad_u32_u24 v0, v0, s63, v1
    v_mad_u32_u24 v102, v0, s65, v102
    buffer_load_dwordx4 v[0:3], v102, s[68:71], 0 offen
    s_setprio 1
    s_waitcnt lgkmcnt(15)
    v_ashrrev_i32 v122, 5, v51
    v_lshlrev_b16 v123, 2, v51
    v_lshlrev_b32 v124, 16, v6
    v_bitop3_b32 v122, v122, v113, v113 bitop3:0x0c
    v_and_b32 v125, 0xffff0000, v6
    v_lshlrev_b32 v126, 16, v7
    v_mul_f32 v122, v114, v122
    v_and_b32 v127, 0xffff0000, v7
    v_add_u32 v123, v123, v123
    v_pk_fma_f32 v[124:125], v[124:125], v[122:123], s[34:35] op_sel_hi:[1,0,1]
    v_pk_fma_f32 v[126:127], v[126:127], v[122:123], s[34:35] op_sel_hi:[1,0,1]
    v_lshl_add_u32 v124, v125, 16, v124
    v_lshl_add_u32 v125, v127, 16, v126
    s_waitcnt lgkmcnt(2)
    v_bitop3_b32 v115, v115, v116, v117 bitop3:0xfe
    v_lshl_add_u64 v[124:125], v[124:125], 0, s[36:37]
    v_cmpx_le_u32 vcc, 0x1000000, v51
    ds_add_rtn_u64 v[116:117], v123, v[124:125] offset:54272
    s_mov_b64 exec, -1
    v_ashrrev_i32 v122, 5, v52
    v_lshlrev_b16 v123, 2, v52
    v_lshlrev_b32 v124, 16, v8
    v_bitop3_b32 v122, v122, v113, v113 bitop3:0x0c
    v_and_b32 v125, 0xffff0000, v8
    v_lshlrev_b32 v126, 16, v9
    v_mul_f32 v122, v114, v122
    v_and_b32 v127, 0xffff0000, v9
    v_add_u32 v123, v123, v123
    v_pk_fma_f32 v[124:125], v[124:125], v[122:123], s[34:35] op_sel_hi:[1,0,1]
    v_pk_fma_f32 v[126:127], v[126:127], v[122:123], s[34:35] op_sel_hi:[1,0,1]
    v_lshl_add_u32 v124, v125, 16, v124
    v_lshl_add_u32 v125, v127, 16, v126
    s_waitcnt lgkmcnt(2)
    v_bitop3_b32 v115, v115, v118, v119 bitop3:0xfe
    v_lshl_add_u64 v[124:125], v[124:125], 0, s[36:37]
    v_cmpx_le_u32 vcc, 0x1000000, v52
    ds_add_rtn_u64 v[118:119], v123, v[124:125] offset:54272
    s_mov_b64 exec, -1
    v_ashrrev_i32 v122, 5, v53
    v_lshlrev_b16 v123, 2, v53
    v_lshlrev_b32 v124, 16, v10
    v_bitop3_b32 v122, v122, v113, v113 bitop3:0x0c
    v_and_b32 v125, 0xffff0000, v10
    v_lshlrev_b32 v126, 16, v11
    v_mul_f32 v122, v114, v122
    v_and_b32 v127, 0xffff0000, v11
    v_add_u32 v123, v123, v123
    v_pk_fma_f32 v[124:125], v[124:125], v[122:123], s[34:35] op_sel_hi:[1,0,1]
    v_pk_fma_f32 v[126:127], v[126:127], v[122:123], s[34:35] op_sel_hi:[1,0,1]
    v_lshl_add_u32 v124, v125, 16, v124
    v_lshl_add_u32 v125, v127, 16, v126
    s_waitcnt lgkmcnt(2)
    v_bitop3_b32 v115, v115, v120, v121 bitop3:0xfe
    v_lshl_add_u64 v[124:125], v[124:125], 0, s[36:37]
    v_cmpx_le_u32 vcc, 0x1000000, v53
    ds_add_rtn_u64 v[120:121], v123, v[124:125] offset:54272
    s_mov_b64 exec, -1
    v_bfe_u32 v6, v103, 14, 4
    v_lshrrev_b32 v7, 18, v103
    v_and_b32 v103, 16383, v103
    v_mad_u32_u24 v6, v6, s63, v7
    v_mad_u32_u24 v103, v6, s65, v103
    buffer_load_dwordx4 v[6:9], v103, s[68:71], 0 offen
    s_waitcnt lgkmcnt(6)
    s_barrier
    s_setprio 3
    s_waitcnt vmcnt(5)
    s_mov_b32 m0, s23
    v_mov_b32 v53, 0
    s_movk_i32 s44, 512
    v_sub_u32_sdwa v4, v111, v110 dst_sel:DWORD dst_unused:UNUSED_PAD src0_sel:WORD_0 src1_sel:WORD_0
    v_sub_u32_sdwa v5, v111, v110 dst_sel:DWORD dst_unused:UNUSED_PAD src0_sel:WORD_1 src1_sel:WORD_1
    v_med3_i32 v4, v4, 0, s44
    v_med3_i32 v5, v5, 0, s44
    v_add_u32 v48, v4, v5
    ds_write_addtid_b32 v53 offset:0
    ds_write_addtid_b32 v53 offset:256
    ds_write_addtid_b32 v53 offset:512
    ds_write_addtid_b32 v53 offset:768
    ds_write_addtid_b32 v53 offset:1024
    ds_write_addtid_b32 v53 offset:1280
    ds_write_addtid_b32 v53 offset:1536
    ds_write_addtid_b32 v53 offset:1792
    v_bfe_i32 v53, v112, 6, 1
    v_lshrrev_b32 v49, 6, v112
    v_bitop3_b32 v53, v53, 15, s10 bitop3:0x6a
    v_lshl_or_b32 v49, v49, 4, v53
    v_and_b32 v53, 0x30, v112
    v_lshl_or_b32 v53, v49, 6, v53
    v_lshlrev_b32 v53, 15, v53
    s_nop 1
    v_add_u32_dpp v48, v48, v48 row_shr:1 row_mask:0xf bank_mask:0xf bound_ctrl:0
    s_nop 1
    v_add_u32_dpp v48, v48, v48 row_shr:2 row_mask:0xf bank_mask:0xf bound_ctrl:0
    s_nop 1
    v_add_u32_dpp v48, v48, v48 row_shr:4 row_mask:0xf bank_mask:0xf bound_ctrl:0
    s_nop 1
    v_add_u32_dpp v48, v48, v48 row_shr:8 row_mask:0xf bank_mask:0xf bound_ctrl:0
    s_nop 1
    v_add_u32_dpp v48, v48, v48 row_bcast:15 row_mask:0xa bank_mask:0xf
    s_nop 1
    v_add_u32_dpp v48, v48, v48 row_bcast:31 row_mask:0xc bank_mask:0xf
    s_nop 1
    s_nop 0
    v_readlane_b32 s38, v48, 63
    v_sub_u32 v50, v48, v5
    v_sub_u32 v49, v50, v4
    v_writelane_b32 v5, 1, 63
    v_sub_u32 v10, 512, v49
    v_mad_u32_u16 v51, v110, 16, v53
    v_lshl_add_u32 v51, v10, 4, v51
    v_med3_i32 v10, v10, 0, v4
    v_lshl_add_u32 v49, v49, 2, s23
    v_sub_u32 v11, 512, v50
    v_mad_u32_u16 v52, v110, 16, v53 op_sel:[1,0,0,0]
    v_add_u32 v52, 262144, v52
    s_mov_b32 s44, 0x1fffc000
    v_writelane_b32 v52, s44, 63
    v_lshl_add_u32 v52, v11, 4, v52
    v_med3_i32 v11, v11, 0, v5
    v_lshl_add_u32 v50, v50, 2, s23
    v_lshl_add_u32 v48, v11, 16, v10
    v_add_u32 v110, v110, v48
    s_min_u32 s17, s38, 512
    s_add_u32 s17, s17, 63
    s_lshr_b32 s17, s17, 6
    v_cmpx_lt_i32 vcc, 0, v10
    ds_write_b32 v49, v51
    s_mov_b64 exec, -1
    v_cmpx_lt_i32 vcc, 0, v11
    ds_write_b32 v50, v52
    s_mov_b64 exec, -1
    s_cmp_lt_u32 s38, 512
    s_cbranch_scc1 p2_nomore0x
    v_cmp_lt_u32_sdwa s[44:45], v110, v111 src0_sel:WORD_0 src1_sel:WORD_0
    v_cmp_lt_u32_sdwa s[46:47], v110, v111 src0_sel:WORD_1 src1_sel:WORD_1
    s_nop 0
    s_or_b64 s[44:45], s[44:45], s[46:47]
    s_cbranch_scc0 p2_nomore0x
    v_mov_b32 v49, s19
    v_mov_b32 v50, 1
    ds_write_b32 v49, v50 offset:53760
p2_nomore0x:
    s_setprio 2
    s_waitcnt lgkmcnt(15)
    v_ashrrev_i32 v122, 5, v54
    v_lshlrev_b16 v123, 2, v54
    v_lshlrev_b32 v124, 16, v12
    v_bitop3_b32 v122, v122, v113, v113 bitop3:0x0c
    v_and_b32 v125, 0xffff0000, v12
    v_lshlrev_b32 v126, 16, v13
    v_mul_f32 v122, v114, v122
    v_and_b32 v127, 0xffff0000, v13
    v_add_u32 v123, v123, v123
    v_pk_fma_f32 v[124:125], v[124:125], v[122:123], s[34:35] op_sel_hi:[1,0,1]
    v_pk_fma_f32 v[126:127], v[126:127], v[122:123], s[34:35] op_sel_hi:[1,0,1]
    v_lshl_add_u32 v124, v125, 16, v124
    v_lshl_add_u32 v125, v127, 16, v126
    s_waitcnt lgkmcnt(12)
    v_bitop3_b32 v115, v115, v116, v117 bitop3:0xfe
    v_lshl_add_u64 v[124:125], v[124:125], 0, s[36:37]
    v_cmpx_le_u32 vcc, 0x1000000, v54
    ds_add_rtn_u64 v[116:117], v123, v[124:125] offset:54272
    s_mov_b64 exec, -1
    v_ashrrev_i32 v122, 5, v55
    v_lshlrev_b16 v123, 2, v55
    v_lshlrev_b32 v124, 16, v14
    v_bitop3_b32 v122, v122, v113, v113 bitop3:0x0c
    v_and_b32 v125, 0xffff0000, v14
    v_lshlrev_b32 v126, 16, v15
    v_mul_f32 v122, v114, v122
    v_and_b32 v127, 0xffff0000, v15
    v_add_u32 v123, v123, v123
    v_pk_fma_f32 v[124:125], v[124:125], v[122:123], s[34:35] op_sel_hi:[1,0,1]
    v_pk_fma_f32 v[126:127], v[126:127], v[122:123], s[34:35] op_sel_hi:[1,0,1]
    v_lshl_add_u32 v124, v125, 16, v124
    v_lshl_add_u32 v125, v127, 16, v126
    s_waitcnt lgkmcnt(12)
    v_bitop3_b32 v115, v115, v118, v119 bitop3:0xfe
    v_lshl_add_u64 v[124:125], v[124:125], 0, s[36:37]
    v_cmpx_le_u32 vcc, 0x1000000, v55
    ds_add_rtn_u64 v[118:119], v123, v[124:125] offset:54272
    s_mov_b64 exec, -1
    v_ashrrev_i32 v122, 5, v56
    v_lshlrev_b16 v123, 2, v56
    v_lshlrev_b32 v124, 16, v16
    v_bitop3_b32 v122, v122, v113, v113 bitop3:0x0c
    v_and_b32 v125, 0xffff0000, v16
    v_lshlrev_b32 v126, 16, v17
    v_mul_f32 v122, v114, v122
    v_and_b32 v127, 0xffff0000, v17
    v_add_u32 v123, v123, v123
    v_pk_fma_f32 v[124:125], v[124:125], v[122:123], s[34:35] op_sel_hi:[1,0,1]
    v_pk_fma_f32 v[126:127], v[126:127], v[122:123], s[34:35] op_sel_hi:[1,0,1]
    v_lshl_add_u32 v124, v125, 16, v124
    v_lshl_add_u32 v125, v127, 16, v126
    s_waitcnt lgkmcnt(12)
    v_bitop3_b32 v115, v115, v120, v121 bitop3:0xfe
    v_lshl_add_u64 v[124:125], v[124:125], 0, s[36:37]
    v_cmpx_le_u32 vcc, 0x1000000, v56
    ds_add_rtn_u64 v[120:121], v123, v[124:125] offset:54272
    s_mov_b64 exec, -1
    v_bfe_u32 v12, v104, 14, 4
    v_lshrrev_b32 v13, 18, v104
    v_and_b32 v104, 16383, v104
    v_mad_u32_u24 v12, v12, s63, v13
    v_mad_u32_u24 v104, v12, s65, v104
    buffer_load_dwordx4 v[12:15], v104, s[68:71], 0 offen
    s_cmp_lt_u32 s15, 8
    s_cbranch_scc1 p2_na0a3
    s_waitcnt lgkmcnt(15)
    v_ashrrev_i32 v122, 5, v57
    v_lshlrev_b16 v123, 2, v57
    v_lshlrev_b32 v124, 16, v18
    v_bitop3_b32 v122, v122, v113, v113 bitop3:0x0c
    v_and_b32 v125, 0xffff0000, v18
    v_lshlrev_b32 v126, 16, v19
    v_mul_f32 v122, v114, v122
    v_and_b32 v127, 0xffff0000, v19
    v_add_u32 v123, v123, v123
    v_pk_fma_f32 v[124:125], v[124:125], v[122:123], s[34:35] op_sel_hi:[1,0,1]
    v_pk_fma_f32 v[126:127], v[126:127], v[122:123], s[34:35] op_sel_hi:[1,0,1]
    v_lshl_add_u32 v124, v125, 16, v124
    v_lshl_add_u32 v125, v127, 16, v126
    s_waitcnt lgkmcnt(2)
    v_bitop3_b32 v115, v115, v116, v117 bitop3:0xfe
    v_lshl_add_u64 v[124:125], v[124:125], 0, s[36:37]
    v_cmpx_le_u32 vcc, 0x1000000, v57
    ds_add_rtn_u64 v[116:117], v123, v[124:125] offset:54272
    s_mov_b64 exec, -1
    v_ashrrev_i32 v122, 5, v58
    v_lshlrev_b16 v123, 2, v58
    v_lshlrev_b32 v124, 16, v20
    v_bitop3_b32 v122, v122, v113, v113 bitop3:0x0c
    v_and_b32 v125, 0xffff0000, v20
    v_lshlrev_b32 v126, 16, v21
    v_mul_f32 v122, v114, v122
    v_and_b32 v127, 0xffff0000, v21
    v_add_u32 v123, v123, v123
    v_pk_fma_f32 v[124:125], v[124:125], v[122:123], s[34:35] op_sel_hi:[1,0,1]
    v_pk_fma_f32 v[126:127], v[126:127], v[122:123], s[34:35] op_sel_hi:[1,0,1]
    v_lshl_add_u32 v124, v125, 16, v124
    v_lshl_add_u32 v125, v127, 16, v126
    s_waitcnt lgkmcnt(2)
    v_bitop3_b32 v115, v115, v118, v119 bitop3:0xfe
    v_lshl_add_u64 v[124:125], v[124:125], 0, s[36:37]
    v_cmpx_le_u32 vcc, 0x1000000, v58
    ds_add_rtn_u64 v[118:119], v123, v[124:125] offset:54272
    s_mov_b64 exec, -1
    v_ashrrev_i32 v122, 5, v59
    v_lshlrev_b16 v123, 2, v59
    v_lshlrev_b32 v124, 16, v22
    v_bitop3_b32 v122, v122, v113, v113 bitop3:0x0c
    v_and_b32 v125, 0xffff0000, v22
    v_lshlrev_b32 v126, 16, v23
    v_mul_f32 v122, v114, v122
    v_and_b32 v127, 0xffff0000, v23
    v_add_u32 v123, v123, v123
    v_pk_fma_f32 v[124:125], v[124:125], v[122:123], s[34:35] op_sel_hi:[1,0,1]
    v_pk_fma_f32 v[126:127], v[126:127], v[122:123], s[34:35] op_sel_hi:[1,0,1]
    v_lshl_add_u32 v124, v125, 16, v124
    v_lshl_add_u32 v125, v127, 16, v126
    s_waitcnt lgkmcnt(2)
    v_bitop3_b32 v115, v115, v120, v121 bitop3:0xfe
    v_lshl_add_u64 v[124:125], v[124:125], 0, s[36:37]
    v_cmpx_le_u32 vcc, 0x1000000, v59
    ds_add_rtn_u64 v[120:121], v123, v[124:125] offset:54272
    s_mov_b64 exec, -1
p2_na0a3:
    v_bfe_u32 v18, v105, 14, 4
    v_lshrrev_b32 v19, 18, v105
    v_and_b32 v105, 16383, v105
    v_mad_u32_u24 v18, v18, s63, v19
    v_mad_u32_u24 v105, v18, s65, v105
    buffer_load_dwordx4 v[18:21], v105, s[68:71], 0 offen
    s_mov_b32 m0, s23
    s_nop 0
    ds_read_addtid_b32 v102 offset:1024
    ds_read_addtid_b32 v103 offset:1280
    ds_read_addtid_b32 v104 offset:1536
    ds_read_addtid_b32 v105 offset:1792
    ds_read_addtid_b32 v106 offset:0
    ds_read_addtid_b32 v107 offset:256
    ds_read_addtid_b32 v108 offset:512
    ds_read_addtid_b32 v109 offset:768
    s_waitcnt vmcnt(4)
    s_mov_b32 m0, s24
    s_cmp_ge_u32 s10, 9
    s_cbranch_scc1 p2_st0s0
    ds_write_addtid_b32 v84 offset:49152
    ds_write_addtid_b32 v85 offset:49408
p2_st0s0:
    s_mov_b32 m0, s23
    s_add_u32 s20, s20, 53760
    ds_write_addtid_b32 v72 offset:0
    ds_write_addtid_b32 v73 offset:256
    ds_write_addtid_b32 v74 offset:512
    ds_write_addtid_b32 v75 offset:768
    ds_write_addtid_b32 v76 offset:1024
    ds_write_addtid_b32 v77 offset:1280
    ds_write_addtid_b32 v78 offset:1536
    ds_write_addtid_b32 v79 offset:1792
    ds_write_addtid_b32 v80 offset:2048
    ds_write_addtid_b32 v81 offset:2304
    ds_write_addtid_b32 v82 offset:2560
    ds_write_addtid_b32 v83 offset:2816
    s_setprio 1
    s_waitcnt lgkmcnt(15)
    v_ashrrev_i32 v122, 5, v60
    v_lshlrev_b16 v123, 2, v60
    v_lshlrev_b32 v124, 16, v24
    v_bitop3_b32 v122, v122, v113, v113 bitop3:0x0c
    v_and_b32 v125, 0xffff0000, v24
    v_lshlrev_b32 v126, 16, v25
    v_mul_f32 v122, v114, v122
    v_and_b32 v127, 0xffff0000, v25
    v_add_u32 v123, v123, v123
    v_pk_fma_f32 v[124:125], v[124:125], v[122:123], s[34:35] op_sel_hi:[1,0,1]
    v_pk_fma_f32 v[126:127], v[126:127], v[122:123], s[34:35] op_sel_hi:[1,0,1]
    v_lshl_add_u32 v124, v125, 16, v124
    v_lshl_add_u32 v125, v127, 16, v126
    s_waitcnt lgkmcnt(15)
    v_bitop3_b32 v115, v115, v116, v117 bitop3:0xfe
    v_lshl_add_u64 v[124:125], v[124:125], 0, s[36:37]
    v_cmpx_le_u32 vcc, 0x1000000, v60
    ds_add_rtn_u64 v[116:117], v123, v[124:125] offset:54272
    s_mov_b64 exec, -1
    v_ashrrev_i32 v122, 5, v61
    v_lshlrev_b16 v123, 2, v61
    v_lshlrev_b32 v124, 16, v26
    v_bitop3_b32 v122, v122, v113, v113 bitop3:0x0c
    v_and_b32 v125, 0xffff0000, v26
    v_lshlrev_b32 v126, 16, v27
    v_mul_f32 v122, v114, v122
    v_and_b32 v127, 0xffff0000, v27
    v_add_u32 v123, v123, v123
    v_pk_fma_f32 v[124:125], v[124:125], v[122:123], s[34:35] op_sel_hi:[1,0,1]
    v_pk_fma_f32 v[126:127], v[126:127], v[122:123], s[34:35] op_sel_hi:[1,0,1]
    v_lshl_add_u32 v124, v125, 16, v124
    v_lshl_add_u32 v125, v127, 16, v126
    s_waitcnt lgkmcnt(15)
    v_bitop3_b32 v115, v115, v118, v119 bitop3:0xfe
    v_lshl_add_u64 v[124:125], v[124:125], 0, s[36:37]
    v_cmpx_le_u32 vcc, 0x1000000, v61
    ds_add_rtn_u64 v[118:119], v123, v[124:125] offset:54272
    s_mov_b64 exec, -1
    v_ashrrev_i32 v122, 5, v62
    v_lshlrev_b16 v123, 2, v62
    v_lshlrev_b32 v124, 16, v28
    v_bitop3_b32 v122, v122, v113, v113 bitop3:0x0c
    v_and_b32 v125, 0xffff0000, v28
    v_lshlrev_b32 v126, 16, v29
    v_mul_f32 v122, v114, v122
    v_and_b32 v127, 0xffff0000, v29
    v_add_u32 v123, v123, v123
    v_pk_fma_f32 v[124:125], v[124:125], v[122:123], s[34:35] op_sel_hi:[1,0,1]
    v_pk_fma_f32 v[126:127], v[126:127], v[122:123], s[34:35] op_sel_hi:[1,0,1]
    v_lshl_add_u32 v124, v125, 16, v124
    v_lshl_add_u32 v125, v127, 16, v126
    s_waitcnt lgkmcnt(15)
    v_bitop3_b32 v115, v115, v120, v121 bitop3:0xfe
    v_lshl_add_u64 v[124:125], v[124:125], 0, s[36:37]
    v_cmpx_le_u32 vcc, 0x1000000, v62
    ds_add_rtn_u64 v[120:121], v123, v[124:125] offset:54272
    s_mov_b64 exec, -1
    s_waitcnt vmcnt(16)
    v_perm_b32 v60, v89, v86, s31
    v_perm_b32 v61, v89, v87, s32
    v_perm_b32 v62, v89, v88, s33
    v_lshlrev_b16 v28, 3, v88
    v_lshlrev_b16 v26, 3, v87
    v_lshlrev_b16 v24, 3, v86
    s_waitcnt lgkmcnt(15)
    s_nop 2
    s_nop 1
    v_max_u32_dpp v106, v106, v106 row_shr:1 row_mask:0xf bank_mask:0xf bound_ctrl:0
    v_max_u32_dpp v107, v107, v107 row_shr:1 row_mask:0xf bank_mask:0xf bound_ctrl:0
    s_nop 0
    v_max_u32_dpp v106, v106, v106 row_shr:2 row_mask:0xf bank_mask:0xf bound_ctrl:0
    v_max_u32_dpp v107, v107, v107 row_shr:2 row_mask:0xf bank_mask:0xf bound_ctrl:0
    s_nop 0
    v_max_u32_dpp v106, v106, v106 row_shr:4 row_mask:0xf bank_mask:0xf bound_ctrl:0
    v_max_u32_dpp v107, v107, v107 row_shr:4 row_mask:0xf bank_mask:0xf bound_ctrl:0
    s_nop 0
    v_max_u32_dpp v106, v106, v106 row_shr:8 row_mask:0xf bank_mask:0xf bound_ctrl:0
    v_max_u32_dpp v107, v107, v107 row_shr:8 row_mask:0xf bank_mask:0xf bound_ctrl:0
    s_nop 0
    v_max_u32_dpp v106, v106, v106 row_bcast:15 row_mask:0xa bank_mask:0xf
    v_max_u32_dpp v107, v107, v107 row_bcast:15 row_mask:0xa bank_mask:0xf
    s_nop 0
    v_max_u32_dpp v106, v106, v106 row_bcast:31 row_mask:0xc bank_mask:0xf
    v_max_u32_dpp v107, v107, v107 row_bcast:31 row_mask:0xc bank_mask:0xf
    s_nop 0
    s_nop 0
    v_readlane_b32 s41, v106, 63
    v_add_u32 v106, v106, v112
    v_add_u32 v106, 4294959104, v106
    v_max_u32 v107, s41, v107
    s_nop 0
    v_readlane_b32 s41, v107, 63
    v_add_u32 v107, v107, v112
    v_add_u32 v107, 4294960128, v107
    v_bfe_u32 v86, v106, 14, 4
    v_lshrrev_b32 v87, 18, v106
    v_and_b32 v106, 16383, v106
    v_mad_u32_u24 v86, v86, s63, v87
    v_mad_u32_u24 v106, v86, s65, v106
    buffer_load_dwordx4 v[86:89], v106, s[68:71], 0 offen
    s_setprio 0
    s_waitcnt lgkmcnt(15)
    v_ashrrev_i32 v122, 5, v63
    v_lshlrev_b16 v123, 2, v63
    v_lshlrev_b32 v124, 16, v30
    v_bitop3_b32 v122, v122, v113, v113 bitop3:0x0c
    v_and_b32 v125, 0xffff0000, v30
    v_lshlrev_b32 v126, 16, v31
    v_mul_f32 v122, v114, v122
    v_and_b32 v127, 0xffff0000, v31
    v_add_u32 v123, v123, v123
    v_pk_fma_f32 v[124:125], v[124:125], v[122:123], s[34:35] op_sel_hi:[1,0,1]
    v_pk_fma_f32 v[126:127], v[126:127], v[122:123], s[34:35] op_sel_hi:[1,0,1]
    v_lshl_add_u32 v124, v125, 16, v124
    v_lshl_add_u32 v125, v127, 16, v126
    s_waitcnt lgkmcnt(2)
    v_bitop3_b32 v115, v115, v116, v117 bitop3:0xfe
    v_lshl_add_u64 v[124:125], v[124:125], 0, s[36:37]
    v_cmpx_le_u32 vcc, 0x1000000, v63
    ds_add_rtn_u64 v[116:117], v123, v[124:125] offset:54272
    s_mov_b64 exec, -1
    v_ashrrev_i32 v122, 5, v64
    v_lshlrev_b16 v123, 2, v64
    v_lshlrev_b32 v124, 16, v32
    v_bitop3_b32 v122, v122, v113, v113 bitop3:0x0c
    v_and_b32 v125, 0xffff0000, v32
    v_lshlrev_b32 v126, 16, v33
    v_mul_f32 v122, v114, v122
    v_and_b32 v127, 0xffff0000, v33
    v_add_u32 v123, v123, v123
    v_pk_fma_f32 v[124:125], v[124:125], v[122:123], s[34:35] op_sel_hi:[1,0,1]
    v_pk_fma_f32 v[126:127], v[126:127], v[122:123], s[34:35] op_sel_hi:[1,0,1]
    v_lshl_add_u32 v124, v125, 16, v124
    v_lshl_add_u32 v125, v127, 16, v126
    s_waitcnt lgkmcnt(2)
    v_bitop3_b32 v115, v115, v118, v119 bitop3:0xfe
    v_lshl_add_u64 v[124:125], v[124:125], 0, s[36:37]
    v_cmpx_le_u32 vcc, 0x1000000, v64
    ds_add_rtn_u64 v[118:119], v123, v[124:125] offset:54272
    s_mov_b64 exec, -1
    v_ashrrev_i32 v122, 5, v65
    v_lshlrev_b16 v123, 2, v65
    v_lshlrev_b32 v124, 16, v34
    v_bitop3_b32 v122, v122, v113, v113 bitop3:0x0c
    v_and_b32 v125, 0xffff0000, v34
    v_lshlrev_b32 v126, 16, v35
    v_mul_f32 v122, v114, v122
    v_and_b32 v127, 0xffff0000, v35
    v_add_u32 v123, v123, v123
    v_pk_fma_f32 v[124:125], v[124:125], v[122:123], s[34:35] op_sel_hi:[1,0,1]
    v_pk_fma_f32 v[126:127], v[126:127], v[122:123], s[34:35] op_sel_hi:[1,0,1]
    v_lshl_add_u32 v124, v125, 16, v124
    v_lshl_add_u32 v125, v127, 16, v126
    s_waitcnt lgkmcnt(2)
    v_bitop3_b32 v115, v115, v120, v121 bitop3:0xfe
    v_lshl_add_u64 v[124:125], v[124:125], 0, s[36:37]
    v_cmpx_le_u32 vcc, 0x1000000, v65
    ds_add_rtn_u64 v[120:121], v123, v[124:125] offset:54272
    s_mov_b64 exec, -1
    s_waitcnt vmcnt(13)
    v_perm_b32 v63, v93, v90, s31
    v_perm_b32 v64, v93, v91, s32
    v_perm_b32 v65, v93, v92, s33
    v_lshlrev_b16 v34, 3, v92
    v_lshlrev_b16 v32, 3, v91
    v_lshlrev_b16 v30, 3, v90
    s_waitcnt lgkmcnt(6)
    s_barrier
    s_setprio 3
    s_cmp_ge_u32 s10, 9
    s_cbranch_scc1 p2_nm0m1a
    v_lshrrev_b32 v84, 1, v112
    s_add_u32 s44, s20, s42
    buffer_load_dwordx2 v[84:85], v84, s[4:7], s44 offen
p2_nm0m1a:
    buffer_load_dwordx4 v[72:75], v112, s[4:7], s20 offen offset:0
    buffer_load_dwordx4 v[76:79], v112, s[4:7], s20 offen offset:1024
    buffer_load_dwordx4 v[80:83], v112, s[4:7], s20 offen offset:2048
    v_cmpx_ge_u16 vcc, 0x3fff, v60
    ds_read_b64 v[24:25], v24
    s_mov_b64 exec, -1
    v_cmpx_ge_u16 vcc, 0x3fff, v61
    ds_read_b64 v[26:27], v26
    s_mov_b64 exec, -1
    v_cmpx_ge_u16 vcc, 0x3fff, v62
    ds_read_b64 v[28:29], v28
    s_mov_b64 exec, -1
    v_cmpx_ge_u16 vcc, 0x3fff, v63
    ds_read_b64 v[30:31], v30
    s_mov_b64 exec, -1
    v_cmpx_ge_u16 vcc, 0x3fff, v64
    ds_read_b64 v[32:33], v32
    s_mov_b64 exec, -1
    v_cmpx_ge_u16 vcc, 0x3fff, v65
    ds_read_b64 v[34:35], v34
    s_mov_b64 exec, -1
    s_setprio 2
    s_waitcnt lgkmcnt(15)
    v_ashrrev_i32 v122, 5, v66
    v_lshlrev_b16 v123, 2, v66
    v_lshlrev_b32 v124, 16, v36
    v_bitop3_b32 v122, v122, v113, v113 bitop3:0x0c
    v_and_b32 v125, 0xffff0000, v36
    v_lshlrev_b32 v126, 16, v37
    v_mul_f32 v122, v114, v122
    v_and_b32 v127, 0xffff0000, v37
    v_add_u32 v123, v123, v123
    v_pk_fma_f32 v[124:125], v[124:125], v[122:123], s[34:35] op_sel_hi:[1,0,1]
    v_pk_fma_f32 v[126:127], v[126:127], v[122:123], s[34:35] op_sel_hi:[1,0,1]
    v_lshl_add_u32 v124, v125, 16, v124
    v_lshl_add_u32 v125, v127, 16, v126
    s_waitcnt lgkmcnt(8)
    v_bitop3_b32 v115, v115, v116, v117 bitop3:0xfe
    v_lshl_add_u64 v[124:125], v[124:125], 0, s[36:37]
    v_cmpx_le_u32 vcc, 0x1000000, v66
    ds_add_rtn_u64 v[116:117], v123, v[124:125] offset:54272
    s_mov_b64 exec, -1
    v_ashrrev_i32 v122, 5, v67
    v_lshlrev_b16 v123, 2, v67
    v_lshlrev_b32 v124, 16, v38
    v_bitop3_b32 v122, v122, v113, v113 bitop3:0x0c
    v_and_b32 v125, 0xffff0000, v38
    v_lshlrev_b32 v126, 16, v39
    v_mul_f32 v122, v114, v122
    v_and_b32 v127, 0xffff0000, v39
    v_add_u32 v123, v123, v123
    v_pk_fma_f32 v[124:125], v[124:125], v[122:123], s[34:35] op_sel_hi:[1,0,1]
    v_pk_fma_f32 v[126:127], v[126:127], v[122:123], s[34:35] op_sel_hi:[1,0,1]
    v_lshl_add_u32 v124, v125, 16, v124
    v_lshl_add_u32 v125, v127, 16, v126
    s_waitcnt lgkmcnt(8)
    v_bitop3_b32 v115, v115, v118, v119 bitop3:0xfe
    v_lshl_add_u64 v[124:125], v[124:125], 0, s[36:37]
    v_cmpx_le_u32 vcc, 0x1000000, v67
    ds_add_rtn_u64 v[118:119], v123, v[124:125] offset:54272
    s_mov_b64 exec, -1
    v_ashrrev_i32 v122, 5, v68
    v_lshlrev_b16 v123, 2, v68
    v_lshlrev_b32 v124, 16, v40
    v_bitop3_b32 v122, v122, v113, v113 bitop3:0x0c
    v_and_b32 v125, 0xffff0000, v40
    v_lshlrev_b32 v126, 16, v41
    v_mul_f32 v122, v114, v122
    v_and_b32 v127, 0xffff0000, v41
    v_add_u32 v123, v123, v123
    v_pk_fma_f32 v[124:125], v[124:125], v[122:123], s[34:35] op_sel_hi:[1,0,1]
    v_pk_fma_f32 v[126:127], v[126:127], v[122:123], s[34:35] op_sel_hi:[1,0,1]
    v_lshl_add_u32 v124, v125, 16, v124
    v_lshl_add_u32 v125, v127, 16, v126
    s_waitcnt lgkmcnt(8)
    v_bitop3_b32 v115, v115, v120, v121 bitop3:0xfe
    v_lshl_add_u64 v[124:125], v[124:125], 0, s[36:37]
    v_cmpx_le_u32 vcc, 0x1000000, v68
    ds_add_rtn_u64 v[120:121], v123, v[124:125] offset:54272
    s_mov_b64 exec, -1
    s_waitcnt vmcnt(15)
    v_perm_b32 v66, v97, v94, s31
    v_perm_b32 v67, v97, v95, s32
    v_perm_b32 v68, v97, v96, s33
    v_lshlrev_b16 v40, 3, v96
    v_lshlrev_b16 v38, 3, v95
    v_lshlrev_b16 v36, 3, v94
    v_cmpx_ge_u16 vcc, 0x3fff, v66
    ds_read_b64 v[36:37], v36
    s_mov_b64 exec, -1
    v_cmpx_ge_u16 vcc, 0x3fff, v67
    ds_read_b64 v[38:39], v38
    s_mov_b64 exec, -1
    v_cmpx_ge_u16 vcc, 0x3fff, v68
    ds_read_b64 v[40:41], v40
    s_mov_b64 exec, -1
    v_bfe_u32 v90, v107, 14, 4
    v_lshrrev_b32 v91, 18, v107
    v_and_b32 v107, 16383, v107
    v_mad_u32_u24 v90, v90, s63, v91
    v_mad_u32_u24 v107, v90, s65, v107
    buffer_load_dwordx4 v[90:93], v107, s[68:71], 0 offen
    s_setprio 1
    s_waitcnt lgkmcnt(15)
    v_ashrrev_i32 v122, 5, v69
    v_lshlrev_b16 v123, 2, v69
    v_lshlrev_b32 v124, 16, v42
    v_bitop3_b32 v122, v122, v113, v113 bitop3:0x0c
    v_and_b32 v125, 0xffff0000, v42
    v_lshlrev_b32 v126, 16, v43
    v_mul_f32 v122, v114, v122
    v_and_b32 v127, 0xffff0000, v43
    v_add_u32 v123, v123, v123
    v_pk_fma_f32 v[124:125], v[124:125], v[122:123], s[34:35] op_sel_hi:[1,0,1]
    v_pk_fma_f32 v[126:127], v[126:127], v[122:123], s[34:35] op_sel_hi:[1,0,1]
    v_lshl_add_u32 v124, v125, 16, v124
    v_lshl_add_u32 v125, v127, 16, v126
    s_waitcnt lgkmcnt(5)
    v_bitop3_b32 v115, v115, v116, v117 bitop3:0xfe
    v_lshl_add_u64 v[124:125], v[124:125], 0, s[36:37]
    v_cmpx_le_u32 vcc, 0x1000000, v69
    ds_add_rtn_u64 v[116:117], v123, v[124:125] offset:54272
    s_mov_b64 exec, -1
    v_ashrrev_i32 v122, 5, v70
    v_lshlrev_b16 v123, 2, v70
    v_lshlrev_b32 v124, 16, v44
    v_bitop3_b32 v122, v122, v113, v113 bitop3:0x0c
    v_and_b32 v125, 0xffff0000, v44
    v_lshlrev_b32 v126, 16, v45
    v_mul_f32 v122, v114, v122
    v_and_b32 v127, 0xffff0000, v45
    v_add_u32 v123, v123, v123
    v_pk_fma_f32 v[124:125], v[124:125], v[122:123], s[34:35] op_sel_hi:[1,0,1]
    v_pk_fma_f32 v[126:127], v[126:127], v[122:123], s[34:35] op_sel_hi:[1,0,1]
    v_lshl_add_u32 v124, v125, 16, v124
    v_lshl_add_u32 v125, v127, 16, v126
    s_waitcnt lgkmcnt(5)
    v_bitop3_b32 v115, v115, v118, v119 bitop3:0xfe
    v_lshl_add_u64 v[124:125], v[124:125], 0, s[36:37]
    v_cmpx_le_u32 vcc, 0x1000000, v70
    ds_add_rtn_u64 v[118:119], v123, v[124:125] offset:54272
    s_mov_b64 exec, -1
    v_ashrrev_i32 v122, 5, v71
    v_lshlrev_b16 v123, 2, v71
    v_lshlrev_b32 v124, 16, v46
    v_bitop3_b32 v122, v122, v113, v113 bitop3:0x0c
    v_and_b32 v125, 0xffff0000, v46
    v_lshlrev_b32 v126, 16, v47
    v_mul_f32 v122, v114, v122
    v_and_b32 v127, 0xffff0000, v47
    v_add_u32 v123, v123, v123
    v_pk_fma_f32 v[124:125], v[124:125], v[122:123], s[34:35] op_sel_hi:[1,0,1]
    v_pk_fma_f32 v[126:127], v[126:127], v[122:123], s[34:35] op_sel_hi:[1,0,1]
    v_lshl_add_u32 v124, v125, 16, v124
    v_lshl_add_u32 v125, v127, 16, v126
    s_waitcnt lgkmcnt(5)
    v_bitop3_b32 v115, v115, v120, v121 bitop3:0xfe
    v_lshl_add_u64 v[124:125], v[124:125], 0, s[36:37]
    v_cmpx_le_u32 vcc, 0x1000000, v71
    ds_add_rtn_u64 v[120:121], v123, v[124:125] offset:54272
    s_mov_b64 exec, -1
    s_waitcnt vmcnt(12)
    v_perm_b32 v69, v101, v98, s31
    v_perm_b32 v70, v101, v99, s32
    v_perm_b32 v71, v101, v100, s33
    v_lshlrev_b16 v46, 3, v100
    v_lshlrev_b16 v44, 3, v99
    v_lshlrev_b16 v42, 3, v98
    v_cmpx_ge_u16 vcc, 0x3fff, v69
    ds_read_b64 v[42:43], v42
    s_mov_b64 exec, -1
    v_cmpx_ge_u16 vcc, 0x3fff, v70
    ds_read_b64 v[44:45], v44
    s_mov_b64 exec, -1
    v_cmpx_ge_u16 vcc, 0x3fff, v71
    ds_read_b64 v[46:47], v46
    s_mov_b64 exec, -1
    s_waitcnt lgkmcnt(15)
    s_nop 2
    s_nop 1
    v_max_u32_dpp v108, v108, v108 row_shr:1 row_mask:0xf bank_mask:0xf bound_ctrl:0
    v_max_u32_dpp v109, v109, v109 row_shr:1 row_mask:0xf bank_mask:0xf bound_ctrl:0
    s_nop 0
    v_max_u32_dpp v108, v108, v108 row_shr:2 row_mask:0xf bank_mask:0xf bound_ctrl:0
    v_max_u32_dpp v109, v109, v109 row_shr:2 row_mask:0xf bank_mask:0xf bound_ctrl:0
    s_nop 0
    v_max_u32_dpp v108, v108, v108 row_shr:4 row_mask:0xf bank_mask:0xf bound_ctrl:0
    v_max_u32_dpp v109, v109, v109 row_shr:4 row_mask:0xf bank_mask:0xf bound_ctrl:0
    s_nop 0
    v_max_u32_dpp v108, v108, v108 row_shr:8 row_mask:0xf bank_mask:0xf bound_ctrl:0
    v_max_u32_dpp v109, v109, v109 row_shr:8 row_mask:0xf bank_mask:0xf bound_ctrl:0
    s_nop 0
    v_max_u32_dpp v108, v108, v108 row_bcast:15 row_mask:0xa bank_mask:0xf
    v_max_u32_dpp v109, v109, v109 row_bcast:15 row_mask:0xa bank_mask:0xf
    s_nop 0
    v_max_u32_dpp v108, v108, v108 row_bcast:31 row_mask:0xc bank_mask:0xf
    v_max_u32_dpp v109, v109, v109 row_bcast:31 row_mask:0xc bank_mask:0xf
    s_nop 0
    s_nop 0
    v_max_u32 v108, s41, v108
    s_nop 0
    v_readlane_b32 s41, v108, 63
    v_add_u32 v108, v108, v112
    v_add_u32 v108, 4294961152, v108
    v_max_u32 v109, s41, v109
    s_nop 0
    v_readlane_b32 s41, v109, 63
    v_add_u32 v109, v109, v112
    v_add_u32 v109, 4294962176, v109
    v_bfe_u32 v94, v108, 14, 4
    v_lshrrev_b32 v95, 18, v108
    v_and_b32 v108, 16383, v108
    v_mad_u32_u24 v94, v94, s63, v95
    v_mad_u32_u24 v108, v94, s65, v108
    buffer_load_dwordx4 v[94:97], v108, s[68:71], 0 offen
    s_setprio 0
    s_waitcnt vmcnt(9)
    v_perm_b32 v48, v3, v0, s31
    v_perm_b32 v49, v3, v1, s32
    v_perm_b32 v50, v3, v2, s33
    v_lshlrev_b16 v4, 3, v2
    v_lshlrev_b16 v2, 3, v1
    v_lshlrev_b16 v0, 3, v0
    v_cmpx_ge_u16 vcc, 0x3fff, v48
    ds_read_b64 v[0:1], v0
    s_mov_b64 exec, -1
    v_cmpx_ge_u16 vcc, 0x3fff, v49
    ds_read_b64 v[2:3], v2
    s_mov_b64 exec, -1
    v_cmpx_ge_u16 vcc, 0x3fff, v50
    ds_read_b64 v[4:5], v4
    s_mov_b64 exec, -1
    s_waitcnt vmcnt(8)
    v_perm_b32 v51, v9, v6, s31
    v_perm_b32 v52, v9, v7, s32
    v_perm_b32 v53, v9, v8, s33
    v_lshlrev_b16 v10, 3, v8
    v_lshlrev_b16 v8, 3, v7
    v_lshlrev_b16 v6, 3, v6
    v_cmpx_ge_u16 vcc, 0x3fff, v51
    ds_read_b64 v[6:7], v6
    s_mov_b64 exec, -1
    v_cmpx_ge_u16 vcc, 0x3fff, v52
    ds_read_b64 v[8:9], v8
    s_mov_b64 exec, -1
    v_cmpx_ge_u16 vcc, 0x3fff, v53
    ds_read_b64 v[10:11], v10
    s_mov_b64 exec, -1
    s_waitcnt vmcnt(7)
    v_perm_b32 v54, v15, v12, s31
    v_perm_b32 v55, v15, v13, s32
    v_perm_b32 v56, v15, v14, s33
    v_lshlrev_b16 v16, 3, v14
    v_lshlrev_b16 v14, 3, v13
    v_lshlrev_b16 v12, 3, v12
    v_cmpx_ge_u16 vcc, 0x3fff, v54
    ds_read_b64 v[12:13], v12
    s_mov_b64 exec, -1
    v_cmpx_ge_u16 vcc, 0x3fff, v55
    ds_read_b64 v[14:15], v14
    s_mov_b64 exec, -1
    v_cmpx_ge_u16 vcc, 0x3fff, v56
    ds_read_b64 v[16:17], v16
    s_mov_b64 exec, -1
    s_waitcnt vmcnt(6)
    v_perm_b32 v57, v21, v18, s31
    v_perm_b32 v58, v21, v19, s32
    v_perm_b32 v59, v21, v20, s33
    v_lshlrev_b16 v22, 3, v20
    v_lshlrev_b16 v20, 3, v19
    v_lshlrev_b16 v18, 3, v18
    s_cmp_lt_u32 s16, 8
    s_cbranch_scc1 p2_g0r03
    v_cmpx_ge_u16 vcc, 0x3fff, v57
    ds_read_b64 v[18:19], v18
    s_mov_b64 exec, -1
    v_cmpx_ge_u16 vcc, 0x3fff, v58
    ds_read_b64 v[20:21], v20
    s_mov_b64 exec, -1
    v_cmpx_ge_u16 vcc, 0x3fff, v59
    ds_read_b64 v[22:23], v22
    s_mov_b64 exec, -1
p2_g0r03:
    s_waitcnt lgkmcnt(0)
    s_barrier
    s_waitcnt lgkmcnt(15)
    s_branch p2_tail
p2_drain0:
    v_cmpx_gt_i16 vcc, 0, v48
    ds_read_b64 v[0:1], v0
    s_mov_b64 exec, -1
    v_cmpx_gt_i16 vcc, 0, v49
    ds_read_b64 v[2:3], v2
    s_mov_b64 exec, -1
    v_cmpx_gt_i16 vcc, 0, v50
    ds_read_b64 v[4:5], v4
    s_mov_b64 exec, -1
    v_cmpx_gt_i16 vcc, 0, v51
    ds_read_b64 v[6:7], v6
    s_mov_b64 exec, -1
    v_cmpx_gt_i16 vcc, 0, v52
    ds_read_b64 v[8:9], v8
    s_mov_b64 exec, -1
    v_cmpx_gt_i16 vcc, 0, v53
    ds_read_b64 v[10:11], v10
    s_mov_b64 exec, -1
    v_cmpx_gt_i16 vcc, 0, v54
    ds_read_b64 v[12:13], v12
    s_mov_b64 exec, -1
    v_cmpx_gt_i16 vcc, 0, v55
    ds_read_b64 v[14:15], v14
    s_mov_b64 exec, -1
    v_cmpx_gt_i16 vcc, 0, v56
    ds_read_b64 v[16:17], v16
    s_mov_b64 exec, -1
    s_cmp_lt_u32 s15, 8
    s_cbranch_scc1 p2_gd0
    v_cmpx_gt_i16 vcc, 0, v57
    ds_read_b64 v[18:19], v18
    s_mov_b64 exec, -1
    v_cmpx_gt_i16 vcc, 0, v58
    ds_read_b64 v[20:21], v20
    s_mov_b64 exec, -1
    v_cmpx_gt_i16 vcc, 0, v59
    ds_read_b64 v[22:23], v22
    s_mov_b64 exec, -1
p2_gd0:
    v_cmpx_gt_i16 vcc, 0, v60
    ds_read_b64 v[24:25], v24
    s_mov_b64 exec, -1
    v_cmpx_gt_i16 vcc, 0, v61
    ds_read_b64 v[26:27], v26
    s_mov_b64 exec, -1
    v_cmpx_gt_i16 vcc, 0, v62
    ds_read_b64 v[28:29], v28
    s_mov_b64 exec, -1
    v_cmpx_gt_i16 vcc, 0, v63
    ds_read_b64 v[30:31], v30
    s_mov_b64 exec, -1
    v_cmpx_gt_i16 vcc, 0, v64
    ds_read_b64 v[32:33], v32
    s_mov_b64 exec, -1
    v_cmpx_gt_i16 vcc, 0, v65
    ds_read_b64 v[34:35], v34
    s_mov_b64 exec, -1
    v_cmpx_gt_i16 vcc, 0, v66
    ds_read_b64 v[36:37], v36
    s_mov_b64 exec, -1
    v_cmpx_gt_i16 vcc, 0, v67
    ds_read_b64 v[38:39], v38
    s_mov_b64 exec, -1
    v_cmpx_gt_i16 vcc, 0, v68
    ds_read_b64 v[40:41], v40
    s_mov_b64 exec, -1
    v_cmpx_gt_i16 vcc, 0, v69
    ds_read_b64 v[42:43], v42
    s_mov_b64 exec, -1
    v_cmpx_gt_i16 vcc, 0, v70
    ds_read_b64 v[44:45], v44
    s_mov_b64 exec, -1
    v_cmpx_gt_i16 vcc, 0, v71
    ds_read_b64 v[46:47], v46
    s_mov_b64 exec, -1
    s_waitcnt lgkmcnt(15)
    v_ashrrev_i32 v122, 5, v48
    v_lshlrev_b16 v123, 2, v48
    v_lshlrev_b32 v124, 16, v0
    v_bitop3_b32 v122, v122, v113, v113 bitop3:0x0c
    v_and_b32 v125, 0xffff0000, v0
    v_lshlrev_b32 v126, 16, v1
    v_mul_f32 v122, v114, v122
    v_and_b32 v127, 0xffff0000, v1
    v_add_u32 v123, v123, v123
    v_pk_fma_f32 v[124:125], v[124:125], v[122:123], s[34:35] op_sel_hi:[1,0,1]
    v_pk_fma_f32 v[126:127], v[126:127], v[122:123], s[34:35] op_sel_hi:[1,0,1]
    v_lshl_add_u32 v124, v125, 16, v124
    v_lshl_add_u32 v125, v127, 16, v126
    s_waitcnt lgkmcnt(15)
    v_bitop3_b32 v115, v115, v116, v117 bitop3:0xfe
    v_lshl_add_u64 v[124:125], v[124:125], 0, s[36:37]
    v_cmpx_le_u32 vcc, 0x1000000, v48
    ds_add_rtn_u64 v[116:117], v123, v[124:125] offset:54272
    s_mov_b64 exec, -1
    v_ashrrev_i32 v122, 5, v49
    v_lshlrev_b16 v123, 2, v49
    v_lshlrev_b32 v124, 16, v2
    v_bitop3_b32 v122, v122, v113, v113 bitop3:0x0c
    v_and_b32 v125, 0xffff0000, v2
    v_lshlrev_b32 v126, 16, v3
    v_mul_f32 v122, v114, v122
    v_and_b32 v127, 0xffff0000, v3
    v_add_u32 v123, v123, v123
    v_pk_fma_f32 v[124:125], v[124:125], v[122:123], s[34:35] op_sel_hi:[1,0,1]
    v_pk_fma_f32 v[126:127], v[126:127], v[122:123], s[34:35] op_sel_hi:[1,0,1]
    v_lshl_add_u32 v124, v125, 16, v124
    v_lshl_add_u32 v125, v127, 16, v126
    s_waitcnt lgkmcnt(15)
    v_bitop3_b32 v115, v115, v118, v119 bitop3:0xfe
    v_lshl_add_u64 v[124:125], v[124:125], 0, s[36:37]
    v_cmpx_le_u32 vcc, 0x1000000, v49
    ds_add_rtn_u64 v[118:119], v123, v[124:125] offset:54272
    s_mov_b64 exec, -1
    v_ashrrev_i32 v122, 5, v50
    v_lshlrev_b16 v123, 2, v50
    v_lshlrev_b32 v124, 16, v4
    v_bitop3_b32 v122, v122, v113, v113 bitop3:0x0c
    v_and_b32 v125, 0xffff0000, v4
    v_lshlrev_b32 v126, 16, v5
    v_mul_f32 v122, v114, v122
    v_and_b32 v127, 0xffff0000, v5
    v_add_u32 v123, v123, v123
    v_pk_fma_f32 v[124:125], v[124:125], v[122:123], s[34:35] op_sel_hi:[1,0,1]
    v_pk_fma_f32 v[126:127], v[126:127], v[122:123], s[34:35] op_sel_hi:[1,0,1]
    v_lshl_add_u32 v124, v125, 16, v124
    v_lshl_add_u32 v125, v127, 16, v126
    s_waitcnt lgkmcnt(15)
    v_bitop3_b32 v115, v115, v120, v121 bitop3:0xfe
    v_lshl_add_u64 v[124:125], v[124:125], 0, s[36:37]
    v_cmpx_le_u32 vcc, 0x1000000, v50
    ds_add_rtn_u64 v[120:121], v123, v[124:125] offset:54272
    s_mov_b64 exec, -1
    s_waitcnt lgkmcnt(15)
    v_ashrrev_i32 v122, 5, v51
    v_lshlrev_b16 v123, 2, v51
    v_lshlrev_b32 v124, 16, v6
    v_bitop3_b32 v122, v122, v113, v113 bitop3:0x0c
    v_and_b32 v125, 0xffff0000, v6
    v_lshlrev_b32 v126, 16, v7
    v_mul_f32 v122, v114, v122
    v_and_b32 v127, 0xffff0000, v7
    v_add_u32 v123, v123, v123
    v_pk_fma_f32 v[124:125], v[124:125], v[122:123], s[34:35] op_sel_hi:[1,0,1]
    v_pk_fma_f32 v[126:127], v[126:127], v[122:123], s[34:35] op_sel_hi:[1,0,1]
    v_lshl_add_u32 v124, v125, 16, v124
    v_lshl_add_u32 v125, v127, 16, v126
    s_waitcnt lgkmcnt(2)
    v_bitop3_b32 v115, v115, v116, v117 bitop3:0xfe
    v_lshl_add_u64 v[124:125], v[124:125], 0, s[36:37]
    v_cmpx_le_u32 vcc, 0x1000000, v51
    ds_add_rtn_u64 v[116:117], v123, v[124:125] offset:54272
    s_mov_b64 exec, -1
    v_ashrrev_i32 v122, 5, v52
    v_lshlrev_b16 v123, 2, v52
    v_lshlrev_b32 v124, 16, v8
    v_bitop3_b32 v122, v122, v113, v113 bitop3:0x0c
    v_and_b32 v125, 0xffff0000, v8
    v_lshlrev_b32 v126, 16, v9
    v_mul_f32 v122, v114, v122
    v_and_b32 v127, 0xffff0000, v9
    v_add_u32 v123, v123, v123
    v_pk_fma_f32 v[124:125], v[124:125], v[122:123], s[34:35] op_sel_hi:[1,0,1]
    v_pk_fma_f32 v[126:127], v[126:127], v[122:123], s[34:35] op_sel_hi:[1,0,1]
    v_lshl_add_u32 v124, v125, 16, v124
    v_lshl_add_u32 v125, v127, 16, v126
    s_waitcnt lgkmcnt(2)
    v_bitop3_b32 v115, v115, v118, v119 bitop3:0xfe
    v_lshl_add_u64 v[124:125], v[124:125], 0, s[36:37]
    v_cmpx_le_u32 vcc, 0x1000000, v52
    ds_add_rtn_u64 v[118:119], v123, v[124:125] offset:54272
    s_mov_b64 exec, -1
    v_ashrrev_i32 v122, 5, v53
    v_lshlrev_b16 v123, 2, v53
    v_lshlrev_b32 v124, 16, v10
    v_bitop3_b32 v122, v122, v113, v113 bitop3:0x0c
    v_and_b32 v125, 0xffff0000, v10
    v_lshlrev_b32 v126, 16, v11
    v_mul_f32 v122, v114, v122
    v_and_b32 v127, 0xffff0000, v11
    v_add_u32 v123, v123, v123
    v_pk_fma_f32 v[124:125], v[124:125], v[122:123], s[34:35] op_sel_hi:[1,0,1]
    v_pk_fma_f32 v[126:127], v[126:127], v[122:123], s[34:35] op_sel_hi:[1,0,1]
    v_lshl_add_u32 v124, v125, 16, v124
    v_lshl_add_u32 v125, v127, 16, v126
    s_waitcnt lgkmcnt(2)
    v_bitop3_b32 v115, v115, v120, v121 bitop3:0xfe
    v_lshl_add_u64 v[124:125], v[124:125], 0, s[36:37]
    v_cmpx_le_u32 vcc, 0x1000000, v53
    ds_add_rtn_u64 v[120:121], v123, v[124:125] offset:54272
    s_mov_b64 exec, -1
    s_waitcnt lgkmcnt(15)
    v_ashrrev_i32 v122, 5, v54
    v_lshlrev_b16 v123, 2, v54
    v_lshlrev_b32 v124, 16, v12
    v_bitop3_b32 v122, v122, v113, v113 bitop3:0x0c
    v_and_b32 v125, 0xffff0000, v12
    v_lshlrev_b32 v126, 16, v13
    v_mul_f32 v122, v114, v122
    v_and_b32 v127, 0xffff0000, v13
    v_add_u32 v123, v123, v123
    v_pk_fma_f32 v[124:125], v[124:125], v[122:123], s[34:35] op_sel_hi:[1,0,1]
    v_pk_fma_f32 v[126:127], v[126:127], v[122:123], s[34:35] op_sel_hi:[1,0,1]
    v_lshl_add_u32 v124, v125, 16, v124
    v_lshl_add_u32 v125, v127, 16, v126
    s_waitcnt lgkmcnt(2)
    v_bitop3_b32 v115, v115, v116, v117 bitop3:0xfe
    v_lshl_add_u64 v[124:125], v[124:125], 0, s[36:37]
    v_cmpx_le_u32 vcc, 0x1000000, v54
    ds_add_rtn_u64 v[116:117], v123, v[124:125] offset:54272
    s_mov_b64 exec, -1
    v_ashrrev_i32 v122, 5, v55
    v_lshlrev_b16 v123, 2, v55
    v_lshlrev_b32 v124, 16, v14
    v_bitop3_b32 v122, v122, v113, v113 bitop3:0x0c
    v_and_b32 v125, 0xffff0000, v14
    v_lshlrev_b32 v126, 16, v15
    v_mul_f32 v122, v114, v122
    v_and_b32 v127, 0xffff0000, v15
    v_add_u32 v123, v123, v123
    v_pk_fma_f32 v[124:125], v[124:125], v[122:123], s[34:35] op_sel_hi:[1,0,1]
    v_pk_fma_f32 v[126:127], v[126:127], v[122:123], s[34:35] op_sel_hi:[1,0,1]
    v_lshl_add_u32 v124, v125, 16, v124
    v_lshl_add_u32 v125, v127, 16, v126
    s_waitcnt lgkmcnt(2)
    v_bitop3_b32 v115, v115, v118, v119 bitop3:0xfe
    v_lshl_add_u64 v[124:125], v[124:125], 0, s[36:37]
    v_cmpx_le_u32 vcc, 0x1000000, v55
    ds_add_rtn_u64 v[118:119], v123, v[124:125] offset:54272
    s_mov_b64 exec, -1
    v_ashrrev_i32 v122, 5, v56
    v_lshlrev_b16 v123, 2, v56
    v_lshlrev_b32 v124, 16, v16
    v_bitop3_b32 v122, v122, v113, v113 bitop3:0x0c
    v_and_b32 v125, 0xffff0000, v16
    v_lshlrev_b32 v126, 16, v17
    v_mul_f32 v122, v114, v122
    v_and_b32 v127, 0xffff0000, v17
    v_add_u32 v123, v123, v123
    v_pk_fma_f32 v[124:125], v[124:125], v[122:123], s[34:35] op_sel_hi:[1,0,1]
    v_pk_fma_f32 v[126:127], v[126:127], v[122:123], s[34:35] op_sel_hi:[1,0,1]
    v_lshl_add_u32 v124, v125, 16, v124
    v_lshl_add_u32 v125, v127, 16, v126
    s_waitcnt lgkmcnt(2)
    v_bitop3_b32 v115, v115, v120, v121 bitop3:0xfe
    v_lshl_add_u64 v[124:125], v[124:125], 0, s[36:37]
    v_cmpx_le_u32 vcc, 0x1000000, v56
    ds_add_rtn_u64 v[120:121], v123, v[124:125] offset:54272
    s_mov_b64 exec, -1
    s_cmp_lt_u32 s15, 8
    s_cbranch_scc1 p2_nad0
    s_waitcnt lgkmcnt(15)
    v_ashrrev_i32 v122, 5, v57
    v_lshlrev_b16 v123, 2, v57
    v_lshlrev_b32 v124, 16, v18
    v_bitop3_b32 v122, v122, v113, v113 bitop3:0x0c
    v_and_b32 v125, 0xffff0000, v18
    v_lshlrev_b32 v126, 16, v19
    v_mul_f32 v122, v114, v122
    v_and_b32 v127, 0xffff0000, v19
    v_add_u32 v123, v123, v123
    v_pk_fma_f32 v[124:125], v[124:125], v[122:123], s[34:35] op_sel_hi:[1,0,1]
    v_pk_fma_f32 v[126:127], v[126:127], v[122:123], s[34:35] op_sel_hi:[1,0,1]
    v_lshl_add_u32 v124, v125, 16, v124
    v_lshl_add_u32 v125, v127, 16, v126
    s_waitcnt lgkmcnt(2)
    v_bitop3_b32 v115, v115, v116, v117 bitop3:0xfe
    v_lshl_add_u64 v[124:125], v[124:125], 0, s[36:37]
    v_cmpx_le_u32 vcc, 0x1000000, v57
    ds_add_rtn_u64 v[116:117], v123, v[124:125] offset:54272
    s_mov_b64 exec, -1
    v_ashrrev_i32 v122, 5, v58
    v_lshlrev_b16 v123, 2, v58
    v_lshlrev_b32 v124, 16, v20
    v_bitop3_b32 v122, v122, v113, v113 bitop3:0x0c
    v_and_b32 v125, 0xffff0000, v20
    v_lshlrev_b32 v126, 16, v21
    v_mul_f32 v122, v114, v122
    v_and_b32 v127, 0xffff0000, v21
    v_add_u32 v123, v123, v123
    v_pk_fma_f32 v[124:125], v[124:125], v[122:123], s[34:35] op_sel_hi:[1,0,1]
    v_pk_fma_f32 v[126:127], v[126:127], v[122:123], s[34:35] op_sel_hi:[1,0,1]
    v_lshl_add_u32 v124, v125, 16, v124
    v_lshl_add_u32 v125, v127, 16, v126
    s_waitcnt lgkmcnt(2)
    v_bitop3_b32 v115, v115, v118, v119 bitop3:0xfe
    v_lshl_add_u64 v[124:125], v[124:125], 0, s[36:37]
    v_cmpx_le_u32 vcc, 0x1000000, v58
    ds_add_rtn_u64 v[118:119], v123, v[124:125] offset:54272
    s_mov_b64 exec, -1
    v_ashrrev_i32 v122, 5, v59
    v_lshlrev_b16 v123, 2, v59
    v_lshlrev_b32 v124, 16, v22
    v_bitop3_b32 v122, v122, v113, v113 bitop3:0x0c
    v_and_b32 v125, 0xffff0000, v22
    v_lshlrev_b32 v126, 16, v23
    v_mul_f32 v122, v114, v122
    v_and_b32 v127, 0xffff0000, v23
    v_add_u32 v123, v123, v123
    v_pk_fma_f32 v[124:125], v[124:125], v[122:123], s[34:35] op_sel_hi:[1,0,1]
    v_pk_fma_f32 v[126:127], v[126:127], v[122:123], s[34:35] op_sel_hi:[1,0,1]
    v_lshl_add_u32 v124, v125, 16, v124
    v_lshl_add_u32 v125, v127, 16, v126
    s_waitcnt lgkmcnt(2)
    v_bitop3_b32 v115, v115, v120, v121 bitop3:0xfe
    v_lshl_add_u64 v[124:125], v[124:125], 0, s[36:37]
    v_cmpx_le_u32 vcc, 0x1000000, v59
    ds_add_rtn_u64 v[120:121], v123, v[124:125] offset:54272
    s_mov_b64 exec, -1
p2_nad0:
    s_waitcnt lgkmcnt(15)
    v_ashrrev_i32 v122, 5, v60
    v_lshlrev_b16 v123, 2, v60
    v_lshlrev_b32 v124, 16, v24
    v_bitop3_b32 v122, v122, v113, v113 bitop3:0x0c
    v_and_b32 v125, 0xffff0000, v24
    v_lshlrev_b32 v126, 16, v25
    v_mul_f32 v122, v114, v122
    v_and_b32 v127, 0xffff0000, v25
    v_add_u32 v123, v123, v123
    v_pk_fma_f32 v[124:125], v[124:125], v[122:123], s[34:35] op_sel_hi:[1,0,1]
    v_pk_fma_f32 v[126:127], v[126:127], v[122:123], s[34:35] op_sel_hi:[1,0,1]
    v_lshl_add_u32 v124, v125, 16, v124
    v_lshl_add_u32 v125, v127, 16, v126
    s_waitcnt lgkmcnt(2)
    v_bitop3_b32 v115, v115, v116, v117 bitop3:0xfe
    v_lshl_add_u64 v[124:125], v[124:125], 0, s[36:37]
    v_cmpx_le_u32 vcc, 0x1000000, v60
    ds_add_rtn_u64 v[116:117], v123, v[124:125] offset:54272
    s_mov_b64 exec, -1
    v_ashrrev_i32 v122, 5, v61
    v_lshlrev_b16 v123, 2, v61
    v_lshlrev_b32 v124, 16, v26
    v_bitop3_b32 v122, v122, v113, v113 bitop3:0x0c
    v_and_b32 v125, 0xffff0000, v26
    v_lshlrev_b32 v126, 16, v27
    v_mul_f32 v122, v114, v122
    v_and_b32 v127, 0xffff0000, v27
    v_add_u32 v123, v123, v123
    v_pk_fma_f32 v[124:125], v[124:125], v[122:123], s[34:35] op_sel_hi:[1,0,1]
    v_pk_fma_f32 v[126:127], v[126:127], v[122:123], s[34:35] op_sel_hi:[1,0,1]
    v_lshl_add_u32 v124, v125, 16, v124
    v_lshl_add_u32 v125, v127, 16, v126
    s_waitcnt lgkmcnt(2)
    v_bitop3_b32 v115, v115, v118, v119 bitop3:0xfe
    v_lshl_add_u64 v[124:125], v[124:125], 0, s[36:37]
    v_cmpx_le_u32 vcc, 0x1000000, v61
    ds_add_rtn_u64 v[118:119], v123, v[124:125] offset:54272
    s_mov_b64 exec, -1
    v_ashrrev_i32 v122, 5, v62
    v_lshlrev_b16 v123, 2, v62
    v_lshlrev_b32 v124, 16, v28
    v_bitop3_b32 v122, v122, v113, v113 bitop3:0x0c
    v_and_b32 v125, 0xffff0000, v28
    v_lshlrev_b32 v126, 16, v29
    v_mul_f32 v122, v114, v122
    v_and_b32 v127, 0xffff0000, v29
    v_add_u32 v123, v123, v123
    v_pk_fma_f32 v[124:125], v[124:125], v[122:123], s[34:35] op_sel_hi:[1,0,1]
    v_pk_fma_f32 v[126:127], v[126:127], v[122:123], s[34:35] op_sel_hi:[1,0,1]
    v_lshl_add_u32 v124, v125, 16, v124
    v_lshl_add_u32 v125, v127, 16, v126
    s_waitcnt lgkmcnt(2)
    v_bitop3_b32 v115, v115, v120, v121 bitop3:0xfe
    v_lshl_add_u64 v[124:125], v[124:125], 0, s[36:37]
    v_cmpx_le_u32 vcc, 0x1000000, v62
    ds_add_rtn_u64 v[120:121], v123, v[124:125] offset:54272
    s_mov_b64 exec, -1
    s_waitcnt lgkmcnt(15)
    v_ashrrev_i32 v122, 5, v63
    v_lshlrev_b16 v123, 2, v63
    v_lshlrev_b32 v124, 16, v30
    v_bitop3_b32 v122, v122, v113, v113 bitop3:0x0c
    v_and_b32 v125, 0xffff0000, v30
    v_lshlrev_b32 v126, 16, v31
    v_mul_f32 v122, v114, v122
    v_and_b32 v127, 0xffff0000, v31
    v_add_u32 v123, v123, v123
    v_pk_fma_f32 v[124:125], v[124:125], v[122:123], s[34:35] op_sel_hi:[1,0,1]
    v_pk_fma_f32 v[126:127], v[126:127], v[122:123], s[34:35] op_sel_hi:[1,0,1]
    v_lshl_add_u32 v124, v125, 16, v124
    v_lshl_add_u32 v125, v127, 16, v126
    s_waitcnt lgkmcnt(2)
    v_bitop3_b32 v115, v115, v116, v117 bitop3:0xfe
    v_lshl_add_u64 v[124:125], v[124:125], 0, s[36:37]
    v_cmpx_le_u32 vcc, 0x1000000, v63
    ds_add_rtn_u64 v[116:117], v123, v[124:125] offset:54272
    s_mov_b64 exec, -1
    v_ashrrev_i32 v122, 5, v64
    v_lshlrev_b16 v123, 2, v64
    v_lshlrev_b32 v124, 16, v32
    v_bitop3_b32 v122, v122, v113, v113 bitop3:0x0c
    v_and_b32 v125, 0xffff0000, v32
    v_lshlrev_b32 v126, 16, v33
    v_mul_f32 v122, v114, v122
    v_and_b32 v127, 0xffff0000, v33
    v_add_u32 v123, v123, v123
    v_pk_fma_f32 v[124:125], v[124:125], v[122:123], s[34:35] op_sel_hi:[1,0,1]
    v_pk_fma_f32 v[126:127], v[126:127], v[122:123], s[34:35] op_sel_hi:[1,0,1]
    v_lshl_add_u32 v124, v125, 16, v124
    v_lshl_add_u32 v125, v127, 16, v126
    s_waitcnt lgkmcnt(2)
    v_bitop3_b32 v115, v115, v118, v119 bitop3:0xfe
    v_lshl_add_u64 v[124:125], v[124:125], 0, s[36:37]
    v_cmpx_le_u32 vcc, 0x1000000, v64
    ds_add_rtn_u64 v[118:119], v123, v[124:125] offset:54272
    s_mov_b64 exec, -1
    v_ashrrev_i32 v122, 5, v65
    v_lshlrev_b16 v123, 2, v65
    v_lshlrev_b32 v124, 16, v34
    v_bitop3_b32 v122, v122, v113, v113 bitop3:0x0c
    v_and_b32 v125, 0xffff0000, v34
    v_lshlrev_b32 v126, 16, v35
    v_mul_f32 v122, v114, v122
    v_and_b32 v127, 0xffff0000, v35
    v_add_u32 v123, v123, v123
    v_pk_fma_f32 v[124:125], v[124:125], v[122:123], s[34:35] op_sel_hi:[1,0,1]
    v_pk_fma_f32 v[126:127], v[126:127], v[122:123], s[34:35] op_sel_hi:[1,0,1]
    v_lshl_add_u32 v124, v125, 16, v124
    v_lshl_add_u32 v125, v127, 16, v126
    s_waitcnt lgkmcnt(2)
    v_bitop3_b32 v115, v115, v120, v121 bitop3:0xfe
    v_lshl_add_u64 v[124:125], v[124:125], 0, s[36:37]
    v_cmpx_le_u32 vcc, 0x1000000, v65
    ds_add_rtn_u64 v[120:121], v123, v[124:125] offset:54272
    s_mov_b64 exec, -1
    s_waitcnt lgkmcnt(15)
    v_ashrrev_i32 v122, 5, v66
    v_lshlrev_b16 v123, 2, v66
    v_lshlrev_b32 v124, 16, v36
    v_bitop3_b32 v122, v122, v113, v113 bitop3:0x0c
    v_and_b32 v125, 0xffff0000, v36
    v_lshlrev_b32 v126, 16, v37
    v_mul_f32 v122, v114, v122
    v_and_b32 v127, 0xffff0000, v37
    v_add_u32 v123, v123, v123
    v_pk_fma_f32 v[124:125], v[124:125], v[122:123], s[34:35] op_sel_hi:[1,0,1]
    v_pk_fma_f32 v[126:127], v[126:127], v[122:123], s[34:35] op_sel_hi:[1,0,1]
    v_lshl_add_u32 v124, v125, 16, v124
    v_lshl_add_u32 v125, v127, 16, v126
    s_waitcnt lgkmcnt(2)
    v_bitop3_b32 v115, v115, v116, v117 bitop3:0xfe
    v_lshl_add_u64 v[124:125], v[124:125], 0, s[36:37]
    v_cmpx_le_u32 vcc, 0x1000000, v66
    ds_add_rtn_u64 v[116:117], v123, v[124:125] offset:54272
    s_mov_b64 exec, -1
    v_ashrrev_i32 v122, 5, v67
    v_lshlrev_b16 v123, 2, v67
    v_lshlrev_b32 v124, 16, v38
    v_bitop3_b32 v122, v122, v113, v113 bitop3:0x0c
    v_and_b32 v125, 0xffff0000, v38
    v_lshlrev_b32 v126, 16, v39
    v_mul_f32 v122, v114, v122
    v_and_b32 v127, 0xffff0000, v39
    v_add_u32 v123, v123, v123
    v_pk_fma_f32 v[124:125], v[124:125], v[122:123], s[34:35] op_sel_hi:[1,0,1]
    v_pk_fma_f32 v[126:127], v[126:127], v[122:123], s[34:35] op_sel_hi:[1,0,1]
    v_lshl_add_u32 v124, v125, 16, v124
    v_lshl_add_u32 v125, v127, 16, v126
    s_waitcnt lgkmcnt(2)
    v_bitop3_b32 v115, v115, v118, v119 bitop3:0xfe
    v_lshl_add_u64 v[124:125], v[124:125], 0, s[36:37]
    v_cmpx_le_u32 vcc, 0x1000000, v67
    ds_add_rtn_u64 v[118:119], v123, v[124:125] offset:54272
    s_mov_b64 exec, -1
    v_ashrrev_i32 v122, 5, v68
    v_lshlrev_b16 v123, 2, v68
    v_lshlrev_b32 v124, 16, v40
    v_bitop3_b32 v122, v122, v113, v113 bitop3:0x0c
    v_and_b32 v125, 0xffff0000, v40
    v_lshlrev_b32 v126, 16, v41
    v_mul_f32 v122, v114, v122
    v_and_b32 v127, 0xffff0000, v41
    v_add_u32 v123, v123, v123
    v_pk_fma_f32 v[124:125], v[124:125], v[122:123], s[34:35] op_sel_hi:[1,0,1]
    v_pk_fma_f32 v[126:127], v[126:127], v[122:123], s[34:35] op_sel_hi:[1,0,1]
    v_lshl_add_u32 v124, v125, 16, v124
    v_lshl_add_u32 v125, v127, 16, v126
    s_waitcnt lgkmcnt(2)
    v_bitop3_b32 v115, v115, v120, v121 bitop3:0xfe
    v_lshl_add_u64 v[124:125], v[124:125], 0, s[36:37]
    v_cmpx_le_u32 vcc, 0x1000000, v68
    ds_add_rtn_u64 v[120:121], v123, v[124:125] offset:54272
    s_mov_b64 exec, -1
    s_waitcnt lgkmcnt(15)
    v_ashrrev_i32 v122, 5, v69
    v_lshlrev_b16 v123, 2, v69
    v_lshlrev_b32 v124, 16, v42
    v_bitop3_b32 v122, v122, v113, v113 bitop3:0x0c
    v_and_b32 v125, 0xffff0000, v42
    v_lshlrev_b32 v126, 16, v43
    v_mul_f32 v122, v114, v122
    v_and_b32 v127, 0xffff0000, v43
    v_add_u32 v123, v123, v123
    v_pk_fma_f32 v[124:125], v[124:125], v[122:123], s[34:35] op_sel_hi:[1,0,1]
    v_pk_fma_f32 v[126:127], v[126:127], v[122:123], s[34:35] op_sel_hi:[1,0,1]
    v_lshl_add_u32 v124, v125, 16, v124
    v_lshl_add_u32 v125, v127, 16, v126
    s_waitcnt lgkmcnt(2)
    v_bitop3_b32 v115, v115, v116, v117 bitop3:0xfe
    v_lshl_add_u64 v[124:125], v[124:125], 0, s[36:37]
    v_cmpx_le_u32 vcc, 0x1000000, v69
    ds_add_rtn_u64 v[116:117], v123, v[124:125] offset:54272
    s_mov_b64 exec, -1
    v_ashrrev_i32 v122, 5, v70
    v_lshlrev_b16 v123, 2, v70
    v_lshlrev_b32 v124, 16, v44
    v_bitop3_b32 v122, v122, v113, v113 bitop3:0x0c
    v_and_b32 v125, 0xffff0000, v44
    v_lshlrev_b32 v126, 16, v45
    v_mul_f32 v122, v114, v122
    v_and_b32 v127, 0xffff0000, v45
    v_add_u32 v123, v123, v123
    v_pk_fma_f32 v[124:125], v[124:125], v[122:123], s[34:35] op_sel_hi:[1,0,1]
    v_pk_fma_f32 v[126:127], v[126:127], v[122:123], s[34:35] op_sel_hi:[1,0,1]
    v_lshl_add_u32 v124, v125, 16, v124
    v_lshl_add_u32 v125, v127, 16, v126
    s_waitcnt lgkmcnt(2)
    v_bitop3_b32 v115, v115, v118, v119 bitop3:0xfe
    v_lshl_add_u64 v[124:125], v[124:125], 0, s[36:37]
    v_cmpx_le_u32 vcc, 0x1000000, v70
    ds_add_rtn_u64 v[118:119], v123, v[124:125] offset:54272
    s_mov_b64 exec, -1
    v_ashrrev_i32 v122, 5, v71
    v_lshlrev_b16 v123, 2, v71
    v_lshlrev_b32 v124, 16, v46
    v_bitop3_b32 v122, v122, v113, v113 bitop3:0x0c
    v_and_b32 v125, 0xffff0000, v46
    v_lshlrev_b32 v126, 16, v47
    v_mul_f32 v122, v114, v122
    v_and_b32 v127, 0xffff0000, v47
    v_add_u32 v123, v123, v123
    v_pk_fma_f32 v[124:125], v[124:125], v[122:123], s[34:35] op_sel_hi:[1,0,1]
    v_pk_fma_f32 v[126:127], v[126:127], v[122:123], s[34:35] op_sel_hi:[1,0,1]
    v_lshl_add_u32 v124, v125, 16, v124
    v_lshl_add_u32 v125, v127, 16, v126
    s_waitcnt lgkmcnt(2)
    v_bitop3_b32 v115, v115, v120, v121 bitop3:0xfe
    v_lshl_add_u64 v[124:125], v[124:125], 0, s[36:37]
    v_cmpx_le_u32 vcc, 0x1000000, v71
    ds_add_rtn_u64 v[120:121], v123, v[124:125] offset:54272
    s_mov_b64 exec, -1
    s_branch p2_fin
p2_topf:
    s_cmp_eq_u32 s60, 10
    s_cbranch_scc1 p2_drain1
    s_setprio 3
    v_cmpx_gt_i16 vcc, 0, v48
    ds_read_b64 v[0:1], v0
    s_mov_b64 exec, -1
    v_cmpx_gt_i16 vcc, 0, v49
    ds_read_b64 v[2:3], v2
    s_mov_b64 exec, -1
    v_cmpx_gt_i16 vcc, 0, v50
    ds_read_b64 v[4:5], v4
    s_mov_b64 exec, -1
    v_cmpx_gt_i16 vcc, 0, v51
    ds_read_b64 v[6:7], v6
    s_mov_b64 exec, -1
    v_cmpx_gt_i16 vcc, 0, v52
    ds_read_b64 v[8:9], v8
    s_mov_b64 exec, -1
    v_cmpx_gt_i16 vcc, 0, v53
    ds_read_b64 v[10:11], v10
    s_mov_b64 exec, -1
    v_cmpx_gt_i16 vcc, 0, v54
    ds_read_b64 v[12:13], v12
    s_mov_b64 exec, -1
    v_cmpx_gt_i16 vcc, 0, v55
    ds_read_b64 v[14:15], v14
    s_mov_b64 exec, -1
    v_cmpx_gt_i16 vcc, 0, v56
    ds_read_b64 v[16:17], v16
    s_mov_b64 exec, -1
    s_cmp_lt_u32 s15, 8
    s_cbranch_scc1 p2_g1r23
    v_cmpx_gt_i16 vcc, 0, v57
    ds_read_b64 v[18:19], v18
    s_mov_b64 exec, -1
    v_cmpx_gt_i16 vcc, 0, v58
    ds_read_b64 v[20:21], v20
    s_mov_b64 exec, -1
    v_cmpx_gt_i16 vcc, 0, v59
    ds_read_b64 v[22:23], v22
    s_mov_b64 exec, -1
p2_g1r23:
    s_cmp_ge_u32 s10, 9
    s_cbranch_scc1 p2_nm1m0a
    v_lshrrev_b32 v84, 1, v112
    s_add_u32 s44, s20, s42
    buffer_load_dwordx2 v[84:85], v84, s[4:7], s44 offen
p2_nm1m0a:
    buffer_load_dwordx4 v[72:75], v112, s[4:7], s20 offen offset:0
    buffer_load_dwordx4 v[76:79], v112, s[4:7], s20 offen offset:1024
    buffer_load_dwordx4 v[80:83], v112, s[4:7], s20 offen offset:2048
    v_cmpx_gt_i16 vcc, 0, v60
    ds_read_b64 v[24:25], v24
    s_mov_b64 exec, -1
    v_cmpx_gt_i16 vcc, 0, v61
    ds_read_b64 v[26:27], v26
    s_mov_b64 exec, -1
    v_cmpx_gt_i16 vcc, 0, v62
    ds_read_b64 v[28:29], v28
    s_mov_b64 exec, -1
    v_cmpx_gt_i16 vcc, 0, v63
    ds_read_b64 v[30:31], v30
    s_mov_b64 exec, -1
    v_cmpx_gt_i16 vcc, 0, v64
    ds_read_b64 v[32:33], v32
    s_mov_b64 exec, -1
    v_cmpx_gt_i16 vcc, 0, v65
    ds_read_b64 v[34:35], v34
    s_mov_b64 exec, -1
    v_cmpx_gt_i16 vcc, 0, v66
    ds_read_b64 v[36:37], v36
    s_mov_b64 exec, -1
    v_cmpx_gt_i16 vcc, 0, v67
    ds_read_b64 v[38:39], v38
    s_mov_b64 exec, -1
    v_cmpx_gt_i16 vcc, 0, v68
    ds_read_b64 v[40:41], v40
    s_mov_b64 exec, -1
    v_cmpx_gt_i16 vcc, 0, v69
    ds_read_b64 v[42:43], v42
    s_mov_b64 exec, -1
    v_cmpx_gt_i16 vcc, 0, v70
    ds_read_b64 v[44:45], v44
    s_mov_b64 exec, -1
    v_cmpx_gt_i16 vcc, 0, v71
    ds_read_b64 v[46:47], v46
    s_mov_b64 exec, -1
    s_setprio 2
    s_waitcnt lgkmcnt(15)
    v_ashrrev_i32 v122, 5, v48
    v_lshlrev_b16 v123, 2, v48
    v_cndmask_b32 v126, v0, v1, s[66:67]
    v_bitop3_b32 v122, v122, v113, v113 bitop3:0x0c
    v_lshlrev_b32 v124, 16, v126
    v_mul_f32 v122, v114, v122
    v_and_b32 v125, 0xffff0000, v126
    v_add_u32 v123, v123, v123
    v_mul_f32 v124, v122, v124
    v_mul_f32 v125, v122, v125
    v_cmpx_le_u32 vcc, 0x1000000, v48
    ds_add_f32 v123, v124 offset:54272
    ds_add_f32 v123, v125 offset:54276
    s_mov_b64 exec, -1
    v_ashrrev_i32 v122, 5, v49
    v_lshlrev_b16 v123, 2, v49
    v_cndmask_b32 v126, v2, v3, s[66:67]
    v_bitop3_b32 v122, v122, v113, v113 bitop3:0x0c
    v_lshlrev_b32 v124, 16, v126
    v_mul_f32 v122, v114, v122
    v_and_b32 v125, 0xffff0000, v126
    v_add_u32 v123, v123, v123
    v_mul_f32 v124, v122, v124
    v_mul_f32 v125, v122, v125
    v_cmpx_le_u32 vcc, 0x1000000, v49
    ds_add_f32 v123, v124 offset:54272
    ds_add_f32 v123, v125 offset:54276
    s_mov_b64 exec, -1
    v_ashrrev_i32 v122, 5, v50
    v_lshlrev_b16 v123, 2, v50
    v_cndmask_b32 v126, v4, v5, s[66:67]
    v_bitop3_b32 v122, v122, v113, v113 bitop3:0x0c
    v_lshlrev_b32 v124, 16, v126
    v_mul_f32 v122, v114, v122
    v_and_b32 v125, 0xffff0000, v126
    v_add_u32 v123, v123, v123
    v_mul_f32 v124, v122, v124
    v_mul_f32 v125, v122, v125
    v_cmpx_le_u32 vcc, 0x1000000, v50
    ds_add_f32 v123, v124 offset:54272
    ds_add_f32 v123, v125 offset:54276
    s_mov_b64 exec, -1
    v_bfe_u32 v0, v102, 14, 4
    v_lshrrev_b32 v1, 18, v102
    v_and_b32 v102, 16383, v102
    v_mad_u32_u24 v0, v0, s63, v1
    v_mad_u32_u24 v102, v0, s65, v102
    buffer_load_dwordx4 v[0:3], v102, s[68:71], 0 offen
    s_setprio 1
    s_waitcnt lgkmcnt(15)
    v_ashrrev_i32 v122, 5, v51
    v_lshlrev_b16 v123, 2, v51
    v_cndmask_b32 v126, v6, v7, s[66:67]
    v_bitop3_b32 v122, v122, v113, v113 bitop3:0x0c
    v_lshlrev_b32 v124, 16, v126
    v_mul_f32 v122, v114, v122
    v_and_b32 v125, 0xffff0000, v126
    v_add_u32 v123, v123, v123
    v_mul_f32 v124, v122, v124
    v_mul_f32 v125, v122, v125
    v_cmpx_le_u32 vcc, 0x1000000, v51
    ds_add_f32 v123, v124 offset:54272
    ds_add_f32 v123, v125 offset:54276
    s_mov_b64 exec, -1
    v_ashrrev_i32 v122, 5, v52
    v_lshlrev_b16 v123, 2, v52
    v_cndmask_b32 v126, v8, v9, s[66:67]
    v_bitop3_b32 v122, v122, v113, v113 bitop3:0x0c
    v_lshlrev_b32 v124, 16, v126
    v_mul_f32 v122, v114, v122
    v_and_b32 v125, 0xffff0000, v126
    v_add_u32 v123, v123, v123
    v_mul_f32 v124, v122, v124
    v_mul_f32 v125, v122, v125
    v_cmpx_le_u32 vcc, 0x1000000, v52
    ds_add_f32 v123, v124 offset:54272
    ds_add_f32 v123, v125 offset:54276
    s_mov_b64 exec, -1
    v_ashrrev_i32 v122, 5, v53
    v_lshlrev_b16 v123, 2, v53
    v_cndmask_b32 v126, v10, v11, s[66:67]
    v_bitop3_b32 v122, v122, v113, v113 bitop3:0x0c
    v_lshlrev_b32 v124, 16, v126
    v_mul_f32 v122, v114, v122
    v_and_b32 v125, 0xffff0000, v126
    v_add_u32 v123, v123, v123
    v_mul_f32 v124, v122, v124
    v_mul_f32 v125, v122, v125
    v_cmpx_le_u32 vcc, 0x1000000, v53
    ds_add_f32 v123, v124 offset:54272
    ds_add_f32 v123, v125 offset:54276
    s_mov_b64 exec, -1
    v_bfe_u32 v6, v103, 14, 4
    v_lshrrev_b32 v7, 18, v103
    v_and_b32 v103, 16383, v103
    v_mad_u32_u24 v6, v6, s63, v7
    v_mad_u32_u24 v103, v6, s65, v103
    buffer_load_dwordx4 v[6:9], v103, s[68:71], 0 offen
    s_waitcnt lgkmcnt(12)
    s_barrier
    s_setprio 3
    s_waitcnt vmcnt(5)
    s_mov_b32 m0, s23
    v_mov_b32 v53, 0
    s_movk_i32 s44, 512
    v_sub_u32_sdwa v4, v111, v110 dst_sel:DWORD dst_unused:UNUSED_PAD src0_sel:WORD_0 src1_sel:WORD_0
    v_sub_u32_sdwa v5, v111, v110 dst_sel:DWORD dst_unused:UNUSED_PAD src0_sel:WORD_1 src1_sel:WORD_1
    v_med3_i32 v4, v4, 0, s44
    v_med3_i32 v5, v5, 0, s44
    v_add_u32 v48, v4, v5
    ds_write_addtid_b32 v53 offset:0
    ds_write_addtid_b32 v53 offset:256
    ds_write_addtid_b32 v53 offset:512
    ds_write_addtid_b32 v53 offset:768
    ds_write_addtid_b32 v53 offset:1024
    ds_write_addtid_b32 v53 offset:1280
    ds_write_addtid_b32 v53 offset:1536
    ds_write_addtid_b32 v53 offset:1792
    v_bfe_i32 v53, v112, 6, 1
    v_lshrrev_b32 v49, 6, v112
    v_bitop3_b32 v53, v53, 15, s10 bitop3:0x6a
    v_lshl_or_b32 v49, v49, 4, v53
    v_and_b32 v53, 0x30, v112
    v_lshl_or_b32 v53, v49, 6, v53
    v_lshlrev_b32 v53, 15, v53
    s_nop 1
    v_add_u32_dpp v48, v48, v48 row_shr:1 row_mask:0xf bank_mask:0xf bound_ctrl:0
    s_nop 1
    v_add_u32_dpp v48, v48, v48 row_shr:2 row_mask:0xf bank_mask:0xf bound_ctrl:0
    s_nop 1
    v_add_u32_dpp v48, v48, v48 row_shr:4 row_mask:0xf bank_mask:0xf bound_ctrl:0
    s_nop 1
    v_add_u32_dpp v48, v48, v48 row_shr:8 row_mask:0xf bank_mask:0xf bound_ctrl:0
    s_nop 1
    v_add_u32_dpp v48, v48, v48 row_bcast:15 row_mask:0xa bank_mask:0xf
    s_nop 1
    v_add_u32_dpp v48, v48, v48 row_bcast:31 row_mask:0xc bank_mask:0xf
    s_nop 1
    s_nop 0
    v_readlane_b32 s38, v48, 63
    v_sub_u32 v50, v48, v5
    v_sub_u32 v49, v50, v4
    v_writelane_b32 v5, 1, 63
    v_sub_u32 v10, 512, v49
    v_mad_u32_u16 v51, v110, 16, v53
    v_lshl_add_u32 v51, v10, 4, v51
    v_med3_i32 v10, v10, 0, v4
    v_lshl_add_u32 v49, v49, 2, s23
    v_sub_u32 v11, 512, v50
    v_mad_u32_u16 v52, v110, 16, v53 op_sel:[1,0,0,0]
    v_add_u32 v52, 262144, v52
    s_mov_b32 s44, 0x1fffc000
    v_writelane_b32 v52, s44, 63
    v_lshl_add_u32 v52, v11, 4, v52
    v_med3_i32 v11, v11, 0, v5
    v_lshl_add_u32 v50, v50, 2, s23
    v_lshl_add_u32 v48, v11, 16, v10
    v_add_u32 v110, v110, v48
    s_min_u32 s17, s38, 512
    s_add_u32 s17, s17, 63
    s_lshr_b32 s17, s17, 6
    v_cmpx_lt_i32 vcc, 0, v10
    ds_write_b32 v49, v51
    s_mov_b64 exec, -1
    v_cmpx_lt_i32 vcc, 0, v11
    ds_write_b32 v50, v52
    s_mov_b64 exec, -1
    s_cmp_lt_u32 s38, 512
    s_cbranch_scc1 p2_nomore1x
    v_cmp_lt_u32_sdwa s[44:45], v110, v111 src0_sel:WORD_0 src1_sel:WORD_0
    v_cmp_lt_u32_sdwa s[46:47], v110, v111 src0_sel:WORD_1 src1_sel:WORD_1
    s_nop 0
    s_or_b64 s[44:45], s[44:45], s[46:47]
    s_cbranch_scc0 p2_nomore1x
    v_mov_b32 v49, s19
    v_mov_b32 v50, 1
    ds_write_b32 v49, v50 offset:53760
p2_nomore1x:
    s_setprio 2
    s_waitcnt lgkmcnt(15)
    v_ashrrev_i32 v122, 5, v54
    v_lshlrev_b16 v123, 2, v54
    v_cndmask_b32 v126, v12, v13, s[66:67]
    v_bitop3_b32 v122, v122, v113, v113 bitop3:0x0c
    v_lshlrev_b32 v124, 16, v126
    v_mul_f32 v122, v114, v122
    v_and_b32 v125, 0xffff0000, v126
    v_add_u32 v123, v123, v123
    v_mul_f32 v124, v122, v124
    v_mul_f32 v125, v122, v125
    v_cmpx_le_u32 vcc, 0x1000000, v54
    ds_add_f32 v123, v124 offset:54272
    ds_add_f32 v123, v125 offset:54276
    s_mov_b64 exec, -1
    v_ashrrev_i32 v122, 5, v55
    v_lshlrev_b16 v123, 2, v55
    v_cndmask_b32 v126, v14, v15, s[66:67]
    v_bitop3_b32 v122, v122, v113, v113 bitop3:0x0c
    v_lshlrev_b32 v124, 16, v126
    v_mul_f32 v122, v114, v122
    v_and_b32 v125, 0xffff0000, v126
    v_add_u32 v123, v123, v123
    v_mul_f32 v124, v122, v124
    v_mul_f32 v125, v122, v125
    v_cmpx_le_u32 vcc, 0x1000000, v55
    ds_add_f32 v123, v124 offset:54272
    ds_add_f32 v123, v125 offset:54276
    s_mov_b64 exec, -1
    v_ashrrev_i32 v122, 5, v56
    v_lshlrev_b16 v123, 2, v56
    v_cndmask_b32 v126, v16, v17, s[66:67]
    v_bitop3_b32 v122, v122, v113, v113 bitop3:0x0c
    v_lshlrev_b32 v124, 16, v126
    v_mul_f32 v122, v114, v122
    v_and_b32 v125, 0xffff0000, v126
    v_add_u32 v123, v123, v123
    v_mul_f32 v124, v122, v124
    v_mul_f32 v125, v122, v125
    v_cmpx_le_u32 vcc, 0x1000000, v56
    ds_add_f32 v123, v124 offset:54272
    ds_add_f32 v123, v125 offset:54276
    s_mov_b64 exec, -1
    v_bfe_u32 v12, v104, 14, 4
    v_lshrrev_b32 v13, 18, v104
    v_and_b32 v104, 16383, v104
    v_mad_u32_u24 v12, v12, s63, v13
    v_mad_u32_u24 v104, v12, s65, v104
    buffer_load_dwordx4 v[12:15], v104, s[68:71], 0 offen
    s_cmp_lt_u32 s15, 8
    s_cbranch_scc1 p2_na1a3
    s_waitcnt lgkmcnt(15)
    v_ashrrev_i32 v122, 5, v57
    v_lshlrev_b16 v123, 2, v57
    v_cndmask_b32 v126, v18, v19, s[66:67]
    v_bitop3_b32 v122, v122, v113, v113 bitop3:0x0c
    v_lshlrev_b32 v124, 16, v126
    v_mul_f32 v122, v114, v122
    v_and_b32 v125, 0xffff0000, v126
    v_add_u32 v123, v123, v123
    v_mul_f32 v124, v122, v124
    v_mul_f32 v125, v122, v125
    v_cmpx_le_u32 vcc, 0x1000000, v57
    ds_add_f32 v123, v124 offset:54272
    ds_add_f32 v123, v125 offset:54276
    s_mov_b64 exec, -1
    v_ashrrev_i32 v122, 5, v58
    v_lshlrev_b16 v123, 2, v58
    v_cndmask_b32 v126, v20, v21, s[66:67]
    v_bitop3_b32 v122, v122, v113, v113 bitop3:0x0c
    v_lshlrev_b32 v124, 16, v126
    v_mul_f32 v122, v114, v122
    v_and_b32 v125, 0xffff0000, v126
    v_add_u32 v123, v123, v123
    v_mul_f32 v124, v122, v124
    v_mul_f32 v125, v122, v125
    v_cmpx_le_u32 vcc, 0x1000000, v58
    ds_add_f32 v123, v124 offset:54272
    ds_add_f32 v123, v125 offset:54276
    s_mov_b64 exec, -1
    v_ashrrev_i32 v122, 5, v59
    v_lshlrev_b16 v123, 2, v59
    v_cndmask_b32 v126, v22, v23, s[66:67]
    v_bitop3_b32 v122, v122, v113, v113 bitop3:0x0c
    v_lshlrev_b32 v124, 16, v126
    v_mul_f32 v122, v114, v122
    v_and_b32 v125, 0xffff0000, v126
    v_add_u32 v123, v123, v123
    v_mul_f32 v124, v122, v124
    v_mul_f32 v125, v122, v125
    v_cmpx_le_u32 vcc, 0x1000000, v59
    ds_add_f32 v123, v124 offset:54272
    ds_add_f32 v123, v125 offset:54276
    s_mov_b64 exec, -1
p2_na1a3:
    v_bfe_u32 v18, v105, 14, 4
    v_lshrrev_b32 v19, 18, v105
    v_and_b32 v105, 16383, v105
    v_mad_u32_u24 v18, v18, s63, v19
    v_mad_u32_u24 v105, v18, s65, v105
    buffer_load_dwordx4 v[18:21], v105, s[68:71], 0 offen
    s_mov_b32 m0, s23
    s_nop 0
    ds_read_addtid_b32 v102 offset:1024
    ds_read_addtid_b32 v103 offset:1280
    ds_read_addtid_b32 v104 offset:1536
    ds_read_addtid_b32 v105 offset:1792
    ds_read_addtid_b32 v106 offset:0
    ds_read_addtid_b32 v107 offset:256
    ds_read_addtid_b32 v108 offset:512
    ds_read_addtid_b32 v109 offset:768
    s_waitcnt vmcnt(4)
    s_mov_b32 m0, s24
    s_cmp_ge_u32 s10, 9
    s_cbranch_scc1 p2_st1s0
    ds_write_addtid_b32 v84 offset:49152
    ds_write_addtid_b32 v85 offset:49408
p2_st1s0:
    s_mov_b32 m0, s23
    s_add_u32 s20, s20, 53760
    ds_write_addtid_b32 v72 offset:0
    ds_write_addtid_b32 v73 offset:256
    ds_write_addtid_b32 v74 offset:512
    ds_write_addtid_b32 v75 offset:768
    ds_write_addtid_b32 v76 offset:1024
    ds_write_addtid_b32 v77 offset:1280
    ds_write_addtid_b32 v78 offset:1536
    ds_write_addtid_b32 v79 offset:1792
    ds_write_addtid_b32 v80 offset:2048
    ds_write_addtid_b32 v81 offset:2304
    ds_write_addtid_b32 v82 offset:2560
    ds_write_addtid_b32 v83 offset:2816
    s_setprio 1
    s_waitcnt lgkmcnt(15)
    v_ashrrev_i32 v122, 5, v60
    v_lshlrev_b16 v123, 2, v60
    v_cndmask_b32 v126, v24, v25, s[66:67]
    v_bitop3_b32 v122, v122, v113, v113 bitop3:0x0c
    v_lshlrev_b32 v124, 16, v126
    v_mul_f32 v122, v114, v122
    v_and_b32 v125, 0xffff0000, v126
    v_add_u32 v123, v123, v123
    v_mul_f32 v124, v122, v124
    v_mul_f32 v125, v122, v125
    v_cmpx_le_u32 vcc, 0x1000000, v60
    ds_add_f32 v123, v124 offset:54272
    ds_add_f32 v123, v125 offset:54276
    s_mov_b64 exec, -1
    v_ashrrev_i32 v122, 5, v61
    v_lshlrev_b16 v123, 2, v61
    v_cndmask_b32 v126, v26, v27, s[66:67]
    v_bitop3_b32 v122, v122, v113, v113 bitop3:0x0c
    v_lshlrev_b32 v124, 16, v126
    v_mul_f32 v122, v114, v122
    v_and_b32 v125, 0xffff0000, v126
    v_add_u32 v123, v123, v123
    v_mul_f32 v124, v122, v124
    v_mul_f32 v125, v122, v125
    v_cmpx_le_u32 vcc, 0x1000000, v61
    ds_add_f32 v123, v124 offset:54272
    ds_add_f32 v123, v125 offset:54276
    s_mov_b64 exec, -1
    v_ashrrev_i32 v122, 5, v62
    v_lshlrev_b16 v123, 2, v62
    v_cndmask_b32 v126, v28, v29, s[66:67]
    v_bitop3_b32 v122, v122, v113, v113 bitop3:0x0c
    v_lshlrev_b32 v124, 16, v126
    v_mul_f32 v122, v114, v122
    v_and_b32 v125, 0xffff0000, v126
    v_add_u32 v123, v123, v123
    v_mul_f32 v124, v122, v124
    v_mul_f32 v125, v122, v125
    v_cmpx_le_u32 vcc, 0x1000000, v62
    ds_add_f32 v123, v124 offset:54272
    ds_add_f32 v123, v125 offset:54276
    s_mov_b64 exec, -1
    s_waitcnt vmcnt(16)
    v_perm_b32 v60, v89, v86, s31
    v_perm_b32 v61, v89, v87, s32
    v_perm_b32 v62, v89, v88, s33
    v_lshlrev_b16 v28, 3, v88
    v_lshlrev_b16 v26, 3, v87
    v_lshlrev_b16 v24, 3, v86
    s_waitcnt lgkmcnt(15)
    s_nop 2
    s_nop 1
    v_max_u32_dpp v106, v106, v106 row_shr:1 row_mask:0xf bank_mask:0xf bound_ctrl:0
    v_max_u32_dpp v107, v107, v107 row_shr:1 row_mask:0xf bank_mask:0xf bound_ctrl:0
    s_nop 0
    v_max_u32_dpp v106, v106, v106 row_shr:2 row_mask:0xf bank_mask:0xf bound_ctrl:0
    v_max_u32_dpp v107, v107, v107 row_shr:2 row_mask:0xf bank_mask:0xf bound_ctrl:0
    s_nop 0
    v_max_u32_dpp v106, v106, v106 row_shr:4 row_mask:0xf bank_mask:0xf bound_ctrl:0
    v_max_u32_dpp v107, v107, v107 row_shr:4 row_mask:0xf bank_mask:0xf bound_ctrl:0
    s_nop 0
    v_max_u32_dpp v106, v106, v106 row_shr:8 row_mask:0xf bank_mask:0xf bound_ctrl:0
    v_max_u32_dpp v107, v107, v107 row_shr:8 row_mask:0xf bank_mask:0xf bound_ctrl:0
    s_nop 0
    v_max_u32_dpp v106, v106, v106 row_bcast:15 row_mask:0xa bank_mask:0xf
    v_max_u32_dpp v107, v107, v107 row_bcast:15 row_mask:0xa bank_mask:0xf
    s_nop 0
    v_max_u32_dpp v106, v106, v106 row_bcast:31 row_mask:0xc bank_mask:0xf
    v_max_u32_dpp v107, v107, v107 row_bcast:31 row_mask:0xc bank_mask:0xf
    s_nop 0
    s_nop 0
    v_readlane_b32 s41, v106, 63
    v_add_u32 v106, v106, v112
    v_add_u32 v106, 4294959104, v106
    v_max_u32 v107, s41, v107
    s_nop 0
    v_readlane_b32 s41, v107, 63
    v_add_u32 v107, v107, v112
    v_add_u32 v107, 4294960128, v107
    v_bfe_u32 v86, v106, 14, 4
    v_lshrrev_b32 v87, 18, v106
    v_and_b32 v106, 16383, v106
    v_mad_u32_u24 v86, v86, s63, v87
    v_mad_u32_u24 v106, v86, s65, v106
    buffer_load_dwordx4 v[86:89], v106, s[68:71], 0 offen
    s_setprio 0
    s_waitcnt lgkmcnt(15)
    v_ashrrev_i32 v122, 5, v63
    v_lshlrev_b16 v123, 2, v63
    v_cndmask_b32 v126, v30, v31, s[66:67]
    v_bitop3_b32 v122, v122, v113, v113 bitop3:0x0c
    v_lshlrev_b32 v124, 16, v126
    v_mul_f32 v122, v114, v122
    v_and_b32 v125, 0xffff0000, v126
    v_add_u32 v123, v123, v123
    v_mul_f32 v124, v122, v124
    v_mul_f32 v125, v122, v125
    v_cmpx_le_u32 vcc, 0x1000000, v63
    ds_add_f32 v123, v124 offset:54272
    ds_add_f32 v123, v125 offset:54276
    s_mov_b64 exec, -1
    v_ashrrev_i32 v122, 5, v64
    v_lshlrev_b16 v123, 2, v64
    v_cndmask_b32 v126, v32, v33, s[66:67]
    v_bitop3_b32 v122, v122, v113, v113 bitop3:0x0c
    v_lshlrev_b32 v124, 16, v126
    v_mul_f32 v122, v114, v122
    v_and_b32 v125, 0xffff0000, v126
    v_add_u32 v123, v123, v123
    v_mul_f32 v124, v122, v124
    v_mul_f32 v125, v122, v125
    v_cmpx_le_u32 vcc, 0x1000000, v64
    ds_add_f32 v123, v124 offset:54272
    ds_add_f32 v123, v125 offset:54276
    s_mov_b64 exec, -1
    v_ashrrev_i32 v122, 5, v65
    v_lshlrev_b16 v123, 2, v65
    v_cndmask_b32 v126, v34, v35, s[66:67]
    v_bitop3_b32 v122, v122, v113, v113 bitop3:0x0c
    v_lshlrev_b32 v124, 16, v126
    v_mul_f32 v122, v114, v122
    v_and_b32 v125, 0xffff0000, v126
    v_add_u32 v123, v123, v123
    v_mul_f32 v124, v122, v124
    v_mul_f32 v125, v122, v125
    v_cmpx_le_u32 vcc, 0x1000000, v65
    ds_add_f32 v123, v124 offset:54272
    ds_add_f32 v123, v125 offset:54276
    s_mov_b64 exec, -1
    s_waitcnt vmcnt(13)
    v_perm_b32 v63, v93, v90, s31
    v_perm_b32 v64, v93, v91, s32
    v_perm_b32 v65, v93, v92, s33
    v_lshlrev_b16 v34, 3, v92
    v_lshlrev_b16 v32, 3, v91
    v_lshlrev_b16 v30, 3, v90
    s_waitcnt lgkmcnt(12)
    s_barrier
    s_setprio 3
    s_cmp_ge_u32 s10, 9
    s_cbranch_scc1 p2_nm1m1a
    v_lshrrev_b32 v84, 1, v112
    s_add_u32 s44, s20, s42
    buffer_load_dwordx2 v[84:85], v84, s[4:7], s44 offen
p2_nm1m1a:
    buffer_load_dwordx4 v[72:75], v112, s[4:7], s20 offen offset:0
    buffer_load_dwordx4 v[76:79], v112, s[4:7], s20 offen offset:1024
    buffer_load_dwordx4 v[80:83], v112, s[4:7], s20 offen offset:2048
    v_cmpx_ge_u16 vcc, 0x3fff, v60
    ds_read_b64 v[24:25], v24
    s_mov_b64 exec, -1
    v_cmpx_ge_u16 vcc, 0x3fff, v61
    ds_read_b64 v[26:27], v26
    s_mov_b64 exec, -1
    v_cmpx_ge_u16 vcc, 0x3fff, v62
    ds_read_b64 v[28:29], v28
    s_mov_b64 exec, -1
    v_cmpx_ge_u16 vcc, 0x3fff, v63
    ds_read_b64 v[30:31], v30
    s_mov_b64 exec, -1
    v_cmpx_ge_u16 vcc, 0x3fff, v64
    ds_read_b64 v[32:33], v32
    s_mov_b64 exec, -1
    v_cmpx_ge_u16 vcc, 0x3fff, v65
    ds_read_b64 v[34:35], v34
    s_mov_b64 exec, -1
    s_setprio 2
    s_waitcnt lgkmcnt(15)
    v_ashrrev_i32 v122, 5, v66
    v_lshlrev_b16 v123, 2, v66
    v_cndmask_b32 v126, v36, v37, s[66:67]
    v_bitop3_b32 v122, v122, v113, v113 bitop3:0x0c
    v_lshlrev_b32 v124, 16, v126
    v_mul_f32 v122, v114, v122
    v_and_b32 v125, 0xffff0000, v126
    v_add_u32 v123, v123, v123
    v_mul_f32 v124, v122, v124
    v_mul_f32 v125, v122, v125
    v_cmpx_le_u32 vcc, 0x1000000, v66
    ds_add_f32 v123, v124 offset:54272
    ds_add_f32 v123, v125 offset:54276
    s_mov_b64 exec, -1
    v_ashrrev_i32 v122, 5, v67
    v_lshlrev_b16 v123, 2, v67
    v_cndmask_b32 v126, v38, v39, s[66:67]
    v_bitop3_b32 v122, v122, v113, v113 bitop3:0x0c
    v_lshlrev_b32 v124, 16, v126
    v_mul_f32 v122, v114, v122
    v_and_b32 v125, 0xffff0000, v126
    v_add_u32 v123, v123, v123
    v_mul_f32 v124, v122, v124
    v_mul_f32 v125, v122, v125
    v_cmpx_le_u32 vcc, 0x1000000, v67
    ds_add_f32 v123, v124 offset:54272
    ds_add_f32 v123, v125 offset:54276
    s_mov_b64 exec, -1
    v_ashrrev_i32 v122, 5, v68
    v_lshlrev_b16 v123, 2, v68
    v_cndmask_b32 v126, v40, v41, s[66:67]
    v_bitop3_b32 v122, v122, v113, v113 bitop3:0x0c
    v_lshlrev_b32 v124, 16, v126
    v_mul_f32 v122, v114, v122
    v_and_b32 v125, 0xffff0000, v126
    v_add_u32 v123, v123, v123
    v_mul_f32 v124, v122, v124
    v_mul_f32 v125, v122, v125
    v_cmpx_le_u32 vcc, 0x1000000, v68
    ds_add_f32 v123, v124 offset:54272
    ds_add_f32 v123, v125 offset:54276
    s_mov_b64 exec, -1
    s_waitcnt vmcnt(15)
    v_perm_b32 v66, v97, v94, s31
    v_perm_b32 v67, v97, v95, s32
    v_perm_b32 v68, v97, v96, s33
    v_lshlrev_b16 v40, 3, v96
    v_lshlrev_b16 v38, 3, v95
    v_lshlrev_b16 v36, 3, v94
    v_cmpx_ge_u16 vcc, 0x3fff, v66
    ds_read_b64 v[36:37], v36
    s_mov_b64 exec, -1
    v_cmpx_ge_u16 vcc, 0x3fff, v67
    ds_read_b64 v[38:39], v38
    s_mov_b64 exec, -1
    v_cmpx_ge_u16 vcc, 0x3fff, v68
    ds_read_b64 v[40:41], v40
    s_mov_b64 exec, -1
    v_bfe_u32 v90, v107, 14, 4
    v_lshrrev_b32 v91, 18, v107
    v_and_b32 v107, 16383, v107
    v_mad_u32_u24 v90, v90, s63, v91
    v_mad_u32_u24 v107, v90, s65, v107
    buffer_load_dwordx4 v[90:93], v107, s[68:71], 0 offen
    s_setprio 1
    s_waitcnt lgkmcnt(15)
    v_ashrrev_i32 v122, 5, v69
    v_lshlrev_b16 v123, 2, v69
    v_cndmask_b32 v126, v42, v43, s[66:67]
    v_bitop3_b32 v122, v122, v113, v113 bitop3:0x0c
    v_lshlrev_b32 v124, 16, v126
    v_mul_f32 v122, v114, v122
    v_and_b32 v125, 0xffff0000, v126
    v_add_u32 v123, v123, v123
    v_mul_f32 v124, v122, v124
    v_mul_f32 v125, v122, v125
    v_cmpx_le_u32 vcc, 0x1000000, v69
    ds_add_f32 v123, v124 offset:54272
    ds_add_f32 v123, v125 offset:54276
    s_mov_b64 exec, -1
    v_ashrrev_i32 v122, 5, v70
    v_lshlrev_b16 v123, 2, v70
    v_cndmask_b32 v126, v44, v45, s[66:67]
    v_bitop3_b32 v122, v122, v113, v113 bitop3:0x0c
    v_lshlrev_b32 v124, 16, v126
    v_mul_f32 v122, v114, v122
    v_and_b32 v125, 0xffff0000, v126
    v_add_u32 v123, v123, v123
    v_mul_f32 v124, v122, v124
    v_mul_f32 v125, v122, v125
    v_cmpx_le_u32 vcc, 0x1000000, v70
    ds_add_f32 v123, v124 offset:54272
    ds_add_f32 v123, v125 offset:54276
    s_mov_b64 exec, -1
    v_ashrrev_i32 v122, 5, v71
    v_lshlrev_b16 v123, 2, v71
    v_cndmask_b32 v126, v46, v47, s[66:67]
    v_bitop3_b32 v122, v122, v113, v113 bitop3:0x0c
    v_lshlrev_b32 v124, 16, v126
    v_mul_f32 v122, v114, v122
    v_and_b32 v125, 0xffff0000, v126
    v_add_u32 v123, v123, v123
    v_mul_f32 v124, v122, v124
    v_mul_f32 v125, v122, v125
    v_cmpx_le_u32 vcc, 0x1000000, v71
    ds_add_f32 v123, v124 offset:54272
    ds_add_f32 v123, v125 offset:54276
    s_mov_b64 exec, -1
    s_waitcnt vmcnt(12)
    v_perm_b32 v69, v101, v98, s31
    v_perm_b32 v70, v101, v99, s32
    v_perm_b32 v71, v101, v100, s33
    v_lshlrev_b16 v46, 3, v100
    v_lshlrev_b16 v44, 3, v99
    v_lshlrev_b16 v42, 3, v98
    v_cmpx_ge_u16 vcc, 0x3fff, v69
    ds_read_b64 v[42:43], v42
    s_mov_b64 exec, -1
    v_cmpx_ge_u16 vcc, 0x3fff, v70
    ds_read_b64 v[44:45], v44
    s_mov_b64 exec, -1
    v_cmpx_ge_u16 vcc, 0x3fff, v71
    ds_read_b64 v[46:47], v46
    s_mov_b64 exec, -1
    s_waitcnt lgkmcnt(15)
    s_nop 2
    s_nop 1
    v_max_u32_dpp v108, v108, v108 row_shr:1 row_mask:0xf bank_mask:0xf bound_ctrl:0
    v_max_u32_dpp v109, v109, v109 row_shr:1 row_mask:0xf bank_mask:0xf bound_ctrl:0
    s_nop 0
    v_max_u32_dpp v108, v108, v108 row_shr:2 row_mask:0xf bank_mask:0xf bound_ctrl:0
    v_max_u32_dpp v109, v109, v109 row_shr:2 row_mask:0xf bank_mask:0xf bound_ctrl:0
    s_nop 0
    v_max_u32_dpp v108, v108, v108 row_shr:4 row_mask:0xf bank_mask:0xf bound_ctrl:0
    v_max_u32_dpp v109, v109, v109 row_shr:4 row_mask:0xf bank_mask:0xf bound_ctrl:0
    s_nop 0
    v_max_u32_dpp v108, v108, v108 row_shr:8 row_mask:0xf bank_mask:0xf bound_ctrl:0
    v_max_u32_dpp v109, v109, v109 row_shr:8 row_mask:0xf bank_mask:0xf bound_ctrl:0
    s_nop 0
    v_max_u32_dpp v108, v108, v108 row_bcast:15 row_mask:0xa bank_mask:0xf
    v_max_u32_dpp v109, v109, v109 row_bcast:15 row_mask:0xa bank_mask:0xf
    s_nop 0
    v_max_u32_dpp v108, v108, v108 row_bcast:31 row_mask:0xc bank_mask:0xf
    v_max_u32_dpp v109, v109, v109 row_bcast:31 row_mask:0xc bank_mask:0xf
    s_nop 0
    s_nop 0
    v_max_u32 v108, s41, v108
    s_nop 0
    v_readlane_b32 s41, v108, 63
    v_add_u32 v108, v108, v112
    v_add_u32 v108, 4294961152, v108
    v_max_u32 v109, s41, v109
    s_nop 0
    v_readlane_b32 s41, v109, 63
    v_add_u32 v109, v109, v112
    v_add_u32 v109, 4294962176, v109
    v_bfe_u32 v94, v108, 14, 4
    v_lshrrev_b32 v95, 18, v108
    v_and_b32 v108, 16383, v108
    v_mad_u32_u24 v94, v94, s63, v95
    v_mad_u32_u24 v108, v94, s65, v108
    buffer_load_dwordx4 v[94:97], v108, s[68:71], 0 offen
    s_setprio 0
    s_waitcnt vmcnt(9)
    v_perm_b32 v48, v3, v0, s31
    v_perm_b32 v49, v3, v1, s32
    v_perm_b32 v50, v3, v2, s33
    v_lshlrev_b16 v4, 3, v2
    v_lshlrev_b16 v2, 3, v1
    v_lshlrev_b16 v0, 3, v0
    v_cmpx_ge_u16 vcc, 0x3fff, v48
    ds_read_b64 v[0:1], v0
    s_mov_b64 exec, -1
    v_cmpx_ge_u16 vcc, 0x3fff, v49
    ds_read_b64 v[2:3], v2
    s_mov_b64 exec, -1
    v_cmpx_ge_u16 vcc, 0x3fff, v50
    ds_read_b64 v[4:5], v4
    s_mov_b64 exec, -1
    s_waitcnt vmcnt(8)
    v_perm_b32 v51, v9, v6, s31
    v_perm_b32 v52, v9, v7, s32
    v_perm_b32 v53, v9, v8, s33
    v_lshlrev_b16 v10, 3, v8
    v_lshlrev_b16 v8, 3, v7
    v_lshlrev_b16 v6, 3, v6
    v_cmpx_ge_u16 vcc, 0x3fff, v51
    ds_read_b64 v[6:7], v6
    s_mov_b64 exec, -1
    v_cmpx_ge_u16 vcc, 0x3fff, v52
    ds_read_b64 v[8:9], v8
    s_mov_b64 exec, -1
    v_cmpx_ge_u16 vcc, 0x3fff, v53
    ds_read_b64 v[10:11], v10
    s_mov_b64 exec, -1
    s_waitcnt vmcnt(7)
    v_perm_b32 v54, v15, v12, s31
    v_perm_b32 v55, v15, v13, s32
    v_perm_b32 v56, v15, v14, s33
    v_lshlrev_b16 v16, 3, v14
    v_lshlrev_b16 v14, 3, v13
    v_lshlrev_b16 v12, 3, v12
    v_cmpx_ge_u16 vcc, 0x3fff, v54
    ds_read_b64 v[12:13], v12
    s_mov_b64 exec, -1
    v_cmpx_ge_u16 vcc, 0x3fff, v55
    ds_read_b64 v[14:15], v14
    s_mov_b64 exec, -1
    v_cmpx_ge_u16 vcc, 0x3fff, v56
    ds_read_b64 v[16:17], v16
    s_mov_b64 exec, -1
    s_waitcnt vmcnt(6)
    v_perm_b32 v57, v21, v18, s31
    v_perm_b32 v58, v21, v19, s32
    v_perm_b32 v59, v21, v20, s33
    v_lshlrev_b16 v22, 3, v20
    v_lshlrev_b16 v20, 3, v19
    v_lshlrev_b16 v18, 3, v18
    s_cmp_lt_u32 s16, 8
    s_cbranch_scc1 p2_g1r03
    v_cmpx_ge_u16 vcc, 0x3fff, v57
    ds_read_b64 v[18:19], v18
    s_mov_b64 exec, -1
    v_cmpx_ge_u16 vcc, 0x3fff, v58
    ds_read_b64 v[20:21], v20
    s_mov_b64 exec, -1
    v_cmpx_ge_u16 vcc, 0x3fff, v59
    ds_read_b64 v[22:23], v22
    s_mov_b64 exec, -1
p2_g1r03:
    s_waitcnt lgkmcnt(0)
    s_barrier
    s_waitcnt lgkmcnt(15)
    s_branch p2_tail
p2_drain1:
    v_cmpx_gt_i16 vcc, 0, v48
    ds_read_b64 v[0:1], v0
    s_mov_b64 exec, -1
    v_cmpx_gt_i16 vcc, 0, v49
    ds_read_b64 v[2:3], v2
    s_mov_b64 exec, -1
    v_cmpx_gt_i16 vcc, 0, v50
    ds_read_b64 v[4:5], v4
    s_mov_b64 exec, -1
    v_cmpx_gt_i16 vcc, 0, v51
    ds_read_b64 v[6:7], v6
    s_mov_b64 exec, -1
    v_cmpx_gt_i16 vcc, 0, v52
    ds_read_b64 v[8:9], v8
    s_mov_b64 exec, -1
    v_cmpx_gt_i16 vcc, 0, v53
    ds_read_b64 v[10:11], v10
    s_mov_b64 exec, -1
    v_cmpx_gt_i16 vcc, 0, v54
    ds_read_b64 v[12:13], v12
    s_mov_b64 exec, -1
    v_cmpx_gt_i16 vcc, 0, v55
    ds_read_b64 v[14:15], v14
    s_mov_b64 exec, -1
    v_cmpx_gt_i16 vcc, 0, v56
    ds_read_b64 v[16:17], v16
    s_mov_b64 exec, -1
    s_cmp_lt_u32 s15, 8
    s_cbranch_scc1 p2_gd1
    v_cmpx_gt_i16 vcc, 0, v57
    ds_read_b64 v[18:19], v18
    s_mov_b64 exec, -1
    v_cmpx_gt_i16 vcc, 0, v58
    ds_read_b64 v[20:21], v20
    s_mov_b64 exec, -1
    v_cmpx_gt_i16 vcc, 0, v59
    ds_read_b64 v[22:23], v22
    s_mov_b64 exec, -1
p2_gd1:
    v_cmpx_gt_i16 vcc, 0, v60
    ds_read_b64 v[24:25], v24
    s_mov_b64 exec, -1
    v_cmpx_gt_i16 vcc, 0, v61
    ds_read_b64 v[26:27], v26
    s_mov_b64 exec, -1
    v_cmpx_gt_i16 vcc, 0, v62
    ds_read_b64 v[28:29], v28
    s_mov_b64 exec, -1
    v_cmpx_gt_i16 vcc, 0, v63
    ds_read_b64 v[30:31], v30
    s_mov_b64 exec, -1
    v_cmpx_gt_i16 vcc, 0, v64
    ds_read_b64 v[32:33], v32
    s_mov_b64 exec, -1
    v_cmpx_gt_i16 vcc, 0, v65
    ds_read_b64 v[34:35], v34
    s_mov_b64 exec, -1
    v_cmpx_gt_i16 vcc, 0, v66
    ds_read_b64 v[36:37], v36
    s_mov_b64 exec, -1
    v_cmpx_gt_i16 vcc, 0, v67
    ds_read_b64 v[38:39], v38
    s_mov_b64 exec, -1
    v_cmpx_gt_i16 vcc, 0, v68
    ds_read_b64 v[40:41], v40
    s_mov_b64 exec, -1
    v_cmpx_gt_i16 vcc, 0, v69
    ds_read_b64 v[42:43], v42
    s_mov_b64 exec, -1
    v_cmpx_gt_i16 vcc, 0, v70
    ds_read_b64 v[44:45], v44
    s_mov_b64 exec, -1
    v_cmpx_gt_i16 vcc, 0, v71
    ds_read_b64 v[46:47], v46
    s_mov_b64 exec, -1
    s_waitcnt lgkmcnt(15)
    v_ashrrev_i32 v122, 5, v48
    v_lshlrev_b16 v123, 2, v48
    v_cndmask_b32 v126, v0, v1, s[66:67]
    v_bitop3_b32 v122, v122, v113, v113 bitop3:0x0c
    v_lshlrev_b32 v124, 16, v126
    v_mul_f32 v122, v114, v122
    v_and_b32 v125, 0xffff0000, v126
    v_add_u32 v123, v123, v123
    v_mul_f32 v124, v122, v124
    v_mul_f32 v125, v122, v125
    v_cmpx_le_u32 vcc, 0x1000000, v48
    ds_add_f32 v123, v124 offset:54272
    ds_add_f32 v123, v125 offset:54276
    s_mov_b64 exec, -1
    v_ashrrev_i32 v122, 5, v49
    v_lshlrev_b16 v123, 2, v49
    v_cndmask_b32 v126, v2, v3, s[66:67]
    v_bitop3_b32 v122, v122, v113, v113 bitop3:0x0c
    v_lshlrev_b32 v124, 16, v126
    v_mul_f32 v122, v114, v122
    v_and_b32 v125, 0xffff0000, v126
    v_add_u32 v123, v123, v123
    v_mul_f32 v124, v122, v124
    v_mul_f32 v125, v122, v125
    v_cmpx_le_u32 vcc, 0x1000000, v49
    ds_add_f32 v123, v124 offset:54272
    ds_add_f32 v123, v125 offset:54276
    s_mov_b64 exec, -1
    v_ashrrev_i32 v122, 5, v50
    v_lshlrev_b16 v123, 2, v50
    v_cndmask_b32 v126, v4, v5, s[66:67]
    v_bitop3_b32 v122, v122, v113, v113 bitop3:0x0c
    v_lshlrev_b32 v124, 16, v126
    v_mul_f32 v122, v114, v122
    v_and_b32 v125, 0xffff0000, v126
    v_add_u32 v123, v123, v123
    v_mul_f32 v124, v122, v124
    v_mul_f32 v125, v122, v125
    v_cmpx_le_u32 vcc, 0x1000000, v50
    ds_add_f32 v123, v124 offset:54272
    ds_add_f32 v123, v125 offset:54276
    s_mov_b64 exec, -1
    s_waitcnt lgkmcnt(15)
    v_ashrrev_i32 v122, 5, v51
    v_lshlrev_b16 v123, 2, v51
    v_cndmask_b32 v126, v6, v7, s[66:67]
    v_bitop3_b32 v122, v122, v113, v113 bitop3:0x0c
    v_lshlrev_b32 v124, 16, v126
    v_mul_f32 v122, v114, v122
    v_and_b32 v125, 0xffff0000, v126
    v_add_u32 v123, v123, v123
    v_mul_f32 v124, v122, v124
    v_mul_f32 v125, v122, v125
    v_cmpx_le_u32 vcc, 0x1000000, v51
    ds_add_f32 v123, v124 offset:54272
    ds_add_f32 v123, v125 offset:54276
    s_mov_b64 exec, -1
    v_ashrrev_i32 v122, 5, v52
    v_lshlrev_b16 v123, 2, v52
    v_cndmask_b32 v126, v8, v9, s[66:67]
    v_bitop3_b32 v122, v122, v113, v113 bitop3:0x0c
    v_lshlrev_b32 v124, 16, v126
    v_mul_f32 v122, v114, v122
    v_and_b32 v125, 0xffff0000, v126
    v_add_u32 v123, v123, v123
    v_mul_f32 v124, v122, v124
    v_mul_f32 v125, v122, v125
    v_cmpx_le_u32 vcc, 0x1000000, v52
    ds_add_f32 v123, v124 offset:54272
    ds_add_f32 v123, v125 offset:54276
    s_mov_b64 exec, -1
    v_ashrrev_i32 v122, 5, v53
    v_lshlrev_b16 v123, 2, v53
    v_cndmask_b32 v126, v10, v11, s[66:67]
    v_bitop3_b32 v122, v122, v113, v113 bitop3:0x0c
    v_lshlrev_b32 v124, 16, v126
    v_mul_f32 v122, v114, v122
    v_and_b32 v125, 0xffff0000, v126
    v_add_u32 v123, v123, v123
    v_mul_f32 v124, v122, v124
    v_mul_f32 v125, v122, v125
    v_cmpx_le_u32 vcc, 0x1000000, v53
    ds_add_f32 v123, v124 offset:54272
    ds_add_f32 v123, v125 offset:54276
    s_mov_b64 exec, -1
    s_waitcnt lgkmcnt(15)
    v_ashrrev_i32 v122, 5, v54
    v_lshlrev_b16 v123, 2, v54
    v_cndmask_b32 v126, v12, v13, s[66:67]
    v_bitop3_b32 v122, v122, v113, v113 bitop3:0x0c
    v_lshlrev_b32 v124, 16, v126
    v_mul_f32 v122, v114, v122
    v_and_b32 v125, 0xffff0000, v126
    v_add_u32 v123, v123, v123
    v_mul_f32 v124, v122, v124
    v_mul_f32 v125, v122, v125
    v_cmpx_le_u32 vcc, 0x1000000, v54
    ds_add_f32 v123, v124 offset:54272
    ds_add_f32 v123, v125 offset:54276
    s_mov_b64 exec, -1
    v_ashrrev_i32 v122, 5, v55
    v_lshlrev_b16 v123, 2, v55
    v_cndmask_b32 v126, v14, v15, s[66:67]
    v_bitop3_b32 v122, v122, v113, v113 bitop3:0x0c
    v_lshlrev_b32 v124, 16, v126
    v_mul_f32 v122, v114, v122
    v_and_b32 v125, 0xffff0000, v126
    v_add_u32 v123, v123, v123
    v_mul_f32 v124, v122, v124
    v_mul_f32 v125, v122, v125
    v_cmpx_le_u32 vcc, 0x1000000, v55
    ds_add_f32 v123, v124 offset:54272
    ds_add_f32 v123, v125 offset:54276
    s_mov_b64 exec, -1
    v_ashrrev_i32 v122, 5, v56
    v_lshlrev_b16 v123, 2, v56
    v_cndmask_b32 v126, v16, v17, s[66:67]
    v_bitop3_b32 v122, v122, v113, v113 bitop3:0x0c
    v_lshlrev_b32 v124, 16, v126
    v_mul_f32 v122, v114, v122
    v_and_b32 v125, 0xffff0000, v126
    v_add_u32 v123, v123, v123
    v_mul_f32 v124, v122, v124
    v_mul_f32 v125, v122, v125
    v_cmpx_le_u32 vcc, 0x1000000, v56
    ds_add_f32 v123, v124 offset:54272
    ds_add_f32 v123, v125 offset:54276
    s_mov_b64 exec, -1
    s_cmp_lt_u32 s15, 8
    s_cbranch_scc1 p2_nad1
    s_waitcnt lgkmcnt(15)
    v_ashrrev_i32 v122, 5, v57
    v_lshlrev_b16 v123, 2, v57
    v_cndmask_b32 v126, v18, v19, s[66:67]
    v_bitop3_b32 v122, v122, v113, v113 bitop3:0x0c
    v_lshlrev_b32 v124, 16, v126
    v_mul_f32 v122, v114, v122
    v_and_b32 v125, 0xffff0000, v126
    v_add_u32 v123, v123, v123
    v_mul_f32 v124, v122, v124
    v_mul_f32 v125, v122, v125
    v_cmpx_le_u32 vcc, 0x1000000, v57
    ds_add_f32 v123, v124 offset:54272
    ds_add_f32 v123, v125 offset:54276
    s_mov_b64 exec, -1
    v_ashrrev_i32 v122, 5, v58
    v_lshlrev_b16 v123, 2, v58
    v_cndmask_b32 v126, v20, v21, s[66:67]
    v_bitop3_b32 v122, v122, v113, v113 bitop3:0x0c
    v_lshlrev_b32 v124, 16, v126
    v_mul_f32 v122, v114, v122
    v_and_b32 v125, 0xffff0000, v126
    v_add_u32 v123, v123, v123
    v_mul_f32 v124, v122, v124
    v_mul_f32 v125, v122, v125
    v_cmpx_le_u32 vcc, 0x1000000, v58
    ds_add_f32 v123, v124 offset:54272
    ds_add_f32 v123, v125 offset:54276
    s_mov_b64 exec, -1
    v_ashrrev_i32 v122, 5, v59
    v_lshlrev_b16 v123, 2, v59
    v_cndmask_b32 v126, v22, v23, s[66:67]
    v_bitop3_b32 v122, v122, v113, v113 bitop3:0x0c
    v_lshlrev_b32 v124, 16, v126
    v_mul_f32 v122, v114, v122
    v_and_b32 v125, 0xffff0000, v126
    v_add_u32 v123, v123, v123
    v_mul_f32 v124, v122, v124
    v_mul_f32 v125, v122, v125
    v_cmpx_le_u32 vcc, 0x1000000, v59
    ds_add_f32 v123, v124 offset:54272
    ds_add_f32 v123, v125 offset:54276
    s_mov_b64 exec, -1
p2_nad1:
    s_waitcnt lgkmcnt(15)
    v_ashrrev_i32 v122, 5, v60
    v_lshlrev_b16 v123, 2, v60
    v_cndmask_b32 v126, v24, v25, s[66:67]
    v_bitop3_b32 v122, v122, v113, v113 bitop3:0x0c
    v_lshlrev_b32 v124, 16, v126
    v_mul_f32 v122, v114, v122
    v_and_b32 v125, 0xffff0000, v126
    v_add_u32 v123, v123, v123
    v_mul_f32 v124, v122, v124
    v_mul_f32 v125, v122, v125
    v_cmpx_le_u32 vcc, 0x1000000, v60
    ds_add_f32 v123, v124 offset:54272
    ds_add_f32 v123, v125 offset:54276
    s_mov_b64 exec, -1
    v_ashrrev_i32 v122, 5, v61
    v_lshlrev_b16 v123, 2, v61
    v_cndmask_b32 v126, v26, v27, s[66:67]
    v_bitop3_b32 v122, v122, v113, v113 bitop3:0x0c
    v_lshlrev_b32 v124, 16, v126
    v_mul_f32 v122, v114, v122
    v_and_b32 v125, 0xffff0000, v126
    v_add_u32 v123, v123, v123
    v_mul_f32 v124, v122, v124
    v_mul_f32 v125, v122, v125
    v_cmpx_le_u32 vcc, 0x1000000, v61
    ds_add_f32 v123, v124 offset:54272
    ds_add_f32 v123, v125 offset:54276
    s_mov_b64 exec, -1
    v_ashrrev_i32 v122, 5, v62
    v_lshlrev_b16 v123, 2, v62
    v_cndmask_b32 v126, v28, v29, s[66:67]
    v_bitop3_b32 v122, v122, v113, v113 bitop3:0x0c
    v_lshlrev_b32 v124, 16, v126
    v_mul_f32 v122, v114, v122
    v_and_b32 v125, 0xffff0000, v126
    v_add_u32 v123, v123, v123
    v_mul_f32 v124, v122, v124
    v_mul_f32 v125, v122, v125
    v_cmpx_le_u32 vcc, 0x1000000, v62
    ds_add_f32 v123, v124 offset:54272
    ds_add_f32 v123, v125 offset:54276
    s_mov_b64 exec, -1
    s_waitcnt lgkmcnt(15)
    v_ashrrev_i32 v122, 5, v63
    v_lshlrev_b16 v123, 2, v63
    v_cndmask_b32 v126, v30, v31, s[66:67]
    v_bitop3_b32 v122, v122, v113, v113 bitop3:0x0c
    v_lshlrev_b32 v124, 16, v126
    v_mul_f32 v122, v114, v122
    v_and_b32 v125, 0xffff0000, v126
    v_add_u32 v123, v123, v123
    v_mul_f32 v124, v122, v124
    v_mul_f32 v125, v122, v125
    v_cmpx_le_u32 vcc, 0x1000000, v63
    ds_add_f32 v123, v124 offset:54272
    ds_add_f32 v123, v125 offset:54276
    s_mov_b64 exec, -1
    v_ashrrev_i32 v122, 5, v64
    v_lshlrev_b16 v123, 2, v64
    v_cndmask_b32 v126, v32, v33, s[66:67]
    v_bitop3_b32 v122, v122, v113, v113 bitop3:0x0c
    v_lshlrev_b32 v124, 16, v126
    v_mul_f32 v122, v114, v122
    v_and_b32 v125, 0xffff0000, v126
    v_add_u32 v123, v123, v123
    v_mul_f32 v124, v122, v124
    v_mul_f32 v125, v122, v125
    v_cmpx_le_u32 vcc, 0x1000000, v64
    ds_add_f32 v123, v124 offset:54272
    ds_add_f32 v123, v125 offset:54276
    s_mov_b64 exec, -1
    v_ashrrev_i32 v122, 5, v65
    v_lshlrev_b16 v123, 2, v65
    v_cndmask_b32 v126, v34, v35, s[66:67]
    v_bitop3_b32 v122, v122, v113, v113 bitop3:0x0c
    v_lshlrev_b32 v124, 16, v126
    v_mul_f32 v122, v114, v122
    v_and_b32 v125, 0xffff0000, v126
    v_add_u32 v123, v123, v123
    v_mul_f32 v124, v122, v124
    v_mul_f32 v125, v122, v125
    v_cmpx_le_u32 vcc, 0x1000000, v65
    ds_add_f32 v123, v124 offset:54272
    ds_add_f32 v123, v125 offset:54276
    s_mov_b64 exec, -1
    s_waitcnt lgkmcnt(15)
    v_ashrrev_i32 v122, 5, v66
    v_lshlrev_b16 v123, 2, v66
    v_cndmask_b32 v126, v36, v37, s[66:67]
    v_bitop3_b32 v122, v122, v113, v113 bitop3:0x0c
    v_lshlrev_b32 v124, 16, v126
    v_mul_f32 v122, v114, v122
    v_and_b32 v125, 0xffff0000, v126
    v_add_u32 v123, v123, v123
    v_mul_f32 v124, v122, v124
    v_mul_f32 v125, v122, v125
    v_cmpx_le_u32 vcc, 0x1000000, v66
    ds_add_f32 v123, v124 offset:54272
    ds_add_f32 v123, v125 offset:54276
    s_mov_b64 exec, -1
    v_ashrrev_i32 v122, 5, v67
    v_lshlrev_b16 v123, 2, v67
    v_cndmask_b32 v126, v38, v39, s[66:67]
    v_bitop3_b32 v122, v122, v113, v113 bitop3:0x0c
    v_lshlrev_b32 v124, 16, v126
    v_mul_f32 v122, v114, v122
    v_and_b32 v125, 0xffff0000, v126
    v_add_u32 v123, v123, v123
    v_mul_f32 v124, v122, v124
    v_mul_f32 v125, v122, v125
    v_cmpx_le_u32 vcc, 0x1000000, v67
    ds_add_f32 v123, v124 offset:54272
    ds_add_f32 v123, v125 offset:54276
    s_mov_b64 exec, -1
    v_ashrrev_i32 v122, 5, v68
    v_lshlrev_b16 v123, 2, v68
    v_cndmask_b32 v126, v40, v41, s[66:67]
    v_bitop3_b32 v122, v122, v113, v113 bitop3:0x0c
    v_lshlrev_b32 v124, 16, v126
    v_mul_f32 v122, v114, v122
    v_and_b32 v125, 0xffff0000, v126
    v_add_u32 v123, v123, v123
    v_mul_f32 v124, v122, v124
    v_mul_f32 v125, v122, v125
    v_cmpx_le_u32 vcc, 0x1000000, v68
    ds_add_f32 v123, v124 offset:54272
    ds_add_f32 v123, v125 offset:54276
    s_mov_b64 exec, -1
    s_waitcnt lgkmcnt(15)
    v_ashrrev_i32 v122, 5, v69
    v_lshlrev_b16 v123, 2, v69
    v_cndmask_b32 v126, v42, v43, s[66:67]
    v_bitop3_b32 v122, v122, v113, v113 bitop3:0x0c
    v_lshlrev_b32 v124, 16, v126
    v_mul_f32 v122, v114, v122
    v_and_b32 v125, 0xffff0000, v126
    v_add_u32 v123, v123, v123
    v_mul_f32 v124, v122, v124
    v_mul_f32 v125, v122, v125
    v_cmpx_le_u32 vcc, 0x1000000, v69
    ds_add_f32 v123, v124 offset:54272
    ds_add_f32 v123, v125 offset:54276
    s_mov_b64 exec, -1
    v_ashrrev_i32 v122, 5, v70
    v_lshlrev_b16 v123, 2, v70
    v_cndmask_b32 v126, v44, v45, s[66:67]
    v_bitop3_b32 v122, v122, v113, v113 bitop3:0x0c
    v_lshlrev_b32 v124, 16, v126
    v_mul_f32 v122, v114, v122
    v_and_b32 v125, 0xffff0000, v126
    v_add_u32 v123, v123, v123
    v_mul_f32 v124, v122, v124
    v_mul_f32 v125, v122, v125
    v_cmpx_le_u32 vcc, 0x1000000, v70
    ds_add_f32 v123, v124 offset:54272
    ds_add_f32 v123, v125 offset:54276
    s_mov_b64 exec, -1
    v_ashrrev_i32 v122, 5, v71
    v_lshlrev_b16 v123, 2, v71
    v_cndmask_b32 v126, v46, v47, s[66:67]
    v_bitop3_b32 v122, v122, v113, v113 bitop3:0x0c
    v_lshlrev_b32 v124, 16, v126
    v_mul_f32 v122, v114, v122
    v_and_b32 v125, 0xffff0000, v126
    v_add_u32 v123, v123, v123
    v_mul_f32 v124, v122, v124
    v_mul_f32 v125, v122, v125
    v_cmpx_le_u32 vcc, 0x1000000, v71
    ds_add_f32 v123, v124 offset:54272
    ds_add_f32 v123, v125 offset:54276
    s_mov_b64 exec, -1
    s_branch p2_fin
p2_tail:
    s_mov_b32 s60, s61
    s_mov_b32 s15, s16
    s_mov_b32 s16, s17
    v_mov_b32 v122, s19
    s_xor_b32 s19, s19, 4
    ds_read_b32 v125, v122 offset:53760
    v_mov_b32 v123, s19
    v_mov_b32 v124, 0
    ds_write_b32 v123, v124 offset:53760
    s_waitcnt vmcnt(2)
    s_mov_b32 m0, s24
    s_cmp_ge_u32 s10, 9
    s_cbranch_scc1 p2_st2s1
    ds_write_addtid_b32 v84 offset:49152
    ds_write_addtid_b32 v85 offset:49408
p2_st2s1:
    s_mov_b32 m0, s23
    s_add_u32 s20, s20, 53760
    ds_write_addtid_b32 v72 offset:0
    ds_write_addtid_b32 v73 offset:256
    ds_write_addtid_b32 v74 offset:512
    ds_write_addtid_b32 v75 offset:768
    ds_write_addtid_b32 v76 offset:1024
    ds_write_addtid_b32 v77 offset:1280
    ds_write_addtid_b32 v78 offset:1536
    ds_write_addtid_b32 v79 offset:1792
    ds_write_addtid_b32 v80 offset:2048
    ds_write_addtid_b32 v81 offset:2304
    ds_write_addtid_b32 v82 offset:2560
    ds_write_addtid_b32 v83 offset:2816
    s_cmp_ge_u32 s10, 9
    s_cbranch_scc1 p2_nm2m2a
    v_lshrrev_b32 v84, 1, v112
    s_add_u32 s44, s20, s42
    buffer_load_dwordx2 v[84:85], v84, s[4:7], s44 offen
p2_nm2m2a:
    buffer_load_dwordx4 v[72:75], v112, s[4:7], s20 offen offset:0
    buffer_load_dwordx4 v[76:79], v112, s[4:7], s20 offen offset:1024
    buffer_load_dwordx4 v[80:83], v112, s[4:7], s20 offen offset:2048
    s_waitcnt lgkmcnt(0)
    s_barrier
    s_setprio 3
    v_cmpx_lt_i16 vcc, 0x3fff, v48
    ds_read_b64 v[0:1], v0
    s_mov_b64 exec, -1
    v_cmpx_lt_i16 vcc, 0x3fff, v49
    ds_read_b64 v[2:3], v2
    s_mov_b64 exec, -1
    v_cmpx_lt_i16 vcc, 0x3fff, v50
    ds_read_b64 v[4:5], v4
    s_mov_b64 exec, -1
    v_cmpx_lt_i16 vcc, 0x3fff, v51
    ds_read_b64 v[6:7], v6
    s_mov_b64 exec, -1
    v_cmpx_lt_i16 vcc, 0x3fff, v52
    ds_read_b64 v[8:9], v8
    s_mov_b64 exec, -1
    v_cmpx_lt_i16 vcc, 0x3fff, v53
    ds_read_b64 v[10:11], v10
    s_mov_b64 exec, -1
    s_waitcnt lgkmcnt(15)
    s_nop 1
    v_readfirstlane_b32 s44, v125
    s_nop 0
    s_cmp_lg_u32 s44, 0
    s_cbranch_scc1 p2_advb
    s_add_u32 s61, s61, 1
    s_min_u32 s61, s61, 10
    v_mov_b32 v110, 0
    v_mov_b32 v111, 0
    s_cmp_eq_u32 s61, 10
    s_cbranch_scc1 p2_advb
    s_add_u32 s44, s61, s18
    s_cmp_ge_u32 s44, 10
    s_cselect_b32 s53, 10, 0
    s_sub_u32 s44, s44, s53
    s_mul_i32 s44, s44, 4160
    s_add_u32 s44, s44, s40
    v_bfe_i32 v111, v112, 6, 1
    v_lshrrev_b32 v110, 6, v112
    v_bitop3_b32 v111, v111, 15, s10 bitop3:0x6a
    v_lshl_or_b32 v110, v110, 4, v111
    v_add_u32 v111, 72, v110
    v_and_b32 v111, 0x100, v111
    v_lshl_or_b32 v110, v111, 7, v110
    v_bfe_u32 v111, v112, 2, 4
    v_mul_u32_u24 v110, 41600, v110
    v_add_u32 v111, v110, v111
    buffer_load_dword v110, v111, s[4:7], s44 offen
    buffer_load_dword v111, v111, s[4:7], s44 offen offset:16
p2_advb:
    s_cmp_lg_u32 s10, 15
    s_cbranch_scc1 p2_ntg
    s_lshr_b32 s44, s2, 3
    s_mul_i32 s44, s44, 5120
    s_add_u32 s45, s60, s18
    s_cmp_ge_u32 s45, 10
    s_cselect_b32 s53, 10, 0
    s_sub_u32 s45, s45, s53
    s_mul_i32 s45, s45, 645120
    s_add_u32 s44, s44, s45
    s_add_u32 s44, s44, s62
    s_sub_u32 s44, s44, s23
    v_lshlrev_b32 v84, 3, v112
    s_mov_b32 exec_hi, 0xff
    buffer_load_dword v85, v84, s[4:7], s44 offen
    s_mov_b64 exec, -1
p2_ntg:
    v_cmpx_lt_i16 vcc, 0x3fff, v54
    ds_read_b64 v[12:13], v12
    s_mov_b64 exec, -1
    v_cmpx_lt_i16 vcc, 0x3fff, v55
    ds_read_b64 v[14:15], v14
    s_mov_b64 exec, -1
    v_cmpx_lt_i16 vcc, 0x3fff, v56
    ds_read_b64 v[16:17], v16
    s_mov_b64 exec, -1
    s_cmp_lt_u32 s15, 8
    s_cbranch_scc1 p2_g2r13
    v_cmpx_lt_i16 vcc, 0x3fff, v57
    ds_read_b64 v[18:19], v18
    s_mov_b64 exec, -1
    v_cmpx_lt_i16 vcc, 0x3fff, v58
    ds_read_b64 v[20:21], v20
    s_mov_b64 exec, -1
    v_cmpx_lt_i16 vcc, 0x3fff, v59
    ds_read_b64 v[22:23], v22
    s_mov_b64 exec, -1
p2_g2r13:
    v_bfe_u32 v98, v109, 14, 4
    v_lshrrev_b32 v99, 18, v109
    v_and_b32 v109, 16383, v109
    v_mad_u32_u24 v98, v98, s63, v99
    v_mad_u32_u24 v109, v98, s65, v109
    buffer_load_dwordx4 v[98:101], v109, s[68:71], 0 offen
    s_setprio 1
    v_cmpx_lt_i16 vcc, 0x3fff, v60
    ds_read_b64 v[24:25], v24
    s_mov_b64 exec, -1
    v_cmpx_lt_i16 vcc, 0x3fff, v61
    ds_read_b64 v[26:27], v26
    s_mov_b64 exec, -1
    v_cmpx_lt_i16 vcc, 0x3fff, v62
    ds_read_b64 v[28:29], v28
    s_mov_b64 exec, -1
    v_cmpx_lt_i16 vcc, 0x3fff, v63
    ds_read_b64 v[30:31], v30
    s_mov_b64 exec, -1
    v_cmpx_lt_i16 vcc, 0x3fff, v64
    ds_read_b64 v[32:33], v32
    s_mov_b64 exec, -1
    v_cmpx_lt_i16 vcc, 0x3fff, v65
    ds_read_b64 v[34:35], v34
    s_mov_b64 exec, -1
    s_nop 2
    s_nop 1
    v_max_u32_dpp v102, v102, v102 row_shr:1 row_mask:0xf bank_mask:0xf bound_ctrl:0
    v_max_u32_dpp v103, v103, v103 row_shr:1 row_mask:0xf bank_mask:0xf bound_ctrl:0
    s_nop 0
    v_max_u32_dpp v102, v102, v102 row_shr:2 row_mask:0xf bank_mask:0xf bound_ctrl:0
    v_max_u32_dpp v103, v103, v103 row_shr:2 row_mask:0xf bank_mask:0xf bound_ctrl:0
    s_nop 0
    v_max_u32_dpp v102, v102, v102 row_shr:4 row_mask:0xf bank_mask:0xf bound_ctrl:0
    v_max_u32_dpp v103, v103, v103 row_shr:4 row_mask:0xf bank_mask:0xf bound_ctrl:0
    s_nop 0
    v_max_u32_dpp v102, v102, v102 row_shr:8 row_mask:0xf bank_mask:0xf bound_ctrl:0
    v_max_u32_dpp v103, v103, v103 row_shr:8 row_mask:0xf bank_mask:0xf bound_ctrl:0
    s_nop 0
    v_max_u32_dpp v102, v102, v102 row_bcast:15 row_mask:0xa bank_mask:0xf
    v_max_u32_dpp v103, v103, v103 row_bcast:15 row_mask:0xa bank_mask:0xf
    s_nop 0
    v_max_u32_dpp v102, v102, v102 row_bcast:31 row_mask:0xc bank_mask:0xf
    v_max_u32_dpp v103, v103, v103 row_bcast:31 row_mask:0xc bank_mask:0xf
    s_nop 0
    s_nop 0
    v_max_u32 v102, s41, v102
    s_nop 0
    v_readlane_b32 s41, v102, 63
    v_add_u32 v102, v102, v112
    v_add_u32 v102, 4294963200, v102
    v_max_u32 v103, s41, v103
    s_nop 0
    v_readlane_b32 s41, v103, 63
    v_add_u32 v103, v103, v112
    v_add_u32 v103, 4294964224, v103
    v_cmpx_lt_i16 vcc, 0x3fff, v66
    ds_read_b64 v[36:37], v36
    s_mov_b64 exec, -1
    v_cmpx_lt_i16 vcc, 0x3fff, v67
    ds_read_b64 v[38:39], v38
    s_mov_b64 exec, -1
    v_cmpx_lt_i16 vcc, 0x3fff, v68
    ds_read_b64 v[40:41], v40
    s_mov_b64 exec, -1
    v_cmpx_lt_i16 vcc, 0x3fff, v69
    ds_read_b64 v[42:43], v42
    s_mov_b64 exec, -1
    v_cmpx_lt_i16 vcc, 0x3fff, v70
    ds_read_b64 v[44:45], v44
    s_mov_b64 exec, -1
    v_cmpx_lt_i16 vcc, 0x3fff, v71
    ds_read_b64 v[46:47], v46
    s_mov_b64 exec, -1
    s_waitcnt lgkmcnt(0)
    s_barrier
    s_waitcnt vmcnt(1)
    s_mov_b32 m0, s24
    s_cmp_ge_u32 s10, 9
    s_cbranch_scc1 p2_st2s2
    ds_write_addtid_b32 v84 offset:49152
    ds_write_addtid_b32 v85 offset:49408
p2_st2s2:
    s_mov_b32 m0, s23
    s_add_u32 s20, s60, s18
    s_cmp_ge_u32 s20, 10
    s_cselect_b32 s53, 10, 0
    s_sub_u32 s20, s20, s53
    s_mul_i32 s20, s20, 645120
    s_add_u32 s20, s20, s62
    ds_write_addtid_b32 v72 offset:0
    ds_write_addtid_b32 v73 offset:256
    ds_write_addtid_b32 v74 offset:512
    ds_write_addtid_b32 v75 offset:768
    ds_write_addtid_b32 v76 offset:1024
    ds_write_addtid_b32 v77 offset:1280
    ds_write_addtid_b32 v78 offset:1536
    ds_write_addtid_b32 v79 offset:1792
    ds_write_addtid_b32 v80 offset:2048
    ds_write_addtid_b32 v81 offset:2304
    ds_write_addtid_b32 v82 offset:2560
    ds_write_addtid_b32 v83 offset:2816
    s_nop 2
    s_nop 1
    v_max_u32_dpp v104, v104, v104 row_shr:1 row_mask:0xf bank_mask:0xf bound_ctrl:0
    v_max_u32_dpp v105, v105, v105 row_shr:1 row_mask:0xf bank_mask:0xf bound_ctrl:0
    s_nop 0
    v_max_u32_dpp v104, v104, v104 row_shr:2 row_mask:0xf bank_mask:0xf bound_ctrl:0
    v_max_u32_dpp v105, v105, v105 row_shr:2 row_mask:0xf bank_mask:0xf bound_ctrl:0
    s_nop 0
    v_max_u32_dpp v104, v104, v104 row_shr:4 row_mask:0xf bank_mask:0xf bound_ctrl:0
    v_max_u32_dpp v105, v105, v105 row_shr:4 row_mask:0xf bank_mask:0xf bound_ctrl:0
    s_nop 0
    v_max_u32_dpp v104, v104, v104 row_shr:8 row_mask:0xf bank_mask:0xf bound_ctrl:0
    v_max_u32_dpp v105, v105, v105 row_shr:8 row_mask:0xf bank_mask:0xf bound_ctrl:0
    s_nop 0
    v_max_u32_dpp v104, v104, v104 row_bcast:15 row_mask:0xa bank_mask:0xf
    v_max_u32_dpp v105, v105, v105 row_bcast:15 row_mask:0xa bank_mask:0xf
    s_nop 0
    v_max_u32_dpp v104, v104, v104 row_bcast:31 row_mask:0xc bank_mask:0xf
    v_max_u32_dpp v105, v105, v105 row_bcast:31 row_mask:0xc bank_mask:0xf
    s_nop 0
    s_nop 0
    v_max_u32 v104, s41, v104
    s_nop 0
    v_readlane_b32 s41, v104, 63
    v_add_u32 v104, v104, v112
    v_add_u32 v104, 4294965248, v104
    v_max_u32 v105, s41, v105
    s_nop 0
    v_readlane_b32 s41, v105, 63
    v_add_u32 v105, v105, v112
    v_add_u32 v105, 4294966272, v105
    s_waitcnt lgkmcnt(0)
    s_barrier
    s_branch p2_top
p2_fin:
    s_waitcnt vmcnt(0) lgkmcnt(0)
    s_barrier
    s_mov_b32 s48, s11
    s_mul_i32 s44, s48, 800768
    s_mul_i32 s45, s12, 12512
    s_add_u32 s49, s44, s45
    s_lshl_b32 s44, s49, 3
    s_add_u32 s44, s44, 491593728
    s_lshl_b32 s48, s48, 2
    s_lshl_b32 s45, s12, 4
    s_add_u32 s48, s48, s45
    s_add_u32 s48, s48, 491592704
    v_add_u32 v123, s64, v112
    v_add_u32 v122, s25, v123
    v_mov_b32 v24, 0
    v_mov_b32 v25, 0
    v_mov_b32 v26, 0
    v_mov_b32 v27, 0
    v_cmp_gt_u32 vcc, 1792, v123
    v_mov_b32 v124, 0x38000000
    v_mov_b32 v126, 0
    v_cndmask_b32 v124, v124, v123, vcc
    ds_read_b128 v[0:3], v122 offset:0
    ds_read_b128 v[4:7], v122 offset:16384
    ds_read_b128 v[8:11], v122 offset:32768
    v_add_u32 v122, 49152, v122
    ds_read_b128 v[12:15], v122 offset:0
    ds_read_b128 v[16:19], v122 offset:16384
    ds_read_b128 v[20:23], v122 offset:32768
    s_mov_b64 exec, vcc
    ds_read_b128 v[24:27], v122 offset:49152
    s_mov_b64 exec, -1
    s_cmp_lg_u32 s21, 0
    s_cbranch_scc1 p2_finf
    s_waitcnt lgkmcnt(6)
    buffer_store_dwordx4 v[0:3], v123, s[4:7], s44 offen nt
    s_add_u32 s44, s44, 16384
    s_waitcnt lgkmcnt(5)
    buffer_store_dwordx4 v[4:7], v123, s[4:7], s44 offen nt
    s_add_u32 s44, s44, 16384
    s_waitcnt lgkmcnt(4)
    buffer_store_dwordx4 v[8:11], v123, s[4:7], s44 offen nt
    s_add_u32 s44, s44, 16384
    s_waitcnt lgkmcnt(3)
    buffer_store_dwordx4 v[12:15], v123, s[4:7], s44 offen nt
    s_add_u32 s44, s44, 16384
    s_waitcnt lgkmcnt(2)
    buffer_store_dwordx4 v[16:19], v123, s[4:7], s44 offen nt
    s_add_u32 s44, s44, 16384
    s_waitcnt lgkmcnt(1)
    buffer_store_dwordx4 v[20:23], v123, s[4:7], s44 offen nt
    s_add_u32 s44, s44, 16384
    s_waitcnt lgkmcnt(0)
    buffer_store_dwordx4 v[24:27], v124, s[4:7], s44 offen nt
    s_add_u32 s44, s44, 16384
    v_bitop3_b32 v115, v115, v0, v1 bitop3:0xfe
    v_bitop3_b32 v115, v115, v2, v3 bitop3:0xfe
    v_bitop3_b32 v115, v115, v4, v5 bitop3:0xfe
    v_bitop3_b32 v115, v115, v6, v7 bitop3:0xfe
    v_bitop3_b32 v115, v115, v8, v9 bitop3:0xfe
    v_bitop3_b32 v115, v115, v10, v11 bitop3:0xfe
    v_bitop3_b32 v115, v115, v12, v13 bitop3:0xfe
    v_bitop3_b32 v115, v115, v14, v15 bitop3:0xfe
    v_bitop3_b32 v115, v115, v16, v17 bitop3:0xfe
    v_bitop3_b32 v115, v115, v18, v19 bitop3:0xfe
    v_bitop3_b32 v115, v115, v20, v21 bitop3:0xfe
    v_bitop3_b32 v115, v115, v22, v23 bitop3:0xfe
    v_bitop3_b32 v115, v115, v24, v25 bitop3:0xfe
    v_bitop3_b32 v115, v115, v26, v27 bitop3:0xfe
    v_bitop3_b32 v115, v115, v116, v117 bitop3:0xfe
    v_bitop3_b32 v115, v115, v118, v119 bitop3:0xfe
    v_bitop3_b32 v115, v115, v120, v121 bitop3:0xfe
    v_mov_b32 v28, 0
    v_mov_b32 v29, 0
    v_lshrrev_b32 v30, 1, v0
    v_bitop3_b32 v28, v28, v0, v30 bitop3:0xf6
    v_lshrrev_b32 v31, 1, v1
    v_bitop3_b32 v29, v29, v1, v31 bitop3:0xf6
    v_lshrrev_b32 v30, 1, v2
    v_bitop3_b32 v28, v28, v2, v30 bitop3:0xf6
    v_lshrrev_b32 v31, 1, v3
    v_bitop3_b32 v29, v29, v3, v31 bitop3:0xf6
    v_lshrrev_b32 v30, 1, v4
    v_bitop3_b32 v28, v28, v4, v30 bitop3:0xf6
    v_lshrrev_b32 v31, 1, v5
    v_bitop3_b32 v29, v29, v5, v31 bitop3:0xf6
    v_lshrrev_b32 v30, 1, v6
    v_bitop3_b32 v28, v28, v6, v30 bitop3:0xf6
    v_lshrrev_b32 v31, 1, v7
    v_bitop3_b32 v29, v29, v7, v31 bitop3:0xf6
    v_lshrrev_b32 v30, 1, v8
    v_bitop3_b32 v28, v28, v8, v30 bitop3:0xf6
    v_lshrrev_b32 v31, 1, v9
    v_bitop3_b32 v29, v29, v9, v31 bitop3:0xf6
    v_lshrrev_b32 v30, 1, v10
    v_bitop3_b32 v28, v28, v10, v30 bitop3:0xf6
    v_lshrrev_b32 v31, 1, v11
    v_bitop3_b32 v29, v29, v11, v31 bitop3:0xf6
    v_lshrrev_b32 v30, 1, v12
    v_bitop3_b32 v28, v28, v12, v30 bitop3:0xf6
    v_lshrrev_b32 v31, 1, v13
    v_bitop3_b32 v29, v29, v13, v31 bitop3:0xf6
    v_lshrrev_b32 v30, 1, v14
    v_bitop3_b32 v28, v28, v14, v30 bitop3:0xf6
    v_lshrrev_b32 v31, 1, v15
    v_bitop3_b32 v29, v29, v15, v31 bitop3:0xf6
    v_lshrrev_b32 v30, 1, v16
    v_bitop3_b32 v28, v28, v16, v30 bitop3:0xf6
    v_lshrrev_b32 v31, 1, v17
    v_bitop3_b32 v29, v29, v17, v31 bitop3:0xf6
    v_lshrrev_b32 v30, 1, v18
    v_bitop3_b32 v28, v28, v18, v30 bitop3:0xf6
    v_lshrrev_b32 v31, 1, v19
    v_bitop3_b32 v29, v29, v19, v31 bitop3:0xf6
    v_lshrrev_b32 v30, 1, v20
    v_bitop3_b32 v28, v28, v20, v30 bitop3:0xf6
    v_lshrrev_b32 v31, 1, v21
    v_bitop3_b32 v29, v29, v21, v31 bitop3:0xf6
    v_lshrrev_b32 v30, 1, v22
    v_bitop3_b32 v28, v28, v22, v30 bitop3:0xf6
    v_lshrrev_b32 v31, 1, v23
    v_bitop3_b32 v29, v29, v23, v31 bitop3:0xf6
    v_lshrrev_b32 v30, 1, v24
    v_bitop3_b32 v28, v28, v24, v30 bitop3:0xf6
    v_lshrrev_b32 v31, 1, v25
    v_bitop3_b32 v29, v29, v25, v31 bitop3:0xf6
    v_lshrrev_b32 v30, 1, v26
    v_bitop3_b32 v28, v28, v26, v30 bitop3:0xf6
    v_lshrrev_b32 v31, 1, v27
    v_bitop3_b32 v29, v29, v27, v31 bitop3:0xf6
    s_mov_b32 s45, 0
    v_and_b32 v30, 7168, v28
    v_cmp_ne_u32 vcc, 0, v30
    s_nop 0
    s_cmp_lg_u64 vcc, 0
    s_cselect_b32 s46, 1, 0
    s_or_b32 s45, s45, s46
    v_and_b32 v30, 469762048, v28
    v_cmp_ne_u32 vcc, 0, v30
    s_nop 0
    s_cmp_lg_u64 vcc, 0
    s_cselect_b32 s46, 2, 0
    s_or_b32 s45, s45, s46
    v_and_b32 v30, 7168, v29
    v_cmp_ne_u32 vcc, 0, v30
    s_nop 0
    s_cmp_lg_u64 vcc, 0
    s_cselect_b32 s46, 4, 0
    s_or_b32 s45, s45, s46
    v_and_b32 v30, 469762048, v29
    v_cmp_ne_u32 vcc, 0, v30
    s_nop 0
    s_cmp_lg_u64 vcc, 0
    s_cselect_b32 s46, 8, 0
    s_or_b32 s45, s45, s46
    v_and_b32 v30, 2147516416, v115
    v_cmp_ne_u32 vcc, 0, v30
    s_nop 0
    s_cmp_lg_u64 vcc, 0
    s_cselect_b32 s46, 16, 0
    s_or_b32 s45, s45, s46
    v_mov_b32 v30, s45
    s_mov_b64 exec, 1
    ds_or_b32 v126, v30 offset:53768
    s_mov_b64 exec, -1
    s_waitcnt lgkmcnt(0)
    s_barrier
    ds_read_b32 v125, v126 offset:53768
    s_waitcnt lgkmcnt(0)
    v_readfirstlane_b32 s45, v125
    s_nop 0
    s_cmp_eq_u32 s45, 15
    s_cbranch_scc1 p2_done
    s_mov_b32 s21, 1
    s_waitcnt vmcnt(0)
    s_branch p2_restart
p2_finf:
    s_lshl_b32 s49, s49, 4
    s_lshl_b32 s45, s21, 3
    s_add_u32 s49, s49, s45
    s_add_u32 s49, s49, 517218296
    v_mov_b32 v28, 1073758208
    v_mov_b32 v29, 1073758208
    v_mov_b32 v30, 1073758208
    v_mov_b32 v31, 1073758208
    v_lshlrev_b32 v122, 1, v123
    v_lshlrev_b32 v125, 1, v124
    s_waitcnt lgkmcnt(0)
    buffer_store_dwordx4 v[28:31], v123, s[4:7], s44 offen
    s_add_u32 s44, s44, 16384
    buffer_store_dwordx2 v[0:1], v122, s[4:7], s49 offen offset:0
    buffer_store_dwordx2 v[2:3], v122, s[4:7], s49 offen offset:16
    s_add_u32 s49, s49, 32768
    buffer_store_dwordx4 v[28:31], v123, s[4:7], s44 offen
    s_add_u32 s44, s44, 16384
    buffer_store_dwordx2 v[4:5], v122, s[4:7], s49 offen offset:0
    buffer_store_dwordx2 v[6:7], v122, s[4:7], s49 offen offset:16
    s_add_u32 s49, s49, 32768
    buffer_store_dwordx4 v[28:31], v123, s[4:7], s44 offen
    s_add_u32 s44, s44, 16384
    buffer_store_dwordx2 v[8:9], v122, s[4:7], s49 offen offset:0
    buffer_store_dwordx2 v[10:11], v122, s[4:7], s49 offen offset:16
    s_add_u32 s49, s49, 32768
    buffer_store_dwordx4 v[28:31], v123, s[4:7], s44 offen
    s_add_u32 s44, s44, 16384
    buffer_store_dwordx2 v[12:13], v122, s[4:7], s49 offen offset:0
    buffer_store_dwordx2 v[14:15], v122, s[4:7], s49 offen offset:16
    s_add_u32 s49, s49, 32768
    buffer_store_dwordx4 v[28:31], v123, s[4:7], s44 offen
    s_add_u32 s44, s44, 16384
    buffer_store_dwordx2 v[16:17], v122, s[4:7], s49 offen offset:0
    buffer_store_dwordx2 v[18:19], v122, s[4:7], s49 offen offset:16
    s_add_u32 s49, s49, 32768
    buffer_store_dwordx4 v[28:31], v123, s[4:7], s44 offen
    s_add_u32 s44, s44, 16384
    buffer_store_dwordx2 v[20:21], v122, s[4:7], s49 offen offset:0
    buffer_store_dwordx2 v[22:23], v122, s[4:7], s49 offen offset:16
    s_add_u32 s49, s49, 32768
    buffer_store_dwordx4 v[28:31], v124, s[4:7], s44 offen
    s_add_u32 s44, s44, 16384
    buffer_store_dwordx2 v[24:25], v125, s[4:7], s49 offen offset:0
    buffer_store_dwordx2 v[26:27], v125, s[4:7], s49 offen offset:16
    s_add_u32 s49, s49, 32768
    s_add_u32 s21, s21, 1
    s_mov_b32 s30, 0
    s_waitcnt vmcnt(0)
    s_cmp_eq_u32 s21, 2
    s_cbranch_scc1 p2_restart
p2_done:
    v_mov_b32 v125, s30
    buffer_store_dword v125, v126, s[4:7], s48 offen
p2_end:
    s_endpgm
.globl p3_kernel
.p2align 8
.type p3_kernel,@function
p3_kernel:
    s_cmp_ge_u32 s2, 1563
    s_cbranch_scc1 p3_end
    s_load_dwordx2 s[4:5], s[0:1], 0
    s_load_dwordx2 s[6:7], s[0:1], 24
    s_load_dwordx2 s[8:9], s[0:1], 40
    s_load_dwordx8 s[12:19], s[0:1], 56
    s_load_dwordx2 s[10:11], s[0:1], 88
    s_load_dwordx2 s[20:21], s[0:1], 104
    s_lshl_b32 s3, s2, 8
    v_add_u32 v0, s3, v0
    v_lshlrev_b32 v2, 4, v0
    v_lshlrev_b32 v3, 2, v0
    v_add_u32 v0, v0, v0
    v_mul_hi_u32_u24 v1, 343268, v0
    v_lshlrev_b16 v1, 4, v1
    s_waitcnt lgkmcnt(0)
    s_load_dwordx4 s[32:35], s[8:9], 0
    s_load_dwordx16 s[36:51], s[12:13], 0
    s_load_dwordx16 s[52:67], s[14:15], 0
    s_load_dwordx8 s[68:75], s[16:17], 0
    s_load_dwordx8 s[76:83], s[18:19], 0
    s_mov_b32 s24, s6
    s_and_b32 s25, s7, 0xffff
    s_mov_b32 s26, 1600000
    s_mov_b32 s27, 0x20000
    buffer_load_dword v4, v3, s[24:27], 0 offen nt
    s_mov_b32 s28, s20
    s_and_b32 s29, s21, 0xffff
    s_mov_b32 s30, 819200000
    s_mov_b32 s31, 0x20000
    s_mov_b32 s22, 491593728
    buffer_load_dwordx4 v[40:43], v2, s[28:31], s22 offen nt
    s_mov_b32 s22, 497999872
    buffer_load_dwordx4 v[44:47], v2, s[28:31], s22 offen nt
    s_mov_b32 s22, 504406016
    buffer_load_dwordx4 v[48:51], v2, s[28:31], s22 offen nt
    s_mov_b32 s22, 510812160
    buffer_load_dwordx4 v[52:55], v2, s[28:31], s22 offen nt
    s_mov_b32 s22, 491592704
    buffer_load_dwordx4 v[56:59], v1, s[28:31], s22 offen
    s_mov_b32 s24, s4
    s_and_b32 s25, s5, 0xffff
    s_mov_b32 s26, 6400000
    s_mov_b32 s27, 0x20000
    buffer_load_dwordx4 v[60:63], v2, s[24:27], 0 offen nt
    s_mov_b32 s24, s10
    s_and_b32 s25, s11, 0xffff
    s_mov_b32 s26, 6400000
    s_mov_b32 s27, 0x20000
    s_waitcnt vmcnt(6) lgkmcnt(0)
    v_and_b32 v5, 0xffff0000, v4
    v_lshlrev_b32 v4, 16, v4
    s_lshl_b32 s14, s32, 16
    s_and_b32 s15, s32, 0xffff0000
    v_pk_add_f32 v[8:9], v[4:5], s[14:15] op_sel:[0,0] op_sel_hi:[0,1] neg_lo:[0,1] neg_hi:[0,1]
    v_pk_add_f32 v[16:17], v[4:5], s[14:15] op_sel:[1,0] op_sel_hi:[1,1] neg_lo:[0,1] neg_hi:[0,1]
    s_lshl_b32 s16, s33, 16
    s_and_b32 s17, s33, 0xffff0000
    v_pk_add_f32 v[10:11], v[4:5], s[16:17] op_sel:[0,0] op_sel_hi:[0,1] neg_lo:[0,1] neg_hi:[0,1]
    v_pk_add_f32 v[18:19], v[4:5], s[16:17] op_sel:[1,0] op_sel_hi:[1,1] neg_lo:[0,1] neg_hi:[0,1]
    s_lshl_b32 s18, s34, 16
    s_and_b32 s19, s34, 0xffff0000
    v_pk_add_f32 v[12:13], v[4:5], s[18:19] op_sel:[0,0] op_sel_hi:[0,1] neg_lo:[0,1] neg_hi:[0,1]
    v_pk_add_f32 v[20:21], v[4:5], s[18:19] op_sel:[1,0] op_sel_hi:[1,1] neg_lo:[0,1] neg_hi:[0,1]
    s_lshl_b32 s12, s35, 16
    s_and_b32 s13, s35, 0xffff0000
    v_pk_add_f32 v[14:15], v[4:5], s[12:13] op_sel:[0,0] op_sel_hi:[0,1] neg_lo:[0,1] neg_hi:[0,1]
    v_pk_add_f32 v[22:23], v[4:5], s[12:13] op_sel:[1,0] op_sel_hi:[1,1] neg_lo:[0,1] neg_hi:[0,1]
    v_cvt_pk_bf16_f32 v8, v8, v9
    v_cvt_pk_bf16_f32 v10, v10, v11
    v_cvt_pk_bf16_f32 v12, v12, v13
    v_cvt_pk_bf16_f32 v14, v14, v15
    v_cvt_pk_bf16_f32 v16, v16, v17
    v_cvt_pk_bf16_f32 v18, v18, v19
    v_cvt_pk_bf16_f32 v20, v20, v21
    v_cvt_pk_bf16_f32 v22, v22, v23
    v_and_b32 v9, 0xffff0000, v8
    v_lshlrev_b32 v8, 16, v8
    v_and_b32 v11, 0xffff0000, v10
    v_lshlrev_b32 v10, 16, v10
    v_and_b32 v13, 0xffff0000, v12
    v_lshlrev_b32 v12, 16, v12
    v_and_b32 v15, 0xffff0000, v14
    v_lshlrev_b32 v14, 16, v14
    v_and_b32 v17, 0xffff0000, v16
    v_lshlrev_b32 v16, 16, v16
    v_and_b32 v19, 0xffff0000, v18
    v_lshlrev_b32 v18, 16, v18
    v_and_b32 v21, 0xffff0000, v20
    v_lshlrev_b32 v20, 16, v20
    v_and_b32 v23, 0xffff0000, v22
    v_lshlrev_b32 v22, 16, v22
    v_mul_f32 v8, v8, v8
    v_mul_f32 v9, v9, v9
    v_mul_f32 v10, v10, v10
    v_mul_f32 v11, v11, v11
    v_mul_f32 v12, v12, v12
    v_mul_f32 v13, v13, v13
    v_mul_f32 v14, v14, v14
    v_mul_f32 v15, v15, v15
    v_mul_f32 v16, v16, v16
    v_mul_f32 v17, v17, v17
    v_mul_f32 v18, v18, v18
    v_mul_f32 v19, v19, v19
    v_mul_f32 v20, v20, v20
    v_mul_f32 v21, v21, v21
    v_mul_f32 v22, v22, v22
    v_mul_f32 v23, v23, v23
    v_cvt_pk_bf16_f32 v8, v8, v9
    v_cvt_pk_bf16_f32 v10, v10, v11
    v_cvt_pk_bf16_f32 v12, v12, v13
    v_cvt_pk_bf16_f32 v14, v14, v15
    v_cvt_pk_bf16_f32 v16, v16, v17
    v_cvt_pk_bf16_f32 v18, v18, v19
    v_cvt_pk_bf16_f32 v20, v20, v21
    v_cvt_pk_bf16_f32 v22, v22, v23
    v_and_b32 v9, 0xffff0000, v8
    v_lshlrev_b32 v8, 16, v8
    v_and_b32 v11, 0xffff0000, v10
    v_lshlrev_b32 v10, 16, v10
    v_and_b32 v13, 0xffff0000, v12
    v_lshlrev_b32 v12, 16, v12
    v_and_b32 v15, 0xffff0000, v14
    v_lshlrev_b32 v14, 16, v14
    v_and_b32 v17, 0xffff0000, v16
    v_lshlrev_b32 v16, 16, v16
    v_and_b32 v19, 0xffff0000, v18
    v_lshlrev_b32 v18, 16, v18
    v_and_b32 v21, 0xffff0000, v20
    v_lshlrev_b32 v20, 16, v20
    v_and_b32 v23, 0xffff0000, v22
    v_lshlrev_b32 v22, 16, v22
    v_mul_f32 v8, 0xc1200000, v8
    v_mul_f32 v9, 0xc1200000, v9
    v_mul_f32 v10, 0xc1200000, v10
    v_mul_f32 v11, 0xc1200000, v11
    v_mul_f32 v12, 0xc1200000, v12
    v_mul_f32 v13, 0xc1200000, v13
    v_mul_f32 v14, 0xc1200000, v14
    v_mul_f32 v15, 0xc1200000, v15
    v_mul_f32 v16, 0xc1200000, v16
    v_mul_f32 v17, 0xc1200000, v17
    v_mul_f32 v18, 0xc1200000, v18
    v_mul_f32 v19, 0xc1200000, v19
    v_mul_f32 v20, 0xc1200000, v20
    v_mul_f32 v21, 0xc1200000, v21
    v_mul_f32 v22, 0xc1200000, v22
    v_mul_f32 v23, 0xc1200000, v23
    v_cvt_pk_bf16_f32 v8, v8, v9
    v_cvt_pk_bf16_f32 v10, v10, v11
    v_cvt_pk_bf16_f32 v12, v12, v13
    v_cvt_pk_bf16_f32 v14, v14, v15
    v_cvt_pk_bf16_f32 v16, v16, v17
    v_cvt_pk_bf16_f32 v18, v18, v19
    v_cvt_pk_bf16_f32 v20, v20, v21
    v_cvt_pk_bf16_f32 v22, v22, v23
    v_and_b32 v9, 0xffff0000, v8
    v_lshlrev_b32 v8, 16, v8
    v_and_b32 v11, 0xffff0000, v10
    v_lshlrev_b32 v10, 16, v10
    v_and_b32 v13, 0xffff0000, v12
    v_lshlrev_b32 v12, 16, v12
    v_and_b32 v15, 0xffff0000, v14
    v_lshlrev_b32 v14, 16, v14
    v_and_b32 v17, 0xffff0000, v16
    v_lshlrev_b32 v16, 16, v16
    v_and_b32 v19, 0xffff0000, v18
    v_lshlrev_b32 v18, 16, v18
    v_and_b32 v21, 0xffff0000, v20
    v_lshlrev_b32 v20, 16, v20
    v_and_b32 v23, 0xffff0000, v22
    v_lshlrev_b32 v22, 16, v22
    v_mul_f32 v8, 0x3fb8aa3b, v8
    v_mul_f32 v9, 0x3fb8aa3b, v9
    v_mul_f32 v10, 0x3fb8aa3b, v10
    v_mul_f32 v11, 0x3fb8aa3b, v11
    v_mul_f32 v12, 0x3fb8aa3b, v12
    v_mul_f32 v13, 0x3fb8aa3b, v13
    v_mul_f32 v14, 0x3fb8aa3b, v14
    v_mul_f32 v15, 0x3fb8aa3b, v15
    v_mul_f32 v16, 0x3fb8aa3b, v16
    v_mul_f32 v17, 0x3fb8aa3b, v17
    v_mul_f32 v18, 0x3fb8aa3b, v18
    v_mul_f32 v19, 0x3fb8aa3b, v19
    v_mul_f32 v20, 0x3fb8aa3b, v20
    v_mul_f32 v21, 0x3fb8aa3b, v21
    v_mul_f32 v22, 0x3fb8aa3b, v22
    v_mul_f32 v23, 0x3fb8aa3b, v23
    v_exp_f32 v8, v8
    v_exp_f32 v9, v9
    v_exp_f32 v10, v10
    v_exp_f32 v11, v11
    v_exp_f32 v12, v12
    v_exp_f32 v13, v13
    v_exp_f32 v14, v14
    v_exp_f32 v15, v15
    v_exp_f32 v16, v16
    v_exp_f32 v17, v17
    v_exp_f32 v18, v18
    v_exp_f32 v19, v19
    v_exp_f32 v20, v20
    v_exp_f32 v21, v21
    v_exp_f32 v22, v22
    v_exp_f32 v23, v23
    s_nop 0
    v_cvt_pk_bf16_f32 v8, v8, v9
    v_cvt_pk_bf16_f32 v10, v10, v11
    v_cvt_pk_bf16_f32 v12, v12, v13
    v_cvt_pk_bf16_f32 v14, v14, v15
    v_cvt_pk_bf16_f32 v16, v16, v17
    v_cvt_pk_bf16_f32 v18, v18, v19
    v_cvt_pk_bf16_f32 v20, v20, v21
    v_cvt_pk_bf16_f32 v22, v22, v23
    v_and_b32 v9, 0xffff0000, v8
    v_lshlrev_b32 v8, 16, v8
    v_and_b32 v11, 0xffff0000, v10
    v_lshlrev_b32 v10, 16, v10
    v_and_b32 v13, 0xffff0000, v12
    v_lshlrev_b32 v12, 16, v12
    v_and_b32 v15, 0xffff0000, v14
    v_lshlrev_b32 v14, 16, v14
    v_and_b32 v17, 0xffff0000, v16
    v_lshlrev_b32 v16, 16, v16
    v_and_b32 v19, 0xffff0000, v18
    v_lshlrev_b32 v18, 16, v18
    v_and_b32 v21, 0xffff0000, v20
    v_lshlrev_b32 v20, 16, v20
    v_and_b32 v23, 0xffff0000, v22
    v_lshlrev_b32 v22, 16, v22
    s_lshl_b32 s14, s52, 16
    s_and_b32 s15, s52, 0xffff0000
    v_pk_mul_f32 v[24:25], v[8:9], s[14:15] op_sel:[0,0] op_sel_hi:[0,1]
    v_pk_mul_f32 v[28:29], v[16:17], s[14:15] op_sel:[0,0] op_sel_hi:[0,1]
    s_lshl_b32 s16, s53, 16
    s_and_b32 s17, s53, 0xffff0000
    v_pk_mul_f32 v[26:27], v[8:9], s[16:17] op_sel:[0,0] op_sel_hi:[0,1]
    v_pk_mul_f32 v[30:31], v[16:17], s[16:17] op_sel:[0,0] op_sel_hi:[0,1]
    s_lshl_b32 s18, s54, 16
    s_and_b32 s19, s54, 0xffff0000
    v_pk_fma_f32 v[24:25], v[8:9], s[18:19], v[24:25] op_sel:[1,0,0] op_sel_hi:[1,1,1]
    v_pk_fma_f32 v[28:29], v[16:17], s[18:19], v[28:29] op_sel:[1,0,0] op_sel_hi:[1,1,1]
    s_lshl_b32 s12, s55, 16
    s_and_b32 s13, s55, 0xffff0000
    v_pk_fma_f32 v[26:27], v[8:9], s[12:13], v[26:27] op_sel:[1,0,0] op_sel_hi:[1,1,1]
    v_pk_fma_f32 v[30:31], v[16:17], s[12:13], v[30:31] op_sel:[1,0,0] op_sel_hi:[1,1,1]
    s_lshl_b32 s14, s56, 16
    s_and_b32 s15, s56, 0xffff0000
    v_pk_fma_f32 v[24:25], v[10:11], s[14:15], v[24:25] op_sel:[0,0,0] op_sel_hi:[0,1,1]
    v_pk_fma_f32 v[28:29], v[18:19], s[14:15], v[28:29] op_sel:[0,0,0] op_sel_hi:[0,1,1]
    s_lshl_b32 s16, s57, 16
    s_and_b32 s17, s57, 0xffff0000
    v_pk_fma_f32 v[26:27], v[10:11], s[16:17], v[26:27] op_sel:[0,0,0] op_sel_hi:[0,1,1]
    v_pk_fma_f32 v[30:31], v[18:19], s[16:17], v[30:31] op_sel:[0,0,0] op_sel_hi:[0,1,1]
    s_lshl_b32 s18, s58, 16
    s_and_b32 s19, s58, 0xffff0000
    v_pk_fma_f32 v[24:25], v[10:11], s[18:19], v[24:25] op_sel:[1,0,0] op_sel_hi:[1,1,1]
    v_pk_fma_f32 v[28:29], v[18:19], s[18:19], v[28:29] op_sel:[1,0,0] op_sel_hi:[1,1,1]
    s_lshl_b32 s12, s59, 16
    s_and_b32 s13, s59, 0xffff0000
    v_pk_fma_f32 v[26:27], v[10:11], s[12:13], v[26:27] op_sel:[1,0,0] op_sel_hi:[1,1,1]
    v_pk_fma_f32 v[30:31], v[18:19], s[12:13], v[30:31] op_sel:[1,0,0] op_sel_hi:[1,1,1]
    s_lshl_b32 s14, s60, 16
    s_and_b32 s15, s60, 0xffff0000
    v_pk_fma_f32 v[24:25], v[12:13], s[14:15], v[24:25] op_sel:[0,0,0] op_sel_hi:[0,1,1]
    v_pk_fma_f32 v[28:29], v[20:21], s[14:15], v[28:29] op_sel:[0,0,0] op_sel_hi:[0,1,1]
    s_lshl_b32 s16, s61, 16
    s_and_b32 s17, s61, 0xffff0000
    v_pk_fma_f32 v[26:27], v[12:13], s[16:17], v[26:27] op_sel:[0,0,0] op_sel_hi:[0,1,1]
    v_pk_fma_f32 v[30:31], v[20:21], s[16:17], v[30:31] op_sel:[0,0,0] op_sel_hi:[0,1,1]
    s_lshl_b32 s18, s62, 16
    s_and_b32 s19, s62, 0xffff0000
    v_pk_fma_f32 v[24:25], v[12:13], s[18:19], v[24:25] op_sel:[1,0,0] op_sel_hi:[1,1,1]
    v_pk_fma_f32 v[28:29], v[20:21], s[18:19], v[28:29] op_sel:[1,0,0] op_sel_hi:[1,1,1]
    s_lshl_b32 s12, s63, 16
    s_and_b32 s13, s63, 0xffff0000
    v_pk_fma_f32 v[26:27], v[12:13], s[12:13], v[26:27] op_sel:[1,0,0] op_sel_hi:[1,1,1]
    v_pk_fma_f32 v[30:31], v[20:21], s[12:13], v[30:31] op_sel:[1,0,0] op_sel_hi:[1,1,1]
    s_lshl_b32 s14, s64, 16
    s_and_b32 s15, s64, 0xffff0000
    v_pk_fma_f32 v[24:25], v[14:15], s[14:15], v[24:25] op_sel:[0,0,0] op_sel_hi:[0,1,1]
    v_pk_fma_f32 v[28:29], v[22:23], s[14:15], v[28:29] op_sel:[0,0,0] op_sel_hi:[0,1,1]
    s_lshl_b32 s16, s65, 16
    s_and_b32 s17, s65, 0xffff0000
    v_pk_fma_f32 v[26:27], v[14:15], s[16:17], v[26:27] op_sel:[0,0,0] op_sel_hi:[0,1,1]
    v_pk_fma_f32 v[30:31], v[22:23], s[16:17], v[30:31] op_sel:[0,0,0] op_sel_hi:[0,1,1]
    s_lshl_b32 s18, s66, 16
    s_and_b32 s19, s66, 0xffff0000
    v_pk_fma_f32 v[24:25], v[14:15], s[18:19], v[24:25] op_sel:[1,0,0] op_sel_hi:[1,1,1]
    v_pk_fma_f32 v[28:29], v[22:23], s[18:19], v[28:29] op_sel:[1,0,0] op_sel_hi:[1,1,1]
    s_lshl_b32 s12, s67, 16
    s_and_b32 s13, s67, 0xffff0000
    v_pk_fma_f32 v[26:27], v[14:15], s[12:13], v[26:27] op_sel:[1,0,0] op_sel_hi:[1,1,1]
    v_pk_fma_f32 v[30:31], v[22:23], s[12:13], v[30:31] op_sel:[1,0,0] op_sel_hi:[1,1,1]
    s_lshl_b32 s14, s36, 16
    s_and_b32 s15, s36, 0xffff0000
    v_pk_mul_f32 v[32:33], v[8:9], s[14:15] op_sel:[0,0] op_sel_hi:[0,1]
    v_pk_mul_f32 v[36:37], v[16:17], s[14:15] op_sel:[0,0] op_sel_hi:[0,1]
    s_lshl_b32 s16, s37, 16
    s_and_b32 s17, s37, 0xffff0000
    v_pk_mul_f32 v[34:35], v[8:9], s[16:17] op_sel:[0,0] op_sel_hi:[0,1]
    v_pk_mul_f32 v[38:39], v[16:17], s[16:17] op_sel:[0,0] op_sel_hi:[0,1]
    s_lshl_b32 s18, s38, 16
    s_and_b32 s19, s38, 0xffff0000
    v_pk_fma_f32 v[32:33], v[8:9], s[18:19], v[32:33] op_sel:[1,0,0] op_sel_hi:[1,1,1]
    v_pk_fma_f32 v[36:37], v[16:17], s[18:19], v[36:37] op_sel:[1,0,0] op_sel_hi:[1,1,1]
    s_lshl_b32 s12, s39, 16
    s_and_b32 s13, s39, 0xffff0000
    v_pk_fma_f32 v[34:35], v[8:9], s[12:13], v[34:35] op_sel:[1,0,0] op_sel_hi:[1,1,1]
    v_pk_fma_f32 v[38:39], v[16:17], s[12:13], v[38:39] op_sel:[1,0,0] op_sel_hi:[1,1,1]
    s_lshl_b32 s14, s40, 16
    s_and_b32 s15, s40, 0xffff0000
    v_pk_fma_f32 v[32:33], v[10:11], s[14:15], v[32:33] op_sel:[0,0,0] op_sel_hi:[0,1,1]
    v_pk_fma_f32 v[36:37], v[18:19], s[14:15], v[36:37] op_sel:[0,0,0] op_sel_hi:[0,1,1]
    s_lshl_b32 s16, s41, 16
    s_and_b32 s17, s41, 0xffff0000
    v_pk_fma_f32 v[34:35], v[10:11], s[16:17], v[34:35] op_sel:[0,0,0] op_sel_hi:[0,1,1]
    v_pk_fma_f32 v[38:39], v[18:19], s[16:17], v[38:39] op_sel:[0,0,0] op_sel_hi:[0,1,1]
    s_lshl_b32 s18, s42, 16
    s_and_b32 s19, s42, 0xffff0000
    v_pk_fma_f32 v[32:33], v[10:11], s[18:19], v[32:33] op_sel:[1,0,0] op_sel_hi:[1,1,1]
    v_pk_fma_f32 v[36:37], v[18:19], s[18:19], v[36:37] op_sel:[1,0,0] op_sel_hi:[1,1,1]
    s_lshl_b32 s12, s43, 16
    s_and_b32 s13, s43, 0xffff0000
    v_pk_fma_f32 v[34:35], v[10:11], s[12:13], v[34:35] op_sel:[1,0,0] op_sel_hi:[1,1,1]
    v_pk_fma_f32 v[38:39], v[18:19], s[12:13], v[38:39] op_sel:[1,0,0] op_sel_hi:[1,1,1]
    s_lshl_b32 s14, s44, 16
    s_and_b32 s15, s44, 0xffff0000
    v_pk_fma_f32 v[32:33], v[12:13], s[14:15], v[32:33] op_sel:[0,0,0] op_sel_hi:[0,1,1]
    v_pk_fma_f32 v[36:37], v[20:21], s[14:15], v[36:37] op_sel:[0,0,0] op_sel_hi:[0,1,1]
    s_lshl_b32 s16, s45, 16
    s_and_b32 s17, s45, 0xffff0000
    v_pk_fma_f32 v[34:35], v[12:13], s[16:17], v[34:35] op_sel:[0,0,0] op_sel_hi:[0,1,1]
    v_pk_fma_f32 v[38:39], v[20:21], s[16:17], v[38:39] op_sel:[0,0,0] op_sel_hi:[0,1,1]
    s_lshl_b32 s18, s46, 16
    s_and_b32 s19, s46, 0xffff0000
    v_pk_fma_f32 v[32:33], v[12:13], s[18:19], v[32:33] op_sel:[1,0,0] op_sel_hi:[1,1,1]
    v_pk_fma_f32 v[36:37], v[20:21], s[18:19], v[36:37] op_sel:[1,0,0] op_sel_hi:[1,1,1]
    s_lshl_b32 s12, s47, 16
    s_and_b32 s13, s47, 0xffff0000
    v_pk_fma_f32 v[34:35], v[12:13], s[12:13], v[34:35] op_sel:[1,0,0] op_sel_hi:[1,1,1]
    v_pk_fma_f32 v[38:39], v[20:21], s[12:13], v[38:39] op_sel:[1,0,0] op_sel_hi:[1,1,1]
    s_lshl_b32 s14, s48, 16
    s_and_b32 s15, s48, 0xffff0000
    v_pk_fma_f32 v[32:33], v[14:15], s[14:15], v[32:33] op_sel:[0,0,0] op_sel_hi:[0,1,1]
    v_pk_fma_f32 v[36:37], v[22:23], s[14:15], v[36:37] op_sel:[0,0,0] op_sel_hi:[0,1,1]
    s_lshl_b32 s16, s49, 16
    s_and_b32 s17, s49, 0xffff0000
    v_pk_fma_f32 v[34:35], v[14:15], s[16:17], v[34:35] op_sel:[0,0,0] op_sel_hi:[0,1,1]
    v_pk_fma_f32 v[38:39], v[22:23], s[16:17], v[38:39] op_sel:[0,0,0] op_sel_hi:[0,1,1]
    s_lshl_b32 s18, s50, 16
    s_and_b32 s19, s50, 0xffff0000
    v_pk_fma_f32 v[32:33], v[14:15], s[18:19], v[32:33] op_sel:[1,0,0] op_sel_hi:[1,1,1]
    v_pk_fma_f32 v[36:37], v[22:23], s[18:19], v[36:37] op_sel:[1,0,0] op_sel_hi:[1,1,1]
    s_lshl_b32 s12, s51, 16
    s_and_b32 s13, s51, 0xffff0000
    v_pk_fma_f32 v[34:35], v[14:15], s[12:13], v[34:35] op_sel:[1,0,0] op_sel_hi:[1,1,1]
    v_pk_fma_f32 v[38:39], v[22:23], s[12:13], v[38:39] op_sel:[1,0,0] op_sel_hi:[1,1,1]
    v_cvt_pk_bf16_f32 v32, v32, v33
    v_cvt_pk_bf16_f32 v34, v34, v35
    v_cvt_pk_bf16_f32 v36, v36, v37
    v_cvt_pk_bf16_f32 v38, v38, v39
    v_and_b32 v33, 0xffff0000, v32
    v_lshlrev_b32 v32, 16, v32
    v_and_b32 v35, 0xffff0000, v34
    v_lshlrev_b32 v34, 16, v34
    v_and_b32 v37, 0xffff0000, v36
    v_lshlrev_b32 v36, 16, v36
    v_and_b32 v39, 0xffff0000, v38
    v_lshlrev_b32 v38, 16, v38
    s_waitcnt vmcnt(1)
    v_add_u32 v40, v40, v44
    v_add_u32 v48, v48, v52
    v_add_u32 v41, v41, v45
    v_add_u32 v49, v49, v53
    v_add_u32 v42, v42, v46
    v_add_u32 v50, v50, v54
    v_add_u32 v43, v43, v47
    v_add_u32 v51, v51, v55
    v_add_u32_sdwa v8, v40, v48 dst_sel:DWORD dst_unused:UNUSED_PAD src0_sel:WORD_0 src1_sel:WORD_0
    v_add_u32_sdwa v9, v40, v48 dst_sel:DWORD dst_unused:UNUSED_PAD src0_sel:WORD_1 src1_sel:WORD_1
    v_add_u32_sdwa v10, v41, v49 dst_sel:DWORD dst_unused:UNUSED_PAD src0_sel:WORD_0 src1_sel:WORD_0
    v_add_u32_sdwa v11, v41, v49 dst_sel:DWORD dst_unused:UNUSED_PAD src0_sel:WORD_1 src1_sel:WORD_1
    v_add_u32_sdwa v12, v42, v50 dst_sel:DWORD dst_unused:UNUSED_PAD src0_sel:WORD_0 src1_sel:WORD_0
    v_add_u32_sdwa v13, v42, v50 dst_sel:DWORD dst_unused:UNUSED_PAD src0_sel:WORD_1 src1_sel:WORD_1
    v_add_u32_sdwa v14, v43, v51 dst_sel:DWORD dst_unused:UNUSED_PAD src0_sel:WORD_0 src1_sel:WORD_0
    v_add_u32_sdwa v15, v43, v51 dst_sel:DWORD dst_unused:UNUSED_PAD src0_sel:WORD_1 src1_sel:WORD_1
    v_min3_u32 v5, v56, v57, v58
    v_bitop3_b32 v4, v56, v57, v58 bitop3:0xfe
    v_min_u32 v5, v5, v59
    v_or_b32 v4, v4, v59
    v_or_b32 v8, 0x4b000000, v8
    v_or_b32 v9, 0x4b000000, v9
    v_or_b32 v10, 0x4b000000, v10
    v_or_b32 v11, 0x4b000000, v11
    v_or_b32 v12, 0x4b000000, v12
    v_or_b32 v13, 0x4b000000, v13
    v_or_b32 v14, 0x4b000000, v14
    v_or_b32 v15, 0x4b000000, v15
    v_cmp_eq_u32 vcc, 0, v5
    v_add_f32 v8, 0xcb010000, v8
    v_add_f32 v9, 0xcb010000, v9
    v_add_f32 v10, 0xcb010000, v10
    v_add_f32 v11, 0xcb010000, v11
    v_add_f32 v12, 0xcb010000, v12
    v_add_f32 v13, 0xcb010000, v13
    v_add_f32 v14, 0xcb010000, v14
    v_add_f32 v15, 0xcb010000, v15
    v_mul_f32 v8, v4, v8
    v_mul_f32 v9, v4, v9
    v_mul_f32 v10, v4, v10
    v_mul_f32 v11, v4, v11
    v_mul_f32 v12, v4, v12
    v_mul_f32 v13, v4, v13
    v_mul_f32 v14, v4, v14
    v_mul_f32 v15, v4, v15
    s_cbranch_vccz p3_nof
    v_lshlrev_b32 v1, 4, v0
    v_mov_b32 v3, 0x70000000
    v_cmp_eq_u32 vcc, 0, v56
    s_mov_b32 s22, 517218304
    s_nop 0
    v_cndmask_b32 v5, v3, v1, vcc
    buffer_load_dwordx4 v[16:19], v5, s[28:31], s22 offen
    buffer_load_dwordx4 v[20:23], v5, s[28:31], s22 offen offset:16
    s_waitcnt vmcnt(0)
    v_add_f32 v8, v8, v16
    v_add_f32 v9, v9, v17
    v_add_f32 v10, v10, v18
    v_add_f32 v11, v11, v19
    v_add_f32 v12, v12, v20
    v_add_f32 v13, v13, v21
    v_add_f32 v14, v14, v22
    v_add_f32 v15, v15, v23
    v_cmp_eq_u32 vcc, 0, v57
    s_mov_b32 s22, 530030592
    s_nop 0
    v_cndmask_b32 v5, v3, v1, vcc
    buffer_load_dwordx4 v[16:19], v5, s[28:31], s22 offen
    buffer_load_dwordx4 v[20:23], v5, s[28:31], s22 offen offset:16
    s_waitcnt vmcnt(0)
    v_add_f32 v8, v8, v16
    v_add_f32 v9, v9, v17
    v_add_f32 v10, v10, v18
    v_add_f32 v11, v11, v19
    v_add_f32 v12, v12, v20
    v_add_f32 v13, v13, v21
    v_add_f32 v14, v14, v22
    v_add_f32 v15, v15, v23
    v_cmp_eq_u32 vcc, 0, v58
    s_mov_b32 s22, 542842880
    s_nop 0
    v_cndmask_b32 v5, v3, v1, vcc
    buffer_load_dwordx4 v[16:19], v5, s[28:31], s22 offen
    buffer_load_dwordx4 v[20:23], v5, s[28:31], s22 offen offset:16
    s_waitcnt vmcnt(0)
    v_add_f32 v8, v8, v16
    v_add_f32 v9, v9, v17
    v_add_f32 v10, v10, v18
    v_add_f32 v11, v11, v19
    v_add_f32 v12, v12, v20
    v_add_f32 v13, v13, v21
    v_add_f32 v14, v14, v22
    v_add_f32 v15, v15, v23
    v_cmp_eq_u32 vcc, 0, v59
    s_mov_b32 s22, 555655168
    s_nop 0
    v_cndmask_b32 v5, v3, v1, vcc
    buffer_load_dwordx4 v[16:19], v5, s[28:31], s22 offen
    buffer_load_dwordx4 v[20:23], v5, s[28:31], s22 offen offset:16
    s_waitcnt vmcnt(0)
    v_add_f32 v8, v8, v16
    v_add_f32 v9, v9, v17
    v_add_f32 v10, v10, v18
    v_add_f32 v11, v11, v19
    v_add_f32 v12, v12, v20
    v_add_f32 v13, v13, v21
    v_add_f32 v14, v14, v22
    v_add_f32 v15, v15, v23
p3_nof:
    s_lshl_b32 s14, s68, 16
    s_and_b32 s15, s68, 0xffff0000
    v_pk_mul_f32 v[16:17], v[8:9], s[14:15] op_sel:[0,0] op_sel_hi:[0,1]
    v_pk_mul_f32 v[20:21], v[12:13], s[14:15] op_sel:[0,0] op_sel_hi:[0,1]
    s_lshl_b32 s16, s69, 16
    s_and_b32 s17, s69, 0xffff0000
    v_pk_mul_f32 v[18:19], v[8:9], s[16:17] op_sel:[0,0] op_sel_hi:[0,1]
    v_pk_mul_f32 v[22:23], v[12:13], s[16:17] op_sel:[0,0] op_sel_hi:[0,1]
    s_lshl_b32 s18, s70, 16
    s_and_b32 s19, s70, 0xffff0000
    v_pk_fma_f32 v[16:17], v[8:9], s[18:19], v[16:17] op_sel:[1,0,0] op_sel_hi:[1,1,1]
    v_pk_fma_f32 v[20:21], v[12:13], s[18:19], v[20:21] op_sel:[1,0,0] op_sel_hi:[1,1,1]
    s_lshl_b32 s12, s71, 16
    s_and_b32 s13, s71, 0xffff0000
    v_pk_fma_f32 v[18:19], v[8:9], s[12:13], v[18:19] op_sel:[1,0,0] op_sel_hi:[1,1,1]
    v_pk_fma_f32 v[22:23], v[12:13], s[12:13], v[22:23] op_sel:[1,0,0] op_sel_hi:[1,1,1]
    s_lshl_b32 s14, s72, 16
    s_and_b32 s15, s72, 0xffff0000
    v_pk_fma_f32 v[16:17], v[10:11], s[14:15], v[16:17] op_sel:[0,0,0] op_sel_hi:[0,1,1]
    v_pk_fma_f32 v[20:21], v[14:15], s[14:15], v[20:21] op_sel:[0,0,0] op_sel_hi:[0,1,1]
    s_lshl_b32 s16, s73, 16
    s_and_b32 s17, s73, 0xffff0000
    v_pk_fma_f32 v[18:19], v[10:11], s[16:17], v[18:19] op_sel:[0,0,0] op_sel_hi:[0,1,1]
    v_pk_fma_f32 v[22:23], v[14:15], s[16:17], v[22:23] op_sel:[0,0,0] op_sel_hi:[0,1,1]
    s_lshl_b32 s18, s74, 16
    s_and_b32 s19, s74, 0xffff0000
    v_pk_fma_f32 v[16:17], v[10:11], s[18:19], v[16:17] op_sel:[1,0,0] op_sel_hi:[1,1,1]
    v_pk_fma_f32 v[20:21], v[14:15], s[18:19], v[20:21] op_sel:[1,0,0] op_sel_hi:[1,1,1]
    s_lshl_b32 s12, s75, 16
    s_and_b32 s13, s75, 0xffff0000
    v_pk_fma_f32 v[18:19], v[10:11], s[12:13], v[18:19] op_sel:[1,0,0] op_sel_hi:[1,1,1]
    v_pk_fma_f32 v[22:23], v[14:15], s[12:13], v[22:23] op_sel:[1,0,0] op_sel_hi:[1,1,1]
    v_mul_f32 v24, v24, v16
    v_mul_f32 v25, v25, v17
    v_mul_f32 v26, v26, v18
    v_mul_f32 v27, v27, v19
    v_mul_f32 v28, v28, v20
    v_mul_f32 v29, v29, v21
    v_mul_f32 v30, v30, v22
    v_mul_f32 v31, v31, v23
    v_cvt_pk_bf16_f32 v24, v24, v25
    v_cvt_pk_bf16_f32 v26, v26, v27
    v_cvt_pk_bf16_f32 v28, v28, v29
    v_cvt_pk_bf16_f32 v30, v30, v31
    v_and_b32 v25, 0xffff0000, v24
    v_lshlrev_b32 v24, 16, v24
    v_and_b32 v27, 0xffff0000, v26
    v_lshlrev_b32 v26, 16, v26
    v_and_b32 v29, 0xffff0000, v28
    v_lshlrev_b32 v28, 16, v28
    v_and_b32 v31, 0xffff0000, v30
    v_lshlrev_b32 v30, 16, v30
    s_lshl_b32 s14, s76, 16
    s_and_b32 s15, s76, 0xffff0000
    v_pk_mul_f32 v[16:17], v[24:25], s[14:15] op_sel:[0,0] op_sel_hi:[0,1]
    v_pk_mul_f32 v[20:21], v[28:29], s[14:15] op_sel:[0,0] op_sel_hi:[0,1]
    s_lshl_b32 s16, s77, 16
    s_and_b32 s17, s77, 0xffff0000
    v_pk_mul_f32 v[18:19], v[24:25], s[16:17] op_sel:[0,0] op_sel_hi:[0,1]
    v_pk_mul_f32 v[22:23], v[28:29], s[16:17] op_sel:[0,0] op_sel_hi:[0,1]
    s_lshl_b32 s18, s78, 16
    s_and_b32 s19, s78, 0xffff0000
    v_pk_fma_f32 v[16:17], v[24:25], s[18:19], v[16:17] op_sel:[1,0,0] op_sel_hi:[1,1,1]
    v_pk_fma_f32 v[20:21], v[28:29], s[18:19], v[20:21] op_sel:[1,0,0] op_sel_hi:[1,1,1]
    s_lshl_b32 s12, s79, 16
    s_and_b32 s13, s79, 0xffff0000
    v_pk_fma_f32 v[18:19], v[24:25], s[12:13], v[18:19] op_sel:[1,0,0] op_sel_hi:[1,1,1]
    v_pk_fma_f32 v[22:23], v[28:29], s[12:13], v[22:23] op_sel:[1,0,0] op_sel_hi:[1,1,1]
    s_lshl_b32 s14, s80, 16
    s_and_b32 s15, s80, 0xffff0000
    v_pk_fma_f32 v[16:17], v[26:27], s[14:15], v[16:17] op_sel:[0,0,0] op_sel_hi:[0,1,1]
    v_pk_fma_f32 v[20:21], v[30:31], s[14:15], v[20:21] op_sel:[0,0,0] op_sel_hi:[0,1,1]
    s_lshl_b32 s16, s81, 16
    s_and_b32 s17, s81, 0xffff0000
    v_pk_fma_f32 v[18:19], v[26:27], s[16:17], v[18:19] op_sel:[0,0,0] op_sel_hi:[0,1,1]
    v_pk_fma_f32 v[22:23], v[30:31], s[16:17], v[22:23] op_sel:[0,0,0] op_sel_hi:[0,1,1]
    s_lshl_b32 s18, s82, 16
    s_and_b32 s19, s82, 0xffff0000
    v_pk_fma_f32 v[16:17], v[26:27], s[18:19], v[16:17] op_sel:[1,0,0] op_sel_hi:[1,1,1]
    v_pk_fma_f32 v[20:21], v[30:31], s[18:19], v[20:21] op_sel:[1,0,0] op_sel_hi:[1,1,1]
    s_lshl_b32 s12, s83, 16
    s_and_b32 s13, s83, 0xffff0000
    v_pk_fma_f32 v[18:19], v[26:27], s[12:13], v[18:19] op_sel:[1,0,0] op_sel_hi:[1,1,1]
    v_pk_fma_f32 v[22:23], v[30:31], s[12:13], v[22:23] op_sel:[1,0,0] op_sel_hi:[1,1,1]
    v_cvt_pk_bf16_f32 v16, v16, v17
    v_cvt_pk_bf16_f32 v18, v18, v19
    v_cvt_pk_bf16_f32 v20, v20, v21
    v_cvt_pk_bf16_f32 v22, v22, v23
    v_and_b32 v17, 0xffff0000, v16
    v_lshlrev_b32 v16, 16, v16
    v_and_b32 v19, 0xffff0000, v18
    v_lshlrev_b32 v18, 16, v18
    v_and_b32 v21, 0xffff0000, v20
    v_lshlrev_b32 v20, 16, v20
    v_and_b32 v23, 0xffff0000, v22
    v_lshlrev_b32 v22, 16, v22
    v_mul_f32 v16, v16, v32
    v_mul_f32 v17, v17, v33
    v_mul_f32 v18, v18, v34
    v_mul_f32 v19, v19, v35
    v_mul_f32 v20, v20, v36
    v_mul_f32 v21, v21, v37
    v_mul_f32 v22, v22, v38
    v_mul_f32 v23, v23, v39
    v_cvt_pk_bf16_f32 v16, v16, v17
    v_cvt_pk_bf16_f32 v18, v18, v19
    v_cvt_pk_bf16_f32 v20, v20, v21
    v_cvt_pk_bf16_f32 v22, v22, v23
    v_and_b32 v17, 0xffff0000, v16
    v_lshlrev_b32 v16, 16, v16
    v_and_b32 v19, 0xffff0000, v18
    v_lshlrev_b32 v18, 16, v18
    v_and_b32 v21, 0xffff0000, v20
    v_lshlrev_b32 v20, 16, v20
    v_and_b32 v23, 0xffff0000, v22
    v_lshlrev_b32 v22, 16, v22
    s_waitcnt vmcnt(0)
    v_lshlrev_b32 v8, 16, v60
    v_and_b32 v9, 0xffff0000, v60
    v_lshlrev_b32 v10, 16, v61
    v_and_b32 v11, 0xffff0000, v61
    v_lshlrev_b32 v12, 16, v62
    v_and_b32 v13, 0xffff0000, v62
    v_lshlrev_b32 v14, 16, v63
    v_and_b32 v15, 0xffff0000, v63
    v_add_f32 v8, v8, v16
    v_add_f32 v9, v9, v17
    v_add_f32 v10, v10, v18
    v_add_f32 v11, v11, v19
    v_add_f32 v12, v12, v20
    v_add_f32 v13, v13, v21
    v_add_f32 v14, v14, v22
    v_add_f32 v15, v15, v23
    v_cvt_pk_bf16_f32 v4, v8, v9
    v_cvt_pk_bf16_f32 v5, v10, v11
    v_cvt_pk_bf16_f32 v6, v12, v13
    v_cvt_pk_bf16_f32 v7, v14, v15
    buffer_store_dwordx4 v[4:7], v2, s[24:27], 0 offen nt
p3_end:
    s_endpgm
.section .rodata,"a"
.p2align 6
.amdhsa_kernel p1_kernel
  .amdhsa_next_free_vgpr 128
  .amdhsa_next_free_sgpr 72
  .amdhsa_accum_offset 128
  .amdhsa_group_segment_fixed_size 0
  .amdhsa_kernarg_size 112
  .amdhsa_user_sgpr_count 2
  .amdhsa_user_sgpr_kernarg_segment_ptr 1
  .amdhsa_system_sgpr_workgroup_id_x 1
  .amdhsa_float_denorm_mode_32 3
.end_amdhsa_kernel
.p2align 6
.amdhsa_kernel p2_kernel
  .amdhsa_next_free_vgpr 128
  .amdhsa_next_free_sgpr 72
  .amdhsa_accum_offset 128
  .amdhsa_group_segment_fixed_size 0
  .amdhsa_kernarg_size 112
  .amdhsa_user_sgpr_count 2
  .amdhsa_user_sgpr_kernarg_segment_ptr 1
  .amdhsa_system_sgpr_workgroup_id_x 1
  .amdhsa_float_denorm_mode_32 3
.end_amdhsa_kernel
.p2align 6
.amdhsa_kernel p3_kernel
  .amdhsa_next_free_vgpr 64
  .amdhsa_next_free_sgpr 84
  .amdhsa_accum_offset 64
  .amdhsa_group_segment_fixed_size 0
  .amdhsa_kernarg_size 112
  .amdhsa_user_sgpr_count 2
  .amdhsa_user_sgpr_kernarg_segment_ptr 1
  .amdhsa_system_sgpr_workgroup_id_x 1
  .amdhsa_float_denorm_mode_32 3
.end_amdhsa_kernel
```

```asm
; @launch kernel=p1_kernel grid=(256,1,1) block=(1024,1,1) lds=163072
; @launch kernel=p2_kernel grid=(256,1,1) block=(1024,1,1) lds=154368
; @launch kernel=p3_kernel grid=(1563,1,1) block=(256,1,1) lds=0
.amdgcn_target "amdgcn-amd-amdhsa--gfx950"
.text
.globl p1_kernel
.p2align 8
.type p1_kernel,@function
p1_kernel:
    s_cmp_ge_u32 s2, 256
    s_cbranch_scc1 p1_end
    s_load_dwordx2 s[52:53], s[0:1], 0
    s_load_dwordx4 s[56:59], s[0:1], 8
    s_load_dwordx2 s[54:55], s[0:1], 32
    s_load_dwordx2 s[60:61], s[0:1], 48
    s_load_dwordx2 s[48:49], s[0:1], 104
    s_load_dwordx2 s[62:63], s[0:1], 96
    v_lshlrev_b32 v1, 4, v0
    v_lshlrev_b32 v2, 3, v0
    v_mov_b32 v3, 1
    v_lshrrev_b32 v117, 6, v0
    s_nop 0
    v_readfirstlane_b32 s28, v117
    s_waitcnt lgkmcnt(0)
    s_load_dword s45, s[60:61], 0
    s_mov_b32 s4, s56
    s_and_b32 s5, s57, 0xffff
    s_mov_b32 s6, 204800000
    s_mov_b32 s7, 0x20000
    s_mov_b32 s8, s58
    s_and_b32 s9, s59, 0xffff
    s_mov_b32 s10, 204800000
    s_mov_b32 s11, 0x20000
    s_mov_b32 s12, s54
    s_and_b32 s13, s55, 0xffff
    s_mov_b32 s14, 102400000
    s_mov_b32 s15, 0x20000
    s_mov_b32 s16, s48
    s_and_b32 s17, s49, 0xffff
    s_mov_b32 s18, 819200000
    s_mov_b32 s19, 0x20000
    s_mov_b32 s29, s2
    s_mul_i32 s31, s2, 73728
    s_lshl_b32 s30, s31, 1
    s_add_u32 s32, s30, 0
    buffer_load_dwordx4 v[94:97], v1, s[4:7], s32 offen nt
    s_add_u32 s32, s30, 0
    buffer_load_dwordx4 v[102:105], v1, s[8:11], s32 offen nt
    s_add_u32 s32, s31, 0
    buffer_load_dwordx2 v[76:77], v2, s[12:15], s32 offen nt
    s_add_u32 s32, s30, 16384
    buffer_load_dwordx4 v[98:101], v1, s[4:7], s32 offen nt
    s_add_u32 s32, s30, 16384
    buffer_load_dwordx4 v[106:109], v1, s[8:11], s32 offen nt
    s_add_u32 s32, s31, 8192
    buffer_load_dwordx2 v[78:79], v2, s[12:15], s32 offen nt
    s_add_u32 s32, s30, 32768
    buffer_load_dwordx4 v[12:15], v1, s[4:7], s32 offen nt
    s_add_u32 s32, s30, 32768
    buffer_load_dwordx4 v[48:51], v1, s[8:11], s32 offen nt
    s_add_u32 s32, s31, 16384
    buffer_load_dwordx2 v[80:81], v2, s[12:15], s32 offen nt
    s_add_u32 s32, s30, 49152
    buffer_load_dwordx4 v[52:55], v1, s[8:11], s32 offen nt
    s_add_u32 s32, s31, 24576
    buffer_load_dwordx2 v[82:83], v2, s[12:15], s32 offen nt
    s_add_u32 s32, s31, 32768
    buffer_load_dwordx2 v[84:85], v2, s[12:15], s32 offen nt
    s_add_u32 s32, s30, 81920
    buffer_load_dwordx4 v[60:63], v1, s[8:11], s32 offen nt
    s_add_u32 s32, s31, 40960
    buffer_load_dwordx2 v[86:87], v2, s[12:15], s32 offen nt
    s_add_u32 s32, s31, 49152
    buffer_load_dwordx2 v[88:89], v2, s[12:15], s32 offen nt
    s_add_u32 s32, s30, 114688
    buffer_load_dwordx4 v[68:71], v1, s[8:11], s32 offen nt
    s_add_u32 s32, s31, 57344
    buffer_load_dwordx2 v[90:91], v2, s[12:15], s32 offen nt
    s_add_u32 s32, s31, 65536
    buffer_load_dwordx2 v[92:93], v2, s[12:15], s32 offen nt
    s_mov_b32 s24, s52
    s_and_b32 s25, s53, 0xffff
    s_mov_b32 s26, 6400000
    s_mov_b32 s27, 0x20000
    s_mov_b32 s20, s48
    s_and_b32 s21, s49, 0xffff
    s_mov_b32 s22, 0
    s_mov_b32 s23, 0x20000
    s_mov_b32 s40, s62
    s_and_b32 s41, s63, 0xffff
    s_mov_b32 s42, 256
    s_mov_b32 s43, 0x20000
    s_mov_b32 s36, 643827
    s_mov_b32 s37, 214609
    s_mov_b32 s38, 343268
    s_mov_b32 s39, -6671
    s_mov_b32 s44, -12512
    s_mov_b32 s34, 1
    v_mov_b32 v122, 0
    v_mov_b32 v123, 0
    v_mov_b32 v124, 0
    v_mov_b32 v125, 0
    ds_write_b128 v1, v[122:125] offset:0
    s_waitcnt lgkmcnt(0)
    s_barrier
    s_lshl_b32 s45, s45, 16
p1_tile:
    v_mov_b32 v122, 0
    v_mov_b32 v123, 0
    v_mov_b32 v124, 0
    v_mov_b32 v125, 0
    ds_write_b128 v1, v[122:125] offset:10496
    ds_write_b128 v1, v[122:125] offset:26880
    ds_write_b128 v1, v[122:125] offset:43264
    s_cmp_lg_u32 s28, 15
    s_cbranch_scc1 p1_tk0
    v_mov_b32 v127, 1
    s_mov_b64 exec, 1
    buffer_atomic_add v127, off, s[40:43], 0 offset:128 sc0 sc1
    s_mov_b64 exec, -1
p1_tk0:
    v_mov_b32 v123, s45
    v_mov_b32 v124, 0x007f007f
    v_mov_b32 v125, 0xe000
    v_mov_b32 v126, 0xffff0000
    s_cmp_lt_u32 s29, 1419
    s_cselect_b32 s6, 204800000, 0
    s_add_u32 s32, s30, 49152
    buffer_load_dwordx4 v[16:19], v1, s[4:7], s32 offen nt
    s_cmp_lg_u32 s34, 0
    s_cbranch_scc1 p1_w1
    s_waitcnt vmcnt(15)
p1_w1:
    s_waitcnt vmcnt(16)
    v_lshlrev_b32 v117, 16, v76
    v_and_b32 v118, v126, v76
    v_mul_f32 v117, v123, v117
    v_mul_f32 v118, v123, v118
    v_cvt_pk_bf16_f32 v117, v117, v118
    v_and_b32 v118, v126, v117
    v_lshlrev_b32 v117, 16, v117
    v_mul_f32 v117, 0.15915494, v117
    v_mul_f32 v118, 0.15915494, v118
    v_fract_f32 v117, v117
    v_fract_f32 v118, v118
    v_cos_f32 v117, v117
    v_cos_f32 v118, v118
    v_mul_hi_u32_u24 v122, s38, v102
    v_mul_hi_u32_u24 v121, s37, v94
    v_mul_hi_u32_u24 v120, s36, v94
    v_mad_i32_i24 v110, v122, s44, v102
    v_mad_u32_u24 v40, v122, 40, v121
    v_mad_i32_i24 v4, v120, s39, v94
    v_lshlrev_b16 v40, 2, v40
    v_mad_i32_i24 v120, v121, -3, v120
    ds_add_u32 v40, v3 offset:0
    v_lshl_or_b32 v4, v110, 16, v4
    v_lshl_or_b32 v4, v120, 30, v4
    v_mul_f32 v117, 0x03800000, v117
    v_mul_f32 v118, 0x03800000, v118
    v_cvt_pk_bf16_f32 v117, v117, v118
    v_mul_hi_u32_u24 v122, s38, v103
    v_mul_hi_u32_u24 v121, s37, v95
    v_mul_hi_u32_u24 v120, s36, v95
    v_mad_i32_i24 v110, v122, s44, v103
    v_mad_u32_u24 v41, v122, 40, v121
    v_mad_i32_i24 v5, v120, s39, v95
    v_lshlrev_b16 v41, 2, v41
    v_mad_i32_i24 v120, v121, -3, v120
    ds_add_u32 v41, v3 offset:0
    v_lshl_or_b32 v5, v110, 16, v5
    v_lshl_or_b32 v5, v120, 30, v5
    v_lshrrev_b32 v118, 3, v117
    v_lshrrev_b32 v119, 8, v117
    v_lshlrev_b16 v117, 13, v117
    v_bitop3_b32 v119, v118, v119, v124 bitop3:0x1b
    v_bitop3_b32 v4, v117, v125, v4 bitop3:0xae
    v_lshl_or_b32 v40, v119, 16, v40
    v_bitop3_b32 v5, v118, v125, v5 bitop3:0xae
    v_bitop3_b32 v41, v119, v126, v41 bitop3:0xea
    v_lshlrev_b32 v117, 16, v77
    v_and_b32 v118, v126, v77
    v_mul_f32 v117, v123, v117
    v_mul_f32 v118, v123, v118
    v_cvt_pk_bf16_f32 v117, v117, v118
    v_and_b32 v118, v126, v117
    v_lshlrev_b32 v117, 16, v117
    v_mul_f32 v117, 0.15915494, v117
    v_mul_f32 v118, 0.15915494, v118
    v_fract_f32 v117, v117
    v_fract_f32 v118, v118
    v_cos_f32 v117, v117
    v_cos_f32 v118, v118
    v_mul_hi_u32_u24 v122, s38, v104
    v_mul_hi_u32_u24 v121, s37, v96
    v_mul_hi_u32_u24 v120, s36, v96
    v_mad_i32_i24 v110, v122, s44, v104
    v_mad_u32_u24 v42, v122, 40, v121
    v_mad_i32_i24 v6, v120, s39, v96
    v_lshlrev_b16 v42, 2, v42
    v_mad_i32_i24 v120, v121, -3, v120
    ds_add_u32 v42, v3 offset:0
    v_lshl_or_b32 v6, v110, 16, v6
    v_lshl_or_b32 v6, v120, 30, v6
    v_mul_f32 v117, 0x03800000, v117
    v_mul_f32 v118, 0x03800000, v118
    v_cvt_pk_bf16_f32 v117, v117, v118
    v_mul_hi_u32_u24 v122, s38, v105
    v_mul_hi_u32_u24 v121, s37, v97
    v_mul_hi_u32_u24 v120, s36, v97
    v_mad_i32_i24 v110, v122, s44, v105
    v_mad_u32_u24 v43, v122, 40, v121
    v_mad_i32_i24 v7, v120, s39, v97
    v_lshlrev_b16 v43, 2, v43
    v_mad_i32_i24 v120, v121, -3, v120
    ds_add_u32 v43, v3 offset:0
    v_lshl_or_b32 v7, v110, 16, v7
    v_lshl_or_b32 v7, v120, 30, v7
    v_lshrrev_b32 v118, 3, v117
    v_lshrrev_b32 v119, 8, v117
    v_lshlrev_b16 v117, 13, v117
    v_bitop3_b32 v119, v118, v119, v124 bitop3:0x1b
    v_bitop3_b32 v6, v117, v125, v6 bitop3:0xae
    v_lshl_or_b32 v42, v119, 16, v42
    v_bitop3_b32 v7, v118, v125, v7 bitop3:0xae
    v_bitop3_b32 v43, v119, v126, v43 bitop3:0xea
    s_cmp_lt_u32 s29, 1392
    s_cselect_b32 s6, 204800000, 0
    s_add_u32 s32, s30, 65536
    buffer_load_dwordx4 v[20:23], v1, s[4:7], s32 offen nt
    s_cmp_lt_u32 s29, 1392
    s_cselect_b32 s10, 204800000, 0
    s_add_u32 s32, s30, 65536
    buffer_load_dwordx4 v[56:59], v1, s[8:11], s32 offen nt
    s_cmp_lg_u32 s34, 0
    s_cbranch_scc1 p1_w2
    s_waitcnt vmcnt(6)
p1_w2:
    s_waitcnt vmcnt(15)
    v_lshlrev_b32 v117, 16, v78
    v_and_b32 v118, v126, v78
    v_mul_f32 v117, v123, v117
    v_mul_f32 v118, v123, v118
    v_cvt_pk_bf16_f32 v117, v117, v118
    v_and_b32 v118, v126, v117
    v_lshlrev_b32 v117, 16, v117
    v_mul_f32 v117, 0.15915494, v117
    v_mul_f32 v118, 0.15915494, v118
    v_fract_f32 v117, v117
    v_fract_f32 v118, v118
    v_cos_f32 v117, v117
    v_cos_f32 v118, v118
    v_mul_hi_u32_u24 v122, s38, v106
    v_mul_hi_u32_u24 v121, s37, v98
    v_mul_hi_u32_u24 v120, s36, v98
    v_mad_i32_i24 v110, v122, s44, v106
    v_mad_u32_u24 v44, v122, 40, v121
    v_mad_i32_i24 v8, v120, s39, v98
    v_lshlrev_b16 v44, 2, v44
    v_mad_i32_i24 v120, v121, -3, v120
    ds_add_u32 v44, v3 offset:0
    v_lshl_or_b32 v8, v110, 16, v8
    v_lshl_or_b32 v8, v120, 30, v8
    v_mul_f32 v117, 0x03800000, v117
    v_mul_f32 v118, 0x03800000, v118
    v_cvt_pk_bf16_f32 v117, v117, v118
    v_mul_hi_u32_u24 v122, s38, v107
    v_mul_hi_u32_u24 v121, s37, v99
    v_mul_hi_u32_u24 v120, s36, v99
    v_mad_i32_i24 v110, v122, s44, v107
    v_mad_u32_u24 v45, v122, 40, v121
    v_mad_i32_i24 v9, v120, s39, v99
    v_lshlrev_b16 v45, 2, v45
    v_mad_i32_i24 v120, v121, -3, v120
    ds_add_u32 v45, v3 offset:0
    v_lshl_or_b32 v9, v110, 16, v9
    v_lshl_or_b32 v9, v120, 30, v9
    v_lshrrev_b32 v118, 3, v117
    v_lshrrev_b32 v119, 8, v117
    v_lshlrev_b16 v117, 13, v117
    v_bitop3_b32 v119, v118, v119, v124 bitop3:0x1b
    v_bitop3_b32 v8, v117, v125, v8 bitop3:0xae
    v_lshl_or_b32 v44, v119, 16, v44
    v_bitop3_b32 v9, v118, v125, v9 bitop3:0xae
    v_bitop3_b32 v45, v119, v126, v45 bitop3:0xea
    v_lshlrev_b32 v117, 16, v79
    v_and_b32 v118, v126, v79
    v_mul_f32 v117, v123, v117
    v_mul_f32 v118, v123, v118
    v_cvt_pk_bf16_f32 v117, v117, v118
    v_and_b32 v118, v126, v117
    v_lshlrev_b32 v117, 16, v117
    v_mul_f32 v117, 0.15915494, v117
    v_mul_f32 v118, 0.15915494, v118
    v_fract_f32 v117, v117
    v_fract_f32 v118, v118
    v_cos_f32 v117, v117
    v_cos_f32 v118, v118
    v_mul_hi_u32_u24 v122, s38, v108
    v_mul_hi_u32_u24 v121, s37, v100
    v_mul_hi_u32_u24 v120, s36, v100
    v_mad_i32_i24 v110, v122, s44, v108
    v_mad_u32_u24 v46, v122, 40, v121
    v_mad_i32_i24 v10, v120, s39, v100
    v_lshlrev_b16 v46, 2, v46
    v_mad_i32_i24 v120, v121, -3, v120
    ds_add_u32 v46, v3 offset:0
    v_lshl_or_b32 v10, v110, 16, v10
    v_lshl_or_b32 v10, v120, 30, v10
    v_mul_f32 v117, 0x03800000, v117
    v_mul_f32 v118, 0x03800000, v118
    v_cvt_pk_bf16_f32 v117, v117, v118
    v_mul_hi_u32_u24 v122, s38, v109
    v_mul_hi_u32_u24 v121, s37, v101
    v_mul_hi_u32_u24 v120, s36, v101
    v_mad_i32_i24 v110, v122, s44, v109
    v_mad_u32_u24 v47, v122, 40, v121
    v_mad_i32_i24 v11, v120, s39, v101
    v_lshlrev_b16 v47, 2, v47
    v_mad_i32_i24 v120, v121, -3, v120
    ds_add_u32 v47, v3 offset:0
    v_lshl_or_b32 v11, v110, 16, v11
    v_lshl_or_b32 v11, v120, 30, v11
    v_lshrrev_b32 v118, 3, v117
    v_lshrrev_b32 v119, 8, v117
    v_lshlrev_b16 v117, 13, v117
    v_bitop3_b32 v119, v118, v119, v124 bitop3:0x1b
    v_bitop3_b32 v10, v117, v125, v10 bitop3:0xae
    v_lshl_or_b32 v46, v119, 16, v46
    v_bitop3_b32 v11, v118, v125, v11 bitop3:0xae
    v_bitop3_b32 v47, v119, v126, v47 bitop3:0xea
    s_cmp_lt_u32 s29, 1365
    s_cselect_b32 s6, 204800000, 0
    s_add_u32 s32, s30, 81920
    buffer_load_dwordx4 v[24:27], v1, s[4:7], s32 offen nt
    s_cmp_ge_u32 s29, 1445
    s_cbranch_scc1 p1_k3
    s_cmp_lg_u32 s34, 0
    s_cbranch_scc1 p1_w4
    s_waitcnt vmcnt(4)
p1_w4:
    s_waitcnt vmcnt(9)
    v_lshlrev_b32 v117, 16, v80
    v_and_b32 v118, v126, v80
    v_mul_f32 v117, v123, v117
    v_mul_f32 v118, v123, v118
    v_cvt_pk_bf16_f32 v117, v117, v118
    v_and_b32 v118, v126, v117
    v_lshlrev_b32 v117, 16, v117
    v_mul_f32 v117, 0.15915494, v117
    v_mul_f32 v118, 0.15915494, v118
    v_fract_f32 v117, v117
    v_fract_f32 v118, v118
    v_cos_f32 v117, v117
    v_cos_f32 v118, v118
    v_mul_hi_u32_u24 v122, s38, v48
    v_mul_hi_u32_u24 v121, s37, v12
    v_mul_hi_u32_u24 v120, s36, v12
    v_mad_i32_i24 v110, v122, s44, v48
    v_mad_u32_u24 v48, v122, 40, v121
    v_mad_i32_i24 v12, v120, s39, v12
    v_lshlrev_b16 v48, 2, v48
    v_mad_i32_i24 v120, v121, -3, v120
    ds_add_u32 v48, v3 offset:0
    v_lshl_or_b32 v12, v110, 16, v12
    v_lshl_or_b32 v12, v120, 30, v12
    v_mul_f32 v117, 0x03800000, v117
    v_mul_f32 v118, 0x03800000, v118
    v_cvt_pk_bf16_f32 v117, v117, v118
    v_mul_hi_u32_u24 v122, s38, v49
    v_mul_hi_u32_u24 v121, s37, v13
    v_mul_hi_u32_u24 v120, s36, v13
    v_mad_i32_i24 v110, v122, s44, v49
    v_mad_u32_u24 v49, v122, 40, v121
    v_mad_i32_i24 v13, v120, s39, v13
    v_lshlrev_b16 v49, 2, v49
    v_mad_i32_i24 v120, v121, -3, v120
    ds_add_u32 v49, v3 offset:0
    v_lshl_or_b32 v13, v110, 16, v13
    v_lshl_or_b32 v13, v120, 30, v13
    v_lshrrev_b32 v118, 3, v117
    v_lshrrev_b32 v119, 8, v117
    v_lshlrev_b16 v117, 13, v117
    v_bitop3_b32 v119, v118, v119, v124 bitop3:0x1b
    v_bitop3_b32 v12, v117, v125, v12 bitop3:0xae
    v_lshl_or_b32 v48, v119, 16, v48
    v_bitop3_b32 v13, v118, v125, v13 bitop3:0xae
    v_bitop3_b32 v49, v119, v126, v49 bitop3:0xea
    v_lshlrev_b32 v117, 16, v81
    v_and_b32 v118, v126, v81
    v_mul_f32 v117, v123, v117
    v_mul_f32 v118, v123, v118
    v_cvt_pk_bf16_f32 v117, v117, v118
    v_and_b32 v118, v126, v117
    v_lshlrev_b32 v117, 16, v117
    v_mul_f32 v117, 0.15915494, v117
    v_mul_f32 v118, 0.15915494, v118
    v_fract_f32 v117, v117
    v_fract_f32 v118, v118
    v_cos_f32 v117, v117
    v_cos_f32 v118, v118
    v_mul_hi_u32_u24 v122, s38, v50
    v_mul_hi_u32_u24 v121, s37, v14
    v_mul_hi_u32_u24 v120, s36, v14
    v_mad_i32_i24 v110, v122, s44, v50
    v_mad_u32_u24 v50, v122, 40, v121
    v_mad_i32_i24 v14, v120, s39, v14
    v_lshlrev_b16 v50, 2, v50
    v_mad_i32_i24 v120, v121, -3, v120
    ds_add_u32 v50, v3 offset:0
    v_lshl_or_b32 v14, v110, 16, v14
    v_lshl_or_b32 v14, v120, 30, v14
    v_mul_f32 v117, 0x03800000, v117
    v_mul_f32 v118, 0x03800000, v118
    v_cvt_pk_bf16_f32 v117, v117, v118
    v_mul_hi_u32_u24 v122, s38, v51
    v_mul_hi_u32_u24 v121, s37, v15
    v_mul_hi_u32_u24 v120, s36, v15
    v_mad_i32_i24 v110, v122, s44, v51
    v_mad_u32_u24 v51, v122, 40, v121
    v_mad_i32_i24 v15, v120, s39, v15
    v_lshlrev_b16 v51, 2, v51
    v_mad_i32_i24 v120, v121, -3, v120
    ds_add_u32 v51, v3 offset:0
    v_lshl_or_b32 v15, v110, 16, v15
    v_lshl_or_b32 v15, v120, 30, v15
    v_lshrrev_b32 v118, 3, v117
    v_lshrrev_b32 v119, 8, v117
    v_lshlrev_b16 v117, 13, v117
    v_bitop3_b32 v119, v118, v119, v124 bitop3:0x1b
    v_bitop3_b32 v14, v117, v125, v14 bitop3:0xae
    v_lshl_or_b32 v50, v119, 16, v50
    v_bitop3_b32 v15, v118, v125, v15 bitop3:0xae
    v_bitop3_b32 v51, v119, v126, v51 bitop3:0xea
p1_k3:
    s_cmp_lt_u32 s29, 1338
    s_cselect_b32 s6, 204800000, 0
    s_add_u32 s32, s30, 98304
    buffer_load_dwordx4 v[28:31], v1, s[4:7], s32 offen nt
    s_cmp_lt_u32 s29, 1338
    s_cselect_b32 s10, 204800000, 0
    s_add_u32 s32, s30, 98304
    buffer_load_dwordx4 v[64:67], v1, s[8:11], s32 offen nt
    s_cmp_ge_u32 s29, 1419
    s_cbranch_scc1 p1_k5
    s_waitcnt vmcnt(5)
    v_lshlrev_b32 v117, 16, v82
    v_and_b32 v118, v126, v82
    v_mul_f32 v117, v123, v117
    v_mul_f32 v118, v123, v118
    v_cvt_pk_bf16_f32 v117, v117, v118
    v_and_b32 v118, v126, v117
    v_lshlrev_b32 v117, 16, v117
    v_mul_f32 v117, 0.15915494, v117
    v_mul_f32 v118, 0.15915494, v118
    v_fract_f32 v117, v117
    v_fract_f32 v118, v118
    v_cos_f32 v117, v117
    v_cos_f32 v118, v118
    v_mul_hi_u32_u24 v122, s38, v52
    v_mul_hi_u32_u24 v121, s37, v16
    v_mul_hi_u32_u24 v120, s36, v16
    v_mad_i32_i24 v110, v122, s44, v52
    v_mad_u32_u24 v52, v122, 40, v121
    v_mad_i32_i24 v16, v120, s39, v16
    v_lshlrev_b16 v52, 2, v52
    v_mad_i32_i24 v120, v121, -3, v120
    ds_add_u32 v52, v3 offset:0
    v_lshl_or_b32 v16, v110, 16, v16
    v_lshl_or_b32 v16, v120, 30, v16
    v_mul_f32 v117, 0x03800000, v117
    v_mul_f32 v118, 0x03800000, v118
    v_cvt_pk_bf16_f32 v117, v117, v118
    v_mul_hi_u32_u24 v122, s38, v53
    v_mul_hi_u32_u24 v121, s37, v17
    v_mul_hi_u32_u24 v120, s36, v17
    v_mad_i32_i24 v110, v122, s44, v53
    v_mad_u32_u24 v53, v122, 40, v121
    v_mad_i32_i24 v17, v120, s39, v17
    v_lshlrev_b16 v53, 2, v53
    v_mad_i32_i24 v120, v121, -3, v120
    ds_add_u32 v53, v3 offset:0
    v_lshl_or_b32 v17, v110, 16, v17
    v_lshl_or_b32 v17, v120, 30, v17
    v_lshrrev_b32 v118, 3, v117
    v_lshrrev_b32 v119, 8, v117
    v_lshlrev_b16 v117, 13, v117
    v_bitop3_b32 v119, v118, v119, v124 bitop3:0x1b
    v_bitop3_b32 v16, v117, v125, v16 bitop3:0xae
    v_lshl_or_b32 v52, v119, 16, v52
    v_bitop3_b32 v17, v118, v125, v17 bitop3:0xae
    v_bitop3_b32 v53, v119, v126, v53 bitop3:0xea
    v_lshlrev_b32 v117, 16, v83
    v_and_b32 v118, v126, v83
    v_mul_f32 v117, v123, v117
    v_mul_f32 v118, v123, v118
    v_cvt_pk_bf16_f32 v117, v117, v118
    v_and_b32 v118, v126, v117
    v_lshlrev_b32 v117, 16, v117
    v_mul_f32 v117, 0.15915494, v117
    v_mul_f32 v118, 0.15915494, v118
    v_fract_f32 v117, v117
    v_fract_f32 v118, v118
    v_cos_f32 v117, v117
    v_cos_f32 v118, v118
    v_mul_hi_u32_u24 v122, s38, v54
    v_mul_hi_u32_u24 v121, s37, v18
    v_mul_hi_u32_u24 v120, s36, v18
    v_mad_i32_i24 v110, v122, s44, v54
    v_mad_u32_u24 v54, v122, 40, v121
    v_mad_i32_i24 v18, v120, s39, v18
    v_lshlrev_b16 v54, 2, v54
    v_mad_i32_i24 v120, v121, -3, v120
    ds_add_u32 v54, v3 offset:0
    v_lshl_or_b32 v18, v110, 16, v18
    v_lshl_or_b32 v18, v120, 30, v18
    v_mul_f32 v117, 0x03800000, v117
    v_mul_f32 v118, 0x03800000, v118
    v_cvt_pk_bf16_f32 v117, v117, v118
    v_mul_hi_u32_u24 v122, s38, v55
    v_mul_hi_u32_u24 v121, s37, v19
    v_mul_hi_u32_u24 v120, s36, v19
    v_mad_i32_i24 v110, v122, s44, v55
    v_mad_u32_u24 v55, v122, 40, v121
    v_mad_i32_i24 v19, v120, s39, v19
    v_lshlrev_b16 v55, 2, v55
    v_mad_i32_i24 v120, v121, -3, v120
    ds_add_u32 v55, v3 offset:0
    v_lshl_or_b32 v19, v110, 16, v19
    v_lshl_or_b32 v19, v120, 30, v19
    v_lshrrev_b32 v118, 3, v117
    v_lshrrev_b32 v119, 8, v117
    v_lshlrev_b16 v117, 13, v117
    v_bitop3_b32 v119, v118, v119, v124 bitop3:0x1b
    v_bitop3_b32 v18, v117, v125, v18 bitop3:0xae
    v_lshl_or_b32 v54, v119, 16, v54
    v_bitop3_b32 v19, v118, v125, v19 bitop3:0xae
    v_bitop3_b32 v55, v119, v126, v55 bitop3:0xea
p1_k5:
    s_cmp_lt_u32 s29, 1312
    s_cselect_b32 s6, 204800000, 0
    s_add_u32 s32, s30, 114688
    buffer_load_dwordx4 v[32:35], v1, s[4:7], s32 offen nt
    s_cmp_ge_u32 s29, 1392
    s_cbranch_scc1 p1_k7
    s_waitcnt vmcnt(4)
    v_lshlrev_b32 v117, 16, v84
    v_and_b32 v118, v126, v84
    v_mul_f32 v117, v123, v117
    v_mul_f32 v118, v123, v118
    v_cvt_pk_bf16_f32 v117, v117, v118
    v_and_b32 v118, v126, v117
    v_lshlrev_b32 v117, 16, v117
    v_mul_f32 v117, 0.15915494, v117
    v_mul_f32 v118, 0.15915494, v118
    v_fract_f32 v117, v117
    v_fract_f32 v118, v118
    v_cos_f32 v117, v117
    v_cos_f32 v118, v118
    v_mul_hi_u32_u24 v122, s38, v56
    v_mul_hi_u32_u24 v121, s37, v20
    v_mul_hi_u32_u24 v120, s36, v20
    v_mad_i32_i24 v110, v122, s44, v56
    v_mad_u32_u24 v56, v122, 40, v121
    v_mad_i32_i24 v20, v120, s39, v20
    v_lshlrev_b16 v56, 2, v56
    v_mad_i32_i24 v120, v121, -3, v120
    ds_add_u32 v56, v3 offset:0
    v_lshl_or_b32 v20, v110, 16, v20
    v_lshl_or_b32 v20, v120, 30, v20
    v_mul_f32 v117, 0x03800000, v117
    v_mul_f32 v118, 0x03800000, v118
    v_cvt_pk_bf16_f32 v117, v117, v118
    v_mul_hi_u32_u24 v122, s38, v57
    v_mul_hi_u32_u24 v121, s37, v21
    v_mul_hi_u32_u24 v120, s36, v21
    v_mad_i32_i24 v110, v122, s44, v57
    v_mad_u32_u24 v57, v122, 40, v121
    v_mad_i32_i24 v21, v120, s39, v21
    v_lshlrev_b16 v57, 2, v57
    v_mad_i32_i24 v120, v121, -3, v120
    ds_add_u32 v57, v3 offset:0
    v_lshl_or_b32 v21, v110, 16, v21
    v_lshl_or_b32 v21, v120, 30, v21
    v_lshrrev_b32 v118, 3, v117
    v_lshrrev_b32 v119, 8, v117
    v_lshlrev_b16 v117, 13, v117
    v_bitop3_b32 v119, v118, v119, v124 bitop3:0x1b
    v_bitop3_b32 v20, v117, v125, v20 bitop3:0xae
    v_lshl_or_b32 v56, v119, 16, v56
    v_bitop3_b32 v21, v118, v125, v21 bitop3:0xae
    v_bitop3_b32 v57, v119, v126, v57 bitop3:0xea
    v_lshlrev_b32 v117, 16, v85
    v_and_b32 v118, v126, v85
    v_mul_f32 v117, v123, v117
    v_mul_f32 v118, v123, v118
    v_cvt_pk_bf16_f32 v117, v117, v118
    v_and_b32 v118, v126, v117
    v_lshlrev_b32 v117, 16, v117
    v_mul_f32 v117, 0.15915494, v117
    v_mul_f32 v118, 0.15915494, v118
    v_fract_f32 v117, v117
    v_fract_f32 v118, v118
    v_cos_f32 v117, v117
    v_cos_f32 v118, v118
    v_mul_hi_u32_u24 v122, s38, v58
    v_mul_hi_u32_u24 v121, s37, v22
    v_mul_hi_u32_u24 v120, s36, v22
    v_mad_i32_i24 v110, v122, s44, v58
    v_mad_u32_u24 v58, v122, 40, v121
    v_mad_i32_i24 v22, v120, s39, v22
    v_lshlrev_b16 v58, 2, v58
    v_mad_i32_i24 v120, v121, -3, v120
    ds_add_u32 v58, v3 offset:0
    v_lshl_or_b32 v22, v110, 16, v22
    v_lshl_or_b32 v22, v120, 30, v22
    v_mul_f32 v117, 0x03800000, v117
    v_mul_f32 v118, 0x03800000, v118
    v_cvt_pk_bf16_f32 v117, v117, v118
    v_mul_hi_u32_u24 v122, s38, v59
    v_mul_hi_u32_u24 v121, s37, v23
    v_mul_hi_u32_u24 v120, s36, v23
    v_mad_i32_i24 v110, v122, s44, v59
    v_mad_u32_u24 v59, v122, 40, v121
    v_mad_i32_i24 v23, v120, s39, v23
    v_lshlrev_b16 v59, 2, v59
    v_mad_i32_i24 v120, v121, -3, v120
    ds_add_u32 v59, v3 offset:0
    v_lshl_or_b32 v23, v110, 16, v23
    v_lshl_or_b32 v23, v120, 30, v23
    v_lshrrev_b32 v118, 3, v117
    v_lshrrev_b32 v119, 8, v117
    v_lshlrev_b16 v117, 13, v117
    v_bitop3_b32 v119, v118, v119, v124 bitop3:0x1b
    v_bitop3_b32 v22, v117, v125, v22 bitop3:0xae
    v_lshl_or_b32 v58, v119, 16, v58
    v_bitop3_b32 v23, v118, v125, v23 bitop3:0xae
    v_bitop3_b32 v59, v119, v126, v59 bitop3:0xea
p1_k7:
    s_cmp_lt_u32 s29, 1285
    s_cselect_b32 s6, 204800000, 0
    s_add_u32 s32, s30, 131072
    buffer_load_dwordx4 v[36:39], v1, s[4:7], s32 offen nt
    s_cmp_lt_u32 s29, 1285
    s_cselect_b32 s10, 204800000, 0
    s_add_u32 s32, s30, 131072
    buffer_load_dwordx4 v[72:75], v1, s[8:11], s32 offen nt
    s_cmp_ge_u32 s29, 1365
    s_cbranch_scc1 p1_k9
    s_waitcnt vmcnt(5)
    v_lshlrev_b32 v117, 16, v86
    v_and_b32 v118, v126, v86
    v_mul_f32 v117, v123, v117
    v_mul_f32 v118, v123, v118
    v_cvt_pk_bf16_f32 v117, v117, v118
    v_and_b32 v118, v126, v117
    v_lshlrev_b32 v117, 16, v117
    v_mul_f32 v117, 0.15915494, v117
    v_mul_f32 v118, 0.15915494, v118
    v_fract_f32 v117, v117
    v_fract_f32 v118, v118
    v_cos_f32 v117, v117
    v_cos_f32 v118, v118
    v_mul_hi_u32_u24 v122, s38, v60
    v_mul_hi_u32_u24 v121, s37, v24
    v_mul_hi_u32_u24 v120, s36, v24
    v_mad_i32_i24 v110, v122, s44, v60
    v_mad_u32_u24 v60, v122, 40, v121
    v_mad_i32_i24 v24, v120, s39, v24
    v_lshlrev_b16 v60, 2, v60
    v_mad_i32_i24 v120, v121, -3, v120
    ds_add_u32 v60, v3 offset:0
    v_lshl_or_b32 v24, v110, 16, v24
    v_lshl_or_b32 v24, v120, 30, v24
    v_mul_f32 v117, 0x03800000, v117
    v_mul_f32 v118, 0x03800000, v118
    v_cvt_pk_bf16_f32 v117, v117, v118
    v_mul_hi_u32_u24 v122, s38, v61
    v_mul_hi_u32_u24 v121, s37, v25
    v_mul_hi_u32_u24 v120, s36, v25
    v_mad_i32_i24 v110, v122, s44, v61
    v_mad_u32_u24 v61, v122, 40, v121
    v_mad_i32_i24 v25, v120, s39, v25
    v_lshlrev_b16 v61, 2, v61
    v_mad_i32_i24 v120, v121, -3, v120
    ds_add_u32 v61, v3 offset:0
    v_lshl_or_b32 v25, v110, 16, v25
    v_lshl_or_b32 v25, v120, 30, v25
    v_lshrrev_b32 v118, 3, v117
    v_lshrrev_b32 v119, 8, v117
    v_lshlrev_b16 v117, 13, v117
    v_bitop3_b32 v119, v118, v119, v124 bitop3:0x1b
    v_bitop3_b32 v24, v117, v125, v24 bitop3:0xae
    v_lshl_or_b32 v60, v119, 16, v60
    v_bitop3_b32 v25, v118, v125, v25 bitop3:0xae
    v_bitop3_b32 v61, v119, v126, v61 bitop3:0xea
    v_lshlrev_b32 v117, 16, v87
    v_and_b32 v118, v126, v87
    v_mul_f32 v117, v123, v117
    v_mul_f32 v118, v123, v118
    v_cvt_pk_bf16_f32 v117, v117, v118
    v_and_b32 v118, v126, v117
    v_lshlrev_b32 v117, 16, v117
    v_mul_f32 v117, 0.15915494, v117
    v_mul_f32 v118, 0.15915494, v118
    v_fract_f32 v117, v117
    v_fract_f32 v118, v118
    v_cos_f32 v117, v117
    v_cos_f32 v118, v118
    v_mul_hi_u32_u24 v122, s38, v62
    v_mul_hi_u32_u24 v121, s37, v26
    v_mul_hi_u32_u24 v120, s36, v26
    v_mad_i32_i24 v110, v122, s44, v62
    v_mad_u32_u24 v62, v122, 40, v121
    v_mad_i32_i24 v26, v120, s39, v26
    v_lshlrev_b16 v62, 2, v62
    v_mad_i32_i24 v120, v121, -3, v120
    ds_add_u32 v62, v3 offset:0
    v_lshl_or_b32 v26, v110, 16, v26
    v_lshl_or_b32 v26, v120, 30, v26
    v_mul_f32 v117, 0x03800000, v117
    v_mul_f32 v118, 0x03800000, v118
    v_cvt_pk_bf16_f32 v117, v117, v118
    v_mul_hi_u32_u24 v122, s38, v63
    v_mul_hi_u32_u24 v121, s37, v27
    v_mul_hi_u32_u24 v120, s36, v27
    v_mad_i32_i24 v110, v122, s44, v63
    v_mad_u32_u24 v63, v122, 40, v121
    v_mad_i32_i24 v27, v120, s39, v27
    v_lshlrev_b16 v63, 2, v63
    v_mad_i32_i24 v120, v121, -3, v120
    ds_add_u32 v63, v3 offset:0
    v_lshl_or_b32 v27, v110, 16, v27
    v_lshl_or_b32 v27, v120, 30, v27
    v_lshrrev_b32 v118, 3, v117
    v_lshrrev_b32 v119, 8, v117
    v_lshlrev_b16 v117, 13, v117
    v_bitop3_b32 v119, v118, v119, v124 bitop3:0x1b
    v_bitop3_b32 v26, v117, v125, v26 bitop3:0xae
    v_lshl_or_b32 v62, v119, 16, v62
    v_bitop3_b32 v27, v118, v125, v27 bitop3:0xae
    v_bitop3_b32 v63, v119, v126, v63 bitop3:0xea
p1_k9:
    s_cmp_ge_u32 s29, 1338
    s_cbranch_scc1 p1_k11
    s_waitcnt vmcnt(3)
    v_lshlrev_b32 v117, 16, v88
    v_and_b32 v118, v126, v88
    v_mul_f32 v117, v123, v117
    v_mul_f32 v118, v123, v118
    v_cvt_pk_bf16_f32 v117, v117, v118
    v_and_b32 v118, v126, v117
    v_lshlrev_b32 v117, 16, v117
    v_mul_f32 v117, 0.15915494, v117
    v_mul_f32 v118, 0.15915494, v118
    v_fract_f32 v117, v117
    v_fract_f32 v118, v118
    v_cos_f32 v117, v117
    v_cos_f32 v118, v118
    v_mul_hi_u32_u24 v122, s38, v64
    v_mul_hi_u32_u24 v121, s37, v28
    v_mul_hi_u32_u24 v120, s36, v28
    v_mad_i32_i24 v110, v122, s44, v64
    v_mad_u32_u24 v64, v122, 40, v121
    v_mad_i32_i24 v28, v120, s39, v28
    v_lshlrev_b16 v64, 2, v64
    v_mad_i32_i24 v120, v121, -3, v120
    ds_add_u32 v64, v3 offset:0
    v_lshl_or_b32 v28, v110, 16, v28
    v_lshl_or_b32 v28, v120, 30, v28
    v_mul_f32 v117, 0x03800000, v117
    v_mul_f32 v118, 0x03800000, v118
    v_cvt_pk_bf16_f32 v117, v117, v118
    v_mul_hi_u32_u24 v122, s38, v65
    v_mul_hi_u32_u24 v121, s37, v29
    v_mul_hi_u32_u24 v120, s36, v29
    v_mad_i32_i24 v110, v122, s44, v65
    v_mad_u32_u24 v65, v122, 40, v121
    v_mad_i32_i24 v29, v120, s39, v29
    v_lshlrev_b16 v65, 2, v65
    v_mad_i32_i24 v120, v121, -3, v120
    ds_add_u32 v65, v3 offset:0
    v_lshl_or_b32 v29, v110, 16, v29
    v_lshl_or_b32 v29, v120, 30, v29
    v_lshrrev_b32 v118, 3, v117
    v_lshrrev_b32 v119, 8, v117
    v_lshlrev_b16 v117, 13, v117
    v_bitop3_b32 v119, v118, v119, v124 bitop3:0x1b
    v_bitop3_b32 v28, v117, v125, v28 bitop3:0xae
    v_lshl_or_b32 v64, v119, 16, v64
    v_bitop3_b32 v29, v118, v125, v29 bitop3:0xae
    v_bitop3_b32 v65, v119, v126, v65 bitop3:0xea
    v_lshlrev_b32 v117, 16, v89
    v_and_b32 v118, v126, v89
    v_mul_f32 v117, v123, v117
    v_mul_f32 v118, v123, v118
    v_cvt_pk_bf16_f32 v117, v117, v118
    v_and_b32 v118, v126, v117
    v_lshlrev_b32 v117, 16, v117
    v_mul_f32 v117, 0.15915494, v117
    v_mul_f32 v118, 0.15915494, v118
    v_fract_f32 v117, v117
    v_fract_f32 v118, v118
    v_cos_f32 v117, v117
    v_cos_f32 v118, v118
    v_mul_hi_u32_u24 v122, s38, v66
    v_mul_hi_u32_u24 v121, s37, v30
    v_mul_hi_u32_u24 v120, s36, v30
    v_mad_i32_i24 v110, v122, s44, v66
    v_mad_u32_u24 v66, v122, 40, v121
    v_mad_i32_i24 v30, v120, s39, v30
    v_lshlrev_b16 v66, 2, v66
    v_mad_i32_i24 v120, v121, -3, v120
    ds_add_u32 v66, v3 offset:0
    v_lshl_or_b32 v30, v110, 16, v30
    v_lshl_or_b32 v30, v120, 30, v30
    v_mul_f32 v117, 0x03800000, v117
    v_mul_f32 v118, 0x03800000, v118
    v_cvt_pk_bf16_f32 v117, v117, v118
    v_mul_hi_u32_u24 v122, s38, v67
    v_mul_hi_u32_u24 v121, s37, v31
    v_mul_hi_u32_u24 v120, s36, v31
    v_mad_i32_i24 v110, v122, s44, v67
    v_mad_u32_u24 v67, v122, 40, v121
    v_mad_i32_i24 v31, v120, s39, v31
    v_lshlrev_b16 v67, 2, v67
    v_mad_i32_i24 v120, v121, -3, v120
    ds_add_u32 v67, v3 offset:0
    v_lshl_or_b32 v31, v110, 16, v31
    v_lshl_or_b32 v31, v120, 30, v31
    v_lshrrev_b32 v118, 3, v117
    v_lshrrev_b32 v119, 8, v117
    v_lshlrev_b16 v117, 13, v117
    v_bitop3_b32 v119, v118, v119, v124 bitop3:0x1b
    v_bitop3_b32 v30, v117, v125, v30 bitop3:0xae
    v_lshl_or_b32 v66, v119, 16, v66
    v_bitop3_b32 v31, v118, v125, v31 bitop3:0xae
    v_bitop3_b32 v67, v119, v126, v67 bitop3:0xea
p1_k11:
    s_cmp_ge_u32 s29, 1312
    s_cbranch_scc1 p1_k13
    s_waitcnt vmcnt(2)
    v_lshlrev_b32 v117, 16, v90
    v_and_b32 v118, v126, v90
    v_mul_f32 v117, v123, v117
    v_mul_f32 v118, v123, v118
    v_cvt_pk_bf16_f32 v117, v117, v118
    v_and_b32 v118, v126, v117
    v_lshlrev_b32 v117, 16, v117
    v_mul_f32 v117, 0.15915494, v117
    v_mul_f32 v118, 0.15915494, v118
    v_fract_f32 v117, v117
    v_fract_f32 v118, v118
    v_cos_f32 v117, v117
    v_cos_f32 v118, v118
    v_mul_hi_u32_u24 v122, s38, v68
    v_mul_hi_u32_u24 v121, s37, v32
    v_mul_hi_u32_u24 v120, s36, v32
    v_mad_i32_i24 v110, v122, s44, v68
    v_mad_u32_u24 v68, v122, 40, v121
    v_mad_i32_i24 v32, v120, s39, v32
    v_lshlrev_b16 v68, 2, v68
    v_mad_i32_i24 v120, v121, -3, v120
    ds_add_u32 v68, v3 offset:0
    v_lshl_or_b32 v32, v110, 16, v32
    v_lshl_or_b32 v32, v120, 30, v32
    v_mul_f32 v117, 0x03800000, v117
    v_mul_f32 v118, 0x03800000, v118
    v_cvt_pk_bf16_f32 v117, v117, v118
    v_mul_hi_u32_u24 v122, s38, v69
    v_mul_hi_u32_u24 v121, s37, v33
    v_mul_hi_u32_u24 v120, s36, v33
    v_mad_i32_i24 v110, v122, s44, v69
    v_mad_u32_u24 v69, v122, 40, v121
    v_mad_i32_i24 v33, v120, s39, v33
    v_lshlrev_b16 v69, 2, v69
    v_mad_i32_i24 v120, v121, -3, v120
    ds_add_u32 v69, v3 offset:0
    v_lshl_or_b32 v33, v110, 16, v33
    v_lshl_or_b32 v33, v120, 30, v33
    v_lshrrev_b32 v118, 3, v117
    v_lshrrev_b32 v119, 8, v117
    v_lshlrev_b16 v117, 13, v117
    v_bitop3_b32 v119, v118, v119, v124 bitop3:0x1b
    v_bitop3_b32 v32, v117, v125, v32 bitop3:0xae
    v_lshl_or_b32 v68, v119, 16, v68
    v_bitop3_b32 v33, v118, v125, v33 bitop3:0xae
    v_bitop3_b32 v69, v119, v126, v69 bitop3:0xea
    v_lshlrev_b32 v117, 16, v91
    v_and_b32 v118, v126, v91
    v_mul_f32 v117, v123, v117
    v_mul_f32 v118, v123, v118
    v_cvt_pk_bf16_f32 v117, v117, v118
    v_and_b32 v118, v126, v117
    v_lshlrev_b32 v117, 16, v117
    v_mul_f32 v117, 0.15915494, v117
    v_mul_f32 v118, 0.15915494, v118
    v_fract_f32 v117, v117
    v_fract_f32 v118, v118
    v_cos_f32 v117, v117
    v_cos_f32 v118, v118
    v_mul_hi_u32_u24 v122, s38, v70
    v_mul_hi_u32_u24 v121, s37, v34
    v_mul_hi_u32_u24 v120, s36, v34
    v_mad_i32_i24 v110, v122, s44, v70
    v_mad_u32_u24 v70, v122, 40, v121
    v_mad_i32_i24 v34, v120, s39, v34
    v_lshlrev_b16 v70, 2, v70
    v_mad_i32_i24 v120, v121, -3, v120
    ds_add_u32 v70, v3 offset:0
    v_lshl_or_b32 v34, v110, 16, v34
    v_lshl_or_b32 v34, v120, 30, v34
    v_mul_f32 v117, 0x03800000, v117
    v_mul_f32 v118, 0x03800000, v118
    v_cvt_pk_bf16_f32 v117, v117, v118
    v_mul_hi_u32_u24 v122, s38, v71
    v_mul_hi_u32_u24 v121, s37, v35
    v_mul_hi_u32_u24 v120, s36, v35
    v_mad_i32_i24 v110, v122, s44, v71
    v_mad_u32_u24 v71, v122, 40, v121
    v_mad_i32_i24 v35, v120, s39, v35
    v_lshlrev_b16 v71, 2, v71
    v_mad_i32_i24 v120, v121, -3, v120
    ds_add_u32 v71, v3 offset:0
    v_lshl_or_b32 v35, v110, 16, v35
    v_lshl_or_b32 v35, v120, 30, v35
    v_lshrrev_b32 v118, 3, v117
    v_lshrrev_b32 v119, 8, v117
    v_lshlrev_b16 v117, 13, v117
    v_bitop3_b32 v119, v118, v119, v124 bitop3:0x1b
    v_bitop3_b32 v34, v117, v125, v34 bitop3:0xae
    v_lshl_or_b32 v70, v119, 16, v70
    v_bitop3_b32 v35, v118, v125, v35 bitop3:0xae
    v_bitop3_b32 v71, v119, v126, v71 bitop3:0xea
p1_k13:
    s_cmp_ge_u32 s29, 1285
    s_cbranch_scc1 p1_k15
    s_waitcnt vmcnt(0)
    v_lshlrev_b32 v117, 16, v92
    v_and_b32 v118, v126, v92
    v_mul_f32 v117, v123, v117
    v_mul_f32 v118, v123, v118
    v_cvt_pk_bf16_f32 v117, v117, v118
    v_and_b32 v118, v126, v117
    v_lshlrev_b32 v117, 16, v117
    v_mul_f32 v117, 0.15915494, v117
    v_mul_f32 v118, 0.15915494, v118
    v_fract_f32 v117, v117
    v_fract_f32 v118, v118
    v_cos_f32 v117, v117
    v_cos_f32 v118, v118
    v_mul_hi_u32_u24 v122, s38, v72
    v_mul_hi_u32_u24 v121, s37, v36
    v_mul_hi_u32_u24 v120, s36, v36
    v_mad_i32_i24 v110, v122, s44, v72
    v_mad_u32_u24 v72, v122, 40, v121
    v_mad_i32_i24 v36, v120, s39, v36
    v_lshlrev_b16 v72, 2, v72
    v_mad_i32_i24 v120, v121, -3, v120
    ds_add_u32 v72, v3 offset:0
    v_lshl_or_b32 v36, v110, 16, v36
    v_lshl_or_b32 v36, v120, 30, v36
    v_mul_f32 v117, 0x03800000, v117
    v_mul_f32 v118, 0x03800000, v118
    v_cvt_pk_bf16_f32 v117, v117, v118
    v_mul_hi_u32_u24 v122, s38, v73
    v_mul_hi_u32_u24 v121, s37, v37
    v_mul_hi_u32_u24 v120, s36, v37
    v_mad_i32_i24 v110, v122, s44, v73
    v_mad_u32_u24 v73, v122, 40, v121
    v_mad_i32_i24 v37, v120, s39, v37
    v_lshlrev_b16 v73, 2, v73
    v_mad_i32_i24 v120, v121, -3, v120
    ds_add_u32 v73, v3 offset:0
    v_lshl_or_b32 v37, v110, 16, v37
    v_lshl_or_b32 v37, v120, 30, v37
    v_lshrrev_b32 v118, 3, v117
    v_lshrrev_b32 v119, 8, v117
    v_lshlrev_b16 v117, 13, v117
    v_bitop3_b32 v119, v118, v119, v124 bitop3:0x1b
    v_bitop3_b32 v36, v117, v125, v36 bitop3:0xae
    v_lshl_or_b32 v72, v119, 16, v72
    v_bitop3_b32 v37, v118, v125, v37 bitop3:0xae
    v_bitop3_b32 v73, v119, v126, v73 bitop3:0xea
    v_lshlrev_b32 v117, 16, v93
    v_and_b32 v118, v126, v93
    v_mul_f32 v117, v123, v117
    v_mul_f32 v118, v123, v118
    v_cvt_pk_bf16_f32 v117, v117, v118
    v_and_b32 v118, v126, v117
    v_lshlrev_b32 v117, 16, v117
    v_mul_f32 v117, 0.15915494, v117
    v_mul_f32 v118, 0.15915494, v118
    v_fract_f32 v117, v117
    v_fract_f32 v118, v118
    v_cos_f32 v117, v117
    v_cos_f32 v118, v118
    v_mul_hi_u32_u24 v122, s38, v74
    v_mul_hi_u32_u24 v121, s37, v38
    v_mul_hi_u32_u24 v120, s36, v38
    v_mad_i32_i24 v110, v122, s44, v74
    v_mad_u32_u24 v74, v122, 40, v121
    v_mad_i32_i24 v38, v120, s39, v38
    v_lshlrev_b16 v74, 2, v74
    v_mad_i32_i24 v120, v121, -3, v120
    ds_add_u32 v74, v3 offset:0
    v_lshl_or_b32 v38, v110, 16, v38
    v_lshl_or_b32 v38, v120, 30, v38
    v_mul_f32 v117, 0x03800000, v117
    v_mul_f32 v118, 0x03800000, v118
    v_cvt_pk_bf16_f32 v117, v117, v118
    v_mul_hi_u32_u24 v122, s38, v75
    v_mul_hi_u32_u24 v121, s37, v39
    v_mul_hi_u32_u24 v120, s36, v39
    v_mad_i32_i24 v110, v122, s44, v75
    v_mad_u32_u24 v75, v122, 40, v121
    v_mad_i32_i24 v39, v120, s39, v39
    v_lshlrev_b16 v75, 2, v75
    v_mad_i32_i24 v120, v121, -3, v120
    ds_add_u32 v75, v3 offset:0
    v_lshl_or_b32 v39, v110, 16, v39
    v_lshl_or_b32 v39, v120, 30, v39
    v_lshrrev_b32 v118, 3, v117
    v_lshrrev_b32 v119, 8, v117
    v_lshlrev_b16 v117, 13, v117
    v_bitop3_b32 v119, v118, v119, v124 bitop3:0x1b
    v_bitop3_b32 v38, v117, v125, v38 bitop3:0xae
    v_lshl_or_b32 v74, v119, 16, v74
    v_bitop3_b32 v39, v118, v125, v39 bitop3:0xae
    v_bitop3_b32 v75, v119, v126, v75 bitop3:0xea
p1_k15:
    s_waitcnt vmcnt(0)
    s_cmp_lg_u32 s28, 15
    s_cbranch_scc1 p1_tk1
    v_mov_b32 v126, 0
    s_mov_b64 exec, 1
    ds_write_b32 v126, v127 offset:10456
    s_mov_b64 exec, -1
p1_tk1:
    s_waitcnt lgkmcnt(0)
    s_barrier
    s_cmp_ge_u32 s28, 10
    s_cbranch_scc1 p1_s1_skip
    v_and_b32 v126, 63, v0
    s_lshl_b32 s54, s28, 4
    v_mul_u32_u24 v117, 160, v126
    v_add_u32 v117, s54, v117
    ds_read_b128 v[118:121], v117 offset:0
    s_waitcnt lgkmcnt(0)
    v_add_u32 v118, 2, v118
    v_add_u32 v119, 2, v119
    v_add_u32 v120, 2, v120
    v_add_u32 v121, 2, v121
    v_mul_u32_u24 v118, 43691, v118
    v_mul_u32_u24 v119, 43691, v119
    v_mul_u32_u24 v120, 43691, v120
    v_mul_u32_u24 v121, 43691, v121
    v_lshrrev_b32 v118, 17, v118
    v_lshrrev_b32 v119, 17, v119
    v_lshrrev_b32 v120, 17, v120
    v_lshrrev_b32 v121, 17, v121
    v_lshl_or_b32 v122, v119, 16, v118
    v_lshl_or_b32 v123, v121, 16, v120
    v_mov_b32 v124, v122
    v_mov_b32 v125, v123
    s_nop 1
    v_add_u32_dpp v124, v124, v124 row_shr:1 row_mask:0xf bank_mask:0xf bound_ctrl:0
    v_add_u32_dpp v125, v125, v125 row_shr:1 row_mask:0xf bank_mask:0xf bound_ctrl:0
    s_nop 0
    v_add_u32_dpp v124, v124, v124 row_shr:2 row_mask:0xf bank_mask:0xf bound_ctrl:0
    v_add_u32_dpp v125, v125, v125 row_shr:2 row_mask:0xf bank_mask:0xf bound_ctrl:0
    s_nop 0
    v_add_u32_dpp v124, v124, v124 row_shr:4 row_mask:0xf bank_mask:0xf bound_ctrl:0
    v_add_u32_dpp v125, v125, v125 row_shr:4 row_mask:0xf bank_mask:0xf bound_ctrl:0
    s_nop 0
    v_add_u32_dpp v124, v124, v124 row_shr:8 row_mask:0xf bank_mask:0xf bound_ctrl:0
    v_add_u32_dpp v125, v125, v125 row_shr:8 row_mask:0xf bank_mask:0xf bound_ctrl:0
    s_nop 0
    v_add_u32_dpp v124, v124, v124 row_bcast:15 row_mask:0xa bank_mask:0xf
    v_add_u32_dpp v125, v125, v125 row_bcast:15 row_mask:0xa bank_mask:0xf
    s_nop 0
    v_add_u32_dpp v124, v124, v124 row_bcast:31 row_mask:0xc bank_mask:0xf
    v_add_u32_dpp v125, v125, v125 row_bcast:31 row_mask:0xc bank_mask:0xf
    s_nop 0
    s_nop 0
    v_mov_b32 v127, s54
    v_and_b32 v118, 0xffff, v124
    v_lshrrev_b32 v119, 16, v124
    v_and_b32 v120, 0xffff, v125
    v_lshrrev_b32 v121, 16, v125
    s_mov_b64 exec, 1
    s_lshl_b64 exec, exec, 63
    ds_write_b128 v127, v[118:121] offset:10240
    s_mov_b64 exec, -1
p1_s1_skip:
    s_waitcnt lgkmcnt(0)
    s_barrier
    v_and_b32 v127, 63, v0
    v_lshlrev_b32 v118, 2, v127
    v_cmp_gt_u32 vcc, 40, v127
    ds_read_b32 v119, v118 offset:10240
    s_waitcnt lgkmcnt(0)
    v_readlane_b32 s33, v119, 54
    v_cndmask_b32 v119, 0, v119, vcc
    v_mov_b32 v120, v119
    s_nop 1
    v_add_u32_dpp v120, v120, v120 row_shr:1 row_mask:0xf bank_mask:0xf bound_ctrl:0
    s_nop 1
    v_add_u32_dpp v120, v120, v120 row_shr:2 row_mask:0xf bank_mask:0xf bound_ctrl:0
    s_nop 1
    v_add_u32_dpp v120, v120, v120 row_shr:4 row_mask:0xf bank_mask:0xf bound_ctrl:0
    s_nop 1
    v_add_u32_dpp v120, v120, v120 row_shr:8 row_mask:0xf bank_mask:0xf bound_ctrl:0
    s_nop 1
    v_add_u32_dpp v120, v120, v120 row_bcast:15 row_mask:0xa bank_mask:0xf
    s_nop 1
    v_add_u32_dpp v120, v120, v120 row_bcast:31 row_mask:0xc bank_mask:0xf
    s_nop 1
    s_nop 0
    v_sub_u32 v119, v120, v119
    v_readlane_b32 s35, v120, 63
    s_add_u32 s33, s33, 256
    s_mul_i32 s46, s33, 2
    s_min_u32 s47, s33, 1445
    s_add_u32 s46, s46, s47
    s_min_u32 s47, s33, 1419
    s_add_u32 s46, s46, s47
    s_min_u32 s47, s33, 1392
    s_add_u32 s46, s46, s47
    s_min_u32 s47, s33, 1365
    s_add_u32 s46, s46, s47
    s_min_u32 s47, s33, 1338
    s_add_u32 s46, s46, s47
    s_min_u32 s47, s33, 1312
    s_add_u32 s46, s46, s47
    s_min_u32 s47, s33, 1285
    s_add_u32 s46, s46, s47
    s_lshl_b32 s30, s46, 14
    s_lshl_b32 s31, s46, 13
    s_cmp_ge_u32 s28, 10
    s_cbranch_scc1 p1_s2_skip
    s_lshl_b32 s54, s28, 2
    s_add_u32 s55, s54, 0
    v_readlane_b32 s56, v119, s55
    s_add_u32 s55, s54, 1
    v_readlane_b32 s57, v119, s55
    s_add_u32 s55, s54, 2
    v_readlane_b32 s58, v119, s55
    s_add_u32 s55, s54, 3
    v_readlane_b32 s59, v119, s55
    s_nop 0
    s_lshl_b32 s57, s57, 16
    s_or_b32 s56, s56, s57
    s_lshl_b32 s59, s59, 16
    s_or_b32 s58, s58, s59
    v_add_u32 v124, s56, v124
    v_add_u32 v125, s58, v125
    v_sub_u32 v122, v124, v122
    v_sub_u32 v123, v125, v123
    v_and_b32 v118, 0xffff, v122
    v_lshrrev_b32 v119, 16, v122
    v_and_b32 v120, 0xffff, v123
    v_lshrrev_b32 v121, 16, v123
    v_mul_u32_u24 v118, 3, v118
    v_mul_u32_u24 v119, 3, v119
    v_mul_u32_u24 v120, 3, v120
    v_mul_u32_u24 v121, 3, v121
    ds_write_b128 v117, v[118:121] offset:0
    s_mul_i32 s55, s29, 5248
    s_mul_i32 s56, s28, 520
    s_add_u32 s55, s55, s56
    s_add_u32 s55, s55, 469745664
    v_lshlrev_b32 v127, 3, v126
    buffer_store_dwordx2 v[122:123], v127, s[16:19], s55 offen sc1
    s_mov_b64 exec, 1
    s_lshl_b64 exec, exec, 63
    buffer_store_dwordx2 v[124:125], v127, s[16:19], s55 offen offset:8 sc1
    s_mov_b64 exec, -1
p1_s2_skip:
    s_mul_i32 s50, s29, 16384
    s_lshr_b32 s52, s35, 10
    s_mul_i32 s52, s52, 33554432
    s_and_b32 s53, s35, 1023
    s_lshl_b32 s53, s53, 4
    s_add_u32 s52, s52, s53
    s_add_u32 s52, s52, s50
    s_min_u32 s22, s52, 469745664
    s_mov_b32 s68, 0
    s_cmp_lt_u32 s28, 2
    s_cselect_b32 s71, 10, 9
    s_cmp_lt_u32 s29, 1285
    s_cselect_b32 s35, 13994, s35
    s_waitcnt lgkmcnt(0)
    s_barrier
    s_cmp_lt_u32 s33, 1472
    s_cbranch_scc1 p1_f0
    s_cmp_lg_u32 s28, 15
    s_cbranch_scc1 p1_hv0
    s_sub_u32 s52, s33, 1472
    s_and_b32 s52, s52, 255
    s_lshl_b32 s58, s52, 2
    s_and_b32 s58, s58, 28
    s_lshl_b32 s53, 1, s58
    v_mov_b32 v127, s53
    s_lshr_b32 s52, s52, 3
    s_lshl_b32 s52, s52, 2
    s_mov_b64 exec, 1
    buffer_atomic_add v127, off, s[40:43], s52 sc0 sc1
    s_mov_b64 exec, -1
p1_hv0:
    s_cmp_ge_u32 s33, 1592
    s_cbranch_scc1 p1_f0
    s_sub_u32 s52, s33, 1472
    s_mul_i32 s52, s52, 53368
    s_mul_i32 s53, s28, 3072
    s_add_u32 s53, s53, s52
    v_and_b32 v92, 63, v0
    v_lshl_add_u32 v93, v92, 2, s53
    s_lshl_b32 s53, s28, 9
    s_add_u32 s53, s53, s52
    s_add_u32 s53, s53, 49152
    s_cmp_lt_u32 s28, 9
    s_cselect_b32 s53, s53, 0x40000000
    v_lshl_add_u32 v94, v92, 2, s53
    buffer_load_dword v76, v93, s[24:27], 0 offen offset:0
    buffer_load_dword v77, v93, s[24:27], 0 offen offset:256
    buffer_load_dword v78, v93, s[24:27], 0 offen offset:512
    buffer_load_dword v79, v93, s[24:27], 0 offen offset:768
    buffer_load_dword v80, v93, s[24:27], 0 offen offset:1024
    buffer_load_dword v81, v93, s[24:27], 0 offen offset:1280
    buffer_load_dword v82, v93, s[24:27], 0 offen offset:1536
    buffer_load_dword v83, v93, s[24:27], 0 offen offset:1792
    buffer_load_dword v84, v93, s[24:27], 0 offen offset:2048
    buffer_load_dword v85, v93, s[24:27], 0 offen offset:2304
    buffer_load_dword v86, v93, s[24:27], 0 offen offset:2560
    buffer_load_dword v87, v93, s[24:27], 0 offen offset:2816
    buffer_load_dword v88, v94, s[24:27], 0 offen offset:0
    buffer_load_dword v89, v94, s[24:27], 0 offen offset:256
p1_f0:
    v_and_b32 v117, 0xffff, v40
    ds_add_rtn_u32 v117, v117, v3 offset:0
    v_and_b32 v118, 0xffff, v41
    ds_add_rtn_u32 v118, v118, v3 offset:0
    v_and_b32 v119, 0xffff, v42
    ds_add_rtn_u32 v119, v119, v3 offset:0
    v_and_b32 v120, 0xffff, v43
    ds_add_rtn_u32 v120, v120, v3 offset:0
    s_cmp_ge_u32 s33, 1472
    s_cbranch_scc1 p1_k17
    s_cmp_lt_u32 s33, 1472
    s_cselect_b32 s6, 204800000, 0
    s_add_u32 s32, s30, 0
    buffer_load_dwordx4 v[94:97], v1, s[4:7], s32 offen nt
p1_k17:
    s_cmp_ge_u32 s33, 1472
    s_cbranch_scc1 p1_k18
    s_cmp_lt_u32 s33, 1472
    s_cselect_b32 s14, 102400000, 0
    s_add_u32 s32, s31, 0
    buffer_load_dwordx2 v[76:77], v2, s[12:15], s32 offen nt
p1_k18:
    s_cmp_ge_u32 s33, 1472
    s_cbranch_scc1 p1_k19
    s_cmp_lt_u32 s33, 1472
    s_cselect_b32 s14, 102400000, 0
    s_add_u32 s32, s31, 8192
    buffer_load_dwordx2 v[78:79], v2, s[12:15], s32 offen nt
p1_k19:
    s_cmp_lt_u32 s29, 1445
    s_cbranch_scc1 p1_pa0
    s_waitcnt lgkmcnt(0)
    s_branch p1_pb0
p1_pa0:
    v_and_b32 v121, 0xffff, v48
    ds_add_rtn_u32 v121, v121, v3 offset:0
    v_and_b32 v122, 0xffff, v49
    ds_add_rtn_u32 v122, v122, v3 offset:0
    v_and_b32 v123, 0xffff, v50
    ds_add_rtn_u32 v123, v123, v3 offset:0
    v_and_b32 v124, 0xffff, v51
    ds_add_rtn_u32 v124, v124, v3 offset:0
    s_waitcnt lgkmcnt(4)
p1_pb0:
    ds_write_b8_d16_hi v117, v40 offset:10496
    v_sub_u32 v40, 55295, v117
    v_lshlrev_b32 v117, 2, v117
    ds_write_b32 v117, v4 offset:52480
    ds_write_b8_d16_hi v118, v41 offset:10496
    v_sub_u32 v41, 55295, v118
    v_lshlrev_b32 v118, 2, v118
    ds_write_b32 v118, v5 offset:52480
    ds_write_b8_d16_hi v119, v42 offset:10496
    v_sub_u32 v42, 55295, v119
    v_lshlrev_b32 v119, 2, v119
    ds_write_b32 v119, v6 offset:52480
    ds_write_b8_d16_hi v120, v43 offset:10496
    v_sub_u32 v43, 55295, v120
    v_lshlrev_b32 v120, 2, v120
    ds_write_b32 v120, v7 offset:52480
    s_cmp_ge_u32 s33, 1472
    s_cbranch_scc1 p1_k20
    s_cmp_lt_u32 s33, 1472
    s_cselect_b32 s10, 204800000, 0
    s_add_u32 s32, s30, 0
    buffer_load_dwordx4 v[102:105], v1, s[8:11], s32 offen nt
p1_k20:
    s_cmp_ge_u32 s33, 1472
    s_cbranch_scc1 p1_k21
    s_cmp_lt_u32 s33, 1445
    s_cselect_b32 s14, 102400000, 0
    s_add_u32 s32, s31, 16384
    buffer_load_dwordx2 v[80:81], v2, s[12:15], s32 offen nt
p1_k21:
    s_cmp_ge_u32 s33, 1472
    s_cbranch_scc1 p1_k22
    s_cmp_lt_u32 s33, 1419
    s_cselect_b32 s14, 102400000, 0
    s_add_u32 s32, s31, 24576
    buffer_load_dwordx2 v[82:83], v2, s[12:15], s32 offen nt
p1_k22:
    v_and_b32 v117, 0xffff, v44
    ds_add_rtn_u32 v117, v117, v3 offset:0
    v_and_b32 v118, 0xffff, v45
    ds_add_rtn_u32 v118, v118, v3 offset:0
    v_and_b32 v119, 0xffff, v46
    ds_add_rtn_u32 v119, v119, v3 offset:0
    v_and_b32 v120, 0xffff, v47
    ds_add_rtn_u32 v120, v120, v3 offset:0
    s_waitcnt lgkmcnt(4)
    s_cmp_ge_u32 s29, 1445
    s_cbranch_scc1 p1_k23
    ds_write_b8_d16_hi v121, v48 offset:10496
    v_sub_u32 v48, 55295, v121
    v_lshlrev_b32 v121, 2, v121
    v_lshl_or_b32 v40, v48, 16, v40
    ds_write_b32 v121, v12 offset:52480
    ds_write_b8_d16_hi v122, v49 offset:10496
    v_sub_u32 v49, 55295, v122
    v_lshlrev_b32 v122, 2, v122
    v_lshl_or_b32 v41, v49, 16, v41
    ds_write_b32 v122, v13 offset:52480
    ds_write_b8_d16_hi v123, v50 offset:10496
    v_sub_u32 v50, 55295, v123
    v_lshlrev_b32 v123, 2, v123
    v_lshl_or_b32 v42, v50, 16, v42
    ds_write_b32 v123, v14 offset:52480
    ds_write_b8_d16_hi v124, v51 offset:10496
    v_sub_u32 v51, 55295, v124
    v_lshlrev_b32 v124, 2, v124
    v_lshl_or_b32 v43, v51, 16, v43
    ds_write_b32 v124, v15 offset:52480
p1_k23:
    s_cmp_ge_u32 s33, 1472
    s_cbranch_scc1 p1_k24
    s_cmp_lt_u32 s33, 1445
    s_cselect_b32 s10, 204800000, 0
    s_add_u32 s32, s30, 32768
    buffer_load_dwordx4 v[48:51], v1, s[8:11], s32 offen nt
p1_k24:
    s_cmp_ge_u32 s33, 1472
    s_cbranch_scc1 p1_k25
    s_cmp_lt_u32 s33, 1392
    s_cselect_b32 s14, 102400000, 0
    s_add_u32 s32, s31, 32768
    buffer_load_dwordx2 v[84:85], v2, s[12:15], s32 offen nt
p1_k25:
    s_cmp_ge_u32 s33, 1472
    s_cbranch_scc1 p1_k26
    s_cmp_lt_u32 s33, 1365
    s_cselect_b32 s14, 102400000, 0
    s_add_u32 s32, s31, 40960
    buffer_load_dwordx2 v[86:87], v2, s[12:15], s32 offen nt
p1_k26:
    s_cmp_lt_u32 s29, 1419
    s_cbranch_scc1 p1_pa2
    s_waitcnt lgkmcnt(0)
    s_branch p1_pb2
p1_pa2:
    v_and_b32 v121, 0xffff, v52
    ds_add_rtn_u32 v121, v121, v3 offset:0
    v_and_b32 v122, 0xffff, v53
    ds_add_rtn_u32 v122, v122, v3 offset:0
    v_and_b32 v123, 0xffff, v54
    ds_add_rtn_u32 v123, v123, v3 offset:0
    v_and_b32 v124, 0xffff, v55
    ds_add_rtn_u32 v124, v124, v3 offset:0
    s_waitcnt lgkmcnt(4)
p1_pb2:
    ds_write_b8_d16_hi v117, v44 offset:10496
    v_sub_u32 v44, 55295, v117
    v_lshlrev_b32 v117, 2, v117
    ds_write_b32 v117, v8 offset:52480
    ds_write_b8_d16_hi v118, v45 offset:10496
    v_sub_u32 v45, 55295, v118
    v_lshlrev_b32 v118, 2, v118
    ds_write_b32 v118, v9 offset:52480
    ds_write_b8_d16_hi v119, v46 offset:10496
    v_sub_u32 v46, 55295, v119
    v_lshlrev_b32 v119, 2, v119
    ds_write_b32 v119, v10 offset:52480
    ds_write_b8_d16_hi v120, v47 offset:10496
    v_sub_u32 v47, 55295, v120
    v_lshlrev_b32 v120, 2, v120
    ds_write_b32 v120, v11 offset:52480
    s_cmp_ge_u32 s28, 10
    s_cbranch_scc1 p1_jn
    s_waitcnt vmcnt(0)
    v_mov_b32 v125, 0
    s_mov_b64 exec, 1
    ds_add_rtn_u32 v125, v125, v3 offset:10432
    s_waitcnt lgkmcnt(0)
    v_readfirstlane_b32 s52, v125
    s_lshr_b32 s53, s29, 1
    s_and_b32 s53, s53, 28
    s_cmp_lg_u32 s52, 9
    s_cbranch_scc1 p1_jn1
    s_lshl_b32 s54, 1, s53
    v_mov_b32 v127, s54
    s_lshr_b32 s54, s29, 6
    s_lshl_b32 s54, s54, 2
    s_mov_b32 s68, 1
    buffer_atomic_add v127, off, s[40:43], s54 sc0 sc1
p1_jn1:
    s_mov_b64 exec, -1
p1_jn:
    s_cmp_ge_u32 s33, 1472
    s_cbranch_scc1 p1_k27
    s_cmp_lt_u32 s33, 1472
    s_cselect_b32 s6, 204800000, 0
    s_add_u32 s32, s30, 16384
    buffer_load_dwordx4 v[98:101], v1, s[4:7], s32 offen nt
p1_k27:
    s_cmp_ge_u32 s33, 1472
    s_cbranch_scc1 p1_k28
    s_cmp_lt_u32 s33, 1338
    s_cselect_b32 s14, 102400000, 0
    s_add_u32 s32, s31, 49152
    buffer_load_dwordx2 v[88:89], v2, s[12:15], s32 offen nt
p1_k28:
    s_cmp_ge_u32 s33, 1472
    s_cbranch_scc1 p1_k29
    s_cmp_lt_u32 s33, 1312
    s_cselect_b32 s14, 102400000, 0
    s_add_u32 s32, s31, 57344
    buffer_load_dwordx2 v[90:91], v2, s[12:15], s32 offen nt
p1_k29:
    s_cmp_lt_u32 s29, 1392
    s_cbranch_scc1 p1_pa3
    s_waitcnt lgkmcnt(0)
    s_branch p1_pb3
p1_pa3:
    v_and_b32 v117, 0xffff, v56
    ds_add_rtn_u32 v117, v117, v3 offset:0
    v_and_b32 v118, 0xffff, v57
    ds_add_rtn_u32 v118, v118, v3 offset:0
    v_and_b32 v119, 0xffff, v58
    ds_add_rtn_u32 v119, v119, v3 offset:0
    v_and_b32 v120, 0xffff, v59
    ds_add_rtn_u32 v120, v120, v3 offset:0
    s_waitcnt lgkmcnt(4)
p1_pb3:
    s_cmp_ge_u32 s29, 1419
    s_cbranch_scc1 p1_k30
    ds_write_b8_d16_hi v121, v52 offset:10496
    v_sub_u32 v52, 55295, v121
    v_lshlrev_b32 v121, 2, v121
    v_lshl_or_b32 v44, v52, 16, v44
    ds_write_b32 v121, v16 offset:52480
    ds_write_b8_d16_hi v122, v53 offset:10496
    v_sub_u32 v53, 55295, v122
    v_lshlrev_b32 v122, 2, v122
    v_lshl_or_b32 v45, v53, 16, v45
    ds_write_b32 v122, v17 offset:52480
    ds_write_b8_d16_hi v123, v54 offset:10496
    v_sub_u32 v54, 55295, v123
    v_lshlrev_b32 v123, 2, v123
    v_lshl_or_b32 v46, v54, 16, v46
    ds_write_b32 v123, v18 offset:52480
    ds_write_b8_d16_hi v124, v55 offset:10496
    v_sub_u32 v55, 55295, v124
    v_lshlrev_b32 v124, 2, v124
    v_lshl_or_b32 v47, v55, 16, v47
    ds_write_b32 v124, v19 offset:52480
p1_k30:
    s_cmp_ge_u32 s33, 1472
    s_cbranch_scc1 p1_k31
    s_cmp_lt_u32 s33, 1419
    s_cselect_b32 s10, 204800000, 0
    s_add_u32 s32, s30, 49152
    buffer_load_dwordx4 v[52:55], v1, s[8:11], s32 offen nt
p1_k31:
    s_cmp_ge_u32 s33, 1472
    s_cbranch_scc1 p1_k32
    s_cmp_lt_u32 s33, 1285
    s_cselect_b32 s14, 102400000, 0
    s_add_u32 s32, s31, 65536
    buffer_load_dwordx2 v[92:93], v2, s[12:15], s32 offen nt
p1_k32:
    s_cmp_lt_u32 s29, 1365
    s_cbranch_scc1 p1_pa4
    s_waitcnt lgkmcnt(0)
    s_branch p1_pb4
p1_pa4:
    v_and_b32 v121, 0xffff, v60
    ds_add_rtn_u32 v121, v121, v3 offset:0
    v_and_b32 v122, 0xffff, v61
    ds_add_rtn_u32 v122, v122, v3 offset:0
    v_and_b32 v123, 0xffff, v62
    ds_add_rtn_u32 v123, v123, v3 offset:0
    v_and_b32 v124, 0xffff, v63
    ds_add_rtn_u32 v124, v124, v3 offset:0
    s_waitcnt lgkmcnt(4)
p1_pb4:
    s_cmp_ge_u32 s29, 1392
    s_cbranch_scc1 p1_k33
    ds_write_b8_d16_hi v117, v56 offset:10496
    v_sub_u32 v56, 55295, v117
    v_lshlrev_b32 v117, 2, v117
    ds_write_b32 v117, v20 offset:52480
    ds_write_b8_d16_hi v118, v57 offset:10496
    v_sub_u32 v57, 55295, v118
    v_lshlrev_b32 v118, 2, v118
    ds_write_b32 v118, v21 offset:52480
    ds_write_b8_d16_hi v119, v58 offset:10496
    v_sub_u32 v58, 55295, v119
    v_lshlrev_b32 v119, 2, v119
    ds_write_b32 v119, v22 offset:52480
    ds_write_b8_d16_hi v120, v59 offset:10496
    v_sub_u32 v59, 55295, v120
    v_lshlrev_b32 v120, 2, v120
    ds_write_b32 v120, v23 offset:52480
p1_k33:
    s_cmp_ge_u32 s33, 1472
    s_cbranch_scc1 p1_k34
    s_cmp_lt_u32 s33, 1472
    s_cselect_b32 s10, 204800000, 0
    s_add_u32 s32, s30, 16384
    buffer_load_dwordx4 v[106:109], v1, s[8:11], s32 offen nt
p1_k34:
    s_cmp_lt_u32 s29, 1338
    s_cbranch_scc1 p1_pa5
    s_waitcnt lgkmcnt(0)
    s_branch p1_pb5
p1_pa5:
    v_and_b32 v117, 0xffff, v64
    ds_add_rtn_u32 v117, v117, v3 offset:0
    v_and_b32 v118, 0xffff, v65
    ds_add_rtn_u32 v118, v118, v3 offset:0
    v_and_b32 v119, 0xffff, v66
    ds_add_rtn_u32 v119, v119, v3 offset:0
    v_and_b32 v120, 0xffff, v67
    ds_add_rtn_u32 v120, v120, v3 offset:0
    s_waitcnt lgkmcnt(4)
p1_pb5:
    s_cmp_ge_u32 s29, 1365
    s_cbranch_scc1 p1_k35
    ds_write_b8_d16_hi v121, v60 offset:10496
    v_sub_u32 v60, 55295, v121
    v_lshlrev_b32 v121, 2, v121
    v_lshl_or_b32 v56, v60, 16, v56
    ds_write_b32 v121, v24 offset:52480
    ds_write_b8_d16_hi v122, v61 offset:10496
    v_sub_u32 v61, 55295, v122
    v_lshlrev_b32 v122, 2, v122
    v_lshl_or_b32 v57, v61, 16, v57
    ds_write_b32 v122, v25 offset:52480
    ds_write_b8_d16_hi v123, v62 offset:10496
    v_sub_u32 v62, 55295, v123
    v_lshlrev_b32 v123, 2, v123
    v_lshl_or_b32 v58, v62, 16, v58
    ds_write_b32 v123, v26 offset:52480
    ds_write_b8_d16_hi v124, v63 offset:10496
    v_sub_u32 v63, 55295, v124
    v_lshlrev_b32 v124, 2, v124
    v_lshl_or_b32 v59, v63, 16, v59
    ds_write_b32 v124, v27 offset:52480
p1_k35:
    s_cmp_ge_u32 s33, 1472
    s_cbranch_scc1 p1_k36
    s_cmp_lt_u32 s33, 1365
    s_cselect_b32 s10, 204800000, 0
    s_add_u32 s32, s30, 81920
    buffer_load_dwordx4 v[60:63], v1, s[8:11], s32 offen nt
p1_k36:
    s_cmp_lt_u32 s29, 1312
    s_cbranch_scc1 p1_pa6
    s_waitcnt lgkmcnt(0)
    s_branch p1_pb6
p1_pa6:
    v_and_b32 v121, 0xffff, v68
    ds_add_rtn_u32 v121, v121, v3 offset:0
    v_and_b32 v122, 0xffff, v69
    ds_add_rtn_u32 v122, v122, v3 offset:0
    v_and_b32 v123, 0xffff, v70
    ds_add_rtn_u32 v123, v123, v3 offset:0
    v_and_b32 v124, 0xffff, v71
    ds_add_rtn_u32 v124, v124, v3 offset:0
    s_waitcnt lgkmcnt(4)
p1_pb6:
    s_cmp_ge_u32 s29, 1338
    s_cbranch_scc1 p1_k37
    ds_write_b8_d16_hi v117, v64 offset:10496
    v_sub_u32 v64, 55295, v117
    v_lshlrev_b32 v117, 2, v117
    ds_write_b32 v117, v28 offset:52480
    ds_write_b8_d16_hi v118, v65 offset:10496
    v_sub_u32 v65, 55295, v118
    v_lshlrev_b32 v118, 2, v118
    ds_write_b32 v118, v29 offset:52480
    ds_write_b8_d16_hi v119, v66 offset:10496
    v_sub_u32 v66, 55295, v119
    v_lshlrev_b32 v119, 2, v119
    ds_write_b32 v119, v30 offset:52480
    ds_write_b8_d16_hi v120, v67 offset:10496
    v_sub_u32 v67, 55295, v120
    v_lshlrev_b32 v120, 2, v120
    ds_write_b32 v120, v31 offset:52480
p1_k37:
    s_cmp_lt_u32 s29, 1285
    s_cbranch_scc1 p1_pa7
    s_waitcnt lgkmcnt(0)
    s_branch p1_pb7
p1_pa7:
    v_and_b32 v117, 0xffff, v72
    ds_add_rtn_u32 v117, v117, v3 offset:0
    v_and_b32 v118, 0xffff, v73
    ds_add_rtn_u32 v118, v118, v3 offset:0
    v_and_b32 v119, 0xffff, v74
    ds_add_rtn_u32 v119, v119, v3 offset:0
    v_and_b32 v120, 0xffff, v75
    ds_add_rtn_u32 v120, v120, v3 offset:0
    s_waitcnt lgkmcnt(4)
p1_pb7:
    s_cmp_ge_u32 s29, 1312
    s_cbranch_scc1 p1_k38
    ds_write_b8_d16_hi v121, v68 offset:10496
    v_sub_u32 v68, 55295, v121
    v_lshlrev_b32 v121, 2, v121
    v_lshl_or_b32 v64, v68, 16, v64
    ds_write_b32 v121, v32 offset:52480
    ds_write_b8_d16_hi v122, v69 offset:10496
    v_sub_u32 v69, 55295, v122
    v_lshlrev_b32 v122, 2, v122
    v_lshl_or_b32 v65, v69, 16, v65
    ds_write_b32 v122, v33 offset:52480
    ds_write_b8_d16_hi v123, v70 offset:10496
    v_sub_u32 v70, 55295, v123
    v_lshlrev_b32 v123, 2, v123
    v_lshl_or_b32 v66, v70, 16, v66
    ds_write_b32 v123, v34 offset:52480
    ds_write_b8_d16_hi v124, v71 offset:10496
    v_sub_u32 v71, 55295, v124
    v_lshlrev_b32 v124, 2, v124
    v_lshl_or_b32 v67, v71, 16, v67
    ds_write_b32 v124, v35 offset:52480
p1_k38:
    s_cmp_ge_u32 s33, 1472
    s_cbranch_scc1 p1_k39
    s_cmp_lt_u32 s33, 1312
    s_cselect_b32 s10, 204800000, 0
    s_add_u32 s32, s30, 114688
    buffer_load_dwordx4 v[68:71], v1, s[8:11], s32 offen nt
p1_k39:
    s_waitcnt lgkmcnt(0)
    s_cmp_ge_u32 s29, 1285
    s_cbranch_scc1 p1_k40
    ds_write_b8_d16_hi v117, v72 offset:10496
    v_sub_u32 v72, 55295, v117
    v_lshlrev_b32 v117, 2, v117
    ds_write_b32 v117, v36 offset:52480
    ds_write_b8_d16_hi v118, v73 offset:10496
    v_sub_u32 v73, 55295, v118
    v_lshlrev_b32 v118, 2, v118
    ds_write_b32 v118, v37 offset:52480
    ds_write_b8_d16_hi v119, v74 offset:10496
    v_sub_u32 v74, 55295, v119
    v_lshlrev_b32 v119, 2, v119
    ds_write_b32 v119, v38 offset:52480
    ds_write_b8_d16_hi v120, v75 offset:10496
    v_sub_u32 v75, 55295, v120
    v_lshlrev_b32 v120, 2, v120
    ds_write_b32 v120, v39 offset:52480
p1_k40:
    s_cmp_eq_u32 s68, 0
    s_cbranch_scc1 p1_sg
    s_cmp_lt_u32 s33, 1472
    s_cbranch_scc1 p1_w41
    s_waitcnt vmcnt(0)
p1_w41:
    s_waitcnt vmcnt(8)
    v_bfe_u32 v127, v127, s53, 4
    v_mov_b32 v125, 0
    s_mov_b64 exec, 1
    ds_write_b32 v125, v127 offset:10452
    s_mov_b64 exec, -1
p1_sg:
    s_cmp_lt_u32 s33, 1472
    s_cbranch_scc1 p1_f1
    s_cmp_lg_u32 s28, 15
    s_cbranch_scc1 p1_hv1
    s_waitcnt vmcnt(0)
    v_bfe_u32 v127, v127, s58, 4
    v_mov_b32 v125, 0
    s_mov_b64 exec, 1
    ds_write_b32 v125, v127 offset:10448
    s_mov_b64 exec, -1
p1_hv1:
    s_cmp_ge_u32 s33, 1592
    s_cbranch_scc1 p1_f1
    s_sub_u32 s52, s33, 1472
    s_mul_i32 s53, s52, 53760
    s_add_u32 s53, s53, 485125120
    s_mul_i32 s54, s28, 3072
    v_lshl_add_u32 v93, v92, 4, s54
    s_lshl_b32 s54, s28, 9
    s_add_u32 s54, s54, 49152
    s_cmp_lt_u32 s28, 9
    s_cselect_b32 s54, s54, 0x40000000
    v_lshl_add_u32 v94, v92, 3, s54
    v_mov_b32 v96, 0
    v_mov_b32 v97, 0
    s_waitcnt vmcnt(0)
    buffer_store_dwordx4 v[76:79], v93, s[16:19], s53 offen offset:0
    buffer_store_dwordx4 v[80:83], v93, s[16:19], s53 offen offset:1024
    buffer_store_dwordx4 v[84:87], v93, s[16:19], s53 offen offset:2048
    buffer_store_dwordx2 v[88:89], v94, s[16:19], s53 offen
    v_and_b32 v98, 0x7fff7fff, v76
    v_pk_max_u16 v96, v96, v98
    v_lshlrev_b32 v99, 16, v98
    v_and_b32 v98, 0xffff0000, v98
    v_fmac_f32 v97, v99, v99
    v_fmac_f32 v97, v98, v98
    v_and_b32 v98, 0x7fff7fff, v77
    v_pk_max_u16 v96, v96, v98
    v_lshlrev_b32 v99, 16, v98
    v_and_b32 v98, 0xffff0000, v98
    v_fmac_f32 v97, v99, v99
    v_fmac_f32 v97, v98, v98
    v_and_b32 v98, 0x7fff7fff, v78
    v_pk_max_u16 v96, v96, v98
    v_lshlrev_b32 v99, 16, v98
    v_and_b32 v98, 0xffff0000, v98
    v_fmac_f32 v97, v99, v99
    v_fmac_f32 v97, v98, v98
    v_and_b32 v98, 0x7fff7fff, v79
    v_pk_max_u16 v96, v96, v98
    v_lshlrev_b32 v99, 16, v98
    v_and_b32 v98, 0xffff0000, v98
    v_fmac_f32 v97, v99, v99
    v_fmac_f32 v97, v98, v98
    v_and_b32 v98, 0x7fff7fff, v80
    v_pk_max_u16 v96, v96, v98
    v_lshlrev_b32 v99, 16, v98
    v_and_b32 v98, 0xffff0000, v98
    v_fmac_f32 v97, v99, v99
    v_fmac_f32 v97, v98, v98
    v_and_b32 v98, 0x7fff7fff, v81
    v_pk_max_u16 v96, v96, v98
    v_lshlrev_b32 v99, 16, v98
    v_and_b32 v98, 0xffff0000, v98
    v_fmac_f32 v97, v99, v99
    v_fmac_f32 v97, v98, v98
    v_and_b32 v98, 0x7fff7fff, v82
    v_pk_max_u16 v96, v96, v98
    v_lshlrev_b32 v99, 16, v98
    v_and_b32 v98, 0xffff0000, v98
    v_fmac_f32 v97, v99, v99
    v_fmac_f32 v97, v98, v98
    v_and_b32 v98, 0x7fff7fff, v83
    v_pk_max_u16 v96, v96, v98
    v_lshlrev_b32 v99, 16, v98
    v_and_b32 v98, 0xffff0000, v98
    v_fmac_f32 v97, v99, v99
    v_fmac_f32 v97, v98, v98
    v_and_b32 v98, 0x7fff7fff, v84
    v_pk_max_u16 v96, v96, v98
    v_lshlrev_b32 v99, 16, v98
    v_and_b32 v98, 0xffff0000, v98
    v_fmac_f32 v97, v99, v99
    v_fmac_f32 v97, v98, v98
    v_and_b32 v98, 0x7fff7fff, v85
    v_pk_max_u16 v96, v96, v98
    v_lshlrev_b32 v99, 16, v98
    v_and_b32 v98, 0xffff0000, v98
    v_fmac_f32 v97, v99, v99
    v_fmac_f32 v97, v98, v98
    v_and_b32 v98, 0x7fff7fff, v86
    v_pk_max_u16 v96, v96, v98
    v_lshlrev_b32 v99, 16, v98
    v_and_b32 v98, 0xffff0000, v98
    v_fmac_f32 v97, v99, v99
    v_fmac_f32 v97, v98, v98
    v_and_b32 v98, 0x7fff7fff, v87
    v_pk_max_u16 v96, v96, v98
    v_lshlrev_b32 v99, 16, v98
    v_and_b32 v98, 0xffff0000, v98
    v_fmac_f32 v97, v99, v99
    v_fmac_f32 v97, v98, v98
    v_and_b32 v98, 0x7fff7fff, v88
    v_pk_max_u16 v96, v96, v98
    v_lshlrev_b32 v99, 16, v98
    v_and_b32 v98, 0xffff0000, v98
    v_fmac_f32 v97, v99, v99
    v_fmac_f32 v97, v98, v98
    v_and_b32 v98, 0x7fff7fff, v89
    v_pk_max_u16 v96, v96, v98
    v_lshlrev_b32 v99, 16, v98
    v_and_b32 v98, 0xffff0000, v98
    v_fmac_f32 v97, v99, v99
    v_fmac_f32 v97, v98, v98
    v_lshrrev_b32 v98, 16, v96
    v_and_b32 v96, 0xffff, v96
    v_max_u32 v96, v96, v98
    s_nop 1
    v_max_u32_dpp v96, v96, v96 row_shr:1 row_mask:0xf bank_mask:0xf bound_ctrl:0
    v_add_f32_dpp v97, v97, v97 row_shr:1 row_mask:0xf bank_mask:0xf bound_ctrl:0
    s_nop 0
    v_max_u32_dpp v96, v96, v96 row_shr:2 row_mask:0xf bank_mask:0xf bound_ctrl:0
    v_add_f32_dpp v97, v97, v97 row_shr:2 row_mask:0xf bank_mask:0xf bound_ctrl:0
    s_nop 0
    v_max_u32_dpp v96, v96, v96 row_shr:4 row_mask:0xf bank_mask:0xf bound_ctrl:0
    v_add_f32_dpp v97, v97, v97 row_shr:4 row_mask:0xf bank_mask:0xf bound_ctrl:0
    s_nop 0
    v_max_u32_dpp v96, v96, v96 row_shr:8 row_mask:0xf bank_mask:0xf bound_ctrl:0
    v_add_f32_dpp v97, v97, v97 row_shr:8 row_mask:0xf bank_mask:0xf bound_ctrl:0
    s_nop 0
    v_max_u32_dpp v96, v96, v96 row_bcast:15 row_mask:0xa bank_mask:0xf
    v_add_f32_dpp v97, v97, v97 row_bcast:15 row_mask:0xa bank_mask:0xf
    s_nop 0
    v_max_u32_dpp v96, v96, v96 row_bcast:31 row_mask:0xc bank_mask:0xf
    v_add_f32_dpp v97, v97, v97 row_bcast:31 row_mask:0xc bank_mask:0xf
    s_nop 0
    s_nop 0
    s_lshl_b32 s52, s52, 4
    s_add_u32 s52, s52, s28
    s_lshl_b32 s52, s52, 3
    s_add_u32 s52, s52, 491576320
    s_mov_b64 exec, 1
    s_lshl_b64 exec, exec, 63
    buffer_store_dwordx2 v[96:97], off, s[16:19], s52
    s_mov_b64 exec, -1
p1_f1:
    s_waitcnt lgkmcnt(0)
    s_barrier
    v_mul_u32_u24 v119, 3, v0
    v_and_b32 v118, -4, v119
    v_add_u32 v120, s50, v1
    v_mov_b32 v122, 0
    v_mov_b32 v123, 0
    v_mov_b32 v124, 0
    v_mov_b32 v125, 0
    ds_read_b64 v[126:127], v122 offset:10448
    ds_write_b32 v122, v122 offset:10432
    v_cmp_gt_u32 vcc, 640, v0
    s_and_saveexec_b64 s[52:53], vcc
    ds_write_b128 v1, v[122:125] offset:0
    s_mov_b64 exec, -1
    s_waitcnt lgkmcnt(2)
    v_readfirstlane_b32 s70, v126
    v_readfirstlane_b32 s69, v127
    s_cmp_ge_u32 s33, 1472
    s_cselect_b32 s70, s70, 0
    s_cmp_gt_u32 s28, 10
    s_cselect_b32 s69, 0, s69
    s_cselect_b32 s70, 0, s70
    s_cmp_lg_u32 s70, 8
    s_cbranch_scc1 p1_h0
    s_sub_u32 s52, s33, 1472
    v_and_b32 v102, 63, v0
    s_cmp_eq_u32 s28, 10
    s_cbranch_scc1 p1_tr10
    s_mul_i32 s53, s28, 520
    v_lshl_add_u32 v100, v102, 3, s53
    s_mul_i32 s53, s28, 4160
    v_lshl_add_u32 v101, v102, 4, s53
    s_branch p1_tr20
p1_tr10:
    v_mul_u32_u24 v100, 520, v102
    v_add_u32 v100, 512, v100
    v_mul_u32_u24 v101, 4160, v102
    v_add_u32 v101, 1024, v101
    v_cmp_gt_u32 vcc, 10, v102
    v_mov_b32 v102, 0x40000000
    s_nop 0
    v_cndmask_b32 v100, v102, v100, vcc
    v_cndmask_b32 v101, v102, v101, vcc
p1_tr20:
    s_mul_i32 s52, s52, 41984
    s_add_u32 s52, s52, 469745664
    buffer_load_dwordx2 v[76:77], v100, s[16:19], s52 offen sc1
    s_add_u32 s52, s52, 5248
    buffer_load_dwordx2 v[78:79], v100, s[16:19], s52 offen sc1
    s_add_u32 s52, s52, 5248
    buffer_load_dwordx2 v[80:81], v100, s[16:19], s52 offen sc1
    s_add_u32 s52, s52, 5248
    buffer_load_dwordx2 v[82:83], v100, s[16:19], s52 offen sc1
    s_add_u32 s52, s52, 5248
    buffer_load_dwordx2 v[84:85], v100, s[16:19], s52 offen sc1
    s_add_u32 s52, s52, 5248
    buffer_load_dwordx2 v[86:87], v100, s[16:19], s52 offen sc1
    s_add_u32 s52, s52, 5248
    buffer_load_dwordx2 v[88:89], v100, s[16:19], s52 offen sc1
    s_add_u32 s52, s52, 5248
    buffer_load_dwordx2 v[90:91], v100, s[16:19], s52 offen sc1
    s_add_u32 s52, s52, 5248
p1_h0:
    v_lshlrev_b32 v117, 2, v119
    v_add_u32 v117, 52480, v117
    ds_read_b32 v110, v117 offset:0
    ds_read_b32 v111, v117 offset:4
    ds_read_b32 v112, v117 offset:8
    ds_read_b32 v113, v118 offset:10496
    ds_read_b32 v114, v118 offset:10500
    ds_read_b32 v122, v117 offset:12288
    ds_read_b32 v123, v117 offset:12292
    ds_read_b32 v124, v117 offset:12296
    ds_read_b32 v125, v118 offset:13568
    ds_read_b32 v121, v118 offset:13572
    s_waitcnt lgkmcnt(5)
    v_alignbyte_b32 v113, v114, v113, v119
    buffer_store_dwordx4 v[110:113], v120, s[20:23], 0 offen
    v_add_u32 v120, 33554432, v120
    s_nop 0
    ds_read_b32 v110, v117 offset:24576
    ds_read_b32 v111, v117 offset:24580
    ds_read_b32 v112, v117 offset:24584
    ds_read_b32 v113, v118 offset:16640
    ds_read_b32 v114, v118 offset:16644
    s_cmp_le_u32 s35, 1024
    s_cbranch_scc1 p1_ce0
    s_waitcnt lgkmcnt(5)
    v_alignbyte_b32 v125, v121, v125, v119
    buffer_store_dwordx4 v[122:125], v120, s[20:23], 0 offen
    v_add_u32 v120, 33554432, v120
    s_nop 0
    ds_read_b32 v122, v117 offset:36864
    ds_read_b32 v123, v117 offset:36868
    ds_read_b32 v124, v117 offset:36872
    ds_read_b32 v125, v118 offset:19712
    ds_read_b32 v121, v118 offset:19716
    s_cmp_le_u32 s35, 2048
    s_cbranch_scc1 p1_ce0
    s_waitcnt lgkmcnt(5)
    v_alignbyte_b32 v113, v114, v113, v119
    buffer_store_dwordx4 v[110:113], v120, s[20:23], 0 offen
    v_add_u32 v120, 33554432, v120
    s_nop 0
    ds_read_b32 v110, v117 offset:49152
    ds_read_b32 v111, v117 offset:49156
    ds_read_b32 v112, v117 offset:49160
    ds_read_b32 v113, v118 offset:22784
    ds_read_b32 v114, v118 offset:22788
    s_cmp_le_u32 s35, 3072
    s_cbranch_scc1 p1_ce0
    s_waitcnt lgkmcnt(5)
    v_alignbyte_b32 v125, v121, v125, v119
    buffer_store_dwordx4 v[122:125], v120, s[20:23], 0 offen
    v_add_u32 v120, 33554432, v120
    s_nop 0
    v_lshlrev_b32 v117, 2, v119
    v_add_u32 v117, 113920, v117
    ds_read_b32 v122, v117 offset:0
    ds_read_b32 v123, v117 offset:4
    ds_read_b32 v124, v117 offset:8
    ds_read_b32 v125, v118 offset:25856
    ds_read_b32 v121, v118 offset:25860
    s_cmp_le_u32 s35, 4096
    s_cbranch_scc1 p1_ce0
    s_waitcnt lgkmcnt(5)
    v_alignbyte_b32 v113, v114, v113, v119
    buffer_store_dwordx4 v[110:113], v120, s[20:23], 0 offen
    v_add_u32 v120, 33554432, v120
    s_nop 0
    ds_read_b32 v110, v117 offset:12288
    ds_read_b32 v111, v117 offset:12292
    ds_read_b32 v112, v117 offset:12296
    ds_read_b32 v113, v118 offset:28928
    ds_read_b32 v114, v118 offset:28932
    s_cmp_le_u32 s35, 5120
    s_cbranch_scc1 p1_ce0
    s_waitcnt lgkmcnt(5)
    v_alignbyte_b32 v125, v121, v125, v119
    buffer_store_dwordx4 v[122:125], v120, s[20:23], 0 offen
    v_add_u32 v120, 33554432, v120
    s_nop 0
    ds_read_b32 v122, v117 offset:24576
    ds_read_b32 v123, v117 offset:24580
    ds_read_b32 v124, v117 offset:24584
    ds_read_b32 v125, v118 offset:32000
    ds_read_b32 v121, v118 offset:32004
    s_cmp_le_u32 s35, 6144
    s_cbranch_scc1 p1_ce0
    s_waitcnt lgkmcnt(5)
    v_alignbyte_b32 v113, v114, v113, v119
    buffer_store_dwordx4 v[110:113], v120, s[20:23], 0 offen
    v_add_u32 v120, 33554432, v120
    s_nop 0
    ds_read_b32 v110, v117 offset:36864
    ds_read_b32 v111, v117 offset:36868
    ds_read_b32 v112, v117 offset:36872
    ds_read_b32 v113, v118 offset:35072
    ds_read_b32 v114, v118 offset:35076
    s_cmp_le_u32 s35, 7168
    s_cbranch_scc1 p1_ce0
    s_waitcnt lgkmcnt(5)
    v_alignbyte_b32 v125, v121, v125, v119
    buffer_store_dwordx4 v[122:125], v120, s[20:23], 0 offen
    v_add_u32 v120, 33554432, v120
    s_nop 0
    s_cmp_le_u32 s35, 8192
    s_cbranch_scc1 p1_ce0
    s_waitcnt lgkmcnt(0)
    v_alignbyte_b32 v113, v114, v113, v119
    buffer_store_dwordx4 v[110:113], v120, s[20:23], 0 offen
    v_add_u32 v120, 33554432, v120
    s_nop 0
p1_ce0:
    s_waitcnt lgkmcnt(0)
    s_cmp_lg_u32 s70, 8
    s_cbranch_scc1 p1_h1
    s_sub_u32 s52, s33, 1472
    s_mul_i32 s52, s52, 41600
    s_add_u32 s52, s52, 477470720
    s_mov_b32 s54, 0x05040100
    s_mov_b32 s55, 0x07060302
    s_waitcnt vmcnt(1)
    v_perm_b32 v92, v78, v76, s54
    v_perm_b32 v93, v82, v80, s54
    v_perm_b32 v94, v86, v84, s54
    v_perm_b32 v95, v90, v88, s54
    buffer_store_dwordx4 v[92:95], v101, s[16:19], s52 offen offset:0
    v_perm_b32 v96, v78, v76, s55
    v_perm_b32 v97, v82, v80, s55
    v_perm_b32 v98, v86, v84, s55
    v_perm_b32 v99, v90, v88, s55
    buffer_store_dwordx4 v[96:99], v101, s[16:19], s52 offen offset:1040
    v_perm_b32 v92, v79, v77, s54
    v_perm_b32 v93, v83, v81, s54
    v_perm_b32 v94, v87, v85, s54
    v_perm_b32 v95, v91, v89, s54
    buffer_store_dwordx4 v[92:95], v101, s[16:19], s52 offen offset:2080
    v_perm_b32 v96, v79, v77, s55
    v_perm_b32 v97, v83, v81, s55
    v_perm_b32 v98, v87, v85, s55
    v_perm_b32 v99, v91, v89, s55
    buffer_store_dwordx4 v[96:99], v101, s[16:19], s52 offen offset:3120
p1_h1:
    s_barrier
    s_cmp_ge_u32 s29, 1445
    s_cbranch_scc1 p1_k42
    s_cmp_le_u32 s35, 9216
    s_cbranch_scc1 p1_s1k2
    v_lshlrev_b32_sdwa v122, 2, v40 dst_sel:DWORD dst_unused:UNUSED_PAD src0_sel:DWORD src1_sel:WORD_1
    ds_write_b32 v122, v12 offset:52480
    v_lshlrev_b32_sdwa v123, 2, v41 dst_sel:DWORD dst_unused:UNUSED_PAD src0_sel:DWORD src1_sel:WORD_1
    ds_write_b32 v123, v13 offset:52480
    v_lshlrev_b32_sdwa v124, 2, v42 dst_sel:DWORD dst_unused:UNUSED_PAD src0_sel:DWORD src1_sel:WORD_1
    ds_write_b32 v124, v14 offset:52480
    v_lshlrev_b32_sdwa v125, 2, v43 dst_sel:DWORD dst_unused:UNUSED_PAD src0_sel:DWORD src1_sel:WORD_1
    ds_write_b32 v125, v15 offset:52480
p1_s1k2:
p1_k42:
    s_cmp_ge_u32 s33, 1472
    s_cbranch_scc1 p1_k43
    s_cmp_lt_u32 s33, 1445
    s_cselect_b32 s6, 204800000, 0
    s_add_u32 s32, s30, 32768
    buffer_load_dwordx4 v[12:15], v1, s[4:7], s32 offen nt
p1_k43:
    s_cmp_ge_u32 s29, 1419
    s_cbranch_scc1 p1_k44
    s_cmp_le_u32 s35, 9216
    s_cbranch_scc1 p1_s1k3
    v_lshlrev_b32_sdwa v122, 2, v44 dst_sel:DWORD dst_unused:UNUSED_PAD src0_sel:DWORD src1_sel:WORD_1
    ds_write_b32 v122, v16 offset:52480
    v_lshlrev_b32_sdwa v123, 2, v45 dst_sel:DWORD dst_unused:UNUSED_PAD src0_sel:DWORD src1_sel:WORD_1
    ds_write_b32 v123, v17 offset:52480
    v_lshlrev_b32_sdwa v124, 2, v46 dst_sel:DWORD dst_unused:UNUSED_PAD src0_sel:DWORD src1_sel:WORD_1
    ds_write_b32 v124, v18 offset:52480
    v_lshlrev_b32_sdwa v125, 2, v47 dst_sel:DWORD dst_unused:UNUSED_PAD src0_sel:DWORD src1_sel:WORD_1
    ds_write_b32 v125, v19 offset:52480
p1_s1k3:
p1_k44:
    s_cmp_ge_u32 s29, 1365
    s_cbranch_scc1 p1_k45
    s_cmp_le_u32 s35, 9216
    s_cbranch_scc1 p1_s1k5
    v_lshlrev_b32_sdwa v122, 2, v56 dst_sel:DWORD dst_unused:UNUSED_PAD src0_sel:DWORD src1_sel:WORD_1
    ds_write_b32 v122, v24 offset:52480
    v_lshlrev_b32_sdwa v123, 2, v57 dst_sel:DWORD dst_unused:UNUSED_PAD src0_sel:DWORD src1_sel:WORD_1
    ds_write_b32 v123, v25 offset:52480
    v_lshlrev_b32_sdwa v124, 2, v58 dst_sel:DWORD dst_unused:UNUSED_PAD src0_sel:DWORD src1_sel:WORD_1
    ds_write_b32 v124, v26 offset:52480
    v_lshlrev_b32_sdwa v125, 2, v59 dst_sel:DWORD dst_unused:UNUSED_PAD src0_sel:DWORD src1_sel:WORD_1
    ds_write_b32 v125, v27 offset:52480
p1_s1k5:
p1_k45:
    s_cmp_ge_u32 s29, 1312
    s_cbranch_scc1 p1_k46
    s_cmp_le_u32 s35, 9216
    s_cbranch_scc1 p1_s1k7
    v_lshlrev_b32_sdwa v122, 2, v64 dst_sel:DWORD dst_unused:UNUSED_PAD src0_sel:DWORD src1_sel:WORD_1
    ds_write_b32 v122, v32 offset:52480
    v_lshlrev_b32_sdwa v123, 2, v65 dst_sel:DWORD dst_unused:UNUSED_PAD src0_sel:DWORD src1_sel:WORD_1
    ds_write_b32 v123, v33 offset:52480
    v_lshlrev_b32_sdwa v124, 2, v66 dst_sel:DWORD dst_unused:UNUSED_PAD src0_sel:DWORD src1_sel:WORD_1
    ds_write_b32 v124, v34 offset:52480
    v_lshlrev_b32_sdwa v125, 2, v67 dst_sel:DWORD dst_unused:UNUSED_PAD src0_sel:DWORD src1_sel:WORD_1
    ds_write_b32 v125, v35 offset:52480
p1_s1k7:
p1_k46:
    s_cmp_ge_u32 s29, 1392
    s_cbranch_scc1 p1_k47
    s_cmp_le_u32 s35, 9216
    s_cbranch_scc1 p1_s1k4
    v_lshlrev_b32_sdwa v122, 2, v56 dst_sel:DWORD dst_unused:UNUSED_PAD src0_sel:DWORD src1_sel:WORD_0
    ds_write_b32 v122, v20 offset:52480
    v_lshlrev_b32_sdwa v123, 2, v57 dst_sel:DWORD dst_unused:UNUSED_PAD src0_sel:DWORD src1_sel:WORD_0
    ds_write_b32 v123, v21 offset:52480
    v_lshlrev_b32_sdwa v124, 2, v58 dst_sel:DWORD dst_unused:UNUSED_PAD src0_sel:DWORD src1_sel:WORD_0
    ds_write_b32 v124, v22 offset:52480
    v_lshlrev_b32_sdwa v125, 2, v59 dst_sel:DWORD dst_unused:UNUSED_PAD src0_sel:DWORD src1_sel:WORD_0
    ds_write_b32 v125, v23 offset:52480
p1_s1k4:
p1_k47:
    s_cmp_ge_u32 s29, 1338
    s_cbranch_scc1 p1_k48
    s_cmp_le_u32 s35, 9216
    s_cbranch_scc1 p1_s1k6
    v_lshlrev_b32_sdwa v122, 2, v64 dst_sel:DWORD dst_unused:UNUSED_PAD src0_sel:DWORD src1_sel:WORD_0
    ds_write_b32 v122, v28 offset:52480
    v_lshlrev_b32_sdwa v123, 2, v65 dst_sel:DWORD dst_unused:UNUSED_PAD src0_sel:DWORD src1_sel:WORD_0
    ds_write_b32 v123, v29 offset:52480
    v_lshlrev_b32_sdwa v124, 2, v66 dst_sel:DWORD dst_unused:UNUSED_PAD src0_sel:DWORD src1_sel:WORD_0
    ds_write_b32 v124, v30 offset:52480
    v_lshlrev_b32_sdwa v125, 2, v67 dst_sel:DWORD dst_unused:UNUSED_PAD src0_sel:DWORD src1_sel:WORD_0
    ds_write_b32 v125, v31 offset:52480
p1_s1k6:
p1_k48:
    s_cmp_ge_u32 s29, 1285
    s_cbranch_scc1 p1_k49
    s_cmp_le_u32 s35, 9216
    s_cbranch_scc1 p1_s1k8
    v_lshlrev_b32_sdwa v122, 2, v72 dst_sel:DWORD dst_unused:UNUSED_PAD src0_sel:DWORD src1_sel:WORD_0
    ds_write_b32 v122, v36 offset:52480
    v_lshlrev_b32_sdwa v123, 2, v73 dst_sel:DWORD dst_unused:UNUSED_PAD src0_sel:DWORD src1_sel:WORD_0
    ds_write_b32 v123, v37 offset:52480
    v_lshlrev_b32_sdwa v124, 2, v74 dst_sel:DWORD dst_unused:UNUSED_PAD src0_sel:DWORD src1_sel:WORD_0
    ds_write_b32 v124, v38 offset:52480
    v_lshlrev_b32_sdwa v125, 2, v75 dst_sel:DWORD dst_unused:UNUSED_PAD src0_sel:DWORD src1_sel:WORD_0
    ds_write_b32 v125, v39 offset:52480
p1_s1k8:
p1_k49:
    s_cmp_le_u32 s35, 9216
    s_cbranch_scc1 p1_s1k0
    v_lshlrev_b32_sdwa v122, 2, v40 dst_sel:DWORD dst_unused:UNUSED_PAD src0_sel:DWORD src1_sel:WORD_0
    ds_write_b32 v122, v4 offset:52480
    v_lshlrev_b32_sdwa v123, 2, v41 dst_sel:DWORD dst_unused:UNUSED_PAD src0_sel:DWORD src1_sel:WORD_0
    ds_write_b32 v123, v5 offset:52480
    v_lshlrev_b32_sdwa v124, 2, v42 dst_sel:DWORD dst_unused:UNUSED_PAD src0_sel:DWORD src1_sel:WORD_0
    ds_write_b32 v124, v6 offset:52480
    v_lshlrev_b32_sdwa v125, 2, v43 dst_sel:DWORD dst_unused:UNUSED_PAD src0_sel:DWORD src1_sel:WORD_0
    ds_write_b32 v125, v7 offset:52480
p1_s1k0:
    s_cmp_le_u32 s35, 9216
    s_cbranch_scc1 p1_s1k1
    v_lshlrev_b32_sdwa v122, 2, v44 dst_sel:DWORD dst_unused:UNUSED_PAD src0_sel:DWORD src1_sel:WORD_0
    ds_write_b32 v122, v8 offset:52480
    v_lshlrev_b32_sdwa v123, 2, v45 dst_sel:DWORD dst_unused:UNUSED_PAD src0_sel:DWORD src1_sel:WORD_0
    ds_write_b32 v123, v9 offset:52480
    v_lshlrev_b32_sdwa v124, 2, v46 dst_sel:DWORD dst_unused:UNUSED_PAD src0_sel:DWORD src1_sel:WORD_0
    ds_write_b32 v124, v10 offset:52480
    v_lshlrev_b32_sdwa v125, 2, v47 dst_sel:DWORD dst_unused:UNUSED_PAD src0_sel:DWORD src1_sel:WORD_0
    ds_write_b32 v125, v11 offset:52480
p1_s1k1:
    s_cmp_lg_u32 s69, 8
    s_cbranch_scc1 p1_o1
    s_lshr_b32 s52, s29, 3
    v_and_b32 v6, 63, v0
    s_cmp_eq_u32 s28, 10
    s_cbranch_scc1 p1_tr11
    s_mul_i32 s53, s28, 520
    v_lshl_add_u32 v4, v6, 3, s53
    s_mul_i32 s53, s28, 4160
    v_lshl_add_u32 v5, v6, 4, s53
    s_branch p1_tr21
p1_tr11:
    v_mul_u32_u24 v4, 520, v6
    v_add_u32 v4, 512, v4
    v_mul_u32_u24 v5, 4160, v6
    v_add_u32 v5, 1024, v5
    v_cmp_gt_u32 vcc, 10, v6
    v_mov_b32 v6, 0x40000000
    s_nop 0
    v_cndmask_b32 v4, v6, v4, vcc
    v_cndmask_b32 v5, v6, v5, vcc
p1_tr21:
    s_mul_i32 s52, s52, 41984
    s_add_u32 s52, s52, 469745664
    buffer_load_dwordx2 v[16:17], v4, s[16:19], s52 offen sc1
    s_add_u32 s52, s52, 5248
    buffer_load_dwordx2 v[18:19], v4, s[16:19], s52 offen sc1
    s_add_u32 s52, s52, 5248
    buffer_load_dwordx2 v[20:21], v4, s[16:19], s52 offen sc1
    s_add_u32 s52, s52, 5248
    buffer_load_dwordx2 v[22:23], v4, s[16:19], s52 offen sc1
    s_add_u32 s52, s52, 5248
    buffer_load_dwordx2 v[24:25], v4, s[16:19], s52 offen sc1
    s_add_u32 s52, s52, 5248
    buffer_load_dwordx2 v[26:27], v4, s[16:19], s52 offen sc1
    s_add_u32 s52, s52, 5248
    buffer_load_dwordx2 v[28:29], v4, s[16:19], s52 offen sc1
    s_add_u32 s52, s52, 5248
    buffer_load_dwordx2 v[30:31], v4, s[16:19], s52 offen sc1
    s_add_u32 s52, s52, 5248
    s_cmp_ge_u32 s33, 1472
    s_cbranch_scc1 p1_o1
    s_lshr_b32 s52, s29, 3
    s_mul_i32 s52, s52, 41600
    s_add_u32 s52, s52, 477470720
    s_mov_b32 s54, 0x05040100
    s_mov_b32 s55, 0x07060302
    s_waitcnt vmcnt(0)
    v_perm_b32 v32, v18, v16, s54
    v_perm_b32 v33, v22, v20, s54
    v_perm_b32 v34, v26, v24, s54
    v_perm_b32 v35, v30, v28, s54
    buffer_store_dwordx4 v[32:35], v5, s[16:19], s52 offen offset:0
    v_perm_b32 v36, v18, v16, s55
    v_perm_b32 v37, v22, v20, s55
    v_perm_b32 v38, v26, v24, s55
    v_perm_b32 v39, v30, v28, s55
    buffer_store_dwordx4 v[36:39], v5, s[16:19], s52 offen offset:1040
    v_perm_b32 v32, v19, v17, s54
    v_perm_b32 v33, v23, v21, s54
    v_perm_b32 v34, v27, v25, s54
    v_perm_b32 v35, v31, v29, s54
    buffer_store_dwordx4 v[32:35], v5, s[16:19], s52 offen offset:2080
    v_perm_b32 v36, v19, v17, s55
    v_perm_b32 v37, v23, v21, s55
    v_perm_b32 v38, v27, v25, s55
    v_perm_b32 v39, v31, v29, s55
    buffer_store_dwordx4 v[36:39], v5, s[16:19], s52 offen offset:3120
    s_mov_b32 s69, 0
p1_o1:
    s_waitcnt lgkmcnt(0)
    s_barrier
    s_cmp_le_u32 s35, 9216
    s_cbranch_scc1 p1_ce1
    v_lshlrev_b32 v117, 2, v119
    v_sub_u32 v117, 113908, v117
    ds_read_b32 v122, v117 offset:49160
    ds_read_b32 v123, v117 offset:49156
    ds_read_b32 v124, v117 offset:49152
    ds_read_b32 v125, v118 offset:38144
    ds_read_b32 v121, v118 offset:38148
    ds_read_b32 v110, v117 offset:36872
    ds_read_b32 v111, v117 offset:36868
    ds_read_b32 v112, v117 offset:36864
    ds_read_b32 v113, v118 offset:41216
    ds_read_b32 v114, v118 offset:41220
    s_waitcnt lgkmcnt(5)
    v_alignbyte_b32 v125, v121, v125, v119
    s_cmp_le_u32 s71, 9
    s_cbranch_scc1 p1_pw9
    buffer_store_dwordx4 v[122:125], v120, s[20:23], 0 offen
    s_branch p1_px9
p1_pw9:
    buffer_store_dwordx4 v[122:125], v120, s[20:23], 0 offen nt
p1_px9:
    v_add_u32 v120, 33554432, v120
    s_nop 0
    ds_read_b32 v122, v117 offset:24584
    ds_read_b32 v123, v117 offset:24580
    ds_read_b32 v124, v117 offset:24576
    ds_read_b32 v125, v118 offset:44288
    ds_read_b32 v121, v118 offset:44292
    s_cmp_le_u32 s35, 10240
    s_cbranch_scc1 p1_ce1
    s_waitcnt lgkmcnt(5)
    v_alignbyte_b32 v113, v114, v113, v119
    buffer_store_dwordx4 v[110:113], v120, s[20:23], 0 offen nt
    v_add_u32 v120, 33554432, v120
    s_nop 0
    ds_read_b32 v110, v117 offset:12296
    ds_read_b32 v111, v117 offset:12292
    ds_read_b32 v112, v117 offset:12288
    ds_read_b32 v113, v118 offset:47360
    ds_read_b32 v114, v118 offset:47364
    s_cmp_le_u32 s35, 11264
    s_cbranch_scc1 p1_ce1
    s_waitcnt lgkmcnt(5)
    v_alignbyte_b32 v125, v121, v125, v119
    buffer_store_dwordx4 v[122:125], v120, s[20:23], 0 offen nt
    v_add_u32 v120, 33554432, v120
    s_nop 0
    ds_read_b32 v122, v117 offset:8
    ds_read_b32 v123, v117 offset:4
    ds_read_b32 v124, v117 offset:0
    ds_read_b32 v125, v118 offset:50432
    ds_read_b32 v121, v118 offset:50436
    s_cmp_le_u32 s35, 12288
    s_cbranch_scc1 p1_ce1
    s_waitcnt lgkmcnt(5)
    v_alignbyte_b32 v113, v114, v113, v119
    buffer_store_dwordx4 v[110:113], v120, s[20:23], 0 offen nt
    v_add_u32 v120, 33554432, v120
    s_nop 0
    s_cmp_le_u32 s35, 13312
    s_cbranch_scc1 p1_ce1
    s_waitcnt lgkmcnt(0)
    v_alignbyte_b32 v125, v121, v125, v119
    buffer_store_dwordx4 v[122:125], v120, s[20:23], 0 offen nt
    v_add_u32 v120, 33554432, v120
    s_nop 0
p1_ce1:
    s_waitcnt lgkmcnt(0)
    s_cmp_lg_u32 s69, 8
    s_cbranch_scc1 p1_o2
    s_lshr_b32 s52, s29, 3
    s_mul_i32 s52, s52, 41600
    s_add_u32 s52, s52, 477470720
    s_mov_b32 s54, 0x05040100
    s_mov_b32 s55, 0x07060302
    s_waitcnt vmcnt(0)
    v_perm_b32 v32, v18, v16, s54
    v_perm_b32 v33, v22, v20, s54
    v_perm_b32 v34, v26, v24, s54
    v_perm_b32 v35, v30, v28, s54
    buffer_store_dwordx4 v[32:35], v5, s[16:19], s52 offen offset:0
    v_perm_b32 v36, v18, v16, s55
    v_perm_b32 v37, v22, v20, s55
    v_perm_b32 v38, v26, v24, s55
    v_perm_b32 v39, v30, v28, s55
    buffer_store_dwordx4 v[36:39], v5, s[16:19], s52 offen offset:1040
    v_perm_b32 v32, v19, v17, s54
    v_perm_b32 v33, v23, v21, s54
    v_perm_b32 v34, v27, v25, s54
    v_perm_b32 v35, v31, v29, s54
    buffer_store_dwordx4 v[32:35], v5, s[16:19], s52 offen offset:2080
    v_perm_b32 v36, v19, v17, s55
    v_perm_b32 v37, v23, v21, s55
    v_perm_b32 v38, v27, v25, s55
    v_perm_b32 v39, v31, v29, s55
    buffer_store_dwordx4 v[36:39], v5, s[16:19], s52 offen offset:3120
p1_o2:
    s_barrier
    s_mov_b32 s29, s33
    s_cmp_lt_u32 s29, 1285
    s_cselect_b32 s34, 1, 0
    s_cmp_lt_u32 s29, 1472
    s_cbranch_scc1 p1_tile
p1_end:
    s_endpgm
.globl p2_kernel
.p2align 8
.type p2_kernel,@function
p2_kernel:
    s_cmp_ge_u32 s2, 256
    s_cbranch_scc1 p2_end
    s_load_dwordx2 s[8:9], s[0:1], 104
    v_and_b32 v112, 63, v0
    v_lshrrev_b32 v122, 6, v0
    v_lshlrev_b32 v112, 4, v112
    v_readfirstlane_b32 s10, v122
    v_mov_b32 v113, 0x83ff0000
    s_and_b32 s44, s2, 7
    s_lshr_b32 s11, s44, 1
    s_and_b32 s44, s44, 1
    s_lshl_b32 s12, s44, 5
    s_lshr_b32 s44, s2, 3
    s_add_u32 s12, s12, s44
    s_mov_b32 s25, 54272
    s_mov_b32 s31, 67175170
    s_mov_b32 s32, 83952386
    s_mov_b32 s33, 100729602
    s_mov_b32 s21, 0
    s_mul_i32 s23, s10, 3072
    s_lshl_b32 s24, s10, 9
    s_lshl_b32 s64, s10, 10
    s_sub_u32 s42, s24, s23
    s_add_u32 s42, s42, 49152
    s_movk_i32 s63, 2048
    s_mov_b32 s65, 16384
    s_mul_i32 s62, s11, 161280
    s_add_u32 s62, s62, 485125120
    s_add_u32 s62, s62, s23
    s_mov_b32 s40, 477470720
    s_mul_i32 s44, s11, 1040
    s_add_u32 s40, s40, s44
    s_lshl_b32 s44, s12, 4
    s_add_u32 s40, s40, s44
    s_waitcnt lgkmcnt(0)
    s_mov_b32 s4, s8
    s_and_b32 s5, s9, 0xffff
    s_mov_b32 s6, 819200000
    s_mov_b32 s7, 0x20000
    s_mov_b32 s68, s8
    s_and_b32 s69, s9, 0xffff
    s_mov_b32 s70, 469745664
    s_mov_b32 s71, 0x20000
    s_and_b32 s44, s2, 7
    s_lshl_b32 s44, s44, 2
    s_lshr_b32 s18, 0x00000000, s44
    s_and_b32 s18, s18, 15
p2_restart:
    s_mov_b32 s61, 0
    s_add_u32 s44, s61, s18
    s_cmp_ge_u32 s44, 10
    s_cselect_b32 s53, 10, 0
    s_sub_u32 s44, s44, s53
    s_mul_i32 s44, s44, 4160
    s_add_u32 s44, s44, s40
    v_bfe_i32 v111, v112, 6, 1
    v_lshrrev_b32 v110, 6, v112
    v_bitop3_b32 v111, v111, 15, s10 bitop3:0x6a
    v_lshl_or_b32 v110, v110, 4, v111
    v_add_u32 v111, 72, v110
    v_and_b32 v111, 0x100, v111
    v_lshl_or_b32 v110, v111, 7, v110
    v_bfe_u32 v111, v112, 2, 4
    v_mul_u32_u24 v110, 41600, v110
    v_add_u32 v111, v110, v111
    buffer_load_dword v110, v111, s[4:7], s44 offen
    buffer_load_dword v111, v111, s[4:7], s44 offen offset:16
    s_mov_b32 s61, 1
    s_add_u32 s44, s61, s18
    s_cmp_ge_u32 s44, 10
    s_cselect_b32 s53, 10, 0
    s_sub_u32 s44, s44, s53
    s_mul_i32 s44, s44, 4160
    s_add_u32 s44, s44, s40
    v_bfe_i32 v67, v112, 6, 1
    v_lshrrev_b32 v66, 6, v112
    v_bitop3_b32 v67, v67, 15, s10 bitop3:0x6a
    v_lshl_or_b32 v66, v66, 4, v67
    v_add_u32 v67, 72, v66
    v_and_b32 v67, 0x100, v67
    v_lshl_or_b32 v66, v67, 7, v66
    v_bfe_u32 v67, v112, 2, 4
    v_mul_u32_u24 v66, 41600, v66
    v_add_u32 v67, v66, v67
    buffer_load_dword v66, v67, s[4:7], s44 offen
    buffer_load_dword v67, v67, s[4:7], s44 offen offset:16
    s_mov_b32 s61, 0
    s_cmp_lt_u32 s10, 15
    s_cselect_b32 s44, s64, 0x40000000
    v_add_u32 v58, s44, v112
    s_mov_b32 s44, 491576320
    buffer_load_dwordx4 v[58:61], v58, s[4:7], s44 offen
    s_mul_i32 s20, s18, 645120
    s_add_u32 s20, s20, s62
    s_cmp_ge_u32 s10, 9
    s_cbranch_scc1 p2_nmp
    v_lshrrev_b32 v84, 1, v112
    s_add_u32 s44, s20, s42
    buffer_load_dwordx2 v[84:85], v84, s[4:7], s44 offen
p2_nmp:
    buffer_load_dwordx4 v[72:75], v112, s[4:7], s20 offen offset:0
    buffer_load_dwordx4 v[76:79], v112, s[4:7], s20 offen offset:1024
    buffer_load_dwordx4 v[80:83], v112, s[4:7], s20 offen offset:2048
    s_barrier
    v_mov_b32 v115, 0
    v_mov_b32 v116, 0
    v_mov_b32 v117, 0
    v_mov_b32 v118, 0
    v_mov_b32 v119, 0
    v_mov_b32 v120, 0
    v_mov_b32 v121, 0
    ds_write_b128 v115, v[116:119] offset:53760
    s_mov_b32 s19, 0
    s_cmp_eq_u32 s21, 2
    s_cselect_b64 s[66:67], -1, 0
    s_waitcnt lgkmcnt(0)
    s_barrier
    s_waitcnt vmcnt(6)
    s_mov_b32 m0, s23
    v_mov_b32 v53, 0
    s_movk_i32 s44, 512
    v_sub_u32_sdwa v4, v111, v110 dst_sel:DWORD dst_unused:UNUSED_PAD src0_sel:WORD_0 src1_sel:WORD_0
    v_sub_u32_sdwa v5, v111, v110 dst_sel:DWORD dst_unused:UNUSED_PAD src0_sel:WORD_1 src1_sel:WORD_1
    v_med3_i32 v4, v4, 0, s44
    v_med3_i32 v5, v5, 0, s44
    v_add_u32 v48, v4, v5
    ds_write_addtid_b32 v53 offset:0
    ds_write_addtid_b32 v53 offset:256
    ds_write_addtid_b32 v53 offset:512
    ds_write_addtid_b32 v53 offset:768
    ds_write_addtid_b32 v53 offset:1024
    ds_write_addtid_b32 v53 offset:1280
    ds_write_addtid_b32 v53 offset:1536
    ds_write_addtid_b32 v53 offset:1792
    v_bfe_i32 v53, v112, 6, 1
    v_lshrrev_b32 v49, 6, v112
    v_bitop3_b32 v53, v53, 15, s10 bitop3:0x6a
    v_lshl_or_b32 v49, v49, 4, v53
    v_and_b32 v53, 0x30, v112
    v_lshl_or_b32 v53, v49, 6, v53
    v_lshlrev_b32 v53, 15, v53
    s_nop 1
    v_add_u32_dpp v48, v48, v48 row_shr:1 row_mask:0xf bank_mask:0xf bound_ctrl:0
    s_nop 1
    v_add_u32_dpp v48, v48, v48 row_shr:2 row_mask:0xf bank_mask:0xf bound_ctrl:0
    s_nop 1
    v_add_u32_dpp v48, v48, v48 row_shr:4 row_mask:0xf bank_mask:0xf bound_ctrl:0
    s_nop 1
    v_add_u32_dpp v48, v48, v48 row_shr:8 row_mask:0xf bank_mask:0xf bound_ctrl:0
    s_nop 1
    v_add_u32_dpp v48, v48, v48 row_bcast:15 row_mask:0xa bank_mask:0xf
    s_nop 1
    v_add_u32_dpp v48, v48, v48 row_bcast:31 row_mask:0xc bank_mask:0xf
    s_nop 1
    s_nop 0
    v_readlane_b32 s38, v48, 63
    v_sub_u32 v50, v48, v5
    v_sub_u32 v49, v50, v4
    v_writelane_b32 v5, 1, 63
    v_sub_u32 v10, 512, v49
    v_mad_u32_u16 v51, v110, 16, v53
    v_lshl_add_u32 v51, v10, 4, v51
    v_med3_i32 v10, v10, 0, v4
    v_lshl_add_u32 v49, v49, 2, s23
    v_sub_u32 v11, 512, v50
    v_mad_u32_u16 v52, v110, 16, v53 op_sel:[1,0,0,0]
    v_add_u32 v52, 262144, v52
    s_mov_b32 s44, 0x1fffc000
    v_writelane_b32 v52, s44, 63
    v_lshl_add_u32 v52, v11, 4, v52
    v_med3_i32 v11, v11, 0, v5
    v_lshl_add_u32 v50, v50, 2, s23
    v_lshl_add_u32 v48, v11, 16, v10
    v_add_u32 v110, v110, v48
    s_min_u32 s17, s38, 512
    s_add_u32 s17, s17, 63
    s_lshr_b32 s17, s17, 6
    v_cmpx_lt_i32 vcc, 0, v10
    ds_write_b32 v49, v51
    s_mov_b64 exec, -1
    v_cmpx_lt_i32 vcc, 0, v11
    ds_write_b32 v50, v52
    s_mov_b64 exec, -1
    s_cmp_lt_u32 s38, 512
    s_cbranch_scc1 p2_nomorea
    v_cmp_lt_u32_sdwa s[44:45], v110, v111 src0_sel:WORD_0 src1_sel:WORD_0
    v_cmp_lt_u32_sdwa s[46:47], v110, v111 src0_sel:WORD_1 src1_sel:WORD_1
    s_nop 0
    s_or_b64 s[44:45], s[44:45], s[46:47]
    s_cbranch_scc0 p2_nomorea
    v_mov_b32 v49, s19
    v_mov_b32 v50, 1
    ds_write_b32 v49, v50 offset:53760
p2_nomorea:
    s_mov_b32 m0, s23
    s_nop 0
    ds_read_addtid_b32 v2 offset:1024
    ds_read_addtid_b32 v8 offset:1280
    ds_read_addtid_b32 v14 offset:1536
    ds_read_addtid_b32 v20 offset:1792
    ds_read_addtid_b32 v88 offset:0
    ds_read_addtid_b32 v92 offset:256
    ds_read_addtid_b32 v96 offset:512
    ds_read_addtid_b32 v100 offset:768
    s_waitcnt lgkmcnt(0)
    s_nop 2
    s_nop 1
    v_max_u32_dpp v88, v88, v88 row_shr:1 row_mask:0xf bank_mask:0xf bound_ctrl:0
    v_max_u32_dpp v92, v92, v92 row_shr:1 row_mask:0xf bank_mask:0xf bound_ctrl:0
    v_max_u32_dpp v96, v96, v96 row_shr:1 row_mask:0xf bank_mask:0xf bound_ctrl:0
    v_max_u32_dpp v100, v100, v100 row_shr:1 row_mask:0xf bank_mask:0xf bound_ctrl:0
    v_max_u32_dpp v2, v2, v2 row_shr:1 row_mask:0xf bank_mask:0xf bound_ctrl:0
    v_max_u32_dpp v8, v8, v8 row_shr:1 row_mask:0xf bank_mask:0xf bound_ctrl:0
    v_max_u32_dpp v14, v14, v14 row_shr:1 row_mask:0xf bank_mask:0xf bound_ctrl:0
    v_max_u32_dpp v20, v20, v20 row_shr:1 row_mask:0xf bank_mask:0xf bound_ctrl:0
    v_max_u32_dpp v88, v88, v88 row_shr:2 row_mask:0xf bank_mask:0xf bound_ctrl:0
    v_max_u32_dpp v92, v92, v92 row_shr:2 row_mask:0xf bank_mask:0xf bound_ctrl:0
    v_max_u32_dpp v96, v96, v96 row_shr:2 row_mask:0xf bank_mask:0xf bound_ctrl:0
    v_max_u32_dpp v100, v100, v100 row_shr:2 row_mask:0xf bank_mask:0xf bound_ctrl:0
    v_max_u32_dpp v2, v2, v2 row_shr:2 row_mask:0xf bank_mask:0xf bound_ctrl:0
    v_max_u32_dpp v8, v8, v8 row_shr:2 row_mask:0xf bank_mask:0xf bound_ctrl:0
    v_max_u32_dpp v14, v14, v14 row_shr:2 row_mask:0xf bank_mask:0xf bound_ctrl:0
    v_max_u32_dpp v20, v20, v20 row_shr:2 row_mask:0xf bank_mask:0xf bound_ctrl:0
    v_max_u32_dpp v88, v88, v88 row_shr:4 row_mask:0xf bank_mask:0xf bound_ctrl:0
    v_max_u32_dpp v92, v92, v92 row_shr:4 row_mask:0xf bank_mask:0xf bound_ctrl:0
    v_max_u32_dpp v96, v96, v96 row_shr:4 row_mask:0xf bank_mask:0xf bound_ctrl:0
    v_max_u32_dpp v100, v100, v100 row_shr:4 row_mask:0xf bank_mask:0xf bound_ctrl:0
    v_max_u32_dpp v2, v2, v2 row_shr:4 row_mask:0xf bank_mask:0xf bound_ctrl:0
    v_max_u32_dpp v8, v8, v8 row_shr:4 row_mask:0xf bank_mask:0xf bound_ctrl:0
    v_max_u32_dpp v14, v14, v14 row_shr:4 row_mask:0xf bank_mask:0xf bound_ctrl:0
    v_max_u32_dpp v20, v20, v20 row_shr:4 row_mask:0xf bank_mask:0xf bound_ctrl:0
    v_max_u32_dpp v88, v88, v88 row_shr:8 row_mask:0xf bank_mask:0xf bound_ctrl:0
    v_max_u32_dpp v92, v92, v92 row_shr:8 row_mask:0xf bank_mask:0xf bound_ctrl:0
    v_max_u32_dpp v96, v96, v96 row_shr:8 row_mask:0xf bank_mask:0xf bound_ctrl:0
    v_max_u32_dpp v100, v100, v100 row_shr:8 row_mask:0xf bank_mask:0xf bound_ctrl:0
    v_max_u32_dpp v2, v2, v2 row_shr:8 row_mask:0xf bank_mask:0xf bound_ctrl:0
    v_max_u32_dpp v8, v8, v8 row_shr:8 row_mask:0xf bank_mask:0xf bound_ctrl:0
    v_max_u32_dpp v14, v14, v14 row_shr:8 row_mask:0xf bank_mask:0xf bound_ctrl:0
    v_max_u32_dpp v20, v20, v20 row_shr:8 row_mask:0xf bank_mask:0xf bound_ctrl:0
    v_max_u32_dpp v88, v88, v88 row_bcast:15 row_mask:0xa bank_mask:0xf
    v_max_u32_dpp v92, v92, v92 row_bcast:15 row_mask:0xa bank_mask:0xf
    v_max_u32_dpp v96, v96, v96 row_bcast:15 row_mask:0xa bank_mask:0xf
    v_max_u32_dpp v100, v100, v100 row_bcast:15 row_mask:0xa bank_mask:0xf
    v_max_u32_dpp v2, v2, v2 row_bcast:15 row_mask:0xa bank_mask:0xf
    v_max_u32_dpp v8, v8, v8 row_bcast:15 row_mask:0xa bank_mask:0xf
    v_max_u32_dpp v14, v14, v14 row_bcast:15 row_mask:0xa bank_mask:0xf
    v_max_u32_dpp v20, v20, v20 row_bcast:15 row_mask:0xa bank_mask:0xf
    v_max_u32_dpp v88, v88, v88 row_bcast:31 row_mask:0xc bank_mask:0xf
    v_max_u32_dpp v92, v92, v92 row_bcast:31 row_mask:0xc bank_mask:0xf
    v_max_u32_dpp v96, v96, v96 row_bcast:31 row_mask:0xc bank_mask:0xf
    v_max_u32_dpp v100, v100, v100 row_bcast:31 row_mask:0xc bank_mask:0xf
    v_max_u32_dpp v2, v2, v2 row_bcast:31 row_mask:0xc bank_mask:0xf
    v_max_u32_dpp v8, v8, v8 row_bcast:31 row_mask:0xc bank_mask:0xf
    v_max_u32_dpp v14, v14, v14 row_bcast:31 row_mask:0xc bank_mask:0xf
    v_max_u32_dpp v20, v20, v20 row_bcast:31 row_mask:0xc bank_mask:0xf
    s_nop 0
    v_readlane_b32 s41, v88, 63
    v_add_u32 v88, v88, v112
    v_add_u32 v88, 4294959104, v88
    v_max_u32 v92, s41, v92
    s_nop 0
    v_readlane_b32 s41, v92, 63
    v_add_u32 v92, v92, v112
    v_add_u32 v92, 4294960128, v92
    v_max_u32 v96, s41, v96
    s_nop 0
    v_readlane_b32 s41, v96, 63
    v_add_u32 v96, v96, v112
    v_add_u32 v96, 4294961152, v96
    v_max_u32 v100, s41, v100
    s_nop 0
    v_readlane_b32 s41, v100, 63
    v_add_u32 v100, v100, v112
    v_add_u32 v100, 4294962176, v100
    v_max_u32 v2, s41, v2
    s_nop 0
    v_readlane_b32 s41, v2, 63
    v_add_u32 v2, v2, v112
    v_add_u32 v2, 4294963200, v2
    v_max_u32 v8, s41, v8
    s_nop 0
    v_readlane_b32 s41, v8, 63
    v_add_u32 v8, v8, v112
    v_add_u32 v8, 4294964224, v8
    v_max_u32 v14, s41, v14
    s_nop 0
    v_readlane_b32 s41, v14, 63
    v_add_u32 v14, v14, v112
    v_add_u32 v14, 4294965248, v14
    v_max_u32 v20, s41, v20
    s_nop 0
    v_readlane_b32 s41, v20, 63
    v_add_u32 v20, v20, v112
    v_add_u32 v20, 4294966272, v20
    v_bfe_u32 v0, v2, 14, 4
    v_lshrrev_b32 v1, 18, v2
    v_and_b32 v2, 16383, v2
    v_mad_u32_u24 v0, v0, s63, v1
    v_mad_u32_u24 v2, v0, s65, v2
    buffer_load_dwordx4 v[0:3], v2, s[68:71], 0 offen
    v_bfe_u32 v6, v8, 14, 4
    v_lshrrev_b32 v7, 18, v8
    v_and_b32 v8, 16383, v8
    v_mad_u32_u24 v6, v6, s63, v7
    v_mad_u32_u24 v8, v6, s65, v8
    buffer_load_dwordx4 v[6:9], v8, s[68:71], 0 offen
    s_cmp_eq_u32 s21, 0
    s_cselect_b32 s44, 1073758208, 0
    v_mov_b32 v124, s44
    v_mov_b32 v125, s44
    v_mov_b32 v126, s44
    v_mov_b32 v127, s44
    v_add_u32 v123, s64, v112
    v_add_u32 v122, s25, v123
    ds_write_b128 v122, v[124:127] offset:0
    ds_write_b128 v122, v[124:127] offset:16384
    ds_write_b128 v122, v[124:127] offset:32768
    v_add_u32 v122, 49152, v122
    ds_write_b128 v122, v[124:127] offset:0
    ds_write_b128 v122, v[124:127] offset:16384
    ds_write_b128 v122, v[124:127] offset:32768
    v_cmpx_gt_u32 vcc, 1792, v123
    ds_write_b128 v122, v[124:127] offset:49152
    s_mov_b64 exec, -1
    v_bfe_u32 v12, v14, 14, 4
    v_lshrrev_b32 v13, 18, v14
    v_and_b32 v14, 16383, v14
    v_mad_u32_u24 v12, v12, s63, v13
    v_mad_u32_u24 v14, v12, s65, v14
    buffer_load_dwordx4 v[12:15], v14, s[68:71], 0 offen
    s_mov_b32 s16, s17
    s_waitcnt vmcnt(6)
    s_cmp_lg_u32 s21, 0
    s_cbranch_scc1 p2_nostat1
    v_max_u32 v58, v58, v60
    v_add_f32 v59, v59, v61
    s_nop 1
    v_max_u32_dpp v58, v58, v58 row_shr:1 row_mask:0xf bank_mask:0xf bound_ctrl:0
    v_add_f32_dpp v59, v59, v59 row_shr:1 row_mask:0xf bank_mask:0xf bound_ctrl:0
    s_nop 0
    v_max_u32_dpp v58, v58, v58 row_shr:2 row_mask:0xf bank_mask:0xf bound_ctrl:0
    v_add_f32_dpp v59, v59, v59 row_shr:2 row_mask:0xf bank_mask:0xf bound_ctrl:0
    s_nop 0
    v_max_u32_dpp v58, v58, v58 row_shr:4 row_mask:0xf bank_mask:0xf bound_ctrl:0
    v_add_f32_dpp v59, v59, v59 row_shr:4 row_mask:0xf bank_mask:0xf bound_ctrl:0
    s_nop 0
    v_max_u32_dpp v58, v58, v58 row_shr:8 row_mask:0xf bank_mask:0xf bound_ctrl:0
    v_add_f32_dpp v59, v59, v59 row_shr:8 row_mask:0xf bank_mask:0xf bound_ctrl:0
    s_nop 0
    v_max_u32_dpp v58, v58, v58 row_bcast:15 row_mask:0xa bank_mask:0xf
    v_add_f32_dpp v59, v59, v59 row_bcast:15 row_mask:0xa bank_mask:0xf
    s_nop 0
    v_max_u32_dpp v58, v58, v58 row_bcast:31 row_mask:0xc bank_mask:0xf
    v_add_f32_dpp v59, v59, v59 row_bcast:31 row_mask:0xc bank_mask:0xf
    s_nop 0
    s_nop 0
    s_lshl_b32 s44, s10, 3
    v_mov_b32 v60, s44
    s_mov_b64 exec, 1
    s_lshl_b64 exec, exec, 63
    ds_write_b64 v60, v[58:59] offset:53824
    s_mov_b64 exec, -1
p2_nostat1:
    s_waitcnt lgkmcnt(0)
    s_barrier
    v_bfe_u32 v18, v20, 14, 4
    v_lshrrev_b32 v19, 18, v20
    v_and_b32 v20, 16383, v20
    v_mad_u32_u24 v18, v18, s63, v19
    v_mad_u32_u24 v20, v18, s65, v20
    buffer_load_dwordx4 v[18:21], v20, s[68:71], 0 offen
    v_mov_b32 v122, s19
    s_xor_b32 s19, s19, 4
    ds_read_b32 v125, v122 offset:53760
    s_cmp_lg_u32 s21, 0
    s_cbranch_scc1 p2_nostat2
    v_bfe_u32 v60, v112, 1, 7
    ds_read_b64 v[58:59], v60 offset:53824
    s_waitcnt lgkmcnt(0)
    s_nop 1
    v_max_u32_dpp v58, v58, v58 row_shr:1 row_mask:0xf bank_mask:0xf bound_ctrl:0
    v_add_f32_dpp v59, v59, v59 row_shr:1 row_mask:0xf bank_mask:0xf bound_ctrl:0
    s_nop 0
    v_max_u32_dpp v58, v58, v58 row_shr:2 row_mask:0xf bank_mask:0xf bound_ctrl:0
    v_add_f32_dpp v59, v59, v59 row_shr:2 row_mask:0xf bank_mask:0xf bound_ctrl:0
    s_nop 0
    v_max_u32_dpp v58, v58, v58 row_shr:4 row_mask:0xf bank_mask:0xf bound_ctrl:0
    v_add_f32_dpp v59, v59, v59 row_shr:4 row_mask:0xf bank_mask:0xf bound_ctrl:0
    s_nop 0
    v_max_u32_dpp v58, v58, v58 row_shr:8 row_mask:0xf bank_mask:0xf bound_ctrl:0
    v_add_f32_dpp v59, v59, v59 row_shr:8 row_mask:0xf bank_mask:0xf bound_ctrl:0
    s_nop 0
    v_max_u32_dpp v58, v58, v58 row_bcast:15 row_mask:0xa bank_mask:0xf
    v_add_f32_dpp v59, v59, v59 row_bcast:15 row_mask:0xa bank_mask:0xf
    s_nop 0
    v_max_u32_dpp v58, v58, v58 row_bcast:31 row_mask:0xc bank_mask:0xf
    v_add_f32_dpp v59, v59, v59 row_bcast:31 row_mask:0xc bank_mask:0xf
    s_nop 0
    s_nop 0
    v_readlane_b32 s44, v58, 15
    v_readlane_b32 s45, v59, 15
    s_nop 1
    s_lshl_b32 s44, s44, 16
    s_lshr_b32 s46, s44, 23
    s_sub_u32 s47, s46, 80
    s_cmp_lt_u32 s47, 100
    s_cselect_b32 s21, 0, 1
    v_mov_b32 v58, s45
    v_mul_f32 v58, 0x34a7c5ac, v58
    v_sqrt_f32 v58, v58
    v_mov_b32 v59, s44
    v_mul_f32 v60, 0x41800000, v58
    v_cmp_nle_f32 vcc, v59, v60
    v_mul_f32 v58, 0x3ac00000, v58
    v_mul_f32 v59, 0x3901742e, v59
    v_max_f32 v58, v58, v59
    s_cmp_lg_u64 vcc, 0
    s_cselect_b32 s21, 1, s21
    v_readfirstlane_b32 s44, v58
    s_nop 0
    s_and_b32 s47, s44, 0x7fffff
    s_or_b32 s47, s47, 0x3f000000
    s_and_b32 s48, s44, 0x7f800000
    s_add_u32 s48, s48, 0x800000
    v_rcp_f32 v58, s47
    s_nop 0
    v_rcp_f32 v59, v58
    v_mul_f32 v58, 0x7b800000, v58
    v_mul_f32 v59, s48, v59
    s_nop 0
    v_readfirstlane_b32 s26, v58
    v_readfirstlane_b32 s30, v59
    s_add_u32 s34, s48, 197132288
    s_mov_b32 s35, s34
    s_sub_u32 s36, 0, s34
    s_subb_u32 s37, 0, s34
    s_cmp_eq_u32 s21, 0
    s_cbranch_scc1 p2_nostat2
    s_waitcnt vmcnt(0) lgkmcnt(0)
    s_branch p2_restart
p2_nostat2:
    s_cmp_eq_u32 s21, 0
    s_cselect_b32 s26, s26, 0x7b800000
    v_mov_b32 v114, s26
    s_waitcnt lgkmcnt(0)
    v_readfirstlane_b32 s44, v125
    s_nop 0
    s_cmp_lg_u32 s44, 0
    s_cbranch_scc1 p2_adva
    s_mov_b32 s61, 1
    v_mov_b32 v110, v66
    v_mov_b32 v111, v67
p2_adva:
    v_bfe_u32 v86, v88, 14, 4
    v_lshrrev_b32 v87, 18, v88
    v_and_b32 v88, 16383, v88
    v_mad_u32_u24 v86, v86, s63, v87
    v_mad_u32_u24 v88, v86, s65, v88
    buffer_load_dwordx4 v[86:89], v88, s[68:71], 0 offen
    s_mov_b32 m0, s23
    v_mov_b32 v53, 0
    s_movk_i32 s44, 512
    v_sub_u32_sdwa v4, v111, v110 dst_sel:DWORD dst_unused:UNUSED_PAD src0_sel:WORD_0 src1_sel:WORD_0
    v_sub_u32_sdwa v5, v111, v110 dst_sel:DWORD dst_unused:UNUSED_PAD src0_sel:WORD_1 src1_sel:WORD_1
    v_med3_i32 v4, v4, 0, s44
    v_med3_i32 v5, v5, 0, s44
    v_add_u32 v48, v4, v5
    ds_write_addtid_b32 v53 offset:0
    ds_write_addtid_b32 v53 offset:256
    ds_write_addtid_b32 v53 offset:512
    ds_write_addtid_b32 v53 offset:768
    ds_write_addtid_b32 v53 offset:1024
    ds_write_addtid_b32 v53 offset:1280
    ds_write_addtid_b32 v53 offset:1536
    ds_write_addtid_b32 v53 offset:1792
    v_bfe_i32 v53, v112, 6, 1
    v_lshrrev_b32 v49, 6, v112
    v_bitop3_b32 v53, v53, 15, s10 bitop3:0x6a
    v_lshl_or_b32 v49, v49, 4, v53
    v_and_b32 v53, 0x30, v112
    v_lshl_or_b32 v53, v49, 6, v53
    v_lshlrev_b32 v53, 15, v53
    s_nop 1
    v_add_u32_dpp v48, v48, v48 row_shr:1 row_mask:0xf bank_mask:0xf bound_ctrl:0
    s_nop 1
    v_add_u32_dpp v48, v48, v48 row_shr:2 row_mask:0xf bank_mask:0xf bound_ctrl:0
    s_nop 1
    v_add_u32_dpp v48, v48, v48 row_shr:4 row_mask:0xf bank_mask:0xf bound_ctrl:0
    s_nop 1
    v_add_u32_dpp v48, v48, v48 row_shr:8 row_mask:0xf bank_mask:0xf bound_ctrl:0
    s_nop 1
    v_add_u32_dpp v48, v48, v48 row_bcast:15 row_mask:0xa bank_mask:0xf
    s_nop 1
    v_add_u32_dpp v48, v48, v48 row_bcast:31 row_mask:0xc bank_mask:0xf
    s_nop 1
    s_nop 0
    v_readlane_b32 s38, v48, 63
    v_sub_u32 v50, v48, v5
    v_sub_u32 v49, v50, v4
    v_writelane_b32 v5, 1, 63
    v_sub_u32 v10, 512, v49
    v_mad_u32_u16 v51, v110, 16, v53
    v_lshl_add_u32 v51, v10, 4, v51
    v_med3_i32 v10, v10, 0, v4
    v_lshl_add_u32 v49, v49, 2, s23
    v_sub_u32 v11, 512, v50
    v_mad_u32_u16 v52, v110, 16, v53 op_sel:[1,0,0,0]
    v_add_u32 v52, 262144, v52
    s_mov_b32 s44, 0x1fffc000
    v_writelane_b32 v52, s44, 63
    v_lshl_add_u32 v52, v11, 4, v52
    v_med3_i32 v11, v11, 0, v5
    v_lshl_add_u32 v50, v50, 2, s23
    v_lshl_add_u32 v48, v11, 16, v10
    v_add_u32 v110, v110, v48
    s_min_u32 s17, s38, 512
    s_add_u32 s17, s17, 63
    s_lshr_b32 s17, s17, 6
    v_cmpx_lt_i32 vcc, 0, v10
    ds_write_b32 v49, v51
    s_mov_b64 exec, -1
    v_cmpx_lt_i32 vcc, 0, v11
    ds_write_b32 v50, v52
    s_mov_b64 exec, -1
    s_cmp_lt_u32 s38, 512
    s_cbranch_scc1 p2_nomoreb
    v_cmp_lt_u32_sdwa s[44:45], v110, v111 src0_sel:WORD_0 src1_sel:WORD_0
    v_cmp_lt_u32_sdwa s[46:47], v110, v111 src0_sel:WORD_1 src1_sel:WORD_1
    s_nop 0
    s_or_b64 s[44:45], s[44:45], s[46:47]
    s_cbranch_scc0 p2_nomoreb
    v_mov_b32 v49, s19
    v_mov_b32 v50, 1
    ds_write_b32 v49, v50 offset:53760
p2_nomoreb:
    s_mov_b32 m0, s23
    s_nop 0
    ds_read_addtid_b32 v102 offset:1024
    ds_read_addtid_b32 v103 offset:1280
    ds_read_addtid_b32 v104 offset:1536
    ds_read_addtid_b32 v105 offset:1792
    ds_read_addtid_b32 v106 offset:0
    ds_read_addtid_b32 v107 offset:256
    ds_read_addtid_b32 v108 offset:512
    ds_read_addtid_b32 v109 offset:768
    v_bfe_u32 v90, v92, 14, 4
    v_lshrrev_b32 v91, 18, v92
    v_and_b32 v92, 16383, v92
    v_mad_u32_u24 v90, v90, s63, v91
    v_mad_u32_u24 v92, v90, s65, v92
    buffer_load_dwordx4 v[90:93], v92, s[68:71], 0 offen
    s_waitcnt vmcnt(6)
    s_mov_b32 m0, s24
    s_cmp_ge_u32 s10, 9
    s_cbranch_scc1 p2_stp
    ds_write_addtid_b32 v84 offset:49152
    ds_write_addtid_b32 v85 offset:49408
p2_stp:
    s_mov_b32 m0, s23
    s_add_u32 s20, s20, 53760
    ds_write_addtid_b32 v72 offset:0
    ds_write_addtid_b32 v73 offset:256
    ds_write_addtid_b32 v74 offset:512
    ds_write_addtid_b32 v75 offset:768
    ds_write_addtid_b32 v76 offset:1024
    ds_write_addtid_b32 v77 offset:1280
    ds_write_addtid_b32 v78 offset:1536
    ds_write_addtid_b32 v79 offset:1792
    ds_write_addtid_b32 v80 offset:2048
    ds_write_addtid_b32 v81 offset:2304
    ds_write_addtid_b32 v82 offset:2560
    ds_write_addtid_b32 v83 offset:2816
    s_waitcnt lgkmcnt(0)
    s_barrier
    v_bfe_u32 v94, v96, 14, 4
    v_lshrrev_b32 v95, 18, v96
    v_and_b32 v96, 16383, v96
    v_mad_u32_u24 v94, v94, s63, v95
    v_mad_u32_u24 v96, v94, s65, v96
    buffer_load_dwordx4 v[94:97], v96, s[68:71], 0 offen
    v_bfe_u32 v98, v100, 14, 4
    v_lshrrev_b32 v99, 18, v100
    v_and_b32 v100, 16383, v100
    v_mad_u32_u24 v98, v98, s63, v99
    v_mad_u32_u24 v100, v98, s65, v100
    buffer_load_dwordx4 v[98:101], v100, s[68:71], 0 offen
    s_nop 2
    s_nop 1
    v_max_u32_dpp v106, v106, v106 row_shr:1 row_mask:0xf bank_mask:0xf bound_ctrl:0
    v_max_u32_dpp v107, v107, v107 row_shr:1 row_mask:0xf bank_mask:0xf bound_ctrl:0
    v_max_u32_dpp v108, v108, v108 row_shr:1 row_mask:0xf bank_mask:0xf bound_ctrl:0
    v_max_u32_dpp v109, v109, v109 row_shr:1 row_mask:0xf bank_mask:0xf bound_ctrl:0
    v_max_u32_dpp v106, v106, v106 row_shr:2 row_mask:0xf bank_mask:0xf bound_ctrl:0
    v_max_u32_dpp v107, v107, v107 row_shr:2 row_mask:0xf bank_mask:0xf bound_ctrl:0
    v_max_u32_dpp v108, v108, v108 row_shr:2 row_mask:0xf bank_mask:0xf bound_ctrl:0
    v_max_u32_dpp v109, v109, v109 row_shr:2 row_mask:0xf bank_mask:0xf bound_ctrl:0
    v_max_u32_dpp v106, v106, v106 row_shr:4 row_mask:0xf bank_mask:0xf bound_ctrl:0
    v_max_u32_dpp v107, v107, v107 row_shr:4 row_mask:0xf bank_mask:0xf bound_ctrl:0
    v_max_u32_dpp v108, v108, v108 row_shr:4 row_mask:0xf bank_mask:0xf bound_ctrl:0
    v_max_u32_dpp v109, v109, v109 row_shr:4 row_mask:0xf bank_mask:0xf bound_ctrl:0
    v_max_u32_dpp v106, v106, v106 row_shr:8 row_mask:0xf bank_mask:0xf bound_ctrl:0
    v_max_u32_dpp v107, v107, v107 row_shr:8 row_mask:0xf bank_mask:0xf bound_ctrl:0
    v_max_u32_dpp v108, v108, v108 row_shr:8 row_mask:0xf bank_mask:0xf bound_ctrl:0
    v_max_u32_dpp v109, v109, v109 row_shr:8 row_mask:0xf bank_mask:0xf bound_ctrl:0
    v_max_u32_dpp v106, v106, v106 row_bcast:15 row_mask:0xa bank_mask:0xf
    v_max_u32_dpp v107, v107, v107 row_bcast:15 row_mask:0xa bank_mask:0xf
    v_max_u32_dpp v108, v108, v108 row_bcast:15 row_mask:0xa bank_mask:0xf
    v_max_u32_dpp v109, v109, v109 row_bcast:15 row_mask:0xa bank_mask:0xf
    v_max_u32_dpp v106, v106, v106 row_bcast:31 row_mask:0xc bank_mask:0xf
    v_max_u32_dpp v107, v107, v107 row_bcast:31 row_mask:0xc bank_mask:0xf
    v_max_u32_dpp v108, v108, v108 row_bcast:31 row_mask:0xc bank_mask:0xf
    v_max_u32_dpp v109, v109, v109 row_bcast:31 row_mask:0xc bank_mask:0xf
    s_nop 0
    v_readlane_b32 s41, v106, 63
    v_add_u32 v106, v106, v112
    v_add_u32 v106, 4294959104, v106
    v_max_u32 v107, s41, v107
    s_nop 0
    v_readlane_b32 s41, v107, 63
    v_add_u32 v107, v107, v112
    v_add_u32 v107, 4294960128, v107
    v_max_u32 v108, s41, v108
    s_nop 0
    v_readlane_b32 s41, v108, 63
    v_add_u32 v108, v108, v112
    v_add_u32 v108, 4294961152, v108
    v_max_u32 v109, s41, v109
    s_nop 0
    v_readlane_b32 s41, v109, 63
    v_add_u32 v109, v109, v112
    v_add_u32 v109, 4294962176, v109
    s_waitcnt vmcnt(7)
    v_perm_b32 v48, v3, v0, s31
    v_perm_b32 v49, v3, v1, s32
    v_perm_b32 v50, v3, v2, s33
    v_lshlrev_b16 v4, 3, v2
    v_lshlrev_b16 v2, 3, v1
    v_lshlrev_b16 v0, 3, v0
    v_cmpx_ge_u16 vcc, 0x3fff, v48
    ds_read_b64 v[0:1], v0
    s_mov_b64 exec, -1
    v_cmpx_ge_u16 vcc, 0x3fff, v49
    ds_read_b64 v[2:3], v2
    s_mov_b64 exec, -1
    v_cmpx_ge_u16 vcc, 0x3fff, v50
    ds_read_b64 v[4:5], v4
    s_mov_b64 exec, -1
    s_waitcnt vmcnt(6)
    v_perm_b32 v51, v9, v6, s31
    v_perm_b32 v52, v9, v7, s32
    v_perm_b32 v53, v9, v8, s33
    v_lshlrev_b16 v10, 3, v8
    v_lshlrev_b16 v8, 3, v7
    v_lshlrev_b16 v6, 3, v6
    v_cmpx_ge_u16 vcc, 0x3fff, v51
    ds_read_b64 v[6:7], v6
    s_mov_b64 exec, -1
    v_cmpx_ge_u16 vcc, 0x3fff, v52
    ds_read_b64 v[8:9], v8
    s_mov_b64 exec, -1
    v_cmpx_ge_u16 vcc, 0x3fff, v53
    ds_read_b64 v[10:11], v10
    s_mov_b64 exec, -1
    s_waitcnt vmcnt(5)
    v_perm_b32 v54, v15, v12, s31
    v_perm_b32 v55, v15, v13, s32
    v_perm_b32 v56, v15, v14, s33
    v_lshlrev_b16 v16, 3, v14
    v_lshlrev_b16 v14, 3, v13
    v_lshlrev_b16 v12, 3, v12
    v_cmpx_ge_u16 vcc, 0x3fff, v54
    ds_read_b64 v[12:13], v12
    s_mov_b64 exec, -1
    v_cmpx_ge_u16 vcc, 0x3fff, v55
    ds_read_b64 v[14:15], v14
    s_mov_b64 exec, -1
    v_cmpx_ge_u16 vcc, 0x3fff, v56
    ds_read_b64 v[16:17], v16
    s_mov_b64 exec, -1
    s_waitcnt vmcnt(4)
    v_perm_b32 v57, v21, v18, s31
    v_perm_b32 v58, v21, v19, s32
    v_perm_b32 v59, v21, v20, s33
    v_lshlrev_b16 v22, 3, v20
    v_lshlrev_b16 v20, 3, v19
    v_lshlrev_b16 v18, 3, v18
    s_cmp_lt_u32 s16, 8
    s_cbranch_scc1 p2_gp
    v_cmpx_ge_u16 vcc, 0x3fff, v57
    ds_read_b64 v[18:19], v18
    s_mov_b64 exec, -1
    v_cmpx_ge_u16 vcc, 0x3fff, v58
    ds_read_b64 v[20:21], v20
    s_mov_b64 exec, -1
    v_cmpx_ge_u16 vcc, 0x3fff, v59
    ds_read_b64 v[22:23], v22
    s_mov_b64 exec, -1
p2_gp:
    s_waitcnt vmcnt(3)
    v_perm_b32 v60, v89, v86, s31
    v_perm_b32 v61, v89, v87, s32
    v_perm_b32 v62, v89, v88, s33
    v_lshlrev_b16 v28, 3, v88
    v_lshlrev_b16 v26, 3, v87
    v_lshlrev_b16 v24, 3, v86
    v_cmpx_ge_u16 vcc, 0x3fff, v60
    ds_read_b64 v[24:25], v24
    s_mov_b64 exec, -1
    v_cmpx_ge_u16 vcc, 0x3fff, v61
    ds_read_b64 v[26:27], v26
    s_mov_b64 exec, -1
    v_cmpx_ge_u16 vcc, 0x3fff, v62
    ds_read_b64 v[28:29], v28
    s_mov_b64 exec, -1
    v_bfe_u32 v86, v106, 14, 4
    v_lshrrev_b32 v87, 18, v106
    v_and_b32 v106, 16383, v106
    v_mad_u32_u24 v86, v86, s63, v87
    v_mad_u32_u24 v106, v86, s65, v106
    buffer_load_dwordx4 v[86:89], v106, s[68:71], 0 offen
    s_cmp_ge_u32 s10, 9
    s_cbranch_scc1 p2_nmq
    v_lshrrev_b32 v84, 1, v112
    s_add_u32 s44, s20, s42
    buffer_load_dwordx2 v[84:85], v84, s[4:7], s44 offen
p2_nmq:
    buffer_load_dwordx4 v[72:75], v112, s[4:7], s20 offen offset:0
    buffer_load_dwordx4 v[76:79], v112, s[4:7], s20 offen offset:1024
    buffer_load_dwordx4 v[80:83], v112, s[4:7], s20 offen offset:2048
    s_waitcnt vmcnt(6)
    v_perm_b32 v63, v93, v90, s31
    v_perm_b32 v64, v93, v91, s32
    v_perm_b32 v65, v93, v92, s33
    v_lshlrev_b16 v34, 3, v92
    v_lshlrev_b16 v32, 3, v91
    v_lshlrev_b16 v30, 3, v90
    v_cmpx_ge_u16 vcc, 0x3fff, v63
    ds_read_b64 v[30:31], v30
    s_mov_b64 exec, -1
    v_cmpx_ge_u16 vcc, 0x3fff, v64
    ds_read_b64 v[32:33], v32
    s_mov_b64 exec, -1
    v_cmpx_ge_u16 vcc, 0x3fff, v65
    ds_read_b64 v[34:35], v34
    s_mov_b64 exec, -1
    v_bfe_u32 v90, v107, 14, 4
    v_lshrrev_b32 v91, 18, v107
    v_and_b32 v107, 16383, v107
    v_mad_u32_u24 v90, v90, s63, v91
    v_mad_u32_u24 v107, v90, s65, v107
    buffer_load_dwordx4 v[90:93], v107, s[68:71], 0 offen
    s_waitcnt vmcnt(6)
    v_perm_b32 v66, v97, v94, s31
    v_perm_b32 v67, v97, v95, s32
    v_perm_b32 v68, v97, v96, s33
    v_lshlrev_b16 v40, 3, v96
    v_lshlrev_b16 v38, 3, v95
    v_lshlrev_b16 v36, 3, v94
    v_cmpx_ge_u16 vcc, 0x3fff, v66
    ds_read_b64 v[36:37], v36
    s_mov_b64 exec, -1
    v_cmpx_ge_u16 vcc, 0x3fff, v67
    ds_read_b64 v[38:39], v38
    s_mov_b64 exec, -1
    v_cmpx_ge_u16 vcc, 0x3fff, v68
    ds_read_b64 v[40:41], v40
    s_mov_b64 exec, -1
    v_bfe_u32 v94, v108, 14, 4
    v_lshrrev_b32 v95, 18, v108
    v_and_b32 v108, 16383, v108
    v_mad_u32_u24 v94, v94, s63, v95
    v_mad_u32_u24 v108, v94, s65, v108
    buffer_load_dwordx4 v[94:97], v108, s[68:71], 0 offen
    s_waitcnt vmcnt(6)
    v_perm_b32 v69, v101, v98, s31
    v_perm_b32 v70, v101, v99, s32
    v_perm_b32 v71, v101, v100, s33
    v_lshlrev_b16 v46, 3, v100
    v_lshlrev_b16 v44, 3, v99
    v_lshlrev_b16 v42, 3, v98
    v_cmpx_ge_u16 vcc, 0x3fff, v69
    ds_read_b64 v[42:43], v42
    s_mov_b64 exec, -1
    v_cmpx_ge_u16 vcc, 0x3fff, v70
    ds_read_b64 v[44:45], v44
    s_mov_b64 exec, -1
    v_cmpx_ge_u16 vcc, 0x3fff, v71
    ds_read_b64 v[46:47], v46
    s_mov_b64 exec, -1
    s_waitcnt lgkmcnt(0)
    s_barrier
    s_branch p2_tail
p2_top:
    s_cmp_lg_u32 s21, 0
    s_cbranch_scc1 p2_topf
    s_cmp_eq_u32 s60, 10
    s_cbranch_scc1 p2_drain0
    s_setprio 3
    v_cmpx_gt_i16 vcc, 0, v48
    ds_read_b64 v[0:1], v0
    s_mov_b64 exec, -1
    v_cmpx_gt_i16 vcc, 0, v49
    ds_read_b64 v[2:3], v2
    s_mov_b64 exec, -1
    v_cmpx_gt_i16 vcc, 0, v50
    ds_read_b64 v[4:5], v4
    s_mov_b64 exec, -1
    v_cmpx_gt_i16 vcc, 0, v51
    ds_read_b64 v[6:7], v6
    s_mov_b64 exec, -1
    v_cmpx_gt_i16 vcc, 0, v52
    ds_read_b64 v[8:9], v8
    s_mov_b64 exec, -1
    v_cmpx_gt_i16 vcc, 0, v53
    ds_read_b64 v[10:11], v10
    s_mov_b64 exec, -1
    v_cmpx_gt_i16 vcc, 0, v54
    ds_read_b64 v[12:13], v12
    s_mov_b64 exec, -1
    v_cmpx_gt_i16 vcc, 0, v55
    ds_read_b64 v[14:15], v14
    s_mov_b64 exec, -1
    v_cmpx_gt_i16 vcc, 0, v56
    ds_read_b64 v[16:17], v16
    s_mov_b64 exec, -1
    s_cmp_lt_u32 s15, 8
    s_cbranch_scc1 p2_g0r23
    v_cmpx_gt_i16 vcc, 0, v57
    ds_read_b64 v[18:19], v18
    s_mov_b64 exec, -1
    v_cmpx_gt_i16 vcc, 0, v58
    ds_read_b64 v[20:21], v20
    s_mov_b64 exec, -1
    v_cmpx_gt_i16 vcc, 0, v59
    ds_read_b64 v[22:23], v22
    s_mov_b64 exec, -1
p2_g0r23:
    s_cmp_ge_u32 s10, 9
    s_cbranch_scc1 p2_nm0m0a
    v_lshrrev_b32 v84, 1, v112
    s_add_u32 s44, s20, s42
    buffer_load_dwordx2 v[84:85], v84, s[4:7], s44 offen
p2_nm0m0a:
    buffer_load_dwordx4 v[72:75], v112, s[4:7], s20 offen offset:0
    buffer_load_dwordx4 v[76:79], v112, s[4:7], s20 offen offset:1024
    buffer_load_dwordx4 v[80:83], v112, s[4:7], s20 offen offset:2048
    v_cmpx_gt_i16 vcc, 0, v60
    ds_read_b64 v[24:25], v24
    s_mov_b64 exec, -1
    v_cmpx_gt_i16 vcc, 0, v61
    ds_read_b64 v[26:27], v26
    s_mov_b64 exec, -1
    v_cmpx_gt_i16 vcc, 0, v62
    ds_read_b64 v[28:29], v28
    s_mov_b64 exec, -1
    v_cmpx_gt_i16 vcc, 0, v63
    ds_read_b64 v[30:31], v30
    s_mov_b64 exec, -1
    v_cmpx_gt_i16 vcc, 0, v64
    ds_read_b64 v[32:33], v32
    s_mov_b64 exec, -1
    v_cmpx_gt_i16 vcc, 0, v65
    ds_read_b64 v[34:35], v34
    s_mov_b64 exec, -1
    v_cmpx_gt_i16 vcc, 0, v66
    ds_read_b64 v[36:37], v36
    s_mov_b64 exec, -1
    v_cmpx_gt_i16 vcc, 0, v67
    ds_read_b64 v[38:39], v38
    s_mov_b64 exec, -1
    v_cmpx_gt_i16 vcc, 0, v68
    ds_read_b64 v[40:41], v40
    s_mov_b64 exec, -1
    v_cmpx_gt_i16 vcc, 0, v69
    ds_read_b64 v[42:43], v42
    s_mov_b64 exec, -1
    v_cmpx_gt_i16 vcc, 0, v70
    ds_read_b64 v[44:45], v44
    s_mov_b64 exec, -1
    v_cmpx_gt_i16 vcc, 0, v71
    ds_read_b64 v[46:47], v46
    s_mov_b64 exec, -1
    s_setprio 2
    s_waitcnt lgkmcnt(15)
    v_ashrrev_i32 v122, 5, v48
    v_lshlrev_b16 v123, 2, v48
    v_lshlrev_b32 v124, 16, v0
    v_bitop3_b32 v122, v122, v113, v113 bitop3:0x0c
    v_and_b32 v125, 0xffff0000, v0
    v_lshlrev_b32 v126, 16, v1
    v_mul_f32 v122, v114, v122
    v_and_b32 v127, 0xffff0000, v1
    v_add_u32 v123, v123, v123
    v_pk_fma_f32 v[124:125], v[124:125], v[122:123], s[34:35] op_sel_hi:[1,0,1]
    v_pk_fma_f32 v[126:127], v[126:127], v[122:123], s[34:35] op_sel_hi:[1,0,1]
    v_lshl_add_u32 v124, v125, 16, v124
    v_lshl_add_u32 v125, v127, 16, v126
    s_waitcnt lgkmcnt(15)
    v_bitop3_b32 v115, v115, v116, v117 bitop3:0xfe
    v_lshl_add_u64 v[124:125], v[124:125], 0, s[36:37]
    v_cmpx_le_u32 vcc, 0x1000000, v48
    ds_add_rtn_u64 v[116:117], v123, v[124:125] offset:54272
    s_mov_b64 exec, -1
    v_ashrrev_i32 v122, 5, v49
    v_lshlrev_b16 v123, 2, v49
    v_lshlrev_b32 v124, 16, v2
    v_bitop3_b32 v122, v122, v113, v113 bitop3:0x0c
    v_and_b32 v125, 0xffff0000, v2
    v_lshlrev_b32 v126, 16, v3
    v_mul_f32 v122, v114, v122
    v_and_b32 v127, 0xffff0000, v3
    v_add_u32 v123, v123, v123
    v_pk_fma_f32 v[124:125], v[124:125], v[122:123], s[34:35] op_sel_hi:[1,0,1]
    v_pk_fma_f32 v[126:127], v[126:127], v[122:123], s[34:35] op_sel_hi:[1,0,1]
    v_lshl_add_u32 v124, v125, 16, v124
    v_lshl_add_u32 v125, v127, 16, v126
    s_waitcnt lgkmcnt(15)
    v_bitop3_b32 v115, v115, v118, v119 bitop3:0xfe
    v_lshl_add_u64 v[124:125], v[124:125], 0, s[36:37]
    v_cmpx_le_u32 vcc, 0x1000000, v49
    ds_add_rtn_u64 v[118:119], v123, v[124:125] offset:54272
    s_mov_b64 exec, -1
    v_ashrrev_i32 v122, 5, v50
    v_lshlrev_b16 v123, 2, v50
    v_lshlrev_b32 v124, 16, v4
    v_bitop3_b32 v122, v122, v113, v113 bitop3:0x0c
    v_and_b32 v125, 0xffff0000, v4
    v_lshlrev_b32 v126, 16, v5
    v_mul_f32 v122, v114, v122
    v_and_b32 v127, 0xffff0000, v5
    v_add_u32 v123, v123, v123
    v_pk_fma_f32 v[124:125], v[124:125], v[122:123], s[34:35] op_sel_hi:[1,0,1]
    v_pk_fma_f32 v[126:127], v[126:127], v[122:123], s[34:35] op_sel_hi:[1,0,1]
    v_lshl_add_u32 v124, v125, 16, v124
    v_lshl_add_u32 v125, v127, 16, v126
    s_waitcnt lgkmcnt(15)
    v_bitop3_b32 v115, v115, v120, v121 bitop3:0xfe
    v_lshl_add_u64 v[124:125], v[124:125], 0, s[36:37]
    v_cmpx_le_u32 vcc, 0x1000000, v50
    ds_add_rtn_u64 v[120:121], v123, v[124:125] offset:54272
    s_mov_b64 exec, -1
    v_bfe_u32 v0, v102, 14, 4
    v_lshrrev_b32 v1, 18, v102
    v_and_b32 v102, 16383, v102
    v_mad_u32_u24 v0, v0, s63, v1
    v_mad_u32_u24 v102, v0, s65, v102
    buffer_load_dwordx4 v[0:3], v102, s[68:71], 0 offen
    s_setprio 1
    s_waitcnt lgkmcnt(15)
    v_ashrrev_i32 v122, 5, v51
    v_lshlrev_b16 v123, 2, v51
    v_lshlrev_b32 v124, 16, v6
    v_bitop3_b32 v122, v122, v113, v113 bitop3:0x0c
    v_and_b32 v125, 0xffff0000, v6
    v_lshlrev_b32 v126, 16, v7
    v_mul_f32 v122, v114, v122
    v_and_b32 v127, 0xffff0000, v7
    v_add_u32 v123, v123, v123
    v_pk_fma_f32 v[124:125], v[124:125], v[122:123], s[34:35] op_sel_hi:[1,0,1]
    v_pk_fma_f32 v[126:127], v[126:127], v[122:123], s[34:35] op_sel_hi:[1,0,1]
    v_lshl_add_u32 v124, v125, 16, v124
    v_lshl_add_u32 v125, v127, 16, v126
    s_waitcnt lgkmcnt(2)
    v_bitop3_b32 v115, v115, v116, v117 bitop3:0xfe
    v_lshl_add_u64 v[124:125], v[124:125], 0, s[36:37]
    v_cmpx_le_u32 vcc, 0x1000000, v51
    ds_add_rtn_u64 v[116:117], v123, v[124:125] offset:54272
    s_mov_b64 exec, -1
    v_ashrrev_i32 v122, 5, v52
    v_lshlrev_b16 v123, 2, v52
    v_lshlrev_b32 v124, 16, v8
    v_bitop3_b32 v122, v122, v113, v113 bitop3:0x0c
    v_and_b32 v125, 0xffff0000, v8
    v_lshlrev_b32 v126, 16, v9
    v_mul_f32 v122, v114, v122
    v_and_b32 v127, 0xffff0000, v9
    v_add_u32 v123, v123, v123
    v_pk_fma_f32 v[124:125], v[124:125], v[122:123], s[34:35] op_sel_hi:[1,0,1]
    v_pk_fma_f32 v[126:127], v[126:127], v[122:123], s[34:35] op_sel_hi:[1,0,1]
    v_lshl_add_u32 v124, v125, 16, v124
    v_lshl_add_u32 v125, v127, 16, v126
    s_waitcnt lgkmcnt(2)
    v_bitop3_b32 v115, v115, v118, v119 bitop3:0xfe
    v_lshl_add_u64 v[124:125], v[124:125], 0, s[36:37]
    v_cmpx_le_u32 vcc, 0x1000000, v52
    ds_add_rtn_u64 v[118:119], v123, v[124:125] offset:54272
    s_mov_b64 exec, -1
    v_ashrrev_i32 v122, 5, v53
    v_lshlrev_b16 v123, 2, v53
    v_lshlrev_b32 v124, 16, v10
    v_bitop3_b32 v122, v122, v113, v113 bitop3:0x0c
    v_and_b32 v125, 0xffff0000, v10
    v_lshlrev_b32 v126, 16, v11
    v_mul_f32 v122, v114, v122
    v_and_b32 v127, 0xffff0000, v11
    v_add_u32 v123, v123, v123
    v_pk_fma_f32 v[124:125], v[124:125], v[122:123], s[34:35] op_sel_hi:[1,0,1]
    v_pk_fma_f32 v[126:127], v[126:127], v[122:123], s[34:35] op_sel_hi:[1,0,1]
    v_lshl_add_u32 v124, v125, 16, v124
    v_lshl_add_u32 v125, v127, 16, v126
    s_waitcnt lgkmcnt(2)
    v_bitop3_b32 v115, v115, v120, v121 bitop3:0xfe
    v_lshl_add_u64 v[124:125], v[124:125], 0, s[36:37]
    v_cmpx_le_u32 vcc, 0x1000000, v53
    ds_add_rtn_u64 v[120:121], v123, v[124:125] offset:54272
    s_mov_b64 exec, -1
    v_bfe_u32 v6, v103, 14, 4
    v_lshrrev_b32 v7, 18, v103
    v_and_b32 v103, 16383, v103
    v_mad_u32_u24 v6, v6, s63, v7
    v_mad_u32_u24 v103, v6, s65, v103
    buffer_load_dwordx4 v[6:9], v103, s[68:71], 0 offen
    s_waitcnt lgkmcnt(6)
    s_barrier
    s_setprio 3
    s_waitcnt vmcnt(5)
    s_mov_b32 m0, s23
    v_mov_b32 v53, 0
    s_movk_i32 s44, 512
    v_sub_u32_sdwa v4, v111, v110 dst_sel:DWORD dst_unused:UNUSED_PAD src0_sel:WORD_0 src1_sel:WORD_0
    v_sub_u32_sdwa v5, v111, v110 dst_sel:DWORD dst_unused:UNUSED_PAD src0_sel:WORD_1 src1_sel:WORD_1
    v_med3_i32 v4, v4, 0, s44
    v_med3_i32 v5, v5, 0, s44
    v_add_u32 v48, v4, v5
    ds_write_addtid_b32 v53 offset:0
    ds_write_addtid_b32 v53 offset:256
    ds_write_addtid_b32 v53 offset:512
    ds_write_addtid_b32 v53 offset:768
    ds_write_addtid_b32 v53 offset:1024
    ds_write_addtid_b32 v53 offset:1280
    ds_write_addtid_b32 v53 offset:1536
    ds_write_addtid_b32 v53 offset:1792
    v_bfe_i32 v53, v112, 6, 1
    v_lshrrev_b32 v49, 6, v112
    v_bitop3_b32 v53, v53, 15, s10 bitop3:0x6a
    v_lshl_or_b32 v49, v49, 4, v53
    v_and_b32 v53, 0x30, v112
    v_lshl_or_b32 v53, v49, 6, v53
    v_lshlrev_b32 v53, 15, v53
    s_nop 1
    v_add_u32_dpp v48, v48, v48 row_shr:1 row_mask:0xf bank_mask:0xf bound_ctrl:0
    s_nop 1
    v_add_u32_dpp v48, v48, v48 row_shr:2 row_mask:0xf bank_mask:0xf bound_ctrl:0
    s_nop 1
    v_add_u32_dpp v48, v48, v48 row_shr:4 row_mask:0xf bank_mask:0xf bound_ctrl:0
    s_nop 1
    v_add_u32_dpp v48, v48, v48 row_shr:8 row_mask:0xf bank_mask:0xf bound_ctrl:0
    s_nop 1
    v_add_u32_dpp v48, v48, v48 row_bcast:15 row_mask:0xa bank_mask:0xf
    s_nop 1
    v_add_u32_dpp v48, v48, v48 row_bcast:31 row_mask:0xc bank_mask:0xf
    s_nop 1
    s_nop 0
    v_readlane_b32 s38, v48, 63
    v_sub_u32 v50, v48, v5
    v_sub_u32 v49, v50, v4
    v_writelane_b32 v5, 1, 63
    v_sub_u32 v10, 512, v49
    v_mad_u32_u16 v51, v110, 16, v53
    v_lshl_add_u32 v51, v10, 4, v51
    v_med3_i32 v10, v10, 0, v4
    v_lshl_add_u32 v49, v49, 2, s23
    v_sub_u32 v11, 512, v50
    v_mad_u32_u16 v52, v110, 16, v53 op_sel:[1,0,0,0]
    v_add_u32 v52, 262144, v52
    s_mov_b32 s44, 0x1fffc000
    v_writelane_b32 v52, s44, 63
    v_lshl_add_u32 v52, v11, 4, v52
    v_med3_i32 v11, v11, 0, v5
    v_lshl_add_u32 v50, v50, 2, s23
    v_lshl_add_u32 v48, v11, 16, v10
    v_add_u32 v110, v110, v48
    s_min_u32 s17, s38, 512
    s_add_u32 s17, s17, 63
    s_lshr_b32 s17, s17, 6
    v_cmpx_lt_i32 vcc, 0, v10
    ds_write_b32 v49, v51
    s_mov_b64 exec, -1
    v_cmpx_lt_i32 vcc, 0, v11
    ds_write_b32 v50, v52
    s_mov_b64 exec, -1
    s_cmp_lt_u32 s38, 512
    s_cbranch_scc1 p2_nomore0x
    v_cmp_lt_u32_sdwa s[44:45], v110, v111 src0_sel:WORD_0 src1_sel:WORD_0
    v_cmp_lt_u32_sdwa s[46:47], v110, v111 src0_sel:WORD_1 src1_sel:WORD_1
    s_nop 0
    s_or_b64 s[44:45], s[44:45], s[46:47]
    s_cbranch_scc0 p2_nomore0x
    v_mov_b32 v49, s19
    v_mov_b32 v50, 1
    ds_write_b32 v49, v50 offset:53760
p2_nomore0x:
    s_setprio 2
    s_waitcnt lgkmcnt(15)
    v_ashrrev_i32 v122, 5, v54
    v_lshlrev_b16 v123, 2, v54
    v_lshlrev_b32 v124, 16, v12
    v_bitop3_b32 v122, v122, v113, v113 bitop3:0x0c
    v_and_b32 v125, 0xffff0000, v12
    v_lshlrev_b32 v126, 16, v13
    v_mul_f32 v122, v114, v122
    v_and_b32 v127, 0xffff0000, v13
    v_add_u32 v123, v123, v123
    v_pk_fma_f32 v[124:125], v[124:125], v[122:123], s[34:35] op_sel_hi:[1,0,1]
    v_pk_fma_f32 v[126:127], v[126:127], v[122:123], s[34:35] op_sel_hi:[1,0,1]
    v_lshl_add_u32 v124, v125, 16, v124
    v_lshl_add_u32 v125, v127, 16, v126
    s_waitcnt lgkmcnt(12)
    v_bitop3_b32 v115, v115, v116, v117 bitop3:0xfe
    v_lshl_add_u64 v[124:125], v[124:125], 0, s[36:37]
    v_cmpx_le_u32 vcc, 0x1000000, v54
    ds_add_rtn_u64 v[116:117], v123, v[124:125] offset:54272
    s_mov_b64 exec, -1
    v_ashrrev_i32 v122, 5, v55
    v_lshlrev_b16 v123, 2, v55
    v_lshlrev_b32 v124, 16, v14
    v_bitop3_b32 v122, v122, v113, v113 bitop3:0x0c
    v_and_b32 v125, 0xffff0000, v14
    v_lshlrev_b32 v126, 16, v15
    v_mul_f32 v122, v114, v122
    v_and_b32 v127, 0xffff0000, v15
    v_add_u32 v123, v123, v123
    v_pk_fma_f32 v[124:125], v[124:125], v[122:123], s[34:35] op_sel_hi:[1,0,1]
    v_pk_fma_f32 v[126:127], v[126:127], v[122:123], s[34:35] op_sel_hi:[1,0,1]
    v_lshl_add_u32 v124, v125, 16, v124
    v_lshl_add_u32 v125, v127, 16, v126
    s_waitcnt lgkmcnt(12)
    v_bitop3_b32 v115, v115, v118, v119 bitop3:0xfe
    v_lshl_add_u64 v[124:125], v[124:125], 0, s[36:37]
    v_cmpx_le_u32 vcc, 0x1000000, v55
    ds_add_rtn_u64 v[118:119], v123, v[124:125] offset:54272
    s_mov_b64 exec, -1
    v_ashrrev_i32 v122, 5, v56
    v_lshlrev_b16 v123, 2, v56
    v_lshlrev_b32 v124, 16, v16
    v_bitop3_b32 v122, v122, v113, v113 bitop3:0x0c
    v_and_b32 v125, 0xffff0000, v16
    v_lshlrev_b32 v126, 16, v17
    v_mul_f32 v122, v114, v122
    v_and_b32 v127, 0xffff0000, v17
    v_add_u32 v123, v123, v123
    v_pk_fma_f32 v[124:125], v[124:125], v[122:123], s[34:35] op_sel_hi:[1,0,1]
    v_pk_fma_f32 v[126:127], v[126:127], v[122:123], s[34:35] op_sel_hi:[1,0,1]
    v_lshl_add_u32 v124, v125, 16, v124
    v_lshl_add_u32 v125, v127, 16, v126
    s_waitcnt lgkmcnt(12)
    v_bitop3_b32 v115, v115, v120, v121 bitop3:0xfe
    v_lshl_add_u64 v[124:125], v[124:125], 0, s[36:37]
    v_cmpx_le_u32 vcc, 0x1000000, v56
    ds_add_rtn_u64 v[120:121], v123, v[124:125] offset:54272
    s_mov_b64 exec, -1
    v_bfe_u32 v12, v104, 14, 4
    v_lshrrev_b32 v13, 18, v104
    v_and_b32 v104, 16383, v104
    v_mad_u32_u24 v12, v12, s63, v13
    v_mad_u32_u24 v104, v12, s65, v104
    buffer_load_dwordx4 v[12:15], v104, s[68:71], 0 offen
    s_cmp_lt_u32 s15, 8
    s_cbranch_scc1 p2_na0a3
    s_waitcnt lgkmcnt(15)
    v_ashrrev_i32 v122, 5, v57
    v_lshlrev_b16 v123, 2, v57
    v_lshlrev_b32 v124, 16, v18
    v_bitop3_b32 v122, v122, v113, v113 bitop3:0x0c
    v_and_b32 v125, 0xffff0000, v18
    v_lshlrev_b32 v126, 16, v19
    v_mul_f32 v122, v114, v122
    v_and_b32 v127, 0xffff0000, v19
    v_add_u32 v123, v123, v123
    v_pk_fma_f32 v[124:125], v[124:125], v[122:123], s[34:35] op_sel_hi:[1,0,1]
    v_pk_fma_f32 v[126:127], v[126:127], v[122:123], s[34:35] op_sel_hi:[1,0,1]
    v_lshl_add_u32 v124, v125, 16, v124
    v_lshl_add_u32 v125, v127, 16, v126
    s_waitcnt lgkmcnt(2)
    v_bitop3_b32 v115, v115, v116, v117 bitop3:0xfe
    v_lshl_add_u64 v[124:125], v[124:125], 0, s[36:37]
    v_cmpx_le_u32 vcc, 0x1000000, v57
    ds_add_rtn_u64 v[116:117], v123, v[124:125] offset:54272
    s_mov_b64 exec, -1
    v_ashrrev_i32 v122, 5, v58
    v_lshlrev_b16 v123, 2, v58
    v_lshlrev_b32 v124, 16, v20
    v_bitop3_b32 v122, v122, v113, v113 bitop3:0x0c
    v_and_b32 v125, 0xffff0000, v20
    v_lshlrev_b32 v126, 16, v21
    v_mul_f32 v122, v114, v122
    v_and_b32 v127, 0xffff0000, v21
    v_add_u32 v123, v123, v123
    v_pk_fma_f32 v[124:125], v[124:125], v[122:123], s[34:35] op_sel_hi:[1,0,1]
    v_pk_fma_f32 v[126:127], v[126:127], v[122:123], s[34:35] op_sel_hi:[1,0,1]
    v_lshl_add_u32 v124, v125, 16, v124
    v_lshl_add_u32 v125, v127, 16, v126
    s_waitcnt lgkmcnt(2)
    v_bitop3_b32 v115, v115, v118, v119 bitop3:0xfe
    v_lshl_add_u64 v[124:125], v[124:125], 0, s[36:37]
    v_cmpx_le_u32 vcc, 0x1000000, v58
    ds_add_rtn_u64 v[118:119], v123, v[124:125] offset:54272
    s_mov_b64 exec, -1
    v_ashrrev_i32 v122, 5, v59
    v_lshlrev_b16 v123, 2, v59
    v_lshlrev_b32 v124, 16, v22
    v_bitop3_b32 v122, v122, v113, v113 bitop3:0x0c
    v_and_b32 v125, 0xffff0000, v22
    v_lshlrev_b32 v126, 16, v23
    v_mul_f32 v122, v114, v122
    v_and_b32 v127, 0xffff0000, v23
    v_add_u32 v123, v123, v123
    v_pk_fma_f32 v[124:125], v[124:125], v[122:123], s[34:35] op_sel_hi:[1,0,1]
    v_pk_fma_f32 v[126:127], v[126:127], v[122:123], s[34:35] op_sel_hi:[1,0,1]
    v_lshl_add_u32 v124, v125, 16, v124
    v_lshl_add_u32 v125, v127, 16, v126
    s_waitcnt lgkmcnt(2)
    v_bitop3_b32 v115, v115, v120, v121 bitop3:0xfe
    v_lshl_add_u64 v[124:125], v[124:125], 0, s[36:37]
    v_cmpx_le_u32 vcc, 0x1000000, v59
    ds_add_rtn_u64 v[120:121], v123, v[124:125] offset:54272
    s_mov_b64 exec, -1
p2_na0a3:
    v_bfe_u32 v18, v105, 14, 4
    v_lshrrev_b32 v19, 18, v105
    v_and_b32 v105, 16383, v105
    v_mad_u32_u24 v18, v18, s63, v19
    v_mad_u32_u24 v105, v18, s65, v105
    buffer_load_dwordx4 v[18:21], v105, s[68:71], 0 offen
    s_mov_b32 m0, s23
    s_nop 0
    ds_read_addtid_b32 v102 offset:1024
    ds_read_addtid_b32 v103 offset:1280
    ds_read_addtid_b32 v104 offset:1536
    ds_read_addtid_b32 v105 offset:1792
    ds_read_addtid_b32 v106 offset:0
    ds_read_addtid_b32 v107 offset:256
    ds_read_addtid_b32 v108 offset:512
    ds_read_addtid_b32 v109 offset:768
    s_waitcnt vmcnt(4)
    s_mov_b32 m0, s24
    s_cmp_ge_u32 s10, 9
    s_cbranch_scc1 p2_st0s0
    ds_write_addtid_b32 v84 offset:49152
    ds_write_addtid_b32 v85 offset:49408
p2_st0s0:
    s_mov_b32 m0, s23
    s_add_u32 s20, s20, 53760
    ds_write_addtid_b32 v72 offset:0
    ds_write_addtid_b32 v73 offset:256
    ds_write_addtid_b32 v74 offset:512
    ds_write_addtid_b32 v75 offset:768
    ds_write_addtid_b32 v76 offset:1024
    ds_write_addtid_b32 v77 offset:1280
    ds_write_addtid_b32 v78 offset:1536
    ds_write_addtid_b32 v79 offset:1792
    ds_write_addtid_b32 v80 offset:2048
    ds_write_addtid_b32 v81 offset:2304
    ds_write_addtid_b32 v82 offset:2560
    ds_write_addtid_b32 v83 offset:2816
    s_setprio 1
    s_waitcnt lgkmcnt(15)
    v_ashrrev_i32 v122, 5, v60
    v_lshlrev_b16 v123, 2, v60
    v_lshlrev_b32 v124, 16, v24
    v_bitop3_b32 v122, v122, v113, v113 bitop3:0x0c
    v_and_b32 v125, 0xffff0000, v24
    v_lshlrev_b32 v126, 16, v25
    v_mul_f32 v122, v114, v122
    v_and_b32 v127, 0xffff0000, v25
    v_add_u32 v123, v123, v123
    v_pk_fma_f32 v[124:125], v[124:125], v[122:123], s[34:35] op_sel_hi:[1,0,1]
    v_pk_fma_f32 v[126:127], v[126:127], v[122:123], s[34:35] op_sel_hi:[1,0,1]
    v_lshl_add_u32 v124, v125, 16, v124
    v_lshl_add_u32 v125, v127, 16, v126
    s_waitcnt lgkmcnt(15)
    v_bitop3_b32 v115, v115, v116, v117 bitop3:0xfe
    v_lshl_add_u64 v[124:125], v[124:125], 0, s[36:37]
    v_cmpx_le_u32 vcc, 0x1000000, v60
    ds_add_rtn_u64 v[116:117], v123, v[124:125] offset:54272
    s_mov_b64 exec, -1
    v_ashrrev_i32 v122, 5, v61
    v_lshlrev_b16 v123, 2, v61
    v_lshlrev_b32 v124, 16, v26
    v_bitop3_b32 v122, v122, v113, v113 bitop3:0x0c
    v_and_b32 v125, 0xffff0000, v26
    v_lshlrev_b32 v126, 16, v27
    v_mul_f32 v122, v114, v122
    v_and_b32 v127, 0xffff0000, v27
    v_add_u32 v123, v123, v123
    v_pk_fma_f32 v[124:125], v[124:125], v[122:123], s[34:35] op_sel_hi:[1,0,1]
    v_pk_fma_f32 v[126:127], v[126:127], v[122:123], s[34:35] op_sel_hi:[1,0,1]
    v_lshl_add_u32 v124, v125, 16, v124
    v_lshl_add_u32 v125, v127, 16, v126
    s_waitcnt lgkmcnt(15)
    v_bitop3_b32 v115, v115, v118, v119 bitop3:0xfe
    v_lshl_add_u64 v[124:125], v[124:125], 0, s[36:37]
    v_cmpx_le_u32 vcc, 0x1000000, v61
    ds_add_rtn_u64 v[118:119], v123, v[124:125] offset:54272
    s_mov_b64 exec, -1
    v_ashrrev_i32 v122, 5, v62
    v_lshlrev_b16 v123, 2, v62
    v_lshlrev_b32 v124, 16, v28
    v_bitop3_b32 v122, v122, v113, v113 bitop3:0x0c
    v_and_b32 v125, 0xffff0000, v28
    v_lshlrev_b32 v126, 16, v29
    v_mul_f32 v122, v114, v122
    v_and_b32 v127, 0xffff0000, v29
    v_add_u32 v123, v123, v123
    v_pk_fma_f32 v[124:125], v[124:125], v[122:123], s[34:35] op_sel_hi:[1,0,1]
    v_pk_fma_f32 v[126:127], v[126:127], v[122:123], s[34:35] op_sel_hi:[1,0,1]
    v_lshl_add_u32 v124, v125, 16, v124
    v_lshl_add_u32 v125, v127, 16, v126
    s_waitcnt lgkmcnt(15)
    v_bitop3_b32 v115, v115, v120, v121 bitop3:0xfe
    v_lshl_add_u64 v[124:125], v[124:125], 0, s[36:37]
    v_cmpx_le_u32 vcc, 0x1000000, v62
    ds_add_rtn_u64 v[120:121], v123, v[124:125] offset:54272
    s_mov_b64 exec, -1
    s_waitcnt vmcnt(16)
    v_perm_b32 v60, v89, v86, s31
    v_perm_b32 v61, v89, v87, s32
    v_perm_b32 v62, v89, v88, s33
    v_lshlrev_b16 v28, 3, v88
    v_lshlrev_b16 v26, 3, v87
    v_lshlrev_b16 v24, 3, v86
    s_waitcnt lgkmcnt(15)
    s_nop 2
    s_nop 1
    v_max_u32_dpp v106, v106, v106 row_shr:1 row_mask:0xf bank_mask:0xf bound_ctrl:0
    v_max_u32_dpp v107, v107, v107 row_shr:1 row_mask:0xf bank_mask:0xf bound_ctrl:0
    s_nop 0
    v_max_u32_dpp v106, v106, v106 row_shr:2 row_mask:0xf bank_mask:0xf bound_ctrl:0
    v_max_u32_dpp v107, v107, v107 row_shr:2 row_mask:0xf bank_mask:0xf bound_ctrl:0
    s_nop 0
    v_max_u32_dpp v106, v106, v106 row_shr:4 row_mask:0xf bank_mask:0xf bound_ctrl:0
    v_max_u32_dpp v107, v107, v107 row_shr:4 row_mask:0xf bank_mask:0xf bound_ctrl:0
    s_nop 0
    v_max_u32_dpp v106, v106, v106 row_shr:8 row_mask:0xf bank_mask:0xf bound_ctrl:0
    v_max_u32_dpp v107, v107, v107 row_shr:8 row_mask:0xf bank_mask:0xf bound_ctrl:0
    s_nop 0
    v_max_u32_dpp v106, v106, v106 row_bcast:15 row_mask:0xa bank_mask:0xf
    v_max_u32_dpp v107, v107, v107 row_bcast:15 row_mask:0xa bank_mask:0xf
    s_nop 0
    v_max_u32_dpp v106, v106, v106 row_bcast:31 row_mask:0xc bank_mask:0xf
    v_max_u32_dpp v107, v107, v107 row_bcast:31 row_mask:0xc bank_mask:0xf
    s_nop 0
    s_nop 0
    v_readlane_b32 s41, v106, 63
    v_add_u32 v106, v106, v112
    v_add_u32 v106, 4294959104, v106
    v_max_u32 v107, s41, v107
    s_nop 0
    v_readlane_b32 s41, v107, 63
    v_add_u32 v107, v107, v112
    v_add_u32 v107, 4294960128, v107
    v_bfe_u32 v86, v106, 14, 4
    v_lshrrev_b32 v87, 18, v106
    v_and_b32 v106, 16383, v106
    v_mad_u32_u24 v86, v86, s63, v87
    v_mad_u32_u24 v106, v86, s65, v106
    buffer_load_dwordx4 v[86:89], v106, s[68:71], 0 offen
    s_setprio 0
    s_waitcnt lgkmcnt(15)
    v_ashrrev_i32 v122, 5, v63
    v_lshlrev_b16 v123, 2, v63
    v_lshlrev_b32 v124, 16, v30
    v_bitop3_b32 v122, v122, v113, v113 bitop3:0x0c
    v_and_b32 v125, 0xffff0000, v30
    v_lshlrev_b32 v126, 16, v31
    v_mul_f32 v122, v114, v122
    v_and_b32 v127, 0xffff0000, v31
    v_add_u32 v123, v123, v123
    v_pk_fma_f32 v[124:125], v[124:125], v[122:123], s[34:35] op_sel_hi:[1,0,1]
    v_pk_fma_f32 v[126:127], v[126:127], v[122:123], s[34:35] op_sel_hi:[1,0,1]
    v_lshl_add_u32 v124, v125, 16, v124
    v_lshl_add_u32 v125, v127, 16, v126
    s_waitcnt lgkmcnt(2)
    v_bitop3_b32 v115, v115, v116, v117 bitop3:0xfe
    v_lshl_add_u64 v[124:125], v[124:125], 0, s[36:37]
    v_cmpx_le_u32 vcc, 0x1000000, v63
    ds_add_rtn_u64 v[116:117], v123, v[124:125] offset:54272
    s_mov_b64 exec, -1
    v_ashrrev_i32 v122, 5, v64
    v_lshlrev_b16 v123, 2, v64
    v_lshlrev_b32 v124, 16, v32
    v_bitop3_b32 v122, v122, v113, v113 bitop3:0x0c
    v_and_b32 v125, 0xffff0000, v32
    v_lshlrev_b32 v126, 16, v33
    v_mul_f32 v122, v114, v122
    v_and_b32 v127, 0xffff0000, v33
    v_add_u32 v123, v123, v123
    v_pk_fma_f32 v[124:125], v[124:125], v[122:123], s[34:35] op_sel_hi:[1,0,1]
    v_pk_fma_f32 v[126:127], v[126:127], v[122:123], s[34:35] op_sel_hi:[1,0,1]
    v_lshl_add_u32 v124, v125, 16, v124
    v_lshl_add_u32 v125, v127, 16, v126
    s_waitcnt lgkmcnt(2)
    v_bitop3_b32 v115, v115, v118, v119 bitop3:0xfe
    v_lshl_add_u64 v[124:125], v[124:125], 0, s[36:37]
    v_cmpx_le_u32 vcc, 0x1000000, v64
    ds_add_rtn_u64 v[118:119], v123, v[124:125] offset:54272
    s_mov_b64 exec, -1
    v_ashrrev_i32 v122, 5, v65
    v_lshlrev_b16 v123, 2, v65
    v_lshlrev_b32 v124, 16, v34
    v_bitop3_b32 v122, v122, v113, v113 bitop3:0x0c
    v_and_b32 v125, 0xffff0000, v34
    v_lshlrev_b32 v126, 16, v35
    v_mul_f32 v122, v114, v122
    v_and_b32 v127, 0xffff0000, v35
    v_add_u32 v123, v123, v123
    v_pk_fma_f32 v[124:125], v[124:125], v[122:123], s[34:35] op_sel_hi:[1,0,1]
    v_pk_fma_f32 v[126:127], v[126:127], v[122:123], s[34:35] op_sel_hi:[1,0,1]
    v_lshl_add_u32 v124, v125, 16, v124
    v_lshl_add_u32 v125, v127, 16, v126
    s_waitcnt lgkmcnt(2)
    v_bitop3_b32 v115, v115, v120, v121 bitop3:0xfe
    v_lshl_add_u64 v[124:125], v[124:125], 0, s[36:37]
    v_cmpx_le_u32 vcc, 0x1000000, v65
    ds_add_rtn_u64 v[120:121], v123, v[124:125] offset:54272
    s_mov_b64 exec, -1
    s_waitcnt vmcnt(13)
    v_perm_b32 v63, v93, v90, s31
    v_perm_b32 v64, v93, v91, s32
    v_perm_b32 v65, v93, v92, s33
    v_lshlrev_b16 v34, 3, v92
    v_lshlrev_b16 v32, 3, v91
    v_lshlrev_b16 v30, 3, v90
    s_waitcnt lgkmcnt(6)
    s_barrier
    s_setprio 3
    s_cmp_ge_u32 s10, 9
    s_cbranch_scc1 p2_nm0m1a
    v_lshrrev_b32 v84, 1, v112
    s_add_u32 s44, s20, s42
    buffer_load_dwordx2 v[84:85], v84, s[4:7], s44 offen
p2_nm0m1a:
    buffer_load_dwordx4 v[72:75], v112, s[4:7], s20 offen offset:0
    buffer_load_dwordx4 v[76:79], v112, s[4:7], s20 offen offset:1024
    buffer_load_dwordx4 v[80:83], v112, s[4:7], s20 offen offset:2048
    v_cmpx_ge_u16 vcc, 0x3fff, v60
    ds_read_b64 v[24:25], v24
    s_mov_b64 exec, -1
    v_cmpx_ge_u16 vcc, 0x3fff, v61
    ds_read_b64 v[26:27], v26
    s_mov_b64 exec, -1
    v_cmpx_ge_u16 vcc, 0x3fff, v62
    ds_read_b64 v[28:29], v28
    s_mov_b64 exec, -1
    v_cmpx_ge_u16 vcc, 0x3fff, v63
    ds_read_b64 v[30:31], v30
    s_mov_b64 exec, -1
    v_cmpx_ge_u16 vcc, 0x3fff, v64
    ds_read_b64 v[32:33], v32
    s_mov_b64 exec, -1
    v_cmpx_ge_u16 vcc, 0x3fff, v65
    ds_read_b64 v[34:35], v34
    s_mov_b64 exec, -1
    s_setprio 2
    s_waitcnt lgkmcnt(15)
    v_ashrrev_i32 v122, 5, v66
    v_lshlrev_b16 v123, 2, v66
    v_lshlrev_b32 v124, 16, v36
    v_bitop3_b32 v122, v122, v113, v113 bitop3:0x0c
    v_and_b32 v125, 0xffff0000, v36
    v_lshlrev_b32 v126, 16, v37
    v_mul_f32 v122, v114, v122
    v_and_b32 v127, 0xffff0000, v37
    v_add_u32 v123, v123, v123
    v_pk_fma_f32 v[124:125], v[124:125], v[122:123], s[34:35] op_sel_hi:[1,0,1]
    v_pk_fma_f32 v[126:127], v[126:127], v[122:123], s[34:35] op_sel_hi:[1,0,1]
    v_lshl_add_u32 v124, v125, 16, v124
    v_lshl_add_u32 v125, v127, 16, v126
    s_waitcnt lgkmcnt(8)
    v_bitop3_b32 v115, v115, v116, v117 bitop3:0xfe
    v_lshl_add_u64 v[124:125], v[124:125], 0, s[36:37]
    v_cmpx_le_u32 vcc, 0x1000000, v66
    ds_add_rtn_u64 v[116:117], v123, v[124:125] offset:54272
    s_mov_b64 exec, -1
    v_ashrrev_i32 v122, 5, v67
    v_lshlrev_b16 v123, 2, v67
    v_lshlrev_b32 v124, 16, v38
    v_bitop3_b32 v122, v122, v113, v113 bitop3:0x0c
    v_and_b32 v125, 0xffff0000, v38
    v_lshlrev_b32 v126, 16, v39
    v_mul_f32 v122, v114, v122
    v_and_b32 v127, 0xffff0000, v39
    v_add_u32 v123, v123, v123
    v_pk_fma_f32 v[124:125], v[124:125], v[122:123], s[34:35] op_sel_hi:[1,0,1]
    v_pk_fma_f32 v[126:127], v[126:127], v[122:123], s[34:35] op_sel_hi:[1,0,1]
    v_lshl_add_u32 v124, v125, 16, v124
    v_lshl_add_u32 v125, v127, 16, v126
    s_waitcnt lgkmcnt(8)
    v_bitop3_b32 v115, v115, v118, v119 bitop3:0xfe
    v_lshl_add_u64 v[124:125], v[124:125], 0, s[36:37]
    v_cmpx_le_u32 vcc, 0x1000000, v67
    ds_add_rtn_u64 v[118:119], v123, v[124:125] offset:54272
    s_mov_b64 exec, -1
    v_ashrrev_i32 v122, 5, v68
    v_lshlrev_b16 v123, 2, v68
    v_lshlrev_b32 v124, 16, v40
    v_bitop3_b32 v122, v122, v113, v113 bitop3:0x0c
    v_and_b32 v125, 0xffff0000, v40
    v_lshlrev_b32 v126, 16, v41
    v_mul_f32 v122, v114, v122
    v_and_b32 v127, 0xffff0000, v41
    v_add_u32 v123, v123, v123
    v_pk_fma_f32 v[124:125], v[124:125], v[122:123], s[34:35] op_sel_hi:[1,0,1]
    v_pk_fma_f32 v[126:127], v[126:127], v[122:123], s[34:35] op_sel_hi:[1,0,1]
    v_lshl_add_u32 v124, v125, 16, v124
    v_lshl_add_u32 v125, v127, 16, v126
    s_waitcnt lgkmcnt(8)
    v_bitop3_b32 v115, v115, v120, v121 bitop3:0xfe
    v_lshl_add_u64 v[124:125], v[124:125], 0, s[36:37]
    v_cmpx_le_u32 vcc, 0x1000000, v68
    ds_add_rtn_u64 v[120:121], v123, v[124:125] offset:54272
    s_mov_b64 exec, -1
    s_waitcnt vmcnt(15)
    v_perm_b32 v66, v97, v94, s31
    v_perm_b32 v67, v97, v95, s32
    v_perm_b32 v68, v97, v96, s33
    v_lshlrev_b16 v40, 3, v96
    v_lshlrev_b16 v38, 3, v95
    v_lshlrev_b16 v36, 3, v94
    v_cmpx_ge_u16 vcc, 0x3fff, v66
    ds_read_b64 v[36:37], v36
    s_mov_b64 exec, -1
    v_cmpx_ge_u16 vcc, 0x3fff, v67
    ds_read_b64 v[38:39], v38
    s_mov_b64 exec, -1
    v_cmpx_ge_u16 vcc, 0x3fff, v68
    ds_read_b64 v[40:41], v40
    s_mov_b64 exec, -1
    v_bfe_u32 v90, v107, 14, 4
    v_lshrrev_b32 v91, 18, v107
    v_and_b32 v107, 16383, v107
    v_mad_u32_u24 v90, v90, s63, v91
    v_mad_u32_u24 v107, v90, s65, v107
    buffer_load_dwordx4 v[90:93], v107, s[68:71], 0 offen
    s_setprio 1
    s_waitcnt lgkmcnt(15)
    v_ashrrev_i32 v122, 5, v69
    v_lshlrev_b16 v123, 2, v69
    v_lshlrev_b32 v124, 16, v42
    v_bitop3_b32 v122, v122, v113, v113 bitop3:0x0c
    v_and_b32 v125, 0xffff0000, v42
    v_lshlrev_b32 v126, 16, v43
    v_mul_f32 v122, v114, v122
    v_and_b32 v127, 0xffff0000, v43
    v_add_u32 v123, v123, v123
    v_pk_fma_f32 v[124:125], v[124:125], v[122:123], s[34:35] op_sel_hi:[1,0,1]
    v_pk_fma_f32 v[126:127], v[126:127], v[122:123], s[34:35] op_sel_hi:[1,0,1]
    v_lshl_add_u32 v124, v125, 16, v124
    v_lshl_add_u32 v125, v127, 16, v126
    s_waitcnt lgkmcnt(5)
    v_bitop3_b32 v115, v115, v116, v117 bitop3:0xfe
    v_lshl_add_u64 v[124:125], v[124:125], 0, s[36:37]
    v_cmpx_le_u32 vcc, 0x1000000, v69
    ds_add_rtn_u64 v[116:117], v123, v[124:125] offset:54272
    s_mov_b64 exec, -1
    v_ashrrev_i32 v122, 5, v70
    v_lshlrev_b16 v123, 2, v70
    v_lshlrev_b32 v124, 16, v44
    v_bitop3_b32 v122, v122, v113, v113 bitop3:0x0c
    v_and_b32 v125, 0xffff0000, v44
    v_lshlrev_b32 v126, 16, v45
    v_mul_f32 v122, v114, v122
    v_and_b32 v127, 0xffff0000, v45
    v_add_u32 v123, v123, v123
    v_pk_fma_f32 v[124:125], v[124:125], v[122:123], s[34:35] op_sel_hi:[1,0,1]
    v_pk_fma_f32 v[126:127], v[126:127], v[122:123], s[34:35] op_sel_hi:[1,0,1]
    v_lshl_add_u32 v124, v125, 16, v124
    v_lshl_add_u32 v125, v127, 16, v126
    s_waitcnt lgkmcnt(5)
    v_bitop3_b32 v115, v115, v118, v119 bitop3:0xfe
    v_lshl_add_u64 v[124:125], v[124:125], 0, s[36:37]
    v_cmpx_le_u32 vcc, 0x1000000, v70
    ds_add_rtn_u64 v[118:119], v123, v[124:125] offset:54272
    s_mov_b64 exec, -1
    v_ashrrev_i32 v122, 5, v71
    v_lshlrev_b16 v123, 2, v71
    v_lshlrev_b32 v124, 16, v46
    v_bitop3_b32 v122, v122, v113, v113 bitop3:0x0c
    v_and_b32 v125, 0xffff0000, v46
    v_lshlrev_b32 v126, 16, v47
    v_mul_f32 v122, v114, v122
    v_and_b32 v127, 0xffff0000, v47
    v_add_u32 v123, v123, v123
    v_pk_fma_f32 v[124:125], v[124:125], v[122:123], s[34:35] op_sel_hi:[1,0,1]
    v_pk_fma_f32 v[126:127], v[126:127], v[122:123], s[34:35] op_sel_hi:[1,0,1]
    v_lshl_add_u32 v124, v125, 16, v124
    v_lshl_add_u32 v125, v127, 16, v126
    s_waitcnt lgkmcnt(5)
    v_bitop3_b32 v115, v115, v120, v121 bitop3:0xfe
    v_lshl_add_u64 v[124:125], v[124:125], 0, s[36:37]
    v_cmpx_le_u32 vcc, 0x1000000, v71
    ds_add_rtn_u64 v[120:121], v123, v[124:125] offset:54272
    s_mov_b64 exec, -1
    s_waitcnt vmcnt(12)
    v_perm_b32 v69, v101, v98, s31
    v_perm_b32 v70, v101, v99, s32
    v_perm_b32 v71, v101, v100, s33
    v_lshlrev_b16 v46, 3, v100
    v_lshlrev_b16 v44, 3, v99
    v_lshlrev_b16 v42, 3, v98
    v_cmpx_ge_u16 vcc, 0x3fff, v69
    ds_read_b64 v[42:43], v42
    s_mov_b64 exec, -1
    v_cmpx_ge_u16 vcc, 0x3fff, v70
    ds_read_b64 v[44:45], v44
    s_mov_b64 exec, -1
    v_cmpx_ge_u16 vcc, 0x3fff, v71
    ds_read_b64 v[46:47], v46
    s_mov_b64 exec, -1
    s_waitcnt lgkmcnt(15)
    s_nop 2
    s_nop 1
    v_max_u32_dpp v108, v108, v108 row_shr:1 row_mask:0xf bank_mask:0xf bound_ctrl:0
    v_max_u32_dpp v109, v109, v109 row_shr:1 row_mask:0xf bank_mask:0xf bound_ctrl:0
    s_nop 0
    v_max_u32_dpp v108, v108, v108 row_shr:2 row_mask:0xf bank_mask:0xf bound_ctrl:0
    v_max_u32_dpp v109, v109, v109 row_shr:2 row_mask:0xf bank_mask:0xf bound_ctrl:0
    s_nop 0
    v_max_u32_dpp v108, v108, v108 row_shr:4 row_mask:0xf bank_mask:0xf bound_ctrl:0
    v_max_u32_dpp v109, v109, v109 row_shr:4 row_mask:0xf bank_mask:0xf bound_ctrl:0
    s_nop 0
    v_max_u32_dpp v108, v108, v108 row_shr:8 row_mask:0xf bank_mask:0xf bound_ctrl:0
    v_max_u32_dpp v109, v109, v109 row_shr:8 row_mask:0xf bank_mask:0xf bound_ctrl:0
    s_nop 0
    v_max_u32_dpp v108, v108, v108 row_bcast:15 row_mask:0xa bank_mask:0xf
    v_max_u32_dpp v109, v109, v109 row_bcast:15 row_mask:0xa bank_mask:0xf
    s_nop 0
    v_max_u32_dpp v108, v108, v108 row_bcast:31 row_mask:0xc bank_mask:0xf
    v_max_u32_dpp v109, v109, v109 row_bcast:31 row_mask:0xc bank_mask:0xf
    s_nop 0
    s_nop 0
    v_max_u32 v108, s41, v108
    s_nop 0
    v_readlane_b32 s41, v108, 63
    v_add_u32 v108, v108, v112
    v_add_u32 v108, 4294961152, v108
    v_max_u32 v109, s41, v109
    s_nop 0
    v_readlane_b32 s41, v109, 63
    v_add_u32 v109, v109, v112
    v_add_u32 v109, 4294962176, v109
    v_bfe_u32 v94, v108, 14, 4
    v_lshrrev_b32 v95, 18, v108
    v_and_b32 v108, 16383, v108
    v_mad_u32_u24 v94, v94, s63, v95
    v_mad_u32_u24 v108, v94, s65, v108
    buffer_load_dwordx4 v[94:97], v108, s[68:71], 0 offen
    s_setprio 0
    s_waitcnt vmcnt(9)
    v_perm_b32 v48, v3, v0, s31
    v_perm_b32 v49, v3, v1, s32
    v_perm_b32 v50, v3, v2, s33
    v_lshlrev_b16 v4, 3, v2
    v_lshlrev_b16 v2, 3, v1
    v_lshlrev_b16 v0, 3, v0
    v_cmpx_ge_u16 vcc, 0x3fff, v48
    ds_read_b64 v[0:1], v0
    s_mov_b64 exec, -1
    v_cmpx_ge_u16 vcc, 0x3fff, v49
    ds_read_b64 v[2:3], v2
    s_mov_b64 exec, -1
    v_cmpx_ge_u16 vcc, 0x3fff, v50
    ds_read_b64 v[4:5], v4
    s_mov_b64 exec, -1
    s_waitcnt vmcnt(8)
    v_perm_b32 v51, v9, v6, s31
    v_perm_b32 v52, v9, v7, s32
    v_perm_b32 v53, v9, v8, s33
    v_lshlrev_b16 v10, 3, v8
    v_lshlrev_b16 v8, 3, v7
    v_lshlrev_b16 v6, 3, v6
    v_cmpx_ge_u16 vcc, 0x3fff, v51
    ds_read_b64 v[6:7], v6
    s_mov_b64 exec, -1
    v_cmpx_ge_u16 vcc, 0x3fff, v52
    ds_read_b64 v[8:9], v8
    s_mov_b64 exec, -1
    v_cmpx_ge_u16 vcc, 0x3fff, v53
    ds_read_b64 v[10:11], v10
    s_mov_b64 exec, -1
    s_waitcnt vmcnt(7)
    v_perm_b32 v54, v15, v12, s31
    v_perm_b32 v55, v15, v13, s32
    v_perm_b32 v56, v15, v14, s33
    v_lshlrev_b16 v16, 3, v14
    v_lshlrev_b16 v14, 3, v13
    v_lshlrev_b16 v12, 3, v12
    v_cmpx_ge_u16 vcc, 0x3fff, v54
    ds_read_b64 v[12:13], v12
    s_mov_b64 exec, -1
    v_cmpx_ge_u16 vcc, 0x3fff, v55
    ds_read_b64 v[14:15], v14
    s_mov_b64 exec, -1
    v_cmpx_ge_u16 vcc, 0x3fff, v56
    ds_read_b64 v[16:17], v16
    s_mov_b64 exec, -1
    s_waitcnt vmcnt(6)
    v_perm_b32 v57, v21, v18, s31
    v_perm_b32 v58, v21, v19, s32
    v_perm_b32 v59, v21, v20, s33
    v_lshlrev_b16 v22, 3, v20
    v_lshlrev_b16 v20, 3, v19
    v_lshlrev_b16 v18, 3, v18
    s_cmp_lt_u32 s16, 8
    s_cbranch_scc1 p2_g0r03
    v_cmpx_ge_u16 vcc, 0x3fff, v57
    ds_read_b64 v[18:19], v18
    s_mov_b64 exec, -1
    v_cmpx_ge_u16 vcc, 0x3fff, v58
    ds_read_b64 v[20:21], v20
    s_mov_b64 exec, -1
    v_cmpx_ge_u16 vcc, 0x3fff, v59
    ds_read_b64 v[22:23], v22
    s_mov_b64 exec, -1
p2_g0r03:
    s_waitcnt lgkmcnt(0)
    s_barrier
    s_waitcnt lgkmcnt(15)
    s_branch p2_tail
p2_drain0:
    v_cmpx_gt_i16 vcc, 0, v48
    ds_read_b64 v[0:1], v0
    s_mov_b64 exec, -1
    v_cmpx_gt_i16 vcc, 0, v49
    ds_read_b64 v[2:3], v2
    s_mov_b64 exec, -1
    v_cmpx_gt_i16 vcc, 0, v50
    ds_read_b64 v[4:5], v4
    s_mov_b64 exec, -1
    v_cmpx_gt_i16 vcc, 0, v51
    ds_read_b64 v[6:7], v6
    s_mov_b64 exec, -1
    v_cmpx_gt_i16 vcc, 0, v52
    ds_read_b64 v[8:9], v8
    s_mov_b64 exec, -1
    v_cmpx_gt_i16 vcc, 0, v53
    ds_read_b64 v[10:11], v10
    s_mov_b64 exec, -1
    v_cmpx_gt_i16 vcc, 0, v54
    ds_read_b64 v[12:13], v12
    s_mov_b64 exec, -1
    v_cmpx_gt_i16 vcc, 0, v55
    ds_read_b64 v[14:15], v14
    s_mov_b64 exec, -1
    v_cmpx_gt_i16 vcc, 0, v56
    ds_read_b64 v[16:17], v16
    s_mov_b64 exec, -1
    s_cmp_lt_u32 s15, 8
    s_cbranch_scc1 p2_gd0
    v_cmpx_gt_i16 vcc, 0, v57
    ds_read_b64 v[18:19], v18
    s_mov_b64 exec, -1
    v_cmpx_gt_i16 vcc, 0, v58
    ds_read_b64 v[20:21], v20
    s_mov_b64 exec, -1
    v_cmpx_gt_i16 vcc, 0, v59
    ds_read_b64 v[22:23], v22
    s_mov_b64 exec, -1
p2_gd0:
    v_cmpx_gt_i16 vcc, 0, v60
    ds_read_b64 v[24:25], v24
    s_mov_b64 exec, -1
    v_cmpx_gt_i16 vcc, 0, v61
    ds_read_b64 v[26:27], v26
    s_mov_b64 exec, -1
    v_cmpx_gt_i16 vcc, 0, v62
    ds_read_b64 v[28:29], v28
    s_mov_b64 exec, -1
    v_cmpx_gt_i16 vcc, 0, v63
    ds_read_b64 v[30:31], v30
    s_mov_b64 exec, -1
    v_cmpx_gt_i16 vcc, 0, v64
    ds_read_b64 v[32:33], v32
    s_mov_b64 exec, -1
    v_cmpx_gt_i16 vcc, 0, v65
    ds_read_b64 v[34:35], v34
    s_mov_b64 exec, -1
    v_cmpx_gt_i16 vcc, 0, v66
    ds_read_b64 v[36:37], v36
    s_mov_b64 exec, -1
    v_cmpx_gt_i16 vcc, 0, v67
    ds_read_b64 v[38:39], v38
    s_mov_b64 exec, -1
    v_cmpx_gt_i16 vcc, 0, v68
    ds_read_b64 v[40:41], v40
    s_mov_b64 exec, -1
    v_cmpx_gt_i16 vcc, 0, v69
    ds_read_b64 v[42:43], v42
    s_mov_b64 exec, -1
    v_cmpx_gt_i16 vcc, 0, v70
    ds_read_b64 v[44:45], v44
    s_mov_b64 exec, -1
    v_cmpx_gt_i16 vcc, 0, v71
    ds_read_b64 v[46:47], v46
    s_mov_b64 exec, -1
    s_waitcnt lgkmcnt(15)
    v_ashrrev_i32 v122, 5, v48
    v_lshlrev_b16 v123, 2, v48
    v_lshlrev_b32 v124, 16, v0
    v_bitop3_b32 v122, v122, v113, v113 bitop3:0x0c
    v_and_b32 v125, 0xffff0000, v0
    v_lshlrev_b32 v126, 16, v1
    v_mul_f32 v122, v114, v122
    v_and_b32 v127, 0xffff0000, v1
    v_add_u32 v123, v123, v123
    v_pk_fma_f32 v[124:125], v[124:125], v[122:123], s[34:35] op_sel_hi:[1,0,1]
    v_pk_fma_f32 v[126:127], v[126:127], v[122:123], s[34:35] op_sel_hi:[1,0,1]
    v_lshl_add_u32 v124, v125, 16, v124
    v_lshl_add_u32 v125, v127, 16, v126
    s_waitcnt lgkmcnt(15)
    v_bitop3_b32 v115, v115, v116, v117 bitop3:0xfe
    v_lshl_add_u64 v[124:125], v[124:125], 0, s[36:37]
    v_cmpx_le_u32 vcc, 0x1000000, v48
    ds_add_rtn_u64 v[116:117], v123, v[124:125] offset:54272
    s_mov_b64 exec, -1
    v_ashrrev_i32 v122, 5, v49
    v_lshlrev_b16 v123, 2, v49
    v_lshlrev_b32 v124, 16, v2
    v_bitop3_b32 v122, v122, v113, v113 bitop3:0x0c
    v_and_b32 v125, 0xffff0000, v2
    v_lshlrev_b32 v126, 16, v3
    v_mul_f32 v122, v114, v122
    v_and_b32 v127, 0xffff0000, v3
    v_add_u32 v123, v123, v123
    v_pk_fma_f32 v[124:125], v[124:125], v[122:123], s[34:35] op_sel_hi:[1,0,1]
    v_pk_fma_f32 v[126:127], v[126:127], v[122:123], s[34:35] op_sel_hi:[1,0,1]
    v_lshl_add_u32 v124, v125, 16, v124
    v_lshl_add_u32 v125, v127, 16, v126
    s_waitcnt lgkmcnt(15)
    v_bitop3_b32 v115, v115, v118, v119 bitop3:0xfe
    v_lshl_add_u64 v[124:125], v[124:125], 0, s[36:37]
    v_cmpx_le_u32 vcc, 0x1000000, v49
    ds_add_rtn_u64 v[118:119], v123, v[124:125] offset:54272
    s_mov_b64 exec, -1
    v_ashrrev_i32 v122, 5, v50
    v_lshlrev_b16 v123, 2, v50
    v_lshlrev_b32 v124, 16, v4
    v_bitop3_b32 v122, v122, v113, v113 bitop3:0x0c
    v_and_b32 v125, 0xffff0000, v4
    v_lshlrev_b32 v126, 16, v5
    v_mul_f32 v122, v114, v122
    v_and_b32 v127, 0xffff0000, v5
    v_add_u32 v123, v123, v123
    v_pk_fma_f32 v[124:125], v[124:125], v[122:123], s[34:35] op_sel_hi:[1,0,1]
    v_pk_fma_f32 v[126:127], v[126:127], v[122:123], s[34:35] op_sel_hi:[1,0,1]
    v_lshl_add_u32 v124, v125, 16, v124
    v_lshl_add_u32 v125, v127, 16, v126
    s_waitcnt lgkmcnt(15)
    v_bitop3_b32 v115, v115, v120, v121 bitop3:0xfe
    v_lshl_add_u64 v[124:125], v[124:125], 0, s[36:37]
    v_cmpx_le_u32 vcc, 0x1000000, v50
    ds_add_rtn_u64 v[120:121], v123, v[124:125] offset:54272
    s_mov_b64 exec, -1
    s_waitcnt lgkmcnt(15)
    v_ashrrev_i32 v122, 5, v51
    v_lshlrev_b16 v123, 2, v51
    v_lshlrev_b32 v124, 16, v6
    v_bitop3_b32 v122, v122, v113, v113 bitop3:0x0c
    v_and_b32 v125, 0xffff0000, v6
    v_lshlrev_b32 v126, 16, v7
    v_mul_f32 v122, v114, v122
    v_and_b32 v127, 0xffff0000, v7
    v_add_u32 v123, v123, v123
    v_pk_fma_f32 v[124:125], v[124:125], v[122:123], s[34:35] op_sel_hi:[1,0,1]
    v_pk_fma_f32 v[126:127], v[126:127], v[122:123], s[34:35] op_sel_hi:[1,0,1]
    v_lshl_add_u32 v124, v125, 16, v124
    v_lshl_add_u32 v125, v127, 16, v126
    s_waitcnt lgkmcnt(2)
    v_bitop3_b32 v115, v115, v116, v117 bitop3:0xfe
    v_lshl_add_u64 v[124:125], v[124:125], 0, s[36:37]
    v_cmpx_le_u32 vcc, 0x1000000, v51
    ds_add_rtn_u64 v[116:117], v123, v[124:125] offset:54272
    s_mov_b64 exec, -1
    v_ashrrev_i32 v122, 5, v52
    v_lshlrev_b16 v123, 2, v52
    v_lshlrev_b32 v124, 16, v8
    v_bitop3_b32 v122, v122, v113, v113 bitop3:0x0c
    v_and_b32 v125, 0xffff0000, v8
    v_lshlrev_b32 v126, 16, v9
    v_mul_f32 v122, v114, v122
    v_and_b32 v127, 0xffff0000, v9
    v_add_u32 v123, v123, v123
    v_pk_fma_f32 v[124:125], v[124:125], v[122:123], s[34:35] op_sel_hi:[1,0,1]
    v_pk_fma_f32 v[126:127], v[126:127], v[122:123], s[34:35] op_sel_hi:[1,0,1]
    v_lshl_add_u32 v124, v125, 16, v124
    v_lshl_add_u32 v125, v127, 16, v126
    s_waitcnt lgkmcnt(2)
    v_bitop3_b32 v115, v115, v118, v119 bitop3:0xfe
    v_lshl_add_u64 v[124:125], v[124:125], 0, s[36:37]
    v_cmpx_le_u32 vcc, 0x1000000, v52
    ds_add_rtn_u64 v[118:119], v123, v[124:125] offset:54272
    s_mov_b64 exec, -1
    v_ashrrev_i32 v122, 5, v53
    v_lshlrev_b16 v123, 2, v53
    v_lshlrev_b32 v124, 16, v10
    v_bitop3_b32 v122, v122, v113, v113 bitop3:0x0c
    v_and_b32 v125, 0xffff0000, v10
    v_lshlrev_b32 v126, 16, v11
    v_mul_f32 v122, v114, v122
    v_and_b32 v127, 0xffff0000, v11
    v_add_u32 v123, v123, v123
    v_pk_fma_f32 v[124:125], v[124:125], v[122:123], s[34:35] op_sel_hi:[1,0,1]
    v_pk_fma_f32 v[126:127], v[126:127], v[122:123], s[34:35] op_sel_hi:[1,0,1]
    v_lshl_add_u32 v124, v125, 16, v124
    v_lshl_add_u32 v125, v127, 16, v126
    s_waitcnt lgkmcnt(2)
    v_bitop3_b32 v115, v115, v120, v121 bitop3:0xfe
    v_lshl_add_u64 v[124:125], v[124:125], 0, s[36:37]
    v_cmpx_le_u32 vcc, 0x1000000, v53
    ds_add_rtn_u64 v[120:121], v123, v[124:125] offset:54272
    s_mov_b64 exec, -1
    s_waitcnt lgkmcnt(15)
    v_ashrrev_i32 v122, 5, v54
    v_lshlrev_b16 v123, 2, v54
    v_lshlrev_b32 v124, 16, v12
    v_bitop3_b32 v122, v122, v113, v113 bitop3:0x0c
    v_and_b32 v125, 0xffff0000, v12
    v_lshlrev_b32 v126, 16, v13
    v_mul_f32 v122, v114, v122
    v_and_b32 v127, 0xffff0000, v13
    v_add_u32 v123, v123, v123
    v_pk_fma_f32 v[124:125], v[124:125], v[122:123], s[34:35] op_sel_hi:[1,0,1]
    v_pk_fma_f32 v[126:127], v[126:127], v[122:123], s[34:35] op_sel_hi:[1,0,1]
    v_lshl_add_u32 v124, v125, 16, v124
    v_lshl_add_u32 v125, v127, 16, v126
    s_waitcnt lgkmcnt(2)
    v_bitop3_b32 v115, v115, v116, v117 bitop3:0xfe
    v_lshl_add_u64 v[124:125], v[124:125], 0, s[36:37]
    v_cmpx_le_u32 vcc, 0x1000000, v54
    ds_add_rtn_u64 v[116:117], v123, v[124:125] offset:54272
    s_mov_b64 exec, -1
    v_ashrrev_i32 v122, 5, v55
    v_lshlrev_b16 v123, 2, v55
    v_lshlrev_b32 v124, 16, v14
    v_bitop3_b32 v122, v122, v113, v113 bitop3:0x0c
    v_and_b32 v125, 0xffff0000, v14
    v_lshlrev_b32 v126, 16, v15
    v_mul_f32 v122, v114, v122
    v_and_b32 v127, 0xffff0000, v15
    v_add_u32 v123, v123, v123
    v_pk_fma_f32 v[124:125], v[124:125], v[122:123], s[34:35] op_sel_hi:[1,0,1]
    v_pk_fma_f32 v[126:127], v[126:127], v[122:123], s[34:35] op_sel_hi:[1,0,1]
    v_lshl_add_u32 v124, v125, 16, v124
    v_lshl_add_u32 v125, v127, 16, v126
    s_waitcnt lgkmcnt(2)
    v_bitop3_b32 v115, v115, v118, v119 bitop3:0xfe
    v_lshl_add_u64 v[124:125], v[124:125], 0, s[36:37]
    v_cmpx_le_u32 vcc, 0x1000000, v55
    ds_add_rtn_u64 v[118:119], v123, v[124:125] offset:54272
    s_mov_b64 exec, -1
    v_ashrrev_i32 v122, 5, v56
    v_lshlrev_b16 v123, 2, v56
    v_lshlrev_b32 v124, 16, v16
    v_bitop3_b32 v122, v122, v113, v113 bitop3:0x0c
    v_and_b32 v125, 0xffff0000, v16
    v_lshlrev_b32 v126, 16, v17
    v_mul_f32 v122, v114, v122
    v_and_b32 v127, 0xffff0000, v17
    v_add_u32 v123, v123, v123
    v_pk_fma_f32 v[124:125], v[124:125], v[122:123], s[34:35] op_sel_hi:[1,0,1]
    v_pk_fma_f32 v[126:127], v[126:127], v[122:123], s[34:35] op_sel_hi:[1,0,1]
    v_lshl_add_u32 v124, v125, 16, v124
    v_lshl_add_u32 v125, v127, 16, v126
    s_waitcnt lgkmcnt(2)
    v_bitop3_b32 v115, v115, v120, v121 bitop3:0xfe
    v_lshl_add_u64 v[124:125], v[124:125], 0, s[36:37]
    v_cmpx_le_u32 vcc, 0x1000000, v56
    ds_add_rtn_u64 v[120:121], v123, v[124:125] offset:54272
    s_mov_b64 exec, -1
    s_cmp_lt_u32 s15, 8
    s_cbranch_scc1 p2_nad0
    s_waitcnt lgkmcnt(15)
    v_ashrrev_i32 v122, 5, v57
    v_lshlrev_b16 v123, 2, v57
    v_lshlrev_b32 v124, 16, v18
    v_bitop3_b32 v122, v122, v113, v113 bitop3:0x0c
    v_and_b32 v125, 0xffff0000, v18
    v_lshlrev_b32 v126, 16, v19
    v_mul_f32 v122, v114, v122
    v_and_b32 v127, 0xffff0000, v19
    v_add_u32 v123, v123, v123
    v_pk_fma_f32 v[124:125], v[124:125], v[122:123], s[34:35] op_sel_hi:[1,0,1]
    v_pk_fma_f32 v[126:127], v[126:127], v[122:123], s[34:35] op_sel_hi:[1,0,1]
    v_lshl_add_u32 v124, v125, 16, v124
    v_lshl_add_u32 v125, v127, 16, v126
    s_waitcnt lgkmcnt(2)
    v_bitop3_b32 v115, v115, v116, v117 bitop3:0xfe
    v_lshl_add_u64 v[124:125], v[124:125], 0, s[36:37]
    v_cmpx_le_u32 vcc, 0x1000000, v57
    ds_add_rtn_u64 v[116:117], v123, v[124:125] offset:54272
    s_mov_b64 exec, -1
    v_ashrrev_i32 v122, 5, v58
    v_lshlrev_b16 v123, 2, v58
    v_lshlrev_b32 v124, 16, v20
    v_bitop3_b32 v122, v122, v113, v113 bitop3:0x0c
    v_and_b32 v125, 0xffff0000, v20
    v_lshlrev_b32 v126, 16, v21
    v_mul_f32 v122, v114, v122
    v_and_b32 v127, 0xffff0000, v21
    v_add_u32 v123, v123, v123
    v_pk_fma_f32 v[124:125], v[124:125], v[122:123], s[34:35] op_sel_hi:[1,0,1]
    v_pk_fma_f32 v[126:127], v[126:127], v[122:123], s[34:35] op_sel_hi:[1,0,1]
    v_lshl_add_u32 v124, v125, 16, v124
    v_lshl_add_u32 v125, v127, 16, v126
    s_waitcnt lgkmcnt(2)
    v_bitop3_b32 v115, v115, v118, v119 bitop3:0xfe
    v_lshl_add_u64 v[124:125], v[124:125], 0, s[36:37]
    v_cmpx_le_u32 vcc, 0x1000000, v58
    ds_add_rtn_u64 v[118:119], v123, v[124:125] offset:54272
    s_mov_b64 exec, -1
    v_ashrrev_i32 v122, 5, v59
    v_lshlrev_b16 v123, 2, v59
    v_lshlrev_b32 v124, 16, v22
    v_bitop3_b32 v122, v122, v113, v113 bitop3:0x0c
    v_and_b32 v125, 0xffff0000, v22
    v_lshlrev_b32 v126, 16, v23
    v_mul_f32 v122, v114, v122
    v_and_b32 v127, 0xffff0000, v23
    v_add_u32 v123, v123, v123
    v_pk_fma_f32 v[124:125], v[124:125], v[122:123], s[34:35] op_sel_hi:[1,0,1]
    v_pk_fma_f32 v[126:127], v[126:127], v[122:123], s[34:35] op_sel_hi:[1,0,1]
    v_lshl_add_u32 v124, v125, 16, v124
    v_lshl_add_u32 v125, v127, 16, v126
    s_waitcnt lgkmcnt(2)
    v_bitop3_b32 v115, v115, v120, v121 bitop3:0xfe
    v_lshl_add_u64 v[124:125], v[124:125], 0, s[36:37]
    v_cmpx_le_u32 vcc, 0x1000000, v59
    ds_add_rtn_u64 v[120:121], v123, v[124:125] offset:54272
    s_mov_b64 exec, -1
p2_nad0:
    s_waitcnt lgkmcnt(15)
    v_ashrrev_i32 v122, 5, v60
    v_lshlrev_b16 v123, 2, v60
    v_lshlrev_b32 v124, 16, v24
    v_bitop3_b32 v122, v122, v113, v113 bitop3:0x0c
    v_and_b32 v125, 0xffff0000, v24
    v_lshlrev_b32 v126, 16, v25
    v_mul_f32 v122, v114, v122
    v_and_b32 v127, 0xffff0000, v25
    v_add_u32 v123, v123, v123
    v_pk_fma_f32 v[124:125], v[124:125], v[122:123], s[34:35] op_sel_hi:[1,0,1]
    v_pk_fma_f32 v[126:127], v[126:127], v[122:123], s[34:35] op_sel_hi:[1,0,1]
    v_lshl_add_u32 v124, v125, 16, v124
    v_lshl_add_u32 v125, v127, 16, v126
    s_waitcnt lgkmcnt(2)
    v_bitop3_b32 v115, v115, v116, v117 bitop3:0xfe
    v_lshl_add_u64 v[124:125], v[124:125], 0, s[36:37]
    v_cmpx_le_u32 vcc, 0x1000000, v60
    ds_add_rtn_u64 v[116:117], v123, v[124:125] offset:54272
    s_mov_b64 exec, -1
    v_ashrrev_i32 v122, 5, v61
    v_lshlrev_b16 v123, 2, v61
    v_lshlrev_b32 v124, 16, v26
    v_bitop3_b32 v122, v122, v113, v113 bitop3:0x0c
    v_and_b32 v125, 0xffff0000, v26
    v_lshlrev_b32 v126, 16, v27
    v_mul_f32 v122, v114, v122
    v_and_b32 v127, 0xffff0000, v27
    v_add_u32 v123, v123, v123
    v_pk_fma_f32 v[124:125], v[124:125], v[122:123], s[34:35] op_sel_hi:[1,0,1]
    v_pk_fma_f32 v[126:127], v[126:127], v[122:123], s[34:35] op_sel_hi:[1,0,1]
    v_lshl_add_u32 v124, v125, 16, v124
    v_lshl_add_u32 v125, v127, 16, v126
    s_waitcnt lgkmcnt(2)
    v_bitop3_b32 v115, v115, v118, v119 bitop3:0xfe
    v_lshl_add_u64 v[124:125], v[124:125], 0, s[36:37]
    v_cmpx_le_u32 vcc, 0x1000000, v61
    ds_add_rtn_u64 v[118:119], v123, v[124:125] offset:54272
    s_mov_b64 exec, -1
    v_ashrrev_i32 v122, 5, v62
    v_lshlrev_b16 v123, 2, v62
    v_lshlrev_b32 v124, 16, v28
    v_bitop3_b32 v122, v122, v113, v113 bitop3:0x0c
    v_and_b32 v125, 0xffff0000, v28
    v_lshlrev_b32 v126, 16, v29
    v_mul_f32 v122, v114, v122
    v_and_b32 v127, 0xffff0000, v29
    v_add_u32 v123, v123, v123
    v_pk_fma_f32 v[124:125], v[124:125], v[122:123], s[34:35] op_sel_hi:[1,0,1]
    v_pk_fma_f32 v[126:127], v[126:127], v[122:123], s[34:35] op_sel_hi:[1,0,1]
    v_lshl_add_u32 v124, v125, 16, v124
    v_lshl_add_u32 v125, v127, 16, v126
    s_waitcnt lgkmcnt(2)
    v_bitop3_b32 v115, v115, v120, v121 bitop3:0xfe
    v_lshl_add_u64 v[124:125], v[124:125], 0, s[36:37]
    v_cmpx_le_u32 vcc, 0x1000000, v62
    ds_add_rtn_u64 v[120:121], v123, v[124:125] offset:54272
    s_mov_b64 exec, -1
    s_waitcnt lgkmcnt(15)
    v_ashrrev_i32 v122, 5, v63
    v_lshlrev_b16 v123, 2, v63
    v_lshlrev_b32 v124, 16, v30
    v_bitop3_b32 v122, v122, v113, v113 bitop3:0x0c
    v_and_b32 v125, 0xffff0000, v30
    v_lshlrev_b32 v126, 16, v31
    v_mul_f32 v122, v114, v122
    v_and_b32 v127, 0xffff0000, v31
    v_add_u32 v123, v123, v123
    v_pk_fma_f32 v[124:125], v[124:125], v[122:123], s[34:35] op_sel_hi:[1,0,1]
    v_pk_fma_f32 v[126:127], v[126:127], v[122:123], s[34:35] op_sel_hi:[1,0,1]
    v_lshl_add_u32 v124, v125, 16, v124
    v_lshl_add_u32 v125, v127, 16, v126
    s_waitcnt lgkmcnt(2)
    v_bitop3_b32 v115, v115, v116, v117 bitop3:0xfe
    v_lshl_add_u64 v[124:125], v[124:125], 0, s[36:37]
    v_cmpx_le_u32 vcc, 0x1000000, v63
    ds_add_rtn_u64 v[116:117], v123, v[124:125] offset:54272
    s_mov_b64 exec, -1
    v_ashrrev_i32 v122, 5, v64
    v_lshlrev_b16 v123, 2, v64
    v_lshlrev_b32 v124, 16, v32
    v_bitop3_b32 v122, v122, v113, v113 bitop3:0x0c
    v_and_b32 v125, 0xffff0000, v32
    v_lshlrev_b32 v126, 16, v33
    v_mul_f32 v122, v114, v122
    v_and_b32 v127, 0xffff0000, v33
    v_add_u32 v123, v123, v123
    v_pk_fma_f32 v[124:125], v[124:125], v[122:123], s[34:35] op_sel_hi:[1,0,1]
    v_pk_fma_f32 v[126:127], v[126:127], v[122:123], s[34:35] op_sel_hi:[1,0,1]
    v_lshl_add_u32 v124, v125, 16, v124
    v_lshl_add_u32 v125, v127, 16, v126
    s_waitcnt lgkmcnt(2)
    v_bitop3_b32 v115, v115, v118, v119 bitop3:0xfe
    v_lshl_add_u64 v[124:125], v[124:125], 0, s[36:37]
    v_cmpx_le_u32 vcc, 0x1000000, v64
    ds_add_rtn_u64 v[118:119], v123, v[124:125] offset:54272
    s_mov_b64 exec, -1
    v_ashrrev_i32 v122, 5, v65
    v_lshlrev_b16 v123, 2, v65
    v_lshlrev_b32 v124, 16, v34
    v_bitop3_b32 v122, v122, v113, v113 bitop3:0x0c
    v_and_b32 v125, 0xffff0000, v34
    v_lshlrev_b32 v126, 16, v35
    v_mul_f32 v122, v114, v122
    v_and_b32 v127, 0xffff0000, v35
    v_add_u32 v123, v123, v123
    v_pk_fma_f32 v[124:125], v[124:125], v[122:123], s[34:35] op_sel_hi:[1,0,1]
    v_pk_fma_f32 v[126:127], v[126:127], v[122:123], s[34:35] op_sel_hi:[1,0,1]
    v_lshl_add_u32 v124, v125, 16, v124
    v_lshl_add_u32 v125, v127, 16, v126
    s_waitcnt lgkmcnt(2)
    v_bitop3_b32 v115, v115, v120, v121 bitop3:0xfe
    v_lshl_add_u64 v[124:125], v[124:125], 0, s[36:37]
    v_cmpx_le_u32 vcc, 0x1000000, v65
    ds_add_rtn_u64 v[120:121], v123, v[124:125] offset:54272
    s_mov_b64 exec, -1
    s_waitcnt lgkmcnt(15)
    v_ashrrev_i32 v122, 5, v66
    v_lshlrev_b16 v123, 2, v66
    v_lshlrev_b32 v124, 16, v36
    v_bitop3_b32 v122, v122, v113, v113 bitop3:0x0c
    v_and_b32 v125, 0xffff0000, v36
    v_lshlrev_b32 v126, 16, v37
    v_mul_f32 v122, v114, v122
    v_and_b32 v127, 0xffff0000, v37
    v_add_u32 v123, v123, v123
    v_pk_fma_f32 v[124:125], v[124:125], v[122:123], s[34:35] op_sel_hi:[1,0,1]
    v_pk_fma_f32 v[126:127], v[126:127], v[122:123], s[34:35] op_sel_hi:[1,0,1]
    v_lshl_add_u32 v124, v125, 16, v124
    v_lshl_add_u32 v125, v127, 16, v126
    s_waitcnt lgkmcnt(2)
    v_bitop3_b32 v115, v115, v116, v117 bitop3:0xfe
    v_lshl_add_u64 v[124:125], v[124:125], 0, s[36:37]
    v_cmpx_le_u32 vcc, 0x1000000, v66
    ds_add_rtn_u64 v[116:117], v123, v[124:125] offset:54272
    s_mov_b64 exec, -1
    v_ashrrev_i32 v122, 5, v67
    v_lshlrev_b16 v123, 2, v67
    v_lshlrev_b32 v124, 16, v38
    v_bitop3_b32 v122, v122, v113, v113 bitop3:0x0c
    v_and_b32 v125, 0xffff0000, v38
    v_lshlrev_b32 v126, 16, v39
    v_mul_f32 v122, v114, v122
    v_and_b32 v127, 0xffff0000, v39
    v_add_u32 v123, v123, v123
    v_pk_fma_f32 v[124:125], v[124:125], v[122:123], s[34:35] op_sel_hi:[1,0,1]
    v_pk_fma_f32 v[126:127], v[126:127], v[122:123], s[34:35] op_sel_hi:[1,0,1]
    v_lshl_add_u32 v124, v125, 16, v124
    v_lshl_add_u32 v125, v127, 16, v126
    s_waitcnt lgkmcnt(2)
    v_bitop3_b32 v115, v115, v118, v119 bitop3:0xfe
    v_lshl_add_u64 v[124:125], v[124:125], 0, s[36:37]
    v_cmpx_le_u32 vcc, 0x1000000, v67
    ds_add_rtn_u64 v[118:119], v123, v[124:125] offset:54272
    s_mov_b64 exec, -1
    v_ashrrev_i32 v122, 5, v68
    v_lshlrev_b16 v123, 2, v68
    v_lshlrev_b32 v124, 16, v40
    v_bitop3_b32 v122, v122, v113, v113 bitop3:0x0c
    v_and_b32 v125, 0xffff0000, v40
    v_lshlrev_b32 v126, 16, v41
    v_mul_f32 v122, v114, v122
    v_and_b32 v127, 0xffff0000, v41
    v_add_u32 v123, v123, v123
    v_pk_fma_f32 v[124:125], v[124:125], v[122:123], s[34:35] op_sel_hi:[1,0,1]
    v_pk_fma_f32 v[126:127], v[126:127], v[122:123], s[34:35] op_sel_hi:[1,0,1]
    v_lshl_add_u32 v124, v125, 16, v124
    v_lshl_add_u32 v125, v127, 16, v126
    s_waitcnt lgkmcnt(2)
    v_bitop3_b32 v115, v115, v120, v121 bitop3:0xfe
    v_lshl_add_u64 v[124:125], v[124:125], 0, s[36:37]
    v_cmpx_le_u32 vcc, 0x1000000, v68
    ds_add_rtn_u64 v[120:121], v123, v[124:125] offset:54272
    s_mov_b64 exec, -1
    s_waitcnt lgkmcnt(15)
    v_ashrrev_i32 v122, 5, v69
    v_lshlrev_b16 v123, 2, v69
    v_lshlrev_b32 v124, 16, v42
    v_bitop3_b32 v122, v122, v113, v113 bitop3:0x0c
    v_and_b32 v125, 0xffff0000, v42
    v_lshlrev_b32 v126, 16, v43
    v_mul_f32 v122, v114, v122
    v_and_b32 v127, 0xffff0000, v43
    v_add_u32 v123, v123, v123
    v_pk_fma_f32 v[124:125], v[124:125], v[122:123], s[34:35] op_sel_hi:[1,0,1]
    v_pk_fma_f32 v[126:127], v[126:127], v[122:123], s[34:35] op_sel_hi:[1,0,1]
    v_lshl_add_u32 v124, v125, 16, v124
    v_lshl_add_u32 v125, v127, 16, v126
    s_waitcnt lgkmcnt(2)
    v_bitop3_b32 v115, v115, v116, v117 bitop3:0xfe
    v_lshl_add_u64 v[124:125], v[124:125], 0, s[36:37]
    v_cmpx_le_u32 vcc, 0x1000000, v69
    ds_add_rtn_u64 v[116:117], v123, v[124:125] offset:54272
    s_mov_b64 exec, -1
    v_ashrrev_i32 v122, 5, v70
    v_lshlrev_b16 v123, 2, v70
    v_lshlrev_b32 v124, 16, v44
    v_bitop3_b32 v122, v122, v113, v113 bitop3:0x0c
    v_and_b32 v125, 0xffff0000, v44
    v_lshlrev_b32 v126, 16, v45
    v_mul_f32 v122, v114, v122
    v_and_b32 v127, 0xffff0000, v45
    v_add_u32 v123, v123, v123
    v_pk_fma_f32 v[124:125], v[124:125], v[122:123], s[34:35] op_sel_hi:[1,0,1]
    v_pk_fma_f32 v[126:127], v[126:127], v[122:123], s[34:35] op_sel_hi:[1,0,1]
    v_lshl_add_u32 v124, v125, 16, v124
    v_lshl_add_u32 v125, v127, 16, v126
    s_waitcnt lgkmcnt(2)
    v_bitop3_b32 v115, v115, v118, v119 bitop3:0xfe
    v_lshl_add_u64 v[124:125], v[124:125], 0, s[36:37]
    v_cmpx_le_u32 vcc, 0x1000000, v70
    ds_add_rtn_u64 v[118:119], v123, v[124:125] offset:54272
    s_mov_b64 exec, -1
    v_ashrrev_i32 v122, 5, v71
    v_lshlrev_b16 v123, 2, v71
    v_lshlrev_b32 v124, 16, v46
    v_bitop3_b32 v122, v122, v113, v113 bitop3:0x0c
    v_and_b32 v125, 0xffff0000, v46
    v_lshlrev_b32 v126, 16, v47
    v_mul_f32 v122, v114, v122
    v_and_b32 v127, 0xffff0000, v47
    v_add_u32 v123, v123, v123
    v_pk_fma_f32 v[124:125], v[124:125], v[122:123], s[34:35] op_sel_hi:[1,0,1]
    v_pk_fma_f32 v[126:127], v[126:127], v[122:123], s[34:35] op_sel_hi:[1,0,1]
    v_lshl_add_u32 v124, v125, 16, v124
    v_lshl_add_u32 v125, v127, 16, v126
    s_waitcnt lgkmcnt(2)
    v_bitop3_b32 v115, v115, v120, v121 bitop3:0xfe
    v_lshl_add_u64 v[124:125], v[124:125], 0, s[36:37]
    v_cmpx_le_u32 vcc, 0x1000000, v71
    ds_add_rtn_u64 v[120:121], v123, v[124:125] offset:54272
    s_mov_b64 exec, -1
    s_branch p2_fin
p2_topf:
    s_cmp_eq_u32 s60, 10
    s_cbranch_scc1 p2_drain1
    s_setprio 3
    v_cmpx_gt_i16 vcc, 0, v48
    ds_read_b64 v[0:1], v0
    s_mov_b64 exec, -1
    v_cmpx_gt_i16 vcc, 0, v49
    ds_read_b64 v[2:3], v2
    s_mov_b64 exec, -1
    v_cmpx_gt_i16 vcc, 0, v50
    ds_read_b64 v[4:5], v4
    s_mov_b64 exec, -1
    v_cmpx_gt_i16 vcc, 0, v51
    ds_read_b64 v[6:7], v6
    s_mov_b64 exec, -1
    v_cmpx_gt_i16 vcc, 0, v52
    ds_read_b64 v[8:9], v8
    s_mov_b64 exec, -1
    v_cmpx_gt_i16 vcc, 0, v53
    ds_read_b64 v[10:11], v10
    s_mov_b64 exec, -1
    v_cmpx_gt_i16 vcc, 0, v54
    ds_read_b64 v[12:13], v12
    s_mov_b64 exec, -1
    v_cmpx_gt_i16 vcc, 0, v55
    ds_read_b64 v[14:15], v14
    s_mov_b64 exec, -1
    v_cmpx_gt_i16 vcc, 0, v56
    ds_read_b64 v[16:17], v16
    s_mov_b64 exec, -1
    s_cmp_lt_u32 s15, 8
    s_cbranch_scc1 p2_g1r23
    v_cmpx_gt_i16 vcc, 0, v57
    ds_read_b64 v[18:19], v18
    s_mov_b64 exec, -1
    v_cmpx_gt_i16 vcc, 0, v58
    ds_read_b64 v[20:21], v20
    s_mov_b64 exec, -1
    v_cmpx_gt_i16 vcc, 0, v59
    ds_read_b64 v[22:23], v22
    s_mov_b64 exec, -1
p2_g1r23:
    s_cmp_ge_u32 s10, 9
    s_cbranch_scc1 p2_nm1m0a
    v_lshrrev_b32 v84, 1, v112
    s_add_u32 s44, s20, s42
    buffer_load_dwordx2 v[84:85], v84, s[4:7], s44 offen
p2_nm1m0a:
    buffer_load_dwordx4 v[72:75], v112, s[4:7], s20 offen offset:0
    buffer_load_dwordx4 v[76:79], v112, s[4:7], s20 offen offset:1024
    buffer_load_dwordx4 v[80:83], v112, s[4:7], s20 offen offset:2048
    v_cmpx_gt_i16 vcc, 0, v60
    ds_read_b64 v[24:25], v24
    s_mov_b64 exec, -1
    v_cmpx_gt_i16 vcc, 0, v61
    ds_read_b64 v[26:27], v26
    s_mov_b64 exec, -1
    v_cmpx_gt_i16 vcc, 0, v62
    ds_read_b64 v[28:29], v28
    s_mov_b64 exec, -1
    v_cmpx_gt_i16 vcc, 0, v63
    ds_read_b64 v[30:31], v30
    s_mov_b64 exec, -1
    v_cmpx_gt_i16 vcc, 0, v64
    ds_read_b64 v[32:33], v32
    s_mov_b64 exec, -1
    v_cmpx_gt_i16 vcc, 0, v65
    ds_read_b64 v[34:35], v34
    s_mov_b64 exec, -1
    v_cmpx_gt_i16 vcc, 0, v66
    ds_read_b64 v[36:37], v36
    s_mov_b64 exec, -1
    v_cmpx_gt_i16 vcc, 0, v67
    ds_read_b64 v[38:39], v38
    s_mov_b64 exec, -1
    v_cmpx_gt_i16 vcc, 0, v68
    ds_read_b64 v[40:41], v40
    s_mov_b64 exec, -1
    v_cmpx_gt_i16 vcc, 0, v69
    ds_read_b64 v[42:43], v42
    s_mov_b64 exec, -1
    v_cmpx_gt_i16 vcc, 0, v70
    ds_read_b64 v[44:45], v44
    s_mov_b64 exec, -1
    v_cmpx_gt_i16 vcc, 0, v71
    ds_read_b64 v[46:47], v46
    s_mov_b64 exec, -1
    s_setprio 2
    s_waitcnt lgkmcnt(15)
    v_ashrrev_i32 v122, 5, v48
    v_lshlrev_b16 v123, 2, v48
    v_cndmask_b32 v126, v0, v1, s[66:67]
    v_bitop3_b32 v122, v122, v113, v113 bitop3:0x0c
    v_lshlrev_b32 v124, 16, v126
    v_mul_f32 v122, v114, v122
    v_and_b32 v125, 0xffff0000, v126
    v_add_u32 v123, v123, v123
    v_mul_f32 v124, v122, v124
    v_mul_f32 v125, v122, v125
    v_cmpx_le_u32 vcc, 0x1000000, v48
    ds_add_f32 v123, v124 offset:54272
    ds_add_f32 v123, v125 offset:54276
    s_mov_b64 exec, -1
    v_ashrrev_i32 v122, 5, v49
    v_lshlrev_b16 v123, 2, v49
    v_cndmask_b32 v126, v2, v3, s[66:67]
    v_bitop3_b32 v122, v122, v113, v113 bitop3:0x0c
    v_lshlrev_b32 v124, 16, v126
    v_mul_f32 v122, v114, v122
    v_and_b32 v125, 0xffff0000, v126
    v_add_u32 v123, v123, v123
    v_mul_f32 v124, v122, v124
    v_mul_f32 v125, v122, v125
    v_cmpx_le_u32 vcc, 0x1000000, v49
    ds_add_f32 v123, v124 offset:54272
    ds_add_f32 v123, v125 offset:54276
    s_mov_b64 exec, -1
    v_ashrrev_i32 v122, 5, v50
    v_lshlrev_b16 v123, 2, v50
    v_cndmask_b32 v126, v4, v5, s[66:67]
    v_bitop3_b32 v122, v122, v113, v113 bitop3:0x0c
    v_lshlrev_b32 v124, 16, v126
    v_mul_f32 v122, v114, v122
    v_and_b32 v125, 0xffff0000, v126
    v_add_u32 v123, v123, v123
    v_mul_f32 v124, v122, v124
    v_mul_f32 v125, v122, v125
    v_cmpx_le_u32 vcc, 0x1000000, v50
    ds_add_f32 v123, v124 offset:54272
    ds_add_f32 v123, v125 offset:54276
    s_mov_b64 exec, -1
    v_bfe_u32 v0, v102, 14, 4
    v_lshrrev_b32 v1, 18, v102
    v_and_b32 v102, 16383, v102
    v_mad_u32_u24 v0, v0, s63, v1
    v_mad_u32_u24 v102, v0, s65, v102
    buffer_load_dwordx4 v[0:3], v102, s[68:71], 0 offen
    s_setprio 1
    s_waitcnt lgkmcnt(15)
    v_ashrrev_i32 v122, 5, v51
    v_lshlrev_b16 v123, 2, v51
    v_cndmask_b32 v126, v6, v7, s[66:67]
    v_bitop3_b32 v122, v122, v113, v113 bitop3:0x0c
    v_lshlrev_b32 v124, 16, v126
    v_mul_f32 v122, v114, v122
    v_and_b32 v125, 0xffff0000, v126
    v_add_u32 v123, v123, v123
    v_mul_f32 v124, v122, v124
    v_mul_f32 v125, v122, v125
    v_cmpx_le_u32 vcc, 0x1000000, v51
    ds_add_f32 v123, v124 offset:54272
    ds_add_f32 v123, v125 offset:54276
    s_mov_b64 exec, -1
    v_ashrrev_i32 v122, 5, v52
    v_lshlrev_b16 v123, 2, v52
    v_cndmask_b32 v126, v8, v9, s[66:67]
    v_bitop3_b32 v122, v122, v113, v113 bitop3:0x0c
    v_lshlrev_b32 v124, 16, v126
    v_mul_f32 v122, v114, v122
    v_and_b32 v125, 0xffff0000, v126
    v_add_u32 v123, v123, v123
    v_mul_f32 v124, v122, v124
    v_mul_f32 v125, v122, v125
    v_cmpx_le_u32 vcc, 0x1000000, v52
    ds_add_f32 v123, v124 offset:54272
    ds_add_f32 v123, v125 offset:54276
    s_mov_b64 exec, -1
    v_ashrrev_i32 v122, 5, v53
    v_lshlrev_b16 v123, 2, v53
    v_cndmask_b32 v126, v10, v11, s[66:67]
    v_bitop3_b32 v122, v122, v113, v113 bitop3:0x0c
    v_lshlrev_b32 v124, 16, v126
    v_mul_f32 v122, v114, v122
    v_and_b32 v125, 0xffff0000, v126
    v_add_u32 v123, v123, v123
    v_mul_f32 v124, v122, v124
    v_mul_f32 v125, v122, v125
    v_cmpx_le_u32 vcc, 0x1000000, v53
    ds_add_f32 v123, v124 offset:54272
    ds_add_f32 v123, v125 offset:54276
    s_mov_b64 exec, -1
    v_bfe_u32 v6, v103, 14, 4
    v_lshrrev_b32 v7, 18, v103
    v_and_b32 v103, 16383, v103
    v_mad_u32_u24 v6, v6, s63, v7
    v_mad_u32_u24 v103, v6, s65, v103
    buffer_load_dwordx4 v[6:9], v103, s[68:71], 0 offen
    s_waitcnt lgkmcnt(12)
    s_barrier
    s_setprio 3
    s_waitcnt vmcnt(5)
    s_mov_b32 m0, s23
    v_mov_b32 v53, 0
    s_movk_i32 s44, 512
    v_sub_u32_sdwa v4, v111, v110 dst_sel:DWORD dst_unused:UNUSED_PAD src0_sel:WORD_0 src1_sel:WORD_0
    v_sub_u32_sdwa v5, v111, v110 dst_sel:DWORD dst_unused:UNUSED_PAD src0_sel:WORD_1 src1_sel:WORD_1
    v_med3_i32 v4, v4, 0, s44
    v_med3_i32 v5, v5, 0, s44
    v_add_u32 v48, v4, v5
    ds_write_addtid_b32 v53 offset:0
    ds_write_addtid_b32 v53 offset:256
    ds_write_addtid_b32 v53 offset:512
    ds_write_addtid_b32 v53 offset:768
    ds_write_addtid_b32 v53 offset:1024
    ds_write_addtid_b32 v53 offset:1280
    ds_write_addtid_b32 v53 offset:1536
    ds_write_addtid_b32 v53 offset:1792
    v_bfe_i32 v53, v112, 6, 1
    v_lshrrev_b32 v49, 6, v112
    v_bitop3_b32 v53, v53, 15, s10 bitop3:0x6a
    v_lshl_or_b32 v49, v49, 4, v53
    v_and_b32 v53, 0x30, v112
    v_lshl_or_b32 v53, v49, 6, v53
    v_lshlrev_b32 v53, 15, v53
    s_nop 1
    v_add_u32_dpp v48, v48, v48 row_shr:1 row_mask:0xf bank_mask:0xf bound_ctrl:0
    s_nop 1
    v_add_u32_dpp v48, v48, v48 row_shr:2 row_mask:0xf bank_mask:0xf bound_ctrl:0
    s_nop 1
    v_add_u32_dpp v48, v48, v48 row_shr:4 row_mask:0xf bank_mask:0xf bound_ctrl:0
    s_nop 1
    v_add_u32_dpp v48, v48, v48 row_shr:8 row_mask:0xf bank_mask:0xf bound_ctrl:0
    s_nop 1
    v_add_u32_dpp v48, v48, v48 row_bcast:15 row_mask:0xa bank_mask:0xf
    s_nop 1
    v_add_u32_dpp v48, v48, v48 row_bcast:31 row_mask:0xc bank_mask:0xf
    s_nop 1
    s_nop 0
    v_readlane_b32 s38, v48, 63
    v_sub_u32 v50, v48, v5
    v_sub_u32 v49, v50, v4
    v_writelane_b32 v5, 1, 63
    v_sub_u32 v10, 512, v49
    v_mad_u32_u16 v51, v110, 16, v53
    v_lshl_add_u32 v51, v10, 4, v51
    v_med3_i32 v10, v10, 0, v4
    v_lshl_add_u32 v49, v49, 2, s23
    v_sub_u32 v11, 512, v50
    v_mad_u32_u16 v52, v110, 16, v53 op_sel:[1,0,0,0]
    v_add_u32 v52, 262144, v52
    s_mov_b32 s44, 0x1fffc000
    v_writelane_b32 v52, s44, 63
    v_lshl_add_u32 v52, v11, 4, v52
    v_med3_i32 v11, v11, 0, v5
    v_lshl_add_u32 v50, v50, 2, s23
    v_lshl_add_u32 v48, v11, 16, v10
    v_add_u32 v110, v110, v48
    s_min_u32 s17, s38, 512
    s_add_u32 s17, s17, 63
    s_lshr_b32 s17, s17, 6
    v_cmpx_lt_i32 vcc, 0, v10
    ds_write_b32 v49, v51
    s_mov_b64 exec, -1
    v_cmpx_lt_i32 vcc, 0, v11
    ds_write_b32 v50, v52
    s_mov_b64 exec, -1
    s_cmp_lt_u32 s38, 512
    s_cbranch_scc1 p2_nomore1x
    v_cmp_lt_u32_sdwa s[44:45], v110, v111 src0_sel:WORD_0 src1_sel:WORD_0
    v_cmp_lt_u32_sdwa s[46:47], v110, v111 src0_sel:WORD_1 src1_sel:WORD_1
    s_nop 0
    s_or_b64 s[44:45], s[44:45], s[46:47]
    s_cbranch_scc0 p2_nomore1x
    v_mov_b32 v49, s19
    v_mov_b32 v50, 1
    ds_write_b32 v49, v50 offset:53760
p2_nomore1x:
    s_setprio 2
    s_waitcnt lgkmcnt(15)
    v_ashrrev_i32 v122, 5, v54
    v_lshlrev_b16 v123, 2, v54
    v_cndmask_b32 v126, v12, v13, s[66:67]
    v_bitop3_b32 v122, v122, v113, v113 bitop3:0x0c
    v_lshlrev_b32 v124, 16, v126
    v_mul_f32 v122, v114, v122
    v_and_b32 v125, 0xffff0000, v126
    v_add_u32 v123, v123, v123
    v_mul_f32 v124, v122, v124
    v_mul_f32 v125, v122, v125
    v_cmpx_le_u32 vcc, 0x1000000, v54
    ds_add_f32 v123, v124 offset:54272
    ds_add_f32 v123, v125 offset:54276
    s_mov_b64 exec, -1
    v_ashrrev_i32 v122, 5, v55
    v_lshlrev_b16 v123, 2, v55
    v_cndmask_b32 v126, v14, v15, s[66:67]
    v_bitop3_b32 v122, v122, v113, v113 bitop3:0x0c
    v_lshlrev_b32 v124, 16, v126
    v_mul_f32 v122, v114, v122
    v_and_b32 v125, 0xffff0000, v126
    v_add_u32 v123, v123, v123
    v_mul_f32 v124, v122, v124
    v_mul_f32 v125, v122, v125
    v_cmpx_le_u32 vcc, 0x1000000, v55
    ds_add_f32 v123, v124 offset:54272
    ds_add_f32 v123, v125 offset:54276
    s_mov_b64 exec, -1
    v_ashrrev_i32 v122, 5, v56
    v_lshlrev_b16 v123, 2, v56
    v_cndmask_b32 v126, v16, v17, s[66:67]
    v_bitop3_b32 v122, v122, v113, v113 bitop3:0x0c
    v_lshlrev_b32 v124, 16, v126
    v_mul_f32 v122, v114, v122
    v_and_b32 v125, 0xffff0000, v126
    v_add_u32 v123, v123, v123
    v_mul_f32 v124, v122, v124
    v_mul_f32 v125, v122, v125
    v_cmpx_le_u32 vcc, 0x1000000, v56
    ds_add_f32 v123, v124 offset:54272
    ds_add_f32 v123, v125 offset:54276
    s_mov_b64 exec, -1
    v_bfe_u32 v12, v104, 14, 4
    v_lshrrev_b32 v13, 18, v104
    v_and_b32 v104, 16383, v104
    v_mad_u32_u24 v12, v12, s63, v13
    v_mad_u32_u24 v104, v12, s65, v104
    buffer_load_dwordx4 v[12:15], v104, s[68:71], 0 offen
    s_cmp_lt_u32 s15, 8
    s_cbranch_scc1 p2_na1a3
    s_waitcnt lgkmcnt(15)
    v_ashrrev_i32 v122, 5, v57
    v_lshlrev_b16 v123, 2, v57
    v_cndmask_b32 v126, v18, v19, s[66:67]
    v_bitop3_b32 v122, v122, v113, v113 bitop3:0x0c
    v_lshlrev_b32 v124, 16, v126
    v_mul_f32 v122, v114, v122
    v_and_b32 v125, 0xffff0000, v126
    v_add_u32 v123, v123, v123
    v_mul_f32 v124, v122, v124
    v_mul_f32 v125, v122, v125
    v_cmpx_le_u32 vcc, 0x1000000, v57
    ds_add_f32 v123, v124 offset:54272
    ds_add_f32 v123, v125 offset:54276
    s_mov_b64 exec, -1
    v_ashrrev_i32 v122, 5, v58
    v_lshlrev_b16 v123, 2, v58
    v_cndmask_b32 v126, v20, v21, s[66:67]
    v_bitop3_b32 v122, v122, v113, v113 bitop3:0x0c
    v_lshlrev_b32 v124, 16, v126
    v_mul_f32 v122, v114, v122
    v_and_b32 v125, 0xffff0000, v126
    v_add_u32 v123, v123, v123
    v_mul_f32 v124, v122, v124
    v_mul_f32 v125, v122, v125
    v_cmpx_le_u32 vcc, 0x1000000, v58
    ds_add_f32 v123, v124 offset:54272
    ds_add_f32 v123, v125 offset:54276
    s_mov_b64 exec, -1
    v_ashrrev_i32 v122, 5, v59
    v_lshlrev_b16 v123, 2, v59
    v_cndmask_b32 v126, v22, v23, s[66:67]
    v_bitop3_b32 v122, v122, v113, v113 bitop3:0x0c
    v_lshlrev_b32 v124, 16, v126
    v_mul_f32 v122, v114, v122
    v_and_b32 v125, 0xffff0000, v126
    v_add_u32 v123, v123, v123
    v_mul_f32 v124, v122, v124
    v_mul_f32 v125, v122, v125
    v_cmpx_le_u32 vcc, 0x1000000, v59
    ds_add_f32 v123, v124 offset:54272
    ds_add_f32 v123, v125 offset:54276
    s_mov_b64 exec, -1
p2_na1a3:
    v_bfe_u32 v18, v105, 14, 4
    v_lshrrev_b32 v19, 18, v105
    v_and_b32 v105, 16383, v105
    v_mad_u32_u24 v18, v18, s63, v19
    v_mad_u32_u24 v105, v18, s65, v105
    buffer_load_dwordx4 v[18:21], v105, s[68:71], 0 offen
    s_mov_b32 m0, s23
    s_nop 0
    ds_read_addtid_b32 v102 offset:1024
    ds_read_addtid_b32 v103 offset:1280
    ds_read_addtid_b32 v104 offset:1536
    ds_read_addtid_b32 v105 offset:1792
    ds_read_addtid_b32 v106 offset:0
    ds_read_addtid_b32 v107 offset:256
    ds_read_addtid_b32 v108 offset:512
    ds_read_addtid_b32 v109 offset:768
    s_waitcnt vmcnt(4)
    s_mov_b32 m0, s24
    s_cmp_ge_u32 s10, 9
    s_cbranch_scc1 p2_st1s0
    ds_write_addtid_b32 v84 offset:49152
    ds_write_addtid_b32 v85 offset:49408
p2_st1s0:
    s_mov_b32 m0, s23
    s_add_u32 s20, s20, 53760
    ds_write_addtid_b32 v72 offset:0
    ds_write_addtid_b32 v73 offset:256
    ds_write_addtid_b32 v74 offset:512
    ds_write_addtid_b32 v75 offset:768
    ds_write_addtid_b32 v76 offset:1024
    ds_write_addtid_b32 v77 offset:1280
    ds_write_addtid_b32 v78 offset:1536
    ds_write_addtid_b32 v79 offset:1792
    ds_write_addtid_b32 v80 offset:2048
    ds_write_addtid_b32 v81 offset:2304
    ds_write_addtid_b32 v82 offset:2560
    ds_write_addtid_b32 v83 offset:2816
    s_setprio 1
    s_waitcnt lgkmcnt(15)
    v_ashrrev_i32 v122, 5, v60
    v_lshlrev_b16 v123, 2, v60
    v_cndmask_b32 v126, v24, v25, s[66:67]
    v_bitop3_b32 v122, v122, v113, v113 bitop3:0x0c
    v_lshlrev_b32 v124, 16, v126
    v_mul_f32 v122, v114, v122
    v_and_b32 v125, 0xffff0000, v126
    v_add_u32 v123, v123, v123
    v_mul_f32 v124, v122, v124
    v_mul_f32 v125, v122, v125
    v_cmpx_le_u32 vcc, 0x1000000, v60
    ds_add_f32 v123, v124 offset:54272
    ds_add_f32 v123, v125 offset:54276
    s_mov_b64 exec, -1
    v_ashrrev_i32 v122, 5, v61
    v_lshlrev_b16 v123, 2, v61
    v_cndmask_b32 v126, v26, v27, s[66:67]
    v_bitop3_b32 v122, v122, v113, v113 bitop3:0x0c
    v_lshlrev_b32 v124, 16, v126
    v_mul_f32 v122, v114, v122
    v_and_b32 v125, 0xffff0000, v126
    v_add_u32 v123, v123, v123
    v_mul_f32 v124, v122, v124
    v_mul_f32 v125, v122, v125
    v_cmpx_le_u32 vcc, 0x1000000, v61
    ds_add_f32 v123, v124 offset:54272
    ds_add_f32 v123, v125 offset:54276
    s_mov_b64 exec, -1
    v_ashrrev_i32 v122, 5, v62
    v_lshlrev_b16 v123, 2, v62
    v_cndmask_b32 v126, v28, v29, s[66:67]
    v_bitop3_b32 v122, v122, v113, v113 bitop3:0x0c
    v_lshlrev_b32 v124, 16, v126
    v_mul_f32 v122, v114, v122
    v_and_b32 v125, 0xffff0000, v126
    v_add_u32 v123, v123, v123
    v_mul_f32 v124, v122, v124
    v_mul_f32 v125, v122, v125
    v_cmpx_le_u32 vcc, 0x1000000, v62
    ds_add_f32 v123, v124 offset:54272
    ds_add_f32 v123, v125 offset:54276
    s_mov_b64 exec, -1
    s_waitcnt vmcnt(16)
    v_perm_b32 v60, v89, v86, s31
    v_perm_b32 v61, v89, v87, s32
    v_perm_b32 v62, v89, v88, s33
    v_lshlrev_b16 v28, 3, v88
    v_lshlrev_b16 v26, 3, v87
    v_lshlrev_b16 v24, 3, v86
    s_waitcnt lgkmcnt(15)
    s_nop 2
    s_nop 1
    v_max_u32_dpp v106, v106, v106 row_shr:1 row_mask:0xf bank_mask:0xf bound_ctrl:0
    v_max_u32_dpp v107, v107, v107 row_shr:1 row_mask:0xf bank_mask:0xf bound_ctrl:0
    s_nop 0
    v_max_u32_dpp v106, v106, v106 row_shr:2 row_mask:0xf bank_mask:0xf bound_ctrl:0
    v_max_u32_dpp v107, v107, v107 row_shr:2 row_mask:0xf bank_mask:0xf bound_ctrl:0
    s_nop 0
    v_max_u32_dpp v106, v106, v106 row_shr:4 row_mask:0xf bank_mask:0xf bound_ctrl:0
    v_max_u32_dpp v107, v107, v107 row_shr:4 row_mask:0xf bank_mask:0xf bound_ctrl:0
    s_nop 0
    v_max_u32_dpp v106, v106, v106 row_shr:8 row_mask:0xf bank_mask:0xf bound_ctrl:0
    v_max_u32_dpp v107, v107, v107 row_shr:8 row_mask:0xf bank_mask:0xf bound_ctrl:0
    s_nop 0
    v_max_u32_dpp v106, v106, v106 row_bcast:15 row_mask:0xa bank_mask:0xf
    v_max_u32_dpp v107, v107, v107 row_bcast:15 row_mask:0xa bank_mask:0xf
    s_nop 0
    v_max_u32_dpp v106, v106, v106 row_bcast:31 row_mask:0xc bank_mask:0xf
    v_max_u32_dpp v107, v107, v107 row_bcast:31 row_mask:0xc bank_mask:0xf
    s_nop 0
    s_nop 0
    v_readlane_b32 s41, v106, 63
    v_add_u32 v106, v106, v112
    v_add_u32 v106, 4294959104, v106
    v_max_u32 v107, s41, v107
    s_nop 0
    v_readlane_b32 s41, v107, 63
    v_add_u32 v107, v107, v112
    v_add_u32 v107, 4294960128, v107
    v_bfe_u32 v86, v106, 14, 4
    v_lshrrev_b32 v87, 18, v106
    v_and_b32 v106, 16383, v106
    v_mad_u32_u24 v86, v86, s63, v87
    v_mad_u32_u24 v106, v86, s65, v106
    buffer_load_dwordx4 v[86:89], v106, s[68:71], 0 offen
    s_setprio 0
    s_waitcnt lgkmcnt(15)
    v_ashrrev_i32 v122, 5, v63
    v_lshlrev_b16 v123, 2, v63
    v_cndmask_b32 v126, v30, v31, s[66:67]
    v_bitop3_b32 v122, v122, v113, v113 bitop3:0x0c
    v_lshlrev_b32 v124, 16, v126
    v_mul_f32 v122, v114, v122
    v_and_b32 v125, 0xffff0000, v126
    v_add_u32 v123, v123, v123
    v_mul_f32 v124, v122, v124
    v_mul_f32 v125, v122, v125
    v_cmpx_le_u32 vcc, 0x1000000, v63
    ds_add_f32 v123, v124 offset:54272
    ds_add_f32 v123, v125 offset:54276
    s_mov_b64 exec, -1
    v_ashrrev_i32 v122, 5, v64
    v_lshlrev_b16 v123, 2, v64
    v_cndmask_b32 v126, v32, v33, s[66:67]
    v_bitop3_b32 v122, v122, v113, v113 bitop3:0x0c
    v_lshlrev_b32 v124, 16, v126
    v_mul_f32 v122, v114, v122
    v_and_b32 v125, 0xffff0000, v126
    v_add_u32 v123, v123, v123
    v_mul_f32 v124, v122, v124
    v_mul_f32 v125, v122, v125
    v_cmpx_le_u32 vcc, 0x1000000, v64
    ds_add_f32 v123, v124 offset:54272
    ds_add_f32 v123, v125 offset:54276
    s_mov_b64 exec, -1
    v_ashrrev_i32 v122, 5, v65
    v_lshlrev_b16 v123, 2, v65
    v_cndmask_b32 v126, v34, v35, s[66:67]
    v_bitop3_b32 v122, v122, v113, v113 bitop3:0x0c
    v_lshlrev_b32 v124, 16, v126
    v_mul_f32 v122, v114, v122
    v_and_b32 v125, 0xffff0000, v126
    v_add_u32 v123, v123, v123
    v_mul_f32 v124, v122, v124
    v_mul_f32 v125, v122, v125
    v_cmpx_le_u32 vcc, 0x1000000, v65
    ds_add_f32 v123, v124 offset:54272
    ds_add_f32 v123, v125 offset:54276
    s_mov_b64 exec, -1
    s_waitcnt vmcnt(13)
    v_perm_b32 v63, v93, v90, s31
    v_perm_b32 v64, v93, v91, s32
    v_perm_b32 v65, v93, v92, s33
    v_lshlrev_b16 v34, 3, v92
    v_lshlrev_b16 v32, 3, v91
    v_lshlrev_b16 v30, 3, v90
    s_waitcnt lgkmcnt(12)
    s_barrier
    s_setprio 3
    s_cmp_ge_u32 s10, 9
    s_cbranch_scc1 p2_nm1m1a
    v_lshrrev_b32 v84, 1, v112
    s_add_u32 s44, s20, s42
    buffer_load_dwordx2 v[84:85], v84, s[4:7], s44 offen
p2_nm1m1a:
    buffer_load_dwordx4 v[72:75], v112, s[4:7], s20 offen offset:0
    buffer_load_dwordx4 v[76:79], v112, s[4:7], s20 offen offset:1024
    buffer_load_dwordx4 v[80:83], v112, s[4:7], s20 offen offset:2048
    v_cmpx_ge_u16 vcc, 0x3fff, v60
    ds_read_b64 v[24:25], v24
    s_mov_b64 exec, -1
    v_cmpx_ge_u16 vcc, 0x3fff, v61
    ds_read_b64 v[26:27], v26
    s_mov_b64 exec, -1
    v_cmpx_ge_u16 vcc, 0x3fff, v62
    ds_read_b64 v[28:29], v28
    s_mov_b64 exec, -1
    v_cmpx_ge_u16 vcc, 0x3fff, v63
    ds_read_b64 v[30:31], v30
    s_mov_b64 exec, -1
    v_cmpx_ge_u16 vcc, 0x3fff, v64
    ds_read_b64 v[32:33], v32
    s_mov_b64 exec, -1
    v_cmpx_ge_u16 vcc, 0x3fff, v65
    ds_read_b64 v[34:35], v34
    s_mov_b64 exec, -1
    s_setprio 2
    s_waitcnt lgkmcnt(15)
    v_ashrrev_i32 v122, 5, v66
    v_lshlrev_b16 v123, 2, v66
    v_cndmask_b32 v126, v36, v37, s[66:67]
    v_bitop3_b32 v122, v122, v113, v113 bitop3:0x0c
    v_lshlrev_b32 v124, 16, v126
    v_mul_f32 v122, v114, v122
    v_and_b32 v125, 0xffff0000, v126
    v_add_u32 v123, v123, v123
    v_mul_f32 v124, v122, v124
    v_mul_f32 v125, v122, v125
    v_cmpx_le_u32 vcc, 0x1000000, v66
    ds_add_f32 v123, v124 offset:54272
    ds_add_f32 v123, v125 offset:54276
    s_mov_b64 exec, -1
    v_ashrrev_i32 v122, 5, v67
    v_lshlrev_b16 v123, 2, v67
    v_cndmask_b32 v126, v38, v39, s[66:67]
    v_bitop3_b32 v122, v122, v113, v113 bitop3:0x0c
    v_lshlrev_b32 v124, 16, v126
    v_mul_f32 v122, v114, v122
    v_and_b32 v125, 0xffff0000, v126
    v_add_u32 v123, v123, v123
    v_mul_f32 v124, v122, v124
    v_mul_f32 v125, v122, v125
    v_cmpx_le_u32 vcc, 0x1000000, v67
    ds_add_f32 v123, v124 offset:54272
    ds_add_f32 v123, v125 offset:54276
    s_mov_b64 exec, -1
    v_ashrrev_i32 v122, 5, v68
    v_lshlrev_b16 v123, 2, v68
    v_cndmask_b32 v126, v40, v41, s[66:67]
    v_bitop3_b32 v122, v122, v113, v113 bitop3:0x0c
    v_lshlrev_b32 v124, 16, v126
    v_mul_f32 v122, v114, v122
    v_and_b32 v125, 0xffff0000, v126
    v_add_u32 v123, v123, v123
    v_mul_f32 v124, v122, v124
    v_mul_f32 v125, v122, v125
    v_cmpx_le_u32 vcc, 0x1000000, v68
    ds_add_f32 v123, v124 offset:54272
    ds_add_f32 v123, v125 offset:54276
    s_mov_b64 exec, -1
    s_waitcnt vmcnt(15)
    v_perm_b32 v66, v97, v94, s31
    v_perm_b32 v67, v97, v95, s32
    v_perm_b32 v68, v97, v96, s33
    v_lshlrev_b16 v40, 3, v96
    v_lshlrev_b16 v38, 3, v95
    v_lshlrev_b16 v36, 3, v94
    v_cmpx_ge_u16 vcc, 0x3fff, v66
    ds_read_b64 v[36:37], v36
    s_mov_b64 exec, -1
    v_cmpx_ge_u16 vcc, 0x3fff, v67
    ds_read_b64 v[38:39], v38
    s_mov_b64 exec, -1
    v_cmpx_ge_u16 vcc, 0x3fff, v68
    ds_read_b64 v[40:41], v40
    s_mov_b64 exec, -1
    v_bfe_u32 v90, v107, 14, 4
    v_lshrrev_b32 v91, 18, v107
    v_and_b32 v107, 16383, v107
    v_mad_u32_u24 v90, v90, s63, v91
    v_mad_u32_u24 v107, v90, s65, v107
    buffer_load_dwordx4 v[90:93], v107, s[68:71], 0 offen
    s_setprio 1
    s_waitcnt lgkmcnt(15)
    v_ashrrev_i32 v122, 5, v69
    v_lshlrev_b16 v123, 2, v69
    v_cndmask_b32 v126, v42, v43, s[66:67]
    v_bitop3_b32 v122, v122, v113, v113 bitop3:0x0c
    v_lshlrev_b32 v124, 16, v126
    v_mul_f32 v122, v114, v122
    v_and_b32 v125, 0xffff0000, v126
    v_add_u32 v123, v123, v123
    v_mul_f32 v124, v122, v124
    v_mul_f32 v125, v122, v125
    v_cmpx_le_u32 vcc, 0x1000000, v69
    ds_add_f32 v123, v124 offset:54272
    ds_add_f32 v123, v125 offset:54276
    s_mov_b64 exec, -1
    v_ashrrev_i32 v122, 5, v70
    v_lshlrev_b16 v123, 2, v70
    v_cndmask_b32 v126, v44, v45, s[66:67]
    v_bitop3_b32 v122, v122, v113, v113 bitop3:0x0c
    v_lshlrev_b32 v124, 16, v126
    v_mul_f32 v122, v114, v122
    v_and_b32 v125, 0xffff0000, v126
    v_add_u32 v123, v123, v123
    v_mul_f32 v124, v122, v124
    v_mul_f32 v125, v122, v125
    v_cmpx_le_u32 vcc, 0x1000000, v70
    ds_add_f32 v123, v124 offset:54272
    ds_add_f32 v123, v125 offset:54276
    s_mov_b64 exec, -1
    v_ashrrev_i32 v122, 5, v71
    v_lshlrev_b16 v123, 2, v71
    v_cndmask_b32 v126, v46, v47, s[66:67]
    v_bitop3_b32 v122, v122, v113, v113 bitop3:0x0c
    v_lshlrev_b32 v124, 16, v126
    v_mul_f32 v122, v114, v122
    v_and_b32 v125, 0xffff0000, v126
    v_add_u32 v123, v123, v123
    v_mul_f32 v124, v122, v124
    v_mul_f32 v125, v122, v125
    v_cmpx_le_u32 vcc, 0x1000000, v71
    ds_add_f32 v123, v124 offset:54272
    ds_add_f32 v123, v125 offset:54276
    s_mov_b64 exec, -1
    s_waitcnt vmcnt(12)
    v_perm_b32 v69, v101, v98, s31
    v_perm_b32 v70, v101, v99, s32
    v_perm_b32 v71, v101, v100, s33
    v_lshlrev_b16 v46, 3, v100
    v_lshlrev_b16 v44, 3, v99
    v_lshlrev_b16 v42, 3, v98
    v_cmpx_ge_u16 vcc, 0x3fff, v69
    ds_read_b64 v[42:43], v42
    s_mov_b64 exec, -1
    v_cmpx_ge_u16 vcc, 0x3fff, v70
    ds_read_b64 v[44:45], v44
    s_mov_b64 exec, -1
    v_cmpx_ge_u16 vcc, 0x3fff, v71
    ds_read_b64 v[46:47], v46
    s_mov_b64 exec, -1
    s_waitcnt lgkmcnt(15)
    s_nop 2
    s_nop 1
    v_max_u32_dpp v108, v108, v108 row_shr:1 row_mask:0xf bank_mask:0xf bound_ctrl:0
    v_max_u32_dpp v109, v109, v109 row_shr:1 row_mask:0xf bank_mask:0xf bound_ctrl:0
    s_nop 0
    v_max_u32_dpp v108, v108, v108 row_shr:2 row_mask:0xf bank_mask:0xf bound_ctrl:0
    v_max_u32_dpp v109, v109, v109 row_shr:2 row_mask:0xf bank_mask:0xf bound_ctrl:0
    s_nop 0
    v_max_u32_dpp v108, v108, v108 row_shr:4 row_mask:0xf bank_mask:0xf bound_ctrl:0
    v_max_u32_dpp v109, v109, v109 row_shr:4 row_mask:0xf bank_mask:0xf bound_ctrl:0
    s_nop 0
    v_max_u32_dpp v108, v108, v108 row_shr:8 row_mask:0xf bank_mask:0xf bound_ctrl:0
    v_max_u32_dpp v109, v109, v109 row_shr:8 row_mask:0xf bank_mask:0xf bound_ctrl:0
    s_nop 0
    v_max_u32_dpp v108, v108, v108 row_bcast:15 row_mask:0xa bank_mask:0xf
    v_max_u32_dpp v109, v109, v109 row_bcast:15 row_mask:0xa bank_mask:0xf
    s_nop 0
    v_max_u32_dpp v108, v108, v108 row_bcast:31 row_mask:0xc bank_mask:0xf
    v_max_u32_dpp v109, v109, v109 row_bcast:31 row_mask:0xc bank_mask:0xf
    s_nop 0
    s_nop 0
    v_max_u32 v108, s41, v108
    s_nop 0
    v_readlane_b32 s41, v108, 63
    v_add_u32 v108, v108, v112
    v_add_u32 v108, 4294961152, v108
    v_max_u32 v109, s41, v109
    s_nop 0
    v_readlane_b32 s41, v109, 63
    v_add_u32 v109, v109, v112
    v_add_u32 v109, 4294962176, v109
    v_bfe_u32 v94, v108, 14, 4
    v_lshrrev_b32 v95, 18, v108
    v_and_b32 v108, 16383, v108
    v_mad_u32_u24 v94, v94, s63, v95
    v_mad_u32_u24 v108, v94, s65, v108
    buffer_load_dwordx4 v[94:97], v108, s[68:71], 0 offen
    s_setprio 0
    s_waitcnt vmcnt(9)
    v_perm_b32 v48, v3, v0, s31
    v_perm_b32 v49, v3, v1, s32
    v_perm_b32 v50, v3, v2, s33
    v_lshlrev_b16 v4, 3, v2
    v_lshlrev_b16 v2, 3, v1
    v_lshlrev_b16 v0, 3, v0
    v_cmpx_ge_u16 vcc, 0x3fff, v48
    ds_read_b64 v[0:1], v0
    s_mov_b64 exec, -1
    v_cmpx_ge_u16 vcc, 0x3fff, v49
    ds_read_b64 v[2:3], v2
    s_mov_b64 exec, -1
    v_cmpx_ge_u16 vcc, 0x3fff, v50
    ds_read_b64 v[4:5], v4
    s_mov_b64 exec, -1
    s_waitcnt vmcnt(8)
    v_perm_b32 v51, v9, v6, s31
    v_perm_b32 v52, v9, v7, s32
    v_perm_b32 v53, v9, v8, s33
    v_lshlrev_b16 v10, 3, v8
    v_lshlrev_b16 v8, 3, v7
    v_lshlrev_b16 v6, 3, v6
    v_cmpx_ge_u16 vcc, 0x3fff, v51
    ds_read_b64 v[6:7], v6
    s_mov_b64 exec, -1
    v_cmpx_ge_u16 vcc, 0x3fff, v52
    ds_read_b64 v[8:9], v8
    s_mov_b64 exec, -1
    v_cmpx_ge_u16 vcc, 0x3fff, v53
    ds_read_b64 v[10:11], v10
    s_mov_b64 exec, -1
    s_waitcnt vmcnt(7)
    v_perm_b32 v54, v15, v12, s31
    v_perm_b32 v55, v15, v13, s32
    v_perm_b32 v56, v15, v14, s33
    v_lshlrev_b16 v16, 3, v14
    v_lshlrev_b16 v14, 3, v13
    v_lshlrev_b16 v12, 3, v12
    v_cmpx_ge_u16 vcc, 0x3fff, v54
    ds_read_b64 v[12:13], v12
    s_mov_b64 exec, -1
    v_cmpx_ge_u16 vcc, 0x3fff, v55
    ds_read_b64 v[14:15], v14
    s_mov_b64 exec, -1
    v_cmpx_ge_u16 vcc, 0x3fff, v56
    ds_read_b64 v[16:17], v16
    s_mov_b64 exec, -1
    s_waitcnt vmcnt(6)
    v_perm_b32 v57, v21, v18, s31
    v_perm_b32 v58, v21, v19, s32
    v_perm_b32 v59, v21, v20, s33
    v_lshlrev_b16 v22, 3, v20
    v_lshlrev_b16 v20, 3, v19
    v_lshlrev_b16 v18, 3, v18
    s_cmp_lt_u32 s16, 8
    s_cbranch_scc1 p2_g1r03
    v_cmpx_ge_u16 vcc, 0x3fff, v57
    ds_read_b64 v[18:19], v18
    s_mov_b64 exec, -1
    v_cmpx_ge_u16 vcc, 0x3fff, v58
    ds_read_b64 v[20:21], v20
    s_mov_b64 exec, -1
    v_cmpx_ge_u16 vcc, 0x3fff, v59
    ds_read_b64 v[22:23], v22
    s_mov_b64 exec, -1
p2_g1r03:
    s_waitcnt lgkmcnt(0)
    s_barrier
    s_waitcnt lgkmcnt(15)
    s_branch p2_tail
p2_drain1:
    v_cmpx_gt_i16 vcc, 0, v48
    ds_read_b64 v[0:1], v0
    s_mov_b64 exec, -1
    v_cmpx_gt_i16 vcc, 0, v49
    ds_read_b64 v[2:3], v2
    s_mov_b64 exec, -1
    v_cmpx_gt_i16 vcc, 0, v50
    ds_read_b64 v[4:5], v4
    s_mov_b64 exec, -1
    v_cmpx_gt_i16 vcc, 0, v51
    ds_read_b64 v[6:7], v6
    s_mov_b64 exec, -1
    v_cmpx_gt_i16 vcc, 0, v52
    ds_read_b64 v[8:9], v8
    s_mov_b64 exec, -1
    v_cmpx_gt_i16 vcc, 0, v53
    ds_read_b64 v[10:11], v10
    s_mov_b64 exec, -1
    v_cmpx_gt_i16 vcc, 0, v54
    ds_read_b64 v[12:13], v12
    s_mov_b64 exec, -1
    v_cmpx_gt_i16 vcc, 0, v55
    ds_read_b64 v[14:15], v14
    s_mov_b64 exec, -1
    v_cmpx_gt_i16 vcc, 0, v56
    ds_read_b64 v[16:17], v16
    s_mov_b64 exec, -1
    s_cmp_lt_u32 s15, 8
    s_cbranch_scc1 p2_gd1
    v_cmpx_gt_i16 vcc, 0, v57
    ds_read_b64 v[18:19], v18
    s_mov_b64 exec, -1
    v_cmpx_gt_i16 vcc, 0, v58
    ds_read_b64 v[20:21], v20
    s_mov_b64 exec, -1
    v_cmpx_gt_i16 vcc, 0, v59
    ds_read_b64 v[22:23], v22
    s_mov_b64 exec, -1
p2_gd1:
    v_cmpx_gt_i16 vcc, 0, v60
    ds_read_b64 v[24:25], v24
    s_mov_b64 exec, -1
    v_cmpx_gt_i16 vcc, 0, v61
    ds_read_b64 v[26:27], v26
    s_mov_b64 exec, -1
    v_cmpx_gt_i16 vcc, 0, v62
    ds_read_b64 v[28:29], v28
    s_mov_b64 exec, -1
    v_cmpx_gt_i16 vcc, 0, v63
    ds_read_b64 v[30:31], v30
    s_mov_b64 exec, -1
    v_cmpx_gt_i16 vcc, 0, v64
    ds_read_b64 v[32:33], v32
    s_mov_b64 exec, -1
    v_cmpx_gt_i16 vcc, 0, v65
    ds_read_b64 v[34:35], v34
    s_mov_b64 exec, -1
    v_cmpx_gt_i16 vcc, 0, v66
    ds_read_b64 v[36:37], v36
    s_mov_b64 exec, -1
    v_cmpx_gt_i16 vcc, 0, v67
    ds_read_b64 v[38:39], v38
    s_mov_b64 exec, -1
    v_cmpx_gt_i16 vcc, 0, v68
    ds_read_b64 v[40:41], v40
    s_mov_b64 exec, -1
    v_cmpx_gt_i16 vcc, 0, v69
    ds_read_b64 v[42:43], v42
    s_mov_b64 exec, -1
    v_cmpx_gt_i16 vcc, 0, v70
    ds_read_b64 v[44:45], v44
    s_mov_b64 exec, -1
    v_cmpx_gt_i16 vcc, 0, v71
    ds_read_b64 v[46:47], v46
    s_mov_b64 exec, -1
    s_waitcnt lgkmcnt(15)
    v_ashrrev_i32 v122, 5, v48
    v_lshlrev_b16 v123, 2, v48
    v_cndmask_b32 v126, v0, v1, s[66:67]
    v_bitop3_b32 v122, v122, v113, v113 bitop3:0x0c
    v_lshlrev_b32 v124, 16, v126
    v_mul_f32 v122, v114, v122
    v_and_b32 v125, 0xffff0000, v126
    v_add_u32 v123, v123, v123
    v_mul_f32 v124, v122, v124
    v_mul_f32 v125, v122, v125
    v_cmpx_le_u32 vcc, 0x1000000, v48
    ds_add_f32 v123, v124 offset:54272
    ds_add_f32 v123, v125 offset:54276
    s_mov_b64 exec, -1
    v_ashrrev_i32 v122, 5, v49
    v_lshlrev_b16 v123, 2, v49
    v_cndmask_b32 v126, v2, v3, s[66:67]
    v_bitop3_b32 v122, v122, v113, v113 bitop3:0x0c
    v_lshlrev_b32 v124, 16, v126
    v_mul_f32 v122, v114, v122
    v_and_b32 v125, 0xffff0000, v126
    v_add_u32 v123, v123, v123
    v_mul_f32 v124, v122, v124
    v_mul_f32 v125, v122, v125
    v_cmpx_le_u32 vcc, 0x1000000, v49
    ds_add_f32 v123, v124 offset:54272
    ds_add_f32 v123, v125 offset:54276
    s_mov_b64 exec, -1
    v_ashrrev_i32 v122, 5, v50
    v_lshlrev_b16 v123, 2, v50
    v_cndmask_b32 v126, v4, v5, s[66:67]
    v_bitop3_b32 v122, v122, v113, v113 bitop3:0x0c
    v_lshlrev_b32 v124, 16, v126
    v_mul_f32 v122, v114, v122
    v_and_b32 v125, 0xffff0000, v126
    v_add_u32 v123, v123, v123
    v_mul_f32 v124, v122, v124
    v_mul_f32 v125, v122, v125
    v_cmpx_le_u32 vcc, 0x1000000, v50
    ds_add_f32 v123, v124 offset:54272
    ds_add_f32 v123, v125 offset:54276
    s_mov_b64 exec, -1
    s_waitcnt lgkmcnt(15)
    v_ashrrev_i32 v122, 5, v51
    v_lshlrev_b16 v123, 2, v51
    v_cndmask_b32 v126, v6, v7, s[66:67]
    v_bitop3_b32 v122, v122, v113, v113 bitop3:0x0c
    v_lshlrev_b32 v124, 16, v126
    v_mul_f32 v122, v114, v122
    v_and_b32 v125, 0xffff0000, v126
    v_add_u32 v123, v123, v123
    v_mul_f32 v124, v122, v124
    v_mul_f32 v125, v122, v125
    v_cmpx_le_u32 vcc, 0x1000000, v51
    ds_add_f32 v123, v124 offset:54272
    ds_add_f32 v123, v125 offset:54276
    s_mov_b64 exec, -1
    v_ashrrev_i32 v122, 5, v52
    v_lshlrev_b16 v123, 2, v52
    v_cndmask_b32 v126, v8, v9, s[66:67]
    v_bitop3_b32 v122, v122, v113, v113 bitop3:0x0c
    v_lshlrev_b32 v124, 16, v126
    v_mul_f32 v122, v114, v122
    v_and_b32 v125, 0xffff0000, v126
    v_add_u32 v123, v123, v123
    v_mul_f32 v124, v122, v124
    v_mul_f32 v125, v122, v125
    v_cmpx_le_u32 vcc, 0x1000000, v52
    ds_add_f32 v123, v124 offset:54272
    ds_add_f32 v123, v125 offset:54276
    s_mov_b64 exec, -1
    v_ashrrev_i32 v122, 5, v53
    v_lshlrev_b16 v123, 2, v53
    v_cndmask_b32 v126, v10, v11, s[66:67]
    v_bitop3_b32 v122, v122, v113, v113 bitop3:0x0c
    v_lshlrev_b32 v124, 16, v126
    v_mul_f32 v122, v114, v122
    v_and_b32 v125, 0xffff0000, v126
    v_add_u32 v123, v123, v123
    v_mul_f32 v124, v122, v124
    v_mul_f32 v125, v122, v125
    v_cmpx_le_u32 vcc, 0x1000000, v53
    ds_add_f32 v123, v124 offset:54272
    ds_add_f32 v123, v125 offset:54276
    s_mov_b64 exec, -1
    s_waitcnt lgkmcnt(15)
    v_ashrrev_i32 v122, 5, v54
    v_lshlrev_b16 v123, 2, v54
    v_cndmask_b32 v126, v12, v13, s[66:67]
    v_bitop3_b32 v122, v122, v113, v113 bitop3:0x0c
    v_lshlrev_b32 v124, 16, v126
    v_mul_f32 v122, v114, v122
    v_and_b32 v125, 0xffff0000, v126
    v_add_u32 v123, v123, v123
    v_mul_f32 v124, v122, v124
    v_mul_f32 v125, v122, v125
    v_cmpx_le_u32 vcc, 0x1000000, v54
    ds_add_f32 v123, v124 offset:54272
    ds_add_f32 v123, v125 offset:54276
    s_mov_b64 exec, -1
    v_ashrrev_i32 v122, 5, v55
    v_lshlrev_b16 v123, 2, v55
    v_cndmask_b32 v126, v14, v15, s[66:67]
    v_bitop3_b32 v122, v122, v113, v113 bitop3:0x0c
    v_lshlrev_b32 v124, 16, v126
    v_mul_f32 v122, v114, v122
    v_and_b32 v125, 0xffff0000, v126
    v_add_u32 v123, v123, v123
    v_mul_f32 v124, v122, v124
    v_mul_f32 v125, v122, v125
    v_cmpx_le_u32 vcc, 0x1000000, v55
    ds_add_f32 v123, v124 offset:54272
    ds_add_f32 v123, v125 offset:54276
    s_mov_b64 exec, -1
    v_ashrrev_i32 v122, 5, v56
    v_lshlrev_b16 v123, 2, v56
    v_cndmask_b32 v126, v16, v17, s[66:67]
    v_bitop3_b32 v122, v122, v113, v113 bitop3:0x0c
    v_lshlrev_b32 v124, 16, v126
    v_mul_f32 v122, v114, v122
    v_and_b32 v125, 0xffff0000, v126
    v_add_u32 v123, v123, v123
    v_mul_f32 v124, v122, v124
    v_mul_f32 v125, v122, v125
    v_cmpx_le_u32 vcc, 0x1000000, v56
    ds_add_f32 v123, v124 offset:54272
    ds_add_f32 v123, v125 offset:54276
    s_mov_b64 exec, -1
    s_cmp_lt_u32 s15, 8
    s_cbranch_scc1 p2_nad1
    s_waitcnt lgkmcnt(15)
    v_ashrrev_i32 v122, 5, v57
    v_lshlrev_b16 v123, 2, v57
    v_cndmask_b32 v126, v18, v19, s[66:67]
    v_bitop3_b32 v122, v122, v113, v113 bitop3:0x0c
    v_lshlrev_b32 v124, 16, v126
    v_mul_f32 v122, v114, v122
    v_and_b32 v125, 0xffff0000, v126
    v_add_u32 v123, v123, v123
    v_mul_f32 v124, v122, v124
    v_mul_f32 v125, v122, v125
    v_cmpx_le_u32 vcc, 0x1000000, v57
    ds_add_f32 v123, v124 offset:54272
    ds_add_f32 v123, v125 offset:54276
    s_mov_b64 exec, -1
    v_ashrrev_i32 v122, 5, v58
    v_lshlrev_b16 v123, 2, v58
    v_cndmask_b32 v126, v20, v21, s[66:67]
    v_bitop3_b32 v122, v122, v113, v113 bitop3:0x0c
    v_lshlrev_b32 v124, 16, v126
    v_mul_f32 v122, v114, v122
    v_and_b32 v125, 0xffff0000, v126
    v_add_u32 v123, v123, v123
    v_mul_f32 v124, v122, v124
    v_mul_f32 v125, v122, v125
    v_cmpx_le_u32 vcc, 0x1000000, v58
    ds_add_f32 v123, v124 offset:54272
    ds_add_f32 v123, v125 offset:54276
    s_mov_b64 exec, -1
    v_ashrrev_i32 v122, 5, v59
    v_lshlrev_b16 v123, 2, v59
    v_cndmask_b32 v126, v22, v23, s[66:67]
    v_bitop3_b32 v122, v122, v113, v113 bitop3:0x0c
    v_lshlrev_b32 v124, 16, v126
    v_mul_f32 v122, v114, v122
    v_and_b32 v125, 0xffff0000, v126
    v_add_u32 v123, v123, v123
    v_mul_f32 v124, v122, v124
    v_mul_f32 v125, v122, v125
    v_cmpx_le_u32 vcc, 0x1000000, v59
    ds_add_f32 v123, v124 offset:54272
    ds_add_f32 v123, v125 offset:54276
    s_mov_b64 exec, -1
p2_nad1:
    s_waitcnt lgkmcnt(15)
    v_ashrrev_i32 v122, 5, v60
    v_lshlrev_b16 v123, 2, v60
    v_cndmask_b32 v126, v24, v25, s[66:67]
    v_bitop3_b32 v122, v122, v113, v113 bitop3:0x0c
    v_lshlrev_b32 v124, 16, v126
    v_mul_f32 v122, v114, v122
    v_and_b32 v125, 0xffff0000, v126
    v_add_u32 v123, v123, v123
    v_mul_f32 v124, v122, v124
    v_mul_f32 v125, v122, v125
    v_cmpx_le_u32 vcc, 0x1000000, v60
    ds_add_f32 v123, v124 offset:54272
    ds_add_f32 v123, v125 offset:54276
    s_mov_b64 exec, -1
    v_ashrrev_i32 v122, 5, v61
    v_lshlrev_b16 v123, 2, v61
    v_cndmask_b32 v126, v26, v27, s[66:67]
    v_bitop3_b32 v122, v122, v113, v113 bitop3:0x0c
    v_lshlrev_b32 v124, 16, v126
    v_mul_f32 v122, v114, v122
    v_and_b32 v125, 0xffff0000, v126
    v_add_u32 v123, v123, v123
    v_mul_f32 v124, v122, v124
    v_mul_f32 v125, v122, v125
    v_cmpx_le_u32 vcc, 0x1000000, v61
    ds_add_f32 v123, v124 offset:54272
    ds_add_f32 v123, v125 offset:54276
    s_mov_b64 exec, -1
    v_ashrrev_i32 v122, 5, v62
    v_lshlrev_b16 v123, 2, v62
    v_cndmask_b32 v126, v28, v29, s[66:67]
    v_bitop3_b32 v122, v122, v113, v113 bitop3:0x0c
    v_lshlrev_b32 v124, 16, v126
    v_mul_f32 v122, v114, v122
    v_and_b32 v125, 0xffff0000, v126
    v_add_u32 v123, v123, v123
    v_mul_f32 v124, v122, v124
    v_mul_f32 v125, v122, v125
    v_cmpx_le_u32 vcc, 0x1000000, v62
    ds_add_f32 v123, v124 offset:54272
    ds_add_f32 v123, v125 offset:54276
    s_mov_b64 exec, -1
    s_waitcnt lgkmcnt(15)
    v_ashrrev_i32 v122, 5, v63
    v_lshlrev_b16 v123, 2, v63
    v_cndmask_b32 v126, v30, v31, s[66:67]
    v_bitop3_b32 v122, v122, v113, v113 bitop3:0x0c
    v_lshlrev_b32 v124, 16, v126
    v_mul_f32 v122, v114, v122
    v_and_b32 v125, 0xffff0000, v126
    v_add_u32 v123, v123, v123
    v_mul_f32 v124, v122, v124
    v_mul_f32 v125, v122, v125
    v_cmpx_le_u32 vcc, 0x1000000, v63
    ds_add_f32 v123, v124 offset:54272
    ds_add_f32 v123, v125 offset:54276
    s_mov_b64 exec, -1
    v_ashrrev_i32 v122, 5, v64
    v_lshlrev_b16 v123, 2, v64
    v_cndmask_b32 v126, v32, v33, s[66:67]
    v_bitop3_b32 v122, v122, v113, v113 bitop3:0x0c
    v_lshlrev_b32 v124, 16, v126
    v_mul_f32 v122, v114, v122
    v_and_b32 v125, 0xffff0000, v126
    v_add_u32 v123, v123, v123
    v_mul_f32 v124, v122, v124
    v_mul_f32 v125, v122, v125
    v_cmpx_le_u32 vcc, 0x1000000, v64
    ds_add_f32 v123, v124 offset:54272
    ds_add_f32 v123, v125 offset:54276
    s_mov_b64 exec, -1
    v_ashrrev_i32 v122, 5, v65
    v_lshlrev_b16 v123, 2, v65
    v_cndmask_b32 v126, v34, v35, s[66:67]
    v_bitop3_b32 v122, v122, v113, v113 bitop3:0x0c
    v_lshlrev_b32 v124, 16, v126
    v_mul_f32 v122, v114, v122
    v_and_b32 v125, 0xffff0000, v126
    v_add_u32 v123, v123, v123
    v_mul_f32 v124, v122, v124
    v_mul_f32 v125, v122, v125
    v_cmpx_le_u32 vcc, 0x1000000, v65
    ds_add_f32 v123, v124 offset:54272
    ds_add_f32 v123, v125 offset:54276
    s_mov_b64 exec, -1
    s_waitcnt lgkmcnt(15)
    v_ashrrev_i32 v122, 5, v66
    v_lshlrev_b16 v123, 2, v66
    v_cndmask_b32 v126, v36, v37, s[66:67]
    v_bitop3_b32 v122, v122, v113, v113 bitop3:0x0c
    v_lshlrev_b32 v124, 16, v126
    v_mul_f32 v122, v114, v122
    v_and_b32 v125, 0xffff0000, v126
    v_add_u32 v123, v123, v123
    v_mul_f32 v124, v122, v124
    v_mul_f32 v125, v122, v125
    v_cmpx_le_u32 vcc, 0x1000000, v66
    ds_add_f32 v123, v124 offset:54272
    ds_add_f32 v123, v125 offset:54276
    s_mov_b64 exec, -1
    v_ashrrev_i32 v122, 5, v67
    v_lshlrev_b16 v123, 2, v67
    v_cndmask_b32 v126, v38, v39, s[66:67]
    v_bitop3_b32 v122, v122, v113, v113 bitop3:0x0c
    v_lshlrev_b32 v124, 16, v126
    v_mul_f32 v122, v114, v122
    v_and_b32 v125, 0xffff0000, v126
    v_add_u32 v123, v123, v123
    v_mul_f32 v124, v122, v124
    v_mul_f32 v125, v122, v125
    v_cmpx_le_u32 vcc, 0x1000000, v67
    ds_add_f32 v123, v124 offset:54272
    ds_add_f32 v123, v125 offset:54276
    s_mov_b64 exec, -1
    v_ashrrev_i32 v122, 5, v68
    v_lshlrev_b16 v123, 2, v68
    v_cndmask_b32 v126, v40, v41, s[66:67]
    v_bitop3_b32 v122, v122, v113, v113 bitop3:0x0c
    v_lshlrev_b32 v124, 16, v126
    v_mul_f32 v122, v114, v122
    v_and_b32 v125, 0xffff0000, v126
    v_add_u32 v123, v123, v123
    v_mul_f32 v124, v122, v124
    v_mul_f32 v125, v122, v125
    v_cmpx_le_u32 vcc, 0x1000000, v68
    ds_add_f32 v123, v124 offset:54272
    ds_add_f32 v123, v125 offset:54276
    s_mov_b64 exec, -1
    s_waitcnt lgkmcnt(15)
    v_ashrrev_i32 v122, 5, v69
    v_lshlrev_b16 v123, 2, v69
    v_cndmask_b32 v126, v42, v43, s[66:67]
    v_bitop3_b32 v122, v122, v113, v113 bitop3:0x0c
    v_lshlrev_b32 v124, 16, v126
    v_mul_f32 v122, v114, v122
    v_and_b32 v125, 0xffff0000, v126
    v_add_u32 v123, v123, v123
    v_mul_f32 v124, v122, v124
    v_mul_f32 v125, v122, v125
    v_cmpx_le_u32 vcc, 0x1000000, v69
    ds_add_f32 v123, v124 offset:54272
    ds_add_f32 v123, v125 offset:54276
    s_mov_b64 exec, -1
    v_ashrrev_i32 v122, 5, v70
    v_lshlrev_b16 v123, 2, v70
    v_cndmask_b32 v126, v44, v45, s[66:67]
    v_bitop3_b32 v122, v122, v113, v113 bitop3:0x0c
    v_lshlrev_b32 v124, 16, v126
    v_mul_f32 v122, v114, v122
    v_and_b32 v125, 0xffff0000, v126
    v_add_u32 v123, v123, v123
    v_mul_f32 v124, v122, v124
    v_mul_f32 v125, v122, v125
    v_cmpx_le_u32 vcc, 0x1000000, v70
    ds_add_f32 v123, v124 offset:54272
    ds_add_f32 v123, v125 offset:54276
    s_mov_b64 exec, -1
    v_ashrrev_i32 v122, 5, v71
    v_lshlrev_b16 v123, 2, v71
    v_cndmask_b32 v126, v46, v47, s[66:67]
    v_bitop3_b32 v122, v122, v113, v113 bitop3:0x0c
    v_lshlrev_b32 v124, 16, v126
    v_mul_f32 v122, v114, v122
    v_and_b32 v125, 0xffff0000, v126
    v_add_u32 v123, v123, v123
    v_mul_f32 v124, v122, v124
    v_mul_f32 v125, v122, v125
    v_cmpx_le_u32 vcc, 0x1000000, v71
    ds_add_f32 v123, v124 offset:54272
    ds_add_f32 v123, v125 offset:54276
    s_mov_b64 exec, -1
    s_branch p2_fin
p2_tail:
    s_mov_b32 s60, s61
    s_mov_b32 s15, s16
    s_mov_b32 s16, s17
    v_mov_b32 v122, s19
    s_xor_b32 s19, s19, 4
    ds_read_b32 v125, v122 offset:53760
    v_mov_b32 v123, s19
    v_mov_b32 v124, 0
    ds_write_b32 v123, v124 offset:53760
    s_waitcnt vmcnt(2)
    s_mov_b32 m0, s24
    s_cmp_ge_u32 s10, 9
    s_cbranch_scc1 p2_st2s1
    ds_write_addtid_b32 v84 offset:49152
    ds_write_addtid_b32 v85 offset:49408
p2_st2s1:
    s_mov_b32 m0, s23
    s_add_u32 s20, s20, 53760
    ds_write_addtid_b32 v72 offset:0
    ds_write_addtid_b32 v73 offset:256
    ds_write_addtid_b32 v74 offset:512
    ds_write_addtid_b32 v75 offset:768
    ds_write_addtid_b32 v76 offset:1024
    ds_write_addtid_b32 v77 offset:1280
    ds_write_addtid_b32 v78 offset:1536
    ds_write_addtid_b32 v79 offset:1792
    ds_write_addtid_b32 v80 offset:2048
    ds_write_addtid_b32 v81 offset:2304
    ds_write_addtid_b32 v82 offset:2560
    ds_write_addtid_b32 v83 offset:2816
    s_cmp_ge_u32 s10, 9
    s_cbranch_scc1 p2_nm2m2a
    v_lshrrev_b32 v84, 1, v112
    s_add_u32 s44, s20, s42
    buffer_load_dwordx2 v[84:85], v84, s[4:7], s44 offen
p2_nm2m2a:
    buffer_load_dwordx4 v[72:75], v112, s[4:7], s20 offen offset:0
    buffer_load_dwordx4 v[76:79], v112, s[4:7], s20 offen offset:1024
    buffer_load_dwordx4 v[80:83], v112, s[4:7], s20 offen offset:2048
    s_waitcnt lgkmcnt(0)
    s_barrier
    s_setprio 3
    v_cmpx_lt_i16 vcc, 0x3fff, v48
    ds_read_b64 v[0:1], v0
    s_mov_b64 exec, -1
    v_cmpx_lt_i16 vcc, 0x3fff, v49
    ds_read_b64 v[2:3], v2
    s_mov_b64 exec, -1
    v_cmpx_lt_i16 vcc, 0x3fff, v50
    ds_read_b64 v[4:5], v4
    s_mov_b64 exec, -1
    v_cmpx_lt_i16 vcc, 0x3fff, v51
    ds_read_b64 v[6:7], v6
    s_mov_b64 exec, -1
    v_cmpx_lt_i16 vcc, 0x3fff, v52
    ds_read_b64 v[8:9], v8
    s_mov_b64 exec, -1
    v_cmpx_lt_i16 vcc, 0x3fff, v53
    ds_read_b64 v[10:11], v10
    s_mov_b64 exec, -1
    s_waitcnt lgkmcnt(15)
    s_nop 1
    v_readfirstlane_b32 s44, v125
    s_nop 0
    s_cmp_lg_u32 s44, 0
    s_cbranch_scc1 p2_advb
    s_add_u32 s61, s61, 1
    s_min_u32 s61, s61, 10
    v_mov_b32 v110, 0
    v_mov_b32 v111, 0
    s_cmp_eq_u32 s61, 10
    s_cbranch_scc1 p2_advb
    s_add_u32 s44, s61, s18
    s_cmp_ge_u32 s44, 10
    s_cselect_b32 s53, 10, 0
    s_sub_u32 s44, s44, s53
    s_mul_i32 s44, s44, 4160
    s_add_u32 s44, s44, s40
    v_bfe_i32 v111, v112, 6, 1
    v_lshrrev_b32 v110, 6, v112
    v_bitop3_b32 v111, v111, 15, s10 bitop3:0x6a
    v_lshl_or_b32 v110, v110, 4, v111
    v_add_u32 v111, 72, v110
    v_and_b32 v111, 0x100, v111
    v_lshl_or_b32 v110, v111, 7, v110
    v_bfe_u32 v111, v112, 2, 4
    v_mul_u32_u24 v110, 41600, v110
    v_add_u32 v111, v110, v111
    buffer_load_dword v110, v111, s[4:7], s44 offen
    buffer_load_dword v111, v111, s[4:7], s44 offen offset:16
p2_advb:
    s_cmp_lg_u32 s10, 15
    s_cbranch_scc1 p2_ntg
    s_lshr_b32 s44, s2, 3
    s_mul_i32 s44, s44, 5120
    s_add_u32 s45, s60, s18
    s_cmp_ge_u32 s45, 10
    s_cselect_b32 s53, 10, 0
    s_sub_u32 s45, s45, s53
    s_mul_i32 s45, s45, 645120
    s_add_u32 s44, s44, s45
    s_add_u32 s44, s44, s62
    s_sub_u32 s44, s44, s23
    v_lshlrev_b32 v84, 3, v112
    s_mov_b32 exec_hi, 0xff
    buffer_load_dword v85, v84, s[4:7], s44 offen
    s_mov_b64 exec, -1
p2_ntg:
    v_cmpx_lt_i16 vcc, 0x3fff, v54
    ds_read_b64 v[12:13], v12
    s_mov_b64 exec, -1
    v_cmpx_lt_i16 vcc, 0x3fff, v55
    ds_read_b64 v[14:15], v14
    s_mov_b64 exec, -1
    v_cmpx_lt_i16 vcc, 0x3fff, v56
    ds_read_b64 v[16:17], v16
    s_mov_b64 exec, -1
    s_cmp_lt_u32 s15, 8
    s_cbranch_scc1 p2_g2r13
    v_cmpx_lt_i16 vcc, 0x3fff, v57
    ds_read_b64 v[18:19], v18
    s_mov_b64 exec, -1
    v_cmpx_lt_i16 vcc, 0x3fff, v58
    ds_read_b64 v[20:21], v20
    s_mov_b64 exec, -1
    v_cmpx_lt_i16 vcc, 0x3fff, v59
    ds_read_b64 v[22:23], v22
    s_mov_b64 exec, -1
p2_g2r13:
    v_bfe_u32 v98, v109, 14, 4
    v_lshrrev_b32 v99, 18, v109
    v_and_b32 v109, 16383, v109
    v_mad_u32_u24 v98, v98, s63, v99
    v_mad_u32_u24 v109, v98, s65, v109
    buffer_load_dwordx4 v[98:101], v109, s[68:71], 0 offen
    s_setprio 1
    v_cmpx_lt_i16 vcc, 0x3fff, v60
    ds_read_b64 v[24:25], v24
    s_mov_b64 exec, -1
    v_cmpx_lt_i16 vcc, 0x3fff, v61
    ds_read_b64 v[26:27], v26
    s_mov_b64 exec, -1
    v_cmpx_lt_i16 vcc, 0x3fff, v62
    ds_read_b64 v[28:29], v28
    s_mov_b64 exec, -1
    v_cmpx_lt_i16 vcc, 0x3fff, v63
    ds_read_b64 v[30:31], v30
    s_mov_b64 exec, -1
    v_cmpx_lt_i16 vcc, 0x3fff, v64
    ds_read_b64 v[32:33], v32
    s_mov_b64 exec, -1
    v_cmpx_lt_i16 vcc, 0x3fff, v65
    ds_read_b64 v[34:35], v34
    s_mov_b64 exec, -1
    s_nop 2
    s_nop 1
    v_max_u32_dpp v102, v102, v102 row_shr:1 row_mask:0xf bank_mask:0xf bound_ctrl:0
    v_max_u32_dpp v103, v103, v103 row_shr:1 row_mask:0xf bank_mask:0xf bound_ctrl:0
    s_nop 0
    v_max_u32_dpp v102, v102, v102 row_shr:2 row_mask:0xf bank_mask:0xf bound_ctrl:0
    v_max_u32_dpp v103, v103, v103 row_shr:2 row_mask:0xf bank_mask:0xf bound_ctrl:0
    s_nop 0
    v_max_u32_dpp v102, v102, v102 row_shr:4 row_mask:0xf bank_mask:0xf bound_ctrl:0
    v_max_u32_dpp v103, v103, v103 row_shr:4 row_mask:0xf bank_mask:0xf bound_ctrl:0
    s_nop 0
    v_max_u32_dpp v102, v102, v102 row_shr:8 row_mask:0xf bank_mask:0xf bound_ctrl:0
    v_max_u32_dpp v103, v103, v103 row_shr:8 row_mask:0xf bank_mask:0xf bound_ctrl:0
    s_nop 0
    v_max_u32_dpp v102, v102, v102 row_bcast:15 row_mask:0xa bank_mask:0xf
    v_max_u32_dpp v103, v103, v103 row_bcast:15 row_mask:0xa bank_mask:0xf
    s_nop 0
    v_max_u32_dpp v102, v102, v102 row_bcast:31 row_mask:0xc bank_mask:0xf
    v_max_u32_dpp v103, v103, v103 row_bcast:31 row_mask:0xc bank_mask:0xf
    s_nop 0
    s_nop 0
    v_max_u32 v102, s41, v102
    s_nop 0
    v_readlane_b32 s41, v102, 63
    v_add_u32 v102, v102, v112
    v_add_u32 v102, 4294963200, v102
    v_max_u32 v103, s41, v103
    s_nop 0
    v_readlane_b32 s41, v103, 63
    v_add_u32 v103, v103, v112
    v_add_u32 v103, 4294964224, v103
    v_cmpx_lt_i16 vcc, 0x3fff, v66
    ds_read_b64 v[36:37], v36
    s_mov_b64 exec, -1
    v_cmpx_lt_i16 vcc, 0x3fff, v67
    ds_read_b64 v[38:39], v38
    s_mov_b64 exec, -1
    v_cmpx_lt_i16 vcc, 0x3fff, v68
    ds_read_b64 v[40:41], v40
    s_mov_b64 exec, -1
    v_cmpx_lt_i16 vcc, 0x3fff, v69
    ds_read_b64 v[42:43], v42
    s_mov_b64 exec, -1
    v_cmpx_lt_i16 vcc, 0x3fff, v70
    ds_read_b64 v[44:45], v44
    s_mov_b64 exec, -1
    v_cmpx_lt_i16 vcc, 0x3fff, v71
    ds_read_b64 v[46:47], v46
    s_mov_b64 exec, -1
    s_waitcnt lgkmcnt(0)
    s_barrier
    s_waitcnt vmcnt(1)
    s_mov_b32 m0, s24
    s_cmp_ge_u32 s10, 9
    s_cbranch_scc1 p2_st2s2
    ds_write_addtid_b32 v84 offset:49152
    ds_write_addtid_b32 v85 offset:49408
p2_st2s2:
    s_mov_b32 m0, s23
    s_add_u32 s20, s60, s18
    s_cmp_ge_u32 s20, 10
    s_cselect_b32 s53, 10, 0
    s_sub_u32 s20, s20, s53
    s_mul_i32 s20, s20, 645120
    s_add_u32 s20, s20, s62
    ds_write_addtid_b32 v72 offset:0
    ds_write_addtid_b32 v73 offset:256
    ds_write_addtid_b32 v74 offset:512
    ds_write_addtid_b32 v75 offset:768
    ds_write_addtid_b32 v76 offset:1024
    ds_write_addtid_b32 v77 offset:1280
    ds_write_addtid_b32 v78 offset:1536
    ds_write_addtid_b32 v79 offset:1792
    ds_write_addtid_b32 v80 offset:2048
    ds_write_addtid_b32 v81 offset:2304
    ds_write_addtid_b32 v82 offset:2560
    ds_write_addtid_b32 v83 offset:2816
    s_nop 2
    s_nop 1
    v_max_u32_dpp v104, v104, v104 row_shr:1 row_mask:0xf bank_mask:0xf bound_ctrl:0
    v_max_u32_dpp v105, v105, v105 row_shr:1 row_mask:0xf bank_mask:0xf bound_ctrl:0
    s_nop 0
    v_max_u32_dpp v104, v104, v104 row_shr:2 row_mask:0xf bank_mask:0xf bound_ctrl:0
    v_max_u32_dpp v105, v105, v105 row_shr:2 row_mask:0xf bank_mask:0xf bound_ctrl:0
    s_nop 0
    v_max_u32_dpp v104, v104, v104 row_shr:4 row_mask:0xf bank_mask:0xf bound_ctrl:0
    v_max_u32_dpp v105, v105, v105 row_shr:4 row_mask:0xf bank_mask:0xf bound_ctrl:0
    s_nop 0
    v_max_u32_dpp v104, v104, v104 row_shr:8 row_mask:0xf bank_mask:0xf bound_ctrl:0
    v_max_u32_dpp v105, v105, v105 row_shr:8 row_mask:0xf bank_mask:0xf bound_ctrl:0
    s_nop 0
    v_max_u32_dpp v104, v104, v104 row_bcast:15 row_mask:0xa bank_mask:0xf
    v_max_u32_dpp v105, v105, v105 row_bcast:15 row_mask:0xa bank_mask:0xf
    s_nop 0
    v_max_u32_dpp v104, v104, v104 row_bcast:31 row_mask:0xc bank_mask:0xf
    v_max_u32_dpp v105, v105, v105 row_bcast:31 row_mask:0xc bank_mask:0xf
    s_nop 0
    s_nop 0
    v_max_u32 v104, s41, v104
    s_nop 0
    v_readlane_b32 s41, v104, 63
    v_add_u32 v104, v104, v112
    v_add_u32 v104, 4294965248, v104
    v_max_u32 v105, s41, v105
    s_nop 0
    v_readlane_b32 s41, v105, 63
    v_add_u32 v105, v105, v112
    v_add_u32 v105, 4294966272, v105
    s_waitcnt lgkmcnt(0)
    s_barrier
    s_branch p2_top
p2_fin:
    s_waitcnt vmcnt(0) lgkmcnt(0)
    s_barrier
    s_mov_b32 s48, s11
    s_mul_i32 s44, s48, 800768
    s_mul_i32 s45, s12, 12512
    s_add_u32 s49, s44, s45
    s_lshl_b32 s44, s49, 3
    s_add_u32 s44, s44, 491593728
    s_lshl_b32 s48, s48, 2
    s_lshl_b32 s45, s12, 4
    s_add_u32 s48, s48, s45
    s_add_u32 s48, s48, 491592704
    v_add_u32 v123, s64, v112
    v_add_u32 v122, s25, v123
    v_mov_b32 v24, 0
    v_mov_b32 v25, 0
    v_mov_b32 v26, 0
    v_mov_b32 v27, 0
    v_cmp_gt_u32 vcc, 1792, v123
    v_mov_b32 v124, 0x38000000
    v_mov_b32 v126, 0
    v_cndmask_b32 v124, v124, v123, vcc
    ds_read_b128 v[0:3], v122 offset:0
    ds_read_b128 v[4:7], v122 offset:16384
    ds_read_b128 v[8:11], v122 offset:32768
    v_add_u32 v122, 49152, v122
    ds_read_b128 v[12:15], v122 offset:0
    ds_read_b128 v[16:19], v122 offset:16384
    ds_read_b128 v[20:23], v122 offset:32768
    s_mov_b64 exec, vcc
    ds_read_b128 v[24:27], v122 offset:49152
    s_mov_b64 exec, -1
    s_cmp_lg_u32 s21, 0
    s_cbranch_scc1 p2_finf
    s_waitcnt lgkmcnt(6)
    buffer_store_dwordx4 v[0:3], v123, s[4:7], s44 offen nt
    s_add_u32 s44, s44, 16384
    s_waitcnt lgkmcnt(5)
    buffer_store_dwordx4 v[4:7], v123, s[4:7], s44 offen nt
    s_add_u32 s44, s44, 16384
    s_waitcnt lgkmcnt(4)
    buffer_store_dwordx4 v[8:11], v123, s[4:7], s44 offen nt
    s_add_u32 s44, s44, 16384
    s_waitcnt lgkmcnt(3)
    buffer_store_dwordx4 v[12:15], v123, s[4:7], s44 offen nt
    s_add_u32 s44, s44, 16384
    s_waitcnt lgkmcnt(2)
    buffer_store_dwordx4 v[16:19], v123, s[4:7], s44 offen nt
    s_add_u32 s44, s44, 16384
    s_waitcnt lgkmcnt(1)
    buffer_store_dwordx4 v[20:23], v123, s[4:7], s44 offen nt
    s_add_u32 s44, s44, 16384
    s_waitcnt lgkmcnt(0)
    buffer_store_dwordx4 v[24:27], v124, s[4:7], s44 offen nt
    s_add_u32 s44, s44, 16384
    v_bitop3_b32 v115, v115, v0, v1 bitop3:0xfe
    v_bitop3_b32 v115, v115, v2, v3 bitop3:0xfe
    v_bitop3_b32 v115, v115, v4, v5 bitop3:0xfe
    v_bitop3_b32 v115, v115, v6, v7 bitop3:0xfe
    v_bitop3_b32 v115, v115, v8, v9 bitop3:0xfe
    v_bitop3_b32 v115, v115, v10, v11 bitop3:0xfe
    v_bitop3_b32 v115, v115, v12, v13 bitop3:0xfe
    v_bitop3_b32 v115, v115, v14, v15 bitop3:0xfe
    v_bitop3_b32 v115, v115, v16, v17 bitop3:0xfe
    v_bitop3_b32 v115, v115, v18, v19 bitop3:0xfe
    v_bitop3_b32 v115, v115, v20, v21 bitop3:0xfe
    v_bitop3_b32 v115, v115, v22, v23 bitop3:0xfe
    v_bitop3_b32 v115, v115, v24, v25 bitop3:0xfe
    v_bitop3_b32 v115, v115, v26, v27 bitop3:0xfe
    v_bitop3_b32 v115, v115, v116, v117 bitop3:0xfe
    v_bitop3_b32 v115, v115, v118, v119 bitop3:0xfe
    v_bitop3_b32 v115, v115, v120, v121 bitop3:0xfe
    v_mov_b32 v28, 0
    v_mov_b32 v29, 0
    v_lshrrev_b32 v30, 1, v0
    v_bitop3_b32 v28, v28, v0, v30 bitop3:0xf6
    v_lshrrev_b32 v31, 1, v1
    v_bitop3_b32 v29, v29, v1, v31 bitop3:0xf6
    v_lshrrev_b32 v30, 1, v2
    v_bitop3_b32 v28, v28, v2, v30 bitop3:0xf6
    v_lshrrev_b32 v31, 1, v3
    v_bitop3_b32 v29, v29, v3, v31 bitop3:0xf6
    v_lshrrev_b32 v30, 1, v4
    v_bitop3_b32 v28, v28, v4, v30 bitop3:0xf6
    v_lshrrev_b32 v31, 1, v5
    v_bitop3_b32 v29, v29, v5, v31 bitop3:0xf6
    v_lshrrev_b32 v30, 1, v6
    v_bitop3_b32 v28, v28, v6, v30 bitop3:0xf6
    v_lshrrev_b32 v31, 1, v7
    v_bitop3_b32 v29, v29, v7, v31 bitop3:0xf6
    v_lshrrev_b32 v30, 1, v8
    v_bitop3_b32 v28, v28, v8, v30 bitop3:0xf6
    v_lshrrev_b32 v31, 1, v9
    v_bitop3_b32 v29, v29, v9, v31 bitop3:0xf6
    v_lshrrev_b32 v30, 1, v10
    v_bitop3_b32 v28, v28, v10, v30 bitop3:0xf6
    v_lshrrev_b32 v31, 1, v11
    v_bitop3_b32 v29, v29, v11, v31 bitop3:0xf6
    v_lshrrev_b32 v30, 1, v12
    v_bitop3_b32 v28, v28, v12, v30 bitop3:0xf6
    v_lshrrev_b32 v31, 1, v13
    v_bitop3_b32 v29, v29, v13, v31 bitop3:0xf6
    v_lshrrev_b32 v30, 1, v14
    v_bitop3_b32 v28, v28, v14, v30 bitop3:0xf6
    v_lshrrev_b32 v31, 1, v15
    v_bitop3_b32 v29, v29, v15, v31 bitop3:0xf6
    v_lshrrev_b32 v30, 1, v16
    v_bitop3_b32 v28, v28, v16, v30 bitop3:0xf6
    v_lshrrev_b32 v31, 1, v17
    v_bitop3_b32 v29, v29, v17, v31 bitop3:0xf6
    v_lshrrev_b32 v30, 1, v18
    v_bitop3_b32 v28, v28, v18, v30 bitop3:0xf6
    v_lshrrev_b32 v31, 1, v19
    v_bitop3_b32 v29, v29, v19, v31 bitop3:0xf6
    v_lshrrev_b32 v30, 1, v20
    v_bitop3_b32 v28, v28, v20, v30 bitop3:0xf6
    v_lshrrev_b32 v31, 1, v21
    v_bitop3_b32 v29, v29, v21, v31 bitop3:0xf6
    v_lshrrev_b32 v30, 1, v22
    v_bitop3_b32 v28, v28, v22, v30 bitop3:0xf6
    v_lshrrev_b32 v31, 1, v23
    v_bitop3_b32 v29, v29, v23, v31 bitop3:0xf6
    v_lshrrev_b32 v30, 1, v24
    v_bitop3_b32 v28, v28, v24, v30 bitop3:0xf6
    v_lshrrev_b32 v31, 1, v25
    v_bitop3_b32 v29, v29, v25, v31 bitop3:0xf6
    v_lshrrev_b32 v30, 1, v26
    v_bitop3_b32 v28, v28, v26, v30 bitop3:0xf6
    v_lshrrev_b32 v31, 1, v27
    v_bitop3_b32 v29, v29, v27, v31 bitop3:0xf6
    s_mov_b32 s45, 0
    v_and_b32 v30, 7168, v28
    v_cmp_ne_u32 vcc, 0, v30
    s_nop 0
    s_cmp_lg_u64 vcc, 0
    s_cselect_b32 s46, 1, 0
    s_or_b32 s45, s45, s46
    v_and_b32 v30, 469762048, v28
    v_cmp_ne_u32 vcc, 0, v30
    s_nop 0
    s_cmp_lg_u64 vcc, 0
    s_cselect_b32 s46, 2, 0
    s_or_b32 s45, s45, s46
    v_and_b32 v30, 7168, v29
    v_cmp_ne_u32 vcc, 0, v30
    s_nop 0
    s_cmp_lg_u64 vcc, 0
    s_cselect_b32 s46, 4, 0
    s_or_b32 s45, s45, s46
    v_and_b32 v30, 469762048, v29
    v_cmp_ne_u32 vcc, 0, v30
    s_nop 0
    s_cmp_lg_u64 vcc, 0
    s_cselect_b32 s46, 8, 0
    s_or_b32 s45, s45, s46
    v_and_b32 v30, 2147516416, v115
    v_cmp_ne_u32 vcc, 0, v30
    s_nop 0
    s_cmp_lg_u64 vcc, 0
    s_cselect_b32 s46, 16, 0
    s_or_b32 s45, s45, s46
    v_mov_b32 v30, s45
    s_mov_b64 exec, 1
    ds_or_b32 v126, v30 offset:53768
    s_mov_b64 exec, -1
    s_waitcnt lgkmcnt(0)
    s_barrier
    ds_read_b32 v125, v126 offset:53768
    s_waitcnt lgkmcnt(0)
    v_readfirstlane_b32 s45, v125
    s_nop 0
    s_cmp_eq_u32 s45, 15
    s_cbranch_scc1 p2_done
    s_mov_b32 s21, 1
    s_waitcnt vmcnt(0)
    s_branch p2_restart
p2_finf:
    s_lshl_b32 s49, s49, 4
    s_lshl_b32 s45, s21, 3
    s_add_u32 s49, s49, s45
    s_add_u32 s49, s49, 517218296
    v_mov_b32 v28, 1073758208
    v_mov_b32 v29, 1073758208
    v_mov_b32 v30, 1073758208
    v_mov_b32 v31, 1073758208
    v_lshlrev_b32 v122, 1, v123
    v_lshlrev_b32 v125, 1, v124
    s_waitcnt lgkmcnt(0)
    buffer_store_dwordx4 v[28:31], v123, s[4:7], s44 offen sc1
    s_add_u32 s44, s44, 16384
    buffer_store_dwordx2 v[0:1], v122, s[4:7], s49 offen offset:0 sc1
    buffer_store_dwordx2 v[2:3], v122, s[4:7], s49 offen offset:16 sc1
    s_add_u32 s49, s49, 32768
    buffer_store_dwordx4 v[28:31], v123, s[4:7], s44 offen sc1
    s_add_u32 s44, s44, 16384
    buffer_store_dwordx2 v[4:5], v122, s[4:7], s49 offen offset:0 sc1
    buffer_store_dwordx2 v[6:7], v122, s[4:7], s49 offen offset:16 sc1
    s_add_u32 s49, s49, 32768
    buffer_store_dwordx4 v[28:31], v123, s[4:7], s44 offen sc1
    s_add_u32 s44, s44, 16384
    buffer_store_dwordx2 v[8:9], v122, s[4:7], s49 offen offset:0 sc1
    buffer_store_dwordx2 v[10:11], v122, s[4:7], s49 offen offset:16 sc1
    s_add_u32 s49, s49, 32768
    buffer_store_dwordx4 v[28:31], v123, s[4:7], s44 offen sc1
    s_add_u32 s44, s44, 16384
    buffer_store_dwordx2 v[12:13], v122, s[4:7], s49 offen offset:0 sc1
    buffer_store_dwordx2 v[14:15], v122, s[4:7], s49 offen offset:16 sc1
    s_add_u32 s49, s49, 32768
    buffer_store_dwordx4 v[28:31], v123, s[4:7], s44 offen sc1
    s_add_u32 s44, s44, 16384
    buffer_store_dwordx2 v[16:17], v122, s[4:7], s49 offen offset:0 sc1
    buffer_store_dwordx2 v[18:19], v122, s[4:7], s49 offen offset:16 sc1
    s_add_u32 s49, s49, 32768
    buffer_store_dwordx4 v[28:31], v123, s[4:7], s44 offen sc1
    s_add_u32 s44, s44, 16384
    buffer_store_dwordx2 v[20:21], v122, s[4:7], s49 offen offset:0 sc1
    buffer_store_dwordx2 v[22:23], v122, s[4:7], s49 offen offset:16 sc1
    s_add_u32 s49, s49, 32768
    buffer_store_dwordx4 v[28:31], v124, s[4:7], s44 offen sc1
    s_add_u32 s44, s44, 16384
    buffer_store_dwordx2 v[24:25], v125, s[4:7], s49 offen offset:0 sc1
    buffer_store_dwordx2 v[26:27], v125, s[4:7], s49 offen offset:16 sc1
    s_add_u32 s49, s49, 32768
    s_add_u32 s21, s21, 1
    s_mov_b32 s30, 0
    s_waitcnt vmcnt(0)
    s_cmp_eq_u32 s21, 2
    s_cbranch_scc1 p2_restart
p2_done:
    v_mov_b32 v125, s30
    s_cmp_lg_u32 s10, 0
    s_cbranch_scc1 p2_inv
    s_mov_b64 exec, 1
    buffer_store_dword v125, off, s[4:7], s48 sc1
    s_mov_b64 exec, -1
p2_inv:
p2_end:
    s_endpgm
.globl p3_kernel
.p2align 8
.type p3_kernel,@function
p3_kernel:
    s_cmp_ge_u32 s2, 1563
    s_cbranch_scc1 p3_end
    s_load_dwordx2 s[4:5], s[0:1], 0
    s_load_dwordx2 s[6:7], s[0:1], 24
    s_load_dwordx2 s[8:9], s[0:1], 40
    s_load_dwordx8 s[12:19], s[0:1], 56
    s_load_dwordx2 s[10:11], s[0:1], 88
    s_load_dwordx2 s[20:21], s[0:1], 104
    s_lshl_b32 s3, s2, 8
    v_add_u32 v0, s3, v0
    v_lshlrev_b32 v2, 4, v0
    v_lshlrev_b32 v3, 2, v0
    v_add_u32 v0, v0, v0
    v_mul_hi_u32_u24 v1, 343268, v0
    v_lshlrev_b16 v1, 4, v1
    s_waitcnt lgkmcnt(0)
    s_load_dwordx4 s[32:35], s[8:9], 0
    s_load_dwordx16 s[36:51], s[12:13], 0
    s_load_dwordx16 s[52:67], s[14:15], 0
    s_load_dwordx8 s[68:75], s[16:17], 0
    s_load_dwordx8 s[76:83], s[18:19], 0
    s_mov_b32 s24, s6
    s_and_b32 s25, s7, 0xffff
    s_mov_b32 s26, 1600000
    s_mov_b32 s27, 0x20000
    buffer_load_dword v4, v3, s[24:27], 0 offen nt
    s_mov_b32 s28, s20
    s_and_b32 s29, s21, 0xffff
    s_mov_b32 s30, 819200000
    s_mov_b32 s31, 0x20000
    s_mov_b32 s22, 491593728
    buffer_load_dwordx4 v[40:43], v2, s[28:31], s22 offen nt
    s_mov_b32 s22, 497999872
    buffer_load_dwordx4 v[44:47], v2, s[28:31], s22 offen nt
    s_mov_b32 s22, 504406016
    buffer_load_dwordx4 v[48:51], v2, s[28:31], s22 offen nt
    s_mov_b32 s22, 510812160
    buffer_load_dwordx4 v[52:55], v2, s[28:31], s22 offen nt
    s_mov_b32 s22, 491592704
    buffer_load_dwordx4 v[56:59], v1, s[28:31], s22 offen
    s_mov_b32 s24, s4
    s_and_b32 s25, s5, 0xffff
    s_mov_b32 s26, 6400000
    s_mov_b32 s27, 0x20000
    buffer_load_dwordx4 v[60:63], v2, s[24:27], 0 offen nt
    s_mov_b32 s24, s10
    s_and_b32 s25, s11, 0xffff
    s_mov_b32 s26, 6400000
    s_mov_b32 s27, 0x20000
    s_waitcnt vmcnt(6) lgkmcnt(0)
    v_and_b32 v5, 0xffff0000, v4
    v_lshlrev_b32 v4, 16, v4
    s_lshl_b32 s14, s32, 16
    s_and_b32 s15, s32, 0xffff0000
    v_pk_add_f32 v[8:9], v[4:5], s[14:15] op_sel:[0,0] op_sel_hi:[0,1] neg_lo:[0,1] neg_hi:[0,1]
    v_pk_add_f32 v[16:17], v[4:5], s[14:15] op_sel:[1,0] op_sel_hi:[1,1] neg_lo:[0,1] neg_hi:[0,1]
    s_lshl_b32 s16, s33, 16
    s_and_b32 s17, s33, 0xffff0000
    v_pk_add_f32 v[10:11], v[4:5], s[16:17] op_sel:[0,0] op_sel_hi:[0,1] neg_lo:[0,1] neg_hi:[0,1]
    v_pk_add_f32 v[18:19], v[4:5], s[16:17] op_sel:[1,0] op_sel_hi:[1,1] neg_lo:[0,1] neg_hi:[0,1]
    s_lshl_b32 s18, s34, 16
    s_and_b32 s19, s34, 0xffff0000
    v_pk_add_f32 v[12:13], v[4:5], s[18:19] op_sel:[0,0] op_sel_hi:[0,1] neg_lo:[0,1] neg_hi:[0,1]
    v_pk_add_f32 v[20:21], v[4:5], s[18:19] op_sel:[1,0] op_sel_hi:[1,1] neg_lo:[0,1] neg_hi:[0,1]
    s_lshl_b32 s12, s35, 16
    s_and_b32 s13, s35, 0xffff0000
    v_pk_add_f32 v[14:15], v[4:5], s[12:13] op_sel:[0,0] op_sel_hi:[0,1] neg_lo:[0,1] neg_hi:[0,1]
    v_pk_add_f32 v[22:23], v[4:5], s[12:13] op_sel:[1,0] op_sel_hi:[1,1] neg_lo:[0,1] neg_hi:[0,1]
    v_cvt_pk_bf16_f32 v8, v8, v9
    v_cvt_pk_bf16_f32 v10, v10, v11
    v_cvt_pk_bf16_f32 v12, v12, v13
    v_cvt_pk_bf16_f32 v14, v14, v15
    v_cvt_pk_bf16_f32 v16, v16, v17
    v_cvt_pk_bf16_f32 v18, v18, v19
    v_cvt_pk_bf16_f32 v20, v20, v21
    v_cvt_pk_bf16_f32 v22, v22, v23
    v_and_b32 v9, 0xffff0000, v8
    v_lshlrev_b32 v8, 16, v8
    v_and_b32 v11, 0xffff0000, v10
    v_lshlrev_b32 v10, 16, v10
    v_and_b32 v13, 0xffff0000, v12
    v_lshlrev_b32 v12, 16, v12
    v_and_b32 v15, 0xffff0000, v14
    v_lshlrev_b32 v14, 16, v14
    v_and_b32 v17, 0xffff0000, v16
    v_lshlrev_b32 v16, 16, v16
    v_and_b32 v19, 0xffff0000, v18
    v_lshlrev_b32 v18, 16, v18
    v_and_b32 v21, 0xffff0000, v20
    v_lshlrev_b32 v20, 16, v20
    v_and_b32 v23, 0xffff0000, v22
    v_lshlrev_b32 v22, 16, v22
    v_mul_f32 v8, v8, v8
    v_mul_f32 v9, v9, v9
    v_mul_f32 v10, v10, v10
    v_mul_f32 v11, v11, v11
    v_mul_f32 v12, v12, v12
    v_mul_f32 v13, v13, v13
    v_mul_f32 v14, v14, v14
    v_mul_f32 v15, v15, v15
    v_mul_f32 v16, v16, v16
    v_mul_f32 v17, v17, v17
    v_mul_f32 v18, v18, v18
    v_mul_f32 v19, v19, v19
    v_mul_f32 v20, v20, v20
    v_mul_f32 v21, v21, v21
    v_mul_f32 v22, v22, v22
    v_mul_f32 v23, v23, v23
    v_cvt_pk_bf16_f32 v8, v8, v9
    v_cvt_pk_bf16_f32 v10, v10, v11
    v_cvt_pk_bf16_f32 v12, v12, v13
    v_cvt_pk_bf16_f32 v14, v14, v15
    v_cvt_pk_bf16_f32 v16, v16, v17
    v_cvt_pk_bf16_f32 v18, v18, v19
    v_cvt_pk_bf16_f32 v20, v20, v21
    v_cvt_pk_bf16_f32 v22, v22, v23
    v_and_b32 v9, 0xffff0000, v8
    v_lshlrev_b32 v8, 16, v8
    v_and_b32 v11, 0xffff0000, v10
    v_lshlrev_b32 v10, 16, v10
    v_and_b32 v13, 0xffff0000, v12
    v_lshlrev_b32 v12, 16, v12
    v_and_b32 v15, 0xffff0000, v14
    v_lshlrev_b32 v14, 16, v14
    v_and_b32 v17, 0xffff0000, v16
    v_lshlrev_b32 v16, 16, v16
    v_and_b32 v19, 0xffff0000, v18
    v_lshlrev_b32 v18, 16, v18
    v_and_b32 v21, 0xffff0000, v20
    v_lshlrev_b32 v20, 16, v20
    v_and_b32 v23, 0xffff0000, v22
    v_lshlrev_b32 v22, 16, v22
    v_mul_f32 v8, 0xc1200000, v8
    v_mul_f32 v9, 0xc1200000, v9
    v_mul_f32 v10, 0xc1200000, v10
    v_mul_f32 v11, 0xc1200000, v11
    v_mul_f32 v12, 0xc1200000, v12
    v_mul_f32 v13, 0xc1200000, v13
    v_mul_f32 v14, 0xc1200000, v14
    v_mul_f32 v15, 0xc1200000, v15
    v_mul_f32 v16, 0xc1200000, v16
    v_mul_f32 v17, 0xc1200000, v17
    v_mul_f32 v18, 0xc1200000, v18
    v_mul_f32 v19, 0xc1200000, v19
    v_mul_f32 v20, 0xc1200000, v20
    v_mul_f32 v21, 0xc1200000, v21
    v_mul_f32 v22, 0xc1200000, v22
    v_mul_f32 v23, 0xc1200000, v23
    v_cvt_pk_bf16_f32 v8, v8, v9
    v_cvt_pk_bf16_f32 v10, v10, v11
    v_cvt_pk_bf16_f32 v12, v12, v13
    v_cvt_pk_bf16_f32 v14, v14, v15
    v_cvt_pk_bf16_f32 v16, v16, v17
    v_cvt_pk_bf16_f32 v18, v18, v19
    v_cvt_pk_bf16_f32 v20, v20, v21
    v_cvt_pk_bf16_f32 v22, v22, v23
    v_and_b32 v9, 0xffff0000, v8
    v_lshlrev_b32 v8, 16, v8
    v_and_b32 v11, 0xffff0000, v10
    v_lshlrev_b32 v10, 16, v10
    v_and_b32 v13, 0xffff0000, v12
    v_lshlrev_b32 v12, 16, v12
    v_and_b32 v15, 0xffff0000, v14
    v_lshlrev_b32 v14, 16, v14
    v_and_b32 v17, 0xffff0000, v16
    v_lshlrev_b32 v16, 16, v16
    v_and_b32 v19, 0xffff0000, v18
    v_lshlrev_b32 v18, 16, v18
    v_and_b32 v21, 0xffff0000, v20
    v_lshlrev_b32 v20, 16, v20
    v_and_b32 v23, 0xffff0000, v22
    v_lshlrev_b32 v22, 16, v22
    v_mul_f32 v8, 0x3fb8aa3b, v8
    v_mul_f32 v9, 0x3fb8aa3b, v9
    v_mul_f32 v10, 0x3fb8aa3b, v10
    v_mul_f32 v11, 0x3fb8aa3b, v11
    v_mul_f32 v12, 0x3fb8aa3b, v12
    v_mul_f32 v13, 0x3fb8aa3b, v13
    v_mul_f32 v14, 0x3fb8aa3b, v14
    v_mul_f32 v15, 0x3fb8aa3b, v15
    v_mul_f32 v16, 0x3fb8aa3b, v16
    v_mul_f32 v17, 0x3fb8aa3b, v17
    v_mul_f32 v18, 0x3fb8aa3b, v18
    v_mul_f32 v19, 0x3fb8aa3b, v19
    v_mul_f32 v20, 0x3fb8aa3b, v20
    v_mul_f32 v21, 0x3fb8aa3b, v21
    v_mul_f32 v22, 0x3fb8aa3b, v22
    v_mul_f32 v23, 0x3fb8aa3b, v23
    v_exp_f32 v8, v8
    v_exp_f32 v9, v9
    v_exp_f32 v10, v10
    v_exp_f32 v11, v11
    v_exp_f32 v12, v12
    v_exp_f32 v13, v13
    v_exp_f32 v14, v14
    v_exp_f32 v15, v15
    v_exp_f32 v16, v16
    v_exp_f32 v17, v17
    v_exp_f32 v18, v18
    v_exp_f32 v19, v19
    v_exp_f32 v20, v20
    v_exp_f32 v21, v21
    v_exp_f32 v22, v22
    v_exp_f32 v23, v23
    s_nop 0
    v_cvt_pk_bf16_f32 v8, v8, v9
    v_cvt_pk_bf16_f32 v10, v10, v11
    v_cvt_pk_bf16_f32 v12, v12, v13
    v_cvt_pk_bf16_f32 v14, v14, v15
    v_cvt_pk_bf16_f32 v16, v16, v17
    v_cvt_pk_bf16_f32 v18, v18, v19
    v_cvt_pk_bf16_f32 v20, v20, v21
    v_cvt_pk_bf16_f32 v22, v22, v23
    v_and_b32 v9, 0xffff0000, v8
    v_lshlrev_b32 v8, 16, v8
    v_and_b32 v11, 0xffff0000, v10
    v_lshlrev_b32 v10, 16, v10
    v_and_b32 v13, 0xffff0000, v12
    v_lshlrev_b32 v12, 16, v12
    v_and_b32 v15, 0xffff0000, v14
    v_lshlrev_b32 v14, 16, v14
    v_and_b32 v17, 0xffff0000, v16
    v_lshlrev_b32 v16, 16, v16
    v_and_b32 v19, 0xffff0000, v18
    v_lshlrev_b32 v18, 16, v18
    v_and_b32 v21, 0xffff0000, v20
    v_lshlrev_b32 v20, 16, v20
    v_and_b32 v23, 0xffff0000, v22
    v_lshlrev_b32 v22, 16, v22
    s_lshl_b32 s14, s52, 16
    s_and_b32 s15, s52, 0xffff0000
    v_pk_mul_f32 v[24:25], v[8:9], s[14:15] op_sel:[0,0] op_sel_hi:[0,1]
    v_pk_mul_f32 v[28:29], v[16:17], s[14:15] op_sel:[0,0] op_sel_hi:[0,1]
    s_lshl_b32 s16, s53, 16
    s_and_b32 s17, s53, 0xffff0000
    v_pk_mul_f32 v[26:27], v[8:9], s[16:17] op_sel:[0,0] op_sel_hi:[0,1]
    v_pk_mul_f32 v[30:31], v[16:17], s[16:17] op_sel:[0,0] op_sel_hi:[0,1]
    s_lshl_b32 s18, s54, 16
    s_and_b32 s19, s54, 0xffff0000
    v_pk_fma_f32 v[24:25], v[8:9], s[18:19], v[24:25] op_sel:[1,0,0] op_sel_hi:[1,1,1]
    v_pk_fma_f32 v[28:29], v[16:17], s[18:19], v[28:29] op_sel:[1,0,0] op_sel_hi:[1,1,1]
    s_lshl_b32 s12, s55, 16
    s_and_b32 s13, s55, 0xffff0000
    v_pk_fma_f32 v[26:27], v[8:9], s[12:13], v[26:27] op_sel:[1,0,0] op_sel_hi:[1,1,1]
    v_pk_fma_f32 v[30:31], v[16:17], s[12:13], v[30:31] op_sel:[1,0,0] op_sel_hi:[1,1,1]
    s_lshl_b32 s14, s56, 16
    s_and_b32 s15, s56, 0xffff0000
    v_pk_fma_f32 v[24:25], v[10:11], s[14:15], v[24:25] op_sel:[0,0,0] op_sel_hi:[0,1,1]
    v_pk_fma_f32 v[28:29], v[18:19], s[14:15], v[28:29] op_sel:[0,0,0] op_sel_hi:[0,1,1]
    s_lshl_b32 s16, s57, 16
    s_and_b32 s17, s57, 0xffff0000
    v_pk_fma_f32 v[26:27], v[10:11], s[16:17], v[26:27] op_sel:[0,0,0] op_sel_hi:[0,1,1]
    v_pk_fma_f32 v[30:31], v[18:19], s[16:17], v[30:31] op_sel:[0,0,0] op_sel_hi:[0,1,1]
    s_lshl_b32 s18, s58, 16
    s_and_b32 s19, s58, 0xffff0000
    v_pk_fma_f32 v[24:25], v[10:11], s[18:19], v[24:25] op_sel:[1,0,0] op_sel_hi:[1,1,1]
    v_pk_fma_f32 v[28:29], v[18:19], s[18:19], v[28:29] op_sel:[1,0,0] op_sel_hi:[1,1,1]
    s_lshl_b32 s12, s59, 16
    s_and_b32 s13, s59, 0xffff0000
    v_pk_fma_f32 v[26:27], v[10:11], s[12:13], v[26:27] op_sel:[1,0,0] op_sel_hi:[1,1,1]
    v_pk_fma_f32 v[30:31], v[18:19], s[12:13], v[30:31] op_sel:[1,0,0] op_sel_hi:[1,1,1]
    s_lshl_b32 s14, s60, 16
    s_and_b32 s15, s60, 0xffff0000
    v_pk_fma_f32 v[24:25], v[12:13], s[14:15], v[24:25] op_sel:[0,0,0] op_sel_hi:[0,1,1]
    v_pk_fma_f32 v[28:29], v[20:21], s[14:15], v[28:29] op_sel:[0,0,0] op_sel_hi:[0,1,1]
    s_lshl_b32 s16, s61, 16
    s_and_b32 s17, s61, 0xffff0000
    v_pk_fma_f32 v[26:27], v[12:13], s[16:17], v[26:27] op_sel:[0,0,0] op_sel_hi:[0,1,1]
    v_pk_fma_f32 v[30:31], v[20:21], s[16:17], v[30:31] op_sel:[0,0,0] op_sel_hi:[0,1,1]
    s_lshl_b32 s18, s62, 16
    s_and_b32 s19, s62, 0xffff0000
    v_pk_fma_f32 v[24:25], v[12:13], s[18:19], v[24:25] op_sel:[1,0,0] op_sel_hi:[1,1,1]
    v_pk_fma_f32 v[28:29], v[20:21], s[18:19], v[28:29] op_sel:[1,0,0] op_sel_hi:[1,1,1]
    s_lshl_b32 s12, s63, 16
    s_and_b32 s13, s63, 0xffff0000
    v_pk_fma_f32 v[26:27], v[12:13], s[12:13], v[26:27] op_sel:[1,0,0] op_sel_hi:[1,1,1]
    v_pk_fma_f32 v[30:31], v[20:21], s[12:13], v[30:31] op_sel:[1,0,0] op_sel_hi:[1,1,1]
    s_lshl_b32 s14, s64, 16
    s_and_b32 s15, s64, 0xffff0000
    v_pk_fma_f32 v[24:25], v[14:15], s[14:15], v[24:25] op_sel:[0,0,0] op_sel_hi:[0,1,1]
    v_pk_fma_f32 v[28:29], v[22:23], s[14:15], v[28:29] op_sel:[0,0,0] op_sel_hi:[0,1,1]
    s_lshl_b32 s16, s65, 16
    s_and_b32 s17, s65, 0xffff0000
    v_pk_fma_f32 v[26:27], v[14:15], s[16:17], v[26:27] op_sel:[0,0,0] op_sel_hi:[0,1,1]
    v_pk_fma_f32 v[30:31], v[22:23], s[16:17], v[30:31] op_sel:[0,0,0] op_sel_hi:[0,1,1]
    s_lshl_b32 s18, s66, 16
    s_and_b32 s19, s66, 0xffff0000
    v_pk_fma_f32 v[24:25], v[14:15], s[18:19], v[24:25] op_sel:[1,0,0] op_sel_hi:[1,1,1]
    v_pk_fma_f32 v[28:29], v[22:23], s[18:19], v[28:29] op_sel:[1,0,0] op_sel_hi:[1,1,1]
    s_lshl_b32 s12, s67, 16
    s_and_b32 s13, s67, 0xffff0000
    v_pk_fma_f32 v[26:27], v[14:15], s[12:13], v[26:27] op_sel:[1,0,0] op_sel_hi:[1,1,1]
    v_pk_fma_f32 v[30:31], v[22:23], s[12:13], v[30:31] op_sel:[1,0,0] op_sel_hi:[1,1,1]
    s_lshl_b32 s14, s36, 16
    s_and_b32 s15, s36, 0xffff0000
    v_pk_mul_f32 v[32:33], v[8:9], s[14:15] op_sel:[0,0] op_sel_hi:[0,1]
    v_pk_mul_f32 v[36:37], v[16:17], s[14:15] op_sel:[0,0] op_sel_hi:[0,1]
    s_lshl_b32 s16, s37, 16
    s_and_b32 s17, s37, 0xffff0000
    v_pk_mul_f32 v[34:35], v[8:9], s[16:17] op_sel:[0,0] op_sel_hi:[0,1]
    v_pk_mul_f32 v[38:39], v[16:17], s[16:17] op_sel:[0,0] op_sel_hi:[0,1]
    s_lshl_b32 s18, s38, 16
    s_and_b32 s19, s38, 0xffff0000
    v_pk_fma_f32 v[32:33], v[8:9], s[18:19], v[32:33] op_sel:[1,0,0] op_sel_hi:[1,1,1]
    v_pk_fma_f32 v[36:37], v[16:17], s[18:19], v[36:37] op_sel:[1,0,0] op_sel_hi:[1,1,1]
    s_lshl_b32 s12, s39, 16
    s_and_b32 s13, s39, 0xffff0000
    v_pk_fma_f32 v[34:35], v[8:9], s[12:13], v[34:35] op_sel:[1,0,0] op_sel_hi:[1,1,1]
    v_pk_fma_f32 v[38:39], v[16:17], s[12:13], v[38:39] op_sel:[1,0,0] op_sel_hi:[1,1,1]
    s_lshl_b32 s14, s40, 16
    s_and_b32 s15, s40, 0xffff0000
    v_pk_fma_f32 v[32:33], v[10:11], s[14:15], v[32:33] op_sel:[0,0,0] op_sel_hi:[0,1,1]
    v_pk_fma_f32 v[36:37], v[18:19], s[14:15], v[36:37] op_sel:[0,0,0] op_sel_hi:[0,1,1]
    s_lshl_b32 s16, s41, 16
    s_and_b32 s17, s41, 0xffff0000
    v_pk_fma_f32 v[34:35], v[10:11], s[16:17], v[34:35] op_sel:[0,0,0] op_sel_hi:[0,1,1]
    v_pk_fma_f32 v[38:39], v[18:19], s[16:17], v[38:39] op_sel:[0,0,0] op_sel_hi:[0,1,1]
    s_lshl_b32 s18, s42, 16
    s_and_b32 s19, s42, 0xffff0000
    v_pk_fma_f32 v[32:33], v[10:11], s[18:19], v[32:33] op_sel:[1,0,0] op_sel_hi:[1,1,1]
    v_pk_fma_f32 v[36:37], v[18:19], s[18:19], v[36:37] op_sel:[1,0,0] op_sel_hi:[1,1,1]
    s_lshl_b32 s12, s43, 16
    s_and_b32 s13, s43, 0xffff0000
    v_pk_fma_f32 v[34:35], v[10:11], s[12:13], v[34:35] op_sel:[1,0,0] op_sel_hi:[1,1,1]
    v_pk_fma_f32 v[38:39], v[18:19], s[12:13], v[38:39] op_sel:[1,0,0] op_sel_hi:[1,1,1]
    s_lshl_b32 s14, s44, 16
    s_and_b32 s15, s44, 0xffff0000
    v_pk_fma_f32 v[32:33], v[12:13], s[14:15], v[32:33] op_sel:[0,0,0] op_sel_hi:[0,1,1]
    v_pk_fma_f32 v[36:37], v[20:21], s[14:15], v[36:37] op_sel:[0,0,0] op_sel_hi:[0,1,1]
    s_lshl_b32 s16, s45, 16
    s_and_b32 s17, s45, 0xffff0000
    v_pk_fma_f32 v[34:35], v[12:13], s[16:17], v[34:35] op_sel:[0,0,0] op_sel_hi:[0,1,1]
    v_pk_fma_f32 v[38:39], v[20:21], s[16:17], v[38:39] op_sel:[0,0,0] op_sel_hi:[0,1,1]
    s_lshl_b32 s18, s46, 16
    s_and_b32 s19, s46, 0xffff0000
    v_pk_fma_f32 v[32:33], v[12:13], s[18:19], v[32:33] op_sel:[1,0,0] op_sel_hi:[1,1,1]
    v_pk_fma_f32 v[36:37], v[20:21], s[18:19], v[36:37] op_sel:[1,0,0] op_sel_hi:[1,1,1]
    s_lshl_b32 s12, s47, 16
    s_and_b32 s13, s47, 0xffff0000
    v_pk_fma_f32 v[34:35], v[12:13], s[12:13], v[34:35] op_sel:[1,0,0] op_sel_hi:[1,1,1]
    v_pk_fma_f32 v[38:39], v[20:21], s[12:13], v[38:39] op_sel:[1,0,0] op_sel_hi:[1,1,1]
    s_lshl_b32 s14, s48, 16
    s_and_b32 s15, s48, 0xffff0000
    v_pk_fma_f32 v[32:33], v[14:15], s[14:15], v[32:33] op_sel:[0,0,0] op_sel_hi:[0,1,1]
    v_pk_fma_f32 v[36:37], v[22:23], s[14:15], v[36:37] op_sel:[0,0,0] op_sel_hi:[0,1,1]
    s_lshl_b32 s16, s49, 16
    s_and_b32 s17, s49, 0xffff0000
    v_pk_fma_f32 v[34:35], v[14:15], s[16:17], v[34:35] op_sel:[0,0,0] op_sel_hi:[0,1,1]
    v_pk_fma_f32 v[38:39], v[22:23], s[16:17], v[38:39] op_sel:[0,0,0] op_sel_hi:[0,1,1]
    s_lshl_b32 s18, s50, 16
    s_and_b32 s19, s50, 0xffff0000
    v_pk_fma_f32 v[32:33], v[14:15], s[18:19], v[32:33] op_sel:[1,0,0] op_sel_hi:[1,1,1]
    v_pk_fma_f32 v[36:37], v[22:23], s[18:19], v[36:37] op_sel:[1,0,0] op_sel_hi:[1,1,1]
    s_lshl_b32 s12, s51, 16
    s_and_b32 s13, s51, 0xffff0000
    v_pk_fma_f32 v[34:35], v[14:15], s[12:13], v[34:35] op_sel:[1,0,0] op_sel_hi:[1,1,1]
    v_pk_fma_f32 v[38:39], v[22:23], s[12:13], v[38:39] op_sel:[1,0,0] op_sel_hi:[1,1,1]
    v_cvt_pk_bf16_f32 v32, v32, v33
    v_cvt_pk_bf16_f32 v34, v34, v35
    v_cvt_pk_bf16_f32 v36, v36, v37
    v_cvt_pk_bf16_f32 v38, v38, v39
    v_and_b32 v33, 0xffff0000, v32
    v_lshlrev_b32 v32, 16, v32
    v_and_b32 v35, 0xffff0000, v34
    v_lshlrev_b32 v34, 16, v34
    v_and_b32 v37, 0xffff0000, v36
    v_lshlrev_b32 v36, 16, v36
    v_and_b32 v39, 0xffff0000, v38
    v_lshlrev_b32 v38, 16, v38
    s_waitcnt vmcnt(1)
    v_add_u32 v40, v40, v44
    v_add_u32 v48, v48, v52
    v_add_u32 v41, v41, v45
    v_add_u32 v49, v49, v53
    v_add_u32 v42, v42, v46
    v_add_u32 v50, v50, v54
    v_add_u32 v43, v43, v47
    v_add_u32 v51, v51, v55
    v_add_u32_sdwa v8, v40, v48 dst_sel:DWORD dst_unused:UNUSED_PAD src0_sel:WORD_0 src1_sel:WORD_0
    v_add_u32_sdwa v9, v40, v48 dst_sel:DWORD dst_unused:UNUSED_PAD src0_sel:WORD_1 src1_sel:WORD_1
    v_add_u32_sdwa v10, v41, v49 dst_sel:DWORD dst_unused:UNUSED_PAD src0_sel:WORD_0 src1_sel:WORD_0
    v_add_u32_sdwa v11, v41, v49 dst_sel:DWORD dst_unused:UNUSED_PAD src0_sel:WORD_1 src1_sel:WORD_1
    v_add_u32_sdwa v12, v42, v50 dst_sel:DWORD dst_unused:UNUSED_PAD src0_sel:WORD_0 src1_sel:WORD_0
    v_add_u32_sdwa v13, v42, v50 dst_sel:DWORD dst_unused:UNUSED_PAD src0_sel:WORD_1 src1_sel:WORD_1
    v_add_u32_sdwa v14, v43, v51 dst_sel:DWORD dst_unused:UNUSED_PAD src0_sel:WORD_0 src1_sel:WORD_0
    v_add_u32_sdwa v15, v43, v51 dst_sel:DWORD dst_unused:UNUSED_PAD src0_sel:WORD_1 src1_sel:WORD_1
    v_min3_u32 v5, v56, v57, v58
    v_bitop3_b32 v4, v56, v57, v58 bitop3:0xfe
    v_min_u32 v5, v5, v59
    v_or_b32 v4, v4, v59
    v_or_b32 v8, 0x4b000000, v8
    v_or_b32 v9, 0x4b000000, v9
    v_or_b32 v10, 0x4b000000, v10
    v_or_b32 v11, 0x4b000000, v11
    v_or_b32 v12, 0x4b000000, v12
    v_or_b32 v13, 0x4b000000, v13
    v_or_b32 v14, 0x4b000000, v14
    v_or_b32 v15, 0x4b000000, v15
    v_cmp_eq_u32 vcc, 0, v5
    v_add_f32 v8, 0xcb010000, v8
    v_add_f32 v9, 0xcb010000, v9
    v_add_f32 v10, 0xcb010000, v10
    v_add_f32 v11, 0xcb010000, v11
    v_add_f32 v12, 0xcb010000, v12
    v_add_f32 v13, 0xcb010000, v13
    v_add_f32 v14, 0xcb010000, v14
    v_add_f32 v15, 0xcb010000, v15
    v_mul_f32 v8, v4, v8
    v_mul_f32 v9, v4, v9
    v_mul_f32 v10, v4, v10
    v_mul_f32 v11, v4, v11
    v_mul_f32 v12, v4, v12
    v_mul_f32 v13, v4, v13
    v_mul_f32 v14, v4, v14
    v_mul_f32 v15, v4, v15
    s_cbranch_vccz p3_nof
    v_lshlrev_b32 v1, 4, v0
    v_mov_b32 v3, 0x70000000
    v_cmp_eq_u32 vcc, 0, v56
    s_mov_b32 s22, 517218304
    s_nop 0
    v_cndmask_b32 v5, v3, v1, vcc
    buffer_load_dwordx4 v[16:19], v5, s[28:31], s22 offen
    buffer_load_dwordx4 v[20:23], v5, s[28:31], s22 offen offset:16
    s_waitcnt vmcnt(0)
    v_add_f32 v8, v8, v16
    v_add_f32 v9, v9, v17
    v_add_f32 v10, v10, v18
    v_add_f32 v11, v11, v19
    v_add_f32 v12, v12, v20
    v_add_f32 v13, v13, v21
    v_add_f32 v14, v14, v22
    v_add_f32 v15, v15, v23
    v_cmp_eq_u32 vcc, 0, v57
    s_mov_b32 s22, 530030592
    s_nop 0
    v_cndmask_b32 v5, v3, v1, vcc
    buffer_load_dwordx4 v[16:19], v5, s[28:31], s22 offen
    buffer_load_dwordx4 v[20:23], v5, s[28:31], s22 offen offset:16
    s_waitcnt vmcnt(0)
    v_add_f32 v8, v8, v16
    v_add_f32 v9, v9, v17
    v_add_f32 v10, v10, v18
    v_add_f32 v11, v11, v19
    v_add_f32 v12, v12, v20
    v_add_f32 v13, v13, v21
    v_add_f32 v14, v14, v22
    v_add_f32 v15, v15, v23
    v_cmp_eq_u32 vcc, 0, v58
    s_mov_b32 s22, 542842880
    s_nop 0
    v_cndmask_b32 v5, v3, v1, vcc
    buffer_load_dwordx4 v[16:19], v5, s[28:31], s22 offen
    buffer_load_dwordx4 v[20:23], v5, s[28:31], s22 offen offset:16
    s_waitcnt vmcnt(0)
    v_add_f32 v8, v8, v16
    v_add_f32 v9, v9, v17
    v_add_f32 v10, v10, v18
    v_add_f32 v11, v11, v19
    v_add_f32 v12, v12, v20
    v_add_f32 v13, v13, v21
    v_add_f32 v14, v14, v22
    v_add_f32 v15, v15, v23
    v_cmp_eq_u32 vcc, 0, v59
    s_mov_b32 s22, 555655168
    s_nop 0
    v_cndmask_b32 v5, v3, v1, vcc
    buffer_load_dwordx4 v[16:19], v5, s[28:31], s22 offen
    buffer_load_dwordx4 v[20:23], v5, s[28:31], s22 offen offset:16
    s_waitcnt vmcnt(0)
    v_add_f32 v8, v8, v16
    v_add_f32 v9, v9, v17
    v_add_f32 v10, v10, v18
    v_add_f32 v11, v11, v19
    v_add_f32 v12, v12, v20
    v_add_f32 v13, v13, v21
    v_add_f32 v14, v14, v22
    v_add_f32 v15, v15, v23
p3_nof:
    s_lshl_b32 s14, s68, 16
    s_and_b32 s15, s68, 0xffff0000
    v_pk_mul_f32 v[16:17], v[8:9], s[14:15] op_sel:[0,0] op_sel_hi:[0,1]
    v_pk_mul_f32 v[20:21], v[12:13], s[14:15] op_sel:[0,0] op_sel_hi:[0,1]
    s_lshl_b32 s16, s69, 16
    s_and_b32 s17, s69, 0xffff0000
    v_pk_mul_f32 v[18:19], v[8:9], s[16:17] op_sel:[0,0] op_sel_hi:[0,1]
    v_pk_mul_f32 v[22:23], v[12:13], s[16:17] op_sel:[0,0] op_sel_hi:[0,1]
    s_lshl_b32 s18, s70, 16
    s_and_b32 s19, s70, 0xffff0000
    v_pk_fma_f32 v[16:17], v[8:9], s[18:19], v[16:17] op_sel:[1,0,0] op_sel_hi:[1,1,1]
    v_pk_fma_f32 v[20:21], v[12:13], s[18:19], v[20:21] op_sel:[1,0,0] op_sel_hi:[1,1,1]
    s_lshl_b32 s12, s71, 16
    s_and_b32 s13, s71, 0xffff0000
    v_pk_fma_f32 v[18:19], v[8:9], s[12:13], v[18:19] op_sel:[1,0,0] op_sel_hi:[1,1,1]
    v_pk_fma_f32 v[22:23], v[12:13], s[12:13], v[22:23] op_sel:[1,0,0] op_sel_hi:[1,1,1]
    s_lshl_b32 s14, s72, 16
    s_and_b32 s15, s72, 0xffff0000
    v_pk_fma_f32 v[16:17], v[10:11], s[14:15], v[16:17] op_sel:[0,0,0] op_sel_hi:[0,1,1]
    v_pk_fma_f32 v[20:21], v[14:15], s[14:15], v[20:21] op_sel:[0,0,0] op_sel_hi:[0,1,1]
    s_lshl_b32 s16, s73, 16
    s_and_b32 s17, s73, 0xffff0000
    v_pk_fma_f32 v[18:19], v[10:11], s[16:17], v[18:19] op_sel:[0,0,0] op_sel_hi:[0,1,1]
    v_pk_fma_f32 v[22:23], v[14:15], s[16:17], v[22:23] op_sel:[0,0,0] op_sel_hi:[0,1,1]
    s_lshl_b32 s18, s74, 16
    s_and_b32 s19, s74, 0xffff0000
    v_pk_fma_f32 v[16:17], v[10:11], s[18:19], v[16:17] op_sel:[1,0,0] op_sel_hi:[1,1,1]
    v_pk_fma_f32 v[20:21], v[14:15], s[18:19], v[20:21] op_sel:[1,0,0] op_sel_hi:[1,1,1]
    s_lshl_b32 s12, s75, 16
    s_and_b32 s13, s75, 0xffff0000
    v_pk_fma_f32 v[18:19], v[10:11], s[12:13], v[18:19] op_sel:[1,0,0] op_sel_hi:[1,1,1]
    v_pk_fma_f32 v[22:23], v[14:15], s[12:13], v[22:23] op_sel:[1,0,0] op_sel_hi:[1,1,1]
    v_mul_f32 v24, v24, v16
    v_mul_f32 v25, v25, v17
    v_mul_f32 v26, v26, v18
    v_mul_f32 v27, v27, v19
    v_mul_f32 v28, v28, v20
    v_mul_f32 v29, v29, v21
    v_mul_f32 v30, v30, v22
    v_mul_f32 v31, v31, v23
    v_cvt_pk_bf16_f32 v24, v24, v25
    v_cvt_pk_bf16_f32 v26, v26, v27
    v_cvt_pk_bf16_f32 v28, v28, v29
    v_cvt_pk_bf16_f32 v30, v30, v31
    v_and_b32 v25, 0xffff0000, v24
    v_lshlrev_b32 v24, 16, v24
    v_and_b32 v27, 0xffff0000, v26
    v_lshlrev_b32 v26, 16, v26
    v_and_b32 v29, 0xffff0000, v28
    v_lshlrev_b32 v28, 16, v28
    v_and_b32 v31, 0xffff0000, v30
    v_lshlrev_b32 v30, 16, v30
    s_lshl_b32 s14, s76, 16
    s_and_b32 s15, s76, 0xffff0000
    v_pk_mul_f32 v[16:17], v[24:25], s[14:15] op_sel:[0,0] op_sel_hi:[0,1]
    v_pk_mul_f32 v[20:21], v[28:29], s[14:15] op_sel:[0,0] op_sel_hi:[0,1]
    s_lshl_b32 s16, s77, 16
    s_and_b32 s17, s77, 0xffff0000
    v_pk_mul_f32 v[18:19], v[24:25], s[16:17] op_sel:[0,0] op_sel_hi:[0,1]
    v_pk_mul_f32 v[22:23], v[28:29], s[16:17] op_sel:[0,0] op_sel_hi:[0,1]
    s_lshl_b32 s18, s78, 16
    s_and_b32 s19, s78, 0xffff0000
    v_pk_fma_f32 v[16:17], v[24:25], s[18:19], v[16:17] op_sel:[1,0,0] op_sel_hi:[1,1,1]
    v_pk_fma_f32 v[20:21], v[28:29], s[18:19], v[20:21] op_sel:[1,0,0] op_sel_hi:[1,1,1]
    s_lshl_b32 s12, s79, 16
    s_and_b32 s13, s79, 0xffff0000
    v_pk_fma_f32 v[18:19], v[24:25], s[12:13], v[18:19] op_sel:[1,0,0] op_sel_hi:[1,1,1]
    v_pk_fma_f32 v[22:23], v[28:29], s[12:13], v[22:23] op_sel:[1,0,0] op_sel_hi:[1,1,1]
    s_lshl_b32 s14, s80, 16
    s_and_b32 s15, s80, 0xffff0000
    v_pk_fma_f32 v[16:17], v[26:27], s[14:15], v[16:17] op_sel:[0,0,0] op_sel_hi:[0,1,1]
    v_pk_fma_f32 v[20:21], v[30:31], s[14:15], v[20:21] op_sel:[0,0,0] op_sel_hi:[0,1,1]
    s_lshl_b32 s16, s81, 16
    s_and_b32 s17, s81, 0xffff0000
    v_pk_fma_f32 v[18:19], v[26:27], s[16:17], v[18:19] op_sel:[0,0,0] op_sel_hi:[0,1,1]
    v_pk_fma_f32 v[22:23], v[30:31], s[16:17], v[22:23] op_sel:[0,0,0] op_sel_hi:[0,1,1]
    s_lshl_b32 s18, s82, 16
    s_and_b32 s19, s82, 0xffff0000
    v_pk_fma_f32 v[16:17], v[26:27], s[18:19], v[16:17] op_sel:[1,0,0] op_sel_hi:[1,1,1]
    v_pk_fma_f32 v[20:21], v[30:31], s[18:19], v[20:21] op_sel:[1,0,0] op_sel_hi:[1,1,1]
    s_lshl_b32 s12, s83, 16
    s_and_b32 s13, s83, 0xffff0000
    v_pk_fma_f32 v[18:19], v[26:27], s[12:13], v[18:19] op_sel:[1,0,0] op_sel_hi:[1,1,1]
    v_pk_fma_f32 v[22:23], v[30:31], s[12:13], v[22:23] op_sel:[1,0,0] op_sel_hi:[1,1,1]
    v_cvt_pk_bf16_f32 v16, v16, v17
    v_cvt_pk_bf16_f32 v18, v18, v19
    v_cvt_pk_bf16_f32 v20, v20, v21
    v_cvt_pk_bf16_f32 v22, v22, v23
    v_and_b32 v17, 0xffff0000, v16
    v_lshlrev_b32 v16, 16, v16
    v_and_b32 v19, 0xffff0000, v18
    v_lshlrev_b32 v18, 16, v18
    v_and_b32 v21, 0xffff0000, v20
    v_lshlrev_b32 v20, 16, v20
    v_and_b32 v23, 0xffff0000, v22
    v_lshlrev_b32 v22, 16, v22
    v_mul_f32 v16, v16, v32
    v_mul_f32 v17, v17, v33
    v_mul_f32 v18, v18, v34
    v_mul_f32 v19, v19, v35
    v_mul_f32 v20, v20, v36
    v_mul_f32 v21, v21, v37
    v_mul_f32 v22, v22, v38
    v_mul_f32 v23, v23, v39
    v_cvt_pk_bf16_f32 v16, v16, v17
    v_cvt_pk_bf16_f32 v18, v18, v19
    v_cvt_pk_bf16_f32 v20, v20, v21
    v_cvt_pk_bf16_f32 v22, v22, v23
    v_and_b32 v17, 0xffff0000, v16
    v_lshlrev_b32 v16, 16, v16
    v_and_b32 v19, 0xffff0000, v18
    v_lshlrev_b32 v18, 16, v18
    v_and_b32 v21, 0xffff0000, v20
    v_lshlrev_b32 v20, 16, v20
    v_and_b32 v23, 0xffff0000, v22
    v_lshlrev_b32 v22, 16, v22
    s_waitcnt vmcnt(0)
    v_lshlrev_b32 v8, 16, v60
    v_and_b32 v9, 0xffff0000, v60
    v_lshlrev_b32 v10, 16, v61
    v_and_b32 v11, 0xffff0000, v61
    v_lshlrev_b32 v12, 16, v62
    v_and_b32 v13, 0xffff0000, v62
    v_lshlrev_b32 v14, 16, v63
    v_and_b32 v15, 0xffff0000, v63
    v_add_f32 v8, v8, v16
    v_add_f32 v9, v9, v17
    v_add_f32 v10, v10, v18
    v_add_f32 v11, v11, v19
    v_add_f32 v12, v12, v20
    v_add_f32 v13, v13, v21
    v_add_f32 v14, v14, v22
    v_add_f32 v15, v15, v23
    v_cvt_pk_bf16_f32 v4, v8, v9
    v_cvt_pk_bf16_f32 v5, v10, v11
    v_cvt_pk_bf16_f32 v6, v12, v13
    v_cvt_pk_bf16_f32 v7, v14, v15
    buffer_store_dwordx4 v[4:7], v2, s[24:27], 0 offen nt
p3_end:
    s_endpgm
.section .rodata,"a"
.p2align 6
.amdhsa_kernel p1_kernel
  .amdhsa_next_free_vgpr 128
  .amdhsa_next_free_sgpr 72
  .amdhsa_accum_offset 128
  .amdhsa_group_segment_fixed_size 0
  .amdhsa_kernarg_size 112
  .amdhsa_user_sgpr_count 2
  .amdhsa_user_sgpr_kernarg_segment_ptr 1
  .amdhsa_system_sgpr_workgroup_id_x 1
  .amdhsa_float_denorm_mode_32 3
.end_amdhsa_kernel
.p2align 6
.amdhsa_kernel p2_kernel
  .amdhsa_next_free_vgpr 128
  .amdhsa_next_free_sgpr 72
  .amdhsa_accum_offset 128
  .amdhsa_group_segment_fixed_size 0
  .amdhsa_kernarg_size 112
  .amdhsa_user_sgpr_count 2
  .amdhsa_user_sgpr_kernarg_segment_ptr 1
  .amdhsa_system_sgpr_workgroup_id_x 1
  .amdhsa_float_denorm_mode_32 3
.end_amdhsa_kernel
.p2align 6
.amdhsa_kernel p3_kernel
  .amdhsa_next_free_vgpr 64
  .amdhsa_next_free_sgpr 84
  .amdhsa_accum_offset 64
  .amdhsa_group_segment_fixed_size 0
  .amdhsa_kernarg_size 112
  .amdhsa_user_sgpr_count 2
  .amdhsa_user_sgpr_kernarg_segment_ptr 1
  .amdhsa_system_sgpr_workgroup_id_x 1
  .amdhsa_float_denorm_mode_32 3
.end_amdhsa_kernel
```
